```python
import torch

def _softmax(x, axis=-1):
    return torch.softmax(x, dim=axis)

def _gelu(x):
    return torch.nn.functional.gelu(x, approximate='tanh')

def _silu(x):
    return torch.nn.functional.silu(x)

def _sigmoid(x):
    return torch.sigmoid(x)

def _layernorm(x, axis=-1, eps=1e-05):
    m = x.mean(dim=axis, keepdim=True)
    v = x.var(dim=axis, keepdim=True, unbiased=False)
    return (x - m) / torch.sqrt(v + eps)

def _scatter_add(tgt, idx, src, axis=0):
    return tgt.clone().index_add_(axis, idx, src)

def _segment_sum(src, seg, n):
    out = torch.zeros((n,) + src.shape[1:], dtype=src.dtype)
    return out.index_add_(0, seg, src)

def _pad(x, pw):
    flat = tuple((v for pair in reversed(pw) for v in pair))
    return torch.nn.functional.pad(x, flat)
kernel_name = 'adaLN_cond__sliding_block_cached__glu_gated_glu__decode'

def setup_inputs():

    _w = lambda a: (lambda t: t.to(torch.bfloat16) if t.is_floating_point() else t)(torch.as_tensor(a))

    def _A_setup():
        B, Sq, D = (8, 1, 512)
        Hq, Hkv, Sk, Dh = (32, 32, 4096, 128)
        assert Hq % Hkv == 0, (Hq, Hkv)
        return {'x': _w((lambda *s: torch.randn(*s, dtype=torch.bfloat16) * 0.05)(B, Sq, D)), 'k_cache': _w((lambda *s: torch.randn(*s, dtype=torch.bfloat16) * 3.2)(B, Hkv, Sk, Dh)), 'v_cache': _w((lambda *s: torch.randn(*s, dtype=torch.bfloat16) * 0.4)(B, Hkv, Sk, Dh)), 'wq': _w((lambda *s: torch.randn(*s, dtype=torch.bfloat16) * 3.2)(D, Hq * Dh) * D ** (-0.5)), 'wo': _w((lambda *s: torch.randn(*s, dtype=torch.bfloat16) * 0.4)(Hq * Dh, D) * (Hq * Dh) ** (-0.5))}
    _A_in = _A_setup()

    def _B_setup():
        B, S, D, F = (8, 1, 512, 1376)
        return {'x': _w((lambda *s: torch.randn(*s, dtype=torch.bfloat16) * 0.05)(B, S, D)), 'w_gate': _w((lambda *s: torch.randn(*s, dtype=torch.bfloat16) * 0.05)(D, F)), 'w_up': _w((lambda *s: torch.randn(*s, dtype=torch.bfloat16) * 0.05)(D, F)), 'w_down': _w((lambda *s: torch.randn(*s, dtype=torch.bfloat16) * 0.05)(F, D))}
    _B_in = _B_setup()
    return {'A_x': _A_in['x'], 'A_k_cache': _A_in['k_cache'], 'A_v_cache': _A_in['v_cache'], 'A_wq': _A_in['wq'], 'A_wo': _A_in['wo'], 'B_x': _B_in['x'], 'B_w_gate': _B_in['w_gate'], 'B_w_up': _B_in['w_up'], 'B_w_down': _B_in['w_down'], 'c': _w((lambda *s: torch.randn(*s, dtype=torch.bfloat16) * 0.1)(8, 512) * 8.0), 'w_mod': _w((lambda *s: torch.randn(*s, dtype=torch.bfloat16) * 0.1)(512, 6 * 512) * 512 ** (-0.5) * 8.0)}

def reference(A_x, A_k_cache, A_v_cache, A_wq, A_wo, B_x, B_w_gate, B_w_up, B_w_down, c, w_mod):

    def _A_ref(x, k_cache, v_cache, wq, wo):
        B, Sq, D = x.shape
        Hq, Dh = (32, 128)
        Hkv, Sk = (k_cache.shape[1], k_cache.shape[2])
        W = min(4096, max(256, Sk // 4))
        rep = Hq // Hkv
        q = (lambda x, *d: x.permute(*d))((x @ wq).reshape(B, Sq, Hq, Dh), 0, 2, 1, 3)
        k = (lambda x, n, axis: torch.repeat_interleave(x, n, dim=axis))(k_cache[:, :, Sk - W:, :], rep, axis=1)
        v = (lambda x, n, axis: torch.repeat_interleave(x, n, dim=axis))(v_cache[:, :, Sk - W:, :], rep, axis=1)
        scores = torch.einsum('bhqd,bhkd->bhqk', q, k) * Dh ** (-0.5)
        p = _softmax(scores, axis=-1)
        o = torch.einsum('bhqk,bhkd->bhqd', p, v)
        return (lambda x, *d: x.permute(*d))(o, 0, 2, 1, 3).reshape(B, Sq, Hq * Dh) @ wo

    def _B_ref(x, w_gate, w_up, w_down):
        g = torch.einsum('bsd,df->bsf', x, w_gate)
        u = torch.einsum('bsd,df->bsf', x, w_up)
        h = _sigmoid(g) * u
        return torch.einsum('bsf,fd->bsd', h, w_down)
    x = A_x
    mod = (_silu(c) @ w_mod).reshape(c.shape[0], 6, 1, -1)
    sa, ca, ga, sb, cb, gb = (mod[:, 0].clone(), mod[:, 1].clone(), mod[:, 2].clone(), mod[:, 3].clone(), mod[:, 4].clone(), mod[:, 5].clone())
    h = _layernorm(x, axis=-1) * (1 + ca) + sa
    x = x + ga * _A_ref(h, A_k_cache, A_v_cache, A_wq, A_wo)
    h = _layernorm(x, axis=-1) * (1 + cb) + sb
    x = x + gb * _B_ref(h, B_w_gate, B_w_up, B_w_down)
    return x
```

```asm
; @launch grid=(256,1,1) block=(512,1,1) lds=131072
.amdgcn_target "amdgcn-amd-amdhsa--gfx950"
.text
.globl adaLN_cond__sliding_block_cached__glu_gated_glu__decode_kernel
.p2align 8
.type adaLN_cond__sliding_block_cached__glu_gated_glu__decode_kernel,@function
adaLN_cond__sliding_block_cached__glu_gated_glu__decode_kernel:
L_code_begin:
s_load_dwordx16 s[4:19], s[0:1], 0
s_load_dwordx8 s[20:27], s[0:1], 64
s_load_dwordx4 s[28:31], s[0:1], 96
s_cmpk_ge_u32 s2, 256
s_cbranch_scc1 L_end
v_lshrrev_b32 v1, 6, v0
v_and_b32 v0, 63, v0
v_readfirstlane_b32 s3, v1
v_lshlrev_b32 v1, 4, v0
s_lshl_b32 s64, s2, 20
s_add_u32 s64, s64, 0xC0000
s_mov_b32 s42, 0x40000
s_mov_b32 s43, 0x20000
s_and_b32 s34, s3, 3
s_cmp_ge_u32 s3, 4
s_cbranch_scc1 L_helper
s_lshl_b32 s65, s34, 13
s_lshl_b32 s66, s2, 10
s_xor_b32 s65, s65, s66
s_waitcnt lgkmcnt(0)
s_add_u32 s40, s6, s64
s_addc_u32 s41, s7, 0
s_add_u32 s44, s8, s64
s_addc_u32 s45, s9, 0
buffer_load_dwordx4 v[8:11], v1, s[40:43], s65 offen nt
s_xor_b32 s64, s65, 32768
buffer_load_dwordx4 v[12:15], v1, s[40:43], s64 offen nt
s_xor_b32 s64, s65, 4096
buffer_load_dwordx4 v[16:19], v1, s[40:43], s64 offen nt
s_xor_b32 s64, s65, 36864
buffer_load_dwordx4 v[20:23], v1, s[40:43], s64 offen nt
s_barrier
s_branch L_srest
L_helper:
s_setprio 2
v_lshlrev_b32 v2, 2, v0
s_cmp_eq_u32 s3, 7
s_cbranch_scc0 L_nopf
s_getpc_b64 s[60:61]
L_pc:
s_lshr_b32 s66, s2, 3
s_lshl_b32 s66, s66, 10
v_add_u32 v10, s66, v1
v_min_u32 v10, L_code_end-L_pc-16, v10
global_load_dwordx4 v[12:15], v10, s[60:61]
v_subrev_u32 v3, 16, v0
v_ashrrev_i32 v3, 31, v3
ds_write_b32 v2, v3 offset:256
L_nopf:
s_and_b32 s67, s2, 7
s_lshr_b32 s68, s2, 3
v_and_b32 v38, 7, v0
v_lshrrev_b32 v37, 3, v0
s_cmp_eq_u32 s34, 0
s_cbranch_scc0 L_p0a
s_mov_b32 s70, 6
s_lshl_b32 s67, s67, 1
s_add_u32 s66, s67, 14
v_min_u32 v38, 5, v38
v_cmp_lt_u32 vcc, 1, v38
v_add_u32 v36, s66, v38
s_nop 0
v_cndmask_b32 v38, v38, v36, vcc
s_branch L_p0b
L_p0a:
s_lshl_b32 s67, s67, 3
s_lshl_b32 s65, s2, 3
s_and_b32 s65, s65, 0xff
s_lshr_b32 s66, s2, 5
s_or_b32 s65, s65, s66
s_cmp_eq_u32 s34, 2
s_cselect_b32 s70, 1, 8
s_cselect_b32 s68, s65, s68
s_cselect_b32 s67, 0, s67
L_p0b:
v_lshl_add_u32 v37, s68, 4, v37
v_mul_u32_u24 v37, s70, v37
v_lshl_add_u32 v38, v37, 3, v38
v_add_lshl_u32 v38, v38, s67, 7
s_lshl_b32 s70, s70, 13
v_add_u32 v39, s70, v38
s_sub_u32 s64, s2, 112
s_cmp_lt_u32 s64, 32
s_waitcnt lgkmcnt(0)
s_barrier
s_cbranch_scc1 L_jan
s_cmp_eq_u32 s34, 3
s_cbranch_scc1 L_p0_123
s_cmp_eq_u32 s34, 0
s_cselect_b32 s62, s24, s10
s_cselect_b32 s63, s25, s11
s_cmp_eq_u32 s34, 2
s_cselect_b32 s62, s12, s62
s_cselect_b32 s63, s13, s63
global_load_dword v12, v38, s[62:63]
global_load_dword v13, v39, s[62:63]
L_p0_123:
L_nop0:
s_cmp_eq_u32 s34, 3
s_cselect_b32 s64, 16, 0
s_cmp_lt_u32 s2, s64
s_cbranch_scc0 L_nopc
v_mov_b32 v4, -1
v_mov_b32 v5, -1
v_mov_b32 v6, -1
v_mov_b32 v7, -1
s_and_b32 s66, s2, 7
s_lshl_b32 s66, s66, 11
s_and_b32 s65, s2, 8
s_lshl_b32 s65, s65, 7
s_add_u32 s66, s66, s65
v_add_u32 v8, s66, v1
global_store_dwordx4 v8, v[4:7], s[30:31] sc1
s_lshl_b32 s66, s2, 2
v_mov_b32 v3, s66
s_waitcnt vmcnt(0)
s_mov_b64 exec, 1
global_store_dword v3, v4, s[28:29] sc1
s_mov_b64 exec, -1
L_nopc:
s_cmp_eq_u32 s34, 3
s_cbranch_scc0 L_w_124
s_and_b32 s67, s2, 7
s_lshr_b32 s68, s2, 3
s_min_u32 s64, s67, 3
s_mul_i32 s65, s67, 5
s_add_u32 s64, s64, s65
s_cmp_lt_u32 s67, 3
s_cselect_b32 s65, 6, 5
L_w_124:
s_lshr_b32 s32, s2, 5
s_and_b32 s33, s2, 31
s_and_b32 s67, s2, 7
s_lshr_b32 s68, s2, 3
s_sub_u32 s68, s68, 26
s_min_u32 s74, s67, 3
s_mul_i32 s66, s67, 5
s_add_u32 s74, s74, s66
s_add_u32 s74, s74, s68
s_cmp_lt_u32 s67, 3
s_cselect_b32 s66, 6, 5
s_cmp_lt_u32 s68, s66
s_cselect_b32 s74, s74, -1
s_cmp_lt_u32 s2, 48
s_cselect_b32 s66, 2, 3
s_cselect_b32 s72, 14+26, 42+26
s_cmp_lt_u32 s2, 16
s_cselect_b32 s66, 1, s66
s_cselect_b32 s72, 26, s72
s_lshl_b32 s66, s67, s66
s_add_u32 s72, s72, s66
s_add_u32 s72, s72, s68
s_mov_b32 s36, s30
s_mov_b32 s37, s31
s_mov_b32 s38, 0x1d0000
s_mov_b32 s39, 0x20000
s_mov_b32 s52, s28
s_mov_b32 s53, s29
s_mov_b32 s54, 0x100
s_mov_b32 s55, 0x20000
v_mov_b32 v9, 1
s_cmp_lt_u32 s2, 112
s_cbranch_scc0 L_norole
L_gemm:
v_and_b32 v16, 7, v0
v_lshlrev_b32 v16, 10, v16
v_and_b32 v17, 8, v0
v_lshl_add_u32 v16, v17, 3, v16
v_and_b32 v17, 48, v0
v_add_u32 v16, v16, v17
s_lshl_b32 s67, s34, 8
v_lshrrev_b32 v19, 3, v0
v_and_b32 v17, 2, v19
v_and_b32 v18, 7, v0
v_xor_b32 v17, v17, v18
v_xor_b32 v18, 4, v17
v_lshlrev_b32 v17, 4, v17
v_lshlrev_b32 v18, 4, v18
s_cmp_lt_u32 s2, 48
s_cbranch_scc0 L_gq0
s_mov_b32 s40, s24
s_mov_b32 s41, s25
s_mov_b32 s42, 0x300000
s_mov_b32 s43, 0x20000
s_mov_b32 s48, s22
s_mov_b32 s49, s23
s_mov_b32 s50, 0x2000
s_mov_b32 s51, 0x20000
s_mov_b32 s70, 6144
s_lshl_b32 s64, s72, 7
s_branch L_g1
L_gq0:
s_mov_b32 s40, s10
s_mov_b32 s41, s11
s_mov_b32 s42, 0x400000
s_mov_b32 s43, 0x20000
s_mov_b32 s48, s4
s_mov_b32 s49, s5
s_mov_b32 s50, 0x2000
s_mov_b32 s51, 0x20000
s_mov_b32 s70, 8192
s_sub_u32 s64, s72, 48
s_lshl_b32 s64, s64, 7
L_g1:
buffer_load_dwordx4 v[192:195], v16, s[48:51], s67 offen offset:0
buffer_load_dwordx4 v[196:199], v16, s[48:51], s67 offen offset:128
v_mul_lo_u32 v19, s70, v19
v_add_u32 v17, v17, v19
v_add_u32 v18, v18, v19
s_lshl_b32 s66, s70, 7
s_mul_i32 s66, s66, s34
s_add_u32 s64, s64, s66
s_lshl_b32 s70, s70, 3
s_lshl_b32 s65, s34, 13
s_add_u32 s65, s65, 4096
s_cmp_lt_u32 s2, 16
s_cselect_b32 s71, 0, 2
s_cmp_ge_u32 s2, 48
s_cselect_b32 s71, 1, s71
s_add_u32 m0, s65, 0
s_nop 0
buffer_load_dwordx4 v17, s[40:43], s64 offen  lds
s_add_u32 s64, s64, s70
s_add_u32 m0, s65, 1024
s_nop 0
buffer_load_dwordx4 v18, s[40:43], s64 offen  lds
s_add_u32 s64, s64, s70
s_cmp_eq_u32 s71, 2
s_cbranch_scc0 L_pace_125
s_waitcnt vmcnt(1)
L_pace_125:
s_add_u32 m0, s65, 2048
s_nop 0
buffer_load_dwordx4 v17, s[40:43], s64 offen  lds
s_add_u32 s64, s64, s70
s_cmp_eq_u32 s71, 0
s_cbranch_scc1 L_pace_126
s_waitcnt vmcnt(2)
s_cmp_eq_u32 s71, 2
s_cbranch_scc0 L_pace_126
s_waitcnt vmcnt(1)
L_pace_126:
s_add_u32 m0, s65, 3072
s_nop 0
buffer_load_dwordx4 v18, s[40:43], s64 offen  lds
s_add_u32 s64, s64, s70
s_cmp_eq_u32 s71, 0
s_cbranch_scc1 L_pace_127
s_waitcnt vmcnt(2)
s_cmp_eq_u32 s71, 2
s_cbranch_scc0 L_pace_127
s_waitcnt vmcnt(1)
L_pace_127:
s_add_u32 m0, s65, 4096
s_nop 0
buffer_load_dwordx4 v17, s[40:43], s64 offen  lds
s_add_u32 s64, s64, s70
s_cmp_eq_u32 s71, 0
s_cbranch_scc1 L_pace_128
s_waitcnt vmcnt(2)
s_cmp_eq_u32 s71, 2
s_cbranch_scc0 L_pace_128
s_waitcnt vmcnt(1)
L_pace_128:
s_add_u32 m0, s65, 5120
s_nop 0
buffer_load_dwordx4 v18, s[40:43], s64 offen  lds
s_add_u32 s64, s64, s70
s_cmp_eq_u32 s71, 0
s_cbranch_scc1 L_pace_129
s_waitcnt vmcnt(2)
s_cmp_eq_u32 s71, 2
s_cbranch_scc0 L_pace_129
s_waitcnt vmcnt(1)
L_pace_129:
s_add_u32 m0, s65, 6144
s_nop 0
buffer_load_dwordx4 v17, s[40:43], s64 offen  lds
s_add_u32 s64, s64, s70
s_cmp_eq_u32 s71, 0
s_cbranch_scc1 L_pace_130
s_waitcnt vmcnt(2)
s_cmp_eq_u32 s71, 2
s_cbranch_scc0 L_pace_130
s_waitcnt vmcnt(1)
L_pace_130:
s_add_u32 m0, s65, 7168
s_nop 0
buffer_load_dwordx4 v18, s[40:43], s64 offen  lds
s_add_u32 s64, s64, s70
s_cmp_eq_u32 s71, 0
s_cbranch_scc1 L_pace_131
s_waitcnt vmcnt(2)
s_cmp_eq_u32 s71, 2
s_cbranch_scc0 L_pace_131
s_waitcnt vmcnt(1)
L_pace_131:
s_add_u32 m0, s65, 32768
s_nop 0
buffer_load_dwordx4 v17, s[40:43], s64 offen  lds
s_add_u32 s64, s64, s70
s_cmp_eq_u32 s71, 0
s_cbranch_scc1 L_pace_132
s_waitcnt vmcnt(2)
s_cmp_eq_u32 s71, 2
s_cbranch_scc0 L_pace_132
s_waitcnt vmcnt(1)
L_pace_132:
s_add_u32 m0, s65, 33792
s_nop 0
buffer_load_dwordx4 v18, s[40:43], s64 offen  lds
s_add_u32 s64, s64, s70
s_cmp_eq_u32 s71, 0
s_cbranch_scc1 L_pace_133
s_waitcnt vmcnt(2)
s_cmp_eq_u32 s71, 2
s_cbranch_scc0 L_pace_133
s_waitcnt vmcnt(1)
L_pace_133:
s_add_u32 m0, s65, 34816
s_nop 0
buffer_load_dwordx4 v17, s[40:43], s64 offen  lds
s_add_u32 s64, s64, s70
s_cmp_eq_u32 s71, 0
s_cbranch_scc1 L_pace_134
s_waitcnt vmcnt(2)
s_cmp_eq_u32 s71, 2
s_cbranch_scc0 L_pace_134
s_waitcnt vmcnt(1)
L_pace_134:
s_add_u32 m0, s65, 35840
s_nop 0
buffer_load_dwordx4 v18, s[40:43], s64 offen  lds
s_add_u32 s64, s64, s70
s_cmp_eq_u32 s71, 0
s_cbranch_scc1 L_pace_135
s_waitcnt vmcnt(2)
s_cmp_eq_u32 s71, 2
s_cbranch_scc0 L_pace_135
s_waitcnt vmcnt(1)
L_pace_135:
s_add_u32 m0, s65, 36864
s_nop 0
buffer_load_dwordx4 v17, s[40:43], s64 offen  lds
s_add_u32 s64, s64, s70
s_cmp_eq_u32 s71, 0
s_cbranch_scc1 L_pace_136
s_waitcnt vmcnt(2)
s_cmp_eq_u32 s71, 2
s_cbranch_scc0 L_pace_136
s_waitcnt vmcnt(1)
L_pace_136:
s_add_u32 m0, s65, 37888
s_nop 0
buffer_load_dwordx4 v18, s[40:43], s64 offen  lds
s_add_u32 s64, s64, s70
s_cmp_eq_u32 s71, 0
s_cbranch_scc1 L_pace_137
s_waitcnt vmcnt(2)
s_cmp_eq_u32 s71, 2
s_cbranch_scc0 L_pace_137
s_waitcnt vmcnt(1)
L_pace_137:
s_add_u32 m0, s65, 38912
s_nop 0
buffer_load_dwordx4 v17, s[40:43], s64 offen  lds
s_add_u32 s64, s64, s70
s_cmp_eq_u32 s71, 0
s_cbranch_scc1 L_pace_138
s_waitcnt vmcnt(2)
s_cmp_eq_u32 s71, 2
s_cbranch_scc0 L_pace_138
s_waitcnt vmcnt(1)
L_pace_138:
s_add_u32 m0, s65, 39936
s_nop 0
buffer_load_dwordx4 v18, s[40:43], s64 offen  lds
s_add_u32 s64, s64, s70
s_waitcnt vmcnt(16)
s_cmp_eq_u32 s34, 0
s_cselect_b32 s73, 48, 0x1000
v_and_b32 v30, 15, v0
v_lshlrev_b32 v30, 2, v30
s_cmp_ge_u32 s2, s73
s_cbranch_scc0 L_fl_139
buffer_load_dword v31, v30, s[52:55], 0 offen sc1
L_fl_139:
s_mov_b32 s68, 0xffff0000
s_cmp_lt_u32 s2, 48
s_cbranch_scc0 L_gq1
s_mov_b32 s66, 0xbfb8aa3b
v_lshlrev_b32 v20, 16, v192
v_and_b32 v21, s68, v192
v_mul_f32 v22, s66, v20
v_mul_f32 v23, s66, v21
v_exp_f32 v22, v22
v_exp_f32 v23, v23
s_nop 0
v_add_f32 v22, 1.0, v22
v_add_f32 v23, 1.0, v23
v_rcp_f32 v22, v22
v_rcp_f32 v23, v23
s_nop 0
v_mul_f32 v20, v20, v22
v_mul_f32 v21, v21, v23
v_cvt_pk_bf16_f32 v48, v20, v21
v_lshlrev_b32 v20, 16, v193
v_and_b32 v21, s68, v193
v_mul_f32 v22, s66, v20
v_mul_f32 v23, s66, v21
v_exp_f32 v22, v22
v_exp_f32 v23, v23
s_nop 0
v_add_f32 v22, 1.0, v22
v_add_f32 v23, 1.0, v23
v_rcp_f32 v22, v22
v_rcp_f32 v23, v23
s_nop 0
v_mul_f32 v20, v20, v22
v_mul_f32 v21, v21, v23
v_cvt_pk_bf16_f32 v49, v20, v21
v_lshlrev_b32 v20, 16, v194
v_and_b32 v21, s68, v194
v_mul_f32 v22, s66, v20
v_mul_f32 v23, s66, v21
v_exp_f32 v22, v22
v_exp_f32 v23, v23
s_nop 0
v_add_f32 v22, 1.0, v22
v_add_f32 v23, 1.0, v23
v_rcp_f32 v22, v22
v_rcp_f32 v23, v23
s_nop 0
v_mul_f32 v20, v20, v22
v_mul_f32 v21, v21, v23
v_cvt_pk_bf16_f32 v50, v20, v21
v_lshlrev_b32 v20, 16, v195
v_and_b32 v21, s68, v195
v_mul_f32 v22, s66, v20
v_mul_f32 v23, s66, v21
v_exp_f32 v22, v22
v_exp_f32 v23, v23
s_nop 0
v_add_f32 v22, 1.0, v22
v_add_f32 v23, 1.0, v23
v_rcp_f32 v22, v22
v_rcp_f32 v23, v23
s_nop 0
v_mul_f32 v20, v20, v22
v_mul_f32 v21, v21, v23
v_cvt_pk_bf16_f32 v51, v20, v21
v_lshlrev_b32 v20, 16, v196
v_and_b32 v21, s68, v196
v_mul_f32 v22, s66, v20
v_mul_f32 v23, s66, v21
v_exp_f32 v22, v22
v_exp_f32 v23, v23
s_nop 0
v_add_f32 v22, 1.0, v22
v_add_f32 v23, 1.0, v23
v_rcp_f32 v22, v22
v_rcp_f32 v23, v23
s_nop 0
v_mul_f32 v20, v20, v22
v_mul_f32 v21, v21, v23
v_cvt_pk_bf16_f32 v52, v20, v21
v_lshlrev_b32 v20, 16, v197
v_and_b32 v21, s68, v197
v_mul_f32 v22, s66, v20
v_mul_f32 v23, s66, v21
v_exp_f32 v22, v22
v_exp_f32 v23, v23
s_nop 0
v_add_f32 v22, 1.0, v22
v_add_f32 v23, 1.0, v23
v_rcp_f32 v22, v22
v_rcp_f32 v23, v23
s_nop 0
v_mul_f32 v20, v20, v22
v_mul_f32 v21, v21, v23
v_cvt_pk_bf16_f32 v53, v20, v21
v_lshlrev_b32 v20, 16, v198
v_and_b32 v21, s68, v198
v_mul_f32 v22, s66, v20
v_mul_f32 v23, s66, v21
v_exp_f32 v22, v22
v_exp_f32 v23, v23
s_nop 0
v_add_f32 v22, 1.0, v22
v_add_f32 v23, 1.0, v23
v_rcp_f32 v22, v22
v_rcp_f32 v23, v23
s_nop 0
v_mul_f32 v20, v20, v22
v_mul_f32 v21, v21, v23
v_cvt_pk_bf16_f32 v54, v20, v21
v_lshlrev_b32 v20, 16, v199
v_and_b32 v21, s68, v199
v_mul_f32 v22, s66, v20
v_mul_f32 v23, s66, v21
v_exp_f32 v22, v22
v_exp_f32 v23, v23
s_nop 0
v_add_f32 v22, 1.0, v22
v_add_f32 v23, 1.0, v23
v_rcp_f32 v22, v22
v_rcp_f32 v23, v23
s_nop 0
v_mul_f32 v20, v20, v22
v_mul_f32 v21, v21, v23
v_cvt_pk_bf16_f32 v55, v20, v21
s_branch L_g2
L_gq1:
v_and_b32 v32, 7, v0
v_lshlrev_b32 v32, 2, v32
v_lshlrev_b32 v96, 16, v192
v_and_b32 v97, s68, v192
v_lshlrev_b32 v98, 16, v193
v_and_b32 v99, s68, v193
v_lshlrev_b32 v100, 16, v194
v_and_b32 v101, s68, v194
v_lshlrev_b32 v102, 16, v195
v_and_b32 v103, s68, v195
v_lshlrev_b32 v104, 16, v196
v_and_b32 v105, s68, v196
v_lshlrev_b32 v106, 16, v197
v_and_b32 v107, s68, v197
v_lshlrev_b32 v108, 16, v198
v_and_b32 v109, s68, v198
v_lshlrev_b32 v110, 16, v199
v_and_b32 v111, s68, v199
v_add_f32 v20, v96, v97
v_add_f32 v20, v20, v98
v_add_f32 v20, v20, v99
v_add_f32 v20, v20, v100
v_add_f32 v20, v20, v101
v_add_f32 v20, v20, v102
v_add_f32 v20, v20, v103
v_add_f32 v20, v20, v104
v_add_f32 v20, v20, v105
v_add_f32 v20, v20, v106
v_add_f32 v20, v20, v107
v_add_f32 v20, v20, v108
v_add_f32 v20, v20, v109
v_add_f32 v20, v20, v110
v_add_f32 v20, v20, v111
s_nop 1
v_add_f32_dpp v20, v20, v20 row_ror:8 row_mask:0xf bank_mask:0xf
v_mov_b32 v22, v20
s_nop 1
v_permlane16_swap_b32 v20, v22
s_nop 1
v_add_f32 v20, v20, v22
v_mov_b32 v22, v20
s_nop 1
v_permlane32_swap_b32 v20, v22
s_nop 1
v_add_f32 v20, v20, v22
v_mul_f32 v20, 0x3c000000, v20
v_mov_b32 v21, 0
v_sub_f32 v22, v96, v20
v_fmac_f32 v21, v22, v22
v_sub_f32 v22, v97, v20
v_fmac_f32 v21, v22, v22
v_sub_f32 v22, v98, v20
v_fmac_f32 v21, v22, v22
v_sub_f32 v22, v99, v20
v_fmac_f32 v21, v22, v22
v_sub_f32 v22, v100, v20
v_fmac_f32 v21, v22, v22
v_sub_f32 v22, v101, v20
v_fmac_f32 v21, v22, v22
v_sub_f32 v22, v102, v20
v_fmac_f32 v21, v22, v22
v_sub_f32 v22, v103, v20
v_fmac_f32 v21, v22, v22
v_sub_f32 v22, v104, v20
v_fmac_f32 v21, v22, v22
v_sub_f32 v22, v105, v20
v_fmac_f32 v21, v22, v22
v_sub_f32 v22, v106, v20
v_fmac_f32 v21, v22, v22
v_sub_f32 v22, v107, v20
v_fmac_f32 v21, v22, v22
v_sub_f32 v22, v108, v20
v_fmac_f32 v21, v22, v22
v_sub_f32 v22, v109, v20
v_fmac_f32 v21, v22, v22
v_sub_f32 v22, v110, v20
v_fmac_f32 v21, v22, v22
v_sub_f32 v22, v111, v20
v_fmac_f32 v21, v22, v22
s_nop 1
v_add_f32_dpp v21, v21, v21 row_ror:8 row_mask:0xf bank_mask:0xf
v_mov_b32 v22, v21
s_nop 1
v_permlane16_swap_b32 v21, v22
s_nop 1
v_add_f32 v21, v21, v22
v_mov_b32 v22, v21
s_nop 1
v_permlane32_swap_b32 v21, v22
s_nop 1
v_add_f32 v21, v21, v22
v_lshlrev_b32 v22, 1, v32
s_lshl_b32 s66, s34, 6
v_add_u32 v23, s66, v22
ds_write_b64 v23, v[20:21] offset:0
v_mov_b32 v23, 0
s_waitcnt lgkmcnt(0)
s_mov_b64 exec, 1
ds_add_u32 v23, v9 offset:332
s_mov_b64 exec, -1
s_mov_b32 s75, 0
L_poll_140:
ds_read_b32 v24, v23 offset:332
s_waitcnt lgkmcnt(0)
v_cmp_gt_u32 vcc, 4, v24
s_cbranch_vccz L_pollx_141
s_add_u32 s75, s75, 1
s_cmp_lt_u32 s75, 0x1000000
s_cbranch_scc1 L_poll_140
L_pollx_141:
ds_read_b64 v[112:113], v22 offset:0
ds_read_b64 v[114:115], v22 offset:64
ds_read_b64 v[116:117], v22 offset:128
ds_read_b64 v[118:119], v22 offset:192
s_waitcnt lgkmcnt(0)
v_add_f32 v20, v112, v114
v_add_f32 v21, v116, v118
v_add_f32 v20, v20, v21
v_mul_f32 v20, 0x3e800000, v20
v_add_f32 v24, v113, v115
v_add_f32 v21, v117, v119
v_add_f32 v24, v24, v21
v_mov_b32 v21, 0
v_sub_f32 v22, v112, v20
v_fmac_f32 v21, v22, v22
v_sub_f32 v22, v114, v20
v_fmac_f32 v21, v22, v22
v_sub_f32 v22, v116, v20
v_fmac_f32 v21, v22, v22
v_sub_f32 v22, v118, v20
v_fmac_f32 v21, v22, v22
v_fmac_f32 v24, 0x43000000, v21
v_mul_f32 v24, 0x3b000000, v24
v_cvt_pk_bf16_f32 v24, 0, v24
v_cvt_pk_bf16_f32 v20, 0, v20
v_add_f32 v24, 0x3727c5ac, v24
v_cvt_pk_bf16_f32 v24, 0, v24
v_sqrt_f32 v24, v24
s_nop 0
v_cvt_pk_bf16_f32 v24, 0, v24
v_rcp_f32 v24, v24
s_nop 0
v_sub_f32 v96, v96, v20
v_cvt_pk_bf16_f32 v96, 0, v96
v_mul_f32 v96, v96, v24
v_cvt_pk_bf16_f32 v96, 0, v96
v_sub_f32 v97, v97, v20
v_cvt_pk_bf16_f32 v97, 0, v97
v_mul_f32 v97, v97, v24
v_cvt_pk_bf16_f32 v97, 0, v97
v_sub_f32 v98, v98, v20
v_cvt_pk_bf16_f32 v98, 0, v98
v_mul_f32 v98, v98, v24
v_cvt_pk_bf16_f32 v98, 0, v98
v_sub_f32 v99, v99, v20
v_cvt_pk_bf16_f32 v99, 0, v99
v_mul_f32 v99, v99, v24
v_cvt_pk_bf16_f32 v99, 0, v99
v_sub_f32 v100, v100, v20
v_cvt_pk_bf16_f32 v100, 0, v100
v_mul_f32 v100, v100, v24
v_cvt_pk_bf16_f32 v100, 0, v100
v_sub_f32 v101, v101, v20
v_cvt_pk_bf16_f32 v101, 0, v101
v_mul_f32 v101, v101, v24
v_cvt_pk_bf16_f32 v101, 0, v101
v_sub_f32 v102, v102, v20
v_cvt_pk_bf16_f32 v102, 0, v102
v_mul_f32 v102, v102, v24
v_cvt_pk_bf16_f32 v102, 0, v102
v_sub_f32 v103, v103, v20
v_cvt_pk_bf16_f32 v103, 0, v103
v_mul_f32 v103, v103, v24
v_cvt_pk_bf16_f32 v103, 0, v103
v_sub_f32 v104, v104, v20
v_cvt_pk_bf16_f32 v104, 0, v104
v_mul_f32 v104, v104, v24
v_cvt_pk_bf16_f32 v104, 0, v104
v_sub_f32 v105, v105, v20
v_cvt_pk_bf16_f32 v105, 0, v105
v_mul_f32 v105, v105, v24
v_cvt_pk_bf16_f32 v105, 0, v105
v_sub_f32 v106, v106, v20
v_cvt_pk_bf16_f32 v106, 0, v106
v_mul_f32 v106, v106, v24
v_cvt_pk_bf16_f32 v106, 0, v106
v_sub_f32 v107, v107, v20
v_cvt_pk_bf16_f32 v107, 0, v107
v_mul_f32 v107, v107, v24
v_cvt_pk_bf16_f32 v107, 0, v107
v_sub_f32 v108, v108, v20
v_cvt_pk_bf16_f32 v108, 0, v108
v_mul_f32 v108, v108, v24
v_cvt_pk_bf16_f32 v108, 0, v108
v_sub_f32 v109, v109, v20
v_cvt_pk_bf16_f32 v109, 0, v109
v_mul_f32 v109, v109, v24
v_cvt_pk_bf16_f32 v109, 0, v109
v_sub_f32 v110, v110, v20
v_cvt_pk_bf16_f32 v110, 0, v110
v_mul_f32 v110, v110, v24
v_cvt_pk_bf16_f32 v110, 0, v110
v_sub_f32 v111, v111, v20
v_cvt_pk_bf16_f32 v111, 0, v111
v_mul_f32 v111, v111, v24
v_cvt_pk_bf16_f32 v111, 0, v111
L_g2:
s_cmp_ge_u32 s2, s73
s_cbranch_scc0 L_fl_142
s_waitcnt vmcnt(0)
v_cmp_eq_u32 vcc, 0, v31
s_cbranch_vccz L_fl_142
s_mov_b32 s75, 0
L_poll_143:
buffer_load_dword v31, v30, s[52:55], 0 offen sc1
s_waitcnt vmcnt(0)
v_cmp_eq_u32 vcc, 0, v31
s_cbranch_vccz L_pollx_144
s_sleep 40
s_add_u32 s75, s75, 1
s_cmp_lt_u32 s75, 0x100000
s_cbranch_scc1 L_poll_143
L_pollx_144:
L_fl_142:
v_mov_b32 v20, 0
s_cmp_eq_u32 s34, 0
s_cbranch_scc0 L_w_145
ds_write_b32 v20, v9 offset:324
L_w_145:
v_lshrrev_b32 v18, 4, v0
v_bfe_u32 v19, v0, 2, 2
v_lshrrev_b32 v20, 1, v19
v_and_b32 v21, 1, v18
v_lshl_add_u32 v20, v21, 1, v20
v_lshlrev_b32 v20, 5, v20
v_lshl_add_u32 v20, v18, 10, v20
v_lshl_add_u32 v20, v19, 7, v20
v_and_b32 v21, 3, v0
v_lshl_add_u32 v20, v21, 3, v20
v_add_u32 v40, s65, v20
v_xor_b32 v41, 32, v40
v_xor_b32 v42, 64, v40
v_xor_b32 v43, 96, v40
s_waitcnt vmcnt(12) lgkmcnt(0)
ds_read_b64_tr_b16 v[128:129], v40 offset:0
ds_read_b64_tr_b16 v[130:131], v40 offset:512
ds_read_b64_tr_b16 v[132:133], v41 offset:0
ds_read_b64_tr_b16 v[134:135], v41 offset:512
ds_read_b64_tr_b16 v[136:137], v42 offset:0
ds_read_b64_tr_b16 v[138:139], v42 offset:512
ds_read_b64_tr_b16 v[140:141], v43 offset:0
ds_read_b64_tr_b16 v[142:143], v43 offset:512
s_waitcnt vmcnt(8) lgkmcnt(0)
ds_read_b64_tr_b16 v[144:145], v40 offset:4096
ds_read_b64_tr_b16 v[146:147], v40 offset:4608
ds_read_b64_tr_b16 v[148:149], v41 offset:4096
ds_read_b64_tr_b16 v[150:151], v41 offset:4608
ds_read_b64_tr_b16 v[152:153], v42 offset:4096
ds_read_b64_tr_b16 v[154:155], v42 offset:4608
ds_read_b64_tr_b16 v[156:157], v43 offset:4096
ds_read_b64_tr_b16 v[158:159], v43 offset:4608
s_waitcnt vmcnt(4) lgkmcnt(0)
ds_read_b64_tr_b16 v[160:161], v40 offset:32768
ds_read_b64_tr_b16 v[162:163], v40 offset:33280
ds_read_b64_tr_b16 v[164:165], v41 offset:32768
ds_read_b64_tr_b16 v[166:167], v41 offset:33280
ds_read_b64_tr_b16 v[168:169], v42 offset:32768
ds_read_b64_tr_b16 v[170:171], v42 offset:33280
ds_read_b64_tr_b16 v[172:173], v43 offset:32768
ds_read_b64_tr_b16 v[174:175], v43 offset:33280
s_waitcnt vmcnt(0) lgkmcnt(0)
ds_read_b64_tr_b16 v[176:177], v40 offset:36864
ds_read_b64_tr_b16 v[178:179], v40 offset:37376
ds_read_b64_tr_b16 v[180:181], v41 offset:36864
ds_read_b64_tr_b16 v[182:183], v41 offset:37376
ds_read_b64_tr_b16 v[184:185], v42 offset:36864
ds_read_b64_tr_b16 v[186:187], v42 offset:37376
ds_read_b64_tr_b16 v[188:189], v43 offset:36864
ds_read_b64_tr_b16 v[190:191], v43 offset:37376
s_waitcnt lgkmcnt(0)
s_cmp_eq_u32 s34, 2
s_cselect_b32 s73, 16, 0x1000
v_and_b32 v30, 31, v0
v_lshlrev_b32 v30, 2, v30
s_cmp_ge_u32 s2, s73
s_cbranch_scc0 L_fl_146
buffer_load_dword v31, v30, s[52:55], 0 offen offset:128 sc1
L_fl_146:
s_cmp_lt_u32 s2, 48
s_cbranch_scc1 L_g3
v_mov_b32 v20, 0
s_mov_b32 s75, 0
L_poll_147:
ds_read_b32 v22, v20 offset:324
s_waitcnt lgkmcnt(0)
v_cmp_eq_u32 vcc, 0, v22
s_cbranch_vccz L_pollx_148
s_sleep 1
s_add_u32 s75, s75, 1
s_cmp_lt_u32 s75, 0x1000000
s_cbranch_scc1 L_poll_147
L_pollx_148:
s_lshl_b32 s64, s34, 11
s_add_u32 s64, s64, 0
s_add_u32 s66, s64, 8192
s_mov_b32 s75, 0
L_poll_149:
buffer_load_dwordx4 v[192:195], v1, s[36:39], s64 offen offset:0 sc1
buffer_load_dwordx4 v[200:203], v1, s[36:39], s66 offen offset:0 sc1
buffer_load_dwordx4 v[196:199], v1, s[36:39], s64 offen offset:1024 sc1
buffer_load_dwordx4 v[204:207], v1, s[36:39], s66 offen offset:1024 sc1
s_waitcnt vmcnt(0)
v_max3_u32 v22, v192, v193, v194
v_max3_u32 v22, v22, v195, v196
v_max3_u32 v22, v22, v197, v198
v_max3_u32 v22, v22, v199, v200
v_max3_u32 v22, v22, v201, v202
v_max3_u32 v22, v22, v203, v204
v_max3_u32 v22, v22, v205, v206
v_max_u32 v22, v22, v207
v_cmp_eq_u32 vcc, -1, v22
s_cbranch_vccz L_pollx_150
s_sleep 16
s_add_u32 s75, s75, 1
s_cmp_lt_u32 s75, 0x100000
s_cbranch_scc1 L_poll_149
L_pollx_150:
v_lshlrev_b32 v20, 16, v200
v_and_b32 v21, s68, v200
v_add_f32 v20, 1.0, v20
v_add_f32 v21, 1.0, v21
v_cvt_pk_bf16_f32 v20, 0, v20
v_cvt_pk_bf16_f32 v21, 0, v21
v_mul_f32 v20, v20, v96
v_mul_f32 v21, v21, v97
v_cvt_pk_bf16_f32 v20, 0, v20
v_cvt_pk_bf16_f32 v21, 0, v21
v_lshlrev_b32 v22, 16, v192
v_and_b32 v23, s68, v192
v_add_f32 v20, v20, v22
v_add_f32 v21, v21, v23
v_cvt_pk_bf16_f32 v48, v20, v21
v_lshlrev_b32 v20, 16, v201
v_and_b32 v21, s68, v201
v_add_f32 v20, 1.0, v20
v_add_f32 v21, 1.0, v21
v_cvt_pk_bf16_f32 v20, 0, v20
v_cvt_pk_bf16_f32 v21, 0, v21
v_mul_f32 v20, v20, v98
v_mul_f32 v21, v21, v99
v_cvt_pk_bf16_f32 v20, 0, v20
v_cvt_pk_bf16_f32 v21, 0, v21
v_lshlrev_b32 v22, 16, v193
v_and_b32 v23, s68, v193
v_add_f32 v20, v20, v22
v_add_f32 v21, v21, v23
v_cvt_pk_bf16_f32 v49, v20, v21
v_lshlrev_b32 v20, 16, v202
v_and_b32 v21, s68, v202
v_add_f32 v20, 1.0, v20
v_add_f32 v21, 1.0, v21
v_cvt_pk_bf16_f32 v20, 0, v20
v_cvt_pk_bf16_f32 v21, 0, v21
v_mul_f32 v20, v20, v100
v_mul_f32 v21, v21, v101
v_cvt_pk_bf16_f32 v20, 0, v20
v_cvt_pk_bf16_f32 v21, 0, v21
v_lshlrev_b32 v22, 16, v194
v_and_b32 v23, s68, v194
v_add_f32 v20, v20, v22
v_add_f32 v21, v21, v23
v_cvt_pk_bf16_f32 v50, v20, v21
v_lshlrev_b32 v20, 16, v203
v_and_b32 v21, s68, v203
v_add_f32 v20, 1.0, v20
v_add_f32 v21, 1.0, v21
v_cvt_pk_bf16_f32 v20, 0, v20
v_cvt_pk_bf16_f32 v21, 0, v21
v_mul_f32 v20, v20, v102
v_mul_f32 v21, v21, v103
v_cvt_pk_bf16_f32 v20, 0, v20
v_cvt_pk_bf16_f32 v21, 0, v21
v_lshlrev_b32 v22, 16, v195
v_and_b32 v23, s68, v195
v_add_f32 v20, v20, v22
v_add_f32 v21, v21, v23
v_cvt_pk_bf16_f32 v51, v20, v21
v_lshlrev_b32 v20, 16, v204
v_and_b32 v21, s68, v204
v_add_f32 v20, 1.0, v20
v_add_f32 v21, 1.0, v21
v_cvt_pk_bf16_f32 v20, 0, v20
v_cvt_pk_bf16_f32 v21, 0, v21
v_mul_f32 v20, v20, v104
v_mul_f32 v21, v21, v105
v_cvt_pk_bf16_f32 v20, 0, v20
v_cvt_pk_bf16_f32 v21, 0, v21
v_lshlrev_b32 v22, 16, v196
v_and_b32 v23, s68, v196
v_add_f32 v20, v20, v22
v_add_f32 v21, v21, v23
v_cvt_pk_bf16_f32 v52, v20, v21
v_lshlrev_b32 v20, 16, v205
v_and_b32 v21, s68, v205
v_add_f32 v20, 1.0, v20
v_add_f32 v21, 1.0, v21
v_cvt_pk_bf16_f32 v20, 0, v20
v_cvt_pk_bf16_f32 v21, 0, v21
v_mul_f32 v20, v20, v106
v_mul_f32 v21, v21, v107
v_cvt_pk_bf16_f32 v20, 0, v20
v_cvt_pk_bf16_f32 v21, 0, v21
v_lshlrev_b32 v22, 16, v197
v_and_b32 v23, s68, v197
v_add_f32 v20, v20, v22
v_add_f32 v21, v21, v23
v_cvt_pk_bf16_f32 v53, v20, v21
v_lshlrev_b32 v20, 16, v206
v_and_b32 v21, s68, v206
v_add_f32 v20, 1.0, v20
v_add_f32 v21, 1.0, v21
v_cvt_pk_bf16_f32 v20, 0, v20
v_cvt_pk_bf16_f32 v21, 0, v21
v_mul_f32 v20, v20, v108
v_mul_f32 v21, v21, v109
v_cvt_pk_bf16_f32 v20, 0, v20
v_cvt_pk_bf16_f32 v21, 0, v21
v_lshlrev_b32 v22, 16, v198
v_and_b32 v23, s68, v198
v_add_f32 v20, v20, v22
v_add_f32 v21, v21, v23
v_cvt_pk_bf16_f32 v54, v20, v21
v_lshlrev_b32 v20, 16, v207
v_and_b32 v21, s68, v207
v_add_f32 v20, 1.0, v20
v_add_f32 v21, 1.0, v21
v_cvt_pk_bf16_f32 v20, 0, v20
v_cvt_pk_bf16_f32 v21, 0, v21
v_mul_f32 v20, v20, v110
v_mul_f32 v21, v21, v111
v_cvt_pk_bf16_f32 v20, 0, v20
v_cvt_pk_bf16_f32 v21, 0, v21
v_lshlrev_b32 v22, 16, v199
v_and_b32 v23, s68, v199
v_add_f32 v20, v20, v22
v_add_f32 v21, v21, v23
v_cvt_pk_bf16_f32 v55, v20, v21
L_g3:
s_cmp_ge_u32 s2, s73
s_cbranch_scc0 L_fl_151
s_waitcnt vmcnt(0)
v_cmp_eq_u32 vcc, 0, v31
s_cbranch_vccz L_fl_151
s_mov_b32 s75, 0
L_poll_152:
buffer_load_dword v31, v30, s[52:55], 0 offen offset:128 sc1
s_waitcnt vmcnt(0)
v_cmp_eq_u32 vcc, 0, v31
s_cbranch_vccz L_pollx_153
s_sleep 40
s_add_u32 s75, s75, 1
s_cmp_lt_u32 s75, 0x100000
s_cbranch_scc1 L_poll_152
L_pollx_153:
L_fl_151:
s_nop 1
v_mfma_f32_16x16x32_bf16 v[64:67], v[128:131], v[48:51], 0
v_mfma_f32_16x16x32_bf16 v[68:71], v[132:135], v[48:51], 0
v_mfma_f32_16x16x32_bf16 v[72:75], v[136:139], v[48:51], 0
v_mfma_f32_16x16x32_bf16 v[76:79], v[140:143], v[48:51], 0
v_mfma_f32_16x16x32_bf16 v[80:83], v[144:147], v[48:51], 0
v_mfma_f32_16x16x32_bf16 v[84:87], v[148:151], v[48:51], 0
v_mfma_f32_16x16x32_bf16 v[88:91], v[152:155], v[48:51], 0
v_mfma_f32_16x16x32_bf16 v[92:95], v[156:159], v[48:51], 0
v_mfma_f32_16x16x32_bf16 v[64:67], v[160:163], v[52:55], v[64:67]
v_mfma_f32_16x16x32_bf16 v[68:71], v[164:167], v[52:55], v[68:71]
v_mfma_f32_16x16x32_bf16 v[72:75], v[168:171], v[52:55], v[72:75]
v_mfma_f32_16x16x32_bf16 v[76:79], v[172:175], v[52:55], v[76:79]
v_mfma_f32_16x16x32_bf16 v[80:83], v[176:179], v[52:55], v[80:83]
v_mfma_f32_16x16x32_bf16 v[84:87], v[180:183], v[52:55], v[84:87]
v_mfma_f32_16x16x32_bf16 v[88:91], v[184:187], v[52:55], v[88:91]
v_mfma_f32_16x16x32_bf16 v[92:95], v[188:191], v[52:55], v[92:95]
v_and_b32 v20, 7, v0
v_mul_u32_u24 v20, 272, v20
v_and_b32 v21, 8, v0
v_lshl_add_u32 v20, v21, 3, v20
v_and_b32 v21, 48, v0
v_add_u32 v20, v20, v21
s_mul_i32 s64, s34, 8192
s_add_u32 s64, s64, 4096
v_add_u32 v20, s64, v20
s_nop 7
v_add_f32_dpp v24, v80, v64 row_ror:8 row_mask:0xf bank_mask:0x3
v_add_f32_dpp v24, v68, v84 row_ror:8 row_mask:0xf bank_mask:0xc
v_add_f32_dpp v25, v81, v65 row_ror:8 row_mask:0xf bank_mask:0x3
v_add_f32_dpp v25, v69, v85 row_ror:8 row_mask:0xf bank_mask:0xc
v_add_f32_dpp v26, v82, v66 row_ror:8 row_mask:0xf bank_mask:0x3
v_add_f32_dpp v26, v70, v86 row_ror:8 row_mask:0xf bank_mask:0xc
v_add_f32_dpp v27, v83, v67 row_ror:8 row_mask:0xf bank_mask:0x3
v_add_f32_dpp v27, v71, v87 row_ror:8 row_mask:0xf bank_mask:0xc
ds_write_b128 v20, v[24:27] offset:0
v_add_f32_dpp v28, v88, v72 row_ror:8 row_mask:0xf bank_mask:0x3
v_add_f32_dpp v28, v76, v92 row_ror:8 row_mask:0xf bank_mask:0xc
v_add_f32_dpp v29, v89, v73 row_ror:8 row_mask:0xf bank_mask:0x3
v_add_f32_dpp v29, v77, v93 row_ror:8 row_mask:0xf bank_mask:0xc
v_add_f32_dpp v30, v90, v74 row_ror:8 row_mask:0xf bank_mask:0x3
v_add_f32_dpp v30, v78, v94 row_ror:8 row_mask:0xf bank_mask:0xc
v_add_f32_dpp v31, v91, v75 row_ror:8 row_mask:0xf bank_mask:0x3
v_add_f32_dpp v31, v79, v95 row_ror:8 row_mask:0xf bank_mask:0xc
ds_write_b128 v20, v[28:31] offset:128
v_mov_b32 v20, 0
s_waitcnt lgkmcnt(0)
s_mov_b64 exec, 1
ds_add_u32 v20, v9 offset:320
s_mov_b64 exec, -1
s_cmp_eq_u32 s34, 0
s_cbranch_scc0 L_waitq
s_cmp_lt_u32 s2, 16
s_cbranch_scc0 L_gq2
v_and_b32 v21, 7, v0
v_lshrrev_b32 v22, 4, v0
v_and_b32 v23, 8, v0
v_lshrrev_b32 v23, 1, v23
v_add_u32 v22, v22, v23
v_mov_b32 v23, v1
s_lshl_b32 s64, s72, 10
s_add_u32 s64, s64, 0
s_branch L_g4
L_gq2:
v_lshrrev_b32 v21, 3, v0
v_and_b32 v22, 7, v0
s_mov_b32 s64, 10240
s_cmp_lt_u32 s2, 48
s_cselect_b32 s64, 22528, s64
s_mov_b32 s65, 12288
v_mul_lo_u32 v23, s65, v21
v_lshl_add_u32 v23, v22, 4, v23
s_lshl_b32 s66, s72, 7
s_add_u32 s64, s64, s66
L_g4:
v_mul_u32_u24 v21, 272, v21
v_lshl_add_u32 v21, v22, 5, v21
v_add_u32 v21, 4096, v21
s_mov_b32 s75, 0
L_poll_154:
ds_read_b32 v22, v20 offset:320
s_waitcnt lgkmcnt(0)
v_cmp_gt_u32 vcc, 4, v22
s_cbranch_vccz L_pollx_155
s_add_u32 s75, s75, 1
s_cmp_lt_u32 s75, 0x1000000
s_cbranch_scc1 L_poll_154
L_pollx_155:
ds_read_b128 v[64:67], v21 offset:0
ds_read_b128 v[68:71], v21 offset:16
ds_read_b128 v[72:75], v21 offset:8192
ds_read_b128 v[76:79], v21 offset:8208
ds_read_b128 v[80:83], v21 offset:16384
ds_read_b128 v[84:87], v21 offset:16400
ds_read_b128 v[88:91], v21 offset:24576
ds_read_b128 v[92:95], v21 offset:24592
s_waitcnt lgkmcnt(0)
v_add_f32 v64, v64, v72
v_add_f32 v65, v65, v73
v_add_f32 v66, v66, v74
v_add_f32 v67, v67, v75
v_add_f32 v68, v68, v76
v_add_f32 v69, v69, v77
v_add_f32 v70, v70, v78
v_add_f32 v71, v71, v79
v_add_f32 v64, v64, v80
v_add_f32 v65, v65, v81
v_add_f32 v66, v66, v82
v_add_f32 v67, v67, v83
v_add_f32 v68, v68, v84
v_add_f32 v69, v69, v85
v_add_f32 v70, v70, v86
v_add_f32 v71, v71, v87
v_add_f32 v64, v64, v88
v_add_f32 v65, v65, v89
v_add_f32 v66, v66, v90
v_add_f32 v67, v67, v91
v_add_f32 v68, v68, v92
v_add_f32 v69, v69, v93
v_add_f32 v70, v70, v94
v_add_f32 v71, v71, v95
v_cvt_pk_bf16_f32 v24, v64, v65
v_cvt_pk_bf16_f32 v25, v66, v67
v_cvt_pk_bf16_f32 v26, v68, v69
v_cvt_pk_bf16_f32 v27, v70, v71
v_min_u32 v24, -2, v24
v_min_u32 v25, -2, v25
v_min_u32 v26, -2, v26
v_min_u32 v27, -2, v27
buffer_store_dwordx4 v[24:27], v23, s[36:39], s64 offen sc1
s_branch L_waitq
L_jan:
v_mov_b32 v4, -1
v_mov_b32 v5, -1
v_mov_b32 v6, -1
v_mov_b32 v7, -1
s_lshl_b32 s67, s64, 2
s_add_u32 s67, s67, s34
s_cmp_lt_u32 s67, 32
s_cselect_b32 s66, 0, 933888
s_mul_i32 s65, s67, 3072
s_add_u32 s65, s65, s66
s_add_u32 s65, s65, 16384
v_add_u32 v8, s65, v1
global_store_dwordx4 v8, v[4:7], s[30:31] offset:0 sc1
global_store_dwordx4 v8, v[4:7], s[30:31] offset:1024 sc1
global_store_dwordx4 v8, v[4:7], s[30:31] offset:2048 sc1
s_and_b32 s66, s67, 64
s_add_u32 s67, s67, s66
s_lshl_b32 s67, s67, 7
s_add_u32 s67, s67, 1343488
v_and_b32 v8, 8, v0
v_lshlrev_b32 v8, 10, v8
v_and_b32 v10, 0x70, v1
v_add3_u32 v8, v8, v10, s67
s_mov_b64 exec, 0xffff
global_store_dwordx4 v8, v[4:7], s[30:31] sc1
s_mov_b64 exec, 1
s_load_dword s68, s[30:31], 0x48000
s_and_b32 s65, s34, 1
s_lshl_b32 s66, s65, 13
s_xor_b32 s67, s67, s66
s_xor_b32 s66, s67, 0x2000
s_waitcnt vmcnt(0) lgkmcnt(0)
s_mov_b64 exec, -1
s_cmp_eq_u32 s34, 3
s_cbranch_scc1 L_p0_156
s_cmp_eq_u32 s34, 0
s_cselect_b32 s62, s24, s10
s_cselect_b32 s63, s25, s11
s_cmp_eq_u32 s34, 2
s_cselect_b32 s62, s12, s62
s_cselect_b32 s63, s13, s63
global_load_dword v12, v38, s[62:63]
global_load_dword v13, v39, s[62:63]
L_p0_156:
s_mov_b64 exec, 1
s_mov_b32 s70, 0
s_load_dword s68, s[30:31], s67
L_race_157:
s_getreg_b32 s69, hwreg(HW_REG_IB_STS, 8, 4)
s_add_u32 s70, s70, 1
s_cmp_eq_u32 s69, 0
s_cbranch_scc0 L_race_157
s_waitcnt lgkmcnt(0)
s_mov_b32 s71, 0
s_load_dword s68, s[30:31], s66
L_race_158:
s_getreg_b32 s69, hwreg(HW_REG_IB_STS, 8, 4)
s_add_u32 s71, s71, 1
s_cmp_eq_u32 s69, 0
s_cbranch_scc0 L_race_158
s_waitcnt lgkmcnt(0)
s_cmp_lt_u32 s71, s70
s_cselect_b32 s70, 1, 0
s_xor_b32 s70, s70, s65
s_getreg_b32 s69, hwreg(HW_REG_XCC_ID, 2, 1)
s_xor_b32 s70, s70, s69
s_lshl_b32 s69, s69, 14
s_lshl_b32 s70, s70, 8
s_add_u32 s70, s70, s69
s_add_u32 s70, s70, 1
v_mov_b32 v9, s70
s_lshl_b32 s65, s64, 2
v_mov_b32 v8, s65
ds_add_rtn_u32 v11, v2, v9 offset:320
s_waitcnt lgkmcnt(0)
v_add_u32 v11, v11, v9
v_and_b32 v10, 0xff, v11
v_cmp_eq_u32 vcc, 4, v10
s_cbranch_vccz L_j_159
global_store_dword v8, v11, s[28:29] offset:128 sc1
L_j_159:
s_mov_b64 exec, -1
s_branch L_nop0
L_norole:
s_cmp_eq_u32 s74, -1
s_cbranch_scc1 L_waitq
L_waitq:
s_cmp_eq_u32 s74, -1
s_cselect_b64 vcc, 0, -1
s_cmp_lt_u32 s2, 112
s_cselect_b64 vcc, -1, vcc
s_mov_b32 s44, s12
s_mov_b32 s45, s13
s_mov_b32 s46, 0x400000
s_mov_b32 s47, 0x20000
v_lshrrev_b32 v18, 4, v0
v_and_b32 v16, 15, v0
v_xor_b32 v16, v16, v18
v_xor_b32 v17, 4, v16
v_lshlrev_b32 v19, 10, v18
v_lshl_add_u32 v22, v16, 4, v19
v_lshl_add_u32 v23, v17, 4, v19
v_and_b32 v19, 1, v18
v_lshlrev_b32 v19, 10, v19
v_lshrrev_b32 v18, 1, v18
v_lshl_add_u32 v18, v18, 11, v19
v_lshl_add_u32 v16, v16, 4, v18
v_lshl_add_u32 v17, v17, 4, v18
v_lshrrev_b32 v18, 4, v0
v_bfe_u32 v19, v0, 2, 2
v_and_b32 v20, 2, v0
v_lshlrev_b32 v20, 2, v20
v_xor_b32 v20, v20, v19
v_and_b32 v21, 1, v18
v_lshlrev_b32 v21, 2, v21
v_xor_b32 v20, v20, v21
v_lshlrev_b32 v20, 4, v20
v_lshl_add_u32 v20, v18, 10, v20
v_lshl_add_u32 v20, v19, 8, v20
v_and_b32 v21, 1, v0
v_lshl_add_u32 v20, v21, 3, v20
s_lshl_b32 s65, s34, 13
s_add_u32 s65, s65, 8192
v_add_u32 v40, s65, v20
v_xor_b32 v41, 16, v40
v_xor_b32 v42, 32, v40
v_xor_b32 v43, 48, v40
v_xor_b32 v44, 64, v40
v_xor_b32 v45, 80, v40
v_xor_b32 v46, 96, v40
v_xor_b32 v47, 112, v40
s_lshl_b32 s64, s33, 17
s_lshl_b32 s66, s34, 8
s_add_u32 s64, s64, s66
s_mov_b32 s68, 0
s_lshl_b32 s66, s68, 10
s_add_u32 s64, s64, s66
s_add_u32 m0, s65, 0
s_xor_b32 s66, s64, 0
buffer_load_dwordx4 v16, s[44:47], s66 offen  lds
s_add_u32 m0, s65, 1024
s_xor_b32 s66, s64, 8192
buffer_load_dwordx4 v17, s[44:47], s66 offen  lds
s_add_u32 m0, s65, 2048
s_xor_b32 s66, s64, 16384
buffer_load_dwordx4 v16, s[44:47], s66 offen  lds
s_waitcnt vmcnt(2)
s_add_u32 m0, s65, 3072
s_xor_b32 s66, s64, 24576
buffer_load_dwordx4 v17, s[44:47], s66 offen  lds
s_waitcnt vmcnt(2)
s_add_u32 m0, s65, 32768
s_xor_b32 s66, s64, 4096
buffer_load_dwordx4 v16, s[44:47], s66 offen  lds
s_waitcnt vmcnt(2)
s_add_u32 m0, s65, 33792
s_xor_b32 s66, s64, 12288
buffer_load_dwordx4 v17, s[44:47], s66 offen  lds
s_waitcnt vmcnt(2)
ds_read_b64_tr_b16 v[128:129], v40 offset:0
ds_read_b64_tr_b16 v[136:137], v41 offset:0
ds_read_b64_tr_b16 v[144:145], v42 offset:0
ds_read_b64_tr_b16 v[152:153], v43 offset:0
ds_read_b64_tr_b16 v[160:161], v44 offset:0
ds_read_b64_tr_b16 v[168:169], v45 offset:0
ds_read_b64_tr_b16 v[176:177], v46 offset:0
ds_read_b64_tr_b16 v[184:185], v47 offset:0
s_add_u32 m0, s65, 34816
s_xor_b32 s66, s64, 20480
buffer_load_dwordx4 v16, s[44:47], s66 offen  lds
s_waitcnt vmcnt(2)
s_add_u32 m0, s65, 35840
s_xor_b32 s66, s64, 28672
buffer_load_dwordx4 v17, s[44:47], s66 offen  lds
s_waitcnt vmcnt(2)
s_waitcnt lgkmcnt(0)
s_add_u32 m0, s65, 0
s_xor_b32 s66, s64, 32768
buffer_load_dwordx4 v16, s[44:47], s66 offen  lds
s_waitcnt vmcnt(2)
s_add_u32 m0, s65, 1024
s_xor_b32 s66, s64, 40960
buffer_load_dwordx4 v17, s[44:47], s66 offen  lds
s_waitcnt vmcnt(2)
ds_read_b64_tr_b16 v[130:131], v40 offset:32768
ds_read_b64_tr_b16 v[138:139], v41 offset:32768
ds_read_b64_tr_b16 v[146:147], v42 offset:32768
ds_read_b64_tr_b16 v[154:155], v43 offset:32768
ds_read_b64_tr_b16 v[162:163], v44 offset:32768
ds_read_b64_tr_b16 v[170:171], v45 offset:32768
ds_read_b64_tr_b16 v[178:179], v46 offset:32768
ds_read_b64_tr_b16 v[186:187], v47 offset:32768
s_add_u32 m0, s65, 2048
s_xor_b32 s66, s64, 49152
buffer_load_dwordx4 v16, s[44:47], s66 offen  lds
s_waitcnt vmcnt(2)
s_add_u32 m0, s65, 3072
s_xor_b32 s66, s64, 57344
buffer_load_dwordx4 v17, s[44:47], s66 offen  lds
s_waitcnt vmcnt(2)
s_waitcnt lgkmcnt(0)
s_add_u32 m0, s65, 32768
s_xor_b32 s66, s64, 36864
buffer_load_dwordx4 v16, s[44:47], s66 offen  lds
s_waitcnt vmcnt(2)
s_add_u32 m0, s65, 33792
s_xor_b32 s66, s64, 45056
buffer_load_dwordx4 v17, s[44:47], s66 offen  lds
s_waitcnt vmcnt(2)
ds_read_b64_tr_b16 v[132:133], v40 offset:0
ds_read_b64_tr_b16 v[140:141], v41 offset:0
ds_read_b64_tr_b16 v[148:149], v42 offset:0
ds_read_b64_tr_b16 v[156:157], v43 offset:0
ds_read_b64_tr_b16 v[164:165], v44 offset:0
ds_read_b64_tr_b16 v[172:173], v45 offset:0
ds_read_b64_tr_b16 v[180:181], v46 offset:0
ds_read_b64_tr_b16 v[188:189], v47 offset:0
s_add_u32 m0, s65, 34816
s_xor_b32 s66, s64, 53248
buffer_load_dwordx4 v16, s[44:47], s66 offen  lds
s_waitcnt vmcnt(2)
s_add_u32 m0, s65, 35840
s_xor_b32 s66, s64, 61440
buffer_load_dwordx4 v17, s[44:47], s66 offen  lds
s_waitcnt vmcnt(2)
s_waitcnt lgkmcnt(0)
s_add_u32 m0, s65, 0
s_xor_b32 s66, s64, 65536
buffer_load_dwordx4 v16, s[44:47], s66 offen  lds
s_waitcnt vmcnt(2)
s_add_u32 m0, s65, 1024
s_xor_b32 s66, s64, 73728
buffer_load_dwordx4 v17, s[44:47], s66 offen  lds
s_waitcnt vmcnt(2)
ds_read_b64_tr_b16 v[134:135], v40 offset:32768
ds_read_b64_tr_b16 v[142:143], v41 offset:32768
ds_read_b64_tr_b16 v[150:151], v42 offset:32768
ds_read_b64_tr_b16 v[158:159], v43 offset:32768
ds_read_b64_tr_b16 v[166:167], v44 offset:32768
ds_read_b64_tr_b16 v[174:175], v45 offset:32768
ds_read_b64_tr_b16 v[182:183], v46 offset:32768
ds_read_b64_tr_b16 v[190:191], v47 offset:32768
s_add_u32 m0, s65, 2048
s_xor_b32 s66, s64, 81920
buffer_load_dwordx4 v16, s[44:47], s66 offen  lds
s_waitcnt vmcnt(2)
s_add_u32 m0, s65, 3072
s_xor_b32 s66, s64, 90112
buffer_load_dwordx4 v17, s[44:47], s66 offen  lds
s_waitcnt vmcnt(2)
s_waitcnt lgkmcnt(0)
s_add_u32 m0, s65, 32768
s_xor_b32 s66, s64, 69632
buffer_load_dwordx4 v16, s[44:47], s66 offen  lds
s_waitcnt vmcnt(2)
s_add_u32 m0, s65, 33792
s_xor_b32 s66, s64, 77824
buffer_load_dwordx4 v17, s[44:47], s66 offen  lds
s_waitcnt vmcnt(2)
ds_read_b64_tr_b16 v[192:193], v40 offset:0
ds_read_b64_tr_b16 v[200:201], v41 offset:0
ds_read_b64_tr_b16 v[208:209], v42 offset:0
ds_read_b64_tr_b16 v[216:217], v43 offset:0
ds_read_b64_tr_b16 v[224:225], v44 offset:0
ds_read_b64_tr_b16 v[232:233], v45 offset:0
ds_read_b64_tr_b16 v[240:241], v46 offset:0
ds_read_b64_tr_b16 v[248:249], v47 offset:0
s_add_u32 m0, s65, 34816
s_xor_b32 s66, s64, 86016
buffer_load_dwordx4 v16, s[44:47], s66 offen  lds
s_waitcnt vmcnt(2)
s_add_u32 m0, s65, 35840
s_xor_b32 s66, s64, 94208
buffer_load_dwordx4 v17, s[44:47], s66 offen  lds
s_waitcnt vmcnt(2)
s_waitcnt lgkmcnt(0)
s_add_u32 m0, s65, 0
s_xor_b32 s66, s64, 98304
buffer_load_dwordx4 v16, s[44:47], s66 offen  lds
s_waitcnt vmcnt(2)
s_add_u32 m0, s65, 1024
s_xor_b32 s66, s64, 106496
buffer_load_dwordx4 v17, s[44:47], s66 offen  lds
s_waitcnt vmcnt(2)
ds_read_b64_tr_b16 v[194:195], v40 offset:32768
ds_read_b64_tr_b16 v[202:203], v41 offset:32768
ds_read_b64_tr_b16 v[210:211], v42 offset:32768
ds_read_b64_tr_b16 v[218:219], v43 offset:32768
ds_read_b64_tr_b16 v[226:227], v44 offset:32768
ds_read_b64_tr_b16 v[234:235], v45 offset:32768
ds_read_b64_tr_b16 v[242:243], v46 offset:32768
ds_read_b64_tr_b16 v[250:251], v47 offset:32768
v_and_b32 v24, 127, v2
buffer_load_dword v25, v24, s[52:55], 0 offen offset:128
s_add_u32 m0, s65, 2048
s_xor_b32 s66, s64, 114688
buffer_load_dwordx4 v16, s[44:47], s66 offen  lds
s_waitcnt vmcnt(2)
s_add_u32 m0, s65, 3072
s_xor_b32 s66, s64, 122880
buffer_load_dwordx4 v17, s[44:47], s66 offen  lds
s_waitcnt vmcnt(2)
s_waitcnt lgkmcnt(0)
s_add_u32 m0, s65, 32768
s_xor_b32 s66, s64, 102400
buffer_load_dwordx4 v16, s[44:47], s66 offen  lds
s_waitcnt vmcnt(2)
s_add_u32 m0, s65, 33792
s_xor_b32 s66, s64, 110592
buffer_load_dwordx4 v17, s[44:47], s66 offen  lds
s_waitcnt vmcnt(2)
ds_read_b64_tr_b16 v[196:197], v40 offset:0
ds_read_b64_tr_b16 v[204:205], v41 offset:0
ds_read_b64_tr_b16 v[212:213], v42 offset:0
ds_read_b64_tr_b16 v[220:221], v43 offset:0
ds_read_b64_tr_b16 v[228:229], v44 offset:0
ds_read_b64_tr_b16 v[236:237], v45 offset:0
ds_read_b64_tr_b16 v[244:245], v46 offset:0
ds_read_b64_tr_b16 v[252:253], v47 offset:0
s_add_u32 m0, s65, 34816
s_xor_b32 s66, s64, 118784
buffer_load_dwordx4 v16, s[44:47], s66 offen  lds
s_waitcnt vmcnt(2)
s_add_u32 m0, s65, 35840
s_xor_b32 s66, s64, 126976
buffer_load_dwordx4 v17, s[44:47], s66 offen  lds
s_waitcnt vmcnt(0)
ds_read_b64_tr_b16 v[198:199], v40 offset:32768
ds_read_b64_tr_b16 v[206:207], v41 offset:32768
ds_read_b64_tr_b16 v[214:215], v42 offset:32768
ds_read_b64_tr_b16 v[222:223], v43 offset:32768
ds_read_b64_tr_b16 v[230:231], v44 offset:32768
ds_read_b64_tr_b16 v[238:239], v45 offset:32768
ds_read_b64_tr_b16 v[246:247], v46 offset:32768
ds_read_b64_tr_b16 v[254:255], v47 offset:32768
s_waitcnt lgkmcnt(0)
v_cmp_eq_u32 vcc, 0, v25
s_cbranch_vccz L_tab_160
s_mov_b32 s75, 0
L_poll_161:
buffer_load_dword v25, v24, s[52:55], 0 offen offset:128 sc1
s_waitcnt vmcnt(0)
v_cmp_eq_u32 vcc, 0, v25
s_cbranch_vccz L_pollx_162
s_sleep 40
s_add_u32 s75, s75, 1
s_cmp_lt_u32 s75, 0x100000
s_cbranch_scc1 L_poll_161
L_pollx_162:
L_tab_160:
v_bfe_u32 v26, v25, 8, 3
v_lshrrev_b32 v25, 16, v25
s_nop 0
v_add_u32_dpp v26, v26, v26 quad_perm:[1,0,3,2] row_mask:0xf bank_mask:0xf
s_nop 1
v_add_u32_dpp v26, v26, v26 quad_perm:[2,3,0,1] row_mask:0xf bank_mask:0xf
s_nop 1
v_add_u32_dpp v26, v26, v26 row_ror:4 row_mask:0xf bank_mask:0xf
s_nop 1
v_add_u32_dpp v26, v26, v26 row_ror:8 row_mask:0xf bank_mask:0xf
s_nop 1
v_readlane_b32 s66, v26, 0
v_readlane_b32 s71, v26, 16
s_add_u32 s66, s66, s71
s_cmp_gt_u32 s66, 64
s_cselect_b32 s66, 1, 0
v_cmp_ne_u32 vcc, s66, v25
s_and_b32 s71, vcc_lo, 0xff
s_bcnt0_i32_b32 s66, s71
s_sub_u32 s66, s66, 24
v_mbcnt_lo_u32_b32 v24, s71, 0
v_sub_u32 v25, v0, v24
v_add_u32 v24, s66, v24
v_cndmask_b32 v24, v25, v24, vcc
v_bfe_u32 v25, v24, 1, 2
v_and_b32 v26, 1, v24
v_lshl_or_b32 v25, v26, 2, v25
v_lshlrev_b32 v25, v2, v25
s_nop 1
v_or_b32_dpp v25, v25, v25 quad_perm:[1,0,3,2] row_mask:0xf bank_mask:0xf
s_nop 1
v_or_b32_dpp v25, v25, v25 quad_perm:[2,3,0,1] row_mask:0xf bank_mask:0xf
s_nop 1
v_or_b32_dpp v25, v25, v25 row_shl:4 row_mask:0xf bank_mask:0xf
s_nop 1
v_readfirstlane_b32 s35, v25
s_mov_b64 exec, 1
ds_write_b32 v2, v25 offset:328
s_mov_b64 exec, -1
s_sub_u32 s64, s2, 144
s_cmp_lt_u32 s64, 64
s_cbranch_scc0 L_rp_163
s_cmp_eq_u32 s34, 0
s_cbranch_scc0 L_rp_163
s_mov_b32 s48, s4
s_mov_b32 s49, s5
s_mov_b32 s50, 0x2000
s_mov_b32 s51, 0x20000
v_and_b32 v5, 15, v0
v_and_b32 v6, 16, v0
v_lshl_add_u32 v5, v6, 1, v5
v_and_b32 v6, 32, v0
v_lshrrev_b32 v6, 1, v6
v_add_u32 v5, v5, v6
v_lshlrev_b32 v5, 1, v5
v_and_b32 v6, 0x7c, v5
s_lshl_b32 s65, s64, 7
s_and_b32 s66, s65, 0x380
s_lshr_b32 s64, s64, 3
s_mul_i32 s64, s64, 12288
s_add_u32 s64, s64, s66
s_add_u32 s64, s64, 24576
buffer_load_ushort v18, v5, s[48:51], s65 offen
s_mov_b32 s75, 0
L_poll_164:
buffer_load_dword v19, v6, s[36:39], s64 offen offset:0 sc1
buffer_load_dword v20, v6, s[36:39], s64 offen offset:3072 sc1
s_waitcnt vmcnt(0)
v_max_u32 v16, v19, v20
v_cmp_eq_u32 vcc, -1, v16
s_cbranch_vccz L_pollx_165
s_sleep 40
s_add_u32 s75, s75, 1
s_cmp_lt_u32 s75, 0x100000
s_cbranch_scc1 L_poll_164
L_pollx_165:
v_and_b32 v16, 1, v0
v_lshlrev_b32 v16, 4, v16
v_xor_b32 v16, 16, v16
v_lshlrev_b32 v18, 16, v18
v_lshlrev_b32 v19, v16, v19
v_and_b32 v19, 0xffff0000, v19
v_lshlrev_b32 v20, v16, v20
v_and_b32 v20, 0xffff0000, v20
ds_write_b32 v2, v18 offset:4096
ds_write_b32 v2, v19 offset:4352
ds_write_b32 v2, v20 offset:4608
L_rp_163:
v_lshlrev_b32 v10, 3, v0
s_lshl_b32 s64, s34, 8
s_add_u32 s64, s64, 2560
s_lshr_b32 s66, s68, 1
v_xor_b32 v12, s66, v0
v_mov_b32 v14, 0
v_bfe_u32 v11, v12, 0, 1
v_lshl_or_b32 v14, v11, 0, v14
v_bfe_u32 v11, v12, 1, 1
v_lshl_or_b32 v14, v11, 1, v14
v_bfe_u32 v11, v12, 2, 1
v_lshl_or_b32 v14, v11, 2, v14
v_bfe_u32 v11, v12, 3, 1
v_lshl_or_b32 v14, v11, 3, v14
v_bfe_u32 v11, v12, 4, 1
v_lshl_or_b32 v14, v11, 4, v14
v_bfe_u32 v11, v12, 5, 1
v_lshl_or_b32 v14, v11, 5, v14
v_and_b32 v11, 0x38, v14
v_and_b32 v12, 1, v14
v_lshl_add_u32 v11, v12, 2, v11
v_bfe_u32 v12, v14, 1, 2
v_add_u32 v11, v11, v12
v_lshl_add_u32 v11, v11, 2, s64
v_and_b32 v14, 1, v0
v_and_b32 v12, 48, v0
v_lshlrev_b32 v12, 1, v12
v_lshl_add_u32 v12, v14, 4, v12
v_add_u32 v12, s64, v12
v_mul_u32_u24 v15, 0xaaaa, v14
v_add_u32 v15, 0x4444, v15
v_mov_b32 v64, 0
v_mov_b32 v65, 0
v_mov_b32 v66, 0
v_mov_b32 v67, 0
v_mov_b32 v68, 0
v_mov_b32 v69, 0
v_mov_b32 v70, 0
v_mov_b32 v71, 0
v_mov_b32 v72, 0
v_mov_b32 v73, 0
v_mov_b32 v74, 0
v_mov_b32 v75, 0
v_mov_b32 v76, 0
v_mov_b32 v77, 0
v_mov_b32 v78, 0
v_mov_b32 v79, 0
v_mov_b32 v80, 0
v_mov_b32 v81, 0
v_mov_b32 v82, 0
v_mov_b32 v83, 0
v_mov_b32 v84, 0
v_mov_b32 v85, 0
v_mov_b32 v86, 0
v_mov_b32 v87, 0
v_mov_b32 v88, 0
v_mov_b32 v89, 0
v_mov_b32 v90, 0
v_mov_b32 v91, 0
v_mov_b32 v92, 0
v_mov_b32 v93, 0
v_mov_b32 v94, 0
v_mov_b32 v95, 0
s_lshl_b32 s64, s34, 3
s_lshr_b32 s64, s35, s64
v_bfe_u32 v13, v0, 3, 1
v_lshlrev_b32 v13, 2, v13
v_bfe_u32 v13, s64, v13, 3
v_and_b32 v14, 0x70, v1
v_lshl_add_u32 v13, v13, 12, v14
s_lshl_b32 s64, s34, 2
s_add_u32 s64, s64, s33
v_bfe_u32 v14, v0, 3, 1
v_lshl_add_u32 v14, v14, 1, s64
v_and_b32 v14, 31, v14
v_lshl_add_u32 v13, v14, 7, v13
s_lshl_b32 s69, s32, 15
s_add_u32 s69, s69, 1048576
s_waitcnt vmcnt(0) lgkmcnt(0)
s_barrier
ds_read_b64 v[20:21], v10 offset:512
ds_read_b64 v[22:23], v10 offset:1024
ds_read_b64 v[24:25], v10 offset:1536
ds_read_b64 v[26:27], v10 offset:2048
s_waitcnt lgkmcnt(2)
v_pk_add_f32 v[20:21], v[20:21], v[22:23]
s_waitcnt lgkmcnt(1)
v_pk_add_f32 v[20:21], v[20:21], v[24:25]
s_waitcnt lgkmcnt(0)
v_pk_add_f32 v[20:21], v[20:21], v[26:27]
v_cvt_pk_bf16_f32 v20, v20, v21
ds_write_b32 v11, v20
ds_read_b128 v[48:51], v12 offset:0
ds_read_b128 v[52:55], v12 offset:128
s_waitcnt lgkmcnt(1)
v_smfmac_f32_16x16x64_bf16 v[64:67], v[48:51], v[128:135], v15
v_smfmac_f32_16x16x64_bf16 v[68:71], v[48:51], v[136:143], v15
v_smfmac_f32_16x16x64_bf16 v[72:75], v[48:51], v[144:151], v15
v_smfmac_f32_16x16x64_bf16 v[76:79], v[48:51], v[152:159], v15
s_waitcnt lgkmcnt(0)
v_smfmac_f32_16x16x64_bf16 v[64:67], v[52:55], v[192:199], v15
v_smfmac_f32_16x16x64_bf16 v[68:71], v[52:55], v[200:207], v15
v_smfmac_f32_16x16x64_bf16 v[72:75], v[52:55], v[208:215], v15
v_smfmac_f32_16x16x64_bf16 v[76:79], v[52:55], v[216:223], v15
v_smfmac_f32_16x16x64_bf16 v[80:83], v[48:51], v[160:167], v15
v_smfmac_f32_16x16x64_bf16 v[84:87], v[48:51], v[168:175], v15
v_smfmac_f32_16x16x64_bf16 v[88:91], v[48:51], v[176:183], v15
v_smfmac_f32_16x16x64_bf16 v[92:95], v[48:51], v[184:191], v15
v_smfmac_f32_16x16x64_bf16 v[80:83], v[52:55], v[224:231], v15
v_add_f32 v64, v64, v65
v_smfmac_f32_16x16x64_bf16 v[84:87], v[52:55], v[232:239], v15
v_add_f32 v68, v68, v69
v_add_f32 v72, v72, v73
v_smfmac_f32_16x16x64_bf16 v[88:91], v[52:55], v[240:247], v15
v_add_f32 v76, v76, v77
v_cvt_pk_bf16_f32 v20, v64, v68
v_smfmac_f32_16x16x64_bf16 v[92:95], v[52:55], v[248:255], v15
v_cvt_pk_bf16_f32 v21, v72, v76
v_add_f32 v80, v80, v81
s_mov_b64 exec, 0xffff
v_add_f32 v84, v84, v85
v_cvt_pk_bf16_f32 v22, v80, v84
s_nop 0
v_add_f32 v88, v88, v89
s_nop 0
v_add_f32 v92, v92, v93
v_cvt_pk_bf16_f32 v23, v88, v92
buffer_store_dwordx4 v[20:23], v13, s[36:39], s69 offen sc1
s_mov_b64 exec, -1
s_sub_u32 s67, s2, 16
s_cmp_lt_u32 s67, 128
s_cbranch_scc0 L_nogp
s_and_b32 s66, s2, 7
s_min_u32 s64, s66, 3
s_mul_i32 s71, s66, 5
s_add_u32 s64, s64, s71
s_cmp_lt_u32 s66, 3
s_cselect_b32 s66, 5, 4
v_and_b32 v8, 7, v0
v_min_u32 v8, s66, v8
v_add_u32 v8, s64, v8
s_and_b32 s64, s67, 0xf8
s_lshl_b32 s64, s64, 2
s_lshl_b32 s66, s34, 3
s_add_u32 s64, s64, s66
v_lshrrev_b32 v9, 3, v0
v_add_u32 v9, s64, v9
v_mul_u32_u24 v9, 2752, v9
v_lshl_add_u32 v8, v8, 6, v9
global_load_dword v10, v8, s[16:17]
global_load_dword v11, v8, s[18:19]
s_and_b32 s66, s2, 7
s_min_u32 s70, s66, 3
s_mul_i32 s71, s66, 5
s_add_u32 s70, s70, s71
s_cmp_lt_u32 s66, 3
s_cselect_b32 s66, 6, 5
s_lshl_b32 s66, s66, 8
s_sub_u32 s66, s66, 1
s_lshr_b32 s71, s67, 3
s_lshl_b32 s71, s71, 2
s_add_u32 s71, s71, s34
s_mul_i32 s71, s71, 24
v_min_u32 v12, 23, v0
v_add_u32 v12, s71, v12
v_min_u32 v12, s66, v12
s_lshl_b32 s70, s70, 15
v_lshl_add_u32 v12, v12, 7, s70
global_load_dword v13, v12, s[20:21]
s_endpgm
L_nogp:
L_tail_s:
s_cmp_eq_u32 s74, -1
s_cbranch_scc0 L_ffn
s_cmp_eq_u32 s3, 0
s_cbranch_scc0 L_fin
s_sub_u32 s70, s2, 144
s_cmp_lt_u32 s70, 64
s_cbranch_scc0 L_fin
s_lshl_b32 s64, s70, 2
s_lshr_b32 s67, s35, s64
s_and_b32 s71, s67, 7
s_andn2_b32 s66, s70, 7
s_add_u32 s66, s66, s71
s_lshl_b32 s66, s66, 12
s_add_u32 s66, s66, 1048576
buffer_load_dwordx4 v[16:19], v1, s[36:39], s66 offen offset:0 sc1
buffer_load_dwordx4 v[20:23], v1, s[36:39], s66 offen offset:1024 sc1
buffer_load_dwordx4 v[24:27], v1, s[36:39], s66 offen offset:2048 sc1
buffer_load_dwordx4 v[28:31], v1, s[36:39], s66 offen offset:3072 sc1
v_mov_b32 v32, -1
v_mov_b32 v33, -1
v_mov_b32 v34, -1
v_mov_b32 v35, -1
s_and_b32 s64, s71, 6
s_lshl_b32 s64, s64, 12
s_and_b32 s65, s71, 1
s_lshl_b32 s65, s65, 15
s_or_b32 s64, s64, s65
s_lshr_b32 s65, s70, 3
s_lshl_b32 s65, s65, 16
s_add_u32 s64, s64, s65
s_lshr_b32 s65, s70, 4
s_lshl_b32 s65, s65, 2
s_and_b32 s67, s70, 7
s_add_u32 s65, s65, s67
s_lshl_b32 s65, s65, 7
s_add_u32 s64, s64, s65
s_add_u32 s64, s64, 1376256
s_add_u32 s65, s64, 4096
buffer_store_dwordx4 v[32:35], v1, s[36:39], s64 offen offset:0 sc1
buffer_store_dwordx4 v[32:35], v1, s[36:39], s64 offen offset:1024 sc1
buffer_store_dwordx4 v[32:35], v1, s[36:39], s64 offen offset:2048 sc1
buffer_store_dwordx4 v[32:35], v1, s[36:39], s64 offen offset:3072 sc1
buffer_store_dwordx4 v[32:35], v1, s[36:39], s65 offen offset:0 sc1
s_mov_b64 exec, 0xffffff
buffer_store_dwordx4 v[32:35], v1, s[36:39], s65 offen offset:1024 sc1
s_mov_b64 exec, -1
v_lshlrev_b32 v2, 2, v0
ds_read_b32 v8, v2 offset:4096
ds_read_b32 v9, v2 offset:4352
ds_read_b32 v10, v2 offset:4608
s_mov_b32 s56, s26
s_mov_b32 s57, s27
s_mov_b32 s58, 0x2000
s_mov_b32 s59, 0x20000
v_and_b32 v5, 15, v0
v_and_b32 v6, 16, v0
v_lshl_add_u32 v5, v6, 1, v5
v_and_b32 v6, 32, v0
v_lshrrev_b32 v6, 1, v6
v_add_u32 v5, v5, v6
v_lshlrev_b32 v5, 1, v5
v_and_b32 v6, 0x7c, v5
s_lshl_b32 s73, s70, 7
v_and_b32 v11, 1, v0
v_lshlrev_b32 v3, 4, v11
v_mov_b32 v7, 0x3f80
v_lshlrev_b32 v7, v3, v7
v_and_b32 v2, 4, v0
v_cmp_eq_u32 vcc, 0, v2
v_bfe_u32 v2, v0, 1, 1
v_mul_u32_u24 v43, 0xaaaa, v2
v_add_u32 v43, 0x4444, v43
v_cndmask_b32 v44, 0, v7, vcc
v_sub_u32 v45, v7, v44
v_mov_b32 v46, v44
v_mov_b32 v47, v45
v_mov_b32 v48, 0
v_mov_b32 v49, 0
v_mov_b32 v50, 0
v_mov_b32 v51, 0
v_mov_b32 v52, 0
v_mov_b32 v53, 0
v_mov_b32 v54, 0
v_mov_b32 v55, 0
s_add_u32 s68, s73, 1310720
s_mov_b32 s76, 0xaaaaaaaa
s_mov_b32 s77, 0xaaaaaaaa
v_cmp_gt_u32 vcc, 24, v0
v_mov_b32 v41, 0x40000000
v_lshl_add_u32 v12, v11, 13, v6
v_cndmask_b32 v41, v41, v1, vcc
s_mov_b32 s75, 0
s_waitcnt vmcnt(0) lgkmcnt(0)
buffer_load_dwordx4 v[16:19], v1, s[36:39], s66 offen offset:0 sc1
buffer_load_dwordx4 v[20:23], v1, s[36:39], s66 offen offset:1024 sc1
buffer_load_dwordx4 v[24:27], v1, s[36:39], s66 offen offset:2048 sc1
buffer_load_dwordx4 v[28:31], v1, s[36:39], s66 offen offset:3072 sc1
s_sleep 1
buffer_load_dwordx4 v[16:19], v1, s[36:39], s66 offen offset:0 sc1
buffer_load_dwordx4 v[20:23], v1, s[36:39], s66 offen offset:1024 sc1
buffer_load_dwordx4 v[24:27], v1, s[36:39], s66 offen offset:2048 sc1
buffer_load_dwordx4 v[28:31], v1, s[36:39], s66 offen offset:3072 sc1
s_sleep 1
buffer_load_dwordx4 v[16:19], v1, s[36:39], s66 offen offset:0 sc1
buffer_load_dwordx4 v[20:23], v1, s[36:39], s66 offen offset:1024 sc1
buffer_load_dwordx4 v[24:27], v1, s[36:39], s66 offen offset:2048 sc1
buffer_load_dwordx4 v[28:31], v1, s[36:39], s66 offen offset:3072 sc1
s_sleep 1
L_rn_168:
v_smfmac_f32_16x16x64_bf16 v[48:51], v[44:47], v[16:23], v43
v_smfmac_f32_16x16x64_bf16 v[48:51], v[44:47], v[24:31], v43
buffer_load_dwordx4 v[16:19], v1, s[36:39], s66 offen offset:0 sc1
buffer_load_dwordx4 v[20:23], v1, s[36:39], s66 offen offset:1024 sc1
buffer_load_dwordx4 v[24:27], v1, s[36:39], s66 offen offset:2048 sc1
buffer_load_dwordx4 v[28:31], v1, s[36:39], s66 offen offset:3072 sc1
s_add_u32 s75, s75, 1
s_and_b32 s78, s75, 15
s_nop 1
v_add_f32_dpp v13, v48, v48 row_ror:8 row_mask:0x3 bank_mask:0x3
v_add_f32_dpp v13, v49, v49 row_ror:8 row_mask:0x3 bank_mask:0xc
v_add_f32_dpp v13, v50, v50 row_ror:8 row_mask:0xc bank_mask:0x3
v_add_f32_dpp v13, v51, v51 row_ror:8 row_mask:0xc bank_mask:0xc
v_cmp_u_f32 vcc, v13, v13
s_cbranch_vccz L_rz_169
v_mov_b32 v48, 0
v_mov_b32 v49, 0
v_mov_b32 v50, 0
v_mov_b32 v51, 0
s_waitcnt vmcnt(12)
s_cbranch_scc1 L_rn_168
v_max3_u32 v2, v16, v17, v18
v_max3_u32 v2, v2, v19, v20
v_max3_u32 v2, v2, v21, v22
v_max3_u32 v2, v2, v23, v24
v_max3_u32 v2, v2, v25, v26
v_max3_u32 v2, v2, v27, v28
v_max3_u32 v2, v2, v29, v30
v_max_u32 v2, v2, v31
v_cmp_eq_u32 vcc, -1, v2
s_cbranch_vccz L_rx_167
s_cmp_lt_u32 s75, 0x100000
s_cbranch_scc1 L_rn_168
L_rx_167:
v_smfmac_f32_16x16x64_bf16 v[48:51], v[44:47], v[16:23], v43
v_smfmac_f32_16x16x64_bf16 v[48:51], v[44:47], v[24:31], v43
s_nop 7
v_add_f32_dpp v13, v48, v48 row_ror:8 row_mask:0x3 bank_mask:0x3
v_add_f32_dpp v13, v49, v49 row_ror:8 row_mask:0x3 bank_mask:0xc
v_add_f32_dpp v13, v50, v50 row_ror:8 row_mask:0xc bank_mask:0x3
v_add_f32_dpp v13, v51, v51 row_ror:8 row_mask:0xc bank_mask:0xc
L_rz_169:
v_fmac_f32 v8, v13, v9
s_nop 1
v_mov_b32_dpp v14, v8 quad_perm:[1,1,3,3] row_mask:0xf bank_mask:0xf
v_mov_b32_dpp v13, v8 quad_perm:[0,0,2,2] row_mask:0xf bank_mask:0xf
v_cvt_pk_bf16_f32 v13, v13, v14
buffer_store_dword v13, v12, s[36:39], s68 offen sc1
v_cvt_pk_bf16_f32 v8, 0, v8
buffer_load_dwordx4 v[64:67], v1, s[36:39], s64 offen offset:0 sc1
buffer_load_dwordx4 v[68:71], v1, s[36:39], s64 offen offset:1024 sc1
buffer_load_dwordx4 v[72:75], v1, s[36:39], s64 offen offset:2048 sc1
buffer_load_dwordx4 v[76:79], v1, s[36:39], s64 offen offset:3072 sc1
buffer_load_dwordx4 v[80:83], v1, s[36:39], s65 offen offset:0 sc1
buffer_load_dwordx4 v[84:87], v41, s[36:39], s65 offen offset:1024 sc1
s_mov_b32 s75, 0
s_waitcnt vmcnt(0)
buffer_load_dwordx4 v[64:67], v1, s[36:39], s64 offen offset:0 sc1
buffer_load_dwordx4 v[68:71], v1, s[36:39], s64 offen offset:1024 sc1
buffer_load_dwordx4 v[72:75], v1, s[36:39], s64 offen offset:2048 sc1
buffer_load_dwordx4 v[76:79], v1, s[36:39], s64 offen offset:3072 sc1
buffer_load_dwordx4 v[80:83], v1, s[36:39], s65 offen offset:0 sc1
buffer_load_dwordx4 v[84:87], v41, s[36:39], s65 offen offset:1024 sc1
s_sleep 1
buffer_load_dwordx4 v[64:67], v1, s[36:39], s64 offen offset:0 sc1
buffer_load_dwordx4 v[68:71], v1, s[36:39], s64 offen offset:1024 sc1
buffer_load_dwordx4 v[72:75], v1, s[36:39], s64 offen offset:2048 sc1
buffer_load_dwordx4 v[76:79], v1, s[36:39], s64 offen offset:3072 sc1
buffer_load_dwordx4 v[80:83], v1, s[36:39], s65 offen offset:0 sc1
buffer_load_dwordx4 v[84:87], v41, s[36:39], s65 offen offset:1024 sc1
s_sleep 1
L_rn_172:
v_smfmac_f32_16x16x64_bf16 v[52:55], v[44:47], v[64:71], v43
v_smfmac_f32_16x16x64_bf16 v[52:55], v[44:47], v[72:79], v43
v_smfmac_f32_16x16x64_bf16 v[52:55], v[44:47], v[80:87], v43
buffer_load_dwordx4 v[64:67], v1, s[36:39], s64 offen offset:0 sc1
buffer_load_dwordx4 v[68:71], v1, s[36:39], s64 offen offset:1024 sc1
buffer_load_dwordx4 v[72:75], v1, s[36:39], s64 offen offset:2048 sc1
buffer_load_dwordx4 v[76:79], v1, s[36:39], s64 offen offset:3072 sc1
buffer_load_dwordx4 v[80:83], v1, s[36:39], s65 offen offset:0 sc1
buffer_load_dwordx4 v[84:87], v41, s[36:39], s65 offen offset:1024 sc1
s_add_u32 s75, s75, 1
s_and_b32 s78, s75, 15
v_add_f32_dpp v13, v52, v52 row_ror:8 row_mask:0x3 bank_mask:0x3
v_add_f32_dpp v13, v53, v53 row_ror:8 row_mask:0x3 bank_mask:0xc
v_add_f32_dpp v13, v54, v54 row_ror:8 row_mask:0xc bank_mask:0x3
v_add_f32_dpp v13, v55, v55 row_ror:8 row_mask:0xc bank_mask:0xc
v_cmp_u_f32 vcc, v13, v13
s_cbranch_vccz L_rz_173
v_mov_b32 v52, 0
v_mov_b32 v53, 0
v_mov_b32 v54, 0
v_mov_b32 v55, 0
s_waitcnt vmcnt(12)
s_cbranch_scc1 L_rn_172
v_max3_u32 v2, v64, v65, v66
v_max3_u32 v2, v2, v67, v68
v_max3_u32 v2, v2, v69, v70
v_max3_u32 v2, v2, v71, v72
v_max3_u32 v2, v2, v73, v74
v_max3_u32 v2, v2, v75, v76
v_max3_u32 v2, v2, v77, v78
v_max3_u32 v2, v2, v79, v80
v_max3_u32 v2, v2, v81, v82
v_max3_u32 v2, v2, v83, v84
v_max3_u32 v2, v2, v85, v86
v_max_u32 v2, v2, v87
v_cmp_eq_u32 vcc, -1, v2
s_cbranch_vccz L_rx_171
s_cmp_lt_u32 s75, 0x100000
s_cbranch_scc1 L_rn_172
L_rx_171:
v_smfmac_f32_16x16x64_bf16 v[52:55], v[44:47], v[64:71], v43
v_smfmac_f32_16x16x64_bf16 v[52:55], v[44:47], v[72:79], v43
v_smfmac_f32_16x16x64_bf16 v[52:55], v[44:47], v[80:87], v43
s_nop 7
v_add_f32_dpp v13, v52, v52 row_ror:8 row_mask:0x3 bank_mask:0x3
v_add_f32_dpp v13, v53, v53 row_ror:8 row_mask:0x3 bank_mask:0xc
v_add_f32_dpp v13, v54, v54 row_ror:8 row_mask:0xc bank_mask:0x3
v_add_f32_dpp v13, v55, v55 row_ror:8 row_mask:0xc bank_mask:0xc
L_rz_173:
v_fmac_f32 v8, v13, v10
s_nop 1
v_mov_b32_dpp v14, v8 quad_perm:[1,1,3,3] row_mask:0xf bank_mask:0xf
s_not_b64 exec, s[76:77]
v_cvt_pk_bf16_f32 v13, v8, v14
buffer_store_dword v13, v6, s[56:59], s73 offen sc1
s_mov_b64 exec, -1
s_cmp_lt_u32 s70, 8
s_cbranch_scc0 L_fin2
s_mov_b64 exec, 0xffff
buffer_store_dwordx4 v[44:47], v1, s[36:39], s62 offen sc1
s_mov_b64 exec, -1
L_fin2:
s_endpgm
L_ffn:
s_mul_i32 s67, s3, 12288
s_add_u32 s67, s67, 25600
v_lshlrev_b32 v7, 3, v0
buffer_load_dwordx4 v[8:11], v1, s[36:39], s67 offen offset:0 sc1
buffer_load_dwordx4 v[12:15], v1, s[36:39], s67 offen offset:1024 sc1
s_cmp_lt_u32 s3, 4
s_cbranch_scc1 L_post_174
s_mov_b32 s40, s16
s_mov_b32 s41, s17
s_mov_b32 s42, 0x158000
s_mov_b32 s43, 0x20000
s_mov_b32 s56, s18
s_mov_b32 s57, s19
s_mov_b32 s58, 0x158000
s_mov_b32 s59, 0x20000
v_lshrrev_b32 v16, 2, v0
v_mul_u32_u24 v16, 2752, v16
v_and_b32 v17, 3, v0
v_lshrrev_b32 v18, 5, v0
v_xor_b32 v17, v17, v18
v_xor_b32 v18, 2, v17
v_lshl_add_u32 v17, v17, 4, v16
v_lshl_add_u32 v18, v18, 4, v16
s_mul_i32 s64, s34, 352256
s_lshl_b32 s65, s74, 6
s_add_u32 s64, s64, s65
s_lshl_b32 s65, s34, 13
s_add_u32 m0, s65, 4096
s_add_u32 s66, s64, 0
buffer_load_dwordx4 v17, s[40:43], s66 offen  lds
s_add_u32 m0, s65, 36864
s_add_u32 s66, s64, 0
buffer_load_dwordx4 v18, s[56:59], s66 offen  lds
s_add_u32 m0, s65, 5120
s_add_u32 s66, s64, 44032
buffer_load_dwordx4 v17, s[40:43], s66 offen  lds
s_add_u32 m0, s65, 37888
s_add_u32 s66, s64, 44032
buffer_load_dwordx4 v18, s[56:59], s66 offen  lds
s_add_u32 m0, s65, 6144
s_add_u32 s66, s64, 88064
buffer_load_dwordx4 v17, s[40:43], s66 offen  lds
s_add_u32 m0, s65, 38912
s_add_u32 s66, s64, 88064
buffer_load_dwordx4 v18, s[56:59], s66 offen  lds
s_add_u32 m0, s65, 7168
s_add_u32 s66, s64, 132096
buffer_load_dwordx4 v17, s[40:43], s66 offen  lds
s_add_u32 m0, s65, 39936
s_add_u32 s66, s64, 132096
buffer_load_dwordx4 v18, s[56:59], s66 offen  lds
s_add_u32 m0, s65, 8192
s_add_u32 s66, s64, 176128
buffer_load_dwordx4 v17, s[40:43], s66 offen  lds
s_add_u32 m0, s65, 40960
s_add_u32 s66, s64, 176128
buffer_load_dwordx4 v18, s[56:59], s66 offen  lds
s_add_u32 m0, s65, 9216
s_add_u32 s66, s64, 220160
buffer_load_dwordx4 v17, s[40:43], s66 offen  lds
s_add_u32 m0, s65, 41984
s_add_u32 s66, s64, 220160
buffer_load_dwordx4 v18, s[56:59], s66 offen  lds
s_add_u32 m0, s65, 10240
s_add_u32 s66, s64, 264192
buffer_load_dwordx4 v17, s[40:43], s66 offen  lds
s_add_u32 m0, s65, 43008
s_add_u32 s66, s64, 264192
buffer_load_dwordx4 v18, s[56:59], s66 offen  lds
s_add_u32 m0, s65, 11264
s_add_u32 s66, s64, 308224
buffer_load_dwordx4 v17, s[40:43], s66 offen  lds
s_add_u32 m0, s65, 44032
s_add_u32 s66, s64, 308224
buffer_load_dwordx4 v18, s[56:59], s66 offen  lds
s_waitcnt vmcnt(16)
s_branch L_post_175
L_post_174:
s_waitcnt vmcnt(0)
L_post_175:
v_max3_u32 v16, v8, v9, v10
v_max3_u32 v16, v16, v11, v12
v_max3_u32 v16, v16, v13, v14
v_max_u32 v16, v16, v15
v_cmp_eq_u32 vcc, -1, v16
s_cbranch_vccz L_cb_176
s_mov_b32 s75, 0
L_poll_177:
buffer_load_dwordx4 v[8:11], v1, s[36:39], s67 offen offset:0 sc1
buffer_load_dwordx4 v[12:15], v1, s[36:39], s67 offen offset:1024 sc1
s_waitcnt vmcnt(0)
v_max3_u32 v16, v8, v9, v10
v_max3_u32 v16, v16, v11, v12
v_max3_u32 v16, v16, v13, v14
v_max_u32 v16, v16, v15
v_cmp_eq_u32 vcc, -1, v16
s_cbranch_vccz L_pollx_178
s_add_u32 s75, s75, 1
s_cmp_lt_u32 s75, 0x100000
s_cbranch_scc1 L_poll_177
L_pollx_178:
L_cb_176:
s_mov_b32 s68, 0xffff0000
v_lshlrev_b32 v24, 16, v8
v_and_b32 v25, s68, v8
v_lshlrev_b32 v32, 16, v12
v_and_b32 v33, s68, v12
v_lshlrev_b32 v26, 16, v9
v_and_b32 v27, s68, v9
v_lshlrev_b32 v34, 16, v13
v_and_b32 v35, s68, v13
v_lshlrev_b32 v28, 16, v10
v_and_b32 v29, s68, v10
v_lshlrev_b32 v36, 16, v14
v_and_b32 v37, s68, v14
v_lshlrev_b32 v30, 16, v11
v_and_b32 v31, s68, v11
v_lshlrev_b32 v38, 16, v15
v_and_b32 v39, s68, v15
v_add_f32 v32, 1.0, v32
v_add_f32 v33, 1.0, v33
v_add_f32 v34, 1.0, v34
v_add_f32 v35, 1.0, v35
v_add_f32 v36, 1.0, v36
v_add_f32 v37, 1.0, v37
v_add_f32 v38, 1.0, v38
v_add_f32 v39, 1.0, v39
v_lshrrev_b32 v2, 3, v0
v_bfe_u32 v3, v0, 1, 3
v_and_b32 v4, 3, v3
s_lshl_b32 s64, s3, 1
v_xor_b32 v3, s64, v3
v_lshlrev_b32 v5, 10, v2
v_lshl_add_u32 v5, v4, 8, v5
v_lshl_add_u32 v5, v3, 4, v5
v_and_b32 v4, 1, v0
v_lshl_add_u32 v5, v4, 3, v5
v_add_u32 v5, 69632, v5
v_xor_b32 v6, 16, v5
v_mul_u32_u24 v16, 0xaaaa, v4
v_add_u32 v16, 0x4444, v16
v_lshrrev_b32 v2, 4, v0
v_bfe_u32 v3, v0, 3, 1
v_xor_b32 v7, v2, v0
v_lshlrev_b32 v7, 4, v7
v_add_u32 v7, 69632, v7
v_xor_b32 v8, 64, v7
v_and_b32 v4, 7, v0
v_and_b32 v9, 0x38, v0
v_lshlrev_b32 v9, 3, v9
v_lshl_add_u32 v9, v4, 1, v9
s_lshl_b32 s64, s34, 4
v_add_u32 v9, s64, v9
v_and_b32 v10, 12, v0
v_lshlrev_b32 v10, 5, v10
v_and_b32 v4, 1, v0
v_lshl_add_u32 v10, v4, 6, v10
v_lshl_add_u32 v10, v2, 4, v10
v_mov_b32 v17, 0xbfb8aa3b
v_mov_b32 v64, 0
v_mov_b32 v65, 0
v_mov_b32 v66, 0
v_mov_b32 v67, 0
s_lshl_b32 s64, s34, 3
s_lshr_b32 s64, s35, s64
v_lshlrev_b32 v3, 2, v3
v_bfe_u32 v3, s64, v3, 3
v_and_b32 v11, 6, v3
v_lshlrev_b32 v11, 12, v11
v_and_b32 v3, 1, v3
v_lshl_add_u32 v11, v3, 15, v11
v_lshl_add_u32 v11, v2, 17, v11
v_and_b32 v4, 240, v1
v_add_u32 v11, v11, v4
v_lshl_add_u32 v11, v2, 9, v11
s_lshl_b32 s64, s34, 8
v_add_u32 v11, s64, v11
s_lshl_b32 s69, s74, 7
s_add_u32 s69, s69, 1376256
s_add_u32 s72, s69, 65536
s_lshl_b32 s64, s3, 10
s_lshl_b32 s65, s2, 2
s_lshr_b32 s65, s35, s65
s_and_b32 s65, s65, 2
s_lshl_b32 s65, s65, 12
s_add_u32 s64, s64, s65
s_add_u32 s64, s64, 1310720
v_mov_b32 v14, 0xbb000000
v_mov_b32 v15, 0x3b000000
v_lshrrev_b32 v18, 4, v0
v_bfe_u32 v19, v0, 2, 2
v_bfe_u32 v20, v0, 1, 1
v_and_b32 v22, 1, v18
v_lshl_add_u32 v22, v20, 1, v22
v_xor_b32 v22, s34, v22
v_lshlrev_b32 v22, 4, v22
v_lshl_add_u32 v22, v20, 15, v22
v_lshl_add_u32 v22, v18, 9, v22
v_lshl_add_u32 v22, v19, 6, v22
v_and_b32 v20, 1, v0
v_lshl_add_u32 v22, v20, 3, v22
v_add_u32 v22, 4096, v22
s_lshr_b32 s73, s3, 2
s_waitcnt vmcnt(0)
s_barrier
buffer_load_dwordx4 v[56:59], v1, s[36:39], s64 offen sc1
s_cmp_eq_u32 s73, 0
s_cbranch_scc1 L_gu_180
ds_read_b64_tr_b16 v[128:129], v22 offset:0
ds_read_b64_tr_b16 v[130:131], v22 offset:256
ds_read_b64_tr_b16 v[132:133], v22 offset:2048
ds_read_b64_tr_b16 v[134:135], v22 offset:2304
ds_read_b64_tr_b16 v[136:137], v22 offset:4096
ds_read_b64_tr_b16 v[138:139], v22 offset:4352
ds_read_b64_tr_b16 v[140:141], v22 offset:6144
ds_read_b64_tr_b16 v[142:143], v22 offset:6400
ds_read_b64_tr_b16 v[144:145], v22 offset:8192
ds_read_b64_tr_b16 v[146:147], v22 offset:8448
ds_read_b64_tr_b16 v[148:149], v22 offset:10240
s_waitcnt lgkmcnt(4)
ds_read_b64_tr_b16 v[150:151], v22 offset:10496
ds_read_b64_tr_b16 v[152:153], v22 offset:12288
ds_read_b64_tr_b16 v[154:155], v22 offset:12544
ds_read_b64_tr_b16 v[156:157], v22 offset:14336
ds_read_b64_tr_b16 v[158:159], v22 offset:14592
ds_read_b64_tr_b16 v[160:161], v22 offset:16384
ds_read_b64_tr_b16 v[162:163], v22 offset:16640
ds_read_b64_tr_b16 v[164:165], v22 offset:18432
ds_read_b64_tr_b16 v[166:167], v22 offset:18688
ds_read_b64_tr_b16 v[168:169], v22 offset:20480
ds_read_b64_tr_b16 v[170:171], v22 offset:20736
s_waitcnt lgkmcnt(4)
ds_read_b64_tr_b16 v[172:173], v22 offset:22528
ds_read_b64_tr_b16 v[174:175], v22 offset:22784
ds_read_b64_tr_b16 v[176:177], v22 offset:24576
ds_read_b64_tr_b16 v[178:179], v22 offset:24832
ds_read_b64_tr_b16 v[180:181], v22 offset:26624
ds_read_b64_tr_b16 v[182:183], v22 offset:26880
ds_read_b64_tr_b16 v[184:185], v22 offset:28672
ds_read_b64_tr_b16 v[186:187], v22 offset:28928
ds_read_b64_tr_b16 v[188:189], v22 offset:30720
ds_read_b64_tr_b16 v[190:191], v22 offset:30976
v_add_u32 v68, 69632, v40
v_add_u32 v69, 69632, v41
v_add_u32 v70, 69632, v42
v_add_u32 v71, 69632, v43
v_add_u32 v72, 69632, v44
v_add_u32 v73, 69632, v45
v_add_u32 v74, 69632, v46
v_add_u32 v75, 69632, v47
L_gu_180:
s_cmp_lt_u32 s3, 4
s_cbranch_scc0 L_dma_181
s_mov_b32 s48, s20
s_mov_b32 s49, s21
s_mov_b32 s50, 0x158000
s_mov_b32 s51, 0x20000
v_lshrrev_b32 v18, 4, v0
v_and_b32 v16, 15, v0
v_xor_b32 v16, v16, v18
v_xor_b32 v17, 4, v16
v_lshlrev_b32 v19, 10, v18
v_lshl_add_u32 v22, v16, 4, v19
v_lshl_add_u32 v23, v17, 4, v19
s_lshl_b32 s76, s74, 15
s_lshl_b32 s66, s34, 8
s_add_u32 s76, s76, s66
s_lshl_b32 s77, s34, 13
s_add_u32 s77, s77, 77824
s_add_u32 m0, s77, 0
s_xor_b32 s66, s76, 0
buffer_load_dwordx4 v22, s[48:51], s66 offen  lds
s_add_u32 m0, s77, 1024
s_xor_b32 s66, s76, 8192
buffer_load_dwordx4 v23, s[48:51], s66 offen  lds
s_add_u32 m0, s77, 2048
s_xor_b32 s66, s76, 16384
buffer_load_dwordx4 v22, s[48:51], s66 offen  lds
s_add_u32 m0, s77, 3072
s_xor_b32 s66, s76, 24576
buffer_load_dwordx4 v23, s[48:51], s66 offen  lds
s_add_u32 m0, s77, 4096
s_xor_b32 s66, s76, 4096
buffer_load_dwordx4 v22, s[48:51], s66 offen  lds
s_add_u32 m0, s77, 5120
s_xor_b32 s66, s76, 12288
buffer_load_dwordx4 v23, s[48:51], s66 offen  lds
s_add_u32 m0, s77, 6144
s_xor_b32 s66, s76, 20480
buffer_load_dwordx4 v22, s[48:51], s66 offen  lds
s_add_u32 m0, s77, 7168
s_xor_b32 s66, s76, 28672
buffer_load_dwordx4 v23, s[48:51], s66 offen  lds
s_waitcnt vmcnt(8)
s_branch L_dma_182
L_dma_181:
s_waitcnt vmcnt(0)
L_dma_182:
s_mov_b32 s73, 0x3f803f80
v_mov_b32 v20, 0
v_mov_b32 v21, 0
v_max3_u32 v12, v56, v57, v58
v_max_u32 v12, v12, v59
v_cmp_eq_u32 vcc, -1, v12
s_cbranch_vccz L_x_179
buffer_load_dwordx4 v[56:59], v1, s[36:39], s64 offen sc1
s_sleep 1
s_mov_b32 s75, 0
L_poll_183:
buffer_load_dwordx4 v[56:59], v1, s[36:39], s64 offen sc1
s_waitcnt vmcnt(1)
v_max3_u32 v12, v56, v57, v58
v_max_u32 v12, v12, v59
v_cmp_eq_u32 vcc, -1, v12
s_cbranch_vccz L_pollx_184
s_add_u32 s75, s75, 1
s_cmp_lt_u32 s75, 0x100000
s_cbranch_scc1 L_poll_183
L_pollx_184:
L_x_179:
v_dot2c_f32_bf16 v20, s73, v56
v_dot2c_f32_bf16 v21, v56, v56
v_dot2c_f32_bf16 v20, s73, v57
v_dot2c_f32_bf16 v21, v57, v57
v_dot2c_f32_bf16 v20, s73, v58
v_dot2c_f32_bf16 v21, v58, v58
v_dot2c_f32_bf16 v20, s73, v59
v_dot2c_f32_bf16 v21, v59, v59
v_lshlrev_b32 v40, 16, v56
v_and_b32 v41, s68, v56
v_lshlrev_b32 v42, 16, v57
v_permlane32_swap_b32 v20, v21
v_add_f32 v12, v20, v21
v_and_b32 v43, s68, v57
v_lshlrev_b32 v44, 16, v58
v_add_f32_dpp v12, v12, v12 quad_perm:[1,0,3,2] row_mask:0xf bank_mask:0xf
v_and_b32 v45, s68, v58
v_lshlrev_b32 v46, 16, v59
v_add_f32_dpp v12, v12, v12 quad_perm:[2,3,0,1] row_mask:0xf bank_mask:0xf
v_and_b32 v47, s68, v59
v_pk_mul_f32 v[48:49], v[40:41], v[32:33]
v_add_f32_dpp v12, v12, v12 row_ror:4 row_mask:0xf bank_mask:0xf
v_pk_mul_f32 v[50:51], v[42:43], v[34:35]
v_pk_mul_f32 v[52:53], v[44:45], v[36:37]
v_add_f32_dpp v12, v12, v12 row_ror:8 row_mask:0xf bank_mask:0xf
v_pk_mul_f32 v[54:55], v[46:47], v[38:39]
s_nop 0
v_add_f32_dpp v12, v12, v12 row_bcast:15 row_mask:0xa bank_mask:0xf
s_nop 0
v_readlane_b32 s70, v12, 16
v_readlane_b32 s71, v12, 48
s_nop 0
v_mul_f32 v12, s70, v14
v_mul_f32 v13, s71, v15
v_fma_f32 v13, -v12, v12, v13
v_max_f32 v13, 0, v13
v_add_f32 v13, 0x3727c5ac, v13
v_rsq_f32 v2, v13
v_pk_fma_f32 v[48:49], v[12:13], v[32:33], v[48:49] op_sel_hi:[0,1,1]
v_pk_fma_f32 v[50:51], v[12:13], v[34:35], v[50:51] op_sel_hi:[0,1,1]
v_pk_fma_f32 v[52:53], v[12:13], v[36:37], v[52:53] op_sel_hi:[0,1,1]
v_pk_fma_f32 v[54:55], v[12:13], v[38:39], v[54:55] op_sel_hi:[0,1,1]
v_pk_fma_f32 v[24:25], v[2:3], v[48:49], v[24:25] op_sel_hi:[0,1,1]
v_pk_fma_f32 v[28:29], v[2:3], v[52:53], v[28:29] op_sel_hi:[0,1,1]
v_pk_fma_f32 v[26:27], v[2:3], v[50:51], v[26:27] op_sel_hi:[0,1,1]
v_pk_fma_f32 v[30:31], v[2:3], v[54:55], v[30:31] op_sel_hi:[0,1,1]
v_cvt_pk_bf16_f32 v40, v24, v25
v_cvt_pk_bf16_f32 v41, v28, v29
ds_write_b64 v5, v[40:41]
v_cvt_pk_bf16_f32 v42, v26, v27
v_cvt_pk_bf16_f32 v43, v30, v31
ds_write_b64 v6, v[42:43]
s_cmp_lt_u32 s3, 4
s_waitcnt lgkmcnt(0)
s_barrier
s_cbranch_scc1 L_bar_fin
ds_read_b128 v[192:195], v7 offset:0
ds_read_b128 v[196:199], v8 offset:1024
ds_read_b128 v[200:203], v7 offset:2048
ds_read_b128 v[204:207], v8 offset:3072
ds_read_b128 v[208:211], v7 offset:4096
ds_read_b128 v[212:215], v8 offset:5120
ds_read_b128 v[216:219], v7 offset:6144
ds_read_b128 v[220:223], v8 offset:7168
s_waitcnt lgkmcnt(7)
v_smfmac_f32_16x16x64_bf16 v[64:67], v[192:195], v[128:135], v16
s_waitcnt lgkmcnt(6)
v_smfmac_f32_16x16x64_bf16 v[64:67], v[196:199], v[136:143], v16
s_waitcnt lgkmcnt(5)
v_smfmac_f32_16x16x64_bf16 v[64:67], v[200:203], v[144:151], v16
s_waitcnt lgkmcnt(4)
v_smfmac_f32_16x16x64_bf16 v[64:67], v[204:207], v[152:159], v16
s_waitcnt lgkmcnt(3)
v_smfmac_f32_16x16x64_bf16 v[64:67], v[208:211], v[160:167], v16
s_waitcnt lgkmcnt(2)
v_smfmac_f32_16x16x64_bf16 v[64:67], v[212:215], v[168:175], v16
s_waitcnt lgkmcnt(1)
v_smfmac_f32_16x16x64_bf16 v[64:67], v[216:219], v[176:183], v16
s_waitcnt lgkmcnt(0)
v_smfmac_f32_16x16x64_bf16 v[64:67], v[220:223], v[184:191], v16
s_nop 7
v_add_f32 v66, v66, v67
v_add_f32 v64, v64, v65
v_mul_f32 v18, v64, v17
v_mul_f32_dpp v18, v66, v17 row_ror:8 row_mask:0xf bank_mask:0xc
v_exp_f32 v18, v18
v_mov_b32_dpp v66, v64 row_ror:8 row_mask:0xf bank_mask:0x3
v_add_f32 v18, 1.0, v18
v_rcp_f32 v18, v18
s_nop 0
v_mul_f32 v18, v18, v66
v_cvt_pk_bf16_f32 v18, v18, v18
ds_write_b16 v9, v18 offset:3584
s_waitcnt lgkmcnt(0)
s_barrier
ds_read_b128 v[48:51], v10 offset:3584
ds_read_b64_tr_b16 v[96:97], v68 offset:0
ds_read_b64_tr_b16 v[98:99], v68 offset:4096
ds_read_b64_tr_b16 v[100:101], v69 offset:0
ds_read_b64_tr_b16 v[102:103], v69 offset:4096
ds_read_b64_tr_b16 v[104:105], v70 offset:0
ds_read_b64_tr_b16 v[106:107], v70 offset:4096
ds_read_b64_tr_b16 v[108:109], v71 offset:0
ds_read_b64_tr_b16 v[110:111], v71 offset:4096
ds_read_b64_tr_b16 v[112:113], v72 offset:0
ds_read_b64_tr_b16 v[114:115], v72 offset:4096
ds_read_b64_tr_b16 v[116:117], v73 offset:0
ds_read_b64_tr_b16 v[118:119], v73 offset:4096
s_waitcnt lgkmcnt(10)
v_mfma_f32_16x16x32_bf16 v[192:195], v[48:51], v[96:99], 0
ds_read_b64_tr_b16 v[120:121], v74 offset:0
ds_read_b64_tr_b16 v[122:123], v74 offset:4096
s_waitcnt lgkmcnt(10)
v_mfma_f32_16x16x32_bf16 v[196:199], v[48:51], v[100:103], 0
ds_read_b64_tr_b16 v[124:125], v75 offset:0
ds_read_b64_tr_b16 v[126:127], v75 offset:4096
s_waitcnt lgkmcnt(10)
v_mfma_f32_16x16x32_bf16 v[200:203], v[48:51], v[104:107], 0
s_waitcnt lgkmcnt(8)
v_mfma_f32_16x16x32_bf16 v[204:207], v[48:51], v[108:111], 0
s_waitcnt lgkmcnt(6)
v_mfma_f32_16x16x32_bf16 v[208:211], v[48:51], v[112:115], 0
s_nop 0
v_cvt_pk_bf16_f32 v16, v192, v196
s_waitcnt lgkmcnt(4)
v_mfma_f32_16x16x32_bf16 v[212:215], v[48:51], v[116:119], 0
v_cvt_pk_bf16_f32 v20, v193, v197
s_waitcnt lgkmcnt(2)
v_mfma_f32_16x16x32_bf16 v[216:219], v[48:51], v[120:123], 0
v_cvt_pk_bf16_f32 v17, v200, v204
v_cvt_pk_bf16_f32 v21, v201, v205
s_waitcnt lgkmcnt(0)
v_mfma_f32_16x16x32_bf16 v[220:223], v[48:51], v[124:127], 0
s_nop 2
v_cvt_pk_bf16_f32 v18, v208, v212
v_cvt_pk_bf16_f32 v22, v209, v213
s_nop 2
v_cvt_pk_bf16_f32 v19, v216, v220
buffer_store_dwordx4 v[16:19], v11, s[36:39], s69 offen sc1
v_cvt_pk_bf16_f32 v23, v217, v221
buffer_store_dwordx4 v[20:23], v11, s[36:39], s72 offen sc1
s_endpgm
L_bar_fin:
s_waitcnt vmcnt(0)
s_barrier
s_endpgm
L_srest:
s_lshr_b32 s32, s2, 5
s_and_b32 s33, s2, 31
s_and_b32 s67, s2, 7
s_lshr_b32 s68, s2, 3
s_sub_u32 s68, s68, 26
s_min_u32 s74, s67, 3
s_mul_i32 s66, s67, 5
s_add_u32 s74, s74, s66
s_add_u32 s74, s74, s68
s_cmp_lt_u32 s67, 3
s_cselect_b32 s66, 6, 5
s_cmp_lt_u32 s68, s66
s_cselect_b32 s74, s74, -1
s_cmp_lt_u32 s2, 48
s_cselect_b32 s66, 2, 3
s_cselect_b32 s72, 14+26, 42+26
s_cmp_lt_u32 s2, 16
s_cselect_b32 s66, 1, s66
s_cselect_b32 s72, 26, s72
s_lshl_b32 s66, s67, s66
s_add_u32 s72, s72, s66
s_add_u32 s72, s72, s68
s_mov_b32 s36, s30
s_mov_b32 s37, s31
s_mov_b32 s38, 0x1d0000
s_mov_b32 s39, 0x20000
s_mov_b32 s52, s28
s_mov_b32 s53, s29
s_mov_b32 s54, 0x100
s_mov_b32 s55, 0x20000
s_mov_b32 s46, 0x40000
s_mov_b32 s47, 0x20000
s_cmp_eq_u32 s74, -1
s_mov_b32 s69, 30
s_cselect_b32 s69, 20, s69
s_cmp_lt_u32 s2, 144
s_cselect_b32 s69, 0, s69
s_cmp_lt_u32 s2, 112
s_cselect_b32 s69, 50, s69
s_cmp_lt_u32 s2, 48
s_cselect_b32 s69, 30, s69
s_cmp_lt_u32 s2, 16
s_cselect_b32 s69, 40, s69
s_and_b32 s66, s72, 7
s_cmp_eq_u32 s66, 3
s_cselect_b32 s66, 40, 0
s_cmp_lt_u32 s2, 112
s_cselect_b32 s66, s66, 0
s_add_u32 s69, s69, s66
s_xor_b32 s64, s65, 1024
s_cmpk_gt_u32 s69, 4
s_cbranch_scc1 L_d_1
s_waitcnt vmcnt(3)
L_d_1:
buffer_load_dwordx4 v[24:27], v1, s[40:43], s64 offen nt
s_xor_b32 s64, s65, 33792
s_cmpk_gt_u32 s69, 5
s_cbranch_scc1 L_d_2
s_waitcnt vmcnt(3)
L_d_2:
buffer_load_dwordx4 v[28:31], v1, s[40:43], s64 offen nt
s_xor_b32 s64, s65, 5120
s_cmpk_gt_u32 s69, 6
s_cbranch_scc1 L_d_3
s_waitcnt vmcnt(3)
L_d_3:
buffer_load_dwordx4 v[32:35], v1, s[40:43], s64 offen nt
s_xor_b32 s64, s65, 37888
s_cmpk_gt_u32 s69, 7
s_waitcnt vmcnt(6)
s_cbranch_scc1 L_d_4
s_waitcnt vmcnt(3)
L_d_4:
buffer_load_dwordx4 v[36:39], v1, s[40:43], s64 offen nt
s_xor_b32 s64, s65, 65536
s_cmpk_gt_u32 s69, 8
s_waitcnt vmcnt(6)
s_cbranch_scc1 L_d_5
s_waitcnt vmcnt(3)
L_d_5:
buffer_load_dwordx4 v[40:43], v1, s[40:43], s64 offen nt
s_xor_b32 s64, s65, 98304
s_cmpk_gt_u32 s69, 9
s_waitcnt vmcnt(6)
s_cbranch_scc1 L_d_6
s_waitcnt vmcnt(3)
L_d_6:
buffer_load_dwordx4 v[44:47], v1, s[40:43], s64 offen nt
s_xor_b32 s64, s65, 69632
s_cmpk_gt_u32 s69, 10
s_waitcnt vmcnt(6)
s_cbranch_scc1 L_d_7
s_waitcnt vmcnt(3)
L_d_7:
buffer_load_dwordx4 v[48:51], v1, s[40:43], s64 offen nt
s_xor_b32 s64, s65, 102400
s_cmpk_gt_u32 s69, 11
s_waitcnt vmcnt(6)
s_cbranch_scc1 L_d_8
s_waitcnt vmcnt(3)
L_d_8:
buffer_load_dwordx4 v[52:55], v1, s[40:43], s64 offen nt
s_xor_b32 s64, s65, 66560
s_cmpk_gt_u32 s69, 12
s_waitcnt vmcnt(6)
s_cbranch_scc1 L_d_9
s_waitcnt vmcnt(3)
L_d_9:
buffer_load_dwordx4 v[56:59], v1, s[40:43], s64 offen nt
s_xor_b32 s64, s65, 99328
s_cmpk_gt_u32 s69, 13
s_waitcnt vmcnt(6)
s_cbranch_scc1 L_d_10
s_waitcnt vmcnt(3)
L_d_10:
buffer_load_dwordx4 v[60:63], v1, s[40:43], s64 offen nt
s_xor_b32 s64, s65, 70656
s_cmpk_gt_u32 s69, 14
s_waitcnt vmcnt(6)
s_cbranch_scc1 L_d_11
s_waitcnt vmcnt(3)
L_d_11:
buffer_load_dwordx4 v[64:67], v1, s[40:43], s64 offen nt
s_xor_b32 s64, s65, 103424
s_cmpk_gt_u32 s69, 15
s_waitcnt vmcnt(6)
s_cbranch_scc1 L_d_12
s_waitcnt vmcnt(3)
L_d_12:
buffer_load_dwordx4 v[68:71], v1, s[40:43], s64 offen nt
s_xor_b32 s64, s65, 131072
s_cmpk_gt_u32 s69, 16
s_waitcnt vmcnt(6)
s_cbranch_scc1 L_d_13
s_waitcnt vmcnt(3)
L_d_13:
buffer_load_dwordx4 v[72:75], v1, s[40:43], s64 offen nt
s_xor_b32 s64, s65, 163840
s_cmpk_gt_u32 s69, 17
s_waitcnt vmcnt(6)
s_cbranch_scc1 L_d_14
s_waitcnt vmcnt(3)
L_d_14:
buffer_load_dwordx4 v[76:79], v1, s[40:43], s64 offen nt
s_xor_b32 s64, s65, 135168
s_cmpk_gt_u32 s69, 18
s_waitcnt vmcnt(6)
s_cbranch_scc1 L_d_15
s_waitcnt vmcnt(3)
L_d_15:
buffer_load_dwordx4 v[80:83], v1, s[40:43], s64 offen nt
s_xor_b32 s64, s65, 167936
s_cmpk_gt_u32 s69, 19
s_waitcnt vmcnt(6)
s_cbranch_scc1 L_d_16
s_waitcnt vmcnt(3)
L_d_16:
buffer_load_dwordx4 v[84:87], v1, s[40:43], s64 offen nt
s_xor_b32 s64, s65, 132096
s_cmpk_gt_u32 s69, 20
s_waitcnt vmcnt(6)
s_cbranch_scc1 L_d_17
s_waitcnt vmcnt(4)
L_d_17:
buffer_load_dwordx4 v[88:91], v1, s[40:43], s64 offen nt
s_xor_b32 s64, s65, 164864
s_cmpk_gt_u32 s69, 21
s_waitcnt vmcnt(6)
s_cbranch_scc1 L_d_18
s_waitcnt vmcnt(4)
L_d_18:
buffer_load_dwordx4 v[92:95], v1, s[40:43], s64 offen nt
s_xor_b32 s64, s65, 136192
s_cmpk_gt_u32 s69, 22
s_waitcnt vmcnt(6)
s_cbranch_scc1 L_d_19
s_waitcnt vmcnt(4)
L_d_19:
buffer_load_dwordx4 v[96:99], v1, s[40:43], s64 offen nt
s_xor_b32 s64, s65, 168960
s_cmpk_gt_u32 s69, 23
s_waitcnt vmcnt(6)
s_cbranch_scc1 L_d_20
s_waitcnt vmcnt(4)
L_d_20:
buffer_load_dwordx4 v[100:103], v1, s[40:43], s64 offen nt
s_xor_b32 s64, s65, 196608
s_cmpk_gt_u32 s69, 24
s_waitcnt vmcnt(6)
s_cbranch_scc1 L_d_21
s_waitcnt vmcnt(4)
L_d_21:
buffer_load_dwordx4 v[104:107], v1, s[40:43], s64 offen nt
s_xor_b32 s64, s65, 229376
s_cmpk_gt_u32 s69, 25
s_waitcnt vmcnt(6)
s_cbranch_scc1 L_d_22
s_waitcnt vmcnt(4)
L_d_22:
buffer_load_dwordx4 v[108:111], v1, s[40:43], s64 offen nt
s_xor_b32 s64, s65, 200704
s_cmpk_gt_u32 s69, 26
s_waitcnt vmcnt(6)
s_cbranch_scc1 L_d_23
s_waitcnt vmcnt(4)
L_d_23:
buffer_load_dwordx4 v[112:115], v1, s[40:43], s64 offen nt
s_xor_b32 s64, s65, 233472
s_cmpk_gt_u32 s69, 27
s_waitcnt vmcnt(6)
s_cbranch_scc1 L_d_24
s_waitcnt vmcnt(4)
L_d_24:
buffer_load_dwordx4 v[116:119], v1, s[40:43], s64 offen nt
s_xor_b32 s64, s65, 197632
s_cmpk_gt_u32 s69, 28
s_waitcnt vmcnt(6)
s_cbranch_scc1 L_d_25
s_waitcnt vmcnt(4)
L_d_25:
buffer_load_dwordx4 v[120:123], v1, s[40:43], s64 offen nt
s_xor_b32 s64, s65, 230400
s_cmpk_gt_u32 s69, 29
s_waitcnt vmcnt(6)
s_cbranch_scc1 L_d_26
s_waitcnt vmcnt(4)
L_d_26:
buffer_load_dwordx4 v[124:127], v1, s[40:43], s64 offen nt
s_xor_b32 s64, s65, 201728
s_cmpk_gt_u32 s69, 30
s_waitcnt vmcnt(6)
s_cbranch_scc1 L_d_27
s_waitcnt vmcnt(4)
L_d_27:
buffer_load_dwordx4 v[128:131], v1, s[40:43], s64 offen nt
s_xor_b32 s64, s65, 234496
s_cmpk_gt_u32 s69, 31
s_waitcnt vmcnt(6)
s_cbranch_scc1 L_d_28
s_waitcnt vmcnt(4)
L_d_28:
buffer_load_dwordx4 v[132:135], v1, s[40:43], s64 offen nt
s_xor_b32 s64, s65, 2048
s_cmpk_gt_u32 s69, 32
s_waitcnt vmcnt(6)
s_cbranch_scc1 L_d_29
s_waitcnt vmcnt(4)
L_d_29:
buffer_load_dwordx4 v[136:139], v1, s[40:43], s64 offen nt
s_xor_b32 s64, s65, 34816
s_cmpk_gt_u32 s69, 33
s_waitcnt vmcnt(6)
s_cbranch_scc1 L_d_30
s_waitcnt vmcnt(4)
L_d_30:
buffer_load_dwordx4 v[140:143], v1, s[40:43], s64 offen nt
s_xor_b32 s64, s65, 6144
s_cmpk_gt_u32 s69, 34
s_waitcnt vmcnt(6)
s_cbranch_scc1 L_d_31
s_waitcnt vmcnt(4)
L_d_31:
buffer_load_dwordx4 v[144:147], v1, s[40:43], s64 offen nt
s_xor_b32 s64, s65, 38912
s_cmpk_gt_u32 s69, 35
s_waitcnt vmcnt(6)
s_cbranch_scc1 L_d_32
s_waitcnt vmcnt(4)
L_d_32:
buffer_load_dwordx4 v[148:151], v1, s[40:43], s64 offen nt
s_xor_b32 s64, s65, 3072
s_cmpk_gt_u32 s69, 36
s_waitcnt vmcnt(6)
s_cbranch_scc1 L_d_33
s_waitcnt vmcnt(4)
L_d_33:
buffer_load_dwordx4 v[152:155], v1, s[40:43], s64 offen nt
s_xor_b32 s64, s65, 35840
s_cmpk_gt_u32 s69, 37
s_waitcnt vmcnt(6)
s_cbranch_scc1 L_d_34
s_waitcnt vmcnt(4)
L_d_34:
buffer_load_dwordx4 v[156:159], v1, s[40:43], s64 offen nt
s_xor_b32 s64, s65, 7168
s_cmpk_gt_u32 s69, 38
s_waitcnt vmcnt(6)
s_cbranch_scc1 L_d_35
s_waitcnt vmcnt(4)
L_d_35:
buffer_load_dwordx4 v[160:163], v1, s[40:43], s64 offen nt
s_xor_b32 s64, s65, 39936
s_cmpk_gt_u32 s69, 39
s_waitcnt vmcnt(6)
s_cbranch_scc1 L_d_36
s_waitcnt vmcnt(4)
L_d_36:
buffer_load_dwordx4 v[164:167], v1, s[40:43], s64 offen nt
s_xor_b32 s64, s65, 67584
s_cmpk_gt_u32 s69, 40
s_waitcnt vmcnt(6)
s_cbranch_scc1 L_d_37
s_waitcnt vmcnt(4)
L_d_37:
buffer_load_dwordx4 v[168:171], v1, s[40:43], s64 offen nt
s_xor_b32 s64, s65, 100352
s_cmpk_gt_u32 s69, 41
s_waitcnt vmcnt(6)
s_cbranch_scc1 L_d_38
s_waitcnt vmcnt(4)
L_d_38:
buffer_load_dwordx4 v[172:175], v1, s[40:43], s64 offen nt
s_xor_b32 s64, s65, 71680
s_cmpk_gt_u32 s69, 42
s_waitcnt vmcnt(6)
s_cbranch_scc1 L_d_39
s_waitcnt vmcnt(4)
L_d_39:
buffer_load_dwordx4 v[176:179], v1, s[40:43], s64 offen nt
s_xor_b32 s64, s65, 104448
s_cmpk_gt_u32 s69, 43
s_waitcnt vmcnt(6)
s_cbranch_scc1 L_d_40
s_waitcnt vmcnt(4)
L_d_40:
buffer_load_dwordx4 v[180:183], v1, s[40:43], s64 offen nt
s_xor_b32 s64, s65, 68608
s_cmpk_gt_u32 s69, 44
s_waitcnt vmcnt(6)
s_cbranch_scc1 L_d_41
s_waitcnt vmcnt(4)
L_d_41:
buffer_load_dwordx4 v[184:187], v1, s[40:43], s64 offen nt
s_xor_b32 s64, s65, 101376
s_cmpk_gt_u32 s69, 45
s_waitcnt vmcnt(6)
s_cbranch_scc1 L_d_42
s_waitcnt vmcnt(4)
L_d_42:
buffer_load_dwordx4 v[188:191], v1, s[40:43], s64 offen nt
s_xor_b32 s64, s65, 72704
s_cmpk_gt_u32 s69, 46
s_waitcnt vmcnt(6)
s_cbranch_scc1 L_d_43
s_waitcnt vmcnt(4)
L_d_43:
buffer_load_dwordx4 v[192:195], v1, s[40:43], s64 offen nt
s_xor_b32 s64, s65, 105472
s_cmpk_gt_u32 s69, 47
s_waitcnt vmcnt(6)
s_cbranch_scc1 L_d_44
s_waitcnt vmcnt(4)
L_d_44:
buffer_load_dwordx4 v[196:199], v1, s[40:43], s64 offen nt
s_xor_b32 s64, s65, 133120
s_cmpk_gt_u32 s69, 48
s_waitcnt vmcnt(6)
s_cbranch_scc1 L_d_45
s_waitcnt vmcnt(4)
L_d_45:
buffer_load_dwordx4 v[200:203], v1, s[40:43], s64 offen nt
s_xor_b32 s64, s65, 165888
s_cmpk_gt_u32 s69, 49
s_waitcnt vmcnt(6)
s_cbranch_scc1 L_d_46
s_waitcnt vmcnt(4)
L_d_46:
buffer_load_dwordx4 v[204:207], v1, s[40:43], s64 offen nt
s_xor_b32 s64, s65, 137216
s_cmpk_gt_u32 s69, 50
s_waitcnt vmcnt(6)
s_cbranch_scc1 L_d_47
s_waitcnt vmcnt(4)
L_d_47:
buffer_load_dwordx4 v[208:211], v1, s[40:43], s64 offen nt
s_xor_b32 s64, s65, 169984
s_cmpk_gt_u32 s69, 51
s_waitcnt vmcnt(6)
s_cbranch_scc1 L_d_48
s_waitcnt vmcnt(4)
L_d_48:
buffer_load_dwordx4 v[212:215], v1, s[40:43], s64 offen nt
s_xor_b32 s64, s65, 134144
s_cmpk_gt_u32 s69, 52
s_waitcnt vmcnt(6)
s_cbranch_scc1 L_d_49
s_waitcnt vmcnt(4)
L_d_49:
buffer_load_dwordx4 v[216:219], v1, s[40:43], s64 offen nt
s_xor_b32 s64, s65, 166912
s_cmpk_gt_u32 s69, 53
s_waitcnt vmcnt(6)
s_cbranch_scc1 L_d_50
s_waitcnt vmcnt(4)
L_d_50:
buffer_load_dwordx4 v[220:223], v1, s[40:43], s64 offen nt
s_xor_b32 s64, s65, 138240
s_cmpk_gt_u32 s69, 54
s_waitcnt vmcnt(6)
s_cbranch_scc1 L_d_51
s_waitcnt vmcnt(4)
L_d_51:
buffer_load_dwordx4 v[224:227], v1, s[40:43], s64 offen nt
s_xor_b32 s64, s65, 171008
s_cmpk_gt_u32 s69, 55
s_waitcnt vmcnt(6)
s_cbranch_scc1 L_d_52
s_waitcnt vmcnt(4)
L_d_52:
buffer_load_dwordx4 v[228:231], v1, s[40:43], s64 offen nt
s_xor_b32 s64, s65, 198656
s_cmpk_gt_u32 s69, 56
s_waitcnt vmcnt(6)
s_cbranch_scc1 L_d_53
s_waitcnt vmcnt(4)
L_d_53:
buffer_load_dwordx4 v[232:235], v1, s[40:43], s64 offen nt
s_xor_b32 s64, s65, 231424
s_cmpk_gt_u32 s69, 57
s_waitcnt vmcnt(6)
s_cbranch_scc1 L_d_54
s_waitcnt vmcnt(4)
L_d_54:
buffer_load_dwordx4 v[236:239], v1, s[40:43], s64 offen nt
s_xor_b32 s64, s65, 202752
s_cmpk_gt_u32 s69, 58
s_waitcnt vmcnt(6)
s_cbranch_scc1 L_d_55
s_waitcnt vmcnt(4)
L_d_55:
buffer_load_dwordx4 v[240:243], v1, s[40:43], s64 offen nt
v_and_b32 v2, 31, v0
v_lshlrev_b32 v2, 2, v2
buffer_load_dword v3, v2, s[52:55], 0 offen offset:128
s_xor_b32 s64, s65, 235520
s_cmpk_gt_u32 s69, 59
s_waitcnt vmcnt(6)
s_cbranch_scc1 L_d_56
s_waitcnt vmcnt(4)
L_d_56:
buffer_load_dwordx4 v[244:247], v1, s[40:43], s64 offen nt
s_xor_b32 s64, s65, 199680
s_cmpk_gt_u32 s69, 60
s_waitcnt vmcnt(6)
s_cbranch_scc1 L_d_57
s_waitcnt vmcnt(4)
L_d_57:
buffer_load_dwordx4 v[248:251], v1, s[40:43], s64 offen nt
s_xor_b32 s64, s65, 232448
s_cmpk_gt_u32 s69, 61
s_waitcnt vmcnt(6)
s_cbranch_scc1 L_d_58
s_waitcnt vmcnt(4)
L_d_58:
buffer_load_dwordx4 v[252:255], v1, s[40:43], s64 offen nt
s_mul_i32 s70, s34, 15360
s_add_u32 s70, s70, 69632
s_add_u32 m0, s70, 0
s_xor_b32 s64, s65, 203776
s_cmpk_gt_u32 s69, 62
s_waitcnt vmcnt(6)
s_cbranch_scc1 L_d_59
s_waitcnt vmcnt(4)
L_d_59:
buffer_load_dwordx4 v1, s[40:43], s64 offen nt lds
s_add_u32 m0, s70, 1024
s_xor_b32 s64, s65, 236544
s_cmpk_gt_u32 s69, 63
s_waitcnt vmcnt(6)
s_cbranch_scc1 L_d_60
s_waitcnt vmcnt(4)
L_d_60:
buffer_load_dwordx4 v1, s[40:43], s64 offen nt lds
s_cmp_eq_u32 s74, -1
s_mov_b32 s69, 80
s_cselect_b32 s69, 80, s69
s_cmp_lt_u32 s2, 144
s_cselect_b32 s69, 80, s69
s_cmp_lt_u32 s2, 112
s_cselect_b32 s69, 112, s69
s_cmp_lt_u32 s2, 48
s_cselect_b32 s69, 0, s69
s_cmp_lt_u32 s2, 16
s_cselect_b32 s69, 112, s69
s_add_u32 m0, s70, 2048
s_xor_b32 s64, s65, 0
s_cmpk_gt_u32 s69, 64
s_waitcnt vmcnt(6)
s_cbranch_scc1 L_d_61
s_waitcnt vmcnt(4)
L_d_61:
buffer_load_dwordx4 v1, s[44:47], s64 offen nt lds
s_add_u32 m0, s70, 3072
s_xor_b32 s64, s65, 32768
s_cmpk_gt_u32 s69, 65
s_waitcnt vmcnt(6)
s_cbranch_scc1 L_d_62
s_waitcnt vmcnt(4)
L_d_62:
buffer_load_dwordx4 v1, s[44:47], s64 offen nt lds
s_add_u32 m0, s70, 4096
s_xor_b32 s64, s65, 4096
s_cmpk_gt_u32 s69, 66
s_waitcnt vmcnt(6)
s_cbranch_scc1 L_d_63
s_waitcnt vmcnt(4)
L_d_63:
buffer_load_dwordx4 v1, s[44:47], s64 offen nt lds
s_add_u32 m0, s70, 5120
s_xor_b32 s64, s65, 36864
s_cmpk_gt_u32 s69, 67
s_waitcnt vmcnt(6)
s_cbranch_scc1 L_d_64
s_waitcnt vmcnt(4)
L_d_64:
buffer_load_dwordx4 v1, s[44:47], s64 offen nt lds
v_cmp_eq_u32 vcc, 0, v3
s_cbranch_vccz L_jf_66
s_mov_b32 s75, 0
L_poll_67:
v_and_b32 v2, 31, v0
v_lshlrev_b32 v2, 2, v2
buffer_load_dword v3, v2, s[52:55], 0 offen offset:128 sc1
s_waitcnt vmcnt(0)
v_cmp_eq_u32 vcc, 0, v3
s_cbranch_vccz L_pollx_68
s_sleep 40
s_add_u32 s75, s75, 1
s_cmp_lt_u32 s75, 0x100000
s_cbranch_scc1 L_poll_67
L_pollx_68:
L_jf_66:
s_mul_i32 s68, s32, 12288
s_lshl_b32 s67, s33, 8
s_add_u32 s68, s68, s67
s_add_u32 s68, s68, 16384
v_and_b32 v2, 0xf0, v1
buffer_load_dwordx4 v[4:7], v2, s[36:39], s68 offen sc1
s_add_u32 m0, s70, 6144
s_xor_b32 s64, s65, 1024
s_cmpk_gt_u32 s69, 68
s_waitcnt vmcnt(6)
s_cbranch_scc1 L_d_65
s_waitcnt vmcnt(4)
L_d_65:
buffer_load_dwordx4 v1, s[44:47], s64 offen nt lds
s_add_u32 m0, s70, 7168
s_xor_b32 s64, s65, 33792
s_cmpk_gt_u32 s69, 69
s_waitcnt vmcnt(6)
s_cbranch_scc1 L_d_69
s_waitcnt vmcnt(4)
L_d_69:
buffer_load_dwordx4 v1, s[44:47], s64 offen nt lds
s_add_u32 m0, s70, 8192
s_xor_b32 s64, s65, 5120
s_cmpk_gt_u32 s69, 70
s_waitcnt vmcnt(6)
s_cbranch_scc1 L_d_70
s_waitcnt vmcnt(4)
L_d_70:
buffer_load_dwordx4 v1, s[44:47], s64 offen nt lds
s_add_u32 m0, s70, 9216
s_xor_b32 s64, s65, 37888
s_cmpk_gt_u32 s69, 71
s_waitcnt vmcnt(6)
s_cbranch_scc1 L_d_71
s_waitcnt vmcnt(4)
L_d_71:
buffer_load_dwordx4 v1, s[44:47], s64 offen nt lds
s_add_u32 m0, s70, 10240
s_xor_b32 s64, s65, 65536
s_cmpk_gt_u32 s69, 72
s_waitcnt vmcnt(6)
s_cbranch_scc1 L_d_72
s_waitcnt vmcnt(4)
L_d_72:
buffer_load_dwordx4 v1, s[44:47], s64 offen nt lds
s_add_u32 m0, s70, 11264
s_xor_b32 s64, s65, 98304
s_cmpk_gt_u32 s69, 73
s_waitcnt vmcnt(6)
s_cbranch_scc1 L_d_73
s_waitcnt vmcnt(4)
L_d_73:
buffer_load_dwordx4 v1, s[44:47], s64 offen nt lds
s_add_u32 m0, s70, 12288
s_xor_b32 s64, s65, 69632
s_cmpk_gt_u32 s69, 74
s_waitcnt vmcnt(6)
s_cbranch_scc1 L_d_74
s_waitcnt vmcnt(4)
L_d_74:
buffer_load_dwordx4 v1, s[44:47], s64 offen nt lds
s_add_u32 m0, s70, 13312
s_xor_b32 s64, s65, 102400
s_cmpk_gt_u32 s69, 75
s_waitcnt vmcnt(6)
s_cbranch_scc1 L_d_75
s_waitcnt vmcnt(4)
L_d_75:
buffer_load_dwordx4 v1, s[44:47], s64 offen nt lds
s_add_u32 m0, s70, 14336
s_xor_b32 s64, s65, 66560
s_cmpk_gt_u32 s69, 76
s_waitcnt vmcnt(6)
s_cbranch_scc1 L_d_76
s_waitcnt vmcnt(4)
L_d_76:
buffer_load_dwordx4 v1, s[44:47], s64 offen nt lds
v_max3_u32 v3, v4, v5, v6
v_max_u32 v3, v3, v7
v_cmp_eq_u32 vcc, -1, v3
s_cbranch_vccz L_q_77
s_mov_b32 s75, 0
L_poll_78:
s_mul_i32 s68, s32, 12288
s_lshl_b32 s67, s33, 8
s_add_u32 s68, s68, s67
s_add_u32 s68, s68, 16384
v_and_b32 v2, 0xf0, v1
buffer_load_dwordx4 v[4:7], v2, s[36:39], s68 offen sc1
s_waitcnt vmcnt(0)
v_max3_u32 v3, v4, v5, v6
v_max_u32 v3, v3, v7
v_cmp_eq_u32 vcc, -1, v3
s_cbranch_vccz L_pollx_79
s_add_u32 s75, s75, 1
s_cmp_lt_u32 s75, 0x100000
s_cbranch_scc1 L_poll_78
L_pollx_79:
L_q_77:
s_mov_b32 s66, 0x3db504f3
v_dot2_f32_bf16 v8, v8, v4, 0
v_dot2_f32_bf16 v12, v12, v4, 0
v_dot2_f32_bf16 v16, v16, v4, 0
v_dot2_f32_bf16 v20, v20, v4, 0
v_dot2c_f32_bf16 v8, v9, v5
v_dot2c_f32_bf16 v12, v13, v5
v_dot2c_f32_bf16 v16, v17, v5
v_dot2c_f32_bf16 v20, v21, v5
v_dot2c_f32_bf16 v8, v10, v6
v_dot2c_f32_bf16 v12, v14, v6
v_dot2c_f32_bf16 v16, v18, v6
v_dot2c_f32_bf16 v20, v22, v6
v_dot2c_f32_bf16 v8, v11, v7
v_dot2c_f32_bf16 v12, v15, v7
v_dot2c_f32_bf16 v16, v19, v7
v_dot2c_f32_bf16 v20, v23, v7
v_add_f32_dpp v9, v8, v8 row_ror:8 row_mask:0xf bank_mask:0x3
v_add_f32_dpp v13, v12, v12 row_ror:8 row_mask:0xf bank_mask:0x3
v_add_f32_dpp v9, v16, v16 row_ror:8 row_mask:0xf bank_mask:0xc
v_add_f32_dpp v13, v20, v20 row_ror:8 row_mask:0xf bank_mask:0xc
s_nop 0
v_add_f32_dpp v17, v9, v9 row_shl:4 row_mask:0xf bank_mask:0x5
v_add_f32_dpp v17, v13, v13 row_shr:4 row_mask:0xf bank_mask:0xa
s_nop 1
v_add_f32_dpp v17, v17, v17 quad_perm:[1,0,3,2] row_mask:0xf bank_mask:0xf
s_nop 1
v_add_f32_dpp v17, v17, v17 quad_perm:[2,3,0,1] row_mask:0xf bank_mask:0xf
v_cvt_pk_bf16_f32 v17, 0, v17
v_mul_f32 v17, s66, v17
v_cvt_pk_bf16_f32 v17, 0, v17
v_dot2_f32_bf16 v24, v24, v4, 0
v_dot2_f32_bf16 v28, v28, v4, 0
v_dot2_f32_bf16 v32, v32, v4, 0
v_dot2_f32_bf16 v36, v36, v4, 0
v_dot2c_f32_bf16 v24, v25, v5
v_dot2c_f32_bf16 v28, v29, v5
v_dot2c_f32_bf16 v32, v33, v5
v_dot2c_f32_bf16 v36, v37, v5
v_dot2c_f32_bf16 v24, v26, v6
v_dot2c_f32_bf16 v28, v30, v6
v_dot2c_f32_bf16 v32, v34, v6
v_dot2c_f32_bf16 v36, v38, v6
v_dot2c_f32_bf16 v24, v27, v7
v_dot2c_f32_bf16 v28, v31, v7
v_dot2c_f32_bf16 v32, v35, v7
v_dot2c_f32_bf16 v36, v39, v7
v_add_f32_dpp v25, v24, v24 row_ror:8 row_mask:0xf bank_mask:0x3
v_add_f32_dpp v29, v28, v28 row_ror:8 row_mask:0xf bank_mask:0x3
v_add_f32_dpp v25, v32, v32 row_ror:8 row_mask:0xf bank_mask:0xc
v_add_f32_dpp v29, v36, v36 row_ror:8 row_mask:0xf bank_mask:0xc
s_nop 0
v_add_f32_dpp v8, v25, v25 row_shl:4 row_mask:0xf bank_mask:0x5
v_add_f32_dpp v8, v29, v29 row_shr:4 row_mask:0xf bank_mask:0xa
s_nop 1
v_add_f32_dpp v8, v8, v8 quad_perm:[1,0,3,2] row_mask:0xf bank_mask:0xf
s_nop 1
v_add_f32_dpp v8, v8, v8 quad_perm:[2,3,0,1] row_mask:0xf bank_mask:0xf
v_cvt_pk_bf16_f32 v8, 0, v8
v_mul_f32 v8, s66, v8
v_cvt_pk_bf16_f32 v8, 0, v8
s_xor_b32 s64, s65, 99328
s_cmpk_gt_u32 s69, 77
s_waitcnt vmcnt(6)
s_cbranch_scc1 L_d_80
s_waitcnt vmcnt(4)
L_d_80:
buffer_load_dwordx4 v[24:27], v1, s[44:47], s64 offen nt
v_dot2_f32_bf16 v40, v40, v4, 0
v_dot2_f32_bf16 v44, v44, v4, 0
v_dot2_f32_bf16 v48, v48, v4, 0
v_dot2_f32_bf16 v52, v52, v4, 0
v_dot2c_f32_bf16 v40, v41, v5
v_dot2c_f32_bf16 v44, v45, v5
v_dot2c_f32_bf16 v48, v49, v5
v_dot2c_f32_bf16 v52, v53, v5
v_dot2c_f32_bf16 v40, v42, v6
v_dot2c_f32_bf16 v44, v46, v6
v_dot2c_f32_bf16 v48, v50, v6
v_dot2c_f32_bf16 v52, v54, v6
v_dot2c_f32_bf16 v40, v43, v7
v_dot2c_f32_bf16 v44, v47, v7
v_dot2c_f32_bf16 v48, v51, v7
v_dot2c_f32_bf16 v52, v55, v7
v_add_f32_dpp v41, v40, v40 row_ror:8 row_mask:0xf bank_mask:0x3
v_add_f32_dpp v45, v44, v44 row_ror:8 row_mask:0xf bank_mask:0x3
v_add_f32_dpp v41, v48, v48 row_ror:8 row_mask:0xf bank_mask:0xc
v_add_f32_dpp v45, v52, v52 row_ror:8 row_mask:0xf bank_mask:0xc
s_nop 0
v_add_f32_dpp v9, v41, v41 row_shl:4 row_mask:0xf bank_mask:0x5
v_add_f32_dpp v9, v45, v45 row_shr:4 row_mask:0xf bank_mask:0xa
s_nop 1
v_add_f32_dpp v9, v9, v9 quad_perm:[1,0,3,2] row_mask:0xf bank_mask:0xf
s_nop 1
v_add_f32_dpp v9, v9, v9 quad_perm:[2,3,0,1] row_mask:0xf bank_mask:0xf
v_cvt_pk_bf16_f32 v9, 0, v9
v_mul_f32 v9, s66, v9
v_cvt_pk_bf16_f32 v9, 0, v9
s_xor_b32 s64, s65, 70656
s_cmpk_gt_u32 s69, 78
s_waitcnt vmcnt(6)
s_cbranch_scc1 L_d_81
s_waitcnt vmcnt(4)
L_d_81:
buffer_load_dwordx4 v[28:31], v1, s[44:47], s64 offen nt
v_dot2_f32_bf16 v56, v56, v4, 0
v_dot2_f32_bf16 v60, v60, v4, 0
v_dot2_f32_bf16 v64, v64, v4, 0
v_dot2_f32_bf16 v68, v68, v4, 0
v_dot2c_f32_bf16 v56, v57, v5
v_dot2c_f32_bf16 v60, v61, v5
v_dot2c_f32_bf16 v64, v65, v5
v_dot2c_f32_bf16 v68, v69, v5
v_dot2c_f32_bf16 v56, v58, v6
v_dot2c_f32_bf16 v60, v62, v6
v_dot2c_f32_bf16 v64, v66, v6
v_dot2c_f32_bf16 v68, v70, v6
v_dot2c_f32_bf16 v56, v59, v7
v_dot2c_f32_bf16 v60, v63, v7
v_dot2c_f32_bf16 v64, v67, v7
v_dot2c_f32_bf16 v68, v71, v7
v_add_f32_dpp v57, v56, v56 row_ror:8 row_mask:0xf bank_mask:0x3
v_add_f32_dpp v61, v60, v60 row_ror:8 row_mask:0xf bank_mask:0x3
v_add_f32_dpp v57, v64, v64 row_ror:8 row_mask:0xf bank_mask:0xc
v_add_f32_dpp v61, v68, v68 row_ror:8 row_mask:0xf bank_mask:0xc
s_nop 0
v_add_f32_dpp v10, v57, v57 row_shl:4 row_mask:0xf bank_mask:0x5
v_add_f32_dpp v10, v61, v61 row_shr:4 row_mask:0xf bank_mask:0xa
s_nop 1
v_add_f32_dpp v10, v10, v10 quad_perm:[1,0,3,2] row_mask:0xf bank_mask:0xf
s_nop 1
v_add_f32_dpp v10, v10, v10 quad_perm:[2,3,0,1] row_mask:0xf bank_mask:0xf
v_cvt_pk_bf16_f32 v10, 0, v10
v_mul_f32 v10, s66, v10
v_cvt_pk_bf16_f32 v10, 0, v10
s_xor_b32 s64, s65, 103424
s_cmpk_gt_u32 s69, 79
s_waitcnt vmcnt(6)
s_cbranch_scc1 L_d_82
s_waitcnt vmcnt(4)
L_d_82:
buffer_load_dwordx4 v[32:35], v1, s[44:47], s64 offen nt
v_dot2_f32_bf16 v72, v72, v4, 0
v_dot2_f32_bf16 v76, v76, v4, 0
v_dot2_f32_bf16 v80, v80, v4, 0
v_dot2_f32_bf16 v84, v84, v4, 0
v_dot2c_f32_bf16 v72, v73, v5
v_dot2c_f32_bf16 v76, v77, v5
v_dot2c_f32_bf16 v80, v81, v5
v_dot2c_f32_bf16 v84, v85, v5
v_dot2c_f32_bf16 v72, v74, v6
v_dot2c_f32_bf16 v76, v78, v6
v_dot2c_f32_bf16 v80, v82, v6
v_dot2c_f32_bf16 v84, v86, v6
v_dot2c_f32_bf16 v72, v75, v7
v_dot2c_f32_bf16 v76, v79, v7
v_dot2c_f32_bf16 v80, v83, v7
v_dot2c_f32_bf16 v84, v87, v7
v_add_f32_dpp v73, v72, v72 row_ror:8 row_mask:0xf bank_mask:0x3
v_add_f32_dpp v77, v76, v76 row_ror:8 row_mask:0xf bank_mask:0x3
v_add_f32_dpp v73, v80, v80 row_ror:8 row_mask:0xf bank_mask:0xc
v_add_f32_dpp v77, v84, v84 row_ror:8 row_mask:0xf bank_mask:0xc
s_nop 0
v_add_f32_dpp v11, v73, v73 row_shl:4 row_mask:0xf bank_mask:0x5
v_add_f32_dpp v11, v77, v77 row_shr:4 row_mask:0xf bank_mask:0xa
s_nop 1
v_add_f32_dpp v11, v11, v11 quad_perm:[1,0,3,2] row_mask:0xf bank_mask:0xf
s_nop 1
v_add_f32_dpp v11, v11, v11 quad_perm:[2,3,0,1] row_mask:0xf bank_mask:0xf
v_cvt_pk_bf16_f32 v11, 0, v11
v_mul_f32 v11, s66, v11
v_cvt_pk_bf16_f32 v11, 0, v11
s_xor_b32 s64, s65, 131072
s_cmpk_gt_u32 s69, 80
s_waitcnt vmcnt(6)
s_cbranch_scc1 L_d_83
s_waitcnt vmcnt(4)
L_d_83:
buffer_load_dwordx4 v[36:39], v1, s[44:47], s64 offen nt
v_dot2_f32_bf16 v88, v88, v4, 0
v_dot2_f32_bf16 v92, v92, v4, 0
v_dot2_f32_bf16 v96, v96, v4, 0
v_dot2_f32_bf16 v100, v100, v4, 0
v_dot2c_f32_bf16 v88, v89, v5
v_dot2c_f32_bf16 v92, v93, v5
v_dot2c_f32_bf16 v96, v97, v5
v_dot2c_f32_bf16 v100, v101, v5
v_dot2c_f32_bf16 v88, v90, v6
v_dot2c_f32_bf16 v92, v94, v6
v_dot2c_f32_bf16 v96, v98, v6
v_dot2c_f32_bf16 v100, v102, v6
v_dot2c_f32_bf16 v88, v91, v7
v_dot2c_f32_bf16 v92, v95, v7
v_dot2c_f32_bf16 v96, v99, v7
v_dot2c_f32_bf16 v100, v103, v7
v_add_f32_dpp v89, v88, v88 row_ror:8 row_mask:0xf bank_mask:0x3
v_add_f32_dpp v93, v92, v92 row_ror:8 row_mask:0xf bank_mask:0x3
v_add_f32_dpp v89, v96, v96 row_ror:8 row_mask:0xf bank_mask:0xc
v_add_f32_dpp v93, v100, v100 row_ror:8 row_mask:0xf bank_mask:0xc
s_nop 0
v_add_f32_dpp v12, v89, v89 row_shl:4 row_mask:0xf bank_mask:0x5
v_add_f32_dpp v12, v93, v93 row_shr:4 row_mask:0xf bank_mask:0xa
s_nop 1
v_add_f32_dpp v12, v12, v12 quad_perm:[1,0,3,2] row_mask:0xf bank_mask:0xf
s_nop 1
v_add_f32_dpp v12, v12, v12 quad_perm:[2,3,0,1] row_mask:0xf bank_mask:0xf
v_cvt_pk_bf16_f32 v12, 0, v12
v_mul_f32 v12, s66, v12
v_cvt_pk_bf16_f32 v12, 0, v12
s_xor_b32 s64, s65, 163840
s_cmpk_gt_u32 s69, 81
s_waitcnt vmcnt(6)
s_cbranch_scc1 L_d_84
s_waitcnt vmcnt(4)
L_d_84:
buffer_load_dwordx4 v[40:43], v1, s[44:47], s64 offen nt
v_dot2_f32_bf16 v104, v104, v4, 0
v_dot2_f32_bf16 v108, v108, v4, 0
v_dot2_f32_bf16 v112, v112, v4, 0
v_dot2_f32_bf16 v116, v116, v4, 0
v_dot2c_f32_bf16 v104, v105, v5
v_dot2c_f32_bf16 v108, v109, v5
v_dot2c_f32_bf16 v112, v113, v5
v_dot2c_f32_bf16 v116, v117, v5
v_dot2c_f32_bf16 v104, v106, v6
v_dot2c_f32_bf16 v108, v110, v6
v_dot2c_f32_bf16 v112, v114, v6
v_dot2c_f32_bf16 v116, v118, v6
v_dot2c_f32_bf16 v104, v107, v7
v_dot2c_f32_bf16 v108, v111, v7
v_dot2c_f32_bf16 v112, v115, v7
v_dot2c_f32_bf16 v116, v119, v7
v_add_f32_dpp v105, v104, v104 row_ror:8 row_mask:0xf bank_mask:0x3
v_add_f32_dpp v109, v108, v108 row_ror:8 row_mask:0xf bank_mask:0x3
v_add_f32_dpp v105, v112, v112 row_ror:8 row_mask:0xf bank_mask:0xc
v_add_f32_dpp v109, v116, v116 row_ror:8 row_mask:0xf bank_mask:0xc
s_nop 0
v_add_f32_dpp v13, v105, v105 row_shl:4 row_mask:0xf bank_mask:0x5
v_add_f32_dpp v13, v109, v109 row_shr:4 row_mask:0xf bank_mask:0xa
s_nop 1
v_add_f32_dpp v13, v13, v13 quad_perm:[1,0,3,2] row_mask:0xf bank_mask:0xf
s_nop 1
v_add_f32_dpp v13, v13, v13 quad_perm:[2,3,0,1] row_mask:0xf bank_mask:0xf
v_cvt_pk_bf16_f32 v13, 0, v13
v_mul_f32 v13, s66, v13
v_cvt_pk_bf16_f32 v13, 0, v13
s_xor_b32 s64, s65, 135168
s_cmpk_gt_u32 s69, 82
s_waitcnt vmcnt(6)
s_cbranch_scc1 L_d_85
s_waitcnt vmcnt(4)
L_d_85:
buffer_load_dwordx4 v[44:47], v1, s[44:47], s64 offen nt
v_dot2_f32_bf16 v120, v120, v4, 0
v_dot2_f32_bf16 v124, v124, v4, 0
v_dot2_f32_bf16 v128, v128, v4, 0
v_dot2_f32_bf16 v132, v132, v4, 0
v_dot2c_f32_bf16 v120, v121, v5
v_dot2c_f32_bf16 v124, v125, v5
v_dot2c_f32_bf16 v128, v129, v5
v_dot2c_f32_bf16 v132, v133, v5
v_dot2c_f32_bf16 v120, v122, v6
v_dot2c_f32_bf16 v124, v126, v6
v_dot2c_f32_bf16 v128, v130, v6
v_dot2c_f32_bf16 v132, v134, v6
v_dot2c_f32_bf16 v120, v123, v7
v_dot2c_f32_bf16 v124, v127, v7
v_dot2c_f32_bf16 v128, v131, v7
v_dot2c_f32_bf16 v132, v135, v7
v_add_f32_dpp v121, v120, v120 row_ror:8 row_mask:0xf bank_mask:0x3
v_add_f32_dpp v125, v124, v124 row_ror:8 row_mask:0xf bank_mask:0x3
v_add_f32_dpp v121, v128, v128 row_ror:8 row_mask:0xf bank_mask:0xc
v_add_f32_dpp v125, v132, v132 row_ror:8 row_mask:0xf bank_mask:0xc
s_nop 0
v_add_f32_dpp v14, v121, v121 row_shl:4 row_mask:0xf bank_mask:0x5
v_add_f32_dpp v14, v125, v125 row_shr:4 row_mask:0xf bank_mask:0xa
s_nop 1
v_add_f32_dpp v14, v14, v14 quad_perm:[1,0,3,2] row_mask:0xf bank_mask:0xf
s_nop 1
v_add_f32_dpp v14, v14, v14 quad_perm:[2,3,0,1] row_mask:0xf bank_mask:0xf
v_cvt_pk_bf16_f32 v14, 0, v14
v_mul_f32 v14, s66, v14
v_cvt_pk_bf16_f32 v14, 0, v14
s_xor_b32 s64, s65, 167936
s_cmpk_gt_u32 s69, 83
s_waitcnt vmcnt(6)
s_cbranch_scc1 L_d_86
s_waitcnt vmcnt(4)
L_d_86:
buffer_load_dwordx4 v[48:51], v1, s[44:47], s64 offen nt
v_dot2_f32_bf16 v136, v136, v4, 0
v_dot2_f32_bf16 v140, v140, v4, 0
v_dot2_f32_bf16 v144, v144, v4, 0
v_dot2_f32_bf16 v148, v148, v4, 0
v_dot2c_f32_bf16 v136, v137, v5
v_dot2c_f32_bf16 v140, v141, v5
v_dot2c_f32_bf16 v144, v145, v5
v_dot2c_f32_bf16 v148, v149, v5
v_dot2c_f32_bf16 v136, v138, v6
v_dot2c_f32_bf16 v140, v142, v6
v_dot2c_f32_bf16 v144, v146, v6
v_dot2c_f32_bf16 v148, v150, v6
v_dot2c_f32_bf16 v136, v139, v7
v_dot2c_f32_bf16 v140, v143, v7
v_dot2c_f32_bf16 v144, v147, v7
v_dot2c_f32_bf16 v148, v151, v7
v_add_f32_dpp v137, v136, v136 row_ror:8 row_mask:0xf bank_mask:0x3
v_add_f32_dpp v141, v140, v140 row_ror:8 row_mask:0xf bank_mask:0x3
v_add_f32_dpp v137, v144, v144 row_ror:8 row_mask:0xf bank_mask:0xc
v_add_f32_dpp v141, v148, v148 row_ror:8 row_mask:0xf bank_mask:0xc
s_nop 0
v_add_f32_dpp v15, v137, v137 row_shl:4 row_mask:0xf bank_mask:0x5
v_add_f32_dpp v15, v141, v141 row_shr:4 row_mask:0xf bank_mask:0xa
s_nop 1
v_add_f32_dpp v15, v15, v15 quad_perm:[1,0,3,2] row_mask:0xf bank_mask:0xf
s_nop 1
v_add_f32_dpp v15, v15, v15 quad_perm:[2,3,0,1] row_mask:0xf bank_mask:0xf
v_cvt_pk_bf16_f32 v15, 0, v15
v_mul_f32 v15, s66, v15
v_cvt_pk_bf16_f32 v15, 0, v15
s_xor_b32 s64, s65, 132096
s_cmpk_gt_u32 s69, 84
s_waitcnt vmcnt(6)
s_cbranch_scc1 L_d_87
s_waitcnt vmcnt(4)
L_d_87:
buffer_load_dwordx4 v[52:55], v1, s[44:47], s64 offen nt
v_dot2_f32_bf16 v152, v152, v4, 0
v_dot2_f32_bf16 v156, v156, v4, 0
v_dot2_f32_bf16 v160, v160, v4, 0
v_dot2_f32_bf16 v164, v164, v4, 0
v_dot2c_f32_bf16 v152, v153, v5
v_dot2c_f32_bf16 v156, v157, v5
v_dot2c_f32_bf16 v160, v161, v5
v_dot2c_f32_bf16 v164, v165, v5
v_dot2c_f32_bf16 v152, v154, v6
v_dot2c_f32_bf16 v156, v158, v6
v_dot2c_f32_bf16 v160, v162, v6
v_dot2c_f32_bf16 v164, v166, v6
v_dot2c_f32_bf16 v152, v155, v7
v_dot2c_f32_bf16 v156, v159, v7
v_dot2c_f32_bf16 v160, v163, v7
v_dot2c_f32_bf16 v164, v167, v7
v_add_f32_dpp v153, v152, v152 row_ror:8 row_mask:0xf bank_mask:0x3
v_add_f32_dpp v157, v156, v156 row_ror:8 row_mask:0xf bank_mask:0x3
v_add_f32_dpp v153, v160, v160 row_ror:8 row_mask:0xf bank_mask:0xc
v_add_f32_dpp v157, v164, v164 row_ror:8 row_mask:0xf bank_mask:0xc
s_nop 0
v_add_f32_dpp v16, v153, v153 row_shl:4 row_mask:0xf bank_mask:0x5
v_add_f32_dpp v16, v157, v157 row_shr:4 row_mask:0xf bank_mask:0xa
s_nop 1
v_add_f32_dpp v16, v16, v16 quad_perm:[1,0,3,2] row_mask:0xf bank_mask:0xf
s_nop 1
v_add_f32_dpp v16, v16, v16 quad_perm:[2,3,0,1] row_mask:0xf bank_mask:0xf
v_cvt_pk_bf16_f32 v16, 0, v16
v_mul_f32 v16, s66, v16
v_cvt_pk_bf16_f32 v16, 0, v16
s_xor_b32 s64, s65, 164864
s_cmpk_gt_u32 s69, 85
s_waitcnt vmcnt(6)
s_cbranch_scc1 L_d_88
s_waitcnt vmcnt(4)
L_d_88:
buffer_load_dwordx4 v[56:59], v1, s[44:47], s64 offen nt
v_dot2_f32_bf16 v168, v168, v4, 0
v_dot2_f32_bf16 v172, v172, v4, 0
v_dot2_f32_bf16 v176, v176, v4, 0
v_dot2_f32_bf16 v180, v180, v4, 0
v_dot2c_f32_bf16 v168, v169, v5
v_dot2c_f32_bf16 v172, v173, v5
v_dot2c_f32_bf16 v176, v177, v5
v_dot2c_f32_bf16 v180, v181, v5
v_dot2c_f32_bf16 v168, v170, v6
v_dot2c_f32_bf16 v172, v174, v6
v_dot2c_f32_bf16 v176, v178, v6
v_dot2c_f32_bf16 v180, v182, v6
v_dot2c_f32_bf16 v168, v171, v7
v_dot2c_f32_bf16 v172, v175, v7
v_dot2c_f32_bf16 v176, v179, v7
v_dot2c_f32_bf16 v180, v183, v7
v_add_f32_dpp v169, v168, v168 row_ror:8 row_mask:0xf bank_mask:0x3
v_add_f32_dpp v173, v172, v172 row_ror:8 row_mask:0xf bank_mask:0x3
v_add_f32_dpp v169, v176, v176 row_ror:8 row_mask:0xf bank_mask:0xc
v_add_f32_dpp v173, v180, v180 row_ror:8 row_mask:0xf bank_mask:0xc
s_nop 0
v_add_f32_dpp v18, v169, v169 row_shl:4 row_mask:0xf bank_mask:0x5
v_add_f32_dpp v18, v173, v173 row_shr:4 row_mask:0xf bank_mask:0xa
s_nop 1
v_add_f32_dpp v18, v18, v18 quad_perm:[1,0,3,2] row_mask:0xf bank_mask:0xf
s_nop 1
v_add_f32_dpp v18, v18, v18 quad_perm:[2,3,0,1] row_mask:0xf bank_mask:0xf
v_cvt_pk_bf16_f32 v18, 0, v18
v_mul_f32 v18, s66, v18
v_cvt_pk_bf16_f32 v18, 0, v18
s_xor_b32 s64, s65, 136192
s_cmpk_gt_u32 s69, 86
s_waitcnt vmcnt(6)
s_cbranch_scc1 L_d_89
s_waitcnt vmcnt(4)
L_d_89:
buffer_load_dwordx4 v[60:63], v1, s[44:47], s64 offen nt
v_dot2_f32_bf16 v184, v184, v4, 0
v_dot2_f32_bf16 v188, v188, v4, 0
v_dot2_f32_bf16 v192, v192, v4, 0
v_dot2_f32_bf16 v196, v196, v4, 0
v_dot2c_f32_bf16 v184, v185, v5
v_dot2c_f32_bf16 v188, v189, v5
v_dot2c_f32_bf16 v192, v193, v5
v_dot2c_f32_bf16 v196, v197, v5
v_dot2c_f32_bf16 v184, v186, v6
v_dot2c_f32_bf16 v188, v190, v6
v_dot2c_f32_bf16 v192, v194, v6
v_dot2c_f32_bf16 v196, v198, v6
v_dot2c_f32_bf16 v184, v187, v7
v_dot2c_f32_bf16 v188, v191, v7
v_dot2c_f32_bf16 v192, v195, v7
v_dot2c_f32_bf16 v196, v199, v7
v_add_f32_dpp v185, v184, v184 row_ror:8 row_mask:0xf bank_mask:0x3
v_add_f32_dpp v189, v188, v188 row_ror:8 row_mask:0xf bank_mask:0x3
v_add_f32_dpp v185, v192, v192 row_ror:8 row_mask:0xf bank_mask:0xc
v_add_f32_dpp v189, v196, v196 row_ror:8 row_mask:0xf bank_mask:0xc
s_nop 0
v_add_f32_dpp v19, v185, v185 row_shl:4 row_mask:0xf bank_mask:0x5
v_add_f32_dpp v19, v189, v189 row_shr:4 row_mask:0xf bank_mask:0xa
s_nop 1
v_add_f32_dpp v19, v19, v19 quad_perm:[1,0,3,2] row_mask:0xf bank_mask:0xf
s_nop 1
v_add_f32_dpp v19, v19, v19 quad_perm:[2,3,0,1] row_mask:0xf bank_mask:0xf
v_cvt_pk_bf16_f32 v19, 0, v19
v_mul_f32 v19, s66, v19
v_cvt_pk_bf16_f32 v19, 0, v19
s_xor_b32 s64, s65, 168960
s_cmpk_gt_u32 s69, 87
s_waitcnt vmcnt(6)
s_cbranch_scc1 L_d_90
s_waitcnt vmcnt(4)
L_d_90:
buffer_load_dwordx4 v[64:67], v1, s[44:47], s64 offen nt
v_dot2_f32_bf16 v200, v200, v4, 0
v_dot2_f32_bf16 v204, v204, v4, 0
v_dot2_f32_bf16 v208, v208, v4, 0
v_dot2_f32_bf16 v212, v212, v4, 0
v_dot2c_f32_bf16 v200, v201, v5
v_dot2c_f32_bf16 v204, v205, v5
v_dot2c_f32_bf16 v208, v209, v5
v_dot2c_f32_bf16 v212, v213, v5
v_dot2c_f32_bf16 v200, v202, v6
v_dot2c_f32_bf16 v204, v206, v6
v_dot2c_f32_bf16 v208, v210, v6
v_dot2c_f32_bf16 v212, v214, v6
v_dot2c_f32_bf16 v200, v203, v7
v_dot2c_f32_bf16 v204, v207, v7
v_dot2c_f32_bf16 v208, v211, v7
v_dot2c_f32_bf16 v212, v215, v7
v_add_f32_dpp v201, v200, v200 row_ror:8 row_mask:0xf bank_mask:0x3
v_add_f32_dpp v205, v204, v204 row_ror:8 row_mask:0xf bank_mask:0x3
v_add_f32_dpp v201, v208, v208 row_ror:8 row_mask:0xf bank_mask:0xc
v_add_f32_dpp v205, v212, v212 row_ror:8 row_mask:0xf bank_mask:0xc
s_nop 0
v_add_f32_dpp v20, v201, v201 row_shl:4 row_mask:0xf bank_mask:0x5
v_add_f32_dpp v20, v205, v205 row_shr:4 row_mask:0xf bank_mask:0xa
s_nop 1
v_add_f32_dpp v20, v20, v20 quad_perm:[1,0,3,2] row_mask:0xf bank_mask:0xf
s_nop 1
v_add_f32_dpp v20, v20, v20 quad_perm:[2,3,0,1] row_mask:0xf bank_mask:0xf
v_cvt_pk_bf16_f32 v20, 0, v20
v_mul_f32 v20, s66, v20
v_cvt_pk_bf16_f32 v20, 0, v20
s_xor_b32 s64, s65, 196608
s_cmpk_gt_u32 s69, 88
s_waitcnt vmcnt(6)
s_cbranch_scc1 L_d_91
s_waitcnt vmcnt(4)
L_d_91:
buffer_load_dwordx4 v[68:71], v1, s[44:47], s64 offen nt
v_dot2_f32_bf16 v216, v216, v4, 0
v_dot2_f32_bf16 v220, v220, v4, 0
v_dot2_f32_bf16 v224, v224, v4, 0
v_dot2_f32_bf16 v228, v228, v4, 0
v_dot2c_f32_bf16 v216, v217, v5
v_dot2c_f32_bf16 v220, v221, v5
v_dot2c_f32_bf16 v224, v225, v5
v_dot2c_f32_bf16 v228, v229, v5
v_dot2c_f32_bf16 v216, v218, v6
v_dot2c_f32_bf16 v220, v222, v6
v_dot2c_f32_bf16 v224, v226, v6
v_dot2c_f32_bf16 v228, v230, v6
v_dot2c_f32_bf16 v216, v219, v7
v_dot2c_f32_bf16 v220, v223, v7
v_dot2c_f32_bf16 v224, v227, v7
v_dot2c_f32_bf16 v228, v231, v7
v_add_f32_dpp v217, v216, v216 row_ror:8 row_mask:0xf bank_mask:0x3
v_add_f32_dpp v221, v220, v220 row_ror:8 row_mask:0xf bank_mask:0x3
v_add_f32_dpp v217, v224, v224 row_ror:8 row_mask:0xf bank_mask:0xc
v_add_f32_dpp v221, v228, v228 row_ror:8 row_mask:0xf bank_mask:0xc
s_nop 0
v_add_f32_dpp v21, v217, v217 row_shl:4 row_mask:0xf bank_mask:0x5
v_add_f32_dpp v21, v221, v221 row_shr:4 row_mask:0xf bank_mask:0xa
s_nop 1
v_add_f32_dpp v21, v21, v21 quad_perm:[1,0,3,2] row_mask:0xf bank_mask:0xf
s_nop 1
v_add_f32_dpp v21, v21, v21 quad_perm:[2,3,0,1] row_mask:0xf bank_mask:0xf
v_cvt_pk_bf16_f32 v21, 0, v21
v_mul_f32 v21, s66, v21
v_cvt_pk_bf16_f32 v21, 0, v21
s_xor_b32 s64, s65, 229376
s_cmpk_gt_u32 s69, 89
s_waitcnt vmcnt(6)
s_cbranch_scc1 L_d_92
s_waitcnt vmcnt(4)
L_d_92:
buffer_load_dwordx4 v[72:75], v1, s[44:47], s64 offen nt
v_dot2_f32_bf16 v232, v232, v4, 0
v_dot2_f32_bf16 v236, v236, v4, 0
v_dot2_f32_bf16 v240, v240, v4, 0
v_dot2_f32_bf16 v244, v244, v4, 0
v_dot2c_f32_bf16 v232, v233, v5
v_dot2c_f32_bf16 v236, v237, v5
v_dot2c_f32_bf16 v240, v241, v5
v_dot2c_f32_bf16 v244, v245, v5
v_dot2c_f32_bf16 v232, v234, v6
v_dot2c_f32_bf16 v236, v238, v6
v_dot2c_f32_bf16 v240, v242, v6
v_dot2c_f32_bf16 v244, v246, v6
v_dot2c_f32_bf16 v232, v235, v7
v_dot2c_f32_bf16 v236, v239, v7
v_dot2c_f32_bf16 v240, v243, v7
v_dot2c_f32_bf16 v244, v247, v7
v_add_f32_dpp v233, v232, v232 row_ror:8 row_mask:0xf bank_mask:0x3
v_add_f32_dpp v237, v236, v236 row_ror:8 row_mask:0xf bank_mask:0x3
v_add_f32_dpp v233, v240, v240 row_ror:8 row_mask:0xf bank_mask:0xc
v_add_f32_dpp v237, v244, v244 row_ror:8 row_mask:0xf bank_mask:0xc
s_nop 0
v_add_f32_dpp v22, v233, v233 row_shl:4 row_mask:0xf bank_mask:0x5
v_add_f32_dpp v22, v237, v237 row_shr:4 row_mask:0xf bank_mask:0xa
s_nop 1
v_add_f32_dpp v22, v22, v22 quad_perm:[1,0,3,2] row_mask:0xf bank_mask:0xf
s_nop 1
v_add_f32_dpp v22, v22, v22 quad_perm:[2,3,0,1] row_mask:0xf bank_mask:0xf
v_cvt_pk_bf16_f32 v22, 0, v22
v_mul_f32 v22, s66, v22
v_cvt_pk_bf16_f32 v22, 0, v22
s_xor_b32 s64, s65, 200704
s_cmpk_gt_u32 s69, 90
s_waitcnt vmcnt(6)
s_cbranch_scc1 L_d_93
s_waitcnt vmcnt(5)
L_d_93:
buffer_load_dwordx4 v[76:79], v1, s[44:47], s64 offen nt
v_lshl_add_u32 v80, v0, 4, s70
ds_read_b128 v[84:87], v80 offset:0
ds_read_b128 v[88:91], v80 offset:1024
s_waitcnt lgkmcnt(0)
v_dot2_f32_bf16 v248, v248, v4, 0
v_dot2_f32_bf16 v252, v252, v4, 0
v_dot2_f32_bf16 v84, v84, v4, 0
v_dot2_f32_bf16 v88, v88, v4, 0
v_dot2c_f32_bf16 v248, v249, v5
v_dot2c_f32_bf16 v252, v253, v5
v_dot2c_f32_bf16 v84, v85, v5
v_dot2c_f32_bf16 v88, v89, v5
v_dot2c_f32_bf16 v248, v250, v6
v_dot2c_f32_bf16 v252, v254, v6
v_dot2c_f32_bf16 v84, v86, v6
v_dot2c_f32_bf16 v88, v90, v6
v_dot2c_f32_bf16 v248, v251, v7
v_dot2c_f32_bf16 v252, v255, v7
v_dot2c_f32_bf16 v84, v87, v7
v_dot2c_f32_bf16 v88, v91, v7
v_add_f32_dpp v249, v248, v248 row_ror:8 row_mask:0xf bank_mask:0x3
v_add_f32_dpp v253, v252, v252 row_ror:8 row_mask:0xf bank_mask:0x3
v_add_f32_dpp v249, v84, v84 row_ror:8 row_mask:0xf bank_mask:0xc
v_add_f32_dpp v253, v88, v88 row_ror:8 row_mask:0xf bank_mask:0xc
s_nop 0
v_add_f32_dpp v23, v249, v249 row_shl:4 row_mask:0xf bank_mask:0x5
v_add_f32_dpp v23, v253, v253 row_shr:4 row_mask:0xf bank_mask:0xa
s_nop 1
v_add_f32_dpp v23, v23, v23 quad_perm:[1,0,3,2] row_mask:0xf bank_mask:0xf
s_nop 1
v_add_f32_dpp v23, v23, v23 quad_perm:[2,3,0,1] row_mask:0xf bank_mask:0xf
v_cvt_pk_bf16_f32 v23, 0, v23
v_mul_f32 v23, s66, v23
v_cvt_pk_bf16_f32 v23, 0, v23
s_xor_b32 s64, s65, 233472
s_cmpk_gt_u32 s69, 91
s_waitcnt vmcnt(6)
s_cbranch_scc1 L_d_94
s_waitcnt vmcnt(5)
L_d_94:
buffer_load_dwordx4 v[92:95], v1, s[44:47], s64 offen nt
v_max3_f32 v2, v17, v8, v9
v_max3_f32 v2, v2, v10, v11
v_max3_f32 v2, v2, v12, v13
v_max3_f32 v2, v2, v14, v15
v_max3_f32 v2, v2, v16, v18
v_max3_f32 v2, v2, v19, v20
v_max3_f32 v2, v2, v21, v22
v_max_f32 v2, v2, v23
v_max_f32 v2, 0xff7fffff, v2
s_nop 1
v_max_f32_dpp v2, v2, v2 row_ror:4 row_mask:0xf bank_mask:0xf
s_nop 1
v_max_f32_dpp v2, v2, v2 row_ror:8 row_mask:0xf bank_mask:0xf
v_mov_b32 v3, v2
s_nop 1
v_permlane16_swap_b32 v2, v3
s_nop 1
v_max_f32 v2, v2, v3
v_mov_b32 v3, v2
s_nop 1
v_permlane32_swap_b32 v2, v3
s_nop 1
v_max_f32 v2, v2, v3
s_mov_b32 s67, 0x3fb8aa3b
v_sub_f32 v17, v17, v2
v_sub_f32 v8, v8, v2
v_sub_f32 v9, v9, v2
v_sub_f32 v10, v10, v2
v_sub_f32 v11, v11, v2
v_sub_f32 v12, v12, v2
v_sub_f32 v13, v13, v2
v_sub_f32 v14, v14, v2
v_sub_f32 v15, v15, v2
v_sub_f32 v16, v16, v2
v_sub_f32 v18, v18, v2
v_sub_f32 v19, v19, v2
v_sub_f32 v20, v20, v2
v_sub_f32 v21, v21, v2
v_sub_f32 v22, v22, v2
v_sub_f32 v23, v23, v2
v_mul_f32 v17, s67, v17
v_mul_f32 v8, s67, v8
v_mul_f32 v9, s67, v9
v_mul_f32 v10, s67, v10
v_mul_f32 v11, s67, v11
v_mul_f32 v12, s67, v12
v_mul_f32 v13, s67, v13
v_mul_f32 v14, s67, v14
v_mul_f32 v15, s67, v15
v_mul_f32 v16, s67, v16
v_mul_f32 v18, s67, v18
v_mul_f32 v19, s67, v19
v_mul_f32 v20, s67, v20
v_mul_f32 v21, s67, v21
v_mul_f32 v22, s67, v22
v_mul_f32 v23, s67, v23
s_xor_b32 s64, s65, 197632
s_cmpk_gt_u32 s69, 92
s_waitcnt vmcnt(6)
s_cbranch_scc1 L_d_95
s_waitcnt vmcnt(5)
L_d_95:
buffer_load_dwordx4 v[116:119], v1, s[44:47], s64 offen nt
v_exp_f32 v17, v17
v_exp_f32 v8, v8
v_exp_f32 v9, v9
v_exp_f32 v10, v10
v_exp_f32 v11, v11
v_exp_f32 v12, v12
v_exp_f32 v13, v13
v_exp_f32 v14, v14
v_exp_f32 v15, v15
v_exp_f32 v16, v16
v_exp_f32 v18, v18
v_exp_f32 v19, v19
v_exp_f32 v20, v20
v_exp_f32 v21, v21
v_exp_f32 v22, v22
v_exp_f32 v23, v23
v_add_f32 v3, v17, v8
v_add_f32 v3, v3, v9
v_add_f32 v3, v3, v10
v_add_f32 v3, v3, v11
v_add_f32 v3, v3, v12
v_add_f32 v3, v3, v13
v_add_f32 v3, v3, v14
v_add_f32 v3, v3, v15
v_add_f32 v3, v3, v16
v_add_f32 v3, v3, v18
v_add_f32 v3, v3, v19
v_add_f32 v3, v3, v20
v_add_f32 v3, v3, v21
v_add_f32 v3, v3, v22
v_add_f32 v3, v3, v23
s_nop 1
v_add_f32_dpp v3, v3, v3 row_ror:4 row_mask:0xf bank_mask:0xf
s_nop 1
v_add_f32_dpp v3, v3, v3 row_ror:8 row_mask:0xf bank_mask:0xf
v_mov_b32 v96, v3
s_nop 1
v_permlane16_swap_b32 v3, v96
s_nop 1
v_add_f32 v3, v3, v96
v_mov_b32 v96, v3
s_nop 1
v_permlane32_swap_b32 v3, v96
s_nop 1
v_add_f32 v3, v3, v96
v_min_u32 v3, -2, v3
s_lshl_b32 s68, s34, 3
v_mov_b32 v96, s68
ds_write_b64 v96, v[2:3] offset:256
v_and_b32 v97, 15, v0
v_lshrrev_b32 v98, 1, v97
v_and_b32 v97, 1, v0
v_lshlrev_b32 v97, 4, v97
v_mov_b32 v99, 0xffff
v_lshlrev_b32 v97, v97, v99
v_cmp_eq_u32 vcc, 0, v98
s_nop 1
v_cndmask_b32 v4, 0, v97, vcc
v_cmp_eq_u32 vcc, 1, v98
s_nop 1
v_cndmask_b32 v5, 0, v97, vcc
v_cmp_eq_u32 vcc, 2, v98
s_nop 1
v_cndmask_b32 v6, 0, v97, vcc
v_cmp_eq_u32 vcc, 3, v98
s_nop 1
v_cndmask_b32 v7, 0, v97, vcc
s_xor_b32 s64, s65, 230400
s_cmpk_gt_u32 s69, 93
s_waitcnt vmcnt(6)
s_cbranch_scc1 L_d_96
s_waitcnt vmcnt(5)
L_d_96:
buffer_load_dwordx4 v[120:123], v1, s[44:47], s64 offen nt
v_mov_b32 v96, 0
s_mov_b32 s75, 0
L_poll_97:
ds_read_b128 v[100:103], v96 offset:256
ds_read_b128 v[104:107], v96 offset:272
s_waitcnt lgkmcnt(0)
v_max3_u32 v97, v101, v103, v105
v_max_u32 v97, v97, v107
v_cmp_eq_u32 vcc, -1, v97
s_cbranch_vccz L_pollx_98
s_add_u32 s75, s75, 1
s_cmp_lt_u32 s75, 0x1000000
s_cbranch_scc1 L_poll_97
L_pollx_98:
v_max3_f32 v97, v100, v102, v104
v_max_f32 v97, v97, v106
v_sub_f32 v100, v100, v97
v_sub_f32 v102, v102, v97
v_sub_f32 v104, v104, v97
v_sub_f32 v106, v106, v97
v_sub_f32 v2, v2, v97
v_mul_f32 v100, s67, v100
v_mul_f32 v102, s67, v102
v_mul_f32 v104, s67, v104
v_mul_f32 v106, s67, v106
v_mul_f32 v2, s67, v2
v_exp_f32 v100, v100
v_exp_f32 v102, v102
v_exp_f32 v104, v104
v_exp_f32 v106, v106
v_exp_f32 v2, v2
v_mul_f32 v3, v100, v101
v_fmac_f32 v3, v102, v103
v_fmac_f32 v3, v104, v105
v_fmac_f32 v3, v106, v107
v_rcp_f32 v3, v3
s_nop 0
v_mul_f32 v2, v2, v3
v_mul_f32 v17, v17, v2
v_mul_f32 v8, v8, v2
v_mul_f32 v9, v9, v2
v_mul_f32 v10, v10, v2
v_mul_f32 v11, v11, v2
v_mul_f32 v12, v12, v2
v_mul_f32 v13, v13, v2
v_mul_f32 v14, v14, v2
v_mul_f32 v15, v15, v2
v_mul_f32 v16, v16, v2
v_mul_f32 v18, v18, v2
v_mul_f32 v19, v19, v2
v_mul_f32 v20, v20, v2
v_mul_f32 v21, v21, v2
v_mul_f32 v22, v22, v2
v_mul_f32 v23, v23, v2
v_cvt_pk_bf16_f32 v17, v17, v17
v_cvt_pk_bf16_f32 v8, v8, v8
v_cvt_pk_bf16_f32 v9, v9, v9
v_cvt_pk_bf16_f32 v10, v10, v10
v_cvt_pk_bf16_f32 v11, v11, v11
v_cvt_pk_bf16_f32 v12, v12, v12
v_cvt_pk_bf16_f32 v13, v13, v13
v_cvt_pk_bf16_f32 v14, v14, v14
v_cvt_pk_bf16_f32 v15, v15, v15
v_cvt_pk_bf16_f32 v16, v16, v16
v_cvt_pk_bf16_f32 v18, v18, v18
v_cvt_pk_bf16_f32 v19, v19, v19
v_cvt_pk_bf16_f32 v20, v20, v20
v_cvt_pk_bf16_f32 v21, v21, v21
v_cvt_pk_bf16_f32 v22, v22, v22
v_cvt_pk_bf16_f32 v23, v23, v23
s_nop 1
s_and_b32 s62, s2, 7
s_lshl_b32 s62, s62, 9
s_add_u32 s62, s62, 1327104
s_lshr_b32 s63, s2, 3
s_lshl_b32 s63, s63, 2
s_add_u32 s63, s63, s62
s_cmp_eq_u32 s34, 0
s_cbranch_scc0 L_w_100
v_mov_b32 v124, 30
s_mov_b64 exec, 1
buffer_store_dword v124, off, s[36:39], s63 offset:0
s_mov_b64 exec, -1
L_w_100:
s_xor_b32 s64, s65, 201728
s_cmpk_gt_u32 s69, 94
s_waitcnt vmcnt(6)
s_cbranch_scc1 L_d_99
s_waitcnt vmcnt(5)
L_d_99:
buffer_load_dwordx4 v[128:131], v1, s[44:47], s64 offen nt
ds_read_b128 v[132:135], v80 offset:2048
ds_read_b128 v[136:139], v80 offset:3072
ds_read_b128 v[140:143], v80 offset:4096
ds_read_b128 v[144:147], v80 offset:5120
ds_read_b128 v[148:151], v80 offset:6144
ds_read_b128 v[152:155], v80 offset:7168
ds_read_b128 v[156:159], v80 offset:8192
ds_read_b128 v[160:163], v80 offset:9216
s_waitcnt lgkmcnt(0)
v_and_b32_dpp v100, v17, v4 row_newbcast:0 row_mask:0xf bank_mask:0xf
v_and_b32_dpp v101, v17, v5 row_newbcast:0 row_mask:0xf bank_mask:0xf
v_and_b32_dpp v102, v17, v6 row_newbcast:0 row_mask:0xf bank_mask:0xf
v_and_b32_dpp v103, v17, v7 row_newbcast:0 row_mask:0xf bank_mask:0xf
v_and_b32_dpp v104, v17, v4 row_newbcast:4 row_mask:0xf bank_mask:0xf
v_and_b32_dpp v105, v17, v5 row_newbcast:4 row_mask:0xf bank_mask:0xf
v_and_b32_dpp v106, v17, v6 row_newbcast:4 row_mask:0xf bank_mask:0xf
v_and_b32_dpp v107, v17, v7 row_newbcast:4 row_mask:0xf bank_mask:0xf
v_mfma_f32_16x16x32_bf16 v[108:111], v[100:103], v[132:135], 0
v_and_b32_dpp v100, v17, v4 row_newbcast:8 row_mask:0xf bank_mask:0xf
v_and_b32_dpp v101, v17, v5 row_newbcast:8 row_mask:0xf bank_mask:0xf
v_and_b32_dpp v102, v17, v6 row_newbcast:8 row_mask:0xf bank_mask:0xf
v_and_b32_dpp v103, v17, v7 row_newbcast:8 row_mask:0xf bank_mask:0xf
v_mfma_f32_16x16x32_bf16 v[108:111], v[104:107], v[136:139], v[108:111]
v_and_b32_dpp v104, v17, v4 row_newbcast:12 row_mask:0xf bank_mask:0xf
v_and_b32_dpp v105, v17, v5 row_newbcast:12 row_mask:0xf bank_mask:0xf
v_and_b32_dpp v106, v17, v6 row_newbcast:12 row_mask:0xf bank_mask:0xf
v_and_b32_dpp v107, v17, v7 row_newbcast:12 row_mask:0xf bank_mask:0xf
v_mfma_f32_16x16x32_bf16 v[108:111], v[100:103], v[140:143], v[108:111]
v_and_b32_dpp v100, v8, v4 row_newbcast:0 row_mask:0xf bank_mask:0xf
v_and_b32_dpp v101, v8, v5 row_newbcast:0 row_mask:0xf bank_mask:0xf
v_and_b32_dpp v102, v8, v6 row_newbcast:0 row_mask:0xf bank_mask:0xf
v_and_b32_dpp v103, v8, v7 row_newbcast:0 row_mask:0xf bank_mask:0xf
v_mfma_f32_16x16x32_bf16 v[108:111], v[104:107], v[144:147], v[108:111]
v_and_b32_dpp v104, v8, v4 row_newbcast:4 row_mask:0xf bank_mask:0xf
v_and_b32_dpp v105, v8, v5 row_newbcast:4 row_mask:0xf bank_mask:0xf
v_and_b32_dpp v106, v8, v6 row_newbcast:4 row_mask:0xf bank_mask:0xf
v_and_b32_dpp v107, v8, v7 row_newbcast:4 row_mask:0xf bank_mask:0xf
v_mfma_f32_16x16x32_bf16 v[108:111], v[100:103], v[148:151], v[108:111]
s_xor_b32 s64, s65, 234496
s_cmpk_gt_u32 s69, 95
s_waitcnt vmcnt(6)
s_cbranch_scc1 L_d_101
s_waitcnt vmcnt(5)
L_d_101:
buffer_load_dwordx4 v[164:167], v1, s[44:47], s64 offen nt
v_and_b32_dpp v100, v8, v4 row_newbcast:8 row_mask:0xf bank_mask:0xf
v_and_b32_dpp v101, v8, v5 row_newbcast:8 row_mask:0xf bank_mask:0xf
v_and_b32_dpp v102, v8, v6 row_newbcast:8 row_mask:0xf bank_mask:0xf
v_and_b32_dpp v103, v8, v7 row_newbcast:8 row_mask:0xf bank_mask:0xf
v_mfma_f32_16x16x32_bf16 v[108:111], v[104:107], v[152:155], v[108:111]
v_and_b32_dpp v104, v8, v4 row_newbcast:12 row_mask:0xf bank_mask:0xf
v_and_b32_dpp v105, v8, v5 row_newbcast:12 row_mask:0xf bank_mask:0xf
v_and_b32_dpp v106, v8, v6 row_newbcast:12 row_mask:0xf bank_mask:0xf
v_and_b32_dpp v107, v8, v7 row_newbcast:12 row_mask:0xf bank_mask:0xf
v_mfma_f32_16x16x32_bf16 v[108:111], v[100:103], v[156:159], v[108:111]
v_and_b32_dpp v100, v9, v4 row_newbcast:0 row_mask:0xf bank_mask:0xf
v_and_b32_dpp v101, v9, v5 row_newbcast:0 row_mask:0xf bank_mask:0xf
v_and_b32_dpp v102, v9, v6 row_newbcast:0 row_mask:0xf bank_mask:0xf
v_and_b32_dpp v103, v9, v7 row_newbcast:0 row_mask:0xf bank_mask:0xf
v_mfma_f32_16x16x32_bf16 v[108:111], v[104:107], v[160:163], v[108:111]
ds_read_b128 v[168:171], v80 offset:10240
ds_read_b128 v[172:175], v80 offset:11264
ds_read_b128 v[176:179], v80 offset:12288
ds_read_b128 v[180:183], v80 offset:13312
ds_read_b128 v[184:187], v80 offset:14336
s_waitcnt lgkmcnt(0)
v_and_b32_dpp v104, v9, v4 row_newbcast:4 row_mask:0xf bank_mask:0xf
v_and_b32_dpp v105, v9, v5 row_newbcast:4 row_mask:0xf bank_mask:0xf
v_and_b32_dpp v106, v9, v6 row_newbcast:4 row_mask:0xf bank_mask:0xf
v_and_b32_dpp v107, v9, v7 row_newbcast:4 row_mask:0xf bank_mask:0xf
v_mfma_f32_16x16x32_bf16 v[108:111], v[100:103], v[168:171], v[108:111]
v_and_b32_dpp v100, v9, v4 row_newbcast:8 row_mask:0xf bank_mask:0xf
v_and_b32_dpp v101, v9, v5 row_newbcast:8 row_mask:0xf bank_mask:0xf
v_and_b32_dpp v102, v9, v6 row_newbcast:8 row_mask:0xf bank_mask:0xf
v_and_b32_dpp v103, v9, v7 row_newbcast:8 row_mask:0xf bank_mask:0xf
v_mfma_f32_16x16x32_bf16 v[108:111], v[104:107], v[172:175], v[108:111]
s_xor_b32 s64, s65, 2048
s_cmpk_gt_u32 s69, 96
s_waitcnt vmcnt(6)
s_cbranch_scc1 L_d_102
s_waitcnt vmcnt(5)
L_d_102:
buffer_load_dwordx4 v[188:191], v1, s[44:47], s64 offen nt
v_and_b32_dpp v104, v9, v4 row_newbcast:12 row_mask:0xf bank_mask:0xf
v_and_b32_dpp v105, v9, v5 row_newbcast:12 row_mask:0xf bank_mask:0xf
v_and_b32_dpp v106, v9, v6 row_newbcast:12 row_mask:0xf bank_mask:0xf
v_and_b32_dpp v107, v9, v7 row_newbcast:12 row_mask:0xf bank_mask:0xf
v_mfma_f32_16x16x32_bf16 v[108:111], v[100:103], v[176:179], v[108:111]
v_and_b32_dpp v100, v10, v4 row_newbcast:0 row_mask:0xf bank_mask:0xf
v_and_b32_dpp v101, v10, v5 row_newbcast:0 row_mask:0xf bank_mask:0xf
v_and_b32_dpp v102, v10, v6 row_newbcast:0 row_mask:0xf bank_mask:0xf
v_and_b32_dpp v103, v10, v7 row_newbcast:0 row_mask:0xf bank_mask:0xf
v_mfma_f32_16x16x32_bf16 v[108:111], v[104:107], v[180:183], v[108:111]
v_and_b32_dpp v104, v10, v4 row_newbcast:4 row_mask:0xf bank_mask:0xf
v_and_b32_dpp v105, v10, v5 row_newbcast:4 row_mask:0xf bank_mask:0xf
v_and_b32_dpp v106, v10, v6 row_newbcast:4 row_mask:0xf bank_mask:0xf
v_and_b32_dpp v107, v10, v7 row_newbcast:4 row_mask:0xf bank_mask:0xf
v_mfma_f32_16x16x32_bf16 v[108:111], v[100:103], v[184:187], v[108:111]
v_and_b32_dpp v100, v10, v4 row_newbcast:8 row_mask:0xf bank_mask:0xf
v_and_b32_dpp v101, v10, v5 row_newbcast:8 row_mask:0xf bank_mask:0xf
v_and_b32_dpp v102, v10, v6 row_newbcast:8 row_mask:0xf bank_mask:0xf
v_and_b32_dpp v103, v10, v7 row_newbcast:8 row_mask:0xf bank_mask:0xf
v_mfma_f32_16x16x32_bf16 v[108:111], v[104:107], v[24:27], v[108:111]
v_and_b32_dpp v104, v10, v4 row_newbcast:12 row_mask:0xf bank_mask:0xf
v_and_b32_dpp v105, v10, v5 row_newbcast:12 row_mask:0xf bank_mask:0xf
v_and_b32_dpp v106, v10, v6 row_newbcast:12 row_mask:0xf bank_mask:0xf
v_and_b32_dpp v107, v10, v7 row_newbcast:12 row_mask:0xf bank_mask:0xf
v_mfma_f32_16x16x32_bf16 v[108:111], v[100:103], v[28:31], v[108:111]
s_xor_b32 s64, s65, 34816
s_cmpk_gt_u32 s69, 97
s_waitcnt vmcnt(6)
s_cbranch_scc1 L_d_103
s_waitcnt vmcnt(5)
L_d_103:
buffer_load_dwordx4 v[192:195], v1, s[44:47], s64 offen nt
v_and_b32_dpp v100, v11, v4 row_newbcast:0 row_mask:0xf bank_mask:0xf
v_and_b32_dpp v101, v11, v5 row_newbcast:0 row_mask:0xf bank_mask:0xf
v_and_b32_dpp v102, v11, v6 row_newbcast:0 row_mask:0xf bank_mask:0xf
v_and_b32_dpp v103, v11, v7 row_newbcast:0 row_mask:0xf bank_mask:0xf
v_mfma_f32_16x16x32_bf16 v[108:111], v[104:107], v[32:35], v[108:111]
v_and_b32_dpp v104, v11, v4 row_newbcast:4 row_mask:0xf bank_mask:0xf
v_and_b32_dpp v105, v11, v5 row_newbcast:4 row_mask:0xf bank_mask:0xf
v_and_b32_dpp v106, v11, v6 row_newbcast:4 row_mask:0xf bank_mask:0xf
v_and_b32_dpp v107, v11, v7 row_newbcast:4 row_mask:0xf bank_mask:0xf
v_mfma_f32_16x16x32_bf16 v[108:111], v[100:103], v[36:39], v[108:111]
v_and_b32_dpp v100, v11, v4 row_newbcast:8 row_mask:0xf bank_mask:0xf
v_and_b32_dpp v101, v11, v5 row_newbcast:8 row_mask:0xf bank_mask:0xf
v_and_b32_dpp v102, v11, v6 row_newbcast:8 row_mask:0xf bank_mask:0xf
v_and_b32_dpp v103, v11, v7 row_newbcast:8 row_mask:0xf bank_mask:0xf
v_mfma_f32_16x16x32_bf16 v[108:111], v[104:107], v[40:43], v[108:111]
v_and_b32_dpp v104, v11, v4 row_newbcast:12 row_mask:0xf bank_mask:0xf
v_and_b32_dpp v105, v11, v5 row_newbcast:12 row_mask:0xf bank_mask:0xf
v_and_b32_dpp v106, v11, v6 row_newbcast:12 row_mask:0xf bank_mask:0xf
v_and_b32_dpp v107, v11, v7 row_newbcast:12 row_mask:0xf bank_mask:0xf
v_mfma_f32_16x16x32_bf16 v[108:111], v[100:103], v[44:47], v[108:111]
v_and_b32_dpp v100, v12, v4 row_newbcast:0 row_mask:0xf bank_mask:0xf
v_and_b32_dpp v101, v12, v5 row_newbcast:0 row_mask:0xf bank_mask:0xf
v_and_b32_dpp v102, v12, v6 row_newbcast:0 row_mask:0xf bank_mask:0xf
v_and_b32_dpp v103, v12, v7 row_newbcast:0 row_mask:0xf bank_mask:0xf
v_mfma_f32_16x16x32_bf16 v[108:111], v[104:107], v[48:51], v[108:111]
s_xor_b32 s64, s65, 6144
s_cmpk_gt_u32 s69, 98
s_waitcnt vmcnt(6)
s_cbranch_scc1 L_d_104
s_waitcnt vmcnt(5)
L_d_104:
buffer_load_dwordx4 v[196:199], v1, s[44:47], s64 offen nt
v_and_b32_dpp v104, v12, v4 row_newbcast:4 row_mask:0xf bank_mask:0xf
v_and_b32_dpp v105, v12, v5 row_newbcast:4 row_mask:0xf bank_mask:0xf
v_and_b32_dpp v106, v12, v6 row_newbcast:4 row_mask:0xf bank_mask:0xf
v_and_b32_dpp v107, v12, v7 row_newbcast:4 row_mask:0xf bank_mask:0xf
v_mfma_f32_16x16x32_bf16 v[108:111], v[100:103], v[52:55], v[108:111]
v_and_b32_dpp v100, v12, v4 row_newbcast:8 row_mask:0xf bank_mask:0xf
v_and_b32_dpp v101, v12, v5 row_newbcast:8 row_mask:0xf bank_mask:0xf
v_and_b32_dpp v102, v12, v6 row_newbcast:8 row_mask:0xf bank_mask:0xf
v_and_b32_dpp v103, v12, v7 row_newbcast:8 row_mask:0xf bank_mask:0xf
v_mfma_f32_16x16x32_bf16 v[108:111], v[104:107], v[56:59], v[108:111]
v_and_b32_dpp v104, v12, v4 row_newbcast:12 row_mask:0xf bank_mask:0xf
v_and_b32_dpp v105, v12, v5 row_newbcast:12 row_mask:0xf bank_mask:0xf
v_and_b32_dpp v106, v12, v6 row_newbcast:12 row_mask:0xf bank_mask:0xf
v_and_b32_dpp v107, v12, v7 row_newbcast:12 row_mask:0xf bank_mask:0xf
v_mfma_f32_16x16x32_bf16 v[108:111], v[100:103], v[60:63], v[108:111]
v_and_b32_dpp v100, v13, v4 row_newbcast:0 row_mask:0xf bank_mask:0xf
v_and_b32_dpp v101, v13, v5 row_newbcast:0 row_mask:0xf bank_mask:0xf
v_and_b32_dpp v102, v13, v6 row_newbcast:0 row_mask:0xf bank_mask:0xf
v_and_b32_dpp v103, v13, v7 row_newbcast:0 row_mask:0xf bank_mask:0xf
v_mfma_f32_16x16x32_bf16 v[108:111], v[104:107], v[64:67], v[108:111]
v_and_b32_dpp v104, v13, v4 row_newbcast:4 row_mask:0xf bank_mask:0xf
v_and_b32_dpp v105, v13, v5 row_newbcast:4 row_mask:0xf bank_mask:0xf
v_and_b32_dpp v106, v13, v6 row_newbcast:4 row_mask:0xf bank_mask:0xf
v_and_b32_dpp v107, v13, v7 row_newbcast:4 row_mask:0xf bank_mask:0xf
v_mfma_f32_16x16x32_bf16 v[108:111], v[100:103], v[68:71], v[108:111]
s_xor_b32 s64, s65, 38912
s_cmpk_gt_u32 s69, 99
s_waitcnt vmcnt(6)
s_cbranch_scc1 L_d_105
s_waitcnt vmcnt(5)
L_d_105:
buffer_load_dwordx4 v[200:203], v1, s[44:47], s64 offen nt
v_and_b32_dpp v100, v13, v4 row_newbcast:8 row_mask:0xf bank_mask:0xf
v_and_b32_dpp v101, v13, v5 row_newbcast:8 row_mask:0xf bank_mask:0xf
v_and_b32_dpp v102, v13, v6 row_newbcast:8 row_mask:0xf bank_mask:0xf
v_and_b32_dpp v103, v13, v7 row_newbcast:8 row_mask:0xf bank_mask:0xf
v_mfma_f32_16x16x32_bf16 v[108:111], v[104:107], v[72:75], v[108:111]
v_and_b32_dpp v104, v13, v4 row_newbcast:12 row_mask:0xf bank_mask:0xf
v_and_b32_dpp v105, v13, v5 row_newbcast:12 row_mask:0xf bank_mask:0xf
v_and_b32_dpp v106, v13, v6 row_newbcast:12 row_mask:0xf bank_mask:0xf
v_and_b32_dpp v107, v13, v7 row_newbcast:12 row_mask:0xf bank_mask:0xf
v_mfma_f32_16x16x32_bf16 v[108:111], v[100:103], v[76:79], v[108:111]
v_and_b32_dpp v100, v14, v4 row_newbcast:0 row_mask:0xf bank_mask:0xf
v_and_b32_dpp v101, v14, v5 row_newbcast:0 row_mask:0xf bank_mask:0xf
v_and_b32_dpp v102, v14, v6 row_newbcast:0 row_mask:0xf bank_mask:0xf
v_and_b32_dpp v103, v14, v7 row_newbcast:0 row_mask:0xf bank_mask:0xf
v_mfma_f32_16x16x32_bf16 v[108:111], v[104:107], v[92:95], v[108:111]
v_and_b32_dpp v104, v14, v4 row_newbcast:4 row_mask:0xf bank_mask:0xf
v_and_b32_dpp v105, v14, v5 row_newbcast:4 row_mask:0xf bank_mask:0xf
v_and_b32_dpp v106, v14, v6 row_newbcast:4 row_mask:0xf bank_mask:0xf
v_and_b32_dpp v107, v14, v7 row_newbcast:4 row_mask:0xf bank_mask:0xf
v_mfma_f32_16x16x32_bf16 v[108:111], v[100:103], v[116:119], v[108:111]
s_xor_b32 s64, s65, 3072
s_cmpk_gt_u32 s69, 100
s_waitcnt vmcnt(6)
s_cbranch_scc1 L_d_106
s_waitcnt vmcnt(5)
L_d_106:
buffer_load_dwordx4 v[204:207], v1, s[44:47], s64 offen nt
v_and_b32_dpp v100, v14, v4 row_newbcast:8 row_mask:0xf bank_mask:0xf
v_and_b32_dpp v101, v14, v5 row_newbcast:8 row_mask:0xf bank_mask:0xf
v_and_b32_dpp v102, v14, v6 row_newbcast:8 row_mask:0xf bank_mask:0xf
v_and_b32_dpp v103, v14, v7 row_newbcast:8 row_mask:0xf bank_mask:0xf
v_mfma_f32_16x16x32_bf16 v[108:111], v[104:107], v[120:123], v[108:111]
s_xor_b32 s64, s65, 35840
s_cmpk_gt_u32 s69, 101
s_waitcnt vmcnt(6)
s_cbranch_scc1 L_d_107
s_waitcnt vmcnt(5)
L_d_107:
buffer_load_dwordx4 v[208:211], v1, s[44:47], s64 offen nt
v_and_b32_dpp v104, v14, v4 row_newbcast:12 row_mask:0xf bank_mask:0xf
v_and_b32_dpp v105, v14, v5 row_newbcast:12 row_mask:0xf bank_mask:0xf
v_and_b32_dpp v106, v14, v6 row_newbcast:12 row_mask:0xf bank_mask:0xf
v_and_b32_dpp v107, v14, v7 row_newbcast:12 row_mask:0xf bank_mask:0xf
v_mfma_f32_16x16x32_bf16 v[108:111], v[100:103], v[128:131], v[108:111]
s_cmp_eq_u32 s34, 1
s_cbranch_scc0 L_w_109
v_mov_b32 v124, 38
s_mov_b64 exec, 1
buffer_store_dword v124, off, s[36:39], s63 offset:0
s_mov_b64 exec, -1
L_w_109:
s_xor_b32 s64, s65, 7168
s_cmpk_gt_u32 s69, 102
s_waitcnt vmcnt(6)
s_cbranch_scc1 L_d_108
s_waitcnt vmcnt(5)
L_d_108:
buffer_load_dwordx4 v[212:215], v1, s[44:47], s64 offen nt
v_and_b32_dpp v100, v15, v4 row_newbcast:0 row_mask:0xf bank_mask:0xf
v_and_b32_dpp v101, v15, v5 row_newbcast:0 row_mask:0xf bank_mask:0xf
v_and_b32_dpp v102, v15, v6 row_newbcast:0 row_mask:0xf bank_mask:0xf
v_and_b32_dpp v103, v15, v7 row_newbcast:0 row_mask:0xf bank_mask:0xf
v_mfma_f32_16x16x32_bf16 v[108:111], v[104:107], v[164:167], v[108:111]
s_xor_b32 s64, s65, 39936
s_cmpk_gt_u32 s69, 103
s_waitcnt vmcnt(6)
s_cbranch_scc1 L_d_110
s_waitcnt vmcnt(5)
L_d_110:
buffer_load_dwordx4 v[216:219], v1, s[44:47], s64 offen nt
v_and_b32_dpp v104, v15, v4 row_newbcast:4 row_mask:0xf bank_mask:0xf
v_and_b32_dpp v105, v15, v5 row_newbcast:4 row_mask:0xf bank_mask:0xf
v_and_b32_dpp v106, v15, v6 row_newbcast:4 row_mask:0xf bank_mask:0xf
v_and_b32_dpp v107, v15, v7 row_newbcast:4 row_mask:0xf bank_mask:0xf
v_mfma_f32_16x16x32_bf16 v[108:111], v[100:103], v[188:191], v[108:111]
s_xor_b32 s64, s65, 67584
s_cmpk_gt_u32 s69, 104
s_waitcnt vmcnt(6)
s_cbranch_scc1 L_d_111
s_waitcnt vmcnt(5)
L_d_111:
buffer_load_dwordx4 v[220:223], v1, s[44:47], s64 offen nt
v_and_b32_dpp v100, v15, v4 row_newbcast:8 row_mask:0xf bank_mask:0xf
v_and_b32_dpp v101, v15, v5 row_newbcast:8 row_mask:0xf bank_mask:0xf
v_and_b32_dpp v102, v15, v6 row_newbcast:8 row_mask:0xf bank_mask:0xf
v_and_b32_dpp v103, v15, v7 row_newbcast:8 row_mask:0xf bank_mask:0xf
v_mfma_f32_16x16x32_bf16 v[108:111], v[104:107], v[192:195], v[108:111]
s_xor_b32 s64, s65, 100352
s_cmpk_gt_u32 s69, 105
s_waitcnt vmcnt(6)
s_cbranch_scc1 L_d_112
s_waitcnt vmcnt(5)
L_d_112:
buffer_load_dwordx4 v[224:227], v1, s[44:47], s64 offen nt
v_and_b32_dpp v104, v15, v4 row_newbcast:12 row_mask:0xf bank_mask:0xf
v_and_b32_dpp v105, v15, v5 row_newbcast:12 row_mask:0xf bank_mask:0xf
v_and_b32_dpp v106, v15, v6 row_newbcast:12 row_mask:0xf bank_mask:0xf
v_and_b32_dpp v107, v15, v7 row_newbcast:12 row_mask:0xf bank_mask:0xf
v_mfma_f32_16x16x32_bf16 v[108:111], v[100:103], v[196:199], v[108:111]
s_xor_b32 s64, s65, 71680
s_cmpk_gt_u32 s69, 106
s_waitcnt vmcnt(6)
s_cbranch_scc1 L_d_113
s_waitcnt vmcnt(5)
L_d_113:
buffer_load_dwordx4 v[228:231], v1, s[44:47], s64 offen nt
v_and_b32_dpp v100, v16, v4 row_newbcast:0 row_mask:0xf bank_mask:0xf
v_and_b32_dpp v101, v16, v5 row_newbcast:0 row_mask:0xf bank_mask:0xf
v_and_b32_dpp v102, v16, v6 row_newbcast:0 row_mask:0xf bank_mask:0xf
v_and_b32_dpp v103, v16, v7 row_newbcast:0 row_mask:0xf bank_mask:0xf
v_mfma_f32_16x16x32_bf16 v[108:111], v[104:107], v[200:203], v[108:111]
s_xor_b32 s64, s65, 104448
s_cmpk_gt_u32 s69, 107
s_waitcnt vmcnt(6)
s_cbranch_scc1 L_d_114
s_waitcnt vmcnt(5)
L_d_114:
buffer_load_dwordx4 v[232:235], v1, s[44:47], s64 offen nt
v_and_b32_dpp v104, v16, v4 row_newbcast:4 row_mask:0xf bank_mask:0xf
v_and_b32_dpp v105, v16, v5 row_newbcast:4 row_mask:0xf bank_mask:0xf
v_and_b32_dpp v106, v16, v6 row_newbcast:4 row_mask:0xf bank_mask:0xf
v_and_b32_dpp v107, v16, v7 row_newbcast:4 row_mask:0xf bank_mask:0xf
v_mfma_f32_16x16x32_bf16 v[108:111], v[100:103], v[204:207], v[108:111]
s_xor_b32 s64, s65, 68608
s_cmpk_gt_u32 s69, 108
s_waitcnt vmcnt(6)
s_cbranch_scc1 L_d_115
s_waitcnt vmcnt(5)
L_d_115:
buffer_load_dwordx4 v[236:239], v1, s[44:47], s64 offen nt
v_and_b32_dpp v100, v16, v4 row_newbcast:8 row_mask:0xf bank_mask:0xf
v_and_b32_dpp v101, v16, v5 row_newbcast:8 row_mask:0xf bank_mask:0xf
v_and_b32_dpp v102, v16, v6 row_newbcast:8 row_mask:0xf bank_mask:0xf
v_and_b32_dpp v103, v16, v7 row_newbcast:8 row_mask:0xf bank_mask:0xf
v_mfma_f32_16x16x32_bf16 v[108:111], v[104:107], v[208:211], v[108:111]
s_xor_b32 s64, s65, 101376
s_cmpk_gt_u32 s69, 109
s_waitcnt vmcnt(6)
s_cbranch_scc1 L_d_116
s_waitcnt vmcnt(5)
L_d_116:
buffer_load_dwordx4 v[240:243], v1, s[44:47], s64 offen nt
v_and_b32_dpp v104, v16, v4 row_newbcast:12 row_mask:0xf bank_mask:0xf
v_and_b32_dpp v105, v16, v5 row_newbcast:12 row_mask:0xf bank_mask:0xf
v_and_b32_dpp v106, v16, v6 row_newbcast:12 row_mask:0xf bank_mask:0xf
v_and_b32_dpp v107, v16, v7 row_newbcast:12 row_mask:0xf bank_mask:0xf
v_mfma_f32_16x16x32_bf16 v[108:111], v[100:103], v[212:215], v[108:111]
s_cmp_eq_u32 s34, 2
s_cbranch_scc0 L_w_118
v_mov_b32 v124, 46
s_mov_b64 exec, 1
buffer_store_dword v124, off, s[36:39], s63 offset:0
s_mov_b64 exec, -1
L_w_118:
s_xor_b32 s64, s65, 72704
s_cmpk_gt_u32 s69, 110
s_waitcnt vmcnt(6)
s_cbranch_scc1 L_d_117
s_waitcnt vmcnt(5)
L_d_117:
buffer_load_dwordx4 v[244:247], v1, s[44:47], s64 offen nt
v_and_b32_dpp v100, v18, v4 row_newbcast:0 row_mask:0xf bank_mask:0xf
v_and_b32_dpp v101, v18, v5 row_newbcast:0 row_mask:0xf bank_mask:0xf
v_and_b32_dpp v102, v18, v6 row_newbcast:0 row_mask:0xf bank_mask:0xf
v_and_b32_dpp v103, v18, v7 row_newbcast:0 row_mask:0xf bank_mask:0xf
v_mfma_f32_16x16x32_bf16 v[108:111], v[104:107], v[216:219], v[108:111]
s_xor_b32 s64, s65, 105472
s_cmpk_gt_u32 s69, 111
s_waitcnt vmcnt(6)
s_cbranch_scc1 L_d_119
s_waitcnt vmcnt(5)
L_d_119:
buffer_load_dwordx4 v[248:251], v1, s[44:47], s64 offen nt
v_and_b32_dpp v104, v18, v4 row_newbcast:4 row_mask:0xf bank_mask:0xf
v_and_b32_dpp v105, v18, v5 row_newbcast:4 row_mask:0xf bank_mask:0xf
v_and_b32_dpp v106, v18, v6 row_newbcast:4 row_mask:0xf bank_mask:0xf
v_and_b32_dpp v107, v18, v7 row_newbcast:4 row_mask:0xf bank_mask:0xf
v_mfma_f32_16x16x32_bf16 v[108:111], v[100:103], v[220:223], v[108:111]
s_xor_b32 s64, s65, 133120
s_waitcnt vmcnt(5)
buffer_load_dwordx4 v[252:255], v1, s[44:47], s64 offen nt
v_and_b32_dpp v100, v18, v4 row_newbcast:8 row_mask:0xf bank_mask:0xf
v_and_b32_dpp v101, v18, v5 row_newbcast:8 row_mask:0xf bank_mask:0xf
v_and_b32_dpp v102, v18, v6 row_newbcast:8 row_mask:0xf bank_mask:0xf
v_and_b32_dpp v103, v18, v7 row_newbcast:8 row_mask:0xf bank_mask:0xf
v_mfma_f32_16x16x32_bf16 v[108:111], v[104:107], v[224:227], v[108:111]
v_and_b32_dpp v104, v18, v4 row_newbcast:12 row_mask:0xf bank_mask:0xf
v_and_b32_dpp v105, v18, v5 row_newbcast:12 row_mask:0xf bank_mask:0xf
v_and_b32_dpp v106, v18, v6 row_newbcast:12 row_mask:0xf bank_mask:0xf
v_and_b32_dpp v107, v18, v7 row_newbcast:12 row_mask:0xf bank_mask:0xf
v_mfma_f32_16x16x32_bf16 v[108:111], v[100:103], v[228:231], v[108:111]
s_xor_b32 s64, s65, 165888
s_waitcnt vmcnt(5)
buffer_load_dwordx4 v[84:87], v1, s[44:47], s64 offen nt
v_and_b32_dpp v100, v19, v4 row_newbcast:0 row_mask:0xf bank_mask:0xf
v_and_b32_dpp v101, v19, v5 row_newbcast:0 row_mask:0xf bank_mask:0xf
v_and_b32_dpp v102, v19, v6 row_newbcast:0 row_mask:0xf bank_mask:0xf
v_and_b32_dpp v103, v19, v7 row_newbcast:0 row_mask:0xf bank_mask:0xf
v_mfma_f32_16x16x32_bf16 v[108:111], v[104:107], v[232:235], v[108:111]
s_xor_b32 s64, s65, 137216
s_waitcnt vmcnt(5)
buffer_load_dwordx4 v[88:91], v1, s[44:47], s64 offen nt
v_and_b32_dpp v104, v19, v4 row_newbcast:4 row_mask:0xf bank_mask:0xf
v_and_b32_dpp v105, v19, v5 row_newbcast:4 row_mask:0xf bank_mask:0xf
v_and_b32_dpp v106, v19, v6 row_newbcast:4 row_mask:0xf bank_mask:0xf
v_and_b32_dpp v107, v19, v7 row_newbcast:4 row_mask:0xf bank_mask:0xf
v_mfma_f32_16x16x32_bf16 v[108:111], v[100:103], v[236:239], v[108:111]
s_xor_b32 s64, s65, 169984
s_waitcnt vmcnt(5)
buffer_load_dwordx4 v[132:135], v1, s[44:47], s64 offen nt
v_and_b32_dpp v100, v19, v4 row_newbcast:8 row_mask:0xf bank_mask:0xf
v_and_b32_dpp v101, v19, v5 row_newbcast:8 row_mask:0xf bank_mask:0xf
v_and_b32_dpp v102, v19, v6 row_newbcast:8 row_mask:0xf bank_mask:0xf
v_and_b32_dpp v103, v19, v7 row_newbcast:8 row_mask:0xf bank_mask:0xf
v_mfma_f32_16x16x32_bf16 v[108:111], v[104:107], v[240:243], v[108:111]
s_xor_b32 s64, s65, 134144
s_waitcnt vmcnt(5)
buffer_load_dwordx4 v[136:139], v1, s[44:47], s64 offen nt
v_and_b32_dpp v104, v19, v4 row_newbcast:12 row_mask:0xf bank_mask:0xf
v_and_b32_dpp v105, v19, v5 row_newbcast:12 row_mask:0xf bank_mask:0xf
v_and_b32_dpp v106, v19, v6 row_newbcast:12 row_mask:0xf bank_mask:0xf
v_and_b32_dpp v107, v19, v7 row_newbcast:12 row_mask:0xf bank_mask:0xf
v_mfma_f32_16x16x32_bf16 v[108:111], v[100:103], v[244:247], v[108:111]
s_xor_b32 s64, s65, 166912
s_waitcnt vmcnt(5)
buffer_load_dwordx4 v[140:143], v1, s[44:47], s64 offen nt
v_and_b32_dpp v100, v20, v4 row_newbcast:0 row_mask:0xf bank_mask:0xf
v_and_b32_dpp v101, v20, v5 row_newbcast:0 row_mask:0xf bank_mask:0xf
v_and_b32_dpp v102, v20, v6 row_newbcast:0 row_mask:0xf bank_mask:0xf
v_and_b32_dpp v103, v20, v7 row_newbcast:0 row_mask:0xf bank_mask:0xf
v_mfma_f32_16x16x32_bf16 v[108:111], v[104:107], v[248:251], v[108:111]
s_cmp_eq_u32 s34, 3
s_cbranch_scc0 L_w_120
v_mov_b32 v124, 54
s_mov_b64 exec, 1
buffer_store_dword v124, off, s[36:39], s63 offset:0
s_mov_b64 exec, -1
L_w_120:
s_xor_b32 s64, s65, 138240
s_waitcnt vmcnt(5)
buffer_load_dwordx4 v[144:147], v1, s[44:47], s64 offen nt
v_and_b32_dpp v104, v20, v4 row_newbcast:4 row_mask:0xf bank_mask:0xf
v_and_b32_dpp v105, v20, v5 row_newbcast:4 row_mask:0xf bank_mask:0xf
v_and_b32_dpp v106, v20, v6 row_newbcast:4 row_mask:0xf bank_mask:0xf
v_and_b32_dpp v107, v20, v7 row_newbcast:4 row_mask:0xf bank_mask:0xf
v_mfma_f32_16x16x32_bf16 v[108:111], v[100:103], v[252:255], v[108:111]
s_xor_b32 s64, s65, 171008
s_waitcnt vmcnt(5)
buffer_load_dwordx4 v[148:151], v1, s[44:47], s64 offen nt
v_and_b32_dpp v100, v20, v4 row_newbcast:8 row_mask:0xf bank_mask:0xf
v_and_b32_dpp v101, v20, v5 row_newbcast:8 row_mask:0xf bank_mask:0xf
v_and_b32_dpp v102, v20, v6 row_newbcast:8 row_mask:0xf bank_mask:0xf
v_and_b32_dpp v103, v20, v7 row_newbcast:8 row_mask:0xf bank_mask:0xf
v_mfma_f32_16x16x32_bf16 v[108:111], v[104:107], v[84:87], v[108:111]
s_xor_b32 s64, s65, 198656
s_waitcnt vmcnt(7)
buffer_load_dwordx4 v[152:155], v1, s[44:47], s64 offen nt
s_xor_b32 s64, s65, 231424
s_waitcnt vmcnt(7)
buffer_load_dwordx4 v[156:159], v1, s[44:47], s64 offen nt
s_cmp_lt_u32 s2, 208
s_cbranch_scc0 L_hp_121
v_lshlrev_b32 v160, 2, v0
buffer_load_dword v161, v160, s[36:39], s62 offen offset:0 sc1
L_hp_121:
s_xor_b32 s64, s65, 202752
s_waitcnt vmcnt(7)
buffer_load_dwordx4 v[176:179], v1, s[44:47], s64 offen nt
v_and_b32_dpp v104, v20, v4 row_newbcast:12 row_mask:0xf bank_mask:0xf
v_and_b32_dpp v105, v20, v5 row_newbcast:12 row_mask:0xf bank_mask:0xf
v_and_b32_dpp v106, v20, v6 row_newbcast:12 row_mask:0xf bank_mask:0xf
v_and_b32_dpp v107, v20, v7 row_newbcast:12 row_mask:0xf bank_mask:0xf
v_mfma_f32_16x16x32_bf16 v[108:111], v[100:103], v[88:91], v[108:111]
s_xor_b32 s64, s65, 235520
s_waitcnt vmcnt(7)
buffer_load_dwordx4 v[180:183], v1, s[44:47], s64 offen nt
v_and_b32_dpp v100, v21, v4 row_newbcast:0 row_mask:0xf bank_mask:0xf
v_and_b32_dpp v101, v21, v5 row_newbcast:0 row_mask:0xf bank_mask:0xf
v_and_b32_dpp v102, v21, v6 row_newbcast:0 row_mask:0xf bank_mask:0xf
v_and_b32_dpp v103, v21, v7 row_newbcast:0 row_mask:0xf bank_mask:0xf
v_mfma_f32_16x16x32_bf16 v[108:111], v[104:107], v[132:135], v[108:111]
s_xor_b32 s64, s65, 199680
s_waitcnt vmcnt(7)
buffer_load_dwordx4 v[184:187], v1, s[44:47], s64 offen nt
v_and_b32_dpp v104, v21, v4 row_newbcast:4 row_mask:0xf bank_mask:0xf
v_and_b32_dpp v105, v21, v5 row_newbcast:4 row_mask:0xf bank_mask:0xf
v_and_b32_dpp v106, v21, v6 row_newbcast:4 row_mask:0xf bank_mask:0xf
v_and_b32_dpp v107, v21, v7 row_newbcast:4 row_mask:0xf bank_mask:0xf
v_mfma_f32_16x16x32_bf16 v[108:111], v[100:103], v[136:139], v[108:111]
s_xor_b32 s64, s65, 232448
s_waitcnt vmcnt(7)
buffer_load_dwordx4 v[24:27], v1, s[44:47], s64 offen nt
v_and_b32_dpp v100, v21, v4 row_newbcast:8 row_mask:0xf bank_mask:0xf
v_and_b32_dpp v101, v21, v5 row_newbcast:8 row_mask:0xf bank_mask:0xf
v_and_b32_dpp v102, v21, v6 row_newbcast:8 row_mask:0xf bank_mask:0xf
v_and_b32_dpp v103, v21, v7 row_newbcast:8 row_mask:0xf bank_mask:0xf
v_mfma_f32_16x16x32_bf16 v[108:111], v[104:107], v[140:143], v[108:111]
s_cmp_eq_u32 s34, 0
s_cbranch_scc0 L_w_122
v_mov_b32 v124, 62
s_mov_b64 exec, 1
buffer_store_dword v124, off, s[36:39], s63 offset:0
s_mov_b64 exec, -1
L_w_122:
s_xor_b32 s64, s65, 203776
s_waitcnt vmcnt(7)
buffer_load_dwordx4 v[28:31], v1, s[44:47], s64 offen nt
v_and_b32_dpp v104, v21, v4 row_newbcast:12 row_mask:0xf bank_mask:0xf
v_and_b32_dpp v105, v21, v5 row_newbcast:12 row_mask:0xf bank_mask:0xf
v_and_b32_dpp v106, v21, v6 row_newbcast:12 row_mask:0xf bank_mask:0xf
v_and_b32_dpp v107, v21, v7 row_newbcast:12 row_mask:0xf bank_mask:0xf
v_mfma_f32_16x16x32_bf16 v[108:111], v[100:103], v[144:147], v[108:111]
s_xor_b32 s64, s65, 236544
s_waitcnt vmcnt(7)
buffer_load_dwordx4 v[32:35], v1, s[44:47], s64 offen nt
v_and_b32_dpp v100, v22, v4 row_newbcast:0 row_mask:0xf bank_mask:0xf
v_and_b32_dpp v101, v22, v5 row_newbcast:0 row_mask:0xf bank_mask:0xf
v_and_b32_dpp v102, v22, v6 row_newbcast:0 row_mask:0xf bank_mask:0xf
v_and_b32_dpp v103, v22, v7 row_newbcast:0 row_mask:0xf bank_mask:0xf
v_mfma_f32_16x16x32_bf16 v[108:111], v[104:107], v[148:151], v[108:111]
s_cmp_lt_u32 s2, 208
s_cbranch_scc0 L_nohelp
v_lshrrev_b32 v172, 3, v0
v_sub_u32 v172, 63, v172
v_and_b32 v168, 7, v0
v_lshlrev_b32 v168, 7, v168
v_bfe_u32 v162, v172, 0, 1
v_lshl_or_b32 v168, v162, 15, v168
v_bfe_u32 v162, v172, 1, 1
v_lshl_or_b32 v168, v162, 12, v168
v_bfe_u32 v162, v172, 2, 1
v_lshl_or_b32 v168, v162, 10, v168
v_bfe_u32 v162, v172, 3, 1
v_lshl_or_b32 v168, v162, 16, v168
v_bfe_u32 v162, v172, 4, 1
v_lshl_or_b32 v168, v162, 17, v168
v_bfe_u32 v162, v172, 5, 1
v_lshl_or_b32 v168, v162, 11, v168
v_lshrrev_b32 v173, 3, v0
v_sub_u32 v173, 55, v173
v_and_b32 v169, 7, v0
v_lshlrev_b32 v169, 7, v169
v_bfe_u32 v162, v173, 0, 1
v_lshl_or_b32 v169, v162, 15, v169
v_bfe_u32 v162, v173, 1, 1
v_lshl_or_b32 v169, v162, 12, v169
v_bfe_u32 v162, v173, 2, 1
v_lshl_or_b32 v169, v162, 10, v169
v_bfe_u32 v162, v173, 3, 1
v_lshl_or_b32 v169, v162, 16, v169
v_bfe_u32 v162, v173, 4, 1
v_lshl_or_b32 v169, v162, 17, v169
v_bfe_u32 v162, v173, 5, 1
v_lshl_or_b32 v169, v162, 11, v169
s_lshr_b32 s71, s2, 3
v_subrev_u32 v163, s71, v0
v_and_b32 v163, 31, v163
s_waitcnt vmcnt(6)
v_mov_b32 v162, v161
s_nop 1
v_permlane32_swap_b32 v161, v162
v_add_u32 v161, 1, v161
v_max_u32 v161, 23, v161
v_cmp_eq_u32 vcc, -1, v162
v_mov_b32 v160, 0xff
s_nop 0
v_cndmask_b32 v161, v160, v161, vcc
v_lshl_or_b32 v161, v161, 5, v163
s_nop 1
v_min_u32_dpp v161, v161, v161 quad_perm:[1,0,3,2] row_mask:0xf bank_mask:0xf
s_nop 1
v_min_u32_dpp v161, v161, v161 quad_perm:[2,3,0,1] row_mask:0xf bank_mask:0xf
s_nop 1
v_min_u32_dpp v161, v161, v161 row_ror:4 row_mask:0xf bank_mask:0xf
s_nop 1
v_min_u32_dpp v161, v161, v161 row_ror:8 row_mask:0xf bank_mask:0xf
s_nop 1
v_readlane_b32 s76, v161, 0
v_readlane_b32 s66, v161, 16
s_min_u32 s76, s76, s66
s_lshr_b32 s66, s76, 5
s_cmp_lt_u32 s66, 50
s_cbranch_scc0 L_drain
s_mov_b32 s48, s8
s_mov_b32 s49, s9
s_mov_b32 s50, 0x10000000
s_mov_b32 s51, 0x20000
s_lshr_b32 s64, s2, 3
s_add_u32 s76, s76, s64
s_and_b32 s76, s76, 31
s_lshl_b32 s67, s76, 2
s_add_u32 s67, s67, s62
s_lshl_b32 s76, s76, 3
s_and_b32 s64, s2, 7
s_or_b32 s76, s76, s64
s_mul_i32 s76, s76, 0x100400
s_lshl_b32 s64, s34, 13
s_or_b32 s64, s64, 0xC0000
s_xor_b32 s76, s76, s64
s_add_u32 s66, s66, 11
v_xor_b32 v169, s76, v169
v_cmp_lt_u32 vcc, s66, v173
s_or_b64 exec, vcc, 1
buffer_load_dword v171, v169, s[48:51], 0 offen
s_mov_b64 exec, -1
v_xor_b32 v168, s76, v168
v_cmp_lt_u32 vcc, s66, v172
s_or_b64 exec, vcc, 1
buffer_load_dword v170, v168, s[48:51], 0 offen
s_mov_b64 exec, -1
s_mov_b64 exec, 1
buffer_store_dword v1, off, s[36:39], s67 offset:128
s_mov_b64 exec, -1
s_waitcnt vmcnt(10)
v_and_b32_dpp v104, v22, v4 row_newbcast:4 row_mask:0xf bank_mask:0xf
v_and_b32_dpp v105, v22, v5 row_newbcast:4 row_mask:0xf bank_mask:0xf
v_and_b32_dpp v106, v22, v6 row_newbcast:4 row_mask:0xf bank_mask:0xf
v_and_b32_dpp v107, v22, v7 row_newbcast:4 row_mask:0xf bank_mask:0xf
v_mfma_f32_16x16x32_bf16 v[108:111], v[100:103], v[152:155], v[108:111]
s_waitcnt vmcnt(9)
v_and_b32_dpp v100, v22, v4 row_newbcast:8 row_mask:0xf bank_mask:0xf
v_and_b32_dpp v101, v22, v5 row_newbcast:8 row_mask:0xf bank_mask:0xf
v_and_b32_dpp v102, v22, v6 row_newbcast:8 row_mask:0xf bank_mask:0xf
v_and_b32_dpp v103, v22, v7 row_newbcast:8 row_mask:0xf bank_mask:0xf
v_mfma_f32_16x16x32_bf16 v[108:111], v[104:107], v[156:159], v[108:111]
s_waitcnt vmcnt(8)
v_and_b32_dpp v104, v22, v4 row_newbcast:12 row_mask:0xf bank_mask:0xf
v_and_b32_dpp v105, v22, v5 row_newbcast:12 row_mask:0xf bank_mask:0xf
v_and_b32_dpp v106, v22, v6 row_newbcast:12 row_mask:0xf bank_mask:0xf
v_and_b32_dpp v107, v22, v7 row_newbcast:12 row_mask:0xf bank_mask:0xf
v_mfma_f32_16x16x32_bf16 v[108:111], v[100:103], v[176:179], v[108:111]
s_waitcnt vmcnt(7)
v_and_b32_dpp v100, v23, v4 row_newbcast:0 row_mask:0xf bank_mask:0xf
v_and_b32_dpp v101, v23, v5 row_newbcast:0 row_mask:0xf bank_mask:0xf
v_and_b32_dpp v102, v23, v6 row_newbcast:0 row_mask:0xf bank_mask:0xf
v_and_b32_dpp v103, v23, v7 row_newbcast:0 row_mask:0xf bank_mask:0xf
v_mfma_f32_16x16x32_bf16 v[108:111], v[104:107], v[180:183], v[108:111]
s_waitcnt vmcnt(6)
v_and_b32_dpp v104, v23, v4 row_newbcast:4 row_mask:0xf bank_mask:0xf
v_and_b32_dpp v105, v23, v5 row_newbcast:4 row_mask:0xf bank_mask:0xf
v_and_b32_dpp v106, v23, v6 row_newbcast:4 row_mask:0xf bank_mask:0xf
v_and_b32_dpp v107, v23, v7 row_newbcast:4 row_mask:0xf bank_mask:0xf
v_mfma_f32_16x16x32_bf16 v[108:111], v[100:103], v[184:187], v[108:111]
s_waitcnt vmcnt(5)
v_and_b32_dpp v100, v23, v4 row_newbcast:8 row_mask:0xf bank_mask:0xf
v_and_b32_dpp v101, v23, v5 row_newbcast:8 row_mask:0xf bank_mask:0xf
v_and_b32_dpp v102, v23, v6 row_newbcast:8 row_mask:0xf bank_mask:0xf
v_and_b32_dpp v103, v23, v7 row_newbcast:8 row_mask:0xf bank_mask:0xf
v_mfma_f32_16x16x32_bf16 v[108:111], v[104:107], v[24:27], v[108:111]
s_waitcnt vmcnt(4)
v_and_b32_dpp v104, v23, v4 row_newbcast:12 row_mask:0xf bank_mask:0xf
v_and_b32_dpp v105, v23, v5 row_newbcast:12 row_mask:0xf bank_mask:0xf
v_and_b32_dpp v106, v23, v6 row_newbcast:12 row_mask:0xf bank_mask:0xf
v_and_b32_dpp v107, v23, v7 row_newbcast:12 row_mask:0xf bank_mask:0xf
v_mfma_f32_16x16x32_bf16 v[108:111], v[100:103], v[28:31], v[108:111]
s_waitcnt vmcnt(3)
v_mfma_f32_16x16x32_bf16 v[108:111], v[104:107], v[32:35], v[108:111]
s_branch L_drained
L_nohelp:
L_drain:
s_waitcnt vmcnt(7)
v_and_b32_dpp v104, v22, v4 row_newbcast:4 row_mask:0xf bank_mask:0xf
v_and_b32_dpp v105, v22, v5 row_newbcast:4 row_mask:0xf bank_mask:0xf
v_and_b32_dpp v106, v22, v6 row_newbcast:4 row_mask:0xf bank_mask:0xf
v_and_b32_dpp v107, v22, v7 row_newbcast:4 row_mask:0xf bank_mask:0xf
v_mfma_f32_16x16x32_bf16 v[108:111], v[100:103], v[152:155], v[108:111]
s_waitcnt vmcnt(6)
v_and_b32_dpp v100, v22, v4 row_newbcast:8 row_mask:0xf bank_mask:0xf
v_and_b32_dpp v101, v22, v5 row_newbcast:8 row_mask:0xf bank_mask:0xf
v_and_b32_dpp v102, v22, v6 row_newbcast:8 row_mask:0xf bank_mask:0xf
v_and_b32_dpp v103, v22, v7 row_newbcast:8 row_mask:0xf bank_mask:0xf
v_mfma_f32_16x16x32_bf16 v[108:111], v[104:107], v[156:159], v[108:111]
s_waitcnt vmcnt(5)
v_and_b32_dpp v104, v22, v4 row_newbcast:12 row_mask:0xf bank_mask:0xf
v_and_b32_dpp v105, v22, v5 row_newbcast:12 row_mask:0xf bank_mask:0xf
v_and_b32_dpp v106, v22, v6 row_newbcast:12 row_mask:0xf bank_mask:0xf
v_and_b32_dpp v107, v22, v7 row_newbcast:12 row_mask:0xf bank_mask:0xf
v_mfma_f32_16x16x32_bf16 v[108:111], v[100:103], v[176:179], v[108:111]
s_waitcnt vmcnt(4)
v_and_b32_dpp v100, v23, v4 row_newbcast:0 row_mask:0xf bank_mask:0xf
v_and_b32_dpp v101, v23, v5 row_newbcast:0 row_mask:0xf bank_mask:0xf
v_and_b32_dpp v102, v23, v6 row_newbcast:0 row_mask:0xf bank_mask:0xf
v_and_b32_dpp v103, v23, v7 row_newbcast:0 row_mask:0xf bank_mask:0xf
v_mfma_f32_16x16x32_bf16 v[108:111], v[104:107], v[180:183], v[108:111]
s_waitcnt vmcnt(3)
v_and_b32_dpp v104, v23, v4 row_newbcast:4 row_mask:0xf bank_mask:0xf
v_and_b32_dpp v105, v23, v5 row_newbcast:4 row_mask:0xf bank_mask:0xf
v_and_b32_dpp v106, v23, v6 row_newbcast:4 row_mask:0xf bank_mask:0xf
v_and_b32_dpp v107, v23, v7 row_newbcast:4 row_mask:0xf bank_mask:0xf
v_mfma_f32_16x16x32_bf16 v[108:111], v[100:103], v[184:187], v[108:111]
s_waitcnt vmcnt(2)
v_and_b32_dpp v100, v23, v4 row_newbcast:8 row_mask:0xf bank_mask:0xf
v_and_b32_dpp v101, v23, v5 row_newbcast:8 row_mask:0xf bank_mask:0xf
v_and_b32_dpp v102, v23, v6 row_newbcast:8 row_mask:0xf bank_mask:0xf
v_and_b32_dpp v103, v23, v7 row_newbcast:8 row_mask:0xf bank_mask:0xf
v_mfma_f32_16x16x32_bf16 v[108:111], v[104:107], v[24:27], v[108:111]
s_waitcnt vmcnt(1)
v_and_b32_dpp v104, v23, v4 row_newbcast:12 row_mask:0xf bank_mask:0xf
v_and_b32_dpp v105, v23, v5 row_newbcast:12 row_mask:0xf bank_mask:0xf
v_and_b32_dpp v106, v23, v6 row_newbcast:12 row_mask:0xf bank_mask:0xf
v_and_b32_dpp v107, v23, v7 row_newbcast:12 row_mask:0xf bank_mask:0xf
v_mfma_f32_16x16x32_bf16 v[108:111], v[100:103], v[28:31], v[108:111]
s_waitcnt vmcnt(0)
v_mfma_f32_16x16x32_bf16 v[108:111], v[104:107], v[32:35], v[108:111]
L_drained:
v_and_b32 v2, 15, v0
v_lshlrev_b32 v2, 5, v2
v_and_b32 v3, 16, v0
v_add_u32 v2, v2, v3
s_lshl_b32 s68, s34, 9
v_add_u32 v2, s68, v2
s_mov_b32 exec_hi, 0
s_nop 1
ds_write_b128 v2, v[108:111] offset:512
s_mov_b32 exec_hi, -1
v_lshlrev_b32 v1, 4, v0
s_waitcnt lgkmcnt(0)
s_barrier
v_mov_b32 v2, 0
ds_read_b32 v3, v2 offset:328
s_waitcnt lgkmcnt(0)
v_readfirstlane_b32 s35, v3
s_branch L_tail_s
L_fin:
L_end:
s_endpgm
L_code_end:
.section .rodata,"a"
.p2align 6
.amdhsa_kernel adaLN_cond__sliding_block_cached__glu_gated_glu__decode_kernel
  .amdhsa_next_free_vgpr 256
  .amdhsa_next_free_sgpr 102
  .amdhsa_accum_offset 256
  .amdhsa_group_segment_fixed_size 0
  .amdhsa_kernarg_size 112
  .amdhsa_user_sgpr_count 2
  .amdhsa_user_sgpr_kernarg_segment_ptr 1
  .amdhsa_system_sgpr_workgroup_id_x 1
  .amdhsa_float_denorm_mode_32 3
.end_amdhsa_kernel
```

```asm
; @launch grid=(256,1,1) block=(512,1,1) lds=131072
.amdgcn_target "amdgcn-amd-amdhsa--gfx950"
.text
.globl adaLN_cond__sliding_block_cached__glu_gated_glu__decode_kernel
.p2align 8
.type adaLN_cond__sliding_block_cached__glu_gated_glu__decode_kernel,@function
adaLN_cond__sliding_block_cached__glu_gated_glu__decode_kernel:
L_code_begin:
s_load_dwordx16 s[4:19], s[0:1], 0
s_load_dwordx8 s[20:27], s[0:1], 64
s_load_dwordx4 s[28:31], s[0:1], 96
s_cmpk_ge_u32 s2, 256
s_cbranch_scc1 L_end
v_lshrrev_b32 v1, 6, v0
v_and_b32 v0, 63, v0
v_readfirstlane_b32 s3, v1
v_lshlrev_b32 v1, 4, v0
s_lshl_b32 s64, s2, 20
s_add_u32 s64, s64, 0xC0000
s_mov_b32 s42, 0x40000
s_mov_b32 s43, 0x20000
s_and_b32 s34, s3, 3
s_cmp_ge_u32 s3, 4
s_cbranch_scc1 L_helper
s_lshl_b32 s65, s34, 13
s_lshl_b32 s66, s2, 10
s_xor_b32 s65, s65, s66
s_waitcnt lgkmcnt(0)
s_add_u32 s40, s6, s64
s_addc_u32 s41, s7, 0
s_add_u32 s44, s8, s64
s_addc_u32 s45, s9, 0
buffer_load_dwordx4 v[8:11], v1, s[40:43], s65 offen nt
s_xor_b32 s64, s65, 32768
buffer_load_dwordx4 v[12:15], v1, s[40:43], s64 offen nt
s_xor_b32 s64, s65, 4096
buffer_load_dwordx4 v[16:19], v1, s[40:43], s64 offen nt
s_xor_b32 s64, s65, 36864
buffer_load_dwordx4 v[20:23], v1, s[40:43], s64 offen nt
s_barrier
s_branch L_srest
L_helper:
s_setprio 2
v_lshlrev_b32 v2, 2, v0
s_cmp_eq_u32 s3, 7
s_cbranch_scc0 L_nopf
s_getpc_b64 s[60:61]
L_pc:
s_lshr_b32 s66, s2, 3
s_lshl_b32 s66, s66, 10
v_add_u32 v10, s66, v1
v_min_u32 v10, L_code_end-L_pc-16, v10
global_load_dwordx4 v[12:15], v10, s[60:61]
v_subrev_u32 v3, 16, v0
v_ashrrev_i32 v3, 31, v3
ds_write_b32 v2, v3 offset:256
L_nopf:
s_and_b32 s67, s2, 7
s_lshr_b32 s68, s2, 3
v_and_b32 v38, 7, v0
v_lshrrev_b32 v37, 3, v0
s_cmp_eq_u32 s34, 0
s_cbranch_scc0 L_p0a
s_mov_b32 s70, 6
s_lshl_b32 s67, s67, 1
s_add_u32 s66, s67, 14
v_min_u32 v38, 5, v38
v_cmp_lt_u32 vcc, 1, v38
v_add_u32 v36, s66, v38
s_nop 0
v_cndmask_b32 v38, v38, v36, vcc
s_branch L_p0b
L_p0a:
s_lshl_b32 s67, s67, 3
s_lshl_b32 s65, s2, 3
s_and_b32 s65, s65, 0xff
s_lshr_b32 s66, s2, 5
s_or_b32 s65, s65, s66
s_cmp_eq_u32 s34, 2
s_cselect_b32 s70, 1, 8
s_cselect_b32 s68, s65, s68
s_cselect_b32 s67, 0, s67
L_p0b:
v_lshl_add_u32 v37, s68, 4, v37
v_mul_u32_u24 v37, s70, v37
v_lshl_add_u32 v38, v37, 3, v38
v_add_lshl_u32 v38, v38, s67, 7
s_lshl_b32 s70, s70, 13
v_add_u32 v39, s70, v38
s_sub_u32 s64, s2, 112
s_cmp_lt_u32 s64, 32
s_waitcnt lgkmcnt(0)
s_barrier
s_cbranch_scc1 L_jan
s_cmp_eq_u32 s34, 3
s_cbranch_scc1 L_p0_123
s_cmp_eq_u32 s34, 0
s_cselect_b32 s62, s24, s10
s_cselect_b32 s63, s25, s11
s_cmp_eq_u32 s34, 2
s_cselect_b32 s62, s12, s62
s_cselect_b32 s63, s13, s63
global_load_dword v12, v38, s[62:63]
global_load_dword v13, v39, s[62:63]
L_p0_123:
L_nop0:
s_cmp_eq_u32 s34, 3
s_cselect_b32 s64, 16, 0
s_cmp_lt_u32 s2, s64
s_cbranch_scc0 L_nopc
v_mov_b32 v4, -1
v_mov_b32 v5, -1
v_mov_b32 v6, -1
v_mov_b32 v7, -1
s_and_b32 s66, s2, 7
s_lshl_b32 s66, s66, 11
s_and_b32 s65, s2, 8
s_lshl_b32 s65, s65, 7
s_add_u32 s66, s66, s65
v_add_u32 v8, s66, v1
global_store_dwordx4 v8, v[4:7], s[30:31] sc1
s_lshl_b32 s66, s2, 2
v_mov_b32 v3, s66
s_waitcnt vmcnt(0)
s_mov_b64 exec, 1
global_store_dword v3, v4, s[28:29] sc1
s_mov_b64 exec, -1
L_nopc:
s_cmp_eq_u32 s34, 3
s_cbranch_scc0 L_w_124
s_and_b32 s67, s2, 7
s_lshr_b32 s68, s2, 3
s_min_u32 s64, s67, 3
s_mul_i32 s65, s67, 5
s_add_u32 s64, s64, s65
s_cmp_lt_u32 s67, 3
s_cselect_b32 s65, 6, 5
L_w_124:
s_lshr_b32 s32, s2, 5
s_and_b32 s33, s2, 31
s_and_b32 s67, s2, 7
s_lshr_b32 s68, s2, 3
s_sub_u32 s68, s68, 26
s_min_u32 s74, s67, 3
s_mul_i32 s66, s67, 5
s_add_u32 s74, s74, s66
s_add_u32 s74, s74, s68
s_cmp_lt_u32 s67, 3
s_cselect_b32 s66, 6, 5
s_cmp_lt_u32 s68, s66
s_cselect_b32 s74, s74, -1
s_cmp_lt_u32 s2, 48
s_cselect_b32 s66, 2, 3
s_cselect_b32 s72, 14+26, 42+26
s_cmp_lt_u32 s2, 16
s_cselect_b32 s66, 1, s66
s_cselect_b32 s72, 26, s72
s_lshl_b32 s66, s67, s66
s_add_u32 s72, s72, s66
s_add_u32 s72, s72, s68
s_mov_b32 s36, s30
s_mov_b32 s37, s31
s_mov_b32 s38, 0x1d0000
s_mov_b32 s39, 0x20000
s_mov_b32 s52, s28
s_mov_b32 s53, s29
s_mov_b32 s54, 0x100
s_mov_b32 s55, 0x20000
v_mov_b32 v9, 1
s_cmp_lt_u32 s2, 112
s_cbranch_scc0 L_norole
L_gemm:
v_and_b32 v16, 7, v0
v_lshlrev_b32 v16, 10, v16
v_and_b32 v17, 8, v0
v_lshl_add_u32 v16, v17, 3, v16
v_and_b32 v17, 48, v0
v_add_u32 v16, v16, v17
s_lshl_b32 s67, s34, 8
v_lshrrev_b32 v19, 3, v0
v_and_b32 v17, 2, v19
v_and_b32 v18, 7, v0
v_xor_b32 v17, v17, v18
v_xor_b32 v18, 4, v17
v_lshlrev_b32 v17, 4, v17
v_lshlrev_b32 v18, 4, v18
s_cmp_lt_u32 s2, 48
s_cbranch_scc0 L_gq0
s_mov_b32 s40, s24
s_mov_b32 s41, s25
s_mov_b32 s42, 0x300000
s_mov_b32 s43, 0x20000
s_mov_b32 s48, s22
s_mov_b32 s49, s23
s_mov_b32 s50, 0x2000
s_mov_b32 s51, 0x20000
s_mov_b32 s70, 6144
s_lshl_b32 s64, s72, 7
s_branch L_g1
L_gq0:
s_mov_b32 s40, s10
s_mov_b32 s41, s11
s_mov_b32 s42, 0x400000
s_mov_b32 s43, 0x20000
s_mov_b32 s48, s4
s_mov_b32 s49, s5
s_mov_b32 s50, 0x2000
s_mov_b32 s51, 0x20000
s_mov_b32 s70, 8192
s_sub_u32 s64, s72, 48
s_lshl_b32 s64, s64, 7
L_g1:
buffer_load_dwordx4 v[192:195], v16, s[48:51], s67 offen offset:0
buffer_load_dwordx4 v[196:199], v16, s[48:51], s67 offen offset:128
v_mul_lo_u32 v19, s70, v19
v_add_u32 v17, v17, v19
v_add_u32 v18, v18, v19
s_lshl_b32 s66, s70, 7
s_mul_i32 s66, s66, s34
s_add_u32 s64, s64, s66
s_lshl_b32 s70, s70, 3
s_lshl_b32 s65, s34, 13
s_add_u32 s65, s65, 4096
s_cmp_lt_u32 s2, 16
s_cselect_b32 s71, 0, 2
s_cmp_ge_u32 s2, 48
s_cselect_b32 s71, 1, s71
s_add_u32 m0, s65, 0
s_nop 0
buffer_load_dwordx4 v17, s[40:43], s64 offen  lds
s_add_u32 s64, s64, s70
s_add_u32 m0, s65, 1024
s_nop 0
buffer_load_dwordx4 v18, s[40:43], s64 offen  lds
s_add_u32 s64, s64, s70
s_cmp_eq_u32 s71, 2
s_cbranch_scc0 L_pace_125
s_waitcnt vmcnt(1)
L_pace_125:
s_add_u32 m0, s65, 2048
s_nop 0
buffer_load_dwordx4 v17, s[40:43], s64 offen  lds
s_add_u32 s64, s64, s70
s_cmp_eq_u32 s71, 0
s_cbranch_scc1 L_pace_126
s_waitcnt vmcnt(2)
s_cmp_eq_u32 s71, 2
s_cbranch_scc0 L_pace_126
s_waitcnt vmcnt(1)
L_pace_126:
s_add_u32 m0, s65, 3072
s_nop 0
buffer_load_dwordx4 v18, s[40:43], s64 offen  lds
s_add_u32 s64, s64, s70
s_cmp_eq_u32 s71, 0
s_cbranch_scc1 L_pace_127
s_waitcnt vmcnt(2)
s_cmp_eq_u32 s71, 2
s_cbranch_scc0 L_pace_127
s_waitcnt vmcnt(1)
L_pace_127:
s_add_u32 m0, s65, 4096
s_nop 0
buffer_load_dwordx4 v17, s[40:43], s64 offen  lds
s_add_u32 s64, s64, s70
s_cmp_eq_u32 s71, 0
s_cbranch_scc1 L_pace_128
s_waitcnt vmcnt(2)
s_cmp_eq_u32 s71, 2
s_cbranch_scc0 L_pace_128
s_waitcnt vmcnt(1)
L_pace_128:
s_add_u32 m0, s65, 5120
s_nop 0
buffer_load_dwordx4 v18, s[40:43], s64 offen  lds
s_add_u32 s64, s64, s70
s_cmp_eq_u32 s71, 0
s_cbranch_scc1 L_pace_129
s_waitcnt vmcnt(2)
s_cmp_eq_u32 s71, 2
s_cbranch_scc0 L_pace_129
s_waitcnt vmcnt(1)
L_pace_129:
s_add_u32 m0, s65, 6144
s_nop 0
buffer_load_dwordx4 v17, s[40:43], s64 offen  lds
s_add_u32 s64, s64, s70
s_cmp_eq_u32 s71, 0
s_cbranch_scc1 L_pace_130
s_waitcnt vmcnt(2)
s_cmp_eq_u32 s71, 2
s_cbranch_scc0 L_pace_130
s_waitcnt vmcnt(1)
L_pace_130:
s_add_u32 m0, s65, 7168
s_nop 0
buffer_load_dwordx4 v18, s[40:43], s64 offen  lds
s_add_u32 s64, s64, s70
s_cmp_eq_u32 s71, 0
s_cbranch_scc1 L_pace_131
s_waitcnt vmcnt(2)
s_cmp_eq_u32 s71, 2
s_cbranch_scc0 L_pace_131
s_waitcnt vmcnt(1)
L_pace_131:
s_add_u32 m0, s65, 32768
s_nop 0
buffer_load_dwordx4 v17, s[40:43], s64 offen  lds
s_add_u32 s64, s64, s70
s_cmp_eq_u32 s71, 0
s_cbranch_scc1 L_pace_132
s_waitcnt vmcnt(2)
s_cmp_eq_u32 s71, 2
s_cbranch_scc0 L_pace_132
s_waitcnt vmcnt(1)
L_pace_132:
s_add_u32 m0, s65, 33792
s_nop 0
buffer_load_dwordx4 v18, s[40:43], s64 offen  lds
s_add_u32 s64, s64, s70
s_cmp_eq_u32 s71, 0
s_cbranch_scc1 L_pace_133
s_waitcnt vmcnt(2)
s_cmp_eq_u32 s71, 2
s_cbranch_scc0 L_pace_133
s_waitcnt vmcnt(1)
L_pace_133:
s_add_u32 m0, s65, 34816
s_nop 0
buffer_load_dwordx4 v17, s[40:43], s64 offen  lds
s_add_u32 s64, s64, s70
s_cmp_eq_u32 s71, 0
s_cbranch_scc1 L_pace_134
s_waitcnt vmcnt(2)
s_cmp_eq_u32 s71, 2
s_cbranch_scc0 L_pace_134
s_waitcnt vmcnt(1)
L_pace_134:
s_add_u32 m0, s65, 35840
s_nop 0
buffer_load_dwordx4 v18, s[40:43], s64 offen  lds
s_add_u32 s64, s64, s70
s_cmp_eq_u32 s71, 0
s_cbranch_scc1 L_pace_135
s_waitcnt vmcnt(2)
s_cmp_eq_u32 s71, 2
s_cbranch_scc0 L_pace_135
s_waitcnt vmcnt(1)
L_pace_135:
s_add_u32 m0, s65, 36864
s_nop 0
buffer_load_dwordx4 v17, s[40:43], s64 offen  lds
s_add_u32 s64, s64, s70
s_cmp_eq_u32 s71, 0
s_cbranch_scc1 L_pace_136
s_waitcnt vmcnt(2)
s_cmp_eq_u32 s71, 2
s_cbranch_scc0 L_pace_136
s_waitcnt vmcnt(1)
L_pace_136:
s_add_u32 m0, s65, 37888
s_nop 0
buffer_load_dwordx4 v18, s[40:43], s64 offen  lds
s_add_u32 s64, s64, s70
s_cmp_eq_u32 s71, 0
s_cbranch_scc1 L_pace_137
s_waitcnt vmcnt(2)
s_cmp_eq_u32 s71, 2
s_cbranch_scc0 L_pace_137
s_waitcnt vmcnt(1)
L_pace_137:
s_add_u32 m0, s65, 38912
s_nop 0
buffer_load_dwordx4 v17, s[40:43], s64 offen  lds
s_add_u32 s64, s64, s70
s_cmp_eq_u32 s71, 0
s_cbranch_scc1 L_pace_138
s_waitcnt vmcnt(2)
s_cmp_eq_u32 s71, 2
s_cbranch_scc0 L_pace_138
s_waitcnt vmcnt(1)
L_pace_138:
s_add_u32 m0, s65, 39936
s_nop 0
buffer_load_dwordx4 v18, s[40:43], s64 offen  lds
s_add_u32 s64, s64, s70
s_waitcnt vmcnt(16)
s_cmp_eq_u32 s34, 0
s_cselect_b32 s73, 48, 0x1000
v_and_b32 v30, 15, v0
v_lshlrev_b32 v30, 2, v30
s_cmp_ge_u32 s2, s73
s_cbranch_scc0 L_fl_139
buffer_load_dword v31, v30, s[52:55], 0 offen sc1
L_fl_139:
s_mov_b32 s68, 0xffff0000
s_cmp_lt_u32 s2, 48
s_cbranch_scc0 L_gq1
s_mov_b32 s66, 0xbfb8aa3b
v_lshlrev_b32 v20, 16, v192
v_and_b32 v21, s68, v192
v_mul_f32 v22, s66, v20
v_mul_f32 v23, s66, v21
v_exp_f32 v22, v22
v_exp_f32 v23, v23
s_nop 0
v_add_f32 v22, 1.0, v22
v_add_f32 v23, 1.0, v23
v_rcp_f32 v22, v22
v_rcp_f32 v23, v23
s_nop 0
v_mul_f32 v20, v20, v22
v_mul_f32 v21, v21, v23
v_cvt_pk_bf16_f32 v48, v20, v21
v_lshlrev_b32 v20, 16, v193
v_and_b32 v21, s68, v193
v_mul_f32 v22, s66, v20
v_mul_f32 v23, s66, v21
v_exp_f32 v22, v22
v_exp_f32 v23, v23
s_nop 0
v_add_f32 v22, 1.0, v22
v_add_f32 v23, 1.0, v23
v_rcp_f32 v22, v22
v_rcp_f32 v23, v23
s_nop 0
v_mul_f32 v20, v20, v22
v_mul_f32 v21, v21, v23
v_cvt_pk_bf16_f32 v49, v20, v21
v_lshlrev_b32 v20, 16, v194
v_and_b32 v21, s68, v194
v_mul_f32 v22, s66, v20
v_mul_f32 v23, s66, v21
v_exp_f32 v22, v22
v_exp_f32 v23, v23
s_nop 0
v_add_f32 v22, 1.0, v22
v_add_f32 v23, 1.0, v23
v_rcp_f32 v22, v22
v_rcp_f32 v23, v23
s_nop 0
v_mul_f32 v20, v20, v22
v_mul_f32 v21, v21, v23
v_cvt_pk_bf16_f32 v50, v20, v21
v_lshlrev_b32 v20, 16, v195
v_and_b32 v21, s68, v195
v_mul_f32 v22, s66, v20
v_mul_f32 v23, s66, v21
v_exp_f32 v22, v22
v_exp_f32 v23, v23
s_nop 0
v_add_f32 v22, 1.0, v22
v_add_f32 v23, 1.0, v23
v_rcp_f32 v22, v22
v_rcp_f32 v23, v23
s_nop 0
v_mul_f32 v20, v20, v22
v_mul_f32 v21, v21, v23
v_cvt_pk_bf16_f32 v51, v20, v21
v_lshlrev_b32 v20, 16, v196
v_and_b32 v21, s68, v196
v_mul_f32 v22, s66, v20
v_mul_f32 v23, s66, v21
v_exp_f32 v22, v22
v_exp_f32 v23, v23
s_nop 0
v_add_f32 v22, 1.0, v22
v_add_f32 v23, 1.0, v23
v_rcp_f32 v22, v22
v_rcp_f32 v23, v23
s_nop 0
v_mul_f32 v20, v20, v22
v_mul_f32 v21, v21, v23
v_cvt_pk_bf16_f32 v52, v20, v21
v_lshlrev_b32 v20, 16, v197
v_and_b32 v21, s68, v197
v_mul_f32 v22, s66, v20
v_mul_f32 v23, s66, v21
v_exp_f32 v22, v22
v_exp_f32 v23, v23
s_nop 0
v_add_f32 v22, 1.0, v22
v_add_f32 v23, 1.0, v23
v_rcp_f32 v22, v22
v_rcp_f32 v23, v23
s_nop 0
v_mul_f32 v20, v20, v22
v_mul_f32 v21, v21, v23
v_cvt_pk_bf16_f32 v53, v20, v21
v_lshlrev_b32 v20, 16, v198
v_and_b32 v21, s68, v198
v_mul_f32 v22, s66, v20
v_mul_f32 v23, s66, v21
v_exp_f32 v22, v22
v_exp_f32 v23, v23
s_nop 0
v_add_f32 v22, 1.0, v22
v_add_f32 v23, 1.0, v23
v_rcp_f32 v22, v22
v_rcp_f32 v23, v23
s_nop 0
v_mul_f32 v20, v20, v22
v_mul_f32 v21, v21, v23
v_cvt_pk_bf16_f32 v54, v20, v21
v_lshlrev_b32 v20, 16, v199
v_and_b32 v21, s68, v199
v_mul_f32 v22, s66, v20
v_mul_f32 v23, s66, v21
v_exp_f32 v22, v22
v_exp_f32 v23, v23
s_nop 0
v_add_f32 v22, 1.0, v22
v_add_f32 v23, 1.0, v23
v_rcp_f32 v22, v22
v_rcp_f32 v23, v23
s_nop 0
v_mul_f32 v20, v20, v22
v_mul_f32 v21, v21, v23
v_cvt_pk_bf16_f32 v55, v20, v21
s_branch L_g2
L_gq1:
v_and_b32 v32, 7, v0
v_lshlrev_b32 v32, 2, v32
v_lshlrev_b32 v96, 16, v192
v_and_b32 v97, s68, v192
v_lshlrev_b32 v98, 16, v193
v_and_b32 v99, s68, v193
v_lshlrev_b32 v100, 16, v194
v_and_b32 v101, s68, v194
v_lshlrev_b32 v102, 16, v195
v_and_b32 v103, s68, v195
v_lshlrev_b32 v104, 16, v196
v_and_b32 v105, s68, v196
v_lshlrev_b32 v106, 16, v197
v_and_b32 v107, s68, v197
v_lshlrev_b32 v108, 16, v198
v_and_b32 v109, s68, v198
v_lshlrev_b32 v110, 16, v199
v_and_b32 v111, s68, v199
v_add_f32 v20, v96, v97
v_add_f32 v20, v20, v98
v_add_f32 v20, v20, v99
v_add_f32 v20, v20, v100
v_add_f32 v20, v20, v101
v_add_f32 v20, v20, v102
v_add_f32 v20, v20, v103
v_add_f32 v20, v20, v104
v_add_f32 v20, v20, v105
v_add_f32 v20, v20, v106
v_add_f32 v20, v20, v107
v_add_f32 v20, v20, v108
v_add_f32 v20, v20, v109
v_add_f32 v20, v20, v110
v_add_f32 v20, v20, v111
s_nop 1
v_add_f32_dpp v20, v20, v20 row_ror:8 row_mask:0xf bank_mask:0xf
v_mov_b32 v22, v20
s_nop 1
v_permlane16_swap_b32 v20, v22
s_nop 1
v_add_f32 v20, v20, v22
v_mov_b32 v22, v20
s_nop 1
v_permlane32_swap_b32 v20, v22
s_nop 1
v_add_f32 v20, v20, v22
v_mul_f32 v20, 0x3c000000, v20
v_mov_b32 v21, 0
v_sub_f32 v22, v96, v20
v_fmac_f32 v21, v22, v22
v_sub_f32 v22, v97, v20
v_fmac_f32 v21, v22, v22
v_sub_f32 v22, v98, v20
v_fmac_f32 v21, v22, v22
v_sub_f32 v22, v99, v20
v_fmac_f32 v21, v22, v22
v_sub_f32 v22, v100, v20
v_fmac_f32 v21, v22, v22
v_sub_f32 v22, v101, v20
v_fmac_f32 v21, v22, v22
v_sub_f32 v22, v102, v20
v_fmac_f32 v21, v22, v22
v_sub_f32 v22, v103, v20
v_fmac_f32 v21, v22, v22
v_sub_f32 v22, v104, v20
v_fmac_f32 v21, v22, v22
v_sub_f32 v22, v105, v20
v_fmac_f32 v21, v22, v22
v_sub_f32 v22, v106, v20
v_fmac_f32 v21, v22, v22
v_sub_f32 v22, v107, v20
v_fmac_f32 v21, v22, v22
v_sub_f32 v22, v108, v20
v_fmac_f32 v21, v22, v22
v_sub_f32 v22, v109, v20
v_fmac_f32 v21, v22, v22
v_sub_f32 v22, v110, v20
v_fmac_f32 v21, v22, v22
v_sub_f32 v22, v111, v20
v_fmac_f32 v21, v22, v22
s_nop 1
v_add_f32_dpp v21, v21, v21 row_ror:8 row_mask:0xf bank_mask:0xf
v_mov_b32 v22, v21
s_nop 1
v_permlane16_swap_b32 v21, v22
s_nop 1
v_add_f32 v21, v21, v22
v_mov_b32 v22, v21
s_nop 1
v_permlane32_swap_b32 v21, v22
s_nop 1
v_add_f32 v21, v21, v22
v_lshlrev_b32 v22, 1, v32
s_lshl_b32 s66, s34, 6
v_add_u32 v23, s66, v22
ds_write_b64 v23, v[20:21] offset:0
v_mov_b32 v23, 0
s_waitcnt lgkmcnt(0)
s_mov_b64 exec, 1
ds_add_u32 v23, v9 offset:332
s_mov_b64 exec, -1
s_mov_b32 s75, 0
L_poll_140:
ds_read_b32 v24, v23 offset:332
s_waitcnt lgkmcnt(0)
v_cmp_gt_u32 vcc, 4, v24
s_cbranch_vccz L_pollx_141
s_add_u32 s75, s75, 1
s_cmp_lt_u32 s75, 0x1000000
s_cbranch_scc1 L_poll_140
L_pollx_141:
ds_read_b64 v[112:113], v22 offset:0
ds_read_b64 v[114:115], v22 offset:64
ds_read_b64 v[116:117], v22 offset:128
ds_read_b64 v[118:119], v22 offset:192
s_waitcnt lgkmcnt(0)
v_add_f32 v20, v112, v114
v_add_f32 v21, v116, v118
v_add_f32 v20, v20, v21
v_mul_f32 v20, 0x3e800000, v20
v_add_f32 v24, v113, v115
v_add_f32 v21, v117, v119
v_add_f32 v24, v24, v21
v_mov_b32 v21, 0
v_sub_f32 v22, v112, v20
v_fmac_f32 v21, v22, v22
v_sub_f32 v22, v114, v20
v_fmac_f32 v21, v22, v22
v_sub_f32 v22, v116, v20
v_fmac_f32 v21, v22, v22
v_sub_f32 v22, v118, v20
v_fmac_f32 v21, v22, v22
v_fmac_f32 v24, 0x43000000, v21
v_mul_f32 v24, 0x3b000000, v24
v_cvt_pk_bf16_f32 v24, 0, v24
v_cvt_pk_bf16_f32 v20, 0, v20
v_add_f32 v24, 0x3727c5ac, v24
v_cvt_pk_bf16_f32 v24, 0, v24
v_sqrt_f32 v24, v24
s_nop 0
v_cvt_pk_bf16_f32 v24, 0, v24
v_rcp_f32 v24, v24
s_nop 0
v_sub_f32 v96, v96, v20
v_cvt_pk_bf16_f32 v96, 0, v96
v_mul_f32 v96, v96, v24
v_cvt_pk_bf16_f32 v96, 0, v96
v_sub_f32 v97, v97, v20
v_cvt_pk_bf16_f32 v97, 0, v97
v_mul_f32 v97, v97, v24
v_cvt_pk_bf16_f32 v97, 0, v97
v_sub_f32 v98, v98, v20
v_cvt_pk_bf16_f32 v98, 0, v98
v_mul_f32 v98, v98, v24
v_cvt_pk_bf16_f32 v98, 0, v98
v_sub_f32 v99, v99, v20
v_cvt_pk_bf16_f32 v99, 0, v99
v_mul_f32 v99, v99, v24
v_cvt_pk_bf16_f32 v99, 0, v99
v_sub_f32 v100, v100, v20
v_cvt_pk_bf16_f32 v100, 0, v100
v_mul_f32 v100, v100, v24
v_cvt_pk_bf16_f32 v100, 0, v100
v_sub_f32 v101, v101, v20
v_cvt_pk_bf16_f32 v101, 0, v101
v_mul_f32 v101, v101, v24
v_cvt_pk_bf16_f32 v101, 0, v101
v_sub_f32 v102, v102, v20
v_cvt_pk_bf16_f32 v102, 0, v102
v_mul_f32 v102, v102, v24
v_cvt_pk_bf16_f32 v102, 0, v102
v_sub_f32 v103, v103, v20
v_cvt_pk_bf16_f32 v103, 0, v103
v_mul_f32 v103, v103, v24
v_cvt_pk_bf16_f32 v103, 0, v103
v_sub_f32 v104, v104, v20
v_cvt_pk_bf16_f32 v104, 0, v104
v_mul_f32 v104, v104, v24
v_cvt_pk_bf16_f32 v104, 0, v104
v_sub_f32 v105, v105, v20
v_cvt_pk_bf16_f32 v105, 0, v105
v_mul_f32 v105, v105, v24
v_cvt_pk_bf16_f32 v105, 0, v105
v_sub_f32 v106, v106, v20
v_cvt_pk_bf16_f32 v106, 0, v106
v_mul_f32 v106, v106, v24
v_cvt_pk_bf16_f32 v106, 0, v106
v_sub_f32 v107, v107, v20
v_cvt_pk_bf16_f32 v107, 0, v107
v_mul_f32 v107, v107, v24
v_cvt_pk_bf16_f32 v107, 0, v107
v_sub_f32 v108, v108, v20
v_cvt_pk_bf16_f32 v108, 0, v108
v_mul_f32 v108, v108, v24
v_cvt_pk_bf16_f32 v108, 0, v108
v_sub_f32 v109, v109, v20
v_cvt_pk_bf16_f32 v109, 0, v109
v_mul_f32 v109, v109, v24
v_cvt_pk_bf16_f32 v109, 0, v109
v_sub_f32 v110, v110, v20
v_cvt_pk_bf16_f32 v110, 0, v110
v_mul_f32 v110, v110, v24
v_cvt_pk_bf16_f32 v110, 0, v110
v_sub_f32 v111, v111, v20
v_cvt_pk_bf16_f32 v111, 0, v111
v_mul_f32 v111, v111, v24
v_cvt_pk_bf16_f32 v111, 0, v111
L_g2:
s_cmp_ge_u32 s2, s73
s_cbranch_scc0 L_fl_142
s_waitcnt vmcnt(0)
v_cmp_eq_u32 vcc, 0, v31
s_cbranch_vccz L_fl_142
s_mov_b32 s75, 0
L_poll_143:
buffer_load_dword v31, v30, s[52:55], 0 offen sc1
s_waitcnt vmcnt(0)
v_cmp_eq_u32 vcc, 0, v31
s_cbranch_vccz L_pollx_144
s_sleep 40
s_add_u32 s75, s75, 1
s_cmp_lt_u32 s75, 0x100000
s_cbranch_scc1 L_poll_143
L_pollx_144:
L_fl_142:
v_mov_b32 v20, 0
s_cmp_eq_u32 s34, 0
s_cbranch_scc0 L_w_145
ds_write_b32 v20, v9 offset:324
L_w_145:
v_lshrrev_b32 v18, 4, v0
v_bfe_u32 v19, v0, 2, 2
v_lshrrev_b32 v20, 1, v19
v_and_b32 v21, 1, v18
v_lshl_add_u32 v20, v21, 1, v20
v_lshlrev_b32 v20, 5, v20
v_lshl_add_u32 v20, v18, 10, v20
v_lshl_add_u32 v20, v19, 7, v20
v_and_b32 v21, 3, v0
v_lshl_add_u32 v20, v21, 3, v20
v_add_u32 v40, s65, v20
v_xor_b32 v41, 32, v40
v_xor_b32 v42, 64, v40
v_xor_b32 v43, 96, v40
s_waitcnt vmcnt(12) lgkmcnt(0)
ds_read_b64_tr_b16 v[128:129], v40 offset:0
ds_read_b64_tr_b16 v[130:131], v40 offset:512
ds_read_b64_tr_b16 v[132:133], v41 offset:0
ds_read_b64_tr_b16 v[134:135], v41 offset:512
ds_read_b64_tr_b16 v[136:137], v42 offset:0
ds_read_b64_tr_b16 v[138:139], v42 offset:512
ds_read_b64_tr_b16 v[140:141], v43 offset:0
ds_read_b64_tr_b16 v[142:143], v43 offset:512
s_waitcnt vmcnt(8) lgkmcnt(0)
ds_read_b64_tr_b16 v[144:145], v40 offset:4096
ds_read_b64_tr_b16 v[146:147], v40 offset:4608
ds_read_b64_tr_b16 v[148:149], v41 offset:4096
ds_read_b64_tr_b16 v[150:151], v41 offset:4608
ds_read_b64_tr_b16 v[152:153], v42 offset:4096
ds_read_b64_tr_b16 v[154:155], v42 offset:4608
ds_read_b64_tr_b16 v[156:157], v43 offset:4096
ds_read_b64_tr_b16 v[158:159], v43 offset:4608
s_waitcnt vmcnt(4) lgkmcnt(0)
ds_read_b64_tr_b16 v[160:161], v40 offset:32768
ds_read_b64_tr_b16 v[162:163], v40 offset:33280
ds_read_b64_tr_b16 v[164:165], v41 offset:32768
ds_read_b64_tr_b16 v[166:167], v41 offset:33280
ds_read_b64_tr_b16 v[168:169], v42 offset:32768
ds_read_b64_tr_b16 v[170:171], v42 offset:33280
ds_read_b64_tr_b16 v[172:173], v43 offset:32768
ds_read_b64_tr_b16 v[174:175], v43 offset:33280
s_waitcnt vmcnt(0) lgkmcnt(0)
ds_read_b64_tr_b16 v[176:177], v40 offset:36864
ds_read_b64_tr_b16 v[178:179], v40 offset:37376
ds_read_b64_tr_b16 v[180:181], v41 offset:36864
ds_read_b64_tr_b16 v[182:183], v41 offset:37376
ds_read_b64_tr_b16 v[184:185], v42 offset:36864
ds_read_b64_tr_b16 v[186:187], v42 offset:37376
ds_read_b64_tr_b16 v[188:189], v43 offset:36864
ds_read_b64_tr_b16 v[190:191], v43 offset:37376
s_waitcnt lgkmcnt(0)
s_cmp_eq_u32 s34, 2
s_cselect_b32 s73, 16, 0x1000
v_and_b32 v30, 31, v0
v_lshlrev_b32 v30, 2, v30
s_cmp_ge_u32 s2, s73
s_cbranch_scc0 L_fl_146
buffer_load_dword v31, v30, s[52:55], 0 offen offset:128 sc1
L_fl_146:
s_cmp_lt_u32 s2, 48
s_cbranch_scc1 L_g3
v_mov_b32 v20, 0
s_mov_b32 s75, 0
L_poll_147:
ds_read_b32 v22, v20 offset:324
s_waitcnt lgkmcnt(0)
v_cmp_eq_u32 vcc, 0, v22
s_cbranch_vccz L_pollx_148
s_sleep 1
s_add_u32 s75, s75, 1
s_cmp_lt_u32 s75, 0x1000000
s_cbranch_scc1 L_poll_147
L_pollx_148:
s_lshl_b32 s64, s34, 11
s_add_u32 s64, s64, 0
s_add_u32 s66, s64, 8192
s_mov_b32 s75, 0
L_poll_149:
buffer_load_dwordx4 v[192:195], v1, s[36:39], s64 offen offset:0 sc1
buffer_load_dwordx4 v[200:203], v1, s[36:39], s66 offen offset:0 sc1
buffer_load_dwordx4 v[196:199], v1, s[36:39], s64 offen offset:1024 sc1
buffer_load_dwordx4 v[204:207], v1, s[36:39], s66 offen offset:1024 sc1
s_waitcnt vmcnt(0)
v_max3_u32 v22, v192, v193, v194
v_max3_u32 v22, v22, v195, v196
v_max3_u32 v22, v22, v197, v198
v_max3_u32 v22, v22, v199, v200
v_max3_u32 v22, v22, v201, v202
v_max3_u32 v22, v22, v203, v204
v_max3_u32 v22, v22, v205, v206
v_max_u32 v22, v22, v207
v_cmp_eq_u32 vcc, -1, v22
s_cbranch_vccz L_pollx_150
s_sleep 16
s_add_u32 s75, s75, 1
s_cmp_lt_u32 s75, 0x100000
s_cbranch_scc1 L_poll_149
L_pollx_150:
v_lshlrev_b32 v20, 16, v200
v_and_b32 v21, s68, v200
v_add_f32 v20, 1.0, v20
v_add_f32 v21, 1.0, v21
v_cvt_pk_bf16_f32 v20, 0, v20
v_cvt_pk_bf16_f32 v21, 0, v21
v_mul_f32 v20, v20, v96
v_mul_f32 v21, v21, v97
v_cvt_pk_bf16_f32 v20, 0, v20
v_cvt_pk_bf16_f32 v21, 0, v21
v_lshlrev_b32 v22, 16, v192
v_and_b32 v23, s68, v192
v_add_f32 v20, v20, v22
v_add_f32 v21, v21, v23
v_cvt_pk_bf16_f32 v48, v20, v21
v_lshlrev_b32 v20, 16, v201
v_and_b32 v21, s68, v201
v_add_f32 v20, 1.0, v20
v_add_f32 v21, 1.0, v21
v_cvt_pk_bf16_f32 v20, 0, v20
v_cvt_pk_bf16_f32 v21, 0, v21
v_mul_f32 v20, v20, v98
v_mul_f32 v21, v21, v99
v_cvt_pk_bf16_f32 v20, 0, v20
v_cvt_pk_bf16_f32 v21, 0, v21
v_lshlrev_b32 v22, 16, v193
v_and_b32 v23, s68, v193
v_add_f32 v20, v20, v22
v_add_f32 v21, v21, v23
v_cvt_pk_bf16_f32 v49, v20, v21
v_lshlrev_b32 v20, 16, v202
v_and_b32 v21, s68, v202
v_add_f32 v20, 1.0, v20
v_add_f32 v21, 1.0, v21
v_cvt_pk_bf16_f32 v20, 0, v20
v_cvt_pk_bf16_f32 v21, 0, v21
v_mul_f32 v20, v20, v100
v_mul_f32 v21, v21, v101
v_cvt_pk_bf16_f32 v20, 0, v20
v_cvt_pk_bf16_f32 v21, 0, v21
v_lshlrev_b32 v22, 16, v194
v_and_b32 v23, s68, v194
v_add_f32 v20, v20, v22
v_add_f32 v21, v21, v23
v_cvt_pk_bf16_f32 v50, v20, v21
v_lshlrev_b32 v20, 16, v203
v_and_b32 v21, s68, v203
v_add_f32 v20, 1.0, v20
v_add_f32 v21, 1.0, v21
v_cvt_pk_bf16_f32 v20, 0, v20
v_cvt_pk_bf16_f32 v21, 0, v21
v_mul_f32 v20, v20, v102
v_mul_f32 v21, v21, v103
v_cvt_pk_bf16_f32 v20, 0, v20
v_cvt_pk_bf16_f32 v21, 0, v21
v_lshlrev_b32 v22, 16, v195
v_and_b32 v23, s68, v195
v_add_f32 v20, v20, v22
v_add_f32 v21, v21, v23
v_cvt_pk_bf16_f32 v51, v20, v21
v_lshlrev_b32 v20, 16, v204
v_and_b32 v21, s68, v204
v_add_f32 v20, 1.0, v20
v_add_f32 v21, 1.0, v21
v_cvt_pk_bf16_f32 v20, 0, v20
v_cvt_pk_bf16_f32 v21, 0, v21
v_mul_f32 v20, v20, v104
v_mul_f32 v21, v21, v105
v_cvt_pk_bf16_f32 v20, 0, v20
v_cvt_pk_bf16_f32 v21, 0, v21
v_lshlrev_b32 v22, 16, v196
v_and_b32 v23, s68, v196
v_add_f32 v20, v20, v22
v_add_f32 v21, v21, v23
v_cvt_pk_bf16_f32 v52, v20, v21
v_lshlrev_b32 v20, 16, v205
v_and_b32 v21, s68, v205
v_add_f32 v20, 1.0, v20
v_add_f32 v21, 1.0, v21
v_cvt_pk_bf16_f32 v20, 0, v20
v_cvt_pk_bf16_f32 v21, 0, v21
v_mul_f32 v20, v20, v106
v_mul_f32 v21, v21, v107
v_cvt_pk_bf16_f32 v20, 0, v20
v_cvt_pk_bf16_f32 v21, 0, v21
v_lshlrev_b32 v22, 16, v197
v_and_b32 v23, s68, v197
v_add_f32 v20, v20, v22
v_add_f32 v21, v21, v23
v_cvt_pk_bf16_f32 v53, v20, v21
v_lshlrev_b32 v20, 16, v206
v_and_b32 v21, s68, v206
v_add_f32 v20, 1.0, v20
v_add_f32 v21, 1.0, v21
v_cvt_pk_bf16_f32 v20, 0, v20
v_cvt_pk_bf16_f32 v21, 0, v21
v_mul_f32 v20, v20, v108
v_mul_f32 v21, v21, v109
v_cvt_pk_bf16_f32 v20, 0, v20
v_cvt_pk_bf16_f32 v21, 0, v21
v_lshlrev_b32 v22, 16, v198
v_and_b32 v23, s68, v198
v_add_f32 v20, v20, v22
v_add_f32 v21, v21, v23
v_cvt_pk_bf16_f32 v54, v20, v21
v_lshlrev_b32 v20, 16, v207
v_and_b32 v21, s68, v207
v_add_f32 v20, 1.0, v20
v_add_f32 v21, 1.0, v21
v_cvt_pk_bf16_f32 v20, 0, v20
v_cvt_pk_bf16_f32 v21, 0, v21
v_mul_f32 v20, v20, v110
v_mul_f32 v21, v21, v111
v_cvt_pk_bf16_f32 v20, 0, v20
v_cvt_pk_bf16_f32 v21, 0, v21
v_lshlrev_b32 v22, 16, v199
v_and_b32 v23, s68, v199
v_add_f32 v20, v20, v22
v_add_f32 v21, v21, v23
v_cvt_pk_bf16_f32 v55, v20, v21
L_g3:
s_cmp_ge_u32 s2, s73
s_cbranch_scc0 L_fl_151
s_waitcnt vmcnt(0)
v_cmp_eq_u32 vcc, 0, v31
s_cbranch_vccz L_fl_151
s_mov_b32 s75, 0
L_poll_152:
buffer_load_dword v31, v30, s[52:55], 0 offen offset:128 sc1
s_waitcnt vmcnt(0)
v_cmp_eq_u32 vcc, 0, v31
s_cbranch_vccz L_pollx_153
s_sleep 40
s_add_u32 s75, s75, 1
s_cmp_lt_u32 s75, 0x100000
s_cbranch_scc1 L_poll_152
L_pollx_153:
L_fl_151:
s_nop 1
v_mfma_f32_16x16x32_bf16 v[64:67], v[128:131], v[48:51], 0
v_mfma_f32_16x16x32_bf16 v[68:71], v[132:135], v[48:51], 0
v_mfma_f32_16x16x32_bf16 v[72:75], v[136:139], v[48:51], 0
v_mfma_f32_16x16x32_bf16 v[76:79], v[140:143], v[48:51], 0
v_mfma_f32_16x16x32_bf16 v[80:83], v[144:147], v[48:51], 0
v_mfma_f32_16x16x32_bf16 v[84:87], v[148:151], v[48:51], 0
v_mfma_f32_16x16x32_bf16 v[88:91], v[152:155], v[48:51], 0
v_mfma_f32_16x16x32_bf16 v[92:95], v[156:159], v[48:51], 0
v_mfma_f32_16x16x32_bf16 v[64:67], v[160:163], v[52:55], v[64:67]
v_mfma_f32_16x16x32_bf16 v[68:71], v[164:167], v[52:55], v[68:71]
v_mfma_f32_16x16x32_bf16 v[72:75], v[168:171], v[52:55], v[72:75]
v_mfma_f32_16x16x32_bf16 v[76:79], v[172:175], v[52:55], v[76:79]
v_mfma_f32_16x16x32_bf16 v[80:83], v[176:179], v[52:55], v[80:83]
v_mfma_f32_16x16x32_bf16 v[84:87], v[180:183], v[52:55], v[84:87]
v_mfma_f32_16x16x32_bf16 v[88:91], v[184:187], v[52:55], v[88:91]
v_mfma_f32_16x16x32_bf16 v[92:95], v[188:191], v[52:55], v[92:95]
v_and_b32 v20, 7, v0
v_mul_u32_u24 v20, 272, v20
v_and_b32 v21, 8, v0
v_lshl_add_u32 v20, v21, 3, v20
v_and_b32 v21, 48, v0
v_add_u32 v20, v20, v21
s_mul_i32 s64, s34, 8192
s_add_u32 s64, s64, 4096
v_add_u32 v20, s64, v20
s_nop 7
v_add_f32_dpp v24, v80, v64 row_ror:8 row_mask:0xf bank_mask:0x3
v_add_f32_dpp v24, v68, v84 row_ror:8 row_mask:0xf bank_mask:0xc
v_add_f32_dpp v25, v81, v65 row_ror:8 row_mask:0xf bank_mask:0x3
v_add_f32_dpp v25, v69, v85 row_ror:8 row_mask:0xf bank_mask:0xc
v_add_f32_dpp v26, v82, v66 row_ror:8 row_mask:0xf bank_mask:0x3
v_add_f32_dpp v26, v70, v86 row_ror:8 row_mask:0xf bank_mask:0xc
v_add_f32_dpp v27, v83, v67 row_ror:8 row_mask:0xf bank_mask:0x3
v_add_f32_dpp v27, v71, v87 row_ror:8 row_mask:0xf bank_mask:0xc
ds_write_b128 v20, v[24:27] offset:0
v_add_f32_dpp v28, v88, v72 row_ror:8 row_mask:0xf bank_mask:0x3
v_add_f32_dpp v28, v76, v92 row_ror:8 row_mask:0xf bank_mask:0xc
v_add_f32_dpp v29, v89, v73 row_ror:8 row_mask:0xf bank_mask:0x3
v_add_f32_dpp v29, v77, v93 row_ror:8 row_mask:0xf bank_mask:0xc
v_add_f32_dpp v30, v90, v74 row_ror:8 row_mask:0xf bank_mask:0x3
v_add_f32_dpp v30, v78, v94 row_ror:8 row_mask:0xf bank_mask:0xc
v_add_f32_dpp v31, v91, v75 row_ror:8 row_mask:0xf bank_mask:0x3
v_add_f32_dpp v31, v79, v95 row_ror:8 row_mask:0xf bank_mask:0xc
ds_write_b128 v20, v[28:31] offset:128
v_mov_b32 v20, 0
s_waitcnt lgkmcnt(0)
s_mov_b64 exec, 1
ds_add_u32 v20, v9 offset:320
s_mov_b64 exec, -1
s_cmp_eq_u32 s34, 0
s_cbranch_scc0 L_waitq
s_cmp_lt_u32 s2, 16
s_cbranch_scc0 L_gq2
v_and_b32 v21, 7, v0
v_lshrrev_b32 v22, 4, v0
v_and_b32 v23, 8, v0
v_lshrrev_b32 v23, 1, v23
v_add_u32 v22, v22, v23
v_mov_b32 v23, v1
s_lshl_b32 s64, s72, 10
s_add_u32 s64, s64, 0
s_branch L_g4
L_gq2:
v_lshrrev_b32 v21, 3, v0
v_and_b32 v22, 7, v0
s_mov_b32 s64, 10240
s_cmp_lt_u32 s2, 48
s_cselect_b32 s64, 22528, s64
s_mov_b32 s65, 12288
v_mul_lo_u32 v23, s65, v21
v_lshl_add_u32 v23, v22, 4, v23
s_lshl_b32 s66, s72, 7
s_add_u32 s64, s64, s66
L_g4:
v_mul_u32_u24 v21, 272, v21
v_lshl_add_u32 v21, v22, 5, v21
v_add_u32 v21, 4096, v21
s_mov_b32 s75, 0
L_poll_154:
ds_read_b32 v22, v20 offset:320
s_waitcnt lgkmcnt(0)
v_cmp_gt_u32 vcc, 4, v22
s_cbranch_vccz L_pollx_155
s_add_u32 s75, s75, 1
s_cmp_lt_u32 s75, 0x1000000
s_cbranch_scc1 L_poll_154
L_pollx_155:
ds_read_b128 v[64:67], v21 offset:0
ds_read_b128 v[68:71], v21 offset:16
ds_read_b128 v[72:75], v21 offset:8192
ds_read_b128 v[76:79], v21 offset:8208
ds_read_b128 v[80:83], v21 offset:16384
ds_read_b128 v[84:87], v21 offset:16400
ds_read_b128 v[88:91], v21 offset:24576
ds_read_b128 v[92:95], v21 offset:24592
s_waitcnt lgkmcnt(0)
v_add_f32 v64, v64, v72
v_add_f32 v65, v65, v73
v_add_f32 v66, v66, v74
v_add_f32 v67, v67, v75
v_add_f32 v68, v68, v76
v_add_f32 v69, v69, v77
v_add_f32 v70, v70, v78
v_add_f32 v71, v71, v79
v_add_f32 v64, v64, v80
v_add_f32 v65, v65, v81
v_add_f32 v66, v66, v82
v_add_f32 v67, v67, v83
v_add_f32 v68, v68, v84
v_add_f32 v69, v69, v85
v_add_f32 v70, v70, v86
v_add_f32 v71, v71, v87
v_add_f32 v64, v64, v88
v_add_f32 v65, v65, v89
v_add_f32 v66, v66, v90
v_add_f32 v67, v67, v91
v_add_f32 v68, v68, v92
v_add_f32 v69, v69, v93
v_add_f32 v70, v70, v94
v_add_f32 v71, v71, v95
v_cvt_pk_bf16_f32 v24, v64, v65
v_cvt_pk_bf16_f32 v25, v66, v67
v_cvt_pk_bf16_f32 v26, v68, v69
v_cvt_pk_bf16_f32 v27, v70, v71
v_min_u32 v24, -2, v24
v_min_u32 v25, -2, v25
v_min_u32 v26, -2, v26
v_min_u32 v27, -2, v27
buffer_store_dwordx4 v[24:27], v23, s[36:39], s64 offen sc1
s_branch L_waitq
L_jan:
v_mov_b32 v4, -1
v_mov_b32 v5, -1
v_mov_b32 v6, -1
v_mov_b32 v7, -1
s_lshl_b32 s67, s64, 2
s_add_u32 s67, s67, s34
s_cmp_lt_u32 s67, 32
s_cselect_b32 s66, 0, 933888
s_mul_i32 s65, s67, 3072
s_add_u32 s65, s65, s66
s_add_u32 s65, s65, 16384
v_add_u32 v8, s65, v1
global_store_dwordx4 v8, v[4:7], s[30:31] offset:0 sc1
global_store_dwordx4 v8, v[4:7], s[30:31] offset:1024 sc1
global_store_dwordx4 v8, v[4:7], s[30:31] offset:2048 sc1
s_and_b32 s66, s67, 64
s_add_u32 s67, s67, s66
s_lshl_b32 s67, s67, 7
s_add_u32 s67, s67, 1343488
v_and_b32 v8, 8, v0
v_lshlrev_b32 v8, 10, v8
v_and_b32 v10, 0x70, v1
v_add3_u32 v8, v8, v10, s67
s_mov_b64 exec, 0xffff
global_store_dwordx4 v8, v[4:7], s[30:31] sc1
s_mov_b64 exec, 1
s_load_dword s68, s[30:31], 0x48000
s_and_b32 s65, s34, 1
s_lshl_b32 s66, s65, 13
s_xor_b32 s67, s67, s66
s_xor_b32 s66, s67, 0x2000
s_waitcnt vmcnt(0) lgkmcnt(0)
s_mov_b64 exec, -1
s_cmp_eq_u32 s34, 3
s_cbranch_scc1 L_p0_156
s_cmp_eq_u32 s34, 0
s_cselect_b32 s62, s24, s10
s_cselect_b32 s63, s25, s11
s_cmp_eq_u32 s34, 2
s_cselect_b32 s62, s12, s62
s_cselect_b32 s63, s13, s63
global_load_dword v12, v38, s[62:63]
global_load_dword v13, v39, s[62:63]
L_p0_156:
s_mov_b64 exec, 1
s_mov_b32 s70, 0
s_load_dword s68, s[30:31], s67
L_race_157:
s_getreg_b32 s69, hwreg(HW_REG_IB_STS, 8, 4)
s_add_u32 s70, s70, 1
s_cmp_eq_u32 s69, 0
s_cbranch_scc0 L_race_157
s_waitcnt lgkmcnt(0)
s_mov_b32 s71, 0
s_load_dword s68, s[30:31], s66
L_race_158:
s_getreg_b32 s69, hwreg(HW_REG_IB_STS, 8, 4)
s_add_u32 s71, s71, 1
s_cmp_eq_u32 s69, 0
s_cbranch_scc0 L_race_158
s_waitcnt lgkmcnt(0)
s_cmp_lt_u32 s71, s70
s_cselect_b32 s70, 1, 0
s_xor_b32 s70, s70, s65
s_getreg_b32 s69, hwreg(HW_REG_XCC_ID, 2, 1)
s_xor_b32 s70, s70, s69
s_lshl_b32 s69, s69, 14
s_lshl_b32 s70, s70, 8
s_add_u32 s70, s70, s69
s_add_u32 s70, s70, 1
v_mov_b32 v9, s70
s_lshl_b32 s65, s64, 2
v_mov_b32 v8, s65
ds_add_rtn_u32 v11, v2, v9 offset:320
s_waitcnt lgkmcnt(0)
v_add_u32 v11, v11, v9
v_and_b32 v10, 0xff, v11
v_cmp_eq_u32 vcc, 4, v10
s_cbranch_vccz L_j_159
global_store_dword v8, v11, s[28:29] offset:128 sc1
L_j_159:
s_mov_b64 exec, -1
s_branch L_nop0
L_norole:
s_cmp_eq_u32 s74, -1
s_cbranch_scc1 L_waitq
L_waitq:
s_cmp_eq_u32 s74, -1
s_cselect_b64 vcc, 0, -1
s_cmp_lt_u32 s2, 112
s_cselect_b64 vcc, -1, vcc
s_mov_b32 s44, s12
s_mov_b32 s45, s13
s_mov_b32 s46, 0x400000
s_mov_b32 s47, 0x20000
v_lshrrev_b32 v18, 4, v0
v_and_b32 v16, 15, v0
v_xor_b32 v16, v16, v18
v_xor_b32 v17, 4, v16
v_lshlrev_b32 v19, 10, v18
v_lshl_add_u32 v22, v16, 4, v19
v_lshl_add_u32 v23, v17, 4, v19
v_and_b32 v19, 1, v18
v_lshlrev_b32 v19, 10, v19
v_lshrrev_b32 v18, 1, v18
v_lshl_add_u32 v18, v18, 11, v19
v_lshl_add_u32 v16, v16, 4, v18
v_lshl_add_u32 v17, v17, 4, v18
v_lshrrev_b32 v18, 4, v0
v_bfe_u32 v19, v0, 2, 2
v_and_b32 v20, 2, v0
v_lshlrev_b32 v20, 2, v20
v_xor_b32 v20, v20, v19
v_and_b32 v21, 1, v18
v_lshlrev_b32 v21, 2, v21
v_xor_b32 v20, v20, v21
v_lshlrev_b32 v20, 4, v20
v_lshl_add_u32 v20, v18, 10, v20
v_lshl_add_u32 v20, v19, 8, v20
v_and_b32 v21, 1, v0
v_lshl_add_u32 v20, v21, 3, v20
s_lshl_b32 s65, s34, 13
s_add_u32 s65, s65, 8192
v_add_u32 v40, s65, v20
v_xor_b32 v41, 16, v40
v_xor_b32 v42, 32, v40
v_xor_b32 v43, 48, v40
v_xor_b32 v44, 64, v40
v_xor_b32 v45, 80, v40
v_xor_b32 v46, 96, v40
v_xor_b32 v47, 112, v40
s_lshl_b32 s64, s33, 17
s_lshl_b32 s66, s34, 8
s_add_u32 s64, s64, s66
s_mov_b32 s68, 0
s_lshl_b32 s66, s68, 10
s_add_u32 s64, s64, s66
s_add_u32 m0, s65, 0
s_xor_b32 s66, s64, 0
buffer_load_dwordx4 v16, s[44:47], s66 offen  lds
s_add_u32 m0, s65, 1024
s_xor_b32 s66, s64, 8192
buffer_load_dwordx4 v17, s[44:47], s66 offen  lds
s_add_u32 m0, s65, 2048
s_xor_b32 s66, s64, 16384
buffer_load_dwordx4 v16, s[44:47], s66 offen  lds
s_waitcnt vmcnt(2)
s_add_u32 m0, s65, 3072
s_xor_b32 s66, s64, 24576
buffer_load_dwordx4 v17, s[44:47], s66 offen  lds
s_waitcnt vmcnt(2)
s_add_u32 m0, s65, 32768
s_xor_b32 s66, s64, 4096
buffer_load_dwordx4 v16, s[44:47], s66 offen  lds
s_waitcnt vmcnt(2)
s_add_u32 m0, s65, 33792
s_xor_b32 s66, s64, 12288
buffer_load_dwordx4 v17, s[44:47], s66 offen  lds
s_waitcnt vmcnt(2)
ds_read_b64_tr_b16 v[128:129], v40 offset:0
ds_read_b64_tr_b16 v[136:137], v41 offset:0
ds_read_b64_tr_b16 v[144:145], v42 offset:0
ds_read_b64_tr_b16 v[152:153], v43 offset:0
ds_read_b64_tr_b16 v[160:161], v44 offset:0
ds_read_b64_tr_b16 v[168:169], v45 offset:0
ds_read_b64_tr_b16 v[176:177], v46 offset:0
ds_read_b64_tr_b16 v[184:185], v47 offset:0
s_add_u32 m0, s65, 34816
s_xor_b32 s66, s64, 20480
buffer_load_dwordx4 v16, s[44:47], s66 offen  lds
s_waitcnt vmcnt(2)
s_add_u32 m0, s65, 35840
s_xor_b32 s66, s64, 28672
buffer_load_dwordx4 v17, s[44:47], s66 offen  lds
s_waitcnt vmcnt(2)
s_waitcnt lgkmcnt(0)
s_add_u32 m0, s65, 0
s_xor_b32 s66, s64, 32768
buffer_load_dwordx4 v16, s[44:47], s66 offen  lds
s_waitcnt vmcnt(2)
s_add_u32 m0, s65, 1024
s_xor_b32 s66, s64, 40960
buffer_load_dwordx4 v17, s[44:47], s66 offen  lds
s_waitcnt vmcnt(2)
ds_read_b64_tr_b16 v[130:131], v40 offset:32768
ds_read_b64_tr_b16 v[138:139], v41 offset:32768
ds_read_b64_tr_b16 v[146:147], v42 offset:32768
ds_read_b64_tr_b16 v[154:155], v43 offset:32768
ds_read_b64_tr_b16 v[162:163], v44 offset:32768
ds_read_b64_tr_b16 v[170:171], v45 offset:32768
ds_read_b64_tr_b16 v[178:179], v46 offset:32768
ds_read_b64_tr_b16 v[186:187], v47 offset:32768
s_add_u32 m0, s65, 2048
s_xor_b32 s66, s64, 49152
buffer_load_dwordx4 v16, s[44:47], s66 offen  lds
s_waitcnt vmcnt(2)
s_add_u32 m0, s65, 3072
s_xor_b32 s66, s64, 57344
buffer_load_dwordx4 v17, s[44:47], s66 offen  lds
s_waitcnt vmcnt(2)
s_waitcnt lgkmcnt(0)
s_add_u32 m0, s65, 32768
s_xor_b32 s66, s64, 36864
buffer_load_dwordx4 v16, s[44:47], s66 offen  lds
s_waitcnt vmcnt(2)
s_add_u32 m0, s65, 33792
s_xor_b32 s66, s64, 45056
buffer_load_dwordx4 v17, s[44:47], s66 offen  lds
s_waitcnt vmcnt(2)
ds_read_b64_tr_b16 v[132:133], v40 offset:0
ds_read_b64_tr_b16 v[140:141], v41 offset:0
ds_read_b64_tr_b16 v[148:149], v42 offset:0
ds_read_b64_tr_b16 v[156:157], v43 offset:0
ds_read_b64_tr_b16 v[164:165], v44 offset:0
ds_read_b64_tr_b16 v[172:173], v45 offset:0
ds_read_b64_tr_b16 v[180:181], v46 offset:0
ds_read_b64_tr_b16 v[188:189], v47 offset:0
s_add_u32 m0, s65, 34816
s_xor_b32 s66, s64, 53248
buffer_load_dwordx4 v16, s[44:47], s66 offen  lds
s_waitcnt vmcnt(2)
s_add_u32 m0, s65, 35840
s_xor_b32 s66, s64, 61440
buffer_load_dwordx4 v17, s[44:47], s66 offen  lds
s_waitcnt vmcnt(2)
s_waitcnt lgkmcnt(0)
s_add_u32 m0, s65, 0
s_xor_b32 s66, s64, 65536
buffer_load_dwordx4 v16, s[44:47], s66 offen  lds
s_waitcnt vmcnt(2)
s_add_u32 m0, s65, 1024
s_xor_b32 s66, s64, 73728
buffer_load_dwordx4 v17, s[44:47], s66 offen  lds
s_waitcnt vmcnt(2)
ds_read_b64_tr_b16 v[134:135], v40 offset:32768
ds_read_b64_tr_b16 v[142:143], v41 offset:32768
ds_read_b64_tr_b16 v[150:151], v42 offset:32768
ds_read_b64_tr_b16 v[158:159], v43 offset:32768
ds_read_b64_tr_b16 v[166:167], v44 offset:32768
ds_read_b64_tr_b16 v[174:175], v45 offset:32768
ds_read_b64_tr_b16 v[182:183], v46 offset:32768
ds_read_b64_tr_b16 v[190:191], v47 offset:32768
s_add_u32 m0, s65, 2048
s_xor_b32 s66, s64, 81920
buffer_load_dwordx4 v16, s[44:47], s66 offen  lds
s_waitcnt vmcnt(2)
s_add_u32 m0, s65, 3072
s_xor_b32 s66, s64, 90112
buffer_load_dwordx4 v17, s[44:47], s66 offen  lds
s_waitcnt vmcnt(2)
s_waitcnt lgkmcnt(0)
s_add_u32 m0, s65, 32768
s_xor_b32 s66, s64, 69632
buffer_load_dwordx4 v16, s[44:47], s66 offen  lds
s_waitcnt vmcnt(2)
s_add_u32 m0, s65, 33792
s_xor_b32 s66, s64, 77824
buffer_load_dwordx4 v17, s[44:47], s66 offen  lds
s_waitcnt vmcnt(2)
ds_read_b64_tr_b16 v[192:193], v40 offset:0
ds_read_b64_tr_b16 v[200:201], v41 offset:0
ds_read_b64_tr_b16 v[208:209], v42 offset:0
ds_read_b64_tr_b16 v[216:217], v43 offset:0
ds_read_b64_tr_b16 v[224:225], v44 offset:0
ds_read_b64_tr_b16 v[232:233], v45 offset:0
ds_read_b64_tr_b16 v[240:241], v46 offset:0
ds_read_b64_tr_b16 v[248:249], v47 offset:0
s_add_u32 m0, s65, 34816
s_xor_b32 s66, s64, 86016
buffer_load_dwordx4 v16, s[44:47], s66 offen  lds
s_waitcnt vmcnt(2)
s_add_u32 m0, s65, 35840
s_xor_b32 s66, s64, 94208
buffer_load_dwordx4 v17, s[44:47], s66 offen  lds
s_waitcnt vmcnt(2)
s_waitcnt lgkmcnt(0)
s_add_u32 m0, s65, 0
s_xor_b32 s66, s64, 98304
buffer_load_dwordx4 v16, s[44:47], s66 offen  lds
s_waitcnt vmcnt(2)
s_add_u32 m0, s65, 1024
s_xor_b32 s66, s64, 106496
buffer_load_dwordx4 v17, s[44:47], s66 offen  lds
s_waitcnt vmcnt(2)
ds_read_b64_tr_b16 v[194:195], v40 offset:32768
ds_read_b64_tr_b16 v[202:203], v41 offset:32768
ds_read_b64_tr_b16 v[210:211], v42 offset:32768
ds_read_b64_tr_b16 v[218:219], v43 offset:32768
ds_read_b64_tr_b16 v[226:227], v44 offset:32768
ds_read_b64_tr_b16 v[234:235], v45 offset:32768
ds_read_b64_tr_b16 v[242:243], v46 offset:32768
ds_read_b64_tr_b16 v[250:251], v47 offset:32768
v_and_b32 v24, 127, v2
buffer_load_dword v25, v24, s[52:55], 0 offen offset:128
s_add_u32 m0, s65, 2048
s_xor_b32 s66, s64, 114688
buffer_load_dwordx4 v16, s[44:47], s66 offen  lds
s_waitcnt vmcnt(2)
s_add_u32 m0, s65, 3072
s_xor_b32 s66, s64, 122880
buffer_load_dwordx4 v17, s[44:47], s66 offen  lds
s_waitcnt vmcnt(2)
s_waitcnt lgkmcnt(0)
s_add_u32 m0, s65, 32768
s_xor_b32 s66, s64, 102400
buffer_load_dwordx4 v16, s[44:47], s66 offen  lds
s_waitcnt vmcnt(2)
s_add_u32 m0, s65, 33792
s_xor_b32 s66, s64, 110592
buffer_load_dwordx4 v17, s[44:47], s66 offen  lds
s_waitcnt vmcnt(2)
ds_read_b64_tr_b16 v[196:197], v40 offset:0
ds_read_b64_tr_b16 v[204:205], v41 offset:0
ds_read_b64_tr_b16 v[212:213], v42 offset:0
ds_read_b64_tr_b16 v[220:221], v43 offset:0
ds_read_b64_tr_b16 v[228:229], v44 offset:0
ds_read_b64_tr_b16 v[236:237], v45 offset:0
ds_read_b64_tr_b16 v[244:245], v46 offset:0
ds_read_b64_tr_b16 v[252:253], v47 offset:0
s_add_u32 m0, s65, 34816
s_xor_b32 s66, s64, 118784
buffer_load_dwordx4 v16, s[44:47], s66 offen  lds
s_waitcnt vmcnt(2)
s_add_u32 m0, s65, 35840
s_xor_b32 s66, s64, 126976
buffer_load_dwordx4 v17, s[44:47], s66 offen  lds
s_waitcnt vmcnt(0)
ds_read_b64_tr_b16 v[198:199], v40 offset:32768
ds_read_b64_tr_b16 v[206:207], v41 offset:32768
ds_read_b64_tr_b16 v[214:215], v42 offset:32768
ds_read_b64_tr_b16 v[222:223], v43 offset:32768
ds_read_b64_tr_b16 v[230:231], v44 offset:32768
ds_read_b64_tr_b16 v[238:239], v45 offset:32768
ds_read_b64_tr_b16 v[246:247], v46 offset:32768
ds_read_b64_tr_b16 v[254:255], v47 offset:32768
s_waitcnt lgkmcnt(0)
v_cmp_eq_u32 vcc, 0, v25
s_cbranch_vccz L_tab_160
s_mov_b32 s75, 0
L_poll_161:
buffer_load_dword v25, v24, s[52:55], 0 offen offset:128 sc1
s_waitcnt vmcnt(0)
v_cmp_eq_u32 vcc, 0, v25
s_cbranch_vccz L_pollx_162
s_sleep 40
s_add_u32 s75, s75, 1
s_cmp_lt_u32 s75, 0x100000
s_cbranch_scc1 L_poll_161
L_pollx_162:
L_tab_160:
v_bfe_u32 v26, v25, 8, 3
v_lshrrev_b32 v25, 16, v25
s_nop 0
v_add_u32_dpp v26, v26, v26 quad_perm:[1,0,3,2] row_mask:0xf bank_mask:0xf
s_nop 1
v_add_u32_dpp v26, v26, v26 quad_perm:[2,3,0,1] row_mask:0xf bank_mask:0xf
s_nop 1
v_add_u32_dpp v26, v26, v26 row_ror:4 row_mask:0xf bank_mask:0xf
s_nop 1
v_add_u32_dpp v26, v26, v26 row_ror:8 row_mask:0xf bank_mask:0xf
s_nop 1
v_readlane_b32 s66, v26, 0
v_readlane_b32 s71, v26, 16
s_add_u32 s66, s66, s71
s_cmp_gt_u32 s66, 64
s_cselect_b32 s66, 1, 0
v_cmp_ne_u32 vcc, s66, v25
s_and_b32 s71, vcc_lo, 0xff
s_bcnt0_i32_b32 s66, s71
s_sub_u32 s66, s66, 24
v_mbcnt_lo_u32_b32 v24, s71, 0
v_sub_u32 v25, v0, v24
v_add_u32 v24, s66, v24
v_cndmask_b32 v24, v25, v24, vcc
v_bfe_u32 v25, v24, 1, 2
v_and_b32 v26, 1, v24
v_lshl_or_b32 v25, v26, 2, v25
v_lshlrev_b32 v25, v2, v25
s_nop 1
v_or_b32_dpp v25, v25, v25 quad_perm:[1,0,3,2] row_mask:0xf bank_mask:0xf
s_nop 1
v_or_b32_dpp v25, v25, v25 quad_perm:[2,3,0,1] row_mask:0xf bank_mask:0xf
s_nop 1
v_or_b32_dpp v25, v25, v25 row_shl:4 row_mask:0xf bank_mask:0xf
s_nop 1
v_readfirstlane_b32 s35, v25
s_mov_b64 exec, 1
ds_write_b32 v2, v25 offset:328
s_mov_b64 exec, -1
s_sub_u32 s64, s2, 144
s_cmp_lt_u32 s64, 64
s_cbranch_scc0 L_rp_163
s_cmp_eq_u32 s34, 0
s_cbranch_scc0 L_rp_163
s_mov_b32 s48, s4
s_mov_b32 s49, s5
s_mov_b32 s50, 0x2000
s_mov_b32 s51, 0x20000
v_and_b32 v5, 15, v0
v_and_b32 v6, 16, v0
v_lshl_add_u32 v5, v6, 1, v5
v_and_b32 v6, 32, v0
v_lshrrev_b32 v6, 1, v6
v_add_u32 v5, v5, v6
v_lshlrev_b32 v5, 1, v5
v_and_b32 v6, 0x7c, v5
s_lshl_b32 s65, s64, 7
s_and_b32 s66, s65, 0x380
s_lshr_b32 s64, s64, 3
s_mul_i32 s64, s64, 12288
s_add_u32 s64, s64, s66
s_add_u32 s64, s64, 24576
buffer_load_ushort v18, v5, s[48:51], s65 offen
s_mov_b32 s75, 0
L_poll_164:
buffer_load_dword v19, v6, s[36:39], s64 offen offset:0 sc1
buffer_load_dword v20, v6, s[36:39], s64 offen offset:3072 sc1
s_waitcnt vmcnt(0)
v_max_u32 v16, v19, v20
v_cmp_eq_u32 vcc, -1, v16
s_cbranch_vccz L_pollx_165
s_sleep 40
s_add_u32 s75, s75, 1
s_cmp_lt_u32 s75, 0x100000
s_cbranch_scc1 L_poll_164
L_pollx_165:
v_and_b32 v16, 1, v0
v_lshlrev_b32 v16, 4, v16
v_xor_b32 v16, 16, v16
v_lshlrev_b32 v18, 16, v18
v_lshlrev_b32 v19, v16, v19
v_and_b32 v19, 0xffff0000, v19
v_lshlrev_b32 v20, v16, v20
v_and_b32 v20, 0xffff0000, v20
ds_write_b32 v2, v18 offset:4096
ds_write_b32 v2, v19 offset:4352
ds_write_b32 v2, v20 offset:4608
L_rp_163:
v_lshlrev_b32 v10, 3, v0
s_lshl_b32 s64, s34, 8
s_add_u32 s64, s64, 2560
s_lshr_b32 s66, s68, 1
v_xor_b32 v12, s66, v0
v_mov_b32 v14, 0
v_bfe_u32 v11, v12, 0, 1
v_lshl_or_b32 v14, v11, 0, v14
v_bfe_u32 v11, v12, 1, 1
v_lshl_or_b32 v14, v11, 1, v14
v_bfe_u32 v11, v12, 2, 1
v_lshl_or_b32 v14, v11, 2, v14
v_bfe_u32 v11, v12, 3, 1
v_lshl_or_b32 v14, v11, 3, v14
v_bfe_u32 v11, v12, 4, 1
v_lshl_or_b32 v14, v11, 4, v14
v_bfe_u32 v11, v12, 5, 1
v_lshl_or_b32 v14, v11, 5, v14
v_and_b32 v11, 0x38, v14
v_and_b32 v12, 1, v14
v_lshl_add_u32 v11, v12, 2, v11
v_bfe_u32 v12, v14, 1, 2
v_add_u32 v11, v11, v12
v_lshl_add_u32 v11, v11, 2, s64
v_and_b32 v14, 1, v0
v_and_b32 v12, 48, v0
v_lshlrev_b32 v12, 1, v12
v_lshl_add_u32 v12, v14, 4, v12
v_add_u32 v12, s64, v12
v_mul_u32_u24 v15, 0xaaaa, v14
v_add_u32 v15, 0x4444, v15
v_mov_b32 v64, 0
v_mov_b32 v65, 0
v_mov_b32 v66, 0
v_mov_b32 v67, 0
v_mov_b32 v68, 0
v_mov_b32 v69, 0
v_mov_b32 v70, 0
v_mov_b32 v71, 0
v_mov_b32 v72, 0
v_mov_b32 v73, 0
v_mov_b32 v74, 0
v_mov_b32 v75, 0
v_mov_b32 v76, 0
v_mov_b32 v77, 0
v_mov_b32 v78, 0
v_mov_b32 v79, 0
v_mov_b32 v80, 0
v_mov_b32 v81, 0
v_mov_b32 v82, 0
v_mov_b32 v83, 0
v_mov_b32 v84, 0
v_mov_b32 v85, 0
v_mov_b32 v86, 0
v_mov_b32 v87, 0
v_mov_b32 v88, 0
v_mov_b32 v89, 0
v_mov_b32 v90, 0
v_mov_b32 v91, 0
v_mov_b32 v92, 0
v_mov_b32 v93, 0
v_mov_b32 v94, 0
v_mov_b32 v95, 0
s_lshl_b32 s64, s34, 3
s_lshr_b32 s64, s35, s64
v_bfe_u32 v13, v0, 3, 1
v_lshlrev_b32 v13, 2, v13
v_bfe_u32 v13, s64, v13, 3
v_and_b32 v14, 0x70, v1
v_lshl_add_u32 v13, v13, 12, v14
s_lshl_b32 s64, s34, 2
s_add_u32 s64, s64, s33
v_bfe_u32 v14, v0, 3, 1
v_lshl_add_u32 v14, v14, 1, s64
v_and_b32 v14, 31, v14
v_lshl_add_u32 v13, v14, 7, v13
s_lshl_b32 s69, s32, 15
s_add_u32 s69, s69, 1048576
s_waitcnt vmcnt(0) lgkmcnt(0)
s_barrier
ds_read_b64 v[20:21], v10 offset:512
ds_read_b64 v[22:23], v10 offset:1024
ds_read_b64 v[24:25], v10 offset:1536
ds_read_b64 v[26:27], v10 offset:2048
s_waitcnt lgkmcnt(2)
v_pk_add_f32 v[20:21], v[20:21], v[22:23]
s_waitcnt lgkmcnt(1)
v_pk_add_f32 v[20:21], v[20:21], v[24:25]
s_waitcnt lgkmcnt(0)
v_pk_add_f32 v[20:21], v[20:21], v[26:27]
v_cvt_pk_bf16_f32 v20, v20, v21
ds_write_b32 v11, v20
ds_read_b128 v[48:51], v12 offset:0
ds_read_b128 v[52:55], v12 offset:128
s_waitcnt lgkmcnt(1)
v_smfmac_f32_16x16x64_bf16 v[64:67], v[48:51], v[128:135], v15
v_smfmac_f32_16x16x64_bf16 v[68:71], v[48:51], v[136:143], v15
v_smfmac_f32_16x16x64_bf16 v[72:75], v[48:51], v[144:151], v15
v_smfmac_f32_16x16x64_bf16 v[76:79], v[48:51], v[152:159], v15
s_waitcnt lgkmcnt(0)
v_smfmac_f32_16x16x64_bf16 v[64:67], v[52:55], v[192:199], v15
v_smfmac_f32_16x16x64_bf16 v[68:71], v[52:55], v[200:207], v15
v_smfmac_f32_16x16x64_bf16 v[72:75], v[52:55], v[208:215], v15
v_smfmac_f32_16x16x64_bf16 v[76:79], v[52:55], v[216:223], v15
v_smfmac_f32_16x16x64_bf16 v[80:83], v[48:51], v[160:167], v15
v_smfmac_f32_16x16x64_bf16 v[84:87], v[48:51], v[168:175], v15
v_smfmac_f32_16x16x64_bf16 v[88:91], v[48:51], v[176:183], v15
v_smfmac_f32_16x16x64_bf16 v[92:95], v[48:51], v[184:191], v15
v_smfmac_f32_16x16x64_bf16 v[80:83], v[52:55], v[224:231], v15
v_add_f32 v64, v64, v65
v_smfmac_f32_16x16x64_bf16 v[84:87], v[52:55], v[232:239], v15
v_add_f32 v68, v68, v69
v_add_f32 v72, v72, v73
v_smfmac_f32_16x16x64_bf16 v[88:91], v[52:55], v[240:247], v15
v_add_f32 v76, v76, v77
v_cvt_pk_bf16_f32 v20, v64, v68
v_smfmac_f32_16x16x64_bf16 v[92:95], v[52:55], v[248:255], v15
v_cvt_pk_bf16_f32 v21, v72, v76
v_add_f32 v80, v80, v81
s_mov_b64 exec, 0xffff
v_add_f32 v84, v84, v85
v_cvt_pk_bf16_f32 v22, v80, v84
s_nop 0
v_add_f32 v88, v88, v89
s_nop 0
v_add_f32 v92, v92, v93
v_cvt_pk_bf16_f32 v23, v88, v92
buffer_store_dwordx4 v[20:23], v13, s[36:39], s69 offen sc1
s_mov_b64 exec, -1
s_sub_u32 s67, s2, 16
s_cmp_lt_u32 s67, 128
s_cbranch_scc0 L_nogp
s_and_b32 s66, s2, 7
s_min_u32 s64, s66, 3
s_mul_i32 s71, s66, 5
s_add_u32 s64, s64, s71
s_cmp_lt_u32 s66, 3
s_cselect_b32 s66, 5, 4
v_and_b32 v8, 7, v0
v_min_u32 v8, s66, v8
v_add_u32 v8, s64, v8
s_and_b32 s64, s67, 0xf8
s_lshl_b32 s64, s64, 2
s_lshl_b32 s66, s34, 3
s_add_u32 s64, s64, s66
v_lshrrev_b32 v9, 3, v0
v_add_u32 v9, s64, v9
v_mul_u32_u24 v9, 2752, v9
v_lshl_add_u32 v8, v8, 6, v9
global_load_dword v10, v8, s[16:17]
global_load_dword v11, v8, s[18:19]
s_and_b32 s66, s2, 7
s_min_u32 s70, s66, 3
s_mul_i32 s71, s66, 5
s_add_u32 s70, s70, s71
s_cmp_lt_u32 s66, 3
s_cselect_b32 s66, 6, 5
s_lshl_b32 s66, s66, 8
s_sub_u32 s66, s66, 1
s_lshr_b32 s71, s67, 3
s_lshl_b32 s71, s71, 2
s_add_u32 s71, s71, s34
s_mul_i32 s71, s71, 24
v_min_u32 v12, 23, v0
v_add_u32 v12, s71, v12
v_min_u32 v12, s66, v12
s_lshl_b32 s70, s70, 15
v_lshl_add_u32 v12, v12, 7, s70
global_load_dword v13, v12, s[20:21]
s_endpgm
L_nogp:
L_tail_s:
s_cmp_eq_u32 s74, -1
s_cbranch_scc0 L_ffn
s_cmp_eq_u32 s3, 0
s_cbranch_scc0 L_fin
s_sub_u32 s70, s2, 144
s_cmp_lt_u32 s70, 64
s_cbranch_scc0 L_fin
s_lshl_b32 s64, s70, 2
s_lshr_b32 s67, s35, s64
s_and_b32 s71, s67, 7
s_andn2_b32 s66, s70, 7
s_add_u32 s66, s66, s71
s_lshl_b32 s66, s66, 12
s_add_u32 s66, s66, 1048576
buffer_load_dwordx4 v[16:19], v1, s[36:39], s66 offen offset:0 sc1
buffer_load_dwordx4 v[20:23], v1, s[36:39], s66 offen offset:1024 sc1
buffer_load_dwordx4 v[24:27], v1, s[36:39], s66 offen offset:2048 sc1
buffer_load_dwordx4 v[28:31], v1, s[36:39], s66 offen offset:3072 sc1
v_mov_b32 v32, -1
v_mov_b32 v33, -1
v_mov_b32 v34, -1
v_mov_b32 v35, -1
s_and_b32 s64, s71, 6
s_lshl_b32 s64, s64, 12
s_and_b32 s65, s71, 1
s_lshl_b32 s65, s65, 15
s_or_b32 s64, s64, s65
s_lshr_b32 s65, s70, 3
s_lshl_b32 s65, s65, 16
s_add_u32 s64, s64, s65
s_lshr_b32 s65, s70, 4
s_lshl_b32 s65, s65, 2
s_and_b32 s67, s70, 7
s_add_u32 s65, s65, s67
s_lshl_b32 s65, s65, 7
s_add_u32 s64, s64, s65
s_add_u32 s64, s64, 1376256
s_add_u32 s65, s64, 4096
buffer_store_dwordx4 v[32:35], v1, s[36:39], s64 offen offset:0 sc1
buffer_store_dwordx4 v[32:35], v1, s[36:39], s64 offen offset:1024 sc1
buffer_store_dwordx4 v[32:35], v1, s[36:39], s64 offen offset:2048 sc1
buffer_store_dwordx4 v[32:35], v1, s[36:39], s64 offen offset:3072 sc1
buffer_store_dwordx4 v[32:35], v1, s[36:39], s65 offen offset:0 sc1
s_mov_b64 exec, 0xffffff
buffer_store_dwordx4 v[32:35], v1, s[36:39], s65 offen offset:1024 sc1
s_mov_b64 exec, -1
v_lshlrev_b32 v2, 2, v0
ds_read_b32 v8, v2 offset:4096
ds_read_b32 v9, v2 offset:4352
ds_read_b32 v10, v2 offset:4608
s_mov_b32 s56, s26
s_mov_b32 s57, s27
s_mov_b32 s58, 0x2000
s_mov_b32 s59, 0x20000
v_and_b32 v5, 15, v0
v_and_b32 v6, 16, v0
v_lshl_add_u32 v5, v6, 1, v5
v_and_b32 v6, 32, v0
v_lshrrev_b32 v6, 1, v6
v_add_u32 v5, v5, v6
v_lshlrev_b32 v5, 1, v5
v_and_b32 v6, 0x7c, v5
s_lshl_b32 s73, s70, 7
v_and_b32 v11, 1, v0
v_lshlrev_b32 v3, 4, v11
v_mov_b32 v7, 0x3f80
v_lshlrev_b32 v7, v3, v7
v_and_b32 v2, 4, v0
v_cmp_eq_u32 vcc, 0, v2
v_bfe_u32 v2, v0, 1, 1
v_mul_u32_u24 v43, 0xaaaa, v2
v_add_u32 v43, 0x4444, v43
v_cndmask_b32 v44, 0, v7, vcc
v_sub_u32 v45, v7, v44
v_mov_b32 v46, v44
v_mov_b32 v47, v45
v_mov_b32 v48, 0
v_mov_b32 v49, 0
v_mov_b32 v50, 0
v_mov_b32 v51, 0
v_mov_b32 v52, 0
v_mov_b32 v53, 0
v_mov_b32 v54, 0
v_mov_b32 v55, 0
s_add_u32 s68, s73, 1310720
s_mov_b32 s76, 0xaaaaaaaa
s_mov_b32 s77, 0xaaaaaaaa
v_cmp_gt_u32 vcc, 24, v0
v_mov_b32 v41, 0x40000000
v_lshl_add_u32 v12, v11, 13, v6
v_cndmask_b32 v41, v41, v1, vcc
s_mov_b32 s75, 0
s_waitcnt vmcnt(0) lgkmcnt(0)
buffer_load_dwordx4 v[16:19], v1, s[36:39], s66 offen offset:0 sc1
buffer_load_dwordx4 v[20:23], v1, s[36:39], s66 offen offset:1024 sc1
buffer_load_dwordx4 v[24:27], v1, s[36:39], s66 offen offset:2048 sc1
buffer_load_dwordx4 v[28:31], v1, s[36:39], s66 offen offset:3072 sc1
s_sleep 1
buffer_load_dwordx4 v[16:19], v1, s[36:39], s66 offen offset:0 sc1
buffer_load_dwordx4 v[20:23], v1, s[36:39], s66 offen offset:1024 sc1
buffer_load_dwordx4 v[24:27], v1, s[36:39], s66 offen offset:2048 sc1
buffer_load_dwordx4 v[28:31], v1, s[36:39], s66 offen offset:3072 sc1
s_sleep 1
buffer_load_dwordx4 v[16:19], v1, s[36:39], s66 offen offset:0 sc1
buffer_load_dwordx4 v[20:23], v1, s[36:39], s66 offen offset:1024 sc1
buffer_load_dwordx4 v[24:27], v1, s[36:39], s66 offen offset:2048 sc1
buffer_load_dwordx4 v[28:31], v1, s[36:39], s66 offen offset:3072 sc1
s_sleep 1
L_rn_168:
v_smfmac_f32_16x16x64_bf16 v[48:51], v[44:47], v[16:23], v43
v_smfmac_f32_16x16x64_bf16 v[48:51], v[44:47], v[24:31], v43
buffer_load_dwordx4 v[16:19], v1, s[36:39], s66 offen offset:0 sc1
buffer_load_dwordx4 v[20:23], v1, s[36:39], s66 offen offset:1024 sc1
buffer_load_dwordx4 v[24:27], v1, s[36:39], s66 offen offset:2048 sc1
buffer_load_dwordx4 v[28:31], v1, s[36:39], s66 offen offset:3072 sc1
s_add_u32 s75, s75, 1
s_and_b32 s78, s75, 15
s_nop 1
v_add_f32_dpp v13, v48, v48 row_ror:8 row_mask:0x3 bank_mask:0x3
v_add_f32_dpp v13, v49, v49 row_ror:8 row_mask:0x3 bank_mask:0xc
v_add_f32_dpp v13, v50, v50 row_ror:8 row_mask:0xc bank_mask:0x3
v_add_f32_dpp v13, v51, v51 row_ror:8 row_mask:0xc bank_mask:0xc
v_cmp_u_f32 vcc, v13, v13
s_cbranch_vccz L_rz_169
v_mov_b32 v48, 0
v_mov_b32 v49, 0
v_mov_b32 v50, 0
v_mov_b32 v51, 0
s_waitcnt vmcnt(12)
s_cbranch_scc1 L_rn_168
v_max3_u32 v2, v16, v17, v18
v_max3_u32 v2, v2, v19, v20
v_max3_u32 v2, v2, v21, v22
v_max3_u32 v2, v2, v23, v24
v_max3_u32 v2, v2, v25, v26
v_max3_u32 v2, v2, v27, v28
v_max3_u32 v2, v2, v29, v30
v_max_u32 v2, v2, v31
v_cmp_eq_u32 vcc, -1, v2
s_cbranch_vccz L_rx_167
s_cmp_lt_u32 s75, 0x100000
s_cbranch_scc1 L_rn_168
L_rx_167:
v_smfmac_f32_16x16x64_bf16 v[48:51], v[44:47], v[16:23], v43
v_smfmac_f32_16x16x64_bf16 v[48:51], v[44:47], v[24:31], v43
s_nop 7
v_add_f32_dpp v13, v48, v48 row_ror:8 row_mask:0x3 bank_mask:0x3
v_add_f32_dpp v13, v49, v49 row_ror:8 row_mask:0x3 bank_mask:0xc
v_add_f32_dpp v13, v50, v50 row_ror:8 row_mask:0xc bank_mask:0x3
v_add_f32_dpp v13, v51, v51 row_ror:8 row_mask:0xc bank_mask:0xc
L_rz_169:
v_fmac_f32 v8, v13, v9
s_nop 1
v_mov_b32_dpp v14, v8 quad_perm:[1,1,3,3] row_mask:0xf bank_mask:0xf
v_mov_b32_dpp v13, v8 quad_perm:[0,0,2,2] row_mask:0xf bank_mask:0xf
v_cvt_pk_bf16_f32 v13, v13, v14
buffer_store_dword v13, v12, s[36:39], s68 offen sc1
v_cvt_pk_bf16_f32 v8, 0, v8
buffer_load_dwordx4 v[64:67], v1, s[36:39], s64 offen offset:0 sc1
buffer_load_dwordx4 v[68:71], v1, s[36:39], s64 offen offset:1024 sc1
buffer_load_dwordx4 v[72:75], v1, s[36:39], s64 offen offset:2048 sc1
buffer_load_dwordx4 v[76:79], v1, s[36:39], s64 offen offset:3072 sc1
buffer_load_dwordx4 v[80:83], v1, s[36:39], s65 offen offset:0 sc1
buffer_load_dwordx4 v[84:87], v41, s[36:39], s65 offen offset:1024 sc1
s_mov_b32 s75, 0
s_waitcnt vmcnt(0)
buffer_load_dwordx4 v[64:67], v1, s[36:39], s64 offen offset:0 sc1
buffer_load_dwordx4 v[68:71], v1, s[36:39], s64 offen offset:1024 sc1
buffer_load_dwordx4 v[72:75], v1, s[36:39], s64 offen offset:2048 sc1
buffer_load_dwordx4 v[76:79], v1, s[36:39], s64 offen offset:3072 sc1
buffer_load_dwordx4 v[80:83], v1, s[36:39], s65 offen offset:0 sc1
buffer_load_dwordx4 v[84:87], v41, s[36:39], s65 offen offset:1024 sc1
s_sleep 1
buffer_load_dwordx4 v[64:67], v1, s[36:39], s64 offen offset:0 sc1
buffer_load_dwordx4 v[68:71], v1, s[36:39], s64 offen offset:1024 sc1
buffer_load_dwordx4 v[72:75], v1, s[36:39], s64 offen offset:2048 sc1
buffer_load_dwordx4 v[76:79], v1, s[36:39], s64 offen offset:3072 sc1
buffer_load_dwordx4 v[80:83], v1, s[36:39], s65 offen offset:0 sc1
buffer_load_dwordx4 v[84:87], v41, s[36:39], s65 offen offset:1024 sc1
s_sleep 1
L_rn_172:
v_smfmac_f32_16x16x64_bf16 v[52:55], v[44:47], v[64:71], v43
v_smfmac_f32_16x16x64_bf16 v[52:55], v[44:47], v[72:79], v43
v_smfmac_f32_16x16x64_bf16 v[52:55], v[44:47], v[80:87], v43
buffer_load_dwordx4 v[64:67], v1, s[36:39], s64 offen offset:0 sc1
buffer_load_dwordx4 v[68:71], v1, s[36:39], s64 offen offset:1024 sc1
buffer_load_dwordx4 v[72:75], v1, s[36:39], s64 offen offset:2048 sc1
buffer_load_dwordx4 v[76:79], v1, s[36:39], s64 offen offset:3072 sc1
buffer_load_dwordx4 v[80:83], v1, s[36:39], s65 offen offset:0 sc1
buffer_load_dwordx4 v[84:87], v41, s[36:39], s65 offen offset:1024 sc1
s_add_u32 s75, s75, 1
s_and_b32 s78, s75, 15
v_add_f32_dpp v13, v52, v52 row_ror:8 row_mask:0x3 bank_mask:0x3
v_add_f32_dpp v13, v53, v53 row_ror:8 row_mask:0x3 bank_mask:0xc
v_add_f32_dpp v13, v54, v54 row_ror:8 row_mask:0xc bank_mask:0x3
v_add_f32_dpp v13, v55, v55 row_ror:8 row_mask:0xc bank_mask:0xc
v_cmp_u_f32 vcc, v13, v13
s_cbranch_vccz L_rz_173
v_mov_b32 v52, 0
v_mov_b32 v53, 0
v_mov_b32 v54, 0
v_mov_b32 v55, 0
s_waitcnt vmcnt(12)
s_cbranch_scc1 L_rn_172
v_max3_u32 v2, v64, v65, v66
v_max3_u32 v2, v2, v67, v68
v_max3_u32 v2, v2, v69, v70
v_max3_u32 v2, v2, v71, v72
v_max3_u32 v2, v2, v73, v74
v_max3_u32 v2, v2, v75, v76
v_max3_u32 v2, v2, v77, v78
v_max3_u32 v2, v2, v79, v80
v_max3_u32 v2, v2, v81, v82
v_max3_u32 v2, v2, v83, v84
v_max3_u32 v2, v2, v85, v86
v_max_u32 v2, v2, v87
v_cmp_eq_u32 vcc, -1, v2
s_cbranch_vccz L_rx_171
s_cmp_lt_u32 s75, 0x100000
s_cbranch_scc1 L_rn_172
L_rx_171:
v_smfmac_f32_16x16x64_bf16 v[52:55], v[44:47], v[64:71], v43
v_smfmac_f32_16x16x64_bf16 v[52:55], v[44:47], v[72:79], v43
v_smfmac_f32_16x16x64_bf16 v[52:55], v[44:47], v[80:87], v43
s_nop 7
v_add_f32_dpp v13, v52, v52 row_ror:8 row_mask:0x3 bank_mask:0x3
v_add_f32_dpp v13, v53, v53 row_ror:8 row_mask:0x3 bank_mask:0xc
v_add_f32_dpp v13, v54, v54 row_ror:8 row_mask:0xc bank_mask:0x3
v_add_f32_dpp v13, v55, v55 row_ror:8 row_mask:0xc bank_mask:0xc
L_rz_173:
v_fmac_f32 v8, v13, v10
s_nop 1
v_mov_b32_dpp v14, v8 quad_perm:[1,1,3,3] row_mask:0xf bank_mask:0xf
s_not_b64 exec, s[76:77]
v_cvt_pk_bf16_f32 v13, v8, v14
buffer_store_dword v13, v6, s[56:59], s73 offen sc1
s_mov_b64 exec, -1
s_cmp_lt_u32 s70, 8
s_cbranch_scc0 L_fin2
s_mov_b64 exec, 0xffff
buffer_store_dwordx4 v[44:47], v1, s[36:39], s62 offen sc1
s_mov_b64 exec, -1
L_fin2:
s_endpgm
L_ffn:
s_mul_i32 s67, s3, 12288
s_add_u32 s67, s67, 25600
v_lshlrev_b32 v7, 3, v0
buffer_load_dwordx4 v[8:11], v1, s[36:39], s67 offen offset:0 sc1
buffer_load_dwordx4 v[12:15], v1, s[36:39], s67 offen offset:1024 sc1
s_cmp_lt_u32 s3, 4
s_cbranch_scc1 L_post_174
s_mov_b32 s40, s16
s_mov_b32 s41, s17
s_mov_b32 s42, 0x158000
s_mov_b32 s43, 0x20000
s_mov_b32 s56, s18
s_mov_b32 s57, s19
s_mov_b32 s58, 0x158000
s_mov_b32 s59, 0x20000
v_lshrrev_b32 v16, 2, v0
v_mul_u32_u24 v16, 2752, v16
v_and_b32 v17, 3, v0
v_lshrrev_b32 v18, 5, v0
v_xor_b32 v17, v17, v18
v_xor_b32 v18, 2, v17
v_lshl_add_u32 v17, v17, 4, v16
v_lshl_add_u32 v18, v18, 4, v16
s_mul_i32 s64, s34, 352256
s_lshl_b32 s65, s74, 6
s_add_u32 s64, s64, s65
s_lshl_b32 s65, s34, 13
s_add_u32 m0, s65, 4096
s_add_u32 s66, s64, 0
buffer_load_dwordx4 v17, s[40:43], s66 offen  lds
s_add_u32 m0, s65, 36864
s_add_u32 s66, s64, 0
buffer_load_dwordx4 v18, s[56:59], s66 offen  lds
s_add_u32 m0, s65, 5120
s_add_u32 s66, s64, 44032
buffer_load_dwordx4 v17, s[40:43], s66 offen  lds
s_add_u32 m0, s65, 37888
s_add_u32 s66, s64, 44032
buffer_load_dwordx4 v18, s[56:59], s66 offen  lds
s_add_u32 m0, s65, 6144
s_add_u32 s66, s64, 88064
buffer_load_dwordx4 v17, s[40:43], s66 offen  lds
s_add_u32 m0, s65, 38912
s_add_u32 s66, s64, 88064
buffer_load_dwordx4 v18, s[56:59], s66 offen  lds
s_add_u32 m0, s65, 7168
s_add_u32 s66, s64, 132096
buffer_load_dwordx4 v17, s[40:43], s66 offen  lds
s_add_u32 m0, s65, 39936
s_add_u32 s66, s64, 132096
buffer_load_dwordx4 v18, s[56:59], s66 offen  lds
s_add_u32 m0, s65, 8192
s_add_u32 s66, s64, 176128
buffer_load_dwordx4 v17, s[40:43], s66 offen  lds
s_add_u32 m0, s65, 40960
s_add_u32 s66, s64, 176128
buffer_load_dwordx4 v18, s[56:59], s66 offen  lds
s_add_u32 m0, s65, 9216
s_add_u32 s66, s64, 220160
buffer_load_dwordx4 v17, s[40:43], s66 offen  lds
s_add_u32 m0, s65, 41984
s_add_u32 s66, s64, 220160
buffer_load_dwordx4 v18, s[56:59], s66 offen  lds
s_add_u32 m0, s65, 10240
s_add_u32 s66, s64, 264192
buffer_load_dwordx4 v17, s[40:43], s66 offen  lds
s_add_u32 m0, s65, 43008
s_add_u32 s66, s64, 264192
buffer_load_dwordx4 v18, s[56:59], s66 offen  lds
s_add_u32 m0, s65, 11264
s_add_u32 s66, s64, 308224
buffer_load_dwordx4 v17, s[40:43], s66 offen  lds
s_add_u32 m0, s65, 44032
s_add_u32 s66, s64, 308224
buffer_load_dwordx4 v18, s[56:59], s66 offen  lds
s_waitcnt vmcnt(16)
s_branch L_post_175
L_post_174:
s_waitcnt vmcnt(0)
L_post_175:
v_max3_u32 v16, v8, v9, v10
v_max3_u32 v16, v16, v11, v12
v_max3_u32 v16, v16, v13, v14
v_max_u32 v16, v16, v15
v_cmp_eq_u32 vcc, -1, v16
s_cbranch_vccz L_cb_176
s_mov_b32 s75, 0
L_poll_177:
buffer_load_dwordx4 v[8:11], v1, s[36:39], s67 offen offset:0 sc1
buffer_load_dwordx4 v[12:15], v1, s[36:39], s67 offen offset:1024 sc1
s_waitcnt vmcnt(0)
v_max3_u32 v16, v8, v9, v10
v_max3_u32 v16, v16, v11, v12
v_max3_u32 v16, v16, v13, v14
v_max_u32 v16, v16, v15
v_cmp_eq_u32 vcc, -1, v16
s_cbranch_vccz L_pollx_178
s_add_u32 s75, s75, 1
s_cmp_lt_u32 s75, 0x100000
s_cbranch_scc1 L_poll_177
L_pollx_178:
L_cb_176:
s_mov_b32 s68, 0xffff0000
v_lshlrev_b32 v24, 16, v8
v_and_b32 v25, s68, v8
v_lshlrev_b32 v32, 16, v12
v_and_b32 v33, s68, v12
v_lshlrev_b32 v26, 16, v9
v_and_b32 v27, s68, v9
v_lshlrev_b32 v34, 16, v13
v_and_b32 v35, s68, v13
v_lshlrev_b32 v28, 16, v10
v_and_b32 v29, s68, v10
v_lshlrev_b32 v36, 16, v14
v_and_b32 v37, s68, v14
v_lshlrev_b32 v30, 16, v11
v_and_b32 v31, s68, v11
v_lshlrev_b32 v38, 16, v15
v_and_b32 v39, s68, v15
v_add_f32 v32, 1.0, v32
v_add_f32 v33, 1.0, v33
v_add_f32 v34, 1.0, v34
v_add_f32 v35, 1.0, v35
v_add_f32 v36, 1.0, v36
v_add_f32 v37, 1.0, v37
v_add_f32 v38, 1.0, v38
v_add_f32 v39, 1.0, v39
v_lshrrev_b32 v2, 3, v0
v_bfe_u32 v3, v0, 1, 3
v_and_b32 v4, 3, v3
s_lshl_b32 s64, s3, 1
v_xor_b32 v3, s64, v3
v_lshlrev_b32 v5, 10, v2
v_lshl_add_u32 v5, v4, 8, v5
v_lshl_add_u32 v5, v3, 4, v5
v_and_b32 v4, 1, v0
v_lshl_add_u32 v5, v4, 3, v5
v_add_u32 v5, 69632, v5
v_xor_b32 v6, 16, v5
v_mul_u32_u24 v16, 0xaaaa, v4
v_add_u32 v16, 0x4444, v16
v_lshrrev_b32 v2, 4, v0
v_bfe_u32 v3, v0, 3, 1
v_xor_b32 v7, v2, v0
v_lshlrev_b32 v7, 4, v7
v_add_u32 v7, 69632, v7
v_xor_b32 v8, 64, v7
v_and_b32 v4, 7, v0
v_and_b32 v9, 0x38, v0
v_lshlrev_b32 v9, 3, v9
v_lshl_add_u32 v9, v4, 1, v9
s_lshl_b32 s64, s34, 4
v_add_u32 v9, s64, v9
v_and_b32 v10, 12, v0
v_lshlrev_b32 v10, 5, v10
v_and_b32 v4, 1, v0
v_lshl_add_u32 v10, v4, 6, v10
v_lshl_add_u32 v10, v2, 4, v10
v_mov_b32 v17, 0xbfb8aa3b
v_mov_b32 v64, 0
v_mov_b32 v65, 0
v_mov_b32 v66, 0
v_mov_b32 v67, 0
s_lshl_b32 s64, s34, 3
s_lshr_b32 s64, s35, s64
v_lshlrev_b32 v3, 2, v3
v_bfe_u32 v3, s64, v3, 3
v_and_b32 v11, 6, v3
v_lshlrev_b32 v11, 12, v11
v_and_b32 v3, 1, v3
v_lshl_add_u32 v11, v3, 15, v11
v_lshl_add_u32 v11, v2, 17, v11
v_and_b32 v4, 240, v1
v_add_u32 v11, v11, v4
v_lshl_add_u32 v11, v2, 9, v11
s_lshl_b32 s64, s34, 8
v_add_u32 v11, s64, v11
s_lshl_b32 s69, s74, 7
s_add_u32 s69, s69, 1376256
s_add_u32 s72, s69, 65536
s_lshl_b32 s64, s3, 10
s_lshl_b32 s65, s2, 2
s_lshr_b32 s65, s35, s65
s_and_b32 s65, s65, 2
s_lshl_b32 s65, s65, 12
s_add_u32 s64, s64, s65
s_add_u32 s64, s64, 1310720
v_mov_b32 v14, 0xbb000000
v_mov_b32 v15, 0x3b000000
v_lshrrev_b32 v18, 4, v0
v_bfe_u32 v19, v0, 2, 2
v_bfe_u32 v20, v0, 1, 1
v_and_b32 v22, 1, v18
v_lshl_add_u32 v22, v20, 1, v22
v_xor_b32 v22, s34, v22
v_lshlrev_b32 v22, 4, v22
v_lshl_add_u32 v22, v20, 15, v22
v_lshl_add_u32 v22, v18, 9, v22
v_lshl_add_u32 v22, v19, 6, v22
v_and_b32 v20, 1, v0
v_lshl_add_u32 v22, v20, 3, v22
v_add_u32 v22, 4096, v22
s_lshr_b32 s73, s3, 2
s_waitcnt vmcnt(0)
s_barrier
buffer_load_dwordx4 v[56:59], v1, s[36:39], s64 offen sc1
s_cmp_eq_u32 s73, 0
s_cbranch_scc1 L_gu_180
ds_read_b64_tr_b16 v[128:129], v22 offset:0
ds_read_b64_tr_b16 v[130:131], v22 offset:256
ds_read_b64_tr_b16 v[132:133], v22 offset:2048
ds_read_b64_tr_b16 v[134:135], v22 offset:2304
ds_read_b64_tr_b16 v[136:137], v22 offset:4096
ds_read_b64_tr_b16 v[138:139], v22 offset:4352
ds_read_b64_tr_b16 v[140:141], v22 offset:6144
ds_read_b64_tr_b16 v[142:143], v22 offset:6400
ds_read_b64_tr_b16 v[144:145], v22 offset:8192
ds_read_b64_tr_b16 v[146:147], v22 offset:8448
ds_read_b64_tr_b16 v[148:149], v22 offset:10240
s_waitcnt lgkmcnt(4)
ds_read_b64_tr_b16 v[150:151], v22 offset:10496
ds_read_b64_tr_b16 v[152:153], v22 offset:12288
ds_read_b64_tr_b16 v[154:155], v22 offset:12544
ds_read_b64_tr_b16 v[156:157], v22 offset:14336
ds_read_b64_tr_b16 v[158:159], v22 offset:14592
ds_read_b64_tr_b16 v[160:161], v22 offset:16384
ds_read_b64_tr_b16 v[162:163], v22 offset:16640
ds_read_b64_tr_b16 v[164:165], v22 offset:18432
ds_read_b64_tr_b16 v[166:167], v22 offset:18688
ds_read_b64_tr_b16 v[168:169], v22 offset:20480
ds_read_b64_tr_b16 v[170:171], v22 offset:20736
s_waitcnt lgkmcnt(4)
ds_read_b64_tr_b16 v[172:173], v22 offset:22528
ds_read_b64_tr_b16 v[174:175], v22 offset:22784
ds_read_b64_tr_b16 v[176:177], v22 offset:24576
ds_read_b64_tr_b16 v[178:179], v22 offset:24832
ds_read_b64_tr_b16 v[180:181], v22 offset:26624
ds_read_b64_tr_b16 v[182:183], v22 offset:26880
ds_read_b64_tr_b16 v[184:185], v22 offset:28672
ds_read_b64_tr_b16 v[186:187], v22 offset:28928
ds_read_b64_tr_b16 v[188:189], v22 offset:30720
ds_read_b64_tr_b16 v[190:191], v22 offset:30976
v_add_u32 v68, 69632, v40
v_add_u32 v69, 69632, v41
v_add_u32 v70, 69632, v42
v_add_u32 v71, 69632, v43
v_add_u32 v72, 69632, v44
v_add_u32 v73, 69632, v45
v_add_u32 v74, 69632, v46
v_add_u32 v75, 69632, v47
L_gu_180:
s_cmp_lt_u32 s3, 4
s_cbranch_scc0 L_dma_181
s_mov_b32 s48, s20
s_mov_b32 s49, s21
s_mov_b32 s50, 0x158000
s_mov_b32 s51, 0x20000
v_lshrrev_b32 v18, 4, v0
v_and_b32 v16, 15, v0
v_xor_b32 v16, v16, v18
v_xor_b32 v17, 4, v16
v_lshlrev_b32 v19, 10, v18
v_lshl_add_u32 v22, v16, 4, v19
v_lshl_add_u32 v23, v17, 4, v19
s_lshl_b32 s76, s74, 15
s_lshl_b32 s66, s34, 8
s_add_u32 s76, s76, s66
s_lshl_b32 s77, s34, 13
s_add_u32 s77, s77, 77824
s_add_u32 m0, s77, 0
s_xor_b32 s66, s76, 0
buffer_load_dwordx4 v22, s[48:51], s66 offen  lds
s_add_u32 m0, s77, 1024
s_xor_b32 s66, s76, 8192
buffer_load_dwordx4 v23, s[48:51], s66 offen  lds
s_add_u32 m0, s77, 2048
s_xor_b32 s66, s76, 16384
buffer_load_dwordx4 v22, s[48:51], s66 offen  lds
s_add_u32 m0, s77, 3072
s_xor_b32 s66, s76, 24576
buffer_load_dwordx4 v23, s[48:51], s66 offen  lds
s_add_u32 m0, s77, 4096
s_xor_b32 s66, s76, 4096
buffer_load_dwordx4 v22, s[48:51], s66 offen  lds
s_add_u32 m0, s77, 5120
s_xor_b32 s66, s76, 12288
buffer_load_dwordx4 v23, s[48:51], s66 offen  lds
s_add_u32 m0, s77, 6144
s_xor_b32 s66, s76, 20480
buffer_load_dwordx4 v22, s[48:51], s66 offen  lds
s_waitcnt vmcnt(7)
s_branch L_dma_182
L_dma_181:
s_waitcnt vmcnt(0)
L_dma_182:
s_mov_b32 s73, 0x3f803f80
v_mov_b32 v20, 0
v_mov_b32 v21, 0
v_max3_u32 v12, v56, v57, v58
v_max_u32 v12, v12, v59
v_cmp_eq_u32 vcc, -1, v12
s_cbranch_vccz L_x_179
buffer_load_dwordx4 v[56:59], v1, s[36:39], s64 offen sc1
s_sleep 1
s_mov_b32 s75, 0
L_poll_183:
buffer_load_dwordx4 v[56:59], v1, s[36:39], s64 offen sc1
s_waitcnt vmcnt(1)
v_max3_u32 v12, v56, v57, v58
v_max_u32 v12, v12, v59
v_cmp_eq_u32 vcc, -1, v12
s_cbranch_vccz L_pollx_184
s_add_u32 s75, s75, 1
s_cmp_lt_u32 s75, 0x100000
s_cbranch_scc1 L_poll_183
L_pollx_184:
L_x_179:
v_dot2c_f32_bf16 v20, s73, v56
v_dot2c_f32_bf16 v21, v56, v56
v_dot2c_f32_bf16 v20, s73, v57
v_dot2c_f32_bf16 v21, v57, v57
v_dot2c_f32_bf16 v20, s73, v58
v_dot2c_f32_bf16 v21, v58, v58
v_dot2c_f32_bf16 v20, s73, v59
v_dot2c_f32_bf16 v21, v59, v59
v_lshlrev_b32 v40, 16, v56
v_and_b32 v41, s68, v56
v_lshlrev_b32 v42, 16, v57
v_permlane32_swap_b32 v20, v21
v_add_f32 v12, v20, v21
v_and_b32 v43, s68, v57
v_lshlrev_b32 v44, 16, v58
v_add_f32_dpp v12, v12, v12 quad_perm:[1,0,3,2] row_mask:0xf bank_mask:0xf
v_and_b32 v45, s68, v58
v_lshlrev_b32 v46, 16, v59
v_add_f32_dpp v12, v12, v12 quad_perm:[2,3,0,1] row_mask:0xf bank_mask:0xf
v_and_b32 v47, s68, v59
v_pk_mul_f32 v[48:49], v[40:41], v[32:33]
v_add_f32_dpp v12, v12, v12 row_ror:4 row_mask:0xf bank_mask:0xf
v_pk_mul_f32 v[50:51], v[42:43], v[34:35]
v_pk_mul_f32 v[52:53], v[44:45], v[36:37]
v_add_f32_dpp v12, v12, v12 row_ror:8 row_mask:0xf bank_mask:0xf
v_pk_mul_f32 v[54:55], v[46:47], v[38:39]
s_nop 0
v_add_f32_dpp v12, v12, v12 row_bcast:15 row_mask:0xa bank_mask:0xf
s_nop 0
v_readlane_b32 s70, v12, 16
v_readlane_b32 s71, v12, 48
s_nop 0
v_mul_f32 v12, s70, v14
v_mul_f32 v13, s71, v15
v_fma_f32 v13, -v12, v12, v13
v_max_f32 v13, 0, v13
v_add_f32 v13, 0x3727c5ac, v13
v_rsq_f32 v2, v13
v_pk_fma_f32 v[48:49], v[12:13], v[32:33], v[48:49] op_sel_hi:[0,1,1]
v_pk_fma_f32 v[50:51], v[12:13], v[34:35], v[50:51] op_sel_hi:[0,1,1]
v_pk_fma_f32 v[52:53], v[12:13], v[36:37], v[52:53] op_sel_hi:[0,1,1]
v_pk_fma_f32 v[54:55], v[12:13], v[38:39], v[54:55] op_sel_hi:[0,1,1]
v_pk_fma_f32 v[24:25], v[2:3], v[48:49], v[24:25] op_sel_hi:[0,1,1]
v_pk_fma_f32 v[28:29], v[2:3], v[52:53], v[28:29] op_sel_hi:[0,1,1]
v_pk_fma_f32 v[26:27], v[2:3], v[50:51], v[26:27] op_sel_hi:[0,1,1]
v_pk_fma_f32 v[30:31], v[2:3], v[54:55], v[30:31] op_sel_hi:[0,1,1]
v_cvt_pk_bf16_f32 v40, v24, v25
v_cvt_pk_bf16_f32 v41, v28, v29
ds_write_b64 v5, v[40:41]
v_cvt_pk_bf16_f32 v42, v26, v27
v_cvt_pk_bf16_f32 v43, v30, v31
ds_write_b64 v6, v[42:43]
s_cmp_lt_u32 s3, 4
s_cbranch_scc0 L_dma_185
s_mov_b32 s48, s20
s_mov_b32 s49, s21
s_mov_b32 s50, 0x158000
s_mov_b32 s51, 0x20000
s_add_u32 m0, s77, 7168
s_xor_b32 s66, s76, 28672
buffer_load_dwordx4 v23, s[48:51], s66 offen  lds
L_dma_185:
s_cmp_lt_u32 s3, 4
s_waitcnt lgkmcnt(0)
s_barrier
s_cbranch_scc1 L_bar_fin
ds_read_b128 v[192:195], v7 offset:0
ds_read_b128 v[196:199], v8 offset:1024
ds_read_b128 v[200:203], v7 offset:2048
ds_read_b128 v[204:207], v8 offset:3072
ds_read_b128 v[208:211], v7 offset:4096
ds_read_b128 v[212:215], v8 offset:5120
ds_read_b128 v[216:219], v7 offset:6144
ds_read_b128 v[220:223], v8 offset:7168
s_waitcnt lgkmcnt(7)
v_smfmac_f32_16x16x64_bf16 v[64:67], v[192:195], v[128:135], v16
s_waitcnt lgkmcnt(6)
v_smfmac_f32_16x16x64_bf16 v[64:67], v[196:199], v[136:143], v16
s_waitcnt lgkmcnt(5)
v_smfmac_f32_16x16x64_bf16 v[64:67], v[200:203], v[144:151], v16
s_waitcnt lgkmcnt(4)
v_smfmac_f32_16x16x64_bf16 v[64:67], v[204:207], v[152:159], v16
s_waitcnt lgkmcnt(3)
v_smfmac_f32_16x16x64_bf16 v[64:67], v[208:211], v[160:167], v16
s_waitcnt lgkmcnt(2)
v_smfmac_f32_16x16x64_bf16 v[64:67], v[212:215], v[168:175], v16
s_waitcnt lgkmcnt(1)
v_smfmac_f32_16x16x64_bf16 v[64:67], v[216:219], v[176:183], v16
s_waitcnt lgkmcnt(0)
v_smfmac_f32_16x16x64_bf16 v[64:67], v[220:223], v[184:191], v16
s_nop 7
v_add_f32 v66, v66, v67
v_add_f32 v64, v64, v65
v_mul_f32 v18, v64, v17
v_mul_f32_dpp v18, v66, v17 row_ror:8 row_mask:0xf bank_mask:0xc
v_exp_f32 v18, v18
v_mov_b32_dpp v66, v64 row_ror:8 row_mask:0xf bank_mask:0x3
v_add_f32 v18, 1.0, v18
v_rcp_f32 v18, v18
s_nop 0
v_mul_f32 v18, v18, v66
v_cvt_pk_bf16_f32 v18, v18, v18
ds_write_b16 v9, v18 offset:3584
s_waitcnt lgkmcnt(0)
s_barrier
ds_read_b128 v[48:51], v10 offset:3584
ds_read_b64_tr_b16 v[96:97], v68 offset:0
ds_read_b64_tr_b16 v[98:99], v68 offset:4096
ds_read_b64_tr_b16 v[100:101], v69 offset:0
ds_read_b64_tr_b16 v[102:103], v69 offset:4096
ds_read_b64_tr_b16 v[104:105], v70 offset:0
ds_read_b64_tr_b16 v[106:107], v70 offset:4096
ds_read_b64_tr_b16 v[108:109], v71 offset:0
ds_read_b64_tr_b16 v[110:111], v71 offset:4096
ds_read_b64_tr_b16 v[112:113], v72 offset:0
ds_read_b64_tr_b16 v[114:115], v72 offset:4096
ds_read_b64_tr_b16 v[116:117], v73 offset:0
ds_read_b64_tr_b16 v[118:119], v73 offset:4096
s_waitcnt lgkmcnt(10)
v_mfma_f32_16x16x32_bf16 v[192:195], v[48:51], v[96:99], 0
ds_read_b64_tr_b16 v[120:121], v74 offset:0
ds_read_b64_tr_b16 v[122:123], v74 offset:4096
s_waitcnt lgkmcnt(10)
v_mfma_f32_16x16x32_bf16 v[196:199], v[48:51], v[100:103], 0
ds_read_b64_tr_b16 v[124:125], v75 offset:0
ds_read_b64_tr_b16 v[126:127], v75 offset:4096
s_waitcnt lgkmcnt(10)
v_mfma_f32_16x16x32_bf16 v[200:203], v[48:51], v[104:107], 0
s_waitcnt lgkmcnt(8)
v_mfma_f32_16x16x32_bf16 v[204:207], v[48:51], v[108:111], 0
s_waitcnt lgkmcnt(6)
v_mfma_f32_16x16x32_bf16 v[208:211], v[48:51], v[112:115], 0
s_nop 0
v_cvt_pk_bf16_f32 v16, v192, v196
s_waitcnt lgkmcnt(4)
v_mfma_f32_16x16x32_bf16 v[212:215], v[48:51], v[116:119], 0
v_cvt_pk_bf16_f32 v20, v193, v197
s_waitcnt lgkmcnt(2)
v_mfma_f32_16x16x32_bf16 v[216:219], v[48:51], v[120:123], 0
v_cvt_pk_bf16_f32 v17, v200, v204
v_cvt_pk_bf16_f32 v21, v201, v205
s_waitcnt lgkmcnt(0)
v_mfma_f32_16x16x32_bf16 v[220:223], v[48:51], v[124:127], 0
s_nop 2
v_cvt_pk_bf16_f32 v18, v208, v212
v_cvt_pk_bf16_f32 v22, v209, v213
s_nop 2
v_cvt_pk_bf16_f32 v19, v216, v220
buffer_store_dwordx4 v[16:19], v11, s[36:39], s69 offen sc1
v_cvt_pk_bf16_f32 v23, v217, v221
buffer_store_dwordx4 v[20:23], v11, s[36:39], s72 offen sc1
s_endpgm
L_bar_fin:
s_waitcnt vmcnt(0)
s_barrier
s_endpgm
L_srest:
s_lshr_b32 s32, s2, 5
s_and_b32 s33, s2, 31
s_and_b32 s67, s2, 7
s_lshr_b32 s68, s2, 3
s_sub_u32 s68, s68, 26
s_min_u32 s74, s67, 3
s_mul_i32 s66, s67, 5
s_add_u32 s74, s74, s66
s_add_u32 s74, s74, s68
s_cmp_lt_u32 s67, 3
s_cselect_b32 s66, 6, 5
s_cmp_lt_u32 s68, s66
s_cselect_b32 s74, s74, -1
s_cmp_lt_u32 s2, 48
s_cselect_b32 s66, 2, 3
s_cselect_b32 s72, 14+26, 42+26
s_cmp_lt_u32 s2, 16
s_cselect_b32 s66, 1, s66
s_cselect_b32 s72, 26, s72
s_lshl_b32 s66, s67, s66
s_add_u32 s72, s72, s66
s_add_u32 s72, s72, s68
s_mov_b32 s36, s30
s_mov_b32 s37, s31
s_mov_b32 s38, 0x1d0000
s_mov_b32 s39, 0x20000
s_mov_b32 s52, s28
s_mov_b32 s53, s29
s_mov_b32 s54, 0x100
s_mov_b32 s55, 0x20000
s_mov_b32 s46, 0x40000
s_mov_b32 s47, 0x20000
s_cmp_eq_u32 s74, -1
s_mov_b32 s69, 30
s_cselect_b32 s69, 20, s69
s_cmp_lt_u32 s2, 144
s_cselect_b32 s69, 0, s69
s_cmp_lt_u32 s2, 112
s_cselect_b32 s69, 50, s69
s_cmp_lt_u32 s2, 48
s_cselect_b32 s69, 30, s69
s_cmp_lt_u32 s2, 16
s_cselect_b32 s69, 40, s69
s_and_b32 s66, s72, 7
s_cmp_eq_u32 s66, 3
s_cselect_b32 s66, 40, 0
s_cmp_lt_u32 s2, 112
s_cselect_b32 s66, s66, 0
s_add_u32 s69, s69, s66
s_xor_b32 s64, s65, 1024
s_cmpk_gt_u32 s69, 4
s_cbranch_scc1 L_d_1
s_waitcnt vmcnt(3)
L_d_1:
buffer_load_dwordx4 v[24:27], v1, s[40:43], s64 offen nt
s_xor_b32 s64, s65, 33792
s_cmpk_gt_u32 s69, 5
s_cbranch_scc1 L_d_2
s_waitcnt vmcnt(3)
L_d_2:
buffer_load_dwordx4 v[28:31], v1, s[40:43], s64 offen nt
s_xor_b32 s64, s65, 5120
s_cmpk_gt_u32 s69, 6
s_cbranch_scc1 L_d_3
s_waitcnt vmcnt(3)
L_d_3:
buffer_load_dwordx4 v[32:35], v1, s[40:43], s64 offen nt
s_xor_b32 s64, s65, 37888
s_cmpk_gt_u32 s69, 7
s_waitcnt vmcnt(6)
s_cbranch_scc1 L_d_4
s_waitcnt vmcnt(3)
L_d_4:
buffer_load_dwordx4 v[36:39], v1, s[40:43], s64 offen nt
s_xor_b32 s64, s65, 65536
s_cmpk_gt_u32 s69, 8
s_waitcnt vmcnt(6)
s_cbranch_scc1 L_d_5
s_waitcnt vmcnt(3)
L_d_5:
buffer_load_dwordx4 v[40:43], v1, s[40:43], s64 offen nt
s_xor_b32 s64, s65, 98304
s_cmpk_gt_u32 s69, 9
s_waitcnt vmcnt(6)
s_cbranch_scc1 L_d_6
s_waitcnt vmcnt(3)
L_d_6:
buffer_load_dwordx4 v[44:47], v1, s[40:43], s64 offen nt
s_xor_b32 s64, s65, 69632
s_cmpk_gt_u32 s69, 10
s_waitcnt vmcnt(6)
s_cbranch_scc1 L_d_7
s_waitcnt vmcnt(3)
L_d_7:
buffer_load_dwordx4 v[48:51], v1, s[40:43], s64 offen nt
s_xor_b32 s64, s65, 102400
s_cmpk_gt_u32 s69, 11
s_waitcnt vmcnt(6)
s_cbranch_scc1 L_d_8
s_waitcnt vmcnt(3)
L_d_8:
buffer_load_dwordx4 v[52:55], v1, s[40:43], s64 offen nt
s_xor_b32 s64, s65, 66560
s_cmpk_gt_u32 s69, 12
s_waitcnt vmcnt(6)
s_cbranch_scc1 L_d_9
s_waitcnt vmcnt(3)
L_d_9:
buffer_load_dwordx4 v[56:59], v1, s[40:43], s64 offen nt
s_xor_b32 s64, s65, 99328
s_cmpk_gt_u32 s69, 13
s_waitcnt vmcnt(6)
s_cbranch_scc1 L_d_10
s_waitcnt vmcnt(3)
L_d_10:
buffer_load_dwordx4 v[60:63], v1, s[40:43], s64 offen nt
s_xor_b32 s64, s65, 70656
s_cmpk_gt_u32 s69, 14
s_waitcnt vmcnt(6)
s_cbranch_scc1 L_d_11
s_waitcnt vmcnt(3)
L_d_11:
buffer_load_dwordx4 v[64:67], v1, s[40:43], s64 offen nt
s_xor_b32 s64, s65, 103424
s_cmpk_gt_u32 s69, 15
s_waitcnt vmcnt(6)
s_cbranch_scc1 L_d_12
s_waitcnt vmcnt(3)
L_d_12:
buffer_load_dwordx4 v[68:71], v1, s[40:43], s64 offen nt
s_xor_b32 s64, s65, 131072
s_cmpk_gt_u32 s69, 16
s_waitcnt vmcnt(6)
s_cbranch_scc1 L_d_13
s_waitcnt vmcnt(3)
L_d_13:
buffer_load_dwordx4 v[72:75], v1, s[40:43], s64 offen nt
s_xor_b32 s64, s65, 163840
s_cmpk_gt_u32 s69, 17
s_waitcnt vmcnt(6)
s_cbranch_scc1 L_d_14
s_waitcnt vmcnt(3)
L_d_14:
buffer_load_dwordx4 v[76:79], v1, s[40:43], s64 offen nt
s_xor_b32 s64, s65, 135168
s_cmpk_gt_u32 s69, 18
s_waitcnt vmcnt(6)
s_cbranch_scc1 L_d_15
s_waitcnt vmcnt(3)
L_d_15:
buffer_load_dwordx4 v[80:83], v1, s[40:43], s64 offen nt
s_xor_b32 s64, s65, 167936
s_cmpk_gt_u32 s69, 19
s_waitcnt vmcnt(6)
s_cbranch_scc1 L_d_16
s_waitcnt vmcnt(3)
L_d_16:
buffer_load_dwordx4 v[84:87], v1, s[40:43], s64 offen nt
s_xor_b32 s64, s65, 132096
s_cmpk_gt_u32 s69, 20
s_waitcnt vmcnt(6)
s_cbranch_scc1 L_d_17
s_waitcnt vmcnt(4)
L_d_17:
buffer_load_dwordx4 v[88:91], v1, s[40:43], s64 offen nt
s_xor_b32 s64, s65, 164864
s_cmpk_gt_u32 s69, 21
s_waitcnt vmcnt(6)
s_cbranch_scc1 L_d_18
s_waitcnt vmcnt(4)
L_d_18:
buffer_load_dwordx4 v[92:95], v1, s[40:43], s64 offen nt
s_xor_b32 s64, s65, 136192
s_cmpk_gt_u32 s69, 22
s_waitcnt vmcnt(6)
s_cbranch_scc1 L_d_19
s_waitcnt vmcnt(4)
L_d_19:
buffer_load_dwordx4 v[96:99], v1, s[40:43], s64 offen nt
s_xor_b32 s64, s65, 168960
s_cmpk_gt_u32 s69, 23
s_waitcnt vmcnt(6)
s_cbranch_scc1 L_d_20
s_waitcnt vmcnt(4)
L_d_20:
buffer_load_dwordx4 v[100:103], v1, s[40:43], s64 offen nt
s_xor_b32 s64, s65, 196608
s_cmpk_gt_u32 s69, 24
s_waitcnt vmcnt(6)
s_cbranch_scc1 L_d_21
s_waitcnt vmcnt(4)
L_d_21:
buffer_load_dwordx4 v[104:107], v1, s[40:43], s64 offen nt
s_xor_b32 s64, s65, 229376
s_cmpk_gt_u32 s69, 25
s_waitcnt vmcnt(6)
s_cbranch_scc1 L_d_22
s_waitcnt vmcnt(4)
L_d_22:
buffer_load_dwordx4 v[108:111], v1, s[40:43], s64 offen nt
s_xor_b32 s64, s65, 200704
s_cmpk_gt_u32 s69, 26
s_waitcnt vmcnt(6)
s_cbranch_scc1 L_d_23
s_waitcnt vmcnt(4)
L_d_23:
buffer_load_dwordx4 v[112:115], v1, s[40:43], s64 offen nt
s_xor_b32 s64, s65, 233472
s_cmpk_gt_u32 s69, 27
s_waitcnt vmcnt(6)
s_cbranch_scc1 L_d_24
s_waitcnt vmcnt(4)
L_d_24:
buffer_load_dwordx4 v[116:119], v1, s[40:43], s64 offen nt
s_xor_b32 s64, s65, 197632
s_cmpk_gt_u32 s69, 28
s_waitcnt vmcnt(6)
s_cbranch_scc1 L_d_25
s_waitcnt vmcnt(4)
L_d_25:
buffer_load_dwordx4 v[120:123], v1, s[40:43], s64 offen nt
s_xor_b32 s64, s65, 230400
s_cmpk_gt_u32 s69, 29
s_waitcnt vmcnt(6)
s_cbranch_scc1 L_d_26
s_waitcnt vmcnt(4)
L_d_26:
buffer_load_dwordx4 v[124:127], v1, s[40:43], s64 offen nt
s_xor_b32 s64, s65, 201728
s_cmpk_gt_u32 s69, 30
s_waitcnt vmcnt(6)
s_cbranch_scc1 L_d_27
s_waitcnt vmcnt(4)
L_d_27:
buffer_load_dwordx4 v[128:131], v1, s[40:43], s64 offen nt
s_xor_b32 s64, s65, 234496
s_cmpk_gt_u32 s69, 31
s_waitcnt vmcnt(6)
s_cbranch_scc1 L_d_28
s_waitcnt vmcnt(4)
L_d_28:
buffer_load_dwordx4 v[132:135], v1, s[40:43], s64 offen nt
s_xor_b32 s64, s65, 2048
s_cmpk_gt_u32 s69, 32
s_waitcnt vmcnt(6)
s_cbranch_scc1 L_d_29
s_waitcnt vmcnt(4)
L_d_29:
buffer_load_dwordx4 v[136:139], v1, s[40:43], s64 offen nt
s_xor_b32 s64, s65, 34816
s_cmpk_gt_u32 s69, 33
s_waitcnt vmcnt(6)
s_cbranch_scc1 L_d_30
s_waitcnt vmcnt(4)
L_d_30:
buffer_load_dwordx4 v[140:143], v1, s[40:43], s64 offen nt
s_xor_b32 s64, s65, 6144
s_cmpk_gt_u32 s69, 34
s_waitcnt vmcnt(6)
s_cbranch_scc1 L_d_31
s_waitcnt vmcnt(4)
L_d_31:
buffer_load_dwordx4 v[144:147], v1, s[40:43], s64 offen nt
s_xor_b32 s64, s65, 38912
s_cmpk_gt_u32 s69, 35
s_waitcnt vmcnt(6)
s_cbranch_scc1 L_d_32
s_waitcnt vmcnt(4)
L_d_32:
buffer_load_dwordx4 v[148:151], v1, s[40:43], s64 offen nt
s_xor_b32 s64, s65, 3072
s_cmpk_gt_u32 s69, 36
s_waitcnt vmcnt(6)
s_cbranch_scc1 L_d_33
s_waitcnt vmcnt(4)
L_d_33:
buffer_load_dwordx4 v[152:155], v1, s[40:43], s64 offen nt
s_xor_b32 s64, s65, 35840
s_cmpk_gt_u32 s69, 37
s_waitcnt vmcnt(6)
s_cbranch_scc1 L_d_34
s_waitcnt vmcnt(4)
L_d_34:
buffer_load_dwordx4 v[156:159], v1, s[40:43], s64 offen nt
s_xor_b32 s64, s65, 7168
s_cmpk_gt_u32 s69, 38
s_waitcnt vmcnt(6)
s_cbranch_scc1 L_d_35
s_waitcnt vmcnt(4)
L_d_35:
buffer_load_dwordx4 v[160:163], v1, s[40:43], s64 offen nt
s_xor_b32 s64, s65, 39936
s_cmpk_gt_u32 s69, 39
s_waitcnt vmcnt(6)
s_cbranch_scc1 L_d_36
s_waitcnt vmcnt(4)
L_d_36:
buffer_load_dwordx4 v[164:167], v1, s[40:43], s64 offen nt
s_xor_b32 s64, s65, 67584
s_cmpk_gt_u32 s69, 40
s_waitcnt vmcnt(6)
s_cbranch_scc1 L_d_37
s_waitcnt vmcnt(4)
L_d_37:
buffer_load_dwordx4 v[168:171], v1, s[40:43], s64 offen nt
s_xor_b32 s64, s65, 100352
s_cmpk_gt_u32 s69, 41
s_waitcnt vmcnt(6)
s_cbranch_scc1 L_d_38
s_waitcnt vmcnt(4)
L_d_38:
buffer_load_dwordx4 v[172:175], v1, s[40:43], s64 offen nt
s_xor_b32 s64, s65, 71680
s_cmpk_gt_u32 s69, 42
s_waitcnt vmcnt(6)
s_cbranch_scc1 L_d_39
s_waitcnt vmcnt(4)
L_d_39:
buffer_load_dwordx4 v[176:179], v1, s[40:43], s64 offen nt
s_xor_b32 s64, s65, 104448
s_cmpk_gt_u32 s69, 43
s_waitcnt vmcnt(6)
s_cbranch_scc1 L_d_40
s_waitcnt vmcnt(4)
L_d_40:
buffer_load_dwordx4 v[180:183], v1, s[40:43], s64 offen nt
s_xor_b32 s64, s65, 68608
s_cmpk_gt_u32 s69, 44
s_waitcnt vmcnt(6)
s_cbranch_scc1 L_d_41
s_waitcnt vmcnt(4)
L_d_41:
buffer_load_dwordx4 v[184:187], v1, s[40:43], s64 offen nt
s_xor_b32 s64, s65, 101376
s_cmpk_gt_u32 s69, 45
s_waitcnt vmcnt(6)
s_cbranch_scc1 L_d_42
s_waitcnt vmcnt(4)
L_d_42:
buffer_load_dwordx4 v[188:191], v1, s[40:43], s64 offen nt
s_xor_b32 s64, s65, 72704
s_cmpk_gt_u32 s69, 46
s_waitcnt vmcnt(6)
s_cbranch_scc1 L_d_43
s_waitcnt vmcnt(4)
L_d_43:
buffer_load_dwordx4 v[192:195], v1, s[40:43], s64 offen nt
s_xor_b32 s64, s65, 105472
s_cmpk_gt_u32 s69, 47
s_waitcnt vmcnt(6)
s_cbranch_scc1 L_d_44
s_waitcnt vmcnt(4)
L_d_44:
buffer_load_dwordx4 v[196:199], v1, s[40:43], s64 offen nt
s_xor_b32 s64, s65, 133120
s_cmpk_gt_u32 s69, 48
s_waitcnt vmcnt(6)
s_cbranch_scc1 L_d_45
s_waitcnt vmcnt(4)
L_d_45:
buffer_load_dwordx4 v[200:203], v1, s[40:43], s64 offen nt
s_xor_b32 s64, s65, 165888
s_cmpk_gt_u32 s69, 49
s_waitcnt vmcnt(6)
s_cbranch_scc1 L_d_46
s_waitcnt vmcnt(4)
L_d_46:
buffer_load_dwordx4 v[204:207], v1, s[40:43], s64 offen nt
s_xor_b32 s64, s65, 137216
s_cmpk_gt_u32 s69, 50
s_waitcnt vmcnt(6)
s_cbranch_scc1 L_d_47
s_waitcnt vmcnt(4)
L_d_47:
buffer_load_dwordx4 v[208:211], v1, s[40:43], s64 offen nt
s_xor_b32 s64, s65, 169984
s_cmpk_gt_u32 s69, 51
s_waitcnt vmcnt(6)
s_cbranch_scc1 L_d_48
s_waitcnt vmcnt(4)
L_d_48:
buffer_load_dwordx4 v[212:215], v1, s[40:43], s64 offen nt
s_xor_b32 s64, s65, 134144
s_cmpk_gt_u32 s69, 52
s_waitcnt vmcnt(6)
s_cbranch_scc1 L_d_49
s_waitcnt vmcnt(4)
L_d_49:
buffer_load_dwordx4 v[216:219], v1, s[40:43], s64 offen nt
s_xor_b32 s64, s65, 166912
s_cmpk_gt_u32 s69, 53
s_waitcnt vmcnt(6)
s_cbranch_scc1 L_d_50
s_waitcnt vmcnt(4)
L_d_50:
buffer_load_dwordx4 v[220:223], v1, s[40:43], s64 offen nt
s_xor_b32 s64, s65, 138240
s_cmpk_gt_u32 s69, 54
s_waitcnt vmcnt(6)
s_cbranch_scc1 L_d_51
s_waitcnt vmcnt(4)
L_d_51:
buffer_load_dwordx4 v[224:227], v1, s[40:43], s64 offen nt
s_xor_b32 s64, s65, 171008
s_cmpk_gt_u32 s69, 55
s_waitcnt vmcnt(6)
s_cbranch_scc1 L_d_52
s_waitcnt vmcnt(4)
L_d_52:
buffer_load_dwordx4 v[228:231], v1, s[40:43], s64 offen nt
s_xor_b32 s64, s65, 198656
s_cmpk_gt_u32 s69, 56
s_waitcnt vmcnt(6)
s_cbranch_scc1 L_d_53
s_waitcnt vmcnt(4)
L_d_53:
buffer_load_dwordx4 v[232:235], v1, s[40:43], s64 offen nt
s_xor_b32 s64, s65, 231424
s_cmpk_gt_u32 s69, 57
s_waitcnt vmcnt(6)
s_cbranch_scc1 L_d_54
s_waitcnt vmcnt(4)
L_d_54:
buffer_load_dwordx4 v[236:239], v1, s[40:43], s64 offen nt
s_xor_b32 s64, s65, 202752
s_cmpk_gt_u32 s69, 58
s_waitcnt vmcnt(6)
s_cbranch_scc1 L_d_55
s_waitcnt vmcnt(4)
L_d_55:
buffer_load_dwordx4 v[240:243], v1, s[40:43], s64 offen nt
v_and_b32 v2, 31, v0
v_lshlrev_b32 v2, 2, v2
buffer_load_dword v3, v2, s[52:55], 0 offen offset:128
s_xor_b32 s64, s65, 235520
s_cmpk_gt_u32 s69, 59
s_waitcnt vmcnt(6)
s_cbranch_scc1 L_d_56
s_waitcnt vmcnt(4)
L_d_56:
buffer_load_dwordx4 v[244:247], v1, s[40:43], s64 offen nt
s_xor_b32 s64, s65, 199680
s_cmpk_gt_u32 s69, 60
s_waitcnt vmcnt(6)
s_cbranch_scc1 L_d_57
s_waitcnt vmcnt(4)
L_d_57:
buffer_load_dwordx4 v[248:251], v1, s[40:43], s64 offen nt
s_xor_b32 s64, s65, 232448
s_cmpk_gt_u32 s69, 61
s_waitcnt vmcnt(6)
s_cbranch_scc1 L_d_58
s_waitcnt vmcnt(4)
L_d_58:
buffer_load_dwordx4 v[252:255], v1, s[40:43], s64 offen nt
s_mul_i32 s70, s34, 15360
s_add_u32 s70, s70, 69632
s_add_u32 m0, s70, 0
s_xor_b32 s64, s65, 203776
s_cmpk_gt_u32 s69, 62
s_waitcnt vmcnt(6)
s_cbranch_scc1 L_d_59
s_waitcnt vmcnt(4)
L_d_59:
buffer_load_dwordx4 v1, s[40:43], s64 offen nt lds
s_add_u32 m0, s70, 1024
s_xor_b32 s64, s65, 236544
s_cmpk_gt_u32 s69, 63
s_waitcnt vmcnt(6)
s_cbranch_scc1 L_d_60
s_waitcnt vmcnt(4)
L_d_60:
buffer_load_dwordx4 v1, s[40:43], s64 offen nt lds
s_cmp_eq_u32 s74, -1
s_mov_b32 s69, 80
s_cselect_b32 s69, 80, s69
s_cmp_lt_u32 s2, 144
s_cselect_b32 s69, 80, s69
s_cmp_lt_u32 s2, 112
s_cselect_b32 s69, 112, s69
s_cmp_lt_u32 s2, 48
s_cselect_b32 s69, 0, s69
s_cmp_lt_u32 s2, 16
s_cselect_b32 s69, 112, s69
s_add_u32 m0, s70, 2048
s_xor_b32 s64, s65, 0
s_cmpk_gt_u32 s69, 64
s_waitcnt vmcnt(6)
s_cbranch_scc1 L_d_61
s_waitcnt vmcnt(4)
L_d_61:
buffer_load_dwordx4 v1, s[44:47], s64 offen nt lds
s_add_u32 m0, s70, 3072
s_xor_b32 s64, s65, 32768
s_cmpk_gt_u32 s69, 65
s_waitcnt vmcnt(6)
s_cbranch_scc1 L_d_62
s_waitcnt vmcnt(4)
L_d_62:
buffer_load_dwordx4 v1, s[44:47], s64 offen nt lds
s_add_u32 m0, s70, 4096
s_xor_b32 s64, s65, 4096
s_cmpk_gt_u32 s69, 66
s_waitcnt vmcnt(6)
s_cbranch_scc1 L_d_63
s_waitcnt vmcnt(4)
L_d_63:
buffer_load_dwordx4 v1, s[44:47], s64 offen nt lds
s_add_u32 m0, s70, 5120
s_xor_b32 s64, s65, 36864
s_cmpk_gt_u32 s69, 67
s_waitcnt vmcnt(6)
s_cbranch_scc1 L_d_64
s_waitcnt vmcnt(4)
L_d_64:
buffer_load_dwordx4 v1, s[44:47], s64 offen nt lds
v_cmp_eq_u32 vcc, 0, v3
s_cbranch_vccz L_jf_66
s_mov_b32 s75, 0
L_poll_67:
v_and_b32 v2, 31, v0
v_lshlrev_b32 v2, 2, v2
buffer_load_dword v3, v2, s[52:55], 0 offen offset:128 sc1
s_waitcnt vmcnt(0)
v_cmp_eq_u32 vcc, 0, v3
s_cbranch_vccz L_pollx_68
s_sleep 40
s_add_u32 s75, s75, 1
s_cmp_lt_u32 s75, 0x100000
s_cbranch_scc1 L_poll_67
L_pollx_68:
L_jf_66:
s_mul_i32 s68, s32, 12288
s_lshl_b32 s67, s33, 8
s_add_u32 s68, s68, s67
s_add_u32 s68, s68, 16384
v_and_b32 v2, 0xf0, v1
buffer_load_dwordx4 v[4:7], v2, s[36:39], s68 offen sc1
s_add_u32 m0, s70, 6144
s_xor_b32 s64, s65, 1024
s_cmpk_gt_u32 s69, 68
s_waitcnt vmcnt(6)
s_cbranch_scc1 L_d_65
s_waitcnt vmcnt(4)
L_d_65:
buffer_load_dwordx4 v1, s[44:47], s64 offen nt lds
s_add_u32 m0, s70, 7168
s_xor_b32 s64, s65, 33792
s_cmpk_gt_u32 s69, 69
s_waitcnt vmcnt(6)
s_cbranch_scc1 L_d_69
s_waitcnt vmcnt(4)
L_d_69:
buffer_load_dwordx4 v1, s[44:47], s64 offen nt lds
s_add_u32 m0, s70, 8192
s_xor_b32 s64, s65, 5120
s_cmpk_gt_u32 s69, 70
s_waitcnt vmcnt(6)
s_cbranch_scc1 L_d_70
s_waitcnt vmcnt(4)
L_d_70:
buffer_load_dwordx4 v1, s[44:47], s64 offen nt lds
s_add_u32 m0, s70, 9216
s_xor_b32 s64, s65, 37888
s_cmpk_gt_u32 s69, 71
s_waitcnt vmcnt(6)
s_cbranch_scc1 L_d_71
s_waitcnt vmcnt(4)
L_d_71:
buffer_load_dwordx4 v1, s[44:47], s64 offen nt lds
s_add_u32 m0, s70, 10240
s_xor_b32 s64, s65, 65536
s_cmpk_gt_u32 s69, 72
s_waitcnt vmcnt(6)
s_cbranch_scc1 L_d_72
s_waitcnt vmcnt(4)
L_d_72:
buffer_load_dwordx4 v1, s[44:47], s64 offen nt lds
s_add_u32 m0, s70, 11264
s_xor_b32 s64, s65, 98304
s_cmpk_gt_u32 s69, 73
s_waitcnt vmcnt(6)
s_cbranch_scc1 L_d_73
s_waitcnt vmcnt(4)
L_d_73:
buffer_load_dwordx4 v1, s[44:47], s64 offen nt lds
s_add_u32 m0, s70, 12288
s_xor_b32 s64, s65, 69632
s_cmpk_gt_u32 s69, 74
s_waitcnt vmcnt(6)
s_cbranch_scc1 L_d_74
s_waitcnt vmcnt(4)
L_d_74:
buffer_load_dwordx4 v1, s[44:47], s64 offen nt lds
s_add_u32 m0, s70, 13312
s_xor_b32 s64, s65, 102400
s_cmpk_gt_u32 s69, 75
s_waitcnt vmcnt(6)
s_cbranch_scc1 L_d_75
s_waitcnt vmcnt(4)
L_d_75:
buffer_load_dwordx4 v1, s[44:47], s64 offen nt lds
s_add_u32 m0, s70, 14336
s_xor_b32 s64, s65, 66560
s_cmpk_gt_u32 s69, 76
s_waitcnt vmcnt(6)
s_cbranch_scc1 L_d_76
s_waitcnt vmcnt(4)
L_d_76:
buffer_load_dwordx4 v1, s[44:47], s64 offen nt lds
v_max3_u32 v3, v4, v5, v6
v_max_u32 v3, v3, v7
v_cmp_eq_u32 vcc, -1, v3
s_cbranch_vccz L_q_77
s_mov_b32 s75, 0
L_poll_78:
s_mul_i32 s68, s32, 12288
s_lshl_b32 s67, s33, 8
s_add_u32 s68, s68, s67
s_add_u32 s68, s68, 16384
v_and_b32 v2, 0xf0, v1
buffer_load_dwordx4 v[4:7], v2, s[36:39], s68 offen sc1
s_waitcnt vmcnt(0)
v_max3_u32 v3, v4, v5, v6
v_max_u32 v3, v3, v7
v_cmp_eq_u32 vcc, -1, v3
s_cbranch_vccz L_pollx_79
s_add_u32 s75, s75, 1
s_cmp_lt_u32 s75, 0x100000
s_cbranch_scc1 L_poll_78
L_pollx_79:
L_q_77:
s_mov_b32 s66, 0x3db504f3
v_dot2_f32_bf16 v8, v8, v4, 0
v_dot2_f32_bf16 v12, v12, v4, 0
v_dot2_f32_bf16 v16, v16, v4, 0
v_dot2_f32_bf16 v20, v20, v4, 0
v_dot2c_f32_bf16 v8, v9, v5
v_dot2c_f32_bf16 v12, v13, v5
v_dot2c_f32_bf16 v16, v17, v5
v_dot2c_f32_bf16 v20, v21, v5
v_dot2c_f32_bf16 v8, v10, v6
v_dot2c_f32_bf16 v12, v14, v6
v_dot2c_f32_bf16 v16, v18, v6
v_dot2c_f32_bf16 v20, v22, v6
v_dot2c_f32_bf16 v8, v11, v7
v_dot2c_f32_bf16 v12, v15, v7
v_dot2c_f32_bf16 v16, v19, v7
v_dot2c_f32_bf16 v20, v23, v7
v_add_f32_dpp v9, v8, v8 row_ror:8 row_mask:0xf bank_mask:0x3
v_add_f32_dpp v13, v12, v12 row_ror:8 row_mask:0xf bank_mask:0x3
v_add_f32_dpp v9, v16, v16 row_ror:8 row_mask:0xf bank_mask:0xc
v_add_f32_dpp v13, v20, v20 row_ror:8 row_mask:0xf bank_mask:0xc
s_nop 0
v_add_f32_dpp v17, v9, v9 row_shl:4 row_mask:0xf bank_mask:0x5
v_add_f32_dpp v17, v13, v13 row_shr:4 row_mask:0xf bank_mask:0xa
s_nop 1
v_add_f32_dpp v17, v17, v17 quad_perm:[1,0,3,2] row_mask:0xf bank_mask:0xf
s_nop 1
v_add_f32_dpp v17, v17, v17 quad_perm:[2,3,0,1] row_mask:0xf bank_mask:0xf
v_cvt_pk_bf16_f32 v17, 0, v17
v_mul_f32 v17, s66, v17
v_cvt_pk_bf16_f32 v17, 0, v17
v_dot2_f32_bf16 v24, v24, v4, 0
v_dot2_f32_bf16 v28, v28, v4, 0
v_dot2_f32_bf16 v32, v32, v4, 0
v_dot2_f32_bf16 v36, v36, v4, 0
v_dot2c_f32_bf16 v24, v25, v5
v_dot2c_f32_bf16 v28, v29, v5
v_dot2c_f32_bf16 v32, v33, v5
v_dot2c_f32_bf16 v36, v37, v5
v_dot2c_f32_bf16 v24, v26, v6
v_dot2c_f32_bf16 v28, v30, v6
v_dot2c_f32_bf16 v32, v34, v6
v_dot2c_f32_bf16 v36, v38, v6
v_dot2c_f32_bf16 v24, v27, v7
v_dot2c_f32_bf16 v28, v31, v7
v_dot2c_f32_bf16 v32, v35, v7
v_dot2c_f32_bf16 v36, v39, v7
v_add_f32_dpp v25, v24, v24 row_ror:8 row_mask:0xf bank_mask:0x3
v_add_f32_dpp v29, v28, v28 row_ror:8 row_mask:0xf bank_mask:0x3
v_add_f32_dpp v25, v32, v32 row_ror:8 row_mask:0xf bank_mask:0xc
v_add_f32_dpp v29, v36, v36 row_ror:8 row_mask:0xf bank_mask:0xc
s_nop 0
v_add_f32_dpp v8, v25, v25 row_shl:4 row_mask:0xf bank_mask:0x5
v_add_f32_dpp v8, v29, v29 row_shr:4 row_mask:0xf bank_mask:0xa
s_nop 1
v_add_f32_dpp v8, v8, v8 quad_perm:[1,0,3,2] row_mask:0xf bank_mask:0xf
s_nop 1
v_add_f32_dpp v8, v8, v8 quad_perm:[2,3,0,1] row_mask:0xf bank_mask:0xf
v_cvt_pk_bf16_f32 v8, 0, v8
v_mul_f32 v8, s66, v8
v_cvt_pk_bf16_f32 v8, 0, v8
s_xor_b32 s64, s65, 99328
s_cmpk_gt_u32 s69, 77
s_waitcnt vmcnt(6)
s_cbranch_scc1 L_d_80
s_waitcnt vmcnt(4)
L_d_80:
buffer_load_dwordx4 v[24:27], v1, s[44:47], s64 offen nt
v_dot2_f32_bf16 v40, v40, v4, 0
v_dot2_f32_bf16 v44, v44, v4, 0
v_dot2_f32_bf16 v48, v48, v4, 0
v_dot2_f32_bf16 v52, v52, v4, 0
v_dot2c_f32_bf16 v40, v41, v5
v_dot2c_f32_bf16 v44, v45, v5
v_dot2c_f32_bf16 v48, v49, v5
v_dot2c_f32_bf16 v52, v53, v5
v_dot2c_f32_bf16 v40, v42, v6
v_dot2c_f32_bf16 v44, v46, v6
v_dot2c_f32_bf16 v48, v50, v6
v_dot2c_f32_bf16 v52, v54, v6
v_dot2c_f32_bf16 v40, v43, v7
v_dot2c_f32_bf16 v44, v47, v7
v_dot2c_f32_bf16 v48, v51, v7
v_dot2c_f32_bf16 v52, v55, v7
v_add_f32_dpp v41, v40, v40 row_ror:8 row_mask:0xf bank_mask:0x3
v_add_f32_dpp v45, v44, v44 row_ror:8 row_mask:0xf bank_mask:0x3
v_add_f32_dpp v41, v48, v48 row_ror:8 row_mask:0xf bank_mask:0xc
v_add_f32_dpp v45, v52, v52 row_ror:8 row_mask:0xf bank_mask:0xc
s_nop 0
v_add_f32_dpp v9, v41, v41 row_shl:4 row_mask:0xf bank_mask:0x5
v_add_f32_dpp v9, v45, v45 row_shr:4 row_mask:0xf bank_mask:0xa
s_nop 1
v_add_f32_dpp v9, v9, v9 quad_perm:[1,0,3,2] row_mask:0xf bank_mask:0xf
s_nop 1
v_add_f32_dpp v9, v9, v9 quad_perm:[2,3,0,1] row_mask:0xf bank_mask:0xf
v_cvt_pk_bf16_f32 v9, 0, v9
v_mul_f32 v9, s66, v9
v_cvt_pk_bf16_f32 v9, 0, v9
s_xor_b32 s64, s65, 70656
s_cmpk_gt_u32 s69, 78
s_waitcnt vmcnt(6)
s_cbranch_scc1 L_d_81
s_waitcnt vmcnt(4)
L_d_81:
buffer_load_dwordx4 v[28:31], v1, s[44:47], s64 offen nt
v_dot2_f32_bf16 v56, v56, v4, 0
v_dot2_f32_bf16 v60, v60, v4, 0
v_dot2_f32_bf16 v64, v64, v4, 0
v_dot2_f32_bf16 v68, v68, v4, 0
v_dot2c_f32_bf16 v56, v57, v5
v_dot2c_f32_bf16 v60, v61, v5
v_dot2c_f32_bf16 v64, v65, v5
v_dot2c_f32_bf16 v68, v69, v5
v_dot2c_f32_bf16 v56, v58, v6
v_dot2c_f32_bf16 v60, v62, v6
v_dot2c_f32_bf16 v64, v66, v6
v_dot2c_f32_bf16 v68, v70, v6
v_dot2c_f32_bf16 v56, v59, v7
v_dot2c_f32_bf16 v60, v63, v7
v_dot2c_f32_bf16 v64, v67, v7
v_dot2c_f32_bf16 v68, v71, v7
v_add_f32_dpp v57, v56, v56 row_ror:8 row_mask:0xf bank_mask:0x3
v_add_f32_dpp v61, v60, v60 row_ror:8 row_mask:0xf bank_mask:0x3
v_add_f32_dpp v57, v64, v64 row_ror:8 row_mask:0xf bank_mask:0xc
v_add_f32_dpp v61, v68, v68 row_ror:8 row_mask:0xf bank_mask:0xc
s_nop 0
v_add_f32_dpp v10, v57, v57 row_shl:4 row_mask:0xf bank_mask:0x5
v_add_f32_dpp v10, v61, v61 row_shr:4 row_mask:0xf bank_mask:0xa
s_nop 1
v_add_f32_dpp v10, v10, v10 quad_perm:[1,0,3,2] row_mask:0xf bank_mask:0xf
s_nop 1
v_add_f32_dpp v10, v10, v10 quad_perm:[2,3,0,1] row_mask:0xf bank_mask:0xf
v_cvt_pk_bf16_f32 v10, 0, v10
v_mul_f32 v10, s66, v10
v_cvt_pk_bf16_f32 v10, 0, v10
s_xor_b32 s64, s65, 103424
s_cmpk_gt_u32 s69, 79
s_waitcnt vmcnt(6)
s_cbranch_scc1 L_d_82
s_waitcnt vmcnt(4)
L_d_82:
buffer_load_dwordx4 v[32:35], v1, s[44:47], s64 offen nt
v_dot2_f32_bf16 v72, v72, v4, 0
v_dot2_f32_bf16 v76, v76, v4, 0
v_dot2_f32_bf16 v80, v80, v4, 0
v_dot2_f32_bf16 v84, v84, v4, 0
v_dot2c_f32_bf16 v72, v73, v5
v_dot2c_f32_bf16 v76, v77, v5
v_dot2c_f32_bf16 v80, v81, v5
v_dot2c_f32_bf16 v84, v85, v5
v_dot2c_f32_bf16 v72, v74, v6
v_dot2c_f32_bf16 v76, v78, v6
v_dot2c_f32_bf16 v80, v82, v6
v_dot2c_f32_bf16 v84, v86, v6
v_dot2c_f32_bf16 v72, v75, v7
v_dot2c_f32_bf16 v76, v79, v7
v_dot2c_f32_bf16 v80, v83, v7
v_dot2c_f32_bf16 v84, v87, v7
v_add_f32_dpp v73, v72, v72 row_ror:8 row_mask:0xf bank_mask:0x3
v_add_f32_dpp v77, v76, v76 row_ror:8 row_mask:0xf bank_mask:0x3
v_add_f32_dpp v73, v80, v80 row_ror:8 row_mask:0xf bank_mask:0xc
v_add_f32_dpp v77, v84, v84 row_ror:8 row_mask:0xf bank_mask:0xc
s_nop 0
v_add_f32_dpp v11, v73, v73 row_shl:4 row_mask:0xf bank_mask:0x5
v_add_f32_dpp v11, v77, v77 row_shr:4 row_mask:0xf bank_mask:0xa
s_nop 1
v_add_f32_dpp v11, v11, v11 quad_perm:[1,0,3,2] row_mask:0xf bank_mask:0xf
s_nop 1
v_add_f32_dpp v11, v11, v11 quad_perm:[2,3,0,1] row_mask:0xf bank_mask:0xf
v_cvt_pk_bf16_f32 v11, 0, v11
v_mul_f32 v11, s66, v11
v_cvt_pk_bf16_f32 v11, 0, v11
s_xor_b32 s64, s65, 131072
s_cmpk_gt_u32 s69, 80
s_waitcnt vmcnt(6)
s_cbranch_scc1 L_d_83
s_waitcnt vmcnt(4)
L_d_83:
buffer_load_dwordx4 v[36:39], v1, s[44:47], s64 offen nt
v_dot2_f32_bf16 v88, v88, v4, 0
v_dot2_f32_bf16 v92, v92, v4, 0
v_dot2_f32_bf16 v96, v96, v4, 0
v_dot2_f32_bf16 v100, v100, v4, 0
v_dot2c_f32_bf16 v88, v89, v5
v_dot2c_f32_bf16 v92, v93, v5
v_dot2c_f32_bf16 v96, v97, v5
v_dot2c_f32_bf16 v100, v101, v5
v_dot2c_f32_bf16 v88, v90, v6
v_dot2c_f32_bf16 v92, v94, v6
v_dot2c_f32_bf16 v96, v98, v6
v_dot2c_f32_bf16 v100, v102, v6
v_dot2c_f32_bf16 v88, v91, v7
v_dot2c_f32_bf16 v92, v95, v7
v_dot2c_f32_bf16 v96, v99, v7
v_dot2c_f32_bf16 v100, v103, v7
v_add_f32_dpp v89, v88, v88 row_ror:8 row_mask:0xf bank_mask:0x3
v_add_f32_dpp v93, v92, v92 row_ror:8 row_mask:0xf bank_mask:0x3
v_add_f32_dpp v89, v96, v96 row_ror:8 row_mask:0xf bank_mask:0xc
v_add_f32_dpp v93, v100, v100 row_ror:8 row_mask:0xf bank_mask:0xc
s_nop 0
v_add_f32_dpp v12, v89, v89 row_shl:4 row_mask:0xf bank_mask:0x5
v_add_f32_dpp v12, v93, v93 row_shr:4 row_mask:0xf bank_mask:0xa
s_nop 1
v_add_f32_dpp v12, v12, v12 quad_perm:[1,0,3,2] row_mask:0xf bank_mask:0xf
s_nop 1
v_add_f32_dpp v12, v12, v12 quad_perm:[2,3,0,1] row_mask:0xf bank_mask:0xf
v_cvt_pk_bf16_f32 v12, 0, v12
v_mul_f32 v12, s66, v12
v_cvt_pk_bf16_f32 v12, 0, v12
s_xor_b32 s64, s65, 163840
s_cmpk_gt_u32 s69, 81
s_waitcnt vmcnt(6)
s_cbranch_scc1 L_d_84
s_waitcnt vmcnt(4)
L_d_84:
buffer_load_dwordx4 v[40:43], v1, s[44:47], s64 offen nt
v_dot2_f32_bf16 v104, v104, v4, 0
v_dot2_f32_bf16 v108, v108, v4, 0
v_dot2_f32_bf16 v112, v112, v4, 0
v_dot2_f32_bf16 v116, v116, v4, 0
v_dot2c_f32_bf16 v104, v105, v5
v_dot2c_f32_bf16 v108, v109, v5
v_dot2c_f32_bf16 v112, v113, v5
v_dot2c_f32_bf16 v116, v117, v5
v_dot2c_f32_bf16 v104, v106, v6
v_dot2c_f32_bf16 v108, v110, v6
v_dot2c_f32_bf16 v112, v114, v6
v_dot2c_f32_bf16 v116, v118, v6
v_dot2c_f32_bf16 v104, v107, v7
v_dot2c_f32_bf16 v108, v111, v7
v_dot2c_f32_bf16 v112, v115, v7
v_dot2c_f32_bf16 v116, v119, v7
v_add_f32_dpp v105, v104, v104 row_ror:8 row_mask:0xf bank_mask:0x3
v_add_f32_dpp v109, v108, v108 row_ror:8 row_mask:0xf bank_mask:0x3
v_add_f32_dpp v105, v112, v112 row_ror:8 row_mask:0xf bank_mask:0xc
v_add_f32_dpp v109, v116, v116 row_ror:8 row_mask:0xf bank_mask:0xc
s_nop 0
v_add_f32_dpp v13, v105, v105 row_shl:4 row_mask:0xf bank_mask:0x5
v_add_f32_dpp v13, v109, v109 row_shr:4 row_mask:0xf bank_mask:0xa
s_nop 1
v_add_f32_dpp v13, v13, v13 quad_perm:[1,0,3,2] row_mask:0xf bank_mask:0xf
s_nop 1
v_add_f32_dpp v13, v13, v13 quad_perm:[2,3,0,1] row_mask:0xf bank_mask:0xf
v_cvt_pk_bf16_f32 v13, 0, v13
v_mul_f32 v13, s66, v13
v_cvt_pk_bf16_f32 v13, 0, v13
s_xor_b32 s64, s65, 135168
s_cmpk_gt_u32 s69, 82
s_waitcnt vmcnt(6)
s_cbranch_scc1 L_d_85
s_waitcnt vmcnt(4)
L_d_85:
buffer_load_dwordx4 v[44:47], v1, s[44:47], s64 offen nt
v_dot2_f32_bf16 v120, v120, v4, 0
v_dot2_f32_bf16 v124, v124, v4, 0
v_dot2_f32_bf16 v128, v128, v4, 0
v_dot2_f32_bf16 v132, v132, v4, 0
v_dot2c_f32_bf16 v120, v121, v5
v_dot2c_f32_bf16 v124, v125, v5
v_dot2c_f32_bf16 v128, v129, v5
v_dot2c_f32_bf16 v132, v133, v5
v_dot2c_f32_bf16 v120, v122, v6
v_dot2c_f32_bf16 v124, v126, v6
v_dot2c_f32_bf16 v128, v130, v6
v_dot2c_f32_bf16 v132, v134, v6
v_dot2c_f32_bf16 v120, v123, v7
v_dot2c_f32_bf16 v124, v127, v7
v_dot2c_f32_bf16 v128, v131, v7
v_dot2c_f32_bf16 v132, v135, v7
v_add_f32_dpp v121, v120, v120 row_ror:8 row_mask:0xf bank_mask:0x3
v_add_f32_dpp v125, v124, v124 row_ror:8 row_mask:0xf bank_mask:0x3
v_add_f32_dpp v121, v128, v128 row_ror:8 row_mask:0xf bank_mask:0xc
v_add_f32_dpp v125, v132, v132 row_ror:8 row_mask:0xf bank_mask:0xc
s_nop 0
v_add_f32_dpp v14, v121, v121 row_shl:4 row_mask:0xf bank_mask:0x5
v_add_f32_dpp v14, v125, v125 row_shr:4 row_mask:0xf bank_mask:0xa
s_nop 1
v_add_f32_dpp v14, v14, v14 quad_perm:[1,0,3,2] row_mask:0xf bank_mask:0xf
s_nop 1
v_add_f32_dpp v14, v14, v14 quad_perm:[2,3,0,1] row_mask:0xf bank_mask:0xf
v_cvt_pk_bf16_f32 v14, 0, v14
v_mul_f32 v14, s66, v14
v_cvt_pk_bf16_f32 v14, 0, v14
s_xor_b32 s64, s65, 167936
s_cmpk_gt_u32 s69, 83
s_waitcnt vmcnt(6)
s_cbranch_scc1 L_d_86
s_waitcnt vmcnt(4)
L_d_86:
buffer_load_dwordx4 v[48:51], v1, s[44:47], s64 offen nt
v_dot2_f32_bf16 v136, v136, v4, 0
v_dot2_f32_bf16 v140, v140, v4, 0
v_dot2_f32_bf16 v144, v144, v4, 0
v_dot2_f32_bf16 v148, v148, v4, 0
v_dot2c_f32_bf16 v136, v137, v5
v_dot2c_f32_bf16 v140, v141, v5
v_dot2c_f32_bf16 v144, v145, v5
v_dot2c_f32_bf16 v148, v149, v5
v_dot2c_f32_bf16 v136, v138, v6
v_dot2c_f32_bf16 v140, v142, v6
v_dot2c_f32_bf16 v144, v146, v6
v_dot2c_f32_bf16 v148, v150, v6
v_dot2c_f32_bf16 v136, v139, v7
v_dot2c_f32_bf16 v140, v143, v7
v_dot2c_f32_bf16 v144, v147, v7
v_dot2c_f32_bf16 v148, v151, v7
v_add_f32_dpp v137, v136, v136 row_ror:8 row_mask:0xf bank_mask:0x3
v_add_f32_dpp v141, v140, v140 row_ror:8 row_mask:0xf bank_mask:0x3
v_add_f32_dpp v137, v144, v144 row_ror:8 row_mask:0xf bank_mask:0xc
v_add_f32_dpp v141, v148, v148 row_ror:8 row_mask:0xf bank_mask:0xc
s_nop 0
v_add_f32_dpp v15, v137, v137 row_shl:4 row_mask:0xf bank_mask:0x5
v_add_f32_dpp v15, v141, v141 row_shr:4 row_mask:0xf bank_mask:0xa
s_nop 1
v_add_f32_dpp v15, v15, v15 quad_perm:[1,0,3,2] row_mask:0xf bank_mask:0xf
s_nop 1
v_add_f32_dpp v15, v15, v15 quad_perm:[2,3,0,1] row_mask:0xf bank_mask:0xf
v_cvt_pk_bf16_f32 v15, 0, v15
v_mul_f32 v15, s66, v15
v_cvt_pk_bf16_f32 v15, 0, v15
s_xor_b32 s64, s65, 132096
s_cmpk_gt_u32 s69, 84
s_waitcnt vmcnt(6)
s_cbranch_scc1 L_d_87
s_waitcnt vmcnt(4)
L_d_87:
buffer_load_dwordx4 v[52:55], v1, s[44:47], s64 offen nt
v_dot2_f32_bf16 v152, v152, v4, 0
v_dot2_f32_bf16 v156, v156, v4, 0
v_dot2_f32_bf16 v160, v160, v4, 0
v_dot2_f32_bf16 v164, v164, v4, 0
v_dot2c_f32_bf16 v152, v153, v5
v_dot2c_f32_bf16 v156, v157, v5
v_dot2c_f32_bf16 v160, v161, v5
v_dot2c_f32_bf16 v164, v165, v5
v_dot2c_f32_bf16 v152, v154, v6
v_dot2c_f32_bf16 v156, v158, v6
v_dot2c_f32_bf16 v160, v162, v6
v_dot2c_f32_bf16 v164, v166, v6
v_dot2c_f32_bf16 v152, v155, v7
v_dot2c_f32_bf16 v156, v159, v7
v_dot2c_f32_bf16 v160, v163, v7
v_dot2c_f32_bf16 v164, v167, v7
v_add_f32_dpp v153, v152, v152 row_ror:8 row_mask:0xf bank_mask:0x3
v_add_f32_dpp v157, v156, v156 row_ror:8 row_mask:0xf bank_mask:0x3
v_add_f32_dpp v153, v160, v160 row_ror:8 row_mask:0xf bank_mask:0xc
v_add_f32_dpp v157, v164, v164 row_ror:8 row_mask:0xf bank_mask:0xc
s_nop 0
v_add_f32_dpp v16, v153, v153 row_shl:4 row_mask:0xf bank_mask:0x5
v_add_f32_dpp v16, v157, v157 row_shr:4 row_mask:0xf bank_mask:0xa
s_nop 1
v_add_f32_dpp v16, v16, v16 quad_perm:[1,0,3,2] row_mask:0xf bank_mask:0xf
s_nop 1
v_add_f32_dpp v16, v16, v16 quad_perm:[2,3,0,1] row_mask:0xf bank_mask:0xf
v_cvt_pk_bf16_f32 v16, 0, v16
v_mul_f32 v16, s66, v16
v_cvt_pk_bf16_f32 v16, 0, v16
s_xor_b32 s64, s65, 164864
s_cmpk_gt_u32 s69, 85
s_waitcnt vmcnt(6)
s_cbranch_scc1 L_d_88
s_waitcnt vmcnt(4)
L_d_88:
buffer_load_dwordx4 v[56:59], v1, s[44:47], s64 offen nt
v_dot2_f32_bf16 v168, v168, v4, 0
v_dot2_f32_bf16 v172, v172, v4, 0
v_dot2_f32_bf16 v176, v176, v4, 0
v_dot2_f32_bf16 v180, v180, v4, 0
v_dot2c_f32_bf16 v168, v169, v5
v_dot2c_f32_bf16 v172, v173, v5
v_dot2c_f32_bf16 v176, v177, v5
v_dot2c_f32_bf16 v180, v181, v5
v_dot2c_f32_bf16 v168, v170, v6
v_dot2c_f32_bf16 v172, v174, v6
v_dot2c_f32_bf16 v176, v178, v6
v_dot2c_f32_bf16 v180, v182, v6
v_dot2c_f32_bf16 v168, v171, v7
v_dot2c_f32_bf16 v172, v175, v7
v_dot2c_f32_bf16 v176, v179, v7
v_dot2c_f32_bf16 v180, v183, v7
v_add_f32_dpp v169, v168, v168 row_ror:8 row_mask:0xf bank_mask:0x3
v_add_f32_dpp v173, v172, v172 row_ror:8 row_mask:0xf bank_mask:0x3
v_add_f32_dpp v169, v176, v176 row_ror:8 row_mask:0xf bank_mask:0xc
v_add_f32_dpp v173, v180, v180 row_ror:8 row_mask:0xf bank_mask:0xc
s_nop 0
v_add_f32_dpp v18, v169, v169 row_shl:4 row_mask:0xf bank_mask:0x5
v_add_f32_dpp v18, v173, v173 row_shr:4 row_mask:0xf bank_mask:0xa
s_nop 1
v_add_f32_dpp v18, v18, v18 quad_perm:[1,0,3,2] row_mask:0xf bank_mask:0xf
s_nop 1
v_add_f32_dpp v18, v18, v18 quad_perm:[2,3,0,1] row_mask:0xf bank_mask:0xf
v_cvt_pk_bf16_f32 v18, 0, v18
v_mul_f32 v18, s66, v18
v_cvt_pk_bf16_f32 v18, 0, v18
s_xor_b32 s64, s65, 136192
s_cmpk_gt_u32 s69, 86
s_waitcnt vmcnt(6)
s_cbranch_scc1 L_d_89
s_waitcnt vmcnt(4)
L_d_89:
buffer_load_dwordx4 v[60:63], v1, s[44:47], s64 offen nt
v_dot2_f32_bf16 v184, v184, v4, 0
v_dot2_f32_bf16 v188, v188, v4, 0
v_dot2_f32_bf16 v192, v192, v4, 0
v_dot2_f32_bf16 v196, v196, v4, 0
v_dot2c_f32_bf16 v184, v185, v5
v_dot2c_f32_bf16 v188, v189, v5
v_dot2c_f32_bf16 v192, v193, v5
v_dot2c_f32_bf16 v196, v197, v5
v_dot2c_f32_bf16 v184, v186, v6
v_dot2c_f32_bf16 v188, v190, v6
v_dot2c_f32_bf16 v192, v194, v6
v_dot2c_f32_bf16 v196, v198, v6
v_dot2c_f32_bf16 v184, v187, v7
v_dot2c_f32_bf16 v188, v191, v7
v_dot2c_f32_bf16 v192, v195, v7
v_dot2c_f32_bf16 v196, v199, v7
v_add_f32_dpp v185, v184, v184 row_ror:8 row_mask:0xf bank_mask:0x3
v_add_f32_dpp v189, v188, v188 row_ror:8 row_mask:0xf bank_mask:0x3
v_add_f32_dpp v185, v192, v192 row_ror:8 row_mask:0xf bank_mask:0xc
v_add_f32_dpp v189, v196, v196 row_ror:8 row_mask:0xf bank_mask:0xc
s_nop 0
v_add_f32_dpp v19, v185, v185 row_shl:4 row_mask:0xf bank_mask:0x5
v_add_f32_dpp v19, v189, v189 row_shr:4 row_mask:0xf bank_mask:0xa
s_nop 1
v_add_f32_dpp v19, v19, v19 quad_perm:[1,0,3,2] row_mask:0xf bank_mask:0xf
s_nop 1
v_add_f32_dpp v19, v19, v19 quad_perm:[2,3,0,1] row_mask:0xf bank_mask:0xf
v_cvt_pk_bf16_f32 v19, 0, v19
v_mul_f32 v19, s66, v19
v_cvt_pk_bf16_f32 v19, 0, v19
s_xor_b32 s64, s65, 168960
s_cmpk_gt_u32 s69, 87
s_waitcnt vmcnt(6)
s_cbranch_scc1 L_d_90
s_waitcnt vmcnt(4)
L_d_90:
buffer_load_dwordx4 v[64:67], v1, s[44:47], s64 offen nt
v_dot2_f32_bf16 v200, v200, v4, 0
v_dot2_f32_bf16 v204, v204, v4, 0
v_dot2_f32_bf16 v208, v208, v4, 0
v_dot2_f32_bf16 v212, v212, v4, 0
v_dot2c_f32_bf16 v200, v201, v5
v_dot2c_f32_bf16 v204, v205, v5
v_dot2c_f32_bf16 v208, v209, v5
v_dot2c_f32_bf16 v212, v213, v5
v_dot2c_f32_bf16 v200, v202, v6
v_dot2c_f32_bf16 v204, v206, v6
v_dot2c_f32_bf16 v208, v210, v6
v_dot2c_f32_bf16 v212, v214, v6
v_dot2c_f32_bf16 v200, v203, v7
v_dot2c_f32_bf16 v204, v207, v7
v_dot2c_f32_bf16 v208, v211, v7
v_dot2c_f32_bf16 v212, v215, v7
v_add_f32_dpp v201, v200, v200 row_ror:8 row_mask:0xf bank_mask:0x3
v_add_f32_dpp v205, v204, v204 row_ror:8 row_mask:0xf bank_mask:0x3
v_add_f32_dpp v201, v208, v208 row_ror:8 row_mask:0xf bank_mask:0xc
v_add_f32_dpp v205, v212, v212 row_ror:8 row_mask:0xf bank_mask:0xc
s_nop 0
v_add_f32_dpp v20, v201, v201 row_shl:4 row_mask:0xf bank_mask:0x5
v_add_f32_dpp v20, v205, v205 row_shr:4 row_mask:0xf bank_mask:0xa
s_nop 1
v_add_f32_dpp v20, v20, v20 quad_perm:[1,0,3,2] row_mask:0xf bank_mask:0xf
s_nop 1
v_add_f32_dpp v20, v20, v20 quad_perm:[2,3,0,1] row_mask:0xf bank_mask:0xf
v_cvt_pk_bf16_f32 v20, 0, v20
v_mul_f32 v20, s66, v20
v_cvt_pk_bf16_f32 v20, 0, v20
s_xor_b32 s64, s65, 196608
s_cmpk_gt_u32 s69, 88
s_waitcnt vmcnt(6)
s_cbranch_scc1 L_d_91
s_waitcnt vmcnt(4)
L_d_91:
buffer_load_dwordx4 v[68:71], v1, s[44:47], s64 offen nt
v_dot2_f32_bf16 v216, v216, v4, 0
v_dot2_f32_bf16 v220, v220, v4, 0
v_dot2_f32_bf16 v224, v224, v4, 0
v_dot2_f32_bf16 v228, v228, v4, 0
v_dot2c_f32_bf16 v216, v217, v5
v_dot2c_f32_bf16 v220, v221, v5
v_dot2c_f32_bf16 v224, v225, v5
v_dot2c_f32_bf16 v228, v229, v5
v_dot2c_f32_bf16 v216, v218, v6
v_dot2c_f32_bf16 v220, v222, v6
v_dot2c_f32_bf16 v224, v226, v6
v_dot2c_f32_bf16 v228, v230, v6
v_dot2c_f32_bf16 v216, v219, v7
v_dot2c_f32_bf16 v220, v223, v7
v_dot2c_f32_bf16 v224, v227, v7
v_dot2c_f32_bf16 v228, v231, v7
v_add_f32_dpp v217, v216, v216 row_ror:8 row_mask:0xf bank_mask:0x3
v_add_f32_dpp v221, v220, v220 row_ror:8 row_mask:0xf bank_mask:0x3
v_add_f32_dpp v217, v224, v224 row_ror:8 row_mask:0xf bank_mask:0xc
v_add_f32_dpp v221, v228, v228 row_ror:8 row_mask:0xf bank_mask:0xc
s_nop 0
v_add_f32_dpp v21, v217, v217 row_shl:4 row_mask:0xf bank_mask:0x5
v_add_f32_dpp v21, v221, v221 row_shr:4 row_mask:0xf bank_mask:0xa
s_nop 1
v_add_f32_dpp v21, v21, v21 quad_perm:[1,0,3,2] row_mask:0xf bank_mask:0xf
s_nop 1
v_add_f32_dpp v21, v21, v21 quad_perm:[2,3,0,1] row_mask:0xf bank_mask:0xf
v_cvt_pk_bf16_f32 v21, 0, v21
v_mul_f32 v21, s66, v21
v_cvt_pk_bf16_f32 v21, 0, v21
s_xor_b32 s64, s65, 229376
s_cmpk_gt_u32 s69, 89
s_waitcnt vmcnt(6)
s_cbranch_scc1 L_d_92
s_waitcnt vmcnt(4)
L_d_92:
buffer_load_dwordx4 v[72:75], v1, s[44:47], s64 offen nt
v_dot2_f32_bf16 v232, v232, v4, 0
v_dot2_f32_bf16 v236, v236, v4, 0
v_dot2_f32_bf16 v240, v240, v4, 0
v_dot2_f32_bf16 v244, v244, v4, 0
v_dot2c_f32_bf16 v232, v233, v5
v_dot2c_f32_bf16 v236, v237, v5
v_dot2c_f32_bf16 v240, v241, v5
v_dot2c_f32_bf16 v244, v245, v5
v_dot2c_f32_bf16 v232, v234, v6
v_dot2c_f32_bf16 v236, v238, v6
v_dot2c_f32_bf16 v240, v242, v6
v_dot2c_f32_bf16 v244, v246, v6
v_dot2c_f32_bf16 v232, v235, v7
v_dot2c_f32_bf16 v236, v239, v7
v_dot2c_f32_bf16 v240, v243, v7
v_dot2c_f32_bf16 v244, v247, v7
v_add_f32_dpp v233, v232, v232 row_ror:8 row_mask:0xf bank_mask:0x3
v_add_f32_dpp v237, v236, v236 row_ror:8 row_mask:0xf bank_mask:0x3
v_add_f32_dpp v233, v240, v240 row_ror:8 row_mask:0xf bank_mask:0xc
v_add_f32_dpp v237, v244, v244 row_ror:8 row_mask:0xf bank_mask:0xc
s_nop 0
v_add_f32_dpp v22, v233, v233 row_shl:4 row_mask:0xf bank_mask:0x5
v_add_f32_dpp v22, v237, v237 row_shr:4 row_mask:0xf bank_mask:0xa
s_nop 1
v_add_f32_dpp v22, v22, v22 quad_perm:[1,0,3,2] row_mask:0xf bank_mask:0xf
s_nop 1
v_add_f32_dpp v22, v22, v22 quad_perm:[2,3,0,1] row_mask:0xf bank_mask:0xf
v_cvt_pk_bf16_f32 v22, 0, v22
v_mul_f32 v22, s66, v22
v_cvt_pk_bf16_f32 v22, 0, v22
s_xor_b32 s64, s65, 200704
s_cmpk_gt_u32 s69, 90
s_waitcnt vmcnt(6)
s_cbranch_scc1 L_d_93
s_waitcnt vmcnt(5)
L_d_93:
buffer_load_dwordx4 v[76:79], v1, s[44:47], s64 offen nt
v_lshl_add_u32 v80, v0, 4, s70
ds_read_b128 v[84:87], v80 offset:0
ds_read_b128 v[88:91], v80 offset:1024
s_waitcnt lgkmcnt(0)
v_dot2_f32_bf16 v248, v248, v4, 0
v_dot2_f32_bf16 v252, v252, v4, 0
v_dot2_f32_bf16 v84, v84, v4, 0
v_dot2_f32_bf16 v88, v88, v4, 0
v_dot2c_f32_bf16 v248, v249, v5
v_dot2c_f32_bf16 v252, v253, v5
v_dot2c_f32_bf16 v84, v85, v5
v_dot2c_f32_bf16 v88, v89, v5
v_dot2c_f32_bf16 v248, v250, v6
v_dot2c_f32_bf16 v252, v254, v6
v_dot2c_f32_bf16 v84, v86, v6
v_dot2c_f32_bf16 v88, v90, v6
v_dot2c_f32_bf16 v248, v251, v7
v_dot2c_f32_bf16 v252, v255, v7
v_dot2c_f32_bf16 v84, v87, v7
v_dot2c_f32_bf16 v88, v91, v7
v_add_f32_dpp v249, v248, v248 row_ror:8 row_mask:0xf bank_mask:0x3
v_add_f32_dpp v253, v252, v252 row_ror:8 row_mask:0xf bank_mask:0x3
v_add_f32_dpp v249, v84, v84 row_ror:8 row_mask:0xf bank_mask:0xc
v_add_f32_dpp v253, v88, v88 row_ror:8 row_mask:0xf bank_mask:0xc
s_nop 0
v_add_f32_dpp v23, v249, v249 row_shl:4 row_mask:0xf bank_mask:0x5
v_add_f32_dpp v23, v253, v253 row_shr:4 row_mask:0xf bank_mask:0xa
s_nop 1
v_add_f32_dpp v23, v23, v23 quad_perm:[1,0,3,2] row_mask:0xf bank_mask:0xf
s_nop 1
v_add_f32_dpp v23, v23, v23 quad_perm:[2,3,0,1] row_mask:0xf bank_mask:0xf
v_cvt_pk_bf16_f32 v23, 0, v23
v_mul_f32 v23, s66, v23
v_cvt_pk_bf16_f32 v23, 0, v23
s_xor_b32 s64, s65, 233472
s_cmpk_gt_u32 s69, 91
s_waitcnt vmcnt(6)
s_cbranch_scc1 L_d_94
s_waitcnt vmcnt(5)
L_d_94:
buffer_load_dwordx4 v[92:95], v1, s[44:47], s64 offen nt
v_max3_f32 v2, v17, v8, v9
v_max3_f32 v2, v2, v10, v11
v_max3_f32 v2, v2, v12, v13
v_max3_f32 v2, v2, v14, v15
v_max3_f32 v2, v2, v16, v18
v_max3_f32 v2, v2, v19, v20
v_max3_f32 v2, v2, v21, v22
v_max_f32 v2, v2, v23
v_max_f32 v2, 0xff7fffff, v2
s_nop 1
v_max_f32_dpp v2, v2, v2 row_ror:4 row_mask:0xf bank_mask:0xf
s_nop 1
v_max_f32_dpp v2, v2, v2 row_ror:8 row_mask:0xf bank_mask:0xf
v_mov_b32 v3, v2
s_nop 1
v_permlane16_swap_b32 v2, v3
s_nop 1
v_max_f32 v2, v2, v3
v_mov_b32 v3, v2
s_nop 1
v_permlane32_swap_b32 v2, v3
s_nop 1
v_max_f32 v2, v2, v3
s_mov_b32 s67, 0x3fb8aa3b
v_sub_f32 v17, v17, v2
v_sub_f32 v8, v8, v2
v_sub_f32 v9, v9, v2
v_sub_f32 v10, v10, v2
v_sub_f32 v11, v11, v2
v_sub_f32 v12, v12, v2
v_sub_f32 v13, v13, v2
v_sub_f32 v14, v14, v2
v_sub_f32 v15, v15, v2
v_sub_f32 v16, v16, v2
v_sub_f32 v18, v18, v2
v_sub_f32 v19, v19, v2
v_sub_f32 v20, v20, v2
v_sub_f32 v21, v21, v2
v_sub_f32 v22, v22, v2
v_sub_f32 v23, v23, v2
v_mul_f32 v17, s67, v17
v_mul_f32 v8, s67, v8
v_mul_f32 v9, s67, v9
v_mul_f32 v10, s67, v10
v_mul_f32 v11, s67, v11
v_mul_f32 v12, s67, v12
v_mul_f32 v13, s67, v13
v_mul_f32 v14, s67, v14
v_mul_f32 v15, s67, v15
v_mul_f32 v16, s67, v16
v_mul_f32 v18, s67, v18
v_mul_f32 v19, s67, v19
v_mul_f32 v20, s67, v20
v_mul_f32 v21, s67, v21
v_mul_f32 v22, s67, v22
v_mul_f32 v23, s67, v23
s_xor_b32 s64, s65, 197632
s_cmpk_gt_u32 s69, 92
s_waitcnt vmcnt(6)
s_cbranch_scc1 L_d_95
s_waitcnt vmcnt(5)
L_d_95:
buffer_load_dwordx4 v[116:119], v1, s[44:47], s64 offen nt
v_exp_f32 v17, v17
v_exp_f32 v8, v8
v_exp_f32 v9, v9
v_exp_f32 v10, v10
v_exp_f32 v11, v11
v_exp_f32 v12, v12
v_exp_f32 v13, v13
v_exp_f32 v14, v14
v_exp_f32 v15, v15
v_exp_f32 v16, v16
v_exp_f32 v18, v18
v_exp_f32 v19, v19
v_exp_f32 v20, v20
v_exp_f32 v21, v21
v_exp_f32 v22, v22
v_exp_f32 v23, v23
v_add_f32 v3, v17, v8
v_add_f32 v3, v3, v9
v_add_f32 v3, v3, v10
v_add_f32 v3, v3, v11
v_add_f32 v3, v3, v12
v_add_f32 v3, v3, v13
v_add_f32 v3, v3, v14
v_add_f32 v3, v3, v15
v_add_f32 v3, v3, v16
v_add_f32 v3, v3, v18
v_add_f32 v3, v3, v19
v_add_f32 v3, v3, v20
v_add_f32 v3, v3, v21
v_add_f32 v3, v3, v22
v_add_f32 v3, v3, v23
s_nop 1
v_add_f32_dpp v3, v3, v3 row_ror:4 row_mask:0xf bank_mask:0xf
s_nop 1
v_add_f32_dpp v3, v3, v3 row_ror:8 row_mask:0xf bank_mask:0xf
v_mov_b32 v96, v3
s_nop 1
v_permlane16_swap_b32 v3, v96
s_nop 1
v_add_f32 v3, v3, v96
v_mov_b32 v96, v3
s_nop 1
v_permlane32_swap_b32 v3, v96
s_nop 1
v_add_f32 v3, v3, v96
v_min_u32 v3, -2, v3
s_lshl_b32 s68, s34, 3
v_mov_b32 v96, s68
ds_write_b64 v96, v[2:3] offset:256
v_and_b32 v97, 15, v0
v_lshrrev_b32 v98, 1, v97
v_and_b32 v97, 1, v0
v_lshlrev_b32 v97, 4, v97
v_mov_b32 v99, 0xffff
v_lshlrev_b32 v97, v97, v99
v_cmp_eq_u32 vcc, 0, v98
s_nop 1
v_cndmask_b32 v4, 0, v97, vcc
v_cmp_eq_u32 vcc, 1, v98
s_nop 1
v_cndmask_b32 v5, 0, v97, vcc
v_cmp_eq_u32 vcc, 2, v98
s_nop 1
v_cndmask_b32 v6, 0, v97, vcc
v_cmp_eq_u32 vcc, 3, v98
s_nop 1
v_cndmask_b32 v7, 0, v97, vcc
s_xor_b32 s64, s65, 230400
s_cmpk_gt_u32 s69, 93
s_waitcnt vmcnt(6)
s_cbranch_scc1 L_d_96
s_waitcnt vmcnt(5)
L_d_96:
buffer_load_dwordx4 v[120:123], v1, s[44:47], s64 offen nt
v_mov_b32 v96, 0
s_mov_b32 s75, 0
L_poll_97:
ds_read_b128 v[100:103], v96 offset:256
ds_read_b128 v[104:107], v96 offset:272
s_waitcnt lgkmcnt(0)
v_max3_u32 v97, v101, v103, v105
v_max_u32 v97, v97, v107
v_cmp_eq_u32 vcc, -1, v97
s_cbranch_vccz L_pollx_98
s_add_u32 s75, s75, 1
s_cmp_lt_u32 s75, 0x1000000
s_cbranch_scc1 L_poll_97
L_pollx_98:
v_max3_f32 v97, v100, v102, v104
v_max_f32 v97, v97, v106
v_sub_f32 v100, v100, v97
v_sub_f32 v102, v102, v97
v_sub_f32 v104, v104, v97
v_sub_f32 v106, v106, v97
v_sub_f32 v2, v2, v97
v_mul_f32 v100, s67, v100
v_mul_f32 v102, s67, v102
v_mul_f32 v104, s67, v104
v_mul_f32 v106, s67, v106
v_mul_f32 v2, s67, v2
v_exp_f32 v100, v100
v_exp_f32 v102, v102
v_exp_f32 v104, v104
v_exp_f32 v106, v106
v_exp_f32 v2, v2
v_mul_f32 v3, v100, v101
v_fmac_f32 v3, v102, v103
v_fmac_f32 v3, v104, v105
v_fmac_f32 v3, v106, v107
v_rcp_f32 v3, v3
s_nop 0
v_mul_f32 v2, v2, v3
v_mul_f32 v17, v17, v2
v_mul_f32 v8, v8, v2
v_mul_f32 v9, v9, v2
v_mul_f32 v10, v10, v2
v_mul_f32 v11, v11, v2
v_mul_f32 v12, v12, v2
v_mul_f32 v13, v13, v2
v_mul_f32 v14, v14, v2
v_mul_f32 v15, v15, v2
v_mul_f32 v16, v16, v2
v_mul_f32 v18, v18, v2
v_mul_f32 v19, v19, v2
v_mul_f32 v20, v20, v2
v_mul_f32 v21, v21, v2
v_mul_f32 v22, v22, v2
v_mul_f32 v23, v23, v2
v_cvt_pk_bf16_f32 v17, v17, v17
v_cvt_pk_bf16_f32 v8, v8, v8
v_cvt_pk_bf16_f32 v9, v9, v9
v_cvt_pk_bf16_f32 v10, v10, v10
v_cvt_pk_bf16_f32 v11, v11, v11
v_cvt_pk_bf16_f32 v12, v12, v12
v_cvt_pk_bf16_f32 v13, v13, v13
v_cvt_pk_bf16_f32 v14, v14, v14
v_cvt_pk_bf16_f32 v15, v15, v15
v_cvt_pk_bf16_f32 v16, v16, v16
v_cvt_pk_bf16_f32 v18, v18, v18
v_cvt_pk_bf16_f32 v19, v19, v19
v_cvt_pk_bf16_f32 v20, v20, v20
v_cvt_pk_bf16_f32 v21, v21, v21
v_cvt_pk_bf16_f32 v22, v22, v22
v_cvt_pk_bf16_f32 v23, v23, v23
s_nop 1
s_and_b32 s62, s2, 7
s_lshl_b32 s62, s62, 9
s_add_u32 s62, s62, 1327104
s_lshr_b32 s63, s2, 3
s_lshl_b32 s63, s63, 2
s_add_u32 s63, s63, s62
s_cmp_eq_u32 s34, 0
s_cbranch_scc0 L_w_100
v_mov_b32 v124, 30
s_mov_b64 exec, 1
buffer_store_dword v124, off, s[36:39], s63 offset:0
s_mov_b64 exec, -1
L_w_100:
s_xor_b32 s64, s65, 201728
s_cmpk_gt_u32 s69, 94
s_waitcnt vmcnt(6)
s_cbranch_scc1 L_d_99
s_waitcnt vmcnt(5)
L_d_99:
buffer_load_dwordx4 v[128:131], v1, s[44:47], s64 offen nt
ds_read_b128 v[132:135], v80 offset:2048
ds_read_b128 v[136:139], v80 offset:3072
ds_read_b128 v[140:143], v80 offset:4096
ds_read_b128 v[144:147], v80 offset:5120
ds_read_b128 v[148:151], v80 offset:6144
ds_read_b128 v[152:155], v80 offset:7168
ds_read_b128 v[156:159], v80 offset:8192
ds_read_b128 v[160:163], v80 offset:9216
s_waitcnt lgkmcnt(0)
v_and_b32_dpp v100, v17, v4 row_newbcast:0 row_mask:0xf bank_mask:0xf
v_and_b32_dpp v101, v17, v5 row_newbcast:0 row_mask:0xf bank_mask:0xf
v_and_b32_dpp v102, v17, v6 row_newbcast:0 row_mask:0xf bank_mask:0xf
v_and_b32_dpp v103, v17, v7 row_newbcast:0 row_mask:0xf bank_mask:0xf
v_and_b32_dpp v104, v17, v4 row_newbcast:4 row_mask:0xf bank_mask:0xf
v_and_b32_dpp v105, v17, v5 row_newbcast:4 row_mask:0xf bank_mask:0xf
v_and_b32_dpp v106, v17, v6 row_newbcast:4 row_mask:0xf bank_mask:0xf
v_and_b32_dpp v107, v17, v7 row_newbcast:4 row_mask:0xf bank_mask:0xf
v_mfma_f32_16x16x32_bf16 v[108:111], v[100:103], v[132:135], 0
v_and_b32_dpp v100, v17, v4 row_newbcast:8 row_mask:0xf bank_mask:0xf
v_and_b32_dpp v101, v17, v5 row_newbcast:8 row_mask:0xf bank_mask:0xf
v_and_b32_dpp v102, v17, v6 row_newbcast:8 row_mask:0xf bank_mask:0xf
v_and_b32_dpp v103, v17, v7 row_newbcast:8 row_mask:0xf bank_mask:0xf
v_mfma_f32_16x16x32_bf16 v[108:111], v[104:107], v[136:139], v[108:111]
v_and_b32_dpp v104, v17, v4 row_newbcast:12 row_mask:0xf bank_mask:0xf
v_and_b32_dpp v105, v17, v5 row_newbcast:12 row_mask:0xf bank_mask:0xf
v_and_b32_dpp v106, v17, v6 row_newbcast:12 row_mask:0xf bank_mask:0xf
v_and_b32_dpp v107, v17, v7 row_newbcast:12 row_mask:0xf bank_mask:0xf
v_mfma_f32_16x16x32_bf16 v[108:111], v[100:103], v[140:143], v[108:111]
v_and_b32_dpp v100, v8, v4 row_newbcast:0 row_mask:0xf bank_mask:0xf
v_and_b32_dpp v101, v8, v5 row_newbcast:0 row_mask:0xf bank_mask:0xf
v_and_b32_dpp v102, v8, v6 row_newbcast:0 row_mask:0xf bank_mask:0xf
v_and_b32_dpp v103, v8, v7 row_newbcast:0 row_mask:0xf bank_mask:0xf
v_mfma_f32_16x16x32_bf16 v[108:111], v[104:107], v[144:147], v[108:111]
v_and_b32_dpp v104, v8, v4 row_newbcast:4 row_mask:0xf bank_mask:0xf
v_and_b32_dpp v105, v8, v5 row_newbcast:4 row_mask:0xf bank_mask:0xf
v_and_b32_dpp v106, v8, v6 row_newbcast:4 row_mask:0xf bank_mask:0xf
v_and_b32_dpp v107, v8, v7 row_newbcast:4 row_mask:0xf bank_mask:0xf
v_mfma_f32_16x16x32_bf16 v[108:111], v[100:103], v[148:151], v[108:111]
s_xor_b32 s64, s65, 234496
s_cmpk_gt_u32 s69, 95
s_waitcnt vmcnt(6)
s_cbranch_scc1 L_d_101
s_waitcnt vmcnt(5)
L_d_101:
buffer_load_dwordx4 v[164:167], v1, s[44:47], s64 offen nt
v_and_b32_dpp v100, v8, v4 row_newbcast:8 row_mask:0xf bank_mask:0xf
v_and_b32_dpp v101, v8, v5 row_newbcast:8 row_mask:0xf bank_mask:0xf
v_and_b32_dpp v102, v8, v6 row_newbcast:8 row_mask:0xf bank_mask:0xf
v_and_b32_dpp v103, v8, v7 row_newbcast:8 row_mask:0xf bank_mask:0xf
v_mfma_f32_16x16x32_bf16 v[108:111], v[104:107], v[152:155], v[108:111]
v_and_b32_dpp v104, v8, v4 row_newbcast:12 row_mask:0xf bank_mask:0xf
v_and_b32_dpp v105, v8, v5 row_newbcast:12 row_mask:0xf bank_mask:0xf
v_and_b32_dpp v106, v8, v6 row_newbcast:12 row_mask:0xf bank_mask:0xf
v_and_b32_dpp v107, v8, v7 row_newbcast:12 row_mask:0xf bank_mask:0xf
v_mfma_f32_16x16x32_bf16 v[108:111], v[100:103], v[156:159], v[108:111]
v_and_b32_dpp v100, v9, v4 row_newbcast:0 row_mask:0xf bank_mask:0xf
v_and_b32_dpp v101, v9, v5 row_newbcast:0 row_mask:0xf bank_mask:0xf
v_and_b32_dpp v102, v9, v6 row_newbcast:0 row_mask:0xf bank_mask:0xf
v_and_b32_dpp v103, v9, v7 row_newbcast:0 row_mask:0xf bank_mask:0xf
v_mfma_f32_16x16x32_bf16 v[108:111], v[104:107], v[160:163], v[108:111]
ds_read_b128 v[168:171], v80 offset:10240
ds_read_b128 v[172:175], v80 offset:11264
ds_read_b128 v[176:179], v80 offset:12288
ds_read_b128 v[180:183], v80 offset:13312
ds_read_b128 v[184:187], v80 offset:14336
s_waitcnt lgkmcnt(0)
v_and_b32_dpp v104, v9, v4 row_newbcast:4 row_mask:0xf bank_mask:0xf
v_and_b32_dpp v105, v9, v5 row_newbcast:4 row_mask:0xf bank_mask:0xf
v_and_b32_dpp v106, v9, v6 row_newbcast:4 row_mask:0xf bank_mask:0xf
v_and_b32_dpp v107, v9, v7 row_newbcast:4 row_mask:0xf bank_mask:0xf
v_mfma_f32_16x16x32_bf16 v[108:111], v[100:103], v[168:171], v[108:111]
v_and_b32_dpp v100, v9, v4 row_newbcast:8 row_mask:0xf bank_mask:0xf
v_and_b32_dpp v101, v9, v5 row_newbcast:8 row_mask:0xf bank_mask:0xf
v_and_b32_dpp v102, v9, v6 row_newbcast:8 row_mask:0xf bank_mask:0xf
v_and_b32_dpp v103, v9, v7 row_newbcast:8 row_mask:0xf bank_mask:0xf
v_mfma_f32_16x16x32_bf16 v[108:111], v[104:107], v[172:175], v[108:111]
s_xor_b32 s64, s65, 2048
s_cmpk_gt_u32 s69, 96
s_waitcnt vmcnt(6)
s_cbranch_scc1 L_d_102
s_waitcnt vmcnt(5)
L_d_102:
buffer_load_dwordx4 v[188:191], v1, s[44:47], s64 offen nt
v_and_b32_dpp v104, v9, v4 row_newbcast:12 row_mask:0xf bank_mask:0xf
v_and_b32_dpp v105, v9, v5 row_newbcast:12 row_mask:0xf bank_mask:0xf
v_and_b32_dpp v106, v9, v6 row_newbcast:12 row_mask:0xf bank_mask:0xf
v_and_b32_dpp v107, v9, v7 row_newbcast:12 row_mask:0xf bank_mask:0xf
v_mfma_f32_16x16x32_bf16 v[108:111], v[100:103], v[176:179], v[108:111]
v_and_b32_dpp v100, v10, v4 row_newbcast:0 row_mask:0xf bank_mask:0xf
v_and_b32_dpp v101, v10, v5 row_newbcast:0 row_mask:0xf bank_mask:0xf
v_and_b32_dpp v102, v10, v6 row_newbcast:0 row_mask:0xf bank_mask:0xf
v_and_b32_dpp v103, v10, v7 row_newbcast:0 row_mask:0xf bank_mask:0xf
v_mfma_f32_16x16x32_bf16 v[108:111], v[104:107], v[180:183], v[108:111]
v_and_b32_dpp v104, v10, v4 row_newbcast:4 row_mask:0xf bank_mask:0xf
v_and_b32_dpp v105, v10, v5 row_newbcast:4 row_mask:0xf bank_mask:0xf
v_and_b32_dpp v106, v10, v6 row_newbcast:4 row_mask:0xf bank_mask:0xf
v_and_b32_dpp v107, v10, v7 row_newbcast:4 row_mask:0xf bank_mask:0xf
v_mfma_f32_16x16x32_bf16 v[108:111], v[100:103], v[184:187], v[108:111]
v_and_b32_dpp v100, v10, v4 row_newbcast:8 row_mask:0xf bank_mask:0xf
v_and_b32_dpp v101, v10, v5 row_newbcast:8 row_mask:0xf bank_mask:0xf
v_and_b32_dpp v102, v10, v6 row_newbcast:8 row_mask:0xf bank_mask:0xf
v_and_b32_dpp v103, v10, v7 row_newbcast:8 row_mask:0xf bank_mask:0xf
v_mfma_f32_16x16x32_bf16 v[108:111], v[104:107], v[24:27], v[108:111]
v_and_b32_dpp v104, v10, v4 row_newbcast:12 row_mask:0xf bank_mask:0xf
v_and_b32_dpp v105, v10, v5 row_newbcast:12 row_mask:0xf bank_mask:0xf
v_and_b32_dpp v106, v10, v6 row_newbcast:12 row_mask:0xf bank_mask:0xf
v_and_b32_dpp v107, v10, v7 row_newbcast:12 row_mask:0xf bank_mask:0xf
v_mfma_f32_16x16x32_bf16 v[108:111], v[100:103], v[28:31], v[108:111]
s_xor_b32 s64, s65, 34816
s_cmpk_gt_u32 s69, 97
s_waitcnt vmcnt(6)
s_cbranch_scc1 L_d_103
s_waitcnt vmcnt(5)
L_d_103:
buffer_load_dwordx4 v[192:195], v1, s[44:47], s64 offen nt
v_and_b32_dpp v100, v11, v4 row_newbcast:0 row_mask:0xf bank_mask:0xf
v_and_b32_dpp v101, v11, v5 row_newbcast:0 row_mask:0xf bank_mask:0xf
v_and_b32_dpp v102, v11, v6 row_newbcast:0 row_mask:0xf bank_mask:0xf
v_and_b32_dpp v103, v11, v7 row_newbcast:0 row_mask:0xf bank_mask:0xf
v_mfma_f32_16x16x32_bf16 v[108:111], v[104:107], v[32:35], v[108:111]
v_and_b32_dpp v104, v11, v4 row_newbcast:4 row_mask:0xf bank_mask:0xf
v_and_b32_dpp v105, v11, v5 row_newbcast:4 row_mask:0xf bank_mask:0xf
v_and_b32_dpp v106, v11, v6 row_newbcast:4 row_mask:0xf bank_mask:0xf
v_and_b32_dpp v107, v11, v7 row_newbcast:4 row_mask:0xf bank_mask:0xf
v_mfma_f32_16x16x32_bf16 v[108:111], v[100:103], v[36:39], v[108:111]
v_and_b32_dpp v100, v11, v4 row_newbcast:8 row_mask:0xf bank_mask:0xf
v_and_b32_dpp v101, v11, v5 row_newbcast:8 row_mask:0xf bank_mask:0xf
v_and_b32_dpp v102, v11, v6 row_newbcast:8 row_mask:0xf bank_mask:0xf
v_and_b32_dpp v103, v11, v7 row_newbcast:8 row_mask:0xf bank_mask:0xf
v_mfma_f32_16x16x32_bf16 v[108:111], v[104:107], v[40:43], v[108:111]
v_and_b32_dpp v104, v11, v4 row_newbcast:12 row_mask:0xf bank_mask:0xf
v_and_b32_dpp v105, v11, v5 row_newbcast:12 row_mask:0xf bank_mask:0xf
v_and_b32_dpp v106, v11, v6 row_newbcast:12 row_mask:0xf bank_mask:0xf
v_and_b32_dpp v107, v11, v7 row_newbcast:12 row_mask:0xf bank_mask:0xf
v_mfma_f32_16x16x32_bf16 v[108:111], v[100:103], v[44:47], v[108:111]
v_and_b32_dpp v100, v12, v4 row_newbcast:0 row_mask:0xf bank_mask:0xf
v_and_b32_dpp v101, v12, v5 row_newbcast:0 row_mask:0xf bank_mask:0xf
v_and_b32_dpp v102, v12, v6 row_newbcast:0 row_mask:0xf bank_mask:0xf
v_and_b32_dpp v103, v12, v7 row_newbcast:0 row_mask:0xf bank_mask:0xf
v_mfma_f32_16x16x32_bf16 v[108:111], v[104:107], v[48:51], v[108:111]
s_xor_b32 s64, s65, 6144
s_cmpk_gt_u32 s69, 98
s_waitcnt vmcnt(6)
s_cbranch_scc1 L_d_104
s_waitcnt vmcnt(5)
L_d_104:
buffer_load_dwordx4 v[196:199], v1, s[44:47], s64 offen nt
v_and_b32_dpp v104, v12, v4 row_newbcast:4 row_mask:0xf bank_mask:0xf
v_and_b32_dpp v105, v12, v5 row_newbcast:4 row_mask:0xf bank_mask:0xf
v_and_b32_dpp v106, v12, v6 row_newbcast:4 row_mask:0xf bank_mask:0xf
v_and_b32_dpp v107, v12, v7 row_newbcast:4 row_mask:0xf bank_mask:0xf
v_mfma_f32_16x16x32_bf16 v[108:111], v[100:103], v[52:55], v[108:111]
v_and_b32_dpp v100, v12, v4 row_newbcast:8 row_mask:0xf bank_mask:0xf
v_and_b32_dpp v101, v12, v5 row_newbcast:8 row_mask:0xf bank_mask:0xf
v_and_b32_dpp v102, v12, v6 row_newbcast:8 row_mask:0xf bank_mask:0xf
v_and_b32_dpp v103, v12, v7 row_newbcast:8 row_mask:0xf bank_mask:0xf
v_mfma_f32_16x16x32_bf16 v[108:111], v[104:107], v[56:59], v[108:111]
v_and_b32_dpp v104, v12, v4 row_newbcast:12 row_mask:0xf bank_mask:0xf
v_and_b32_dpp v105, v12, v5 row_newbcast:12 row_mask:0xf bank_mask:0xf
v_and_b32_dpp v106, v12, v6 row_newbcast:12 row_mask:0xf bank_mask:0xf
v_and_b32_dpp v107, v12, v7 row_newbcast:12 row_mask:0xf bank_mask:0xf
v_mfma_f32_16x16x32_bf16 v[108:111], v[100:103], v[60:63], v[108:111]
v_and_b32_dpp v100, v13, v4 row_newbcast:0 row_mask:0xf bank_mask:0xf
v_and_b32_dpp v101, v13, v5 row_newbcast:0 row_mask:0xf bank_mask:0xf
v_and_b32_dpp v102, v13, v6 row_newbcast:0 row_mask:0xf bank_mask:0xf
v_and_b32_dpp v103, v13, v7 row_newbcast:0 row_mask:0xf bank_mask:0xf
v_mfma_f32_16x16x32_bf16 v[108:111], v[104:107], v[64:67], v[108:111]
v_and_b32_dpp v104, v13, v4 row_newbcast:4 row_mask:0xf bank_mask:0xf
v_and_b32_dpp v105, v13, v5 row_newbcast:4 row_mask:0xf bank_mask:0xf
v_and_b32_dpp v106, v13, v6 row_newbcast:4 row_mask:0xf bank_mask:0xf
v_and_b32_dpp v107, v13, v7 row_newbcast:4 row_mask:0xf bank_mask:0xf
v_mfma_f32_16x16x32_bf16 v[108:111], v[100:103], v[68:71], v[108:111]
s_xor_b32 s64, s65, 38912
s_cmpk_gt_u32 s69, 99
s_waitcnt vmcnt(6)
s_cbranch_scc1 L_d_105
s_waitcnt vmcnt(5)
L_d_105:
buffer_load_dwordx4 v[200:203], v1, s[44:47], s64 offen nt
v_and_b32_dpp v100, v13, v4 row_newbcast:8 row_mask:0xf bank_mask:0xf
v_and_b32_dpp v101, v13, v5 row_newbcast:8 row_mask:0xf bank_mask:0xf
v_and_b32_dpp v102, v13, v6 row_newbcast:8 row_mask:0xf bank_mask:0xf
v_and_b32_dpp v103, v13, v7 row_newbcast:8 row_mask:0xf bank_mask:0xf
v_mfma_f32_16x16x32_bf16 v[108:111], v[104:107], v[72:75], v[108:111]
v_and_b32_dpp v104, v13, v4 row_newbcast:12 row_mask:0xf bank_mask:0xf
v_and_b32_dpp v105, v13, v5 row_newbcast:12 row_mask:0xf bank_mask:0xf
v_and_b32_dpp v106, v13, v6 row_newbcast:12 row_mask:0xf bank_mask:0xf
v_and_b32_dpp v107, v13, v7 row_newbcast:12 row_mask:0xf bank_mask:0xf
v_mfma_f32_16x16x32_bf16 v[108:111], v[100:103], v[76:79], v[108:111]
v_and_b32_dpp v100, v14, v4 row_newbcast:0 row_mask:0xf bank_mask:0xf
v_and_b32_dpp v101, v14, v5 row_newbcast:0 row_mask:0xf bank_mask:0xf
v_and_b32_dpp v102, v14, v6 row_newbcast:0 row_mask:0xf bank_mask:0xf
v_and_b32_dpp v103, v14, v7 row_newbcast:0 row_mask:0xf bank_mask:0xf
v_mfma_f32_16x16x32_bf16 v[108:111], v[104:107], v[92:95], v[108:111]
v_and_b32_dpp v104, v14, v4 row_newbcast:4 row_mask:0xf bank_mask:0xf
v_and_b32_dpp v105, v14, v5 row_newbcast:4 row_mask:0xf bank_mask:0xf
v_and_b32_dpp v106, v14, v6 row_newbcast:4 row_mask:0xf bank_mask:0xf
v_and_b32_dpp v107, v14, v7 row_newbcast:4 row_mask:0xf bank_mask:0xf
v_mfma_f32_16x16x32_bf16 v[108:111], v[100:103], v[116:119], v[108:111]
s_xor_b32 s64, s65, 3072
s_cmpk_gt_u32 s69, 100
s_waitcnt vmcnt(6)
s_cbranch_scc1 L_d_106
s_waitcnt vmcnt(5)
L_d_106:
buffer_load_dwordx4 v[204:207], v1, s[44:47], s64 offen nt
v_and_b32_dpp v100, v14, v4 row_newbcast:8 row_mask:0xf bank_mask:0xf
v_and_b32_dpp v101, v14, v5 row_newbcast:8 row_mask:0xf bank_mask:0xf
v_and_b32_dpp v102, v14, v6 row_newbcast:8 row_mask:0xf bank_mask:0xf
v_and_b32_dpp v103, v14, v7 row_newbcast:8 row_mask:0xf bank_mask:0xf
v_mfma_f32_16x16x32_bf16 v[108:111], v[104:107], v[120:123], v[108:111]
s_xor_b32 s64, s65, 35840
s_cmpk_gt_u32 s69, 101
s_waitcnt vmcnt(6)
s_cbranch_scc1 L_d_107
s_waitcnt vmcnt(5)
L_d_107:
buffer_load_dwordx4 v[208:211], v1, s[44:47], s64 offen nt
v_and_b32_dpp v104, v14, v4 row_newbcast:12 row_mask:0xf bank_mask:0xf
v_and_b32_dpp v105, v14, v5 row_newbcast:12 row_mask:0xf bank_mask:0xf
v_and_b32_dpp v106, v14, v6 row_newbcast:12 row_mask:0xf bank_mask:0xf
v_and_b32_dpp v107, v14, v7 row_newbcast:12 row_mask:0xf bank_mask:0xf
v_mfma_f32_16x16x32_bf16 v[108:111], v[100:103], v[128:131], v[108:111]
s_cmp_eq_u32 s34, 1
s_cbranch_scc0 L_w_109
v_mov_b32 v124, 38
s_mov_b64 exec, 1
buffer_store_dword v124, off, s[36:39], s63 offset:0
s_mov_b64 exec, -1
L_w_109:
s_xor_b32 s64, s65, 7168
s_cmpk_gt_u32 s69, 102
s_waitcnt vmcnt(6)
s_cbranch_scc1 L_d_108
s_waitcnt vmcnt(5)
L_d_108:
buffer_load_dwordx4 v[212:215], v1, s[44:47], s64 offen nt
v_and_b32_dpp v100, v15, v4 row_newbcast:0 row_mask:0xf bank_mask:0xf
v_and_b32_dpp v101, v15, v5 row_newbcast:0 row_mask:0xf bank_mask:0xf
v_and_b32_dpp v102, v15, v6 row_newbcast:0 row_mask:0xf bank_mask:0xf
v_and_b32_dpp v103, v15, v7 row_newbcast:0 row_mask:0xf bank_mask:0xf
v_mfma_f32_16x16x32_bf16 v[108:111], v[104:107], v[164:167], v[108:111]
s_xor_b32 s64, s65, 39936
s_cmpk_gt_u32 s69, 103
s_waitcnt vmcnt(6)
s_cbranch_scc1 L_d_110
s_waitcnt vmcnt(5)
L_d_110:
buffer_load_dwordx4 v[216:219], v1, s[44:47], s64 offen nt
v_and_b32_dpp v104, v15, v4 row_newbcast:4 row_mask:0xf bank_mask:0xf
v_and_b32_dpp v105, v15, v5 row_newbcast:4 row_mask:0xf bank_mask:0xf
v_and_b32_dpp v106, v15, v6 row_newbcast:4 row_mask:0xf bank_mask:0xf
v_and_b32_dpp v107, v15, v7 row_newbcast:4 row_mask:0xf bank_mask:0xf
v_mfma_f32_16x16x32_bf16 v[108:111], v[100:103], v[188:191], v[108:111]
s_xor_b32 s64, s65, 67584
s_cmpk_gt_u32 s69, 104
s_waitcnt vmcnt(6)
s_cbranch_scc1 L_d_111
s_waitcnt vmcnt(5)
L_d_111:
buffer_load_dwordx4 v[220:223], v1, s[44:47], s64 offen nt
v_and_b32_dpp v100, v15, v4 row_newbcast:8 row_mask:0xf bank_mask:0xf
v_and_b32_dpp v101, v15, v5 row_newbcast:8 row_mask:0xf bank_mask:0xf
v_and_b32_dpp v102, v15, v6 row_newbcast:8 row_mask:0xf bank_mask:0xf
v_and_b32_dpp v103, v15, v7 row_newbcast:8 row_mask:0xf bank_mask:0xf
v_mfma_f32_16x16x32_bf16 v[108:111], v[104:107], v[192:195], v[108:111]
s_xor_b32 s64, s65, 100352
s_cmpk_gt_u32 s69, 105
s_waitcnt vmcnt(6)
s_cbranch_scc1 L_d_112
s_waitcnt vmcnt(5)
L_d_112:
buffer_load_dwordx4 v[224:227], v1, s[44:47], s64 offen nt
v_and_b32_dpp v104, v15, v4 row_newbcast:12 row_mask:0xf bank_mask:0xf
v_and_b32_dpp v105, v15, v5 row_newbcast:12 row_mask:0xf bank_mask:0xf
v_and_b32_dpp v106, v15, v6 row_newbcast:12 row_mask:0xf bank_mask:0xf
v_and_b32_dpp v107, v15, v7 row_newbcast:12 row_mask:0xf bank_mask:0xf
v_mfma_f32_16x16x32_bf16 v[108:111], v[100:103], v[196:199], v[108:111]
s_xor_b32 s64, s65, 71680
s_cmpk_gt_u32 s69, 106
s_waitcnt vmcnt(6)
s_cbranch_scc1 L_d_113
s_waitcnt vmcnt(5)
L_d_113:
buffer_load_dwordx4 v[228:231], v1, s[44:47], s64 offen nt
v_and_b32_dpp v100, v16, v4 row_newbcast:0 row_mask:0xf bank_mask:0xf
v_and_b32_dpp v101, v16, v5 row_newbcast:0 row_mask:0xf bank_mask:0xf
v_and_b32_dpp v102, v16, v6 row_newbcast:0 row_mask:0xf bank_mask:0xf
v_and_b32_dpp v103, v16, v7 row_newbcast:0 row_mask:0xf bank_mask:0xf
v_mfma_f32_16x16x32_bf16 v[108:111], v[104:107], v[200:203], v[108:111]
s_xor_b32 s64, s65, 104448
s_cmpk_gt_u32 s69, 107
s_waitcnt vmcnt(6)
s_cbranch_scc1 L_d_114
s_waitcnt vmcnt(5)
L_d_114:
buffer_load_dwordx4 v[232:235], v1, s[44:47], s64 offen nt
v_and_b32_dpp v104, v16, v4 row_newbcast:4 row_mask:0xf bank_mask:0xf
v_and_b32_dpp v105, v16, v5 row_newbcast:4 row_mask:0xf bank_mask:0xf
v_and_b32_dpp v106, v16, v6 row_newbcast:4 row_mask:0xf bank_mask:0xf
v_and_b32_dpp v107, v16, v7 row_newbcast:4 row_mask:0xf bank_mask:0xf
v_mfma_f32_16x16x32_bf16 v[108:111], v[100:103], v[204:207], v[108:111]
s_xor_b32 s64, s65, 68608
s_cmpk_gt_u32 s69, 108
s_waitcnt vmcnt(6)
s_cbranch_scc1 L_d_115
s_waitcnt vmcnt(5)
L_d_115:
buffer_load_dwordx4 v[236:239], v1, s[44:47], s64 offen nt
v_and_b32_dpp v100, v16, v4 row_newbcast:8 row_mask:0xf bank_mask:0xf
v_and_b32_dpp v101, v16, v5 row_newbcast:8 row_mask:0xf bank_mask:0xf
v_and_b32_dpp v102, v16, v6 row_newbcast:8 row_mask:0xf bank_mask:0xf
v_and_b32_dpp v103, v16, v7 row_newbcast:8 row_mask:0xf bank_mask:0xf
v_mfma_f32_16x16x32_bf16 v[108:111], v[104:107], v[208:211], v[108:111]
s_xor_b32 s64, s65, 101376
s_cmpk_gt_u32 s69, 109
s_waitcnt vmcnt(6)
s_cbranch_scc1 L_d_116
s_waitcnt vmcnt(5)
L_d_116:
buffer_load_dwordx4 v[240:243], v1, s[44:47], s64 offen nt
v_and_b32_dpp v104, v16, v4 row_newbcast:12 row_mask:0xf bank_mask:0xf
v_and_b32_dpp v105, v16, v5 row_newbcast:12 row_mask:0xf bank_mask:0xf
v_and_b32_dpp v106, v16, v6 row_newbcast:12 row_mask:0xf bank_mask:0xf
v_and_b32_dpp v107, v16, v7 row_newbcast:12 row_mask:0xf bank_mask:0xf
v_mfma_f32_16x16x32_bf16 v[108:111], v[100:103], v[212:215], v[108:111]
s_cmp_eq_u32 s34, 2
s_cbranch_scc0 L_w_118
v_mov_b32 v124, 46
s_mov_b64 exec, 1
buffer_store_dword v124, off, s[36:39], s63 offset:0
s_mov_b64 exec, -1
L_w_118:
s_xor_b32 s64, s65, 72704
s_cmpk_gt_u32 s69, 110
s_waitcnt vmcnt(6)
s_cbranch_scc1 L_d_117
s_waitcnt vmcnt(5)
L_d_117:
buffer_load_dwordx4 v[244:247], v1, s[44:47], s64 offen nt
v_and_b32_dpp v100, v18, v4 row_newbcast:0 row_mask:0xf bank_mask:0xf
v_and_b32_dpp v101, v18, v5 row_newbcast:0 row_mask:0xf bank_mask:0xf
v_and_b32_dpp v102, v18, v6 row_newbcast:0 row_mask:0xf bank_mask:0xf
v_and_b32_dpp v103, v18, v7 row_newbcast:0 row_mask:0xf bank_mask:0xf
v_mfma_f32_16x16x32_bf16 v[108:111], v[104:107], v[216:219], v[108:111]
s_xor_b32 s64, s65, 105472
s_cmpk_gt_u32 s69, 111
s_waitcnt vmcnt(6)
s_cbranch_scc1 L_d_119
s_waitcnt vmcnt(5)
L_d_119:
buffer_load_dwordx4 v[248:251], v1, s[44:47], s64 offen nt
v_and_b32_dpp v104, v18, v4 row_newbcast:4 row_mask:0xf bank_mask:0xf
v_and_b32_dpp v105, v18, v5 row_newbcast:4 row_mask:0xf bank_mask:0xf
v_and_b32_dpp v106, v18, v6 row_newbcast:4 row_mask:0xf bank_mask:0xf
v_and_b32_dpp v107, v18, v7 row_newbcast:4 row_mask:0xf bank_mask:0xf
v_mfma_f32_16x16x32_bf16 v[108:111], v[100:103], v[220:223], v[108:111]
s_xor_b32 s64, s65, 133120
s_waitcnt vmcnt(5)
buffer_load_dwordx4 v[252:255], v1, s[44:47], s64 offen nt
v_and_b32_dpp v100, v18, v4 row_newbcast:8 row_mask:0xf bank_mask:0xf
v_and_b32_dpp v101, v18, v5 row_newbcast:8 row_mask:0xf bank_mask:0xf
v_and_b32_dpp v102, v18, v6 row_newbcast:8 row_mask:0xf bank_mask:0xf
v_and_b32_dpp v103, v18, v7 row_newbcast:8 row_mask:0xf bank_mask:0xf
v_mfma_f32_16x16x32_bf16 v[108:111], v[104:107], v[224:227], v[108:111]
v_and_b32_dpp v104, v18, v4 row_newbcast:12 row_mask:0xf bank_mask:0xf
v_and_b32_dpp v105, v18, v5 row_newbcast:12 row_mask:0xf bank_mask:0xf
v_and_b32_dpp v106, v18, v6 row_newbcast:12 row_mask:0xf bank_mask:0xf
v_and_b32_dpp v107, v18, v7 row_newbcast:12 row_mask:0xf bank_mask:0xf
v_mfma_f32_16x16x32_bf16 v[108:111], v[100:103], v[228:231], v[108:111]
s_xor_b32 s64, s65, 165888
s_waitcnt vmcnt(5)
buffer_load_dwordx4 v[84:87], v1, s[44:47], s64 offen nt
v_and_b32_dpp v100, v19, v4 row_newbcast:0 row_mask:0xf bank_mask:0xf
v_and_b32_dpp v101, v19, v5 row_newbcast:0 row_mask:0xf bank_mask:0xf
v_and_b32_dpp v102, v19, v6 row_newbcast:0 row_mask:0xf bank_mask:0xf
v_and_b32_dpp v103, v19, v7 row_newbcast:0 row_mask:0xf bank_mask:0xf
v_mfma_f32_16x16x32_bf16 v[108:111], v[104:107], v[232:235], v[108:111]
s_xor_b32 s64, s65, 137216
s_waitcnt vmcnt(5)
buffer_load_dwordx4 v[88:91], v1, s[44:47], s64 offen nt
v_and_b32_dpp v104, v19, v4 row_newbcast:4 row_mask:0xf bank_mask:0xf
v_and_b32_dpp v105, v19, v5 row_newbcast:4 row_mask:0xf bank_mask:0xf
v_and_b32_dpp v106, v19, v6 row_newbcast:4 row_mask:0xf bank_mask:0xf
v_and_b32_dpp v107, v19, v7 row_newbcast:4 row_mask:0xf bank_mask:0xf
v_mfma_f32_16x16x32_bf16 v[108:111], v[100:103], v[236:239], v[108:111]
s_xor_b32 s64, s65, 169984
s_waitcnt vmcnt(5)
buffer_load_dwordx4 v[132:135], v1, s[44:47], s64 offen nt
v_and_b32_dpp v100, v19, v4 row_newbcast:8 row_mask:0xf bank_mask:0xf
v_and_b32_dpp v101, v19, v5 row_newbcast:8 row_mask:0xf bank_mask:0xf
v_and_b32_dpp v102, v19, v6 row_newbcast:8 row_mask:0xf bank_mask:0xf
v_and_b32_dpp v103, v19, v7 row_newbcast:8 row_mask:0xf bank_mask:0xf
v_mfma_f32_16x16x32_bf16 v[108:111], v[104:107], v[240:243], v[108:111]
s_xor_b32 s64, s65, 134144
s_waitcnt vmcnt(5)
buffer_load_dwordx4 v[136:139], v1, s[44:47], s64 offen nt
v_and_b32_dpp v104, v19, v4 row_newbcast:12 row_mask:0xf bank_mask:0xf
v_and_b32_dpp v105, v19, v5 row_newbcast:12 row_mask:0xf bank_mask:0xf
v_and_b32_dpp v106, v19, v6 row_newbcast:12 row_mask:0xf bank_mask:0xf
v_and_b32_dpp v107, v19, v7 row_newbcast:12 row_mask:0xf bank_mask:0xf
v_mfma_f32_16x16x32_bf16 v[108:111], v[100:103], v[244:247], v[108:111]
s_xor_b32 s64, s65, 166912
s_waitcnt vmcnt(5)
buffer_load_dwordx4 v[140:143], v1, s[44:47], s64 offen nt
v_and_b32_dpp v100, v20, v4 row_newbcast:0 row_mask:0xf bank_mask:0xf
v_and_b32_dpp v101, v20, v5 row_newbcast:0 row_mask:0xf bank_mask:0xf
v_and_b32_dpp v102, v20, v6 row_newbcast:0 row_mask:0xf bank_mask:0xf
v_and_b32_dpp v103, v20, v7 row_newbcast:0 row_mask:0xf bank_mask:0xf
v_mfma_f32_16x16x32_bf16 v[108:111], v[104:107], v[248:251], v[108:111]
s_cmp_eq_u32 s34, 3
s_cbranch_scc0 L_w_120
v_mov_b32 v124, 54
s_mov_b64 exec, 1
buffer_store_dword v124, off, s[36:39], s63 offset:0
s_mov_b64 exec, -1
L_w_120:
s_xor_b32 s64, s65, 138240
s_waitcnt vmcnt(5)
buffer_load_dwordx4 v[144:147], v1, s[44:47], s64 offen nt
v_and_b32_dpp v104, v20, v4 row_newbcast:4 row_mask:0xf bank_mask:0xf
v_and_b32_dpp v105, v20, v5 row_newbcast:4 row_mask:0xf bank_mask:0xf
v_and_b32_dpp v106, v20, v6 row_newbcast:4 row_mask:0xf bank_mask:0xf
v_and_b32_dpp v107, v20, v7 row_newbcast:4 row_mask:0xf bank_mask:0xf
v_mfma_f32_16x16x32_bf16 v[108:111], v[100:103], v[252:255], v[108:111]
s_xor_b32 s64, s65, 171008
s_waitcnt vmcnt(5)
buffer_load_dwordx4 v[148:151], v1, s[44:47], s64 offen nt
v_and_b32_dpp v100, v20, v4 row_newbcast:8 row_mask:0xf bank_mask:0xf
v_and_b32_dpp v101, v20, v5 row_newbcast:8 row_mask:0xf bank_mask:0xf
v_and_b32_dpp v102, v20, v6 row_newbcast:8 row_mask:0xf bank_mask:0xf
v_and_b32_dpp v103, v20, v7 row_newbcast:8 row_mask:0xf bank_mask:0xf
v_mfma_f32_16x16x32_bf16 v[108:111], v[104:107], v[84:87], v[108:111]
s_xor_b32 s64, s65, 198656
s_waitcnt vmcnt(7)
buffer_load_dwordx4 v[152:155], v1, s[44:47], s64 offen nt
s_xor_b32 s64, s65, 231424
s_waitcnt vmcnt(7)
buffer_load_dwordx4 v[156:159], v1, s[44:47], s64 offen nt
s_cmp_lt_u32 s2, 208
s_cbranch_scc0 L_hp_121
v_lshlrev_b32 v160, 2, v0
buffer_load_dword v161, v160, s[36:39], s62 offen offset:0 sc1
L_hp_121:
s_xor_b32 s64, s65, 202752
s_waitcnt vmcnt(7)
buffer_load_dwordx4 v[176:179], v1, s[44:47], s64 offen nt
v_and_b32_dpp v104, v20, v4 row_newbcast:12 row_mask:0xf bank_mask:0xf
v_and_b32_dpp v105, v20, v5 row_newbcast:12 row_mask:0xf bank_mask:0xf
v_and_b32_dpp v106, v20, v6 row_newbcast:12 row_mask:0xf bank_mask:0xf
v_and_b32_dpp v107, v20, v7 row_newbcast:12 row_mask:0xf bank_mask:0xf
v_mfma_f32_16x16x32_bf16 v[108:111], v[100:103], v[88:91], v[108:111]
s_xor_b32 s64, s65, 235520
s_waitcnt vmcnt(7)
buffer_load_dwordx4 v[180:183], v1, s[44:47], s64 offen nt
v_and_b32_dpp v100, v21, v4 row_newbcast:0 row_mask:0xf bank_mask:0xf
v_and_b32_dpp v101, v21, v5 row_newbcast:0 row_mask:0xf bank_mask:0xf
v_and_b32_dpp v102, v21, v6 row_newbcast:0 row_mask:0xf bank_mask:0xf
v_and_b32_dpp v103, v21, v7 row_newbcast:0 row_mask:0xf bank_mask:0xf
v_mfma_f32_16x16x32_bf16 v[108:111], v[104:107], v[132:135], v[108:111]
s_xor_b32 s64, s65, 199680
s_waitcnt vmcnt(7)
buffer_load_dwordx4 v[184:187], v1, s[44:47], s64 offen nt
v_and_b32_dpp v104, v21, v4 row_newbcast:4 row_mask:0xf bank_mask:0xf
v_and_b32_dpp v105, v21, v5 row_newbcast:4 row_mask:0xf bank_mask:0xf
v_and_b32_dpp v106, v21, v6 row_newbcast:4 row_mask:0xf bank_mask:0xf
v_and_b32_dpp v107, v21, v7 row_newbcast:4 row_mask:0xf bank_mask:0xf
v_mfma_f32_16x16x32_bf16 v[108:111], v[100:103], v[136:139], v[108:111]
s_xor_b32 s64, s65, 232448
s_waitcnt vmcnt(7)
buffer_load_dwordx4 v[24:27], v1, s[44:47], s64 offen nt
v_and_b32_dpp v100, v21, v4 row_newbcast:8 row_mask:0xf bank_mask:0xf
v_and_b32_dpp v101, v21, v5 row_newbcast:8 row_mask:0xf bank_mask:0xf
v_and_b32_dpp v102, v21, v6 row_newbcast:8 row_mask:0xf bank_mask:0xf
v_and_b32_dpp v103, v21, v7 row_newbcast:8 row_mask:0xf bank_mask:0xf
v_mfma_f32_16x16x32_bf16 v[108:111], v[104:107], v[140:143], v[108:111]
s_cmp_eq_u32 s34, 0
s_cbranch_scc0 L_w_122
v_mov_b32 v124, 62
s_mov_b64 exec, 1
buffer_store_dword v124, off, s[36:39], s63 offset:0
s_mov_b64 exec, -1
L_w_122:
s_xor_b32 s64, s65, 203776
s_waitcnt vmcnt(7)
buffer_load_dwordx4 v[28:31], v1, s[44:47], s64 offen nt
v_and_b32_dpp v104, v21, v4 row_newbcast:12 row_mask:0xf bank_mask:0xf
v_and_b32_dpp v105, v21, v5 row_newbcast:12 row_mask:0xf bank_mask:0xf
v_and_b32_dpp v106, v21, v6 row_newbcast:12 row_mask:0xf bank_mask:0xf
v_and_b32_dpp v107, v21, v7 row_newbcast:12 row_mask:0xf bank_mask:0xf
v_mfma_f32_16x16x32_bf16 v[108:111], v[100:103], v[144:147], v[108:111]
s_xor_b32 s64, s65, 236544
s_waitcnt vmcnt(7)
buffer_load_dwordx4 v[32:35], v1, s[44:47], s64 offen nt
v_and_b32_dpp v100, v22, v4 row_newbcast:0 row_mask:0xf bank_mask:0xf
v_and_b32_dpp v101, v22, v5 row_newbcast:0 row_mask:0xf bank_mask:0xf
v_and_b32_dpp v102, v22, v6 row_newbcast:0 row_mask:0xf bank_mask:0xf
v_and_b32_dpp v103, v22, v7 row_newbcast:0 row_mask:0xf bank_mask:0xf
v_mfma_f32_16x16x32_bf16 v[108:111], v[104:107], v[148:151], v[108:111]
s_cmp_lt_u32 s2, 208
s_cbranch_scc0 L_nohelp
v_lshrrev_b32 v172, 3, v0
v_sub_u32 v172, 63, v172
v_and_b32 v168, 7, v0
v_lshlrev_b32 v168, 7, v168
v_bfe_u32 v162, v172, 0, 1
v_lshl_or_b32 v168, v162, 15, v168
v_bfe_u32 v162, v172, 1, 1
v_lshl_or_b32 v168, v162, 12, v168
v_bfe_u32 v162, v172, 2, 1
v_lshl_or_b32 v168, v162, 10, v168
v_bfe_u32 v162, v172, 3, 1
v_lshl_or_b32 v168, v162, 16, v168
v_bfe_u32 v162, v172, 4, 1
v_lshl_or_b32 v168, v162, 17, v168
v_bfe_u32 v162, v172, 5, 1
v_lshl_or_b32 v168, v162, 11, v168
v_lshrrev_b32 v173, 3, v0
v_sub_u32 v173, 55, v173
v_and_b32 v169, 7, v0
v_lshlrev_b32 v169, 7, v169
v_bfe_u32 v162, v173, 0, 1
v_lshl_or_b32 v169, v162, 15, v169
v_bfe_u32 v162, v173, 1, 1
v_lshl_or_b32 v169, v162, 12, v169
v_bfe_u32 v162, v173, 2, 1
v_lshl_or_b32 v169, v162, 10, v169
v_bfe_u32 v162, v173, 3, 1
v_lshl_or_b32 v169, v162, 16, v169
v_bfe_u32 v162, v173, 4, 1
v_lshl_or_b32 v169, v162, 17, v169
v_bfe_u32 v162, v173, 5, 1
v_lshl_or_b32 v169, v162, 11, v169
s_lshr_b32 s71, s2, 3
v_subrev_u32 v163, s71, v0
v_and_b32 v163, 31, v163
s_waitcnt vmcnt(6)
v_mov_b32 v162, v161
s_nop 1
v_permlane32_swap_b32 v161, v162
v_add_u32 v161, 1, v161
v_max_u32 v161, 23, v161
v_cmp_eq_u32 vcc, -1, v162
v_mov_b32 v160, 0xff
s_nop 0
v_cndmask_b32 v161, v160, v161, vcc
v_lshl_or_b32 v161, v161, 5, v163
s_nop 1
v_min_u32_dpp v161, v161, v161 quad_perm:[1,0,3,2] row_mask:0xf bank_mask:0xf
s_nop 1
v_min_u32_dpp v161, v161, v161 quad_perm:[2,3,0,1] row_mask:0xf bank_mask:0xf
s_nop 1
v_min_u32_dpp v161, v161, v161 row_ror:4 row_mask:0xf bank_mask:0xf
s_nop 1
v_min_u32_dpp v161, v161, v161 row_ror:8 row_mask:0xf bank_mask:0xf
s_nop 1
v_readlane_b32 s76, v161, 0
v_readlane_b32 s66, v161, 16
s_min_u32 s76, s76, s66
s_lshr_b32 s66, s76, 5
s_cmp_lt_u32 s66, 50
s_cbranch_scc0 L_drain
s_mov_b32 s48, s8
s_mov_b32 s49, s9
s_mov_b32 s50, 0x10000000
s_mov_b32 s51, 0x20000
s_lshr_b32 s64, s2, 3
s_add_u32 s76, s76, s64
s_and_b32 s76, s76, 31
s_lshl_b32 s67, s76, 2
s_add_u32 s67, s67, s62
s_lshl_b32 s76, s76, 3
s_and_b32 s64, s2, 7
s_or_b32 s76, s76, s64
s_mul_i32 s76, s76, 0x100400
s_lshl_b32 s64, s34, 13
s_or_b32 s64, s64, 0xC0000
s_xor_b32 s76, s76, s64
s_add_u32 s66, s66, 11
v_xor_b32 v169, s76, v169
v_cmp_lt_u32 vcc, s66, v173
s_or_b64 exec, vcc, 1
buffer_load_dword v171, v169, s[48:51], 0 offen
s_mov_b64 exec, -1
v_xor_b32 v168, s76, v168
v_cmp_lt_u32 vcc, s66, v172
s_or_b64 exec, vcc, 1
buffer_load_dword v170, v168, s[48:51], 0 offen
s_mov_b64 exec, -1
s_mov_b64 exec, 1
buffer_store_dword v1, off, s[36:39], s67 offset:128
s_mov_b64 exec, -1
s_waitcnt vmcnt(10)
v_and_b32_dpp v104, v22, v4 row_newbcast:4 row_mask:0xf bank_mask:0xf
v_and_b32_dpp v105, v22, v5 row_newbcast:4 row_mask:0xf bank_mask:0xf
v_and_b32_dpp v106, v22, v6 row_newbcast:4 row_mask:0xf bank_mask:0xf
v_and_b32_dpp v107, v22, v7 row_newbcast:4 row_mask:0xf bank_mask:0xf
v_mfma_f32_16x16x32_bf16 v[108:111], v[100:103], v[152:155], v[108:111]
s_waitcnt vmcnt(9)
v_and_b32_dpp v100, v22, v4 row_newbcast:8 row_mask:0xf bank_mask:0xf
v_and_b32_dpp v101, v22, v5 row_newbcast:8 row_mask:0xf bank_mask:0xf
v_and_b32_dpp v102, v22, v6 row_newbcast:8 row_mask:0xf bank_mask:0xf
v_and_b32_dpp v103, v22, v7 row_newbcast:8 row_mask:0xf bank_mask:0xf
v_mfma_f32_16x16x32_bf16 v[108:111], v[104:107], v[156:159], v[108:111]
s_waitcnt vmcnt(8)
v_and_b32_dpp v104, v22, v4 row_newbcast:12 row_mask:0xf bank_mask:0xf
v_and_b32_dpp v105, v22, v5 row_newbcast:12 row_mask:0xf bank_mask:0xf
v_and_b32_dpp v106, v22, v6 row_newbcast:12 row_mask:0xf bank_mask:0xf
v_and_b32_dpp v107, v22, v7 row_newbcast:12 row_mask:0xf bank_mask:0xf
v_mfma_f32_16x16x32_bf16 v[108:111], v[100:103], v[176:179], v[108:111]
s_waitcnt vmcnt(7)
v_and_b32_dpp v100, v23, v4 row_newbcast:0 row_mask:0xf bank_mask:0xf
v_and_b32_dpp v101, v23, v5 row_newbcast:0 row_mask:0xf bank_mask:0xf
v_and_b32_dpp v102, v23, v6 row_newbcast:0 row_mask:0xf bank_mask:0xf
v_and_b32_dpp v103, v23, v7 row_newbcast:0 row_mask:0xf bank_mask:0xf
v_mfma_f32_16x16x32_bf16 v[108:111], v[104:107], v[180:183], v[108:111]
s_waitcnt vmcnt(6)
v_and_b32_dpp v104, v23, v4 row_newbcast:4 row_mask:0xf bank_mask:0xf
v_and_b32_dpp v105, v23, v5 row_newbcast:4 row_mask:0xf bank_mask:0xf
v_and_b32_dpp v106, v23, v6 row_newbcast:4 row_mask:0xf bank_mask:0xf
v_and_b32_dpp v107, v23, v7 row_newbcast:4 row_mask:0xf bank_mask:0xf
v_mfma_f32_16x16x32_bf16 v[108:111], v[100:103], v[184:187], v[108:111]
s_waitcnt vmcnt(5)
v_and_b32_dpp v100, v23, v4 row_newbcast:8 row_mask:0xf bank_mask:0xf
v_and_b32_dpp v101, v23, v5 row_newbcast:8 row_mask:0xf bank_mask:0xf
v_and_b32_dpp v102, v23, v6 row_newbcast:8 row_mask:0xf bank_mask:0xf
v_and_b32_dpp v103, v23, v7 row_newbcast:8 row_mask:0xf bank_mask:0xf
v_mfma_f32_16x16x32_bf16 v[108:111], v[104:107], v[24:27], v[108:111]
s_waitcnt vmcnt(4)
v_and_b32_dpp v104, v23, v4 row_newbcast:12 row_mask:0xf bank_mask:0xf
v_and_b32_dpp v105, v23, v5 row_newbcast:12 row_mask:0xf bank_mask:0xf
v_and_b32_dpp v106, v23, v6 row_newbcast:12 row_mask:0xf bank_mask:0xf
v_and_b32_dpp v107, v23, v7 row_newbcast:12 row_mask:0xf bank_mask:0xf
v_mfma_f32_16x16x32_bf16 v[108:111], v[100:103], v[28:31], v[108:111]
s_waitcnt vmcnt(3)
v_mfma_f32_16x16x32_bf16 v[108:111], v[104:107], v[32:35], v[108:111]
s_branch L_drained
L_nohelp:
L_drain:
s_waitcnt vmcnt(7)
v_and_b32_dpp v104, v22, v4 row_newbcast:4 row_mask:0xf bank_mask:0xf
v_and_b32_dpp v105, v22, v5 row_newbcast:4 row_mask:0xf bank_mask:0xf
v_and_b32_dpp v106, v22, v6 row_newbcast:4 row_mask:0xf bank_mask:0xf
v_and_b32_dpp v107, v22, v7 row_newbcast:4 row_mask:0xf bank_mask:0xf
v_mfma_f32_16x16x32_bf16 v[108:111], v[100:103], v[152:155], v[108:111]
s_waitcnt vmcnt(6)
v_and_b32_dpp v100, v22, v4 row_newbcast:8 row_mask:0xf bank_mask:0xf
v_and_b32_dpp v101, v22, v5 row_newbcast:8 row_mask:0xf bank_mask:0xf
v_and_b32_dpp v102, v22, v6 row_newbcast:8 row_mask:0xf bank_mask:0xf
v_and_b32_dpp v103, v22, v7 row_newbcast:8 row_mask:0xf bank_mask:0xf
v_mfma_f32_16x16x32_bf16 v[108:111], v[104:107], v[156:159], v[108:111]
s_waitcnt vmcnt(5)
v_and_b32_dpp v104, v22, v4 row_newbcast:12 row_mask:0xf bank_mask:0xf
v_and_b32_dpp v105, v22, v5 row_newbcast:12 row_mask:0xf bank_mask:0xf
v_and_b32_dpp v106, v22, v6 row_newbcast:12 row_mask:0xf bank_mask:0xf
v_and_b32_dpp v107, v22, v7 row_newbcast:12 row_mask:0xf bank_mask:0xf
v_mfma_f32_16x16x32_bf16 v[108:111], v[100:103], v[176:179], v[108:111]
s_waitcnt vmcnt(4)
v_and_b32_dpp v100, v23, v4 row_newbcast:0 row_mask:0xf bank_mask:0xf
v_and_b32_dpp v101, v23, v5 row_newbcast:0 row_mask:0xf bank_mask:0xf
v_and_b32_dpp v102, v23, v6 row_newbcast:0 row_mask:0xf bank_mask:0xf
v_and_b32_dpp v103, v23, v7 row_newbcast:0 row_mask:0xf bank_mask:0xf
v_mfma_f32_16x16x32_bf16 v[108:111], v[104:107], v[180:183], v[108:111]
s_waitcnt vmcnt(3)
v_and_b32_dpp v104, v23, v4 row_newbcast:4 row_mask:0xf bank_mask:0xf
v_and_b32_dpp v105, v23, v5 row_newbcast:4 row_mask:0xf bank_mask:0xf
v_and_b32_dpp v106, v23, v6 row_newbcast:4 row_mask:0xf bank_mask:0xf
v_and_b32_dpp v107, v23, v7 row_newbcast:4 row_mask:0xf bank_mask:0xf
v_mfma_f32_16x16x32_bf16 v[108:111], v[100:103], v[184:187], v[108:111]
s_waitcnt vmcnt(2)
v_and_b32_dpp v100, v23, v4 row_newbcast:8 row_mask:0xf bank_mask:0xf
v_and_b32_dpp v101, v23, v5 row_newbcast:8 row_mask:0xf bank_mask:0xf
v_and_b32_dpp v102, v23, v6 row_newbcast:8 row_mask:0xf bank_mask:0xf
v_and_b32_dpp v103, v23, v7 row_newbcast:8 row_mask:0xf bank_mask:0xf
v_mfma_f32_16x16x32_bf16 v[108:111], v[104:107], v[24:27], v[108:111]
s_waitcnt vmcnt(1)
v_and_b32_dpp v104, v23, v4 row_newbcast:12 row_mask:0xf bank_mask:0xf
v_and_b32_dpp v105, v23, v5 row_newbcast:12 row_mask:0xf bank_mask:0xf
v_and_b32_dpp v106, v23, v6 row_newbcast:12 row_mask:0xf bank_mask:0xf
v_and_b32_dpp v107, v23, v7 row_newbcast:12 row_mask:0xf bank_mask:0xf
v_mfma_f32_16x16x32_bf16 v[108:111], v[100:103], v[28:31], v[108:111]
s_waitcnt vmcnt(0)
v_mfma_f32_16x16x32_bf16 v[108:111], v[104:107], v[32:35], v[108:111]
L_drained:
v_and_b32 v2, 15, v0
v_lshlrev_b32 v2, 5, v2
v_and_b32 v3, 16, v0
v_add_u32 v2, v2, v3
s_lshl_b32 s68, s34, 9
v_add_u32 v2, s68, v2
s_mov_b32 exec_hi, 0
s_nop 1
ds_write_b128 v2, v[108:111] offset:512
s_mov_b32 exec_hi, -1
v_lshlrev_b32 v1, 4, v0
s_waitcnt lgkmcnt(0)
s_barrier
v_mov_b32 v2, 0
ds_read_b32 v3, v2 offset:328
s_waitcnt lgkmcnt(0)
v_readfirstlane_b32 s35, v3
s_branch L_tail_s
L_fin:
L_end:
s_endpgm
L_code_end:
.section .rodata,"a"
.p2align 6
.amdhsa_kernel adaLN_cond__sliding_block_cached__glu_gated_glu__decode_kernel
  .amdhsa_next_free_vgpr 256
  .amdhsa_next_free_sgpr 102
  .amdhsa_accum_offset 256
  .amdhsa_group_segment_fixed_size 0
  .amdhsa_kernarg_size 112
  .amdhsa_user_sgpr_count 2
  .amdhsa_user_sgpr_kernarg_segment_ptr 1
  .amdhsa_system_sgpr_workgroup_id_x 1
  .amdhsa_float_denorm_mode_32 3
.end_amdhsa_kernel
```

```asm
; @launch grid=(256,1,1) block=(512,1,1) lds=131072
.amdgcn_target "amdgcn-amd-amdhsa--gfx950"
.text
.globl adaLN_cond__sliding_block_cached__glu_gated_glu__decode_kernel
.p2align 8
.type adaLN_cond__sliding_block_cached__glu_gated_glu__decode_kernel,@function
adaLN_cond__sliding_block_cached__glu_gated_glu__decode_kernel:
L_code_begin:
s_load_dwordx16 s[4:19], s[0:1], 0
s_load_dwordx8 s[20:27], s[0:1], 64
s_load_dwordx4 s[28:31], s[0:1], 96
s_cmpk_ge_u32 s2, 256
s_cbranch_scc1 L_end
v_lshrrev_b32 v1, 6, v0
v_and_b32 v0, 63, v0
v_readfirstlane_b32 s3, v1
v_lshlrev_b32 v1, 4, v0
s_lshl_b32 s64, s2, 20
s_add_u32 s64, s64, 0xC0000
s_mov_b32 s42, 0x40000
s_mov_b32 s43, 0x20000
s_and_b32 s34, s3, 3
s_cmp_ge_u32 s3, 4
s_cbranch_scc1 L_helper
s_and_b32 s65, s34, 1
s_lshl_b32 s65, s65, 14
s_lshr_b32 s66, s34, 1
s_lshl_b32 s66, s66, 13
s_or_b32 s65, s65, s66
s_lshl_b32 s66, s2, 10
s_xor_b32 s65, s65, s66
s_waitcnt lgkmcnt(0)
s_add_u32 s40, s6, s64
s_addc_u32 s41, s7, 0
s_add_u32 s44, s8, s64
s_addc_u32 s45, s9, 0
buffer_load_dwordx4 v[8:11], v1, s[40:43], s65 offen nt
s_xor_b32 s64, s65, 65536
buffer_load_dwordx4 v[12:15], v1, s[40:43], s64 offen nt
s_xor_b32 s64, s65, 2048
buffer_load_dwordx4 v[16:19], v1, s[40:43], s64 offen nt
s_xor_b32 s64, s65, 67584
buffer_load_dwordx4 v[20:23], v1, s[40:43], s64 offen nt
s_barrier
s_branch L_srest
L_helper:
s_setprio 2
v_lshlrev_b32 v2, 2, v0
s_cmp_eq_u32 s3, 7
s_cbranch_scc0 L_nopf
s_getpc_b64 s[60:61]
L_pc:
s_lshr_b32 s66, s2, 3
s_lshl_b32 s66, s66, 10
v_add_u32 v10, s66, v1
v_min_u32 v10, L_code_end-L_pc-16, v10
global_load_dwordx4 v[12:15], v10, s[60:61]
v_subrev_u32 v3, 16, v0
v_ashrrev_i32 v3, 31, v3
ds_write_b32 v2, v3 offset:256
L_nopf:
s_and_b32 s67, s2, 7
s_lshr_b32 s68, s2, 3
v_and_b32 v38, 7, v0
v_lshrrev_b32 v37, 3, v0
s_cmp_eq_u32 s34, 0
s_cbranch_scc0 L_p0a
s_mov_b32 s70, 6
s_lshl_b32 s67, s67, 1
s_add_u32 s66, s67, 14
v_min_u32 v38, 5, v38
v_cmp_lt_u32 vcc, 1, v38
v_add_u32 v36, s66, v38
s_nop 0
v_cndmask_b32 v38, v38, v36, vcc
s_branch L_p0b
L_p0a:
s_lshl_b32 s67, s67, 3
s_lshl_b32 s65, s2, 3
s_and_b32 s65, s65, 0xff
s_lshr_b32 s66, s2, 5
s_or_b32 s65, s65, s66
s_cmp_eq_u32 s34, 2
s_cselect_b32 s70, 1, 8
s_cselect_b32 s68, s65, s68
s_cselect_b32 s67, 0, s67
L_p0b:
v_lshl_add_u32 v37, s68, 4, v37
v_mul_u32_u24 v37, s70, v37
v_lshl_add_u32 v38, v37, 3, v38
v_add_lshl_u32 v38, v38, s67, 7
s_lshl_b32 s70, s70, 13
v_add_u32 v39, s70, v38
s_sub_u32 s64, s2, 112
s_cmp_lt_u32 s64, 32
s_waitcnt lgkmcnt(0)
s_barrier
s_cbranch_scc1 L_jan
s_cmp_eq_u32 s34, 3
s_cbranch_scc1 L_p0_123
s_cmp_eq_u32 s34, 0
s_cselect_b32 s62, s24, s10
s_cselect_b32 s63, s25, s11
s_cmp_eq_u32 s34, 2
s_cselect_b32 s62, s12, s62
s_cselect_b32 s63, s13, s63
global_load_dword v12, v38, s[62:63]
global_load_dword v13, v39, s[62:63]
L_p0_123:
L_nop0:
s_cmp_eq_u32 s34, 3
s_cselect_b32 s64, 16, 0
s_cmp_lt_u32 s2, s64
s_cbranch_scc0 L_nopc
v_mov_b32 v4, -1
v_mov_b32 v5, -1
v_mov_b32 v6, -1
v_mov_b32 v7, -1
s_and_b32 s66, s2, 7
s_lshl_b32 s66, s66, 11
s_and_b32 s65, s2, 8
s_lshl_b32 s65, s65, 7
s_add_u32 s66, s66, s65
v_add_u32 v8, s66, v1
global_store_dwordx4 v8, v[4:7], s[30:31] sc1
s_lshl_b32 s66, s2, 2
v_mov_b32 v3, s66
s_waitcnt vmcnt(0)
s_mov_b64 exec, 1
global_store_dword v3, v4, s[28:29] sc1
s_mov_b64 exec, -1
L_nopc:
s_cmp_eq_u32 s34, 3
s_cbranch_scc0 L_w_124
s_and_b32 s67, s2, 7
s_lshr_b32 s68, s2, 3
s_min_u32 s64, s67, 3
s_mul_i32 s65, s67, 5
s_add_u32 s64, s64, s65
s_cmp_lt_u32 s67, 3
s_cselect_b32 s65, 6, 5
L_w_124:
s_lshr_b32 s32, s2, 5
s_and_b32 s33, s2, 31
s_and_b32 s67, s2, 7
s_lshr_b32 s68, s2, 3
s_sub_u32 s68, s68, 26
s_min_u32 s74, s67, 3
s_mul_i32 s66, s67, 5
s_add_u32 s74, s74, s66
s_add_u32 s74, s74, s68
s_cmp_lt_u32 s67, 3
s_cselect_b32 s66, 6, 5
s_cmp_lt_u32 s68, s66
s_cselect_b32 s74, s74, -1
s_cmp_lt_u32 s2, 48
s_cselect_b32 s66, 2, 3
s_cselect_b32 s72, 14+26, 42+26
s_cmp_lt_u32 s2, 16
s_cselect_b32 s66, 1, s66
s_cselect_b32 s72, 26, s72
s_lshl_b32 s66, s67, s66
s_add_u32 s72, s72, s66
s_add_u32 s72, s72, s68
s_mov_b32 s36, s30
s_mov_b32 s37, s31
s_mov_b32 s38, 0x1d0000
s_mov_b32 s39, 0x20000
s_mov_b32 s52, s28
s_mov_b32 s53, s29
s_mov_b32 s54, 0x100
s_mov_b32 s55, 0x20000
v_mov_b32 v9, 1
s_cmp_lt_u32 s2, 112
s_cbranch_scc0 L_norole
L_gemm:
v_and_b32 v16, 7, v0
v_lshlrev_b32 v16, 10, v16
v_and_b32 v17, 8, v0
v_lshl_add_u32 v16, v17, 3, v16
v_and_b32 v17, 48, v0
v_add_u32 v16, v16, v17
s_lshl_b32 s67, s34, 8
v_lshrrev_b32 v19, 3, v0
v_and_b32 v17, 2, v19
v_and_b32 v18, 7, v0
v_xor_b32 v17, v17, v18
v_xor_b32 v18, 4, v17
v_lshlrev_b32 v17, 4, v17
v_lshlrev_b32 v18, 4, v18
s_cmp_lt_u32 s2, 48
s_cbranch_scc0 L_gq0
s_mov_b32 s40, s24
s_mov_b32 s41, s25
s_mov_b32 s42, 0x300000
s_mov_b32 s43, 0x20000
s_mov_b32 s48, s22
s_mov_b32 s49, s23
s_mov_b32 s50, 0x2000
s_mov_b32 s51, 0x20000
s_mov_b32 s70, 6144
s_lshl_b32 s64, s72, 7
s_branch L_g1
L_gq0:
s_mov_b32 s40, s10
s_mov_b32 s41, s11
s_mov_b32 s42, 0x400000
s_mov_b32 s43, 0x20000
s_mov_b32 s48, s4
s_mov_b32 s49, s5
s_mov_b32 s50, 0x2000
s_mov_b32 s51, 0x20000
s_mov_b32 s70, 8192
s_sub_u32 s64, s72, 48
s_lshl_b32 s64, s64, 7
L_g1:
buffer_load_dwordx4 v[192:195], v16, s[48:51], s67 offen offset:0
buffer_load_dwordx4 v[196:199], v16, s[48:51], s67 offen offset:128
v_mul_lo_u32 v19, s70, v19
v_add_u32 v17, v17, v19
v_add_u32 v18, v18, v19
s_lshl_b32 s66, s70, 7
s_mul_i32 s66, s66, s34
s_add_u32 s64, s64, s66
s_lshl_b32 s70, s70, 3
s_lshl_b32 s65, s34, 13
s_add_u32 s65, s65, 4096
s_cmp_lt_u32 s2, 16
s_cselect_b32 s71, 0, 2
s_cmp_ge_u32 s2, 48
s_cselect_b32 s71, 1, s71
s_add_u32 m0, s65, 0
s_nop 0
buffer_load_dwordx4 v17, s[40:43], s64 offen  lds
s_add_u32 s64, s64, s70
s_add_u32 m0, s65, 1024
s_nop 0
buffer_load_dwordx4 v18, s[40:43], s64 offen  lds
s_add_u32 s64, s64, s70
s_cmp_eq_u32 s71, 2
s_cbranch_scc0 L_pace_125
s_waitcnt vmcnt(1)
L_pace_125:
s_add_u32 m0, s65, 2048
s_nop 0
buffer_load_dwordx4 v17, s[40:43], s64 offen  lds
s_add_u32 s64, s64, s70
s_cmp_eq_u32 s71, 0
s_cbranch_scc1 L_pace_126
s_waitcnt vmcnt(2)
s_cmp_eq_u32 s71, 2
s_cbranch_scc0 L_pace_126
s_waitcnt vmcnt(1)
L_pace_126:
s_add_u32 m0, s65, 3072
s_nop 0
buffer_load_dwordx4 v18, s[40:43], s64 offen  lds
s_add_u32 s64, s64, s70
s_cmp_eq_u32 s71, 0
s_cbranch_scc1 L_pace_127
s_waitcnt vmcnt(2)
s_cmp_eq_u32 s71, 2
s_cbranch_scc0 L_pace_127
s_waitcnt vmcnt(1)
L_pace_127:
s_add_u32 m0, s65, 4096
s_nop 0
buffer_load_dwordx4 v17, s[40:43], s64 offen  lds
s_add_u32 s64, s64, s70
s_cmp_eq_u32 s71, 0
s_cbranch_scc1 L_pace_128
s_waitcnt vmcnt(2)
s_cmp_eq_u32 s71, 2
s_cbranch_scc0 L_pace_128
s_waitcnt vmcnt(1)
L_pace_128:
s_add_u32 m0, s65, 5120
s_nop 0
buffer_load_dwordx4 v18, s[40:43], s64 offen  lds
s_add_u32 s64, s64, s70
s_cmp_eq_u32 s71, 0
s_cbranch_scc1 L_pace_129
s_waitcnt vmcnt(2)
s_cmp_eq_u32 s71, 2
s_cbranch_scc0 L_pace_129
s_waitcnt vmcnt(1)
L_pace_129:
s_add_u32 m0, s65, 6144
s_nop 0
buffer_load_dwordx4 v17, s[40:43], s64 offen  lds
s_add_u32 s64, s64, s70
s_cmp_eq_u32 s71, 0
s_cbranch_scc1 L_pace_130
s_waitcnt vmcnt(2)
s_cmp_eq_u32 s71, 2
s_cbranch_scc0 L_pace_130
s_waitcnt vmcnt(1)
L_pace_130:
s_add_u32 m0, s65, 7168
s_nop 0
buffer_load_dwordx4 v18, s[40:43], s64 offen  lds
s_add_u32 s64, s64, s70
s_cmp_eq_u32 s71, 0
s_cbranch_scc1 L_pace_131
s_waitcnt vmcnt(2)
s_cmp_eq_u32 s71, 2
s_cbranch_scc0 L_pace_131
s_waitcnt vmcnt(1)
L_pace_131:
s_add_u32 m0, s65, 32768
s_nop 0
buffer_load_dwordx4 v17, s[40:43], s64 offen  lds
s_add_u32 s64, s64, s70
s_cmp_eq_u32 s71, 0
s_cbranch_scc1 L_pace_132
s_waitcnt vmcnt(2)
s_cmp_eq_u32 s71, 2
s_cbranch_scc0 L_pace_132
s_waitcnt vmcnt(1)
L_pace_132:
s_add_u32 m0, s65, 33792
s_nop 0
buffer_load_dwordx4 v18, s[40:43], s64 offen  lds
s_add_u32 s64, s64, s70
s_cmp_eq_u32 s71, 0
s_cbranch_scc1 L_pace_133
s_waitcnt vmcnt(2)
s_cmp_eq_u32 s71, 2
s_cbranch_scc0 L_pace_133
s_waitcnt vmcnt(1)
L_pace_133:
s_add_u32 m0, s65, 34816
s_nop 0
buffer_load_dwordx4 v17, s[40:43], s64 offen  lds
s_add_u32 s64, s64, s70
s_cmp_eq_u32 s71, 0
s_cbranch_scc1 L_pace_134
s_waitcnt vmcnt(2)
s_cmp_eq_u32 s71, 2
s_cbranch_scc0 L_pace_134
s_waitcnt vmcnt(1)
L_pace_134:
s_add_u32 m0, s65, 35840
s_nop 0
buffer_load_dwordx4 v18, s[40:43], s64 offen  lds
s_add_u32 s64, s64, s70
s_cmp_eq_u32 s71, 0
s_cbranch_scc1 L_pace_135
s_waitcnt vmcnt(2)
s_cmp_eq_u32 s71, 2
s_cbranch_scc0 L_pace_135
s_waitcnt vmcnt(1)
L_pace_135:
s_add_u32 m0, s65, 36864
s_nop 0
buffer_load_dwordx4 v17, s[40:43], s64 offen  lds
s_add_u32 s64, s64, s70
s_cmp_eq_u32 s71, 0
s_cbranch_scc1 L_pace_136
s_waitcnt vmcnt(2)
s_cmp_eq_u32 s71, 2
s_cbranch_scc0 L_pace_136
s_waitcnt vmcnt(1)
L_pace_136:
s_add_u32 m0, s65, 37888
s_nop 0
buffer_load_dwordx4 v18, s[40:43], s64 offen  lds
s_add_u32 s64, s64, s70
s_cmp_eq_u32 s71, 0
s_cbranch_scc1 L_pace_137
s_waitcnt vmcnt(2)
s_cmp_eq_u32 s71, 2
s_cbranch_scc0 L_pace_137
s_waitcnt vmcnt(1)
L_pace_137:
s_add_u32 m0, s65, 38912
s_nop 0
buffer_load_dwordx4 v17, s[40:43], s64 offen  lds
s_add_u32 s64, s64, s70
s_cmp_eq_u32 s71, 0
s_cbranch_scc1 L_pace_138
s_waitcnt vmcnt(2)
s_cmp_eq_u32 s71, 2
s_cbranch_scc0 L_pace_138
s_waitcnt vmcnt(1)
L_pace_138:
s_add_u32 m0, s65, 39936
s_nop 0
buffer_load_dwordx4 v18, s[40:43], s64 offen  lds
s_add_u32 s64, s64, s70
s_waitcnt vmcnt(16)
s_cmp_eq_u32 s34, 0
s_cselect_b32 s73, 48, 0x1000
v_and_b32 v30, 15, v0
v_lshlrev_b32 v30, 2, v30
s_cmp_ge_u32 s2, s73
s_cbranch_scc0 L_fl_139
buffer_load_dword v31, v30, s[52:55], 0 offen sc1
L_fl_139:
s_mov_b32 s68, 0xffff0000
s_cmp_lt_u32 s2, 48
s_cbranch_scc0 L_gq1
s_mov_b32 s66, 0xbfb8aa3b
v_lshlrev_b32 v20, 16, v192
v_and_b32 v21, s68, v192
v_mul_f32 v22, s66, v20
v_mul_f32 v23, s66, v21
v_exp_f32 v22, v22
v_exp_f32 v23, v23
s_nop 0
v_add_f32 v22, 1.0, v22
v_add_f32 v23, 1.0, v23
v_rcp_f32 v22, v22
v_rcp_f32 v23, v23
s_nop 0
v_mul_f32 v20, v20, v22
v_mul_f32 v21, v21, v23
v_cvt_pk_bf16_f32 v48, v20, v21
v_lshlrev_b32 v20, 16, v193
v_and_b32 v21, s68, v193
v_mul_f32 v22, s66, v20
v_mul_f32 v23, s66, v21
v_exp_f32 v22, v22
v_exp_f32 v23, v23
s_nop 0
v_add_f32 v22, 1.0, v22
v_add_f32 v23, 1.0, v23
v_rcp_f32 v22, v22
v_rcp_f32 v23, v23
s_nop 0
v_mul_f32 v20, v20, v22
v_mul_f32 v21, v21, v23
v_cvt_pk_bf16_f32 v49, v20, v21
v_lshlrev_b32 v20, 16, v194
v_and_b32 v21, s68, v194
v_mul_f32 v22, s66, v20
v_mul_f32 v23, s66, v21
v_exp_f32 v22, v22
v_exp_f32 v23, v23
s_nop 0
v_add_f32 v22, 1.0, v22
v_add_f32 v23, 1.0, v23
v_rcp_f32 v22, v22
v_rcp_f32 v23, v23
s_nop 0
v_mul_f32 v20, v20, v22
v_mul_f32 v21, v21, v23
v_cvt_pk_bf16_f32 v50, v20, v21
v_lshlrev_b32 v20, 16, v195
v_and_b32 v21, s68, v195
v_mul_f32 v22, s66, v20
v_mul_f32 v23, s66, v21
v_exp_f32 v22, v22
v_exp_f32 v23, v23
s_nop 0
v_add_f32 v22, 1.0, v22
v_add_f32 v23, 1.0, v23
v_rcp_f32 v22, v22
v_rcp_f32 v23, v23
s_nop 0
v_mul_f32 v20, v20, v22
v_mul_f32 v21, v21, v23
v_cvt_pk_bf16_f32 v51, v20, v21
v_lshlrev_b32 v20, 16, v196
v_and_b32 v21, s68, v196
v_mul_f32 v22, s66, v20
v_mul_f32 v23, s66, v21
v_exp_f32 v22, v22
v_exp_f32 v23, v23
s_nop 0
v_add_f32 v22, 1.0, v22
v_add_f32 v23, 1.0, v23
v_rcp_f32 v22, v22
v_rcp_f32 v23, v23
s_nop 0
v_mul_f32 v20, v20, v22
v_mul_f32 v21, v21, v23
v_cvt_pk_bf16_f32 v52, v20, v21
v_lshlrev_b32 v20, 16, v197
v_and_b32 v21, s68, v197
v_mul_f32 v22, s66, v20
v_mul_f32 v23, s66, v21
v_exp_f32 v22, v22
v_exp_f32 v23, v23
s_nop 0
v_add_f32 v22, 1.0, v22
v_add_f32 v23, 1.0, v23
v_rcp_f32 v22, v22
v_rcp_f32 v23, v23
s_nop 0
v_mul_f32 v20, v20, v22
v_mul_f32 v21, v21, v23
v_cvt_pk_bf16_f32 v53, v20, v21
v_lshlrev_b32 v20, 16, v198
v_and_b32 v21, s68, v198
v_mul_f32 v22, s66, v20
v_mul_f32 v23, s66, v21
v_exp_f32 v22, v22
v_exp_f32 v23, v23
s_nop 0
v_add_f32 v22, 1.0, v22
v_add_f32 v23, 1.0, v23
v_rcp_f32 v22, v22
v_rcp_f32 v23, v23
s_nop 0
v_mul_f32 v20, v20, v22
v_mul_f32 v21, v21, v23
v_cvt_pk_bf16_f32 v54, v20, v21
v_lshlrev_b32 v20, 16, v199
v_and_b32 v21, s68, v199
v_mul_f32 v22, s66, v20
v_mul_f32 v23, s66, v21
v_exp_f32 v22, v22
v_exp_f32 v23, v23
s_nop 0
v_add_f32 v22, 1.0, v22
v_add_f32 v23, 1.0, v23
v_rcp_f32 v22, v22
v_rcp_f32 v23, v23
s_nop 0
v_mul_f32 v20, v20, v22
v_mul_f32 v21, v21, v23
v_cvt_pk_bf16_f32 v55, v20, v21
s_branch L_g2
L_gq1:
v_and_b32 v32, 7, v0
v_lshlrev_b32 v32, 2, v32
v_lshlrev_b32 v96, 16, v192
v_and_b32 v97, s68, v192
v_lshlrev_b32 v98, 16, v193
v_and_b32 v99, s68, v193
v_lshlrev_b32 v100, 16, v194
v_and_b32 v101, s68, v194
v_lshlrev_b32 v102, 16, v195
v_and_b32 v103, s68, v195
v_lshlrev_b32 v104, 16, v196
v_and_b32 v105, s68, v196
v_lshlrev_b32 v106, 16, v197
v_and_b32 v107, s68, v197
v_lshlrev_b32 v108, 16, v198
v_and_b32 v109, s68, v198
v_lshlrev_b32 v110, 16, v199
v_and_b32 v111, s68, v199
v_add_f32 v20, v96, v97
v_add_f32 v20, v20, v98
v_add_f32 v20, v20, v99
v_add_f32 v20, v20, v100
v_add_f32 v20, v20, v101
v_add_f32 v20, v20, v102
v_add_f32 v20, v20, v103
v_add_f32 v20, v20, v104
v_add_f32 v20, v20, v105
v_add_f32 v20, v20, v106
v_add_f32 v20, v20, v107
v_add_f32 v20, v20, v108
v_add_f32 v20, v20, v109
v_add_f32 v20, v20, v110
v_add_f32 v20, v20, v111
s_nop 1
v_add_f32_dpp v20, v20, v20 row_ror:8 row_mask:0xf bank_mask:0xf
v_mov_b32 v22, v20
s_nop 1
v_permlane16_swap_b32 v20, v22
s_nop 1
v_add_f32 v20, v20, v22
v_mov_b32 v22, v20
s_nop 1
v_permlane32_swap_b32 v20, v22
s_nop 1
v_add_f32 v20, v20, v22
v_mul_f32 v20, 0x3c000000, v20
v_mov_b32 v21, 0
v_sub_f32 v22, v96, v20
v_fmac_f32 v21, v22, v22
v_sub_f32 v22, v97, v20
v_fmac_f32 v21, v22, v22
v_sub_f32 v22, v98, v20
v_fmac_f32 v21, v22, v22
v_sub_f32 v22, v99, v20
v_fmac_f32 v21, v22, v22
v_sub_f32 v22, v100, v20
v_fmac_f32 v21, v22, v22
v_sub_f32 v22, v101, v20
v_fmac_f32 v21, v22, v22
v_sub_f32 v22, v102, v20
v_fmac_f32 v21, v22, v22
v_sub_f32 v22, v103, v20
v_fmac_f32 v21, v22, v22
v_sub_f32 v22, v104, v20
v_fmac_f32 v21, v22, v22
v_sub_f32 v22, v105, v20
v_fmac_f32 v21, v22, v22
v_sub_f32 v22, v106, v20
v_fmac_f32 v21, v22, v22
v_sub_f32 v22, v107, v20
v_fmac_f32 v21, v22, v22
v_sub_f32 v22, v108, v20
v_fmac_f32 v21, v22, v22
v_sub_f32 v22, v109, v20
v_fmac_f32 v21, v22, v22
v_sub_f32 v22, v110, v20
v_fmac_f32 v21, v22, v22
v_sub_f32 v22, v111, v20
v_fmac_f32 v21, v22, v22
s_nop 1
v_add_f32_dpp v21, v21, v21 row_ror:8 row_mask:0xf bank_mask:0xf
v_mov_b32 v22, v21
s_nop 1
v_permlane16_swap_b32 v21, v22
s_nop 1
v_add_f32 v21, v21, v22
v_mov_b32 v22, v21
s_nop 1
v_permlane32_swap_b32 v21, v22
s_nop 1
v_add_f32 v21, v21, v22
v_lshlrev_b32 v22, 1, v32
s_lshl_b32 s66, s34, 6
v_add_u32 v23, s66, v22
ds_write_b64 v23, v[20:21] offset:0
v_mov_b32 v23, 0
s_waitcnt lgkmcnt(0)
s_mov_b64 exec, 1
ds_add_u32 v23, v9 offset:332
s_mov_b64 exec, -1
s_mov_b32 s75, 0
L_poll_140:
ds_read_b32 v24, v23 offset:332
s_waitcnt lgkmcnt(0)
v_cmp_gt_u32 vcc, 4, v24
s_cbranch_vccz L_pollx_141
s_add_u32 s75, s75, 1
s_cmp_lt_u32 s75, 0x1000000
s_cbranch_scc1 L_poll_140
L_pollx_141:
ds_read_b64 v[112:113], v22 offset:0
ds_read_b64 v[114:115], v22 offset:64
ds_read_b64 v[116:117], v22 offset:128
ds_read_b64 v[118:119], v22 offset:192
s_waitcnt lgkmcnt(0)
v_add_f32 v20, v112, v114
v_add_f32 v21, v116, v118
v_add_f32 v20, v20, v21
v_mul_f32 v20, 0x3e800000, v20
v_add_f32 v24, v113, v115
v_add_f32 v21, v117, v119
v_add_f32 v24, v24, v21
v_mov_b32 v21, 0
v_sub_f32 v22, v112, v20
v_fmac_f32 v21, v22, v22
v_sub_f32 v22, v114, v20
v_fmac_f32 v21, v22, v22
v_sub_f32 v22, v116, v20
v_fmac_f32 v21, v22, v22
v_sub_f32 v22, v118, v20
v_fmac_f32 v21, v22, v22
v_fmac_f32 v24, 0x43000000, v21
v_mul_f32 v24, 0x3b000000, v24
v_cvt_pk_bf16_f32 v24, 0, v24
v_cvt_pk_bf16_f32 v20, 0, v20
v_add_f32 v24, 0x3727c5ac, v24
v_cvt_pk_bf16_f32 v24, 0, v24
v_sqrt_f32 v24, v24
s_nop 0
v_cvt_pk_bf16_f32 v24, 0, v24
v_rcp_f32 v24, v24
s_nop 0
v_sub_f32 v96, v96, v20
v_cvt_pk_bf16_f32 v96, 0, v96
v_mul_f32 v96, v96, v24
v_cvt_pk_bf16_f32 v96, 0, v96
v_sub_f32 v97, v97, v20
v_cvt_pk_bf16_f32 v97, 0, v97
v_mul_f32 v97, v97, v24
v_cvt_pk_bf16_f32 v97, 0, v97
v_sub_f32 v98, v98, v20
v_cvt_pk_bf16_f32 v98, 0, v98
v_mul_f32 v98, v98, v24
v_cvt_pk_bf16_f32 v98, 0, v98
v_sub_f32 v99, v99, v20
v_cvt_pk_bf16_f32 v99, 0, v99
v_mul_f32 v99, v99, v24
v_cvt_pk_bf16_f32 v99, 0, v99
v_sub_f32 v100, v100, v20
v_cvt_pk_bf16_f32 v100, 0, v100
v_mul_f32 v100, v100, v24
v_cvt_pk_bf16_f32 v100, 0, v100
v_sub_f32 v101, v101, v20
v_cvt_pk_bf16_f32 v101, 0, v101
v_mul_f32 v101, v101, v24
v_cvt_pk_bf16_f32 v101, 0, v101
v_sub_f32 v102, v102, v20
v_cvt_pk_bf16_f32 v102, 0, v102
v_mul_f32 v102, v102, v24
v_cvt_pk_bf16_f32 v102, 0, v102
v_sub_f32 v103, v103, v20
v_cvt_pk_bf16_f32 v103, 0, v103
v_mul_f32 v103, v103, v24
v_cvt_pk_bf16_f32 v103, 0, v103
v_sub_f32 v104, v104, v20
v_cvt_pk_bf16_f32 v104, 0, v104
v_mul_f32 v104, v104, v24
v_cvt_pk_bf16_f32 v104, 0, v104
v_sub_f32 v105, v105, v20
v_cvt_pk_bf16_f32 v105, 0, v105
v_mul_f32 v105, v105, v24
v_cvt_pk_bf16_f32 v105, 0, v105
v_sub_f32 v106, v106, v20
v_cvt_pk_bf16_f32 v106, 0, v106
v_mul_f32 v106, v106, v24
v_cvt_pk_bf16_f32 v106, 0, v106
v_sub_f32 v107, v107, v20
v_cvt_pk_bf16_f32 v107, 0, v107
v_mul_f32 v107, v107, v24
v_cvt_pk_bf16_f32 v107, 0, v107
v_sub_f32 v108, v108, v20
v_cvt_pk_bf16_f32 v108, 0, v108
v_mul_f32 v108, v108, v24
v_cvt_pk_bf16_f32 v108, 0, v108
v_sub_f32 v109, v109, v20
v_cvt_pk_bf16_f32 v109, 0, v109
v_mul_f32 v109, v109, v24
v_cvt_pk_bf16_f32 v109, 0, v109
v_sub_f32 v110, v110, v20
v_cvt_pk_bf16_f32 v110, 0, v110
v_mul_f32 v110, v110, v24
v_cvt_pk_bf16_f32 v110, 0, v110
v_sub_f32 v111, v111, v20
v_cvt_pk_bf16_f32 v111, 0, v111
v_mul_f32 v111, v111, v24
v_cvt_pk_bf16_f32 v111, 0, v111
L_g2:
s_cmp_ge_u32 s2, s73
s_cbranch_scc0 L_fl_142
s_waitcnt vmcnt(0)
v_cmp_eq_u32 vcc, 0, v31
s_cbranch_vccz L_fl_142
s_mov_b32 s75, 0
L_poll_143:
buffer_load_dword v31, v30, s[52:55], 0 offen sc1
s_waitcnt vmcnt(0)
v_cmp_eq_u32 vcc, 0, v31
s_cbranch_vccz L_pollx_144
s_sleep 40
s_add_u32 s75, s75, 1
s_cmp_lt_u32 s75, 0x100000
s_cbranch_scc1 L_poll_143
L_pollx_144:
L_fl_142:
v_mov_b32 v20, 0
s_cmp_eq_u32 s34, 0
s_cbranch_scc0 L_w_145
ds_write_b32 v20, v9 offset:324
L_w_145:
v_lshrrev_b32 v18, 4, v0
v_bfe_u32 v19, v0, 2, 2
v_lshrrev_b32 v20, 1, v19
v_and_b32 v21, 1, v18
v_lshl_add_u32 v20, v21, 1, v20
v_lshlrev_b32 v20, 5, v20
v_lshl_add_u32 v20, v18, 10, v20
v_lshl_add_u32 v20, v19, 7, v20
v_and_b32 v21, 3, v0
v_lshl_add_u32 v20, v21, 3, v20
v_add_u32 v40, s65, v20
v_xor_b32 v41, 32, v40
v_xor_b32 v42, 64, v40
v_xor_b32 v43, 96, v40
s_waitcnt vmcnt(12) lgkmcnt(0)
ds_read_b64_tr_b16 v[128:129], v40 offset:0
ds_read_b64_tr_b16 v[130:131], v40 offset:512
ds_read_b64_tr_b16 v[132:133], v41 offset:0
ds_read_b64_tr_b16 v[134:135], v41 offset:512
ds_read_b64_tr_b16 v[136:137], v42 offset:0
ds_read_b64_tr_b16 v[138:139], v42 offset:512
ds_read_b64_tr_b16 v[140:141], v43 offset:0
ds_read_b64_tr_b16 v[142:143], v43 offset:512
s_waitcnt vmcnt(8) lgkmcnt(0)
ds_read_b64_tr_b16 v[144:145], v40 offset:4096
ds_read_b64_tr_b16 v[146:147], v40 offset:4608
ds_read_b64_tr_b16 v[148:149], v41 offset:4096
ds_read_b64_tr_b16 v[150:151], v41 offset:4608
ds_read_b64_tr_b16 v[152:153], v42 offset:4096
ds_read_b64_tr_b16 v[154:155], v42 offset:4608
ds_read_b64_tr_b16 v[156:157], v43 offset:4096
ds_read_b64_tr_b16 v[158:159], v43 offset:4608
s_waitcnt vmcnt(4) lgkmcnt(0)
ds_read_b64_tr_b16 v[160:161], v40 offset:32768
ds_read_b64_tr_b16 v[162:163], v40 offset:33280
ds_read_b64_tr_b16 v[164:165], v41 offset:32768
ds_read_b64_tr_b16 v[166:167], v41 offset:33280
ds_read_b64_tr_b16 v[168:169], v42 offset:32768
ds_read_b64_tr_b16 v[170:171], v42 offset:33280
ds_read_b64_tr_b16 v[172:173], v43 offset:32768
ds_read_b64_tr_b16 v[174:175], v43 offset:33280
s_waitcnt vmcnt(0) lgkmcnt(0)
ds_read_b64_tr_b16 v[176:177], v40 offset:36864
ds_read_b64_tr_b16 v[178:179], v40 offset:37376
ds_read_b64_tr_b16 v[180:181], v41 offset:36864
ds_read_b64_tr_b16 v[182:183], v41 offset:37376
ds_read_b64_tr_b16 v[184:185], v42 offset:36864
ds_read_b64_tr_b16 v[186:187], v42 offset:37376
ds_read_b64_tr_b16 v[188:189], v43 offset:36864
ds_read_b64_tr_b16 v[190:191], v43 offset:37376
s_waitcnt lgkmcnt(0)
s_cmp_eq_u32 s34, 2
s_cselect_b32 s73, 16, 0x1000
v_and_b32 v30, 31, v0
v_lshlrev_b32 v30, 2, v30
s_cmp_ge_u32 s2, s73
s_cbranch_scc0 L_fl_146
buffer_load_dword v31, v30, s[52:55], 0 offen offset:128 sc1
L_fl_146:
s_cmp_lt_u32 s2, 48
s_cbranch_scc1 L_g3
v_mov_b32 v20, 0
s_mov_b32 s75, 0
L_poll_147:
ds_read_b32 v22, v20 offset:324
s_waitcnt lgkmcnt(0)
v_cmp_eq_u32 vcc, 0, v22
s_cbranch_vccz L_pollx_148
s_sleep 1
s_add_u32 s75, s75, 1
s_cmp_lt_u32 s75, 0x1000000
s_cbranch_scc1 L_poll_147
L_pollx_148:
s_lshl_b32 s64, s34, 11
s_add_u32 s64, s64, 0
s_add_u32 s66, s64, 8192
s_mov_b32 s75, 0
L_poll_149:
buffer_load_dwordx4 v[192:195], v1, s[36:39], s64 offen offset:0 sc1
buffer_load_dwordx4 v[200:203], v1, s[36:39], s66 offen offset:0 sc1
buffer_load_dwordx4 v[196:199], v1, s[36:39], s64 offen offset:1024 sc1
buffer_load_dwordx4 v[204:207], v1, s[36:39], s66 offen offset:1024 sc1
s_waitcnt vmcnt(0)
v_max3_u32 v22, v192, v193, v194
v_max3_u32 v22, v22, v195, v196
v_max3_u32 v22, v22, v197, v198
v_max3_u32 v22, v22, v199, v200
v_max3_u32 v22, v22, v201, v202
v_max3_u32 v22, v22, v203, v204
v_max3_u32 v22, v22, v205, v206
v_max_u32 v22, v22, v207
v_cmp_eq_u32 vcc, -1, v22
s_cbranch_vccz L_pollx_150
s_sleep 16
s_add_u32 s75, s75, 1
s_cmp_lt_u32 s75, 0x100000
s_cbranch_scc1 L_poll_149
L_pollx_150:
v_lshlrev_b32 v20, 16, v200
v_and_b32 v21, s68, v200
v_add_f32 v20, 1.0, v20
v_add_f32 v21, 1.0, v21
v_cvt_pk_bf16_f32 v20, 0, v20
v_cvt_pk_bf16_f32 v21, 0, v21
v_mul_f32 v20, v20, v96
v_mul_f32 v21, v21, v97
v_cvt_pk_bf16_f32 v20, 0, v20
v_cvt_pk_bf16_f32 v21, 0, v21
v_lshlrev_b32 v22, 16, v192
v_and_b32 v23, s68, v192
v_add_f32 v20, v20, v22
v_add_f32 v21, v21, v23
v_cvt_pk_bf16_f32 v48, v20, v21
v_lshlrev_b32 v20, 16, v201
v_and_b32 v21, s68, v201
v_add_f32 v20, 1.0, v20
v_add_f32 v21, 1.0, v21
v_cvt_pk_bf16_f32 v20, 0, v20
v_cvt_pk_bf16_f32 v21, 0, v21
v_mul_f32 v20, v20, v98
v_mul_f32 v21, v21, v99
v_cvt_pk_bf16_f32 v20, 0, v20
v_cvt_pk_bf16_f32 v21, 0, v21
v_lshlrev_b32 v22, 16, v193
v_and_b32 v23, s68, v193
v_add_f32 v20, v20, v22
v_add_f32 v21, v21, v23
v_cvt_pk_bf16_f32 v49, v20, v21
v_lshlrev_b32 v20, 16, v202
v_and_b32 v21, s68, v202
v_add_f32 v20, 1.0, v20
v_add_f32 v21, 1.0, v21
v_cvt_pk_bf16_f32 v20, 0, v20
v_cvt_pk_bf16_f32 v21, 0, v21
v_mul_f32 v20, v20, v100
v_mul_f32 v21, v21, v101
v_cvt_pk_bf16_f32 v20, 0, v20
v_cvt_pk_bf16_f32 v21, 0, v21
v_lshlrev_b32 v22, 16, v194
v_and_b32 v23, s68, v194
v_add_f32 v20, v20, v22
v_add_f32 v21, v21, v23
v_cvt_pk_bf16_f32 v50, v20, v21
v_lshlrev_b32 v20, 16, v203
v_and_b32 v21, s68, v203
v_add_f32 v20, 1.0, v20
v_add_f32 v21, 1.0, v21
v_cvt_pk_bf16_f32 v20, 0, v20
v_cvt_pk_bf16_f32 v21, 0, v21
v_mul_f32 v20, v20, v102
v_mul_f32 v21, v21, v103
v_cvt_pk_bf16_f32 v20, 0, v20
v_cvt_pk_bf16_f32 v21, 0, v21
v_lshlrev_b32 v22, 16, v195
v_and_b32 v23, s68, v195
v_add_f32 v20, v20, v22
v_add_f32 v21, v21, v23
v_cvt_pk_bf16_f32 v51, v20, v21
v_lshlrev_b32 v20, 16, v204
v_and_b32 v21, s68, v204
v_add_f32 v20, 1.0, v20
v_add_f32 v21, 1.0, v21
v_cvt_pk_bf16_f32 v20, 0, v20
v_cvt_pk_bf16_f32 v21, 0, v21
v_mul_f32 v20, v20, v104
v_mul_f32 v21, v21, v105
v_cvt_pk_bf16_f32 v20, 0, v20
v_cvt_pk_bf16_f32 v21, 0, v21
v_lshlrev_b32 v22, 16, v196
v_and_b32 v23, s68, v196
v_add_f32 v20, v20, v22
v_add_f32 v21, v21, v23
v_cvt_pk_bf16_f32 v52, v20, v21
v_lshlrev_b32 v20, 16, v205
v_and_b32 v21, s68, v205
v_add_f32 v20, 1.0, v20
v_add_f32 v21, 1.0, v21
v_cvt_pk_bf16_f32 v20, 0, v20
v_cvt_pk_bf16_f32 v21, 0, v21
v_mul_f32 v20, v20, v106
v_mul_f32 v21, v21, v107
v_cvt_pk_bf16_f32 v20, 0, v20
v_cvt_pk_bf16_f32 v21, 0, v21
v_lshlrev_b32 v22, 16, v197
v_and_b32 v23, s68, v197
v_add_f32 v20, v20, v22
v_add_f32 v21, v21, v23
v_cvt_pk_bf16_f32 v53, v20, v21
v_lshlrev_b32 v20, 16, v206
v_and_b32 v21, s68, v206
v_add_f32 v20, 1.0, v20
v_add_f32 v21, 1.0, v21
v_cvt_pk_bf16_f32 v20, 0, v20
v_cvt_pk_bf16_f32 v21, 0, v21
v_mul_f32 v20, v20, v108
v_mul_f32 v21, v21, v109
v_cvt_pk_bf16_f32 v20, 0, v20
v_cvt_pk_bf16_f32 v21, 0, v21
v_lshlrev_b32 v22, 16, v198
v_and_b32 v23, s68, v198
v_add_f32 v20, v20, v22
v_add_f32 v21, v21, v23
v_cvt_pk_bf16_f32 v54, v20, v21
v_lshlrev_b32 v20, 16, v207
v_and_b32 v21, s68, v207
v_add_f32 v20, 1.0, v20
v_add_f32 v21, 1.0, v21
v_cvt_pk_bf16_f32 v20, 0, v20
v_cvt_pk_bf16_f32 v21, 0, v21
v_mul_f32 v20, v20, v110
v_mul_f32 v21, v21, v111
v_cvt_pk_bf16_f32 v20, 0, v20
v_cvt_pk_bf16_f32 v21, 0, v21
v_lshlrev_b32 v22, 16, v199
v_and_b32 v23, s68, v199
v_add_f32 v20, v20, v22
v_add_f32 v21, v21, v23
v_cvt_pk_bf16_f32 v55, v20, v21
L_g3:
s_cmp_ge_u32 s2, s73
s_cbranch_scc0 L_fl_151
s_waitcnt vmcnt(0)
v_cmp_eq_u32 vcc, 0, v31
s_cbranch_vccz L_fl_151
s_mov_b32 s75, 0
L_poll_152:
buffer_load_dword v31, v30, s[52:55], 0 offen offset:128 sc1
s_waitcnt vmcnt(0)
v_cmp_eq_u32 vcc, 0, v31
s_cbranch_vccz L_pollx_153
s_sleep 40
s_add_u32 s75, s75, 1
s_cmp_lt_u32 s75, 0x100000
s_cbranch_scc1 L_poll_152
L_pollx_153:
L_fl_151:
s_nop 1
v_mfma_f32_16x16x32_bf16 v[64:67], v[128:131], v[48:51], 0
v_mfma_f32_16x16x32_bf16 v[68:71], v[132:135], v[48:51], 0
v_mfma_f32_16x16x32_bf16 v[72:75], v[136:139], v[48:51], 0
v_mfma_f32_16x16x32_bf16 v[76:79], v[140:143], v[48:51], 0
v_mfma_f32_16x16x32_bf16 v[80:83], v[144:147], v[48:51], 0
v_mfma_f32_16x16x32_bf16 v[84:87], v[148:151], v[48:51], 0
v_mfma_f32_16x16x32_bf16 v[88:91], v[152:155], v[48:51], 0
v_mfma_f32_16x16x32_bf16 v[92:95], v[156:159], v[48:51], 0
v_mfma_f32_16x16x32_bf16 v[64:67], v[160:163], v[52:55], v[64:67]
v_mfma_f32_16x16x32_bf16 v[68:71], v[164:167], v[52:55], v[68:71]
v_mfma_f32_16x16x32_bf16 v[72:75], v[168:171], v[52:55], v[72:75]
v_mfma_f32_16x16x32_bf16 v[76:79], v[172:175], v[52:55], v[76:79]
v_mfma_f32_16x16x32_bf16 v[80:83], v[176:179], v[52:55], v[80:83]
v_mfma_f32_16x16x32_bf16 v[84:87], v[180:183], v[52:55], v[84:87]
v_mfma_f32_16x16x32_bf16 v[88:91], v[184:187], v[52:55], v[88:91]
v_mfma_f32_16x16x32_bf16 v[92:95], v[188:191], v[52:55], v[92:95]
v_and_b32 v20, 7, v0
v_mul_u32_u24 v20, 272, v20
v_and_b32 v21, 8, v0
v_lshl_add_u32 v20, v21, 3, v20
v_and_b32 v21, 48, v0
v_add_u32 v20, v20, v21
s_mul_i32 s64, s34, 8192
s_add_u32 s64, s64, 4096
v_add_u32 v20, s64, v20
s_nop 7
v_add_f32_dpp v24, v80, v64 row_ror:8 row_mask:0xf bank_mask:0x3
v_add_f32_dpp v24, v68, v84 row_ror:8 row_mask:0xf bank_mask:0xc
v_add_f32_dpp v25, v81, v65 row_ror:8 row_mask:0xf bank_mask:0x3
v_add_f32_dpp v25, v69, v85 row_ror:8 row_mask:0xf bank_mask:0xc
v_add_f32_dpp v26, v82, v66 row_ror:8 row_mask:0xf bank_mask:0x3
v_add_f32_dpp v26, v70, v86 row_ror:8 row_mask:0xf bank_mask:0xc
v_add_f32_dpp v27, v83, v67 row_ror:8 row_mask:0xf bank_mask:0x3
v_add_f32_dpp v27, v71, v87 row_ror:8 row_mask:0xf bank_mask:0xc
ds_write_b128 v20, v[24:27] offset:0
v_add_f32_dpp v28, v88, v72 row_ror:8 row_mask:0xf bank_mask:0x3
v_add_f32_dpp v28, v76, v92 row_ror:8 row_mask:0xf bank_mask:0xc
v_add_f32_dpp v29, v89, v73 row_ror:8 row_mask:0xf bank_mask:0x3
v_add_f32_dpp v29, v77, v93 row_ror:8 row_mask:0xf bank_mask:0xc
v_add_f32_dpp v30, v90, v74 row_ror:8 row_mask:0xf bank_mask:0x3
v_add_f32_dpp v30, v78, v94 row_ror:8 row_mask:0xf bank_mask:0xc
v_add_f32_dpp v31, v91, v75 row_ror:8 row_mask:0xf bank_mask:0x3
v_add_f32_dpp v31, v79, v95 row_ror:8 row_mask:0xf bank_mask:0xc
ds_write_b128 v20, v[28:31] offset:128
v_mov_b32 v20, 0
s_waitcnt lgkmcnt(0)
s_mov_b64 exec, 1
ds_add_u32 v20, v9 offset:320
s_mov_b64 exec, -1
s_cmp_eq_u32 s34, 0
s_cbranch_scc0 L_waitq
s_cmp_lt_u32 s2, 16
s_cbranch_scc0 L_gq2
v_and_b32 v21, 7, v0
v_lshrrev_b32 v22, 4, v0
v_and_b32 v23, 8, v0
v_lshrrev_b32 v23, 1, v23
v_add_u32 v22, v22, v23
v_mov_b32 v23, v1
s_lshl_b32 s64, s72, 10
s_add_u32 s64, s64, 0
s_branch L_g4
L_gq2:
v_lshrrev_b32 v21, 3, v0
v_and_b32 v22, 7, v0
s_mov_b32 s64, 10240
s_cmp_lt_u32 s2, 48
s_cselect_b32 s64, 22528, s64
s_mov_b32 s65, 12288
v_mul_lo_u32 v23, s65, v21
v_lshl_add_u32 v23, v22, 4, v23
s_lshl_b32 s66, s72, 7
s_add_u32 s64, s64, s66
L_g4:
v_mul_u32_u24 v21, 272, v21
v_lshl_add_u32 v21, v22, 5, v21
v_add_u32 v21, 4096, v21
s_mov_b32 s75, 0
L_poll_154:
ds_read_b32 v22, v20 offset:320
s_waitcnt lgkmcnt(0)
v_cmp_gt_u32 vcc, 4, v22
s_cbranch_vccz L_pollx_155
s_add_u32 s75, s75, 1
s_cmp_lt_u32 s75, 0x1000000
s_cbranch_scc1 L_poll_154
L_pollx_155:
ds_read_b128 v[64:67], v21 offset:0
ds_read_b128 v[68:71], v21 offset:16
ds_read_b128 v[72:75], v21 offset:8192
ds_read_b128 v[76:79], v21 offset:8208
ds_read_b128 v[80:83], v21 offset:16384
ds_read_b128 v[84:87], v21 offset:16400
ds_read_b128 v[88:91], v21 offset:24576
ds_read_b128 v[92:95], v21 offset:24592
s_waitcnt lgkmcnt(0)
v_add_f32 v64, v64, v72
v_add_f32 v65, v65, v73
v_add_f32 v66, v66, v74
v_add_f32 v67, v67, v75
v_add_f32 v68, v68, v76
v_add_f32 v69, v69, v77
v_add_f32 v70, v70, v78
v_add_f32 v71, v71, v79
v_add_f32 v64, v64, v80
v_add_f32 v65, v65, v81
v_add_f32 v66, v66, v82
v_add_f32 v67, v67, v83
v_add_f32 v68, v68, v84
v_add_f32 v69, v69, v85
v_add_f32 v70, v70, v86
v_add_f32 v71, v71, v87
v_add_f32 v64, v64, v88
v_add_f32 v65, v65, v89
v_add_f32 v66, v66, v90
v_add_f32 v67, v67, v91
v_add_f32 v68, v68, v92
v_add_f32 v69, v69, v93
v_add_f32 v70, v70, v94
v_add_f32 v71, v71, v95
v_cvt_pk_bf16_f32 v24, v64, v65
v_cvt_pk_bf16_f32 v25, v66, v67
v_cvt_pk_bf16_f32 v26, v68, v69
v_cvt_pk_bf16_f32 v27, v70, v71
v_min_u32 v24, -2, v24
v_min_u32 v25, -2, v25
v_min_u32 v26, -2, v26
v_min_u32 v27, -2, v27
buffer_store_dwordx4 v[24:27], v23, s[36:39], s64 offen sc1
s_branch L_waitq
L_jan:
v_mov_b32 v4, -1
v_mov_b32 v5, -1
v_mov_b32 v6, -1
v_mov_b32 v7, -1
s_lshl_b32 s67, s64, 2
s_add_u32 s67, s67, s34
s_cmp_lt_u32 s67, 32
s_cselect_b32 s66, 0, 933888
s_mul_i32 s65, s67, 3072
s_add_u32 s65, s65, s66
s_add_u32 s65, s65, 16384
v_add_u32 v8, s65, v1
global_store_dwordx4 v8, v[4:7], s[30:31] offset:0 sc1
global_store_dwordx4 v8, v[4:7], s[30:31] offset:1024 sc1
global_store_dwordx4 v8, v[4:7], s[30:31] offset:2048 sc1
s_and_b32 s66, s67, 64
s_add_u32 s67, s67, s66
s_lshl_b32 s67, s67, 7
s_add_u32 s67, s67, 1343488
v_and_b32 v8, 8, v0
v_lshlrev_b32 v8, 10, v8
v_and_b32 v10, 0x70, v1
v_add3_u32 v8, v8, v10, s67
s_mov_b64 exec, 0xffff
global_store_dwordx4 v8, v[4:7], s[30:31] sc1
s_mov_b64 exec, 1
s_load_dword s68, s[30:31], 0x48000
s_and_b32 s65, s34, 1
s_lshl_b32 s66, s65, 13
s_xor_b32 s67, s67, s66
s_xor_b32 s66, s67, 0x2000
s_waitcnt vmcnt(0) lgkmcnt(0)
s_mov_b64 exec, -1
s_cmp_eq_u32 s34, 3
s_cbranch_scc1 L_p0_156
s_cmp_eq_u32 s34, 0
s_cselect_b32 s62, s24, s10
s_cselect_b32 s63, s25, s11
s_cmp_eq_u32 s34, 2
s_cselect_b32 s62, s12, s62
s_cselect_b32 s63, s13, s63
global_load_dword v12, v38, s[62:63]
global_load_dword v13, v39, s[62:63]
L_p0_156:
s_mov_b64 exec, 1
s_mov_b32 s70, 0
s_load_dword s68, s[30:31], s67
L_race_157:
s_getreg_b32 s69, hwreg(HW_REG_IB_STS, 8, 4)
s_add_u32 s70, s70, 1
s_cmp_eq_u32 s69, 0
s_cbranch_scc0 L_race_157
s_waitcnt lgkmcnt(0)
s_mov_b32 s71, 0
s_load_dword s68, s[30:31], s66
L_race_158:
s_getreg_b32 s69, hwreg(HW_REG_IB_STS, 8, 4)
s_add_u32 s71, s71, 1
s_cmp_eq_u32 s69, 0
s_cbranch_scc0 L_race_158
s_waitcnt lgkmcnt(0)
s_cmp_lt_u32 s71, s70
s_cselect_b32 s70, 1, 0
s_xor_b32 s70, s70, s65
s_getreg_b32 s69, hwreg(HW_REG_XCC_ID, 2, 1)
s_xor_b32 s70, s70, s69
s_lshl_b32 s69, s69, 14
s_lshl_b32 s70, s70, 8
s_add_u32 s70, s70, s69
s_add_u32 s70, s70, 1
v_mov_b32 v9, s70
s_lshl_b32 s65, s64, 2
v_mov_b32 v8, s65
ds_add_rtn_u32 v11, v2, v9 offset:320
s_waitcnt lgkmcnt(0)
v_add_u32 v11, v11, v9
v_and_b32 v10, 0xff, v11
v_cmp_eq_u32 vcc, 4, v10
s_cbranch_vccz L_j_159
global_store_dword v8, v11, s[28:29] offset:128 sc1
L_j_159:
s_mov_b64 exec, -1
s_branch L_nop0
L_norole:
s_cmp_eq_u32 s74, -1
s_cbranch_scc1 L_waitq
L_waitq:
s_cmp_eq_u32 s74, -1
s_cselect_b64 vcc, 0, -1
s_cmp_lt_u32 s2, 112
s_cselect_b64 vcc, -1, vcc
s_mov_b32 s44, s12
s_mov_b32 s45, s13
s_mov_b32 s46, 0x400000
s_mov_b32 s47, 0x20000
v_lshrrev_b32 v18, 4, v0
v_and_b32 v16, 15, v0
v_xor_b32 v16, v16, v18
v_xor_b32 v17, 4, v16
v_lshlrev_b32 v19, 10, v18
v_lshl_add_u32 v22, v16, 4, v19
v_lshl_add_u32 v23, v17, 4, v19
v_and_b32 v19, 1, v18
v_lshlrev_b32 v19, 10, v19
v_lshrrev_b32 v18, 1, v18
v_lshl_add_u32 v18, v18, 11, v19
v_lshl_add_u32 v16, v16, 4, v18
v_lshl_add_u32 v17, v17, 4, v18
v_lshrrev_b32 v18, 4, v0
v_bfe_u32 v19, v0, 2, 2
v_and_b32 v20, 2, v0
v_lshlrev_b32 v20, 2, v20
v_xor_b32 v20, v20, v19
v_and_b32 v21, 1, v18
v_lshlrev_b32 v21, 2, v21
v_xor_b32 v20, v20, v21
v_lshlrev_b32 v20, 4, v20
v_lshl_add_u32 v20, v18, 10, v20
v_lshl_add_u32 v20, v19, 8, v20
v_and_b32 v21, 1, v0
v_lshl_add_u32 v20, v21, 3, v20
s_lshl_b32 s65, s34, 13
s_add_u32 s65, s65, 8192
v_add_u32 v40, s65, v20
v_xor_b32 v41, 16, v40
v_xor_b32 v42, 32, v40
v_xor_b32 v43, 48, v40
v_xor_b32 v44, 64, v40
v_xor_b32 v45, 80, v40
v_xor_b32 v46, 96, v40
v_xor_b32 v47, 112, v40
s_lshl_b32 s64, s33, 17
s_lshl_b32 s66, s34, 8
s_add_u32 s64, s64, s66
s_mov_b32 s68, 0
s_lshl_b32 s66, s68, 10
s_add_u32 s64, s64, s66
s_add_u32 m0, s65, 0
s_xor_b32 s66, s64, 0
buffer_load_dwordx4 v16, s[44:47], s66 offen  lds
s_add_u32 m0, s65, 1024
s_xor_b32 s66, s64, 8192
buffer_load_dwordx4 v17, s[44:47], s66 offen  lds
s_add_u32 m0, s65, 2048
s_xor_b32 s66, s64, 16384
buffer_load_dwordx4 v16, s[44:47], s66 offen  lds
s_waitcnt vmcnt(2)
s_add_u32 m0, s65, 3072
s_xor_b32 s66, s64, 24576
buffer_load_dwordx4 v17, s[44:47], s66 offen  lds
s_waitcnt vmcnt(2)
s_add_u32 m0, s65, 32768
s_xor_b32 s66, s64, 4096
buffer_load_dwordx4 v16, s[44:47], s66 offen  lds
s_waitcnt vmcnt(2)
s_add_u32 m0, s65, 33792
s_xor_b32 s66, s64, 12288
buffer_load_dwordx4 v17, s[44:47], s66 offen  lds
s_waitcnt vmcnt(2)
ds_read_b64_tr_b16 v[128:129], v40 offset:0
ds_read_b64_tr_b16 v[136:137], v41 offset:0
ds_read_b64_tr_b16 v[144:145], v42 offset:0
ds_read_b64_tr_b16 v[152:153], v43 offset:0
ds_read_b64_tr_b16 v[160:161], v44 offset:0
ds_read_b64_tr_b16 v[168:169], v45 offset:0
ds_read_b64_tr_b16 v[176:177], v46 offset:0
ds_read_b64_tr_b16 v[184:185], v47 offset:0
s_add_u32 m0, s65, 34816
s_xor_b32 s66, s64, 20480
buffer_load_dwordx4 v16, s[44:47], s66 offen  lds
s_waitcnt vmcnt(2)
s_add_u32 m0, s65, 35840
s_xor_b32 s66, s64, 28672
buffer_load_dwordx4 v17, s[44:47], s66 offen  lds
s_waitcnt vmcnt(2)
s_waitcnt lgkmcnt(0)
s_add_u32 m0, s65, 0
s_xor_b32 s66, s64, 32768
buffer_load_dwordx4 v16, s[44:47], s66 offen  lds
s_waitcnt vmcnt(2)
s_add_u32 m0, s65, 1024
s_xor_b32 s66, s64, 40960
buffer_load_dwordx4 v17, s[44:47], s66 offen  lds
s_waitcnt vmcnt(2)
ds_read_b64_tr_b16 v[130:131], v40 offset:32768
ds_read_b64_tr_b16 v[138:139], v41 offset:32768
ds_read_b64_tr_b16 v[146:147], v42 offset:32768
ds_read_b64_tr_b16 v[154:155], v43 offset:32768
ds_read_b64_tr_b16 v[162:163], v44 offset:32768
ds_read_b64_tr_b16 v[170:171], v45 offset:32768
ds_read_b64_tr_b16 v[178:179], v46 offset:32768
ds_read_b64_tr_b16 v[186:187], v47 offset:32768
s_add_u32 m0, s65, 2048
s_xor_b32 s66, s64, 49152
buffer_load_dwordx4 v16, s[44:47], s66 offen  lds
s_waitcnt vmcnt(2)
s_add_u32 m0, s65, 3072
s_xor_b32 s66, s64, 57344
buffer_load_dwordx4 v17, s[44:47], s66 offen  lds
s_waitcnt vmcnt(2)
s_waitcnt lgkmcnt(0)
s_add_u32 m0, s65, 32768
s_xor_b32 s66, s64, 36864
buffer_load_dwordx4 v16, s[44:47], s66 offen  lds
s_waitcnt vmcnt(2)
s_add_u32 m0, s65, 33792
s_xor_b32 s66, s64, 45056
buffer_load_dwordx4 v17, s[44:47], s66 offen  lds
s_waitcnt vmcnt(2)
ds_read_b64_tr_b16 v[132:133], v40 offset:0
ds_read_b64_tr_b16 v[140:141], v41 offset:0
ds_read_b64_tr_b16 v[148:149], v42 offset:0
ds_read_b64_tr_b16 v[156:157], v43 offset:0
ds_read_b64_tr_b16 v[164:165], v44 offset:0
ds_read_b64_tr_b16 v[172:173], v45 offset:0
ds_read_b64_tr_b16 v[180:181], v46 offset:0
ds_read_b64_tr_b16 v[188:189], v47 offset:0
s_add_u32 m0, s65, 34816
s_xor_b32 s66, s64, 53248
buffer_load_dwordx4 v16, s[44:47], s66 offen  lds
s_waitcnt vmcnt(2)
s_add_u32 m0, s65, 35840
s_xor_b32 s66, s64, 61440
buffer_load_dwordx4 v17, s[44:47], s66 offen  lds
s_waitcnt vmcnt(2)
s_waitcnt lgkmcnt(0)
s_add_u32 m0, s65, 0
s_xor_b32 s66, s64, 65536
buffer_load_dwordx4 v16, s[44:47], s66 offen  lds
s_waitcnt vmcnt(2)
s_add_u32 m0, s65, 1024
s_xor_b32 s66, s64, 73728
buffer_load_dwordx4 v17, s[44:47], s66 offen  lds
s_waitcnt vmcnt(2)
ds_read_b64_tr_b16 v[134:135], v40 offset:32768
ds_read_b64_tr_b16 v[142:143], v41 offset:32768
ds_read_b64_tr_b16 v[150:151], v42 offset:32768
ds_read_b64_tr_b16 v[158:159], v43 offset:32768
ds_read_b64_tr_b16 v[166:167], v44 offset:32768
ds_read_b64_tr_b16 v[174:175], v45 offset:32768
ds_read_b64_tr_b16 v[182:183], v46 offset:32768
ds_read_b64_tr_b16 v[190:191], v47 offset:32768
s_add_u32 m0, s65, 2048
s_xor_b32 s66, s64, 81920
buffer_load_dwordx4 v16, s[44:47], s66 offen  lds
s_waitcnt vmcnt(2)
s_add_u32 m0, s65, 3072
s_xor_b32 s66, s64, 90112
buffer_load_dwordx4 v17, s[44:47], s66 offen  lds
s_waitcnt vmcnt(2)
s_waitcnt lgkmcnt(0)
s_add_u32 m0, s65, 32768
s_xor_b32 s66, s64, 69632
buffer_load_dwordx4 v16, s[44:47], s66 offen  lds
s_waitcnt vmcnt(2)
s_add_u32 m0, s65, 33792
s_xor_b32 s66, s64, 77824
buffer_load_dwordx4 v17, s[44:47], s66 offen  lds
s_waitcnt vmcnt(2)
ds_read_b64_tr_b16 v[192:193], v40 offset:0
ds_read_b64_tr_b16 v[200:201], v41 offset:0
ds_read_b64_tr_b16 v[208:209], v42 offset:0
ds_read_b64_tr_b16 v[216:217], v43 offset:0
ds_read_b64_tr_b16 v[224:225], v44 offset:0
ds_read_b64_tr_b16 v[232:233], v45 offset:0
ds_read_b64_tr_b16 v[240:241], v46 offset:0
ds_read_b64_tr_b16 v[248:249], v47 offset:0
s_add_u32 m0, s65, 34816
s_xor_b32 s66, s64, 86016
buffer_load_dwordx4 v16, s[44:47], s66 offen  lds
s_waitcnt vmcnt(2)
s_add_u32 m0, s65, 35840
s_xor_b32 s66, s64, 94208
buffer_load_dwordx4 v17, s[44:47], s66 offen  lds
s_waitcnt vmcnt(2)
s_waitcnt lgkmcnt(0)
s_add_u32 m0, s65, 0
s_xor_b32 s66, s64, 98304
buffer_load_dwordx4 v16, s[44:47], s66 offen  lds
s_waitcnt vmcnt(2)
s_add_u32 m0, s65, 1024
s_xor_b32 s66, s64, 106496
buffer_load_dwordx4 v17, s[44:47], s66 offen  lds
s_waitcnt vmcnt(2)
ds_read_b64_tr_b16 v[194:195], v40 offset:32768
ds_read_b64_tr_b16 v[202:203], v41 offset:32768
ds_read_b64_tr_b16 v[210:211], v42 offset:32768
ds_read_b64_tr_b16 v[218:219], v43 offset:32768
ds_read_b64_tr_b16 v[226:227], v44 offset:32768
ds_read_b64_tr_b16 v[234:235], v45 offset:32768
ds_read_b64_tr_b16 v[242:243], v46 offset:32768
ds_read_b64_tr_b16 v[250:251], v47 offset:32768
v_and_b32 v24, 127, v2
buffer_load_dword v25, v24, s[52:55], 0 offen offset:128
s_add_u32 m0, s65, 2048
s_xor_b32 s66, s64, 114688
buffer_load_dwordx4 v16, s[44:47], s66 offen  lds
s_waitcnt vmcnt(2)
s_add_u32 m0, s65, 3072
s_xor_b32 s66, s64, 122880
buffer_load_dwordx4 v17, s[44:47], s66 offen  lds
s_waitcnt vmcnt(2)
s_waitcnt lgkmcnt(0)
s_add_u32 m0, s65, 32768
s_xor_b32 s66, s64, 102400
buffer_load_dwordx4 v16, s[44:47], s66 offen  lds
s_waitcnt vmcnt(2)
s_add_u32 m0, s65, 33792
s_xor_b32 s66, s64, 110592
buffer_load_dwordx4 v17, s[44:47], s66 offen  lds
s_waitcnt vmcnt(2)
ds_read_b64_tr_b16 v[196:197], v40 offset:0
ds_read_b64_tr_b16 v[204:205], v41 offset:0
ds_read_b64_tr_b16 v[212:213], v42 offset:0
ds_read_b64_tr_b16 v[220:221], v43 offset:0
ds_read_b64_tr_b16 v[228:229], v44 offset:0
ds_read_b64_tr_b16 v[236:237], v45 offset:0
ds_read_b64_tr_b16 v[244:245], v46 offset:0
ds_read_b64_tr_b16 v[252:253], v47 offset:0
s_add_u32 m0, s65, 34816
s_xor_b32 s66, s64, 118784
buffer_load_dwordx4 v16, s[44:47], s66 offen  lds
s_waitcnt vmcnt(2)
s_add_u32 m0, s65, 35840
s_xor_b32 s66, s64, 126976
buffer_load_dwordx4 v17, s[44:47], s66 offen  lds
s_waitcnt vmcnt(0)
ds_read_b64_tr_b16 v[198:199], v40 offset:32768
ds_read_b64_tr_b16 v[206:207], v41 offset:32768
ds_read_b64_tr_b16 v[214:215], v42 offset:32768
ds_read_b64_tr_b16 v[222:223], v43 offset:32768
ds_read_b64_tr_b16 v[230:231], v44 offset:32768
ds_read_b64_tr_b16 v[238:239], v45 offset:32768
ds_read_b64_tr_b16 v[246:247], v46 offset:32768
ds_read_b64_tr_b16 v[254:255], v47 offset:32768
s_waitcnt lgkmcnt(0)
v_cmp_eq_u32 vcc, 0, v25
s_cbranch_vccz L_tab_160
s_mov_b32 s75, 0
L_poll_161:
buffer_load_dword v25, v24, s[52:55], 0 offen offset:128 sc1
s_waitcnt vmcnt(0)
v_cmp_eq_u32 vcc, 0, v25
s_cbranch_vccz L_pollx_162
s_sleep 40
s_add_u32 s75, s75, 1
s_cmp_lt_u32 s75, 0x100000
s_cbranch_scc1 L_poll_161
L_pollx_162:
L_tab_160:
v_bfe_u32 v26, v25, 8, 3
v_lshrrev_b32 v25, 16, v25
s_nop 0
v_add_u32_dpp v26, v26, v26 quad_perm:[1,0,3,2] row_mask:0xf bank_mask:0xf
s_nop 1
v_add_u32_dpp v26, v26, v26 quad_perm:[2,3,0,1] row_mask:0xf bank_mask:0xf
s_nop 1
v_add_u32_dpp v26, v26, v26 row_ror:4 row_mask:0xf bank_mask:0xf
s_nop 1
v_add_u32_dpp v26, v26, v26 row_ror:8 row_mask:0xf bank_mask:0xf
s_nop 1
v_readlane_b32 s66, v26, 0
v_readlane_b32 s71, v26, 16
s_add_u32 s66, s66, s71
s_cmp_gt_u32 s66, 64
s_cselect_b32 s66, 1, 0
v_cmp_ne_u32 vcc, s66, v25
s_and_b32 s71, vcc_lo, 0xff
s_bcnt0_i32_b32 s66, s71
s_sub_u32 s66, s66, 24
v_mbcnt_lo_u32_b32 v24, s71, 0
v_sub_u32 v25, v0, v24
v_add_u32 v24, s66, v24
v_cndmask_b32 v24, v25, v24, vcc
v_bfe_u32 v25, v24, 1, 2
v_and_b32 v26, 1, v24
v_lshl_or_b32 v25, v26, 2, v25
v_lshlrev_b32 v25, v2, v25
s_nop 1
v_or_b32_dpp v25, v25, v25 quad_perm:[1,0,3,2] row_mask:0xf bank_mask:0xf
s_nop 1
v_or_b32_dpp v25, v25, v25 quad_perm:[2,3,0,1] row_mask:0xf bank_mask:0xf
s_nop 1
v_or_b32_dpp v25, v25, v25 row_shl:4 row_mask:0xf bank_mask:0xf
s_nop 1
v_readfirstlane_b32 s35, v25
s_mov_b64 exec, 1
ds_write_b32 v2, v25 offset:328
s_mov_b64 exec, -1
s_sub_u32 s64, s2, 144
s_cmp_lt_u32 s64, 64
s_cbranch_scc0 L_rp_163
s_cmp_eq_u32 s34, 0
s_cbranch_scc0 L_rp_163
s_mov_b32 s48, s4
s_mov_b32 s49, s5
s_mov_b32 s50, 0x2000
s_mov_b32 s51, 0x20000
v_and_b32 v5, 15, v0
v_and_b32 v6, 16, v0
v_lshl_add_u32 v5, v6, 1, v5
v_and_b32 v6, 32, v0
v_lshrrev_b32 v6, 1, v6
v_add_u32 v5, v5, v6
v_lshlrev_b32 v5, 1, v5
v_and_b32 v6, 0x7c, v5
s_lshl_b32 s65, s64, 7
s_and_b32 s66, s65, 0x380
s_lshr_b32 s64, s64, 3
s_mul_i32 s64, s64, 12288
s_add_u32 s64, s64, s66
s_add_u32 s64, s64, 24576
buffer_load_ushort v18, v5, s[48:51], s65 offen
s_mov_b32 s75, 0
L_poll_164:
buffer_load_dword v19, v6, s[36:39], s64 offen offset:0 sc1
buffer_load_dword v20, v6, s[36:39], s64 offen offset:3072 sc1
s_waitcnt vmcnt(0)
v_max_u32 v16, v19, v20
v_cmp_eq_u32 vcc, -1, v16
s_cbranch_vccz L_pollx_165
s_sleep 40
s_add_u32 s75, s75, 1
s_cmp_lt_u32 s75, 0x100000
s_cbranch_scc1 L_poll_164
L_pollx_165:
v_and_b32 v16, 1, v0
v_lshlrev_b32 v16, 4, v16
v_xor_b32 v16, 16, v16
v_lshlrev_b32 v18, 16, v18
v_lshlrev_b32 v19, v16, v19
v_and_b32 v19, 0xffff0000, v19
v_lshlrev_b32 v20, v16, v20
v_and_b32 v20, 0xffff0000, v20
ds_write_b32 v2, v18 offset:4096
ds_write_b32 v2, v19 offset:4352
ds_write_b32 v2, v20 offset:4608
L_rp_163:
v_lshlrev_b32 v10, 3, v0
s_lshl_b32 s64, s34, 8
s_add_u32 s64, s64, 2560
s_lshr_b32 s66, s68, 1
v_xor_b32 v12, s66, v0
v_mov_b32 v14, 0
v_bfe_u32 v11, v12, 0, 1
v_lshl_or_b32 v14, v11, 0, v14
v_bfe_u32 v11, v12, 1, 1
v_lshl_or_b32 v14, v11, 1, v14
v_bfe_u32 v11, v12, 2, 1
v_lshl_or_b32 v14, v11, 2, v14
v_bfe_u32 v11, v12, 3, 1
v_lshl_or_b32 v14, v11, 3, v14
v_bfe_u32 v11, v12, 4, 1
v_lshl_or_b32 v14, v11, 4, v14
v_bfe_u32 v11, v12, 5, 1
v_lshl_or_b32 v14, v11, 5, v14
v_and_b32 v11, 0x38, v14
v_and_b32 v12, 1, v14
v_lshl_add_u32 v11, v12, 2, v11
v_bfe_u32 v12, v14, 1, 2
v_add_u32 v11, v11, v12
v_lshl_add_u32 v11, v11, 2, s64
v_and_b32 v14, 1, v0
v_and_b32 v12, 48, v0
v_lshlrev_b32 v12, 1, v12
v_lshl_add_u32 v12, v14, 4, v12
v_add_u32 v12, s64, v12
v_mul_u32_u24 v15, 0xaaaa, v14
v_add_u32 v15, 0x4444, v15
v_mov_b32 v64, 0
v_mov_b32 v65, 0
v_mov_b32 v66, 0
v_mov_b32 v67, 0
v_mov_b32 v68, 0
v_mov_b32 v69, 0
v_mov_b32 v70, 0
v_mov_b32 v71, 0
v_mov_b32 v72, 0
v_mov_b32 v73, 0
v_mov_b32 v74, 0
v_mov_b32 v75, 0
v_mov_b32 v76, 0
v_mov_b32 v77, 0
v_mov_b32 v78, 0
v_mov_b32 v79, 0
v_mov_b32 v80, 0
v_mov_b32 v81, 0
v_mov_b32 v82, 0
v_mov_b32 v83, 0
v_mov_b32 v84, 0
v_mov_b32 v85, 0
v_mov_b32 v86, 0
v_mov_b32 v87, 0
v_mov_b32 v88, 0
v_mov_b32 v89, 0
v_mov_b32 v90, 0
v_mov_b32 v91, 0
v_mov_b32 v92, 0
v_mov_b32 v93, 0
v_mov_b32 v94, 0
v_mov_b32 v95, 0
s_lshl_b32 s64, s34, 3
s_lshr_b32 s64, s35, s64
v_bfe_u32 v13, v0, 3, 1
v_lshlrev_b32 v13, 2, v13
v_bfe_u32 v13, s64, v13, 3
v_and_b32 v14, 0x70, v1
v_lshl_add_u32 v13, v13, 12, v14
s_lshl_b32 s64, s34, 2
s_add_u32 s64, s64, s33
v_bfe_u32 v14, v0, 3, 1
v_lshl_add_u32 v14, v14, 1, s64
v_and_b32 v14, 31, v14
v_lshl_add_u32 v13, v14, 7, v13
s_lshl_b32 s69, s32, 15
s_add_u32 s69, s69, 1048576
s_waitcnt vmcnt(0) lgkmcnt(0)
s_barrier
ds_read_b64 v[20:21], v10 offset:512
ds_read_b64 v[22:23], v10 offset:1024
ds_read_b64 v[24:25], v10 offset:1536
ds_read_b64 v[26:27], v10 offset:2048
s_waitcnt lgkmcnt(2)
v_pk_add_f32 v[20:21], v[20:21], v[22:23]
s_waitcnt lgkmcnt(1)
v_pk_add_f32 v[20:21], v[20:21], v[24:25]
s_waitcnt lgkmcnt(0)
v_pk_add_f32 v[20:21], v[20:21], v[26:27]
v_cvt_pk_bf16_f32 v20, v20, v21
ds_write_b32 v11, v20
ds_read_b128 v[48:51], v12 offset:0
ds_read_b128 v[52:55], v12 offset:128
s_waitcnt lgkmcnt(1)
v_smfmac_f32_16x16x64_bf16 v[64:67], v[48:51], v[128:135], v15
v_smfmac_f32_16x16x64_bf16 v[68:71], v[48:51], v[136:143], v15
v_smfmac_f32_16x16x64_bf16 v[72:75], v[48:51], v[144:151], v15
v_smfmac_f32_16x16x64_bf16 v[76:79], v[48:51], v[152:159], v15
s_waitcnt lgkmcnt(0)
v_smfmac_f32_16x16x64_bf16 v[64:67], v[52:55], v[192:199], v15
v_smfmac_f32_16x16x64_bf16 v[68:71], v[52:55], v[200:207], v15
v_smfmac_f32_16x16x64_bf16 v[72:75], v[52:55], v[208:215], v15
v_smfmac_f32_16x16x64_bf16 v[76:79], v[52:55], v[216:223], v15
v_smfmac_f32_16x16x64_bf16 v[80:83], v[48:51], v[160:167], v15
v_smfmac_f32_16x16x64_bf16 v[84:87], v[48:51], v[168:175], v15
v_smfmac_f32_16x16x64_bf16 v[88:91], v[48:51], v[176:183], v15
v_smfmac_f32_16x16x64_bf16 v[92:95], v[48:51], v[184:191], v15
v_smfmac_f32_16x16x64_bf16 v[80:83], v[52:55], v[224:231], v15
v_add_f32 v64, v64, v65
v_smfmac_f32_16x16x64_bf16 v[84:87], v[52:55], v[232:239], v15
v_add_f32 v68, v68, v69
v_add_f32 v72, v72, v73
v_smfmac_f32_16x16x64_bf16 v[88:91], v[52:55], v[240:247], v15
v_add_f32 v76, v76, v77
v_cvt_pk_bf16_f32 v20, v64, v68
v_smfmac_f32_16x16x64_bf16 v[92:95], v[52:55], v[248:255], v15
v_cvt_pk_bf16_f32 v21, v72, v76
v_add_f32 v80, v80, v81
s_mov_b64 exec, 0xffff
v_add_f32 v84, v84, v85
v_cvt_pk_bf16_f32 v22, v80, v84
s_nop 0
v_add_f32 v88, v88, v89
s_nop 0
v_add_f32 v92, v92, v93
v_cvt_pk_bf16_f32 v23, v88, v92
buffer_store_dwordx4 v[20:23], v13, s[36:39], s69 offen sc1
s_mov_b64 exec, -1
s_sub_u32 s67, s2, 16
s_cmp_lt_u32 s67, 128
s_cbranch_scc0 L_nogp
s_and_b32 s66, s2, 7
s_min_u32 s64, s66, 3
s_mul_i32 s71, s66, 5
s_add_u32 s64, s64, s71
s_cmp_lt_u32 s66, 3
s_cselect_b32 s66, 5, 4
v_and_b32 v8, 7, v0
v_min_u32 v8, s66, v8
v_add_u32 v8, s64, v8
s_and_b32 s64, s67, 0xf8
s_lshl_b32 s64, s64, 2
s_lshl_b32 s66, s34, 3
s_add_u32 s64, s64, s66
v_lshrrev_b32 v9, 3, v0
v_add_u32 v9, s64, v9
v_mul_u32_u24 v9, 2752, v9
v_lshl_add_u32 v8, v8, 6, v9
global_load_dword v10, v8, s[16:17]
global_load_dword v11, v8, s[18:19]
s_and_b32 s66, s2, 7
s_min_u32 s70, s66, 3
s_mul_i32 s71, s66, 5
s_add_u32 s70, s70, s71
s_cmp_lt_u32 s66, 3
s_cselect_b32 s66, 6, 5
s_lshl_b32 s66, s66, 8
s_sub_u32 s66, s66, 1
s_lshr_b32 s71, s67, 3
s_lshl_b32 s71, s71, 2
s_add_u32 s71, s71, s34
s_mul_i32 s71, s71, 24
v_min_u32 v12, 23, v0
v_add_u32 v12, s71, v12
v_min_u32 v12, s66, v12
s_lshl_b32 s70, s70, 15
v_lshl_add_u32 v12, v12, 7, s70
global_load_dword v13, v12, s[20:21]
s_endpgm
L_nogp:
L_tail_s:
s_cmp_eq_u32 s74, -1
s_cbranch_scc0 L_ffn
s_cmp_eq_u32 s3, 0
s_cbranch_scc0 L_fin
s_sub_u32 s70, s2, 144
s_cmp_lt_u32 s70, 64
s_cbranch_scc0 L_fin
s_lshl_b32 s64, s70, 2
s_lshr_b32 s67, s35, s64
s_and_b32 s71, s67, 7
s_andn2_b32 s66, s70, 7
s_add_u32 s66, s66, s71
s_lshl_b32 s66, s66, 12
s_add_u32 s66, s66, 1048576
buffer_load_dwordx4 v[16:19], v1, s[36:39], s66 offen offset:0 sc1
buffer_load_dwordx4 v[20:23], v1, s[36:39], s66 offen offset:1024 sc1
buffer_load_dwordx4 v[24:27], v1, s[36:39], s66 offen offset:2048 sc1
buffer_load_dwordx4 v[28:31], v1, s[36:39], s66 offen offset:3072 sc1
v_mov_b32 v32, -1
v_mov_b32 v33, -1
v_mov_b32 v34, -1
v_mov_b32 v35, -1
s_and_b32 s64, s71, 6
s_lshl_b32 s64, s64, 12
s_and_b32 s65, s71, 1
s_lshl_b32 s65, s65, 15
s_or_b32 s64, s64, s65
s_lshr_b32 s65, s70, 3
s_lshl_b32 s65, s65, 16
s_add_u32 s64, s64, s65
s_lshr_b32 s65, s70, 4
s_lshl_b32 s65, s65, 2
s_and_b32 s67, s70, 7
s_add_u32 s65, s65, s67
s_lshl_b32 s65, s65, 7
s_add_u32 s64, s64, s65
s_add_u32 s64, s64, 1376256
s_add_u32 s65, s64, 4096
buffer_store_dwordx4 v[32:35], v1, s[36:39], s64 offen offset:0 sc1
buffer_store_dwordx4 v[32:35], v1, s[36:39], s64 offen offset:1024 sc1
buffer_store_dwordx4 v[32:35], v1, s[36:39], s64 offen offset:2048 sc1
buffer_store_dwordx4 v[32:35], v1, s[36:39], s64 offen offset:3072 sc1
buffer_store_dwordx4 v[32:35], v1, s[36:39], s65 offen offset:0 sc1
s_mov_b64 exec, 0xffffff
buffer_store_dwordx4 v[32:35], v1, s[36:39], s65 offen offset:1024 sc1
s_mov_b64 exec, -1
v_lshlrev_b32 v2, 2, v0
ds_read_b32 v8, v2 offset:4096
ds_read_b32 v9, v2 offset:4352
ds_read_b32 v10, v2 offset:4608
s_mov_b32 s56, s26
s_mov_b32 s57, s27
s_mov_b32 s58, 0x2000
s_mov_b32 s59, 0x20000
v_and_b32 v5, 15, v0
v_and_b32 v6, 16, v0
v_lshl_add_u32 v5, v6, 1, v5
v_and_b32 v6, 32, v0
v_lshrrev_b32 v6, 1, v6
v_add_u32 v5, v5, v6
v_lshlrev_b32 v5, 1, v5
v_and_b32 v6, 0x7c, v5
s_lshl_b32 s73, s70, 7
v_and_b32 v11, 1, v0
v_lshlrev_b32 v3, 4, v11
v_mov_b32 v7, 0x3f80
v_lshlrev_b32 v7, v3, v7
v_and_b32 v2, 4, v0
v_cmp_eq_u32 vcc, 0, v2
v_bfe_u32 v2, v0, 1, 1
v_mul_u32_u24 v43, 0xaaaa, v2
v_add_u32 v43, 0x4444, v43
v_cndmask_b32 v44, 0, v7, vcc
v_sub_u32 v45, v7, v44
v_mov_b32 v46, v44
v_mov_b32 v47, v45
v_mov_b32 v48, 0
v_mov_b32 v49, 0
v_mov_b32 v50, 0
v_mov_b32 v51, 0
v_mov_b32 v52, 0
v_mov_b32 v53, 0
v_mov_b32 v54, 0
v_mov_b32 v55, 0
s_add_u32 s68, s73, 1310720
s_mov_b32 s76, 0xaaaaaaaa
s_mov_b32 s77, 0xaaaaaaaa
v_cmp_gt_u32 vcc, 24, v0
v_mov_b32 v41, 0x40000000
v_lshl_add_u32 v12, v11, 13, v6
v_cndmask_b32 v41, v41, v1, vcc
s_mov_b32 s75, 0
s_waitcnt vmcnt(0) lgkmcnt(0)
buffer_load_dwordx4 v[16:19], v1, s[36:39], s66 offen offset:0 sc1
buffer_load_dwordx4 v[20:23], v1, s[36:39], s66 offen offset:1024 sc1
buffer_load_dwordx4 v[24:27], v1, s[36:39], s66 offen offset:2048 sc1
buffer_load_dwordx4 v[28:31], v1, s[36:39], s66 offen offset:3072 sc1
s_sleep 1
buffer_load_dwordx4 v[16:19], v1, s[36:39], s66 offen offset:0 sc1
buffer_load_dwordx4 v[20:23], v1, s[36:39], s66 offen offset:1024 sc1
buffer_load_dwordx4 v[24:27], v1, s[36:39], s66 offen offset:2048 sc1
buffer_load_dwordx4 v[28:31], v1, s[36:39], s66 offen offset:3072 sc1
s_sleep 1
buffer_load_dwordx4 v[16:19], v1, s[36:39], s66 offen offset:0 sc1
buffer_load_dwordx4 v[20:23], v1, s[36:39], s66 offen offset:1024 sc1
buffer_load_dwordx4 v[24:27], v1, s[36:39], s66 offen offset:2048 sc1
buffer_load_dwordx4 v[28:31], v1, s[36:39], s66 offen offset:3072 sc1
s_sleep 1
L_rn_168:
v_smfmac_f32_16x16x64_bf16 v[48:51], v[44:47], v[16:23], v43
v_smfmac_f32_16x16x64_bf16 v[48:51], v[44:47], v[24:31], v43
buffer_load_dwordx4 v[16:19], v1, s[36:39], s66 offen offset:0 sc1
buffer_load_dwordx4 v[20:23], v1, s[36:39], s66 offen offset:1024 sc1
buffer_load_dwordx4 v[24:27], v1, s[36:39], s66 offen offset:2048 sc1
buffer_load_dwordx4 v[28:31], v1, s[36:39], s66 offen offset:3072 sc1
s_add_u32 s75, s75, 1
s_and_b32 s78, s75, 15
s_nop 1
v_add_f32_dpp v13, v48, v48 row_ror:8 row_mask:0x3 bank_mask:0x3
v_add_f32_dpp v13, v49, v49 row_ror:8 row_mask:0x3 bank_mask:0xc
v_add_f32_dpp v13, v50, v50 row_ror:8 row_mask:0xc bank_mask:0x3
v_add_f32_dpp v13, v51, v51 row_ror:8 row_mask:0xc bank_mask:0xc
v_cmp_u_f32 vcc, v13, v13
s_cbranch_vccz L_rz_169
v_mov_b32 v48, 0
v_mov_b32 v49, 0
v_mov_b32 v50, 0
v_mov_b32 v51, 0
s_waitcnt vmcnt(12)
s_cbranch_scc1 L_rn_168
v_max3_u32 v2, v16, v17, v18
v_max3_u32 v2, v2, v19, v20
v_max3_u32 v2, v2, v21, v22
v_max3_u32 v2, v2, v23, v24
v_max3_u32 v2, v2, v25, v26
v_max3_u32 v2, v2, v27, v28
v_max3_u32 v2, v2, v29, v30
v_max_u32 v2, v2, v31
v_cmp_eq_u32 vcc, -1, v2
s_cbranch_vccz L_rx_167
s_cmp_lt_u32 s75, 0x100000
s_cbranch_scc1 L_rn_168
L_rx_167:
v_smfmac_f32_16x16x64_bf16 v[48:51], v[44:47], v[16:23], v43
v_smfmac_f32_16x16x64_bf16 v[48:51], v[44:47], v[24:31], v43
s_nop 7
v_add_f32_dpp v13, v48, v48 row_ror:8 row_mask:0x3 bank_mask:0x3
v_add_f32_dpp v13, v49, v49 row_ror:8 row_mask:0x3 bank_mask:0xc
v_add_f32_dpp v13, v50, v50 row_ror:8 row_mask:0xc bank_mask:0x3
v_add_f32_dpp v13, v51, v51 row_ror:8 row_mask:0xc bank_mask:0xc
L_rz_169:
v_fmac_f32 v8, v13, v9
s_nop 1
v_mov_b32_dpp v14, v8 quad_perm:[1,1,3,3] row_mask:0xf bank_mask:0xf
v_mov_b32_dpp v13, v8 quad_perm:[0,0,2,2] row_mask:0xf bank_mask:0xf
v_cvt_pk_bf16_f32 v13, v13, v14
buffer_store_dword v13, v12, s[36:39], s68 offen sc1
v_cvt_pk_bf16_f32 v8, 0, v8
buffer_load_dwordx4 v[64:67], v1, s[36:39], s64 offen offset:0 sc1
buffer_load_dwordx4 v[68:71], v1, s[36:39], s64 offen offset:1024 sc1
buffer_load_dwordx4 v[72:75], v1, s[36:39], s64 offen offset:2048 sc1
buffer_load_dwordx4 v[76:79], v1, s[36:39], s64 offen offset:3072 sc1
buffer_load_dwordx4 v[80:83], v1, s[36:39], s65 offen offset:0 sc1
buffer_load_dwordx4 v[84:87], v41, s[36:39], s65 offen offset:1024 sc1
s_mov_b32 s75, 0
s_waitcnt vmcnt(0)
buffer_load_dwordx4 v[64:67], v1, s[36:39], s64 offen offset:0 sc1
buffer_load_dwordx4 v[68:71], v1, s[36:39], s64 offen offset:1024 sc1
buffer_load_dwordx4 v[72:75], v1, s[36:39], s64 offen offset:2048 sc1
buffer_load_dwordx4 v[76:79], v1, s[36:39], s64 offen offset:3072 sc1
buffer_load_dwordx4 v[80:83], v1, s[36:39], s65 offen offset:0 sc1
buffer_load_dwordx4 v[84:87], v41, s[36:39], s65 offen offset:1024 sc1
s_sleep 1
buffer_load_dwordx4 v[64:67], v1, s[36:39], s64 offen offset:0 sc1
buffer_load_dwordx4 v[68:71], v1, s[36:39], s64 offen offset:1024 sc1
buffer_load_dwordx4 v[72:75], v1, s[36:39], s64 offen offset:2048 sc1
buffer_load_dwordx4 v[76:79], v1, s[36:39], s64 offen offset:3072 sc1
buffer_load_dwordx4 v[80:83], v1, s[36:39], s65 offen offset:0 sc1
buffer_load_dwordx4 v[84:87], v41, s[36:39], s65 offen offset:1024 sc1
s_sleep 1
L_rn_172:
v_smfmac_f32_16x16x64_bf16 v[52:55], v[44:47], v[64:71], v43
v_smfmac_f32_16x16x64_bf16 v[52:55], v[44:47], v[72:79], v43
v_smfmac_f32_16x16x64_bf16 v[52:55], v[44:47], v[80:87], v43
buffer_load_dwordx4 v[64:67], v1, s[36:39], s64 offen offset:0 sc1
buffer_load_dwordx4 v[68:71], v1, s[36:39], s64 offen offset:1024 sc1
buffer_load_dwordx4 v[72:75], v1, s[36:39], s64 offen offset:2048 sc1
buffer_load_dwordx4 v[76:79], v1, s[36:39], s64 offen offset:3072 sc1
buffer_load_dwordx4 v[80:83], v1, s[36:39], s65 offen offset:0 sc1
buffer_load_dwordx4 v[84:87], v41, s[36:39], s65 offen offset:1024 sc1
s_add_u32 s75, s75, 1
s_and_b32 s78, s75, 15
v_add_f32_dpp v13, v52, v52 row_ror:8 row_mask:0x3 bank_mask:0x3
v_add_f32_dpp v13, v53, v53 row_ror:8 row_mask:0x3 bank_mask:0xc
v_add_f32_dpp v13, v54, v54 row_ror:8 row_mask:0xc bank_mask:0x3
v_add_f32_dpp v13, v55, v55 row_ror:8 row_mask:0xc bank_mask:0xc
v_cmp_u_f32 vcc, v13, v13
s_cbranch_vccz L_rz_173
v_mov_b32 v52, 0
v_mov_b32 v53, 0
v_mov_b32 v54, 0
v_mov_b32 v55, 0
s_waitcnt vmcnt(12)
s_cbranch_scc1 L_rn_172
v_max3_u32 v2, v64, v65, v66
v_max3_u32 v2, v2, v67, v68
v_max3_u32 v2, v2, v69, v70
v_max3_u32 v2, v2, v71, v72
v_max3_u32 v2, v2, v73, v74
v_max3_u32 v2, v2, v75, v76
v_max3_u32 v2, v2, v77, v78
v_max3_u32 v2, v2, v79, v80
v_max3_u32 v2, v2, v81, v82
v_max3_u32 v2, v2, v83, v84
v_max3_u32 v2, v2, v85, v86
v_max_u32 v2, v2, v87
v_cmp_eq_u32 vcc, -1, v2
s_cbranch_vccz L_rx_171
s_cmp_lt_u32 s75, 0x100000
s_cbranch_scc1 L_rn_172
L_rx_171:
v_smfmac_f32_16x16x64_bf16 v[52:55], v[44:47], v[64:71], v43
v_smfmac_f32_16x16x64_bf16 v[52:55], v[44:47], v[72:79], v43
v_smfmac_f32_16x16x64_bf16 v[52:55], v[44:47], v[80:87], v43
s_nop 7
v_add_f32_dpp v13, v52, v52 row_ror:8 row_mask:0x3 bank_mask:0x3
v_add_f32_dpp v13, v53, v53 row_ror:8 row_mask:0x3 bank_mask:0xc
v_add_f32_dpp v13, v54, v54 row_ror:8 row_mask:0xc bank_mask:0x3
v_add_f32_dpp v13, v55, v55 row_ror:8 row_mask:0xc bank_mask:0xc
L_rz_173:
v_fmac_f32 v8, v13, v10
s_nop 1
v_mov_b32_dpp v14, v8 quad_perm:[1,1,3,3] row_mask:0xf bank_mask:0xf
s_not_b64 exec, s[76:77]
v_cvt_pk_bf16_f32 v13, v8, v14
buffer_store_dword v13, v6, s[56:59], s73 offen sc1
s_mov_b64 exec, -1
s_cmp_lt_u32 s70, 8
s_cbranch_scc0 L_fin2
s_mov_b64 exec, 0xffff
buffer_store_dwordx4 v[44:47], v1, s[36:39], s62 offen sc1
s_mov_b64 exec, -1
L_fin2:
s_endpgm
L_ffn:
s_mul_i32 s67, s3, 12288
s_add_u32 s67, s67, 25600
v_lshlrev_b32 v7, 3, v0
buffer_load_dwordx4 v[8:11], v1, s[36:39], s67 offen offset:0 sc1
buffer_load_dwordx4 v[12:15], v1, s[36:39], s67 offen offset:1024 sc1
s_cmp_lt_u32 s3, 4
s_cbranch_scc1 L_post_174
s_mov_b32 s40, s16
s_mov_b32 s41, s17
s_mov_b32 s42, 0x158000
s_mov_b32 s43, 0x20000
s_mov_b32 s56, s18
s_mov_b32 s57, s19
s_mov_b32 s58, 0x158000
s_mov_b32 s59, 0x20000
v_lshrrev_b32 v16, 2, v0
v_mul_u32_u24 v16, 2752, v16
v_and_b32 v17, 3, v0
v_lshrrev_b32 v18, 5, v0
v_xor_b32 v17, v17, v18
v_xor_b32 v18, 2, v17
v_lshl_add_u32 v17, v17, 4, v16
v_lshl_add_u32 v18, v18, 4, v16
s_mul_i32 s64, s34, 352256
s_lshl_b32 s65, s74, 6
s_add_u32 s64, s64, s65
s_lshl_b32 s65, s34, 13
s_add_u32 m0, s65, 4096
s_add_u32 s66, s64, 0
buffer_load_dwordx4 v17, s[40:43], s66 offen  lds
s_add_u32 m0, s65, 36864
s_add_u32 s66, s64, 0
buffer_load_dwordx4 v18, s[56:59], s66 offen  lds
s_add_u32 m0, s65, 5120
s_add_u32 s66, s64, 44032
buffer_load_dwordx4 v17, s[40:43], s66 offen  lds
s_add_u32 m0, s65, 37888
s_add_u32 s66, s64, 44032
buffer_load_dwordx4 v18, s[56:59], s66 offen  lds
s_add_u32 m0, s65, 6144
s_add_u32 s66, s64, 88064
buffer_load_dwordx4 v17, s[40:43], s66 offen  lds
s_add_u32 m0, s65, 38912
s_add_u32 s66, s64, 88064
buffer_load_dwordx4 v18, s[56:59], s66 offen  lds
s_add_u32 m0, s65, 7168
s_add_u32 s66, s64, 132096
buffer_load_dwordx4 v17, s[40:43], s66 offen  lds
s_add_u32 m0, s65, 39936
s_add_u32 s66, s64, 132096
buffer_load_dwordx4 v18, s[56:59], s66 offen  lds
s_add_u32 m0, s65, 8192
s_add_u32 s66, s64, 176128
buffer_load_dwordx4 v17, s[40:43], s66 offen  lds
s_add_u32 m0, s65, 40960
s_add_u32 s66, s64, 176128
buffer_load_dwordx4 v18, s[56:59], s66 offen  lds
s_add_u32 m0, s65, 9216
s_add_u32 s66, s64, 220160
buffer_load_dwordx4 v17, s[40:43], s66 offen  lds
s_add_u32 m0, s65, 41984
s_add_u32 s66, s64, 220160
buffer_load_dwordx4 v18, s[56:59], s66 offen  lds
s_add_u32 m0, s65, 10240
s_add_u32 s66, s64, 264192
buffer_load_dwordx4 v17, s[40:43], s66 offen  lds
s_add_u32 m0, s65, 43008
s_add_u32 s66, s64, 264192
buffer_load_dwordx4 v18, s[56:59], s66 offen  lds
s_add_u32 m0, s65, 11264
s_add_u32 s66, s64, 308224
buffer_load_dwordx4 v17, s[40:43], s66 offen  lds
s_add_u32 m0, s65, 44032
s_add_u32 s66, s64, 308224
buffer_load_dwordx4 v18, s[56:59], s66 offen  lds
s_waitcnt vmcnt(16)
s_branch L_post_175
L_post_174:
s_waitcnt vmcnt(0)
L_post_175:
v_max3_u32 v16, v8, v9, v10
v_max3_u32 v16, v16, v11, v12
v_max3_u32 v16, v16, v13, v14
v_max_u32 v16, v16, v15
v_cmp_eq_u32 vcc, -1, v16
s_cbranch_vccz L_cb_176
s_mov_b32 s75, 0
L_poll_177:
buffer_load_dwordx4 v[8:11], v1, s[36:39], s67 offen offset:0 sc1
buffer_load_dwordx4 v[12:15], v1, s[36:39], s67 offen offset:1024 sc1
s_waitcnt vmcnt(0)
v_max3_u32 v16, v8, v9, v10
v_max3_u32 v16, v16, v11, v12
v_max3_u32 v16, v16, v13, v14
v_max_u32 v16, v16, v15
v_cmp_eq_u32 vcc, -1, v16
s_cbranch_vccz L_pollx_178
s_add_u32 s75, s75, 1
s_cmp_lt_u32 s75, 0x100000
s_cbranch_scc1 L_poll_177
L_pollx_178:
L_cb_176:
s_mov_b32 s68, 0xffff0000
v_lshlrev_b32 v24, 16, v8
v_and_b32 v25, s68, v8
v_lshlrev_b32 v32, 16, v12
v_and_b32 v33, s68, v12
v_lshlrev_b32 v26, 16, v9
v_and_b32 v27, s68, v9
v_lshlrev_b32 v34, 16, v13
v_and_b32 v35, s68, v13
v_lshlrev_b32 v28, 16, v10
v_and_b32 v29, s68, v10
v_lshlrev_b32 v36, 16, v14
v_and_b32 v37, s68, v14
v_lshlrev_b32 v30, 16, v11
v_and_b32 v31, s68, v11
v_lshlrev_b32 v38, 16, v15
v_and_b32 v39, s68, v15
v_add_f32 v32, 1.0, v32
v_add_f32 v33, 1.0, v33
v_add_f32 v34, 1.0, v34
v_add_f32 v35, 1.0, v35
v_add_f32 v36, 1.0, v36
v_add_f32 v37, 1.0, v37
v_add_f32 v38, 1.0, v38
v_add_f32 v39, 1.0, v39
v_lshrrev_b32 v2, 3, v0
v_bfe_u32 v3, v0, 1, 3
v_and_b32 v4, 3, v3
s_lshl_b32 s64, s3, 1
v_xor_b32 v3, s64, v3
v_lshlrev_b32 v5, 10, v2
v_lshl_add_u32 v5, v4, 8, v5
v_lshl_add_u32 v5, v3, 4, v5
v_and_b32 v4, 1, v0
v_lshl_add_u32 v5, v4, 3, v5
v_add_u32 v5, 69632, v5
v_xor_b32 v6, 16, v5
v_mul_u32_u24 v16, 0xaaaa, v4
v_add_u32 v16, 0x4444, v16
v_lshrrev_b32 v2, 4, v0
v_bfe_u32 v3, v0, 3, 1
v_xor_b32 v7, v2, v0
v_lshlrev_b32 v7, 4, v7
v_add_u32 v7, 69632, v7
v_xor_b32 v8, 64, v7
v_and_b32 v4, 7, v0
v_and_b32 v9, 0x38, v0
v_lshlrev_b32 v9, 3, v9
v_lshl_add_u32 v9, v4, 1, v9
s_lshl_b32 s64, s34, 4
v_add_u32 v9, s64, v9
v_and_b32 v10, 12, v0
v_lshlrev_b32 v10, 5, v10
v_and_b32 v4, 1, v0
v_lshl_add_u32 v10, v4, 6, v10
v_lshl_add_u32 v10, v2, 4, v10
v_mov_b32 v17, 0xbfb8aa3b
v_mov_b32 v64, 0
v_mov_b32 v65, 0
v_mov_b32 v66, 0
v_mov_b32 v67, 0
s_lshl_b32 s64, s34, 3
s_lshr_b32 s64, s35, s64
v_lshlrev_b32 v3, 2, v3
v_bfe_u32 v3, s64, v3, 3
v_and_b32 v11, 6, v3
v_lshlrev_b32 v11, 12, v11
v_and_b32 v3, 1, v3
v_lshl_add_u32 v11, v3, 15, v11
v_lshl_add_u32 v11, v2, 17, v11
v_and_b32 v4, 240, v1
v_add_u32 v11, v11, v4
v_lshl_add_u32 v11, v2, 9, v11
s_lshl_b32 s64, s34, 8
v_add_u32 v11, s64, v11
s_lshl_b32 s69, s74, 7
s_add_u32 s69, s69, 1376256
s_add_u32 s72, s69, 65536
s_lshl_b32 s64, s3, 10
s_lshl_b32 s65, s2, 2
s_lshr_b32 s65, s35, s65
s_and_b32 s65, s65, 2
s_lshl_b32 s65, s65, 12
s_add_u32 s64, s64, s65
s_add_u32 s64, s64, 1310720
v_mov_b32 v14, 0xbb000000
v_mov_b32 v15, 0x3b000000
v_lshrrev_b32 v18, 4, v0
v_bfe_u32 v19, v0, 2, 2
v_bfe_u32 v20, v0, 1, 1
v_and_b32 v22, 1, v18
v_lshl_add_u32 v22, v20, 1, v22
v_xor_b32 v22, s34, v22
v_lshlrev_b32 v22, 4, v22
v_lshl_add_u32 v22, v20, 15, v22
v_lshl_add_u32 v22, v18, 9, v22
v_lshl_add_u32 v22, v19, 6, v22
v_and_b32 v20, 1, v0
v_lshl_add_u32 v22, v20, 3, v22
v_add_u32 v22, 4096, v22
s_lshr_b32 s73, s3, 2
s_waitcnt vmcnt(0)
s_barrier
buffer_load_dwordx4 v[56:59], v1, s[36:39], s64 offen sc1
s_cmp_eq_u32 s73, 0
s_cbranch_scc1 L_gu_180
ds_read_b64_tr_b16 v[128:129], v22 offset:0
ds_read_b64_tr_b16 v[130:131], v22 offset:256
ds_read_b64_tr_b16 v[132:133], v22 offset:2048
ds_read_b64_tr_b16 v[134:135], v22 offset:2304
ds_read_b64_tr_b16 v[136:137], v22 offset:4096
ds_read_b64_tr_b16 v[138:139], v22 offset:4352
ds_read_b64_tr_b16 v[140:141], v22 offset:6144
ds_read_b64_tr_b16 v[142:143], v22 offset:6400
ds_read_b64_tr_b16 v[144:145], v22 offset:8192
ds_read_b64_tr_b16 v[146:147], v22 offset:8448
ds_read_b64_tr_b16 v[148:149], v22 offset:10240
s_waitcnt lgkmcnt(4)
ds_read_b64_tr_b16 v[150:151], v22 offset:10496
ds_read_b64_tr_b16 v[152:153], v22 offset:12288
ds_read_b64_tr_b16 v[154:155], v22 offset:12544
ds_read_b64_tr_b16 v[156:157], v22 offset:14336
ds_read_b64_tr_b16 v[158:159], v22 offset:14592
ds_read_b64_tr_b16 v[160:161], v22 offset:16384
ds_read_b64_tr_b16 v[162:163], v22 offset:16640
ds_read_b64_tr_b16 v[164:165], v22 offset:18432
ds_read_b64_tr_b16 v[166:167], v22 offset:18688
ds_read_b64_tr_b16 v[168:169], v22 offset:20480
ds_read_b64_tr_b16 v[170:171], v22 offset:20736
s_waitcnt lgkmcnt(4)
ds_read_b64_tr_b16 v[172:173], v22 offset:22528
ds_read_b64_tr_b16 v[174:175], v22 offset:22784
ds_read_b64_tr_b16 v[176:177], v22 offset:24576
ds_read_b64_tr_b16 v[178:179], v22 offset:24832
ds_read_b64_tr_b16 v[180:181], v22 offset:26624
ds_read_b64_tr_b16 v[182:183], v22 offset:26880
ds_read_b64_tr_b16 v[184:185], v22 offset:28672
ds_read_b64_tr_b16 v[186:187], v22 offset:28928
ds_read_b64_tr_b16 v[188:189], v22 offset:30720
ds_read_b64_tr_b16 v[190:191], v22 offset:30976
v_add_u32 v68, 69632, v40
v_add_u32 v69, 69632, v41
v_add_u32 v70, 69632, v42
v_add_u32 v71, 69632, v43
v_add_u32 v72, 69632, v44
v_add_u32 v73, 69632, v45
v_add_u32 v74, 69632, v46
v_add_u32 v75, 69632, v47
L_gu_180:
s_cmp_lt_u32 s3, 4
s_cbranch_scc0 L_dma_181
s_mov_b32 s48, s20
s_mov_b32 s49, s21
s_mov_b32 s50, 0x158000
s_mov_b32 s51, 0x20000
v_lshrrev_b32 v18, 4, v0
v_and_b32 v16, 15, v0
v_xor_b32 v16, v16, v18
v_xor_b32 v17, 4, v16
v_lshlrev_b32 v19, 10, v18
v_lshl_add_u32 v22, v16, 4, v19
v_lshl_add_u32 v23, v17, 4, v19
s_lshl_b32 s76, s74, 15
s_lshl_b32 s66, s34, 8
s_add_u32 s76, s76, s66
s_lshl_b32 s77, s34, 13
s_add_u32 s77, s77, 77824
s_add_u32 m0, s77, 0
s_xor_b32 s66, s76, 0
buffer_load_dwordx4 v22, s[48:51], s66 offen  lds
s_add_u32 m0, s77, 1024
s_xor_b32 s66, s76, 8192
buffer_load_dwordx4 v23, s[48:51], s66 offen  lds
s_add_u32 m0, s77, 2048
s_xor_b32 s66, s76, 16384
buffer_load_dwordx4 v22, s[48:51], s66 offen  lds
s_add_u32 m0, s77, 3072
s_xor_b32 s66, s76, 24576
buffer_load_dwordx4 v23, s[48:51], s66 offen  lds
s_add_u32 m0, s77, 4096
s_xor_b32 s66, s76, 4096
buffer_load_dwordx4 v22, s[48:51], s66 offen  lds
s_add_u32 m0, s77, 5120
s_xor_b32 s66, s76, 12288
buffer_load_dwordx4 v23, s[48:51], s66 offen  lds
s_add_u32 m0, s77, 6144
s_xor_b32 s66, s76, 20480
buffer_load_dwordx4 v22, s[48:51], s66 offen  lds
s_waitcnt vmcnt(7)
s_branch L_dma_182
L_dma_181:
s_waitcnt vmcnt(0)
L_dma_182:
s_mov_b32 s73, 0x3f803f80
v_mov_b32 v20, 0
v_mov_b32 v21, 0
v_max3_u32 v12, v56, v57, v58
v_max_u32 v12, v12, v59
v_cmp_eq_u32 vcc, -1, v12
s_cbranch_vccz L_x_179
buffer_load_dwordx4 v[56:59], v1, s[36:39], s64 offen sc1
s_sleep 1
s_mov_b32 s75, 0
L_poll_183:
buffer_load_dwordx4 v[56:59], v1, s[36:39], s64 offen sc1
s_waitcnt vmcnt(1)
v_max3_u32 v12, v56, v57, v58
v_max_u32 v12, v12, v59
v_cmp_eq_u32 vcc, -1, v12
s_cbranch_vccz L_pollx_184
s_add_u32 s75, s75, 1
s_cmp_lt_u32 s75, 0x100000
s_cbranch_scc1 L_poll_183
L_pollx_184:
L_x_179:
v_dot2c_f32_bf16 v20, s73, v56
v_dot2c_f32_bf16 v21, v56, v56
v_dot2c_f32_bf16 v20, s73, v57
v_dot2c_f32_bf16 v21, v57, v57
v_dot2c_f32_bf16 v20, s73, v58
v_dot2c_f32_bf16 v21, v58, v58
v_dot2c_f32_bf16 v20, s73, v59
v_dot2c_f32_bf16 v21, v59, v59
v_lshlrev_b32 v40, 16, v56
v_and_b32 v41, s68, v56
v_lshlrev_b32 v42, 16, v57
v_permlane32_swap_b32 v20, v21
v_add_f32 v12, v20, v21
v_and_b32 v43, s68, v57
v_lshlrev_b32 v44, 16, v58
v_add_f32_dpp v12, v12, v12 quad_perm:[1,0,3,2] row_mask:0xf bank_mask:0xf
v_and_b32 v45, s68, v58
v_lshlrev_b32 v46, 16, v59
v_add_f32_dpp v12, v12, v12 quad_perm:[2,3,0,1] row_mask:0xf bank_mask:0xf
v_and_b32 v47, s68, v59
v_pk_mul_f32 v[48:49], v[40:41], v[32:33]
v_add_f32_dpp v12, v12, v12 row_ror:4 row_mask:0xf bank_mask:0xf
v_pk_mul_f32 v[50:51], v[42:43], v[34:35]
v_pk_mul_f32 v[52:53], v[44:45], v[36:37]
v_add_f32_dpp v12, v12, v12 row_ror:8 row_mask:0xf bank_mask:0xf
v_pk_mul_f32 v[54:55], v[46:47], v[38:39]
s_nop 0
v_add_f32_dpp v12, v12, v12 row_bcast:15 row_mask:0xa bank_mask:0xf
s_nop 0
v_readlane_b32 s70, v12, 16
v_readlane_b32 s71, v12, 48
s_nop 0
v_mul_f32 v12, s70, v14
v_mul_f32 v13, s71, v15
v_fma_f32 v13, -v12, v12, v13
v_max_f32 v13, 0, v13
v_add_f32 v13, 0x3727c5ac, v13
v_rsq_f32 v2, v13
v_pk_fma_f32 v[48:49], v[12:13], v[32:33], v[48:49] op_sel_hi:[0,1,1]
v_pk_fma_f32 v[50:51], v[12:13], v[34:35], v[50:51] op_sel_hi:[0,1,1]
v_pk_fma_f32 v[52:53], v[12:13], v[36:37], v[52:53] op_sel_hi:[0,1,1]
v_pk_fma_f32 v[54:55], v[12:13], v[38:39], v[54:55] op_sel_hi:[0,1,1]
v_pk_fma_f32 v[24:25], v[2:3], v[48:49], v[24:25] op_sel_hi:[0,1,1]
v_pk_fma_f32 v[28:29], v[2:3], v[52:53], v[28:29] op_sel_hi:[0,1,1]
v_pk_fma_f32 v[26:27], v[2:3], v[50:51], v[26:27] op_sel_hi:[0,1,1]
v_pk_fma_f32 v[30:31], v[2:3], v[54:55], v[30:31] op_sel_hi:[0,1,1]
v_cvt_pk_bf16_f32 v40, v24, v25
v_cvt_pk_bf16_f32 v41, v28, v29
ds_write_b64 v5, v[40:41]
v_cvt_pk_bf16_f32 v42, v26, v27
v_cvt_pk_bf16_f32 v43, v30, v31
ds_write_b64 v6, v[42:43]
s_cmp_lt_u32 s3, 4
s_cbranch_scc0 L_dma_185
s_mov_b32 s48, s20
s_mov_b32 s49, s21
s_mov_b32 s50, 0x158000
s_mov_b32 s51, 0x20000
s_add_u32 m0, s77, 7168
s_xor_b32 s66, s76, 28672
buffer_load_dwordx4 v23, s[48:51], s66 offen  lds
L_dma_185:
s_cmp_lt_u32 s3, 4
s_waitcnt lgkmcnt(0)
s_barrier
s_cbranch_scc1 L_bar_fin
ds_read_b128 v[192:195], v7 offset:0
ds_read_b128 v[196:199], v8 offset:1024
ds_read_b128 v[200:203], v7 offset:2048
ds_read_b128 v[204:207], v8 offset:3072
ds_read_b128 v[208:211], v7 offset:4096
ds_read_b128 v[212:215], v8 offset:5120
ds_read_b128 v[216:219], v7 offset:6144
ds_read_b128 v[220:223], v8 offset:7168
s_waitcnt lgkmcnt(7)
v_smfmac_f32_16x16x64_bf16 v[64:67], v[192:195], v[128:135], v16
s_waitcnt lgkmcnt(6)
v_smfmac_f32_16x16x64_bf16 v[64:67], v[196:199], v[136:143], v16
s_waitcnt lgkmcnt(5)
v_smfmac_f32_16x16x64_bf16 v[64:67], v[200:203], v[144:151], v16
s_waitcnt lgkmcnt(4)
v_smfmac_f32_16x16x64_bf16 v[64:67], v[204:207], v[152:159], v16
s_waitcnt lgkmcnt(3)
v_smfmac_f32_16x16x64_bf16 v[64:67], v[208:211], v[160:167], v16
s_waitcnt lgkmcnt(2)
v_smfmac_f32_16x16x64_bf16 v[64:67], v[212:215], v[168:175], v16
s_waitcnt lgkmcnt(1)
v_smfmac_f32_16x16x64_bf16 v[64:67], v[216:219], v[176:183], v16
s_waitcnt lgkmcnt(0)
v_smfmac_f32_16x16x64_bf16 v[64:67], v[220:223], v[184:191], v16
s_nop 7
v_add_f32 v66, v66, v67
v_add_f32 v64, v64, v65
v_mul_f32 v18, v64, v17
v_mul_f32_dpp v18, v66, v17 row_ror:8 row_mask:0xf bank_mask:0xc
v_exp_f32 v18, v18
v_mov_b32_dpp v66, v64 row_ror:8 row_mask:0xf bank_mask:0x3
v_add_f32 v18, 1.0, v18
v_rcp_f32 v18, v18
s_nop 0
v_mul_f32 v18, v18, v66
v_cvt_pk_bf16_f32 v18, v18, v18
ds_write_b16 v9, v18 offset:3584
s_waitcnt lgkmcnt(0)
s_barrier
ds_read_b128 v[48:51], v10 offset:3584
ds_read_b64_tr_b16 v[96:97], v68 offset:0
ds_read_b64_tr_b16 v[98:99], v68 offset:4096
ds_read_b64_tr_b16 v[100:101], v69 offset:0
ds_read_b64_tr_b16 v[102:103], v69 offset:4096
ds_read_b64_tr_b16 v[104:105], v70 offset:0
ds_read_b64_tr_b16 v[106:107], v70 offset:4096
ds_read_b64_tr_b16 v[108:109], v71 offset:0
ds_read_b64_tr_b16 v[110:111], v71 offset:4096
ds_read_b64_tr_b16 v[112:113], v72 offset:0
ds_read_b64_tr_b16 v[114:115], v72 offset:4096
ds_read_b64_tr_b16 v[116:117], v73 offset:0
ds_read_b64_tr_b16 v[118:119], v73 offset:4096
s_waitcnt lgkmcnt(10)
v_mfma_f32_16x16x32_bf16 v[192:195], v[48:51], v[96:99], 0
ds_read_b64_tr_b16 v[120:121], v74 offset:0
ds_read_b64_tr_b16 v[122:123], v74 offset:4096
s_waitcnt lgkmcnt(10)
v_mfma_f32_16x16x32_bf16 v[196:199], v[48:51], v[100:103], 0
ds_read_b64_tr_b16 v[124:125], v75 offset:0
ds_read_b64_tr_b16 v[126:127], v75 offset:4096
s_waitcnt lgkmcnt(10)
v_mfma_f32_16x16x32_bf16 v[200:203], v[48:51], v[104:107], 0
s_waitcnt lgkmcnt(8)
v_mfma_f32_16x16x32_bf16 v[204:207], v[48:51], v[108:111], 0
s_waitcnt lgkmcnt(6)
v_mfma_f32_16x16x32_bf16 v[208:211], v[48:51], v[112:115], 0
s_nop 0
v_cvt_pk_bf16_f32 v16, v192, v196
s_waitcnt lgkmcnt(4)
v_mfma_f32_16x16x32_bf16 v[212:215], v[48:51], v[116:119], 0
v_cvt_pk_bf16_f32 v20, v193, v197
s_waitcnt lgkmcnt(2)
v_mfma_f32_16x16x32_bf16 v[216:219], v[48:51], v[120:123], 0
v_cvt_pk_bf16_f32 v17, v200, v204
v_cvt_pk_bf16_f32 v21, v201, v205
s_waitcnt lgkmcnt(0)
v_mfma_f32_16x16x32_bf16 v[220:223], v[48:51], v[124:127], 0
s_nop 2
v_cvt_pk_bf16_f32 v18, v208, v212
v_cvt_pk_bf16_f32 v22, v209, v213
s_nop 2
v_cvt_pk_bf16_f32 v19, v216, v220
buffer_store_dwordx4 v[16:19], v11, s[36:39], s69 offen sc1
v_cvt_pk_bf16_f32 v23, v217, v221
buffer_store_dwordx4 v[20:23], v11, s[36:39], s72 offen sc1
s_endpgm
L_bar_fin:
s_waitcnt vmcnt(0)
s_barrier
s_endpgm
L_srest:
s_lshr_b32 s32, s2, 5
s_and_b32 s33, s2, 31
s_and_b32 s67, s2, 7
s_lshr_b32 s68, s2, 3
s_sub_u32 s68, s68, 26
s_min_u32 s74, s67, 3
s_mul_i32 s66, s67, 5
s_add_u32 s74, s74, s66
s_add_u32 s74, s74, s68
s_cmp_lt_u32 s67, 3
s_cselect_b32 s66, 6, 5
s_cmp_lt_u32 s68, s66
s_cselect_b32 s74, s74, -1
s_cmp_lt_u32 s2, 48
s_cselect_b32 s66, 2, 3
s_cselect_b32 s72, 14+26, 42+26
s_cmp_lt_u32 s2, 16
s_cselect_b32 s66, 1, s66
s_cselect_b32 s72, 26, s72
s_lshl_b32 s66, s67, s66
s_add_u32 s72, s72, s66
s_add_u32 s72, s72, s68
s_mov_b32 s36, s30
s_mov_b32 s37, s31
s_mov_b32 s38, 0x1d0000
s_mov_b32 s39, 0x20000
s_mov_b32 s52, s28
s_mov_b32 s53, s29
s_mov_b32 s54, 0x100
s_mov_b32 s55, 0x20000
s_mov_b32 s46, 0x40000
s_mov_b32 s47, 0x20000
s_cmp_eq_u32 s74, -1
s_mov_b32 s69, 30
s_cselect_b32 s69, 20, s69
s_cmp_lt_u32 s2, 144
s_cselect_b32 s69, 0, s69
s_cmp_lt_u32 s2, 112
s_cselect_b32 s69, 50, s69
s_cmp_lt_u32 s2, 48
s_cselect_b32 s69, 30, s69
s_cmp_lt_u32 s2, 16
s_cselect_b32 s69, 40, s69
s_and_b32 s66, s72, 7
s_cmp_eq_u32 s66, 3
s_cselect_b32 s66, 40, 0
s_cmp_lt_u32 s2, 112
s_cselect_b32 s66, s66, 0
s_add_u32 s69, s69, s66
s_xor_b32 s64, s65, 1024
s_cmpk_gt_u32 s69, 4
s_cbranch_scc1 L_d_1
s_waitcnt vmcnt(3)
L_d_1:
buffer_load_dwordx4 v[24:27], v1, s[40:43], s64 offen nt
s_xor_b32 s64, s65, 66560
s_cmpk_gt_u32 s69, 5
s_cbranch_scc1 L_d_2
s_waitcnt vmcnt(3)
L_d_2:
buffer_load_dwordx4 v[28:31], v1, s[40:43], s64 offen nt
s_xor_b32 s64, s65, 3072
s_cmpk_gt_u32 s69, 6
s_cbranch_scc1 L_d_3
s_waitcnt vmcnt(3)
L_d_3:
buffer_load_dwordx4 v[32:35], v1, s[40:43], s64 offen nt
s_xor_b32 s64, s65, 68608
s_cmpk_gt_u32 s69, 7
s_waitcnt vmcnt(6)
s_cbranch_scc1 L_d_4
s_waitcnt vmcnt(3)
L_d_4:
buffer_load_dwordx4 v[36:39], v1, s[40:43], s64 offen nt
s_xor_b32 s64, s65, 32768
s_cmpk_gt_u32 s69, 8
s_waitcnt vmcnt(6)
s_cbranch_scc1 L_d_5
s_waitcnt vmcnt(3)
L_d_5:
buffer_load_dwordx4 v[40:43], v1, s[40:43], s64 offen nt
s_xor_b32 s64, s65, 98304
s_cmpk_gt_u32 s69, 9
s_waitcnt vmcnt(6)
s_cbranch_scc1 L_d_6
s_waitcnt vmcnt(3)
L_d_6:
buffer_load_dwordx4 v[44:47], v1, s[40:43], s64 offen nt
s_xor_b32 s64, s65, 34816
s_cmpk_gt_u32 s69, 10
s_waitcnt vmcnt(6)
s_cbranch_scc1 L_d_7
s_waitcnt vmcnt(3)
L_d_7:
buffer_load_dwordx4 v[48:51], v1, s[40:43], s64 offen nt
s_xor_b32 s64, s65, 100352
s_cmpk_gt_u32 s69, 11
s_waitcnt vmcnt(6)
s_cbranch_scc1 L_d_8
s_waitcnt vmcnt(3)
L_d_8:
buffer_load_dwordx4 v[52:55], v1, s[40:43], s64 offen nt
s_xor_b32 s64, s65, 33792
s_cmpk_gt_u32 s69, 12
s_waitcnt vmcnt(6)
s_cbranch_scc1 L_d_9
s_waitcnt vmcnt(3)
L_d_9:
buffer_load_dwordx4 v[56:59], v1, s[40:43], s64 offen nt
s_xor_b32 s64, s65, 99328
s_cmpk_gt_u32 s69, 13
s_waitcnt vmcnt(6)
s_cbranch_scc1 L_d_10
s_waitcnt vmcnt(3)
L_d_10:
buffer_load_dwordx4 v[60:63], v1, s[40:43], s64 offen nt
s_xor_b32 s64, s65, 35840
s_cmpk_gt_u32 s69, 14
s_waitcnt vmcnt(6)
s_cbranch_scc1 L_d_11
s_waitcnt vmcnt(3)
L_d_11:
buffer_load_dwordx4 v[64:67], v1, s[40:43], s64 offen nt
s_xor_b32 s64, s65, 101376
s_cmpk_gt_u32 s69, 15
s_waitcnt vmcnt(6)
s_cbranch_scc1 L_d_12
s_waitcnt vmcnt(3)
L_d_12:
buffer_load_dwordx4 v[68:71], v1, s[40:43], s64 offen nt
s_xor_b32 s64, s65, 131072
s_cmpk_gt_u32 s69, 16
s_waitcnt vmcnt(6)
s_cbranch_scc1 L_d_13
s_waitcnt vmcnt(3)
L_d_13:
buffer_load_dwordx4 v[72:75], v1, s[40:43], s64 offen nt
s_xor_b32 s64, s65, 196608
s_cmpk_gt_u32 s69, 17
s_waitcnt vmcnt(6)
s_cbranch_scc1 L_d_14
s_waitcnt vmcnt(3)
L_d_14:
buffer_load_dwordx4 v[76:79], v1, s[40:43], s64 offen nt
s_xor_b32 s64, s65, 133120
s_cmpk_gt_u32 s69, 18
s_waitcnt vmcnt(6)
s_cbranch_scc1 L_d_15
s_waitcnt vmcnt(3)
L_d_15:
buffer_load_dwordx4 v[80:83], v1, s[40:43], s64 offen nt
s_xor_b32 s64, s65, 198656
s_cmpk_gt_u32 s69, 19
s_waitcnt vmcnt(6)
s_cbranch_scc1 L_d_16
s_waitcnt vmcnt(3)
L_d_16:
buffer_load_dwordx4 v[84:87], v1, s[40:43], s64 offen nt
s_xor_b32 s64, s65, 132096
s_cmpk_gt_u32 s69, 20
s_waitcnt vmcnt(6)
s_cbranch_scc1 L_d_17
s_waitcnt vmcnt(4)
L_d_17:
buffer_load_dwordx4 v[88:91], v1, s[40:43], s64 offen nt
s_xor_b32 s64, s65, 197632
s_cmpk_gt_u32 s69, 21
s_waitcnt vmcnt(6)
s_cbranch_scc1 L_d_18
s_waitcnt vmcnt(4)
L_d_18:
buffer_load_dwordx4 v[92:95], v1, s[40:43], s64 offen nt
s_xor_b32 s64, s65, 134144
s_cmpk_gt_u32 s69, 22
s_waitcnt vmcnt(6)
s_cbranch_scc1 L_d_19
s_waitcnt vmcnt(4)
L_d_19:
buffer_load_dwordx4 v[96:99], v1, s[40:43], s64 offen nt
s_xor_b32 s64, s65, 199680
s_cmpk_gt_u32 s69, 23
s_waitcnt vmcnt(6)
s_cbranch_scc1 L_d_20
s_waitcnt vmcnt(4)
L_d_20:
buffer_load_dwordx4 v[100:103], v1, s[40:43], s64 offen nt
s_xor_b32 s64, s65, 163840
s_cmpk_gt_u32 s69, 24
s_waitcnt vmcnt(6)
s_cbranch_scc1 L_d_21
s_waitcnt vmcnt(4)
L_d_21:
buffer_load_dwordx4 v[104:107], v1, s[40:43], s64 offen nt
s_xor_b32 s64, s65, 229376
s_cmpk_gt_u32 s69, 25
s_waitcnt vmcnt(6)
s_cbranch_scc1 L_d_22
s_waitcnt vmcnt(4)
L_d_22:
buffer_load_dwordx4 v[108:111], v1, s[40:43], s64 offen nt
s_xor_b32 s64, s65, 165888
s_cmpk_gt_u32 s69, 26
s_waitcnt vmcnt(6)
s_cbranch_scc1 L_d_23
s_waitcnt vmcnt(4)
L_d_23:
buffer_load_dwordx4 v[112:115], v1, s[40:43], s64 offen nt
s_xor_b32 s64, s65, 231424
s_cmpk_gt_u32 s69, 27
s_waitcnt vmcnt(6)
s_cbranch_scc1 L_d_24
s_waitcnt vmcnt(4)
L_d_24:
buffer_load_dwordx4 v[116:119], v1, s[40:43], s64 offen nt
s_xor_b32 s64, s65, 164864
s_cmpk_gt_u32 s69, 28
s_waitcnt vmcnt(6)
s_cbranch_scc1 L_d_25
s_waitcnt vmcnt(4)
L_d_25:
buffer_load_dwordx4 v[120:123], v1, s[40:43], s64 offen nt
s_xor_b32 s64, s65, 230400
s_cmpk_gt_u32 s69, 29
s_waitcnt vmcnt(6)
s_cbranch_scc1 L_d_26
s_waitcnt vmcnt(4)
L_d_26:
buffer_load_dwordx4 v[124:127], v1, s[40:43], s64 offen nt
s_xor_b32 s64, s65, 166912
s_cmpk_gt_u32 s69, 30
s_waitcnt vmcnt(6)
s_cbranch_scc1 L_d_27
s_waitcnt vmcnt(4)
L_d_27:
buffer_load_dwordx4 v[128:131], v1, s[40:43], s64 offen nt
s_xor_b32 s64, s65, 232448
s_cmpk_gt_u32 s69, 31
s_waitcnt vmcnt(6)
s_cbranch_scc1 L_d_28
s_waitcnt vmcnt(4)
L_d_28:
buffer_load_dwordx4 v[132:135], v1, s[40:43], s64 offen nt
s_xor_b32 s64, s65, 4096
s_cmpk_gt_u32 s69, 32
s_waitcnt vmcnt(6)
s_cbranch_scc1 L_d_29
s_waitcnt vmcnt(4)
L_d_29:
buffer_load_dwordx4 v[136:139], v1, s[40:43], s64 offen nt
s_xor_b32 s64, s65, 69632
s_cmpk_gt_u32 s69, 33
s_waitcnt vmcnt(6)
s_cbranch_scc1 L_d_30
s_waitcnt vmcnt(4)
L_d_30:
buffer_load_dwordx4 v[140:143], v1, s[40:43], s64 offen nt
s_xor_b32 s64, s65, 6144
s_cmpk_gt_u32 s69, 34
s_waitcnt vmcnt(6)
s_cbranch_scc1 L_d_31
s_waitcnt vmcnt(4)
L_d_31:
buffer_load_dwordx4 v[144:147], v1, s[40:43], s64 offen nt
s_xor_b32 s64, s65, 71680
s_cmpk_gt_u32 s69, 35
s_waitcnt vmcnt(6)
s_cbranch_scc1 L_d_32
s_waitcnt vmcnt(4)
L_d_32:
buffer_load_dwordx4 v[148:151], v1, s[40:43], s64 offen nt
s_xor_b32 s64, s65, 5120
s_cmpk_gt_u32 s69, 36
s_waitcnt vmcnt(6)
s_cbranch_scc1 L_d_33
s_waitcnt vmcnt(4)
L_d_33:
buffer_load_dwordx4 v[152:155], v1, s[40:43], s64 offen nt
s_xor_b32 s64, s65, 70656
s_cmpk_gt_u32 s69, 37
s_waitcnt vmcnt(6)
s_cbranch_scc1 L_d_34
s_waitcnt vmcnt(4)
L_d_34:
buffer_load_dwordx4 v[156:159], v1, s[40:43], s64 offen nt
s_xor_b32 s64, s65, 7168
s_cmpk_gt_u32 s69, 38
s_waitcnt vmcnt(6)
s_cbranch_scc1 L_d_35
s_waitcnt vmcnt(4)
L_d_35:
buffer_load_dwordx4 v[160:163], v1, s[40:43], s64 offen nt
s_xor_b32 s64, s65, 72704
s_cmpk_gt_u32 s69, 39
s_waitcnt vmcnt(6)
s_cbranch_scc1 L_d_36
s_waitcnt vmcnt(4)
L_d_36:
buffer_load_dwordx4 v[164:167], v1, s[40:43], s64 offen nt
s_xor_b32 s64, s65, 36864
s_cmpk_gt_u32 s69, 40
s_waitcnt vmcnt(6)
s_cbranch_scc1 L_d_37
s_waitcnt vmcnt(4)
L_d_37:
buffer_load_dwordx4 v[168:171], v1, s[40:43], s64 offen nt
s_xor_b32 s64, s65, 102400
s_cmpk_gt_u32 s69, 41
s_waitcnt vmcnt(6)
s_cbranch_scc1 L_d_38
s_waitcnt vmcnt(4)
L_d_38:
buffer_load_dwordx4 v[172:175], v1, s[40:43], s64 offen nt
s_xor_b32 s64, s65, 38912
s_cmpk_gt_u32 s69, 42
s_waitcnt vmcnt(6)
s_cbranch_scc1 L_d_39
s_waitcnt vmcnt(4)
L_d_39:
buffer_load_dwordx4 v[176:179], v1, s[40:43], s64 offen nt
s_xor_b32 s64, s65, 104448
s_cmpk_gt_u32 s69, 43
s_waitcnt vmcnt(6)
s_cbranch_scc1 L_d_40
s_waitcnt vmcnt(4)
L_d_40:
buffer_load_dwordx4 v[180:183], v1, s[40:43], s64 offen nt
s_xor_b32 s64, s65, 37888
s_cmpk_gt_u32 s69, 44
s_waitcnt vmcnt(6)
s_cbranch_scc1 L_d_41
s_waitcnt vmcnt(4)
L_d_41:
buffer_load_dwordx4 v[184:187], v1, s[40:43], s64 offen nt
s_xor_b32 s64, s65, 103424
s_cmpk_gt_u32 s69, 45
s_waitcnt vmcnt(6)
s_cbranch_scc1 L_d_42
s_waitcnt vmcnt(4)
L_d_42:
buffer_load_dwordx4 v[188:191], v1, s[40:43], s64 offen nt
s_xor_b32 s64, s65, 39936
s_cmpk_gt_u32 s69, 46
s_waitcnt vmcnt(6)
s_cbranch_scc1 L_d_43
s_waitcnt vmcnt(4)
L_d_43:
buffer_load_dwordx4 v[192:195], v1, s[40:43], s64 offen nt
s_xor_b32 s64, s65, 105472
s_cmpk_gt_u32 s69, 47
s_waitcnt vmcnt(6)
s_cbranch_scc1 L_d_44
s_waitcnt vmcnt(4)
L_d_44:
buffer_load_dwordx4 v[196:199], v1, s[40:43], s64 offen nt
s_xor_b32 s64, s65, 135168
s_cmpk_gt_u32 s69, 48
s_waitcnt vmcnt(6)
s_cbranch_scc1 L_d_45
s_waitcnt vmcnt(4)
L_d_45:
buffer_load_dwordx4 v[200:203], v1, s[40:43], s64 offen nt
s_xor_b32 s64, s65, 200704
s_cmpk_gt_u32 s69, 49
s_waitcnt vmcnt(6)
s_cbranch_scc1 L_d_46
s_waitcnt vmcnt(4)
L_d_46:
buffer_load_dwordx4 v[204:207], v1, s[40:43], s64 offen nt
s_xor_b32 s64, s65, 137216
s_cmpk_gt_u32 s69, 50
s_waitcnt vmcnt(6)
s_cbranch_scc1 L_d_47
s_waitcnt vmcnt(4)
L_d_47:
buffer_load_dwordx4 v[208:211], v1, s[40:43], s64 offen nt
s_xor_b32 s64, s65, 202752
s_cmpk_gt_u32 s69, 51
s_waitcnt vmcnt(6)
s_cbranch_scc1 L_d_48
s_waitcnt vmcnt(4)
L_d_48:
buffer_load_dwordx4 v[212:215], v1, s[40:43], s64 offen nt
s_xor_b32 s64, s65, 136192
s_cmpk_gt_u32 s69, 52
s_waitcnt vmcnt(6)
s_cbranch_scc1 L_d_49
s_waitcnt vmcnt(4)
L_d_49:
buffer_load_dwordx4 v[216:219], v1, s[40:43], s64 offen nt
s_xor_b32 s64, s65, 201728
s_cmpk_gt_u32 s69, 53
s_waitcnt vmcnt(6)
s_cbranch_scc1 L_d_50
s_waitcnt vmcnt(4)
L_d_50:
buffer_load_dwordx4 v[220:223], v1, s[40:43], s64 offen nt
s_xor_b32 s64, s65, 138240
s_cmpk_gt_u32 s69, 54
s_waitcnt vmcnt(6)
s_cbranch_scc1 L_d_51
s_waitcnt vmcnt(4)
L_d_51:
buffer_load_dwordx4 v[224:227], v1, s[40:43], s64 offen nt
s_xor_b32 s64, s65, 203776
s_cmpk_gt_u32 s69, 55
s_waitcnt vmcnt(6)
s_cbranch_scc1 L_d_52
s_waitcnt vmcnt(4)
L_d_52:
buffer_load_dwordx4 v[228:231], v1, s[40:43], s64 offen nt
s_xor_b32 s64, s65, 167936
s_cmpk_gt_u32 s69, 56
s_waitcnt vmcnt(6)
s_cbranch_scc1 L_d_53
s_waitcnt vmcnt(4)
L_d_53:
buffer_load_dwordx4 v[232:235], v1, s[40:43], s64 offen nt
s_xor_b32 s64, s65, 233472
s_cmpk_gt_u32 s69, 57
s_waitcnt vmcnt(6)
s_cbranch_scc1 L_d_54
s_waitcnt vmcnt(4)
L_d_54:
buffer_load_dwordx4 v[236:239], v1, s[40:43], s64 offen nt
s_xor_b32 s64, s65, 169984
s_cmpk_gt_u32 s69, 58
s_waitcnt vmcnt(6)
s_cbranch_scc1 L_d_55
s_waitcnt vmcnt(4)
L_d_55:
buffer_load_dwordx4 v[240:243], v1, s[40:43], s64 offen nt
v_and_b32 v2, 31, v0
v_lshlrev_b32 v2, 2, v2
buffer_load_dword v3, v2, s[52:55], 0 offen offset:128
s_xor_b32 s64, s65, 235520
s_cmpk_gt_u32 s69, 59
s_waitcnt vmcnt(6)
s_cbranch_scc1 L_d_56
s_waitcnt vmcnt(4)
L_d_56:
buffer_load_dwordx4 v[244:247], v1, s[40:43], s64 offen nt
s_xor_b32 s64, s65, 168960
s_cmpk_gt_u32 s69, 60
s_waitcnt vmcnt(6)
s_cbranch_scc1 L_d_57
s_waitcnt vmcnt(4)
L_d_57:
buffer_load_dwordx4 v[248:251], v1, s[40:43], s64 offen nt
s_xor_b32 s64, s65, 234496
s_cmpk_gt_u32 s69, 61
s_waitcnt vmcnt(6)
s_cbranch_scc1 L_d_58
s_waitcnt vmcnt(4)
L_d_58:
buffer_load_dwordx4 v[252:255], v1, s[40:43], s64 offen nt
s_mul_i32 s70, s34, 15360
s_add_u32 s70, s70, 69632
s_add_u32 m0, s70, 0
s_xor_b32 s64, s65, 171008
s_cmpk_gt_u32 s69, 62
s_waitcnt vmcnt(6)
s_cbranch_scc1 L_d_59
s_waitcnt vmcnt(4)
L_d_59:
buffer_load_dwordx4 v1, s[40:43], s64 offen nt lds
s_add_u32 m0, s70, 1024
s_xor_b32 s64, s65, 236544
s_cmpk_gt_u32 s69, 63
s_waitcnt vmcnt(6)
s_cbranch_scc1 L_d_60
s_waitcnt vmcnt(4)
L_d_60:
buffer_load_dwordx4 v1, s[40:43], s64 offen nt lds
s_cmp_eq_u32 s74, -1
s_mov_b32 s69, 80
s_cselect_b32 s69, 80, s69
s_cmp_lt_u32 s2, 144
s_cselect_b32 s69, 80, s69
s_cmp_lt_u32 s2, 112
s_cselect_b32 s69, 112, s69
s_cmp_lt_u32 s2, 48
s_cselect_b32 s69, 0, s69
s_cmp_lt_u32 s2, 16
s_cselect_b32 s69, 112, s69
s_add_u32 m0, s70, 2048
s_xor_b32 s64, s65, 0
s_cmpk_gt_u32 s69, 64
s_waitcnt vmcnt(6)
s_cbranch_scc1 L_d_61
s_waitcnt vmcnt(4)
L_d_61:
buffer_load_dwordx4 v1, s[44:47], s64 offen nt lds
s_add_u32 m0, s70, 3072
s_xor_b32 s64, s65, 65536
s_cmpk_gt_u32 s69, 65
s_waitcnt vmcnt(6)
s_cbranch_scc1 L_d_62
s_waitcnt vmcnt(4)
L_d_62:
buffer_load_dwordx4 v1, s[44:47], s64 offen nt lds
s_add_u32 m0, s70, 4096
s_xor_b32 s64, s65, 2048
s_cmpk_gt_u32 s69, 66
s_waitcnt vmcnt(6)
s_cbranch_scc1 L_d_63
s_waitcnt vmcnt(4)
L_d_63:
buffer_load_dwordx4 v1, s[44:47], s64 offen nt lds
s_add_u32 m0, s70, 5120
s_xor_b32 s64, s65, 67584
s_cmpk_gt_u32 s69, 67
s_waitcnt vmcnt(6)
s_cbranch_scc1 L_d_64
s_waitcnt vmcnt(4)
L_d_64:
buffer_load_dwordx4 v1, s[44:47], s64 offen nt lds
v_cmp_eq_u32 vcc, 0, v3
s_cbranch_vccz L_jf_66
s_mov_b32 s75, 0
L_poll_67:
v_and_b32 v2, 31, v0
v_lshlrev_b32 v2, 2, v2
buffer_load_dword v3, v2, s[52:55], 0 offen offset:128 sc1
s_waitcnt vmcnt(0)
v_cmp_eq_u32 vcc, 0, v3
s_cbranch_vccz L_pollx_68
s_sleep 40
s_add_u32 s75, s75, 1
s_cmp_lt_u32 s75, 0x100000
s_cbranch_scc1 L_poll_67
L_pollx_68:
L_jf_66:
s_mul_i32 s68, s32, 12288
s_lshl_b32 s67, s33, 8
s_add_u32 s68, s68, s67
s_add_u32 s68, s68, 16384
v_and_b32 v2, 0xf0, v1
buffer_load_dwordx4 v[4:7], v2, s[36:39], s68 offen sc1
s_add_u32 m0, s70, 6144
s_xor_b32 s64, s65, 1024
s_cmpk_gt_u32 s69, 68
s_waitcnt vmcnt(6)
s_cbranch_scc1 L_d_65
s_waitcnt vmcnt(4)
L_d_65:
buffer_load_dwordx4 v1, s[44:47], s64 offen nt lds
s_add_u32 m0, s70, 7168
s_xor_b32 s64, s65, 66560
s_cmpk_gt_u32 s69, 69
s_waitcnt vmcnt(6)
s_cbranch_scc1 L_d_69
s_waitcnt vmcnt(4)
L_d_69:
buffer_load_dwordx4 v1, s[44:47], s64 offen nt lds
s_add_u32 m0, s70, 8192
s_xor_b32 s64, s65, 3072
s_cmpk_gt_u32 s69, 70
s_waitcnt vmcnt(6)
s_cbranch_scc1 L_d_70
s_waitcnt vmcnt(4)
L_d_70:
buffer_load_dwordx4 v1, s[44:47], s64 offen nt lds
s_add_u32 m0, s70, 9216
s_xor_b32 s64, s65, 68608
s_cmpk_gt_u32 s69, 71
s_waitcnt vmcnt(6)
s_cbranch_scc1 L_d_71
s_waitcnt vmcnt(4)
L_d_71:
buffer_load_dwordx4 v1, s[44:47], s64 offen nt lds
s_add_u32 m0, s70, 10240
s_xor_b32 s64, s65, 32768
s_cmpk_gt_u32 s69, 72
s_waitcnt vmcnt(6)
s_cbranch_scc1 L_d_72
s_waitcnt vmcnt(4)
L_d_72:
buffer_load_dwordx4 v1, s[44:47], s64 offen nt lds
s_add_u32 m0, s70, 11264
s_xor_b32 s64, s65, 98304
s_cmpk_gt_u32 s69, 73
s_waitcnt vmcnt(6)
s_cbranch_scc1 L_d_73
s_waitcnt vmcnt(4)
L_d_73:
buffer_load_dwordx4 v1, s[44:47], s64 offen nt lds
s_add_u32 m0, s70, 12288
s_xor_b32 s64, s65, 34816
s_cmpk_gt_u32 s69, 74
s_waitcnt vmcnt(6)
s_cbranch_scc1 L_d_74
s_waitcnt vmcnt(4)
L_d_74:
buffer_load_dwordx4 v1, s[44:47], s64 offen nt lds
s_add_u32 m0, s70, 13312
s_xor_b32 s64, s65, 100352
s_cmpk_gt_u32 s69, 75
s_waitcnt vmcnt(6)
s_cbranch_scc1 L_d_75
s_waitcnt vmcnt(4)
L_d_75:
buffer_load_dwordx4 v1, s[44:47], s64 offen nt lds
s_add_u32 m0, s70, 14336
s_xor_b32 s64, s65, 33792
s_cmpk_gt_u32 s69, 76
s_waitcnt vmcnt(6)
s_cbranch_scc1 L_d_76
s_waitcnt vmcnt(4)
L_d_76:
buffer_load_dwordx4 v1, s[44:47], s64 offen nt lds
v_max3_u32 v3, v4, v5, v6
v_max_u32 v3, v3, v7
v_cmp_eq_u32 vcc, -1, v3
s_cbranch_vccz L_q_77
s_mov_b32 s75, 0
L_poll_78:
s_mul_i32 s68, s32, 12288
s_lshl_b32 s67, s33, 8
s_add_u32 s68, s68, s67
s_add_u32 s68, s68, 16384
v_and_b32 v2, 0xf0, v1
buffer_load_dwordx4 v[4:7], v2, s[36:39], s68 offen sc1
s_waitcnt vmcnt(0)
v_max3_u32 v3, v4, v5, v6
v_max_u32 v3, v3, v7
v_cmp_eq_u32 vcc, -1, v3
s_cbranch_vccz L_pollx_79
s_add_u32 s75, s75, 1
s_cmp_lt_u32 s75, 0x100000
s_cbranch_scc1 L_poll_78
L_pollx_79:
L_q_77:
s_mov_b32 s66, 0x3db504f3
v_dot2_f32_bf16 v8, v8, v4, 0
v_dot2_f32_bf16 v12, v12, v4, 0
v_dot2_f32_bf16 v16, v16, v4, 0
v_dot2_f32_bf16 v20, v20, v4, 0
v_dot2c_f32_bf16 v8, v9, v5
v_dot2c_f32_bf16 v12, v13, v5
v_dot2c_f32_bf16 v16, v17, v5
v_dot2c_f32_bf16 v20, v21, v5
v_dot2c_f32_bf16 v8, v10, v6
v_dot2c_f32_bf16 v12, v14, v6
v_dot2c_f32_bf16 v16, v18, v6
v_dot2c_f32_bf16 v20, v22, v6
v_dot2c_f32_bf16 v8, v11, v7
v_dot2c_f32_bf16 v12, v15, v7
v_dot2c_f32_bf16 v16, v19, v7
v_dot2c_f32_bf16 v20, v23, v7
v_add_f32_dpp v9, v8, v8 row_ror:8 row_mask:0xf bank_mask:0x3
v_add_f32_dpp v13, v12, v12 row_ror:8 row_mask:0xf bank_mask:0x3
v_add_f32_dpp v9, v16, v16 row_ror:8 row_mask:0xf bank_mask:0xc
v_add_f32_dpp v13, v20, v20 row_ror:8 row_mask:0xf bank_mask:0xc
s_nop 0
v_add_f32_dpp v17, v9, v9 row_shl:4 row_mask:0xf bank_mask:0x5
v_add_f32_dpp v17, v13, v13 row_shr:4 row_mask:0xf bank_mask:0xa
s_nop 1
v_add_f32_dpp v17, v17, v17 quad_perm:[1,0,3,2] row_mask:0xf bank_mask:0xf
s_nop 1
v_add_f32_dpp v17, v17, v17 quad_perm:[2,3,0,1] row_mask:0xf bank_mask:0xf
v_cvt_pk_bf16_f32 v17, 0, v17
v_mul_f32 v17, s66, v17
v_cvt_pk_bf16_f32 v17, 0, v17
v_dot2_f32_bf16 v24, v24, v4, 0
v_dot2_f32_bf16 v28, v28, v4, 0
v_dot2_f32_bf16 v32, v32, v4, 0
v_dot2_f32_bf16 v36, v36, v4, 0
v_dot2c_f32_bf16 v24, v25, v5
v_dot2c_f32_bf16 v28, v29, v5
v_dot2c_f32_bf16 v32, v33, v5
v_dot2c_f32_bf16 v36, v37, v5
v_dot2c_f32_bf16 v24, v26, v6
v_dot2c_f32_bf16 v28, v30, v6
v_dot2c_f32_bf16 v32, v34, v6
v_dot2c_f32_bf16 v36, v38, v6
v_dot2c_f32_bf16 v24, v27, v7
v_dot2c_f32_bf16 v28, v31, v7
v_dot2c_f32_bf16 v32, v35, v7
v_dot2c_f32_bf16 v36, v39, v7
v_add_f32_dpp v25, v24, v24 row_ror:8 row_mask:0xf bank_mask:0x3
v_add_f32_dpp v29, v28, v28 row_ror:8 row_mask:0xf bank_mask:0x3
v_add_f32_dpp v25, v32, v32 row_ror:8 row_mask:0xf bank_mask:0xc
v_add_f32_dpp v29, v36, v36 row_ror:8 row_mask:0xf bank_mask:0xc
s_nop 0
v_add_f32_dpp v8, v25, v25 row_shl:4 row_mask:0xf bank_mask:0x5
v_add_f32_dpp v8, v29, v29 row_shr:4 row_mask:0xf bank_mask:0xa
s_nop 1
v_add_f32_dpp v8, v8, v8 quad_perm:[1,0,3,2] row_mask:0xf bank_mask:0xf
s_nop 1
v_add_f32_dpp v8, v8, v8 quad_perm:[2,3,0,1] row_mask:0xf bank_mask:0xf
v_cvt_pk_bf16_f32 v8, 0, v8
v_mul_f32 v8, s66, v8
v_cvt_pk_bf16_f32 v8, 0, v8
s_xor_b32 s64, s65, 99328
s_cmpk_gt_u32 s69, 77
s_waitcnt vmcnt(6)
s_cbranch_scc1 L_d_80
s_waitcnt vmcnt(4)
L_d_80:
buffer_load_dwordx4 v[24:27], v1, s[44:47], s64 offen nt
v_dot2_f32_bf16 v40, v40, v4, 0
v_dot2_f32_bf16 v44, v44, v4, 0
v_dot2_f32_bf16 v48, v48, v4, 0
v_dot2_f32_bf16 v52, v52, v4, 0
v_dot2c_f32_bf16 v40, v41, v5
v_dot2c_f32_bf16 v44, v45, v5
v_dot2c_f32_bf16 v48, v49, v5
v_dot2c_f32_bf16 v52, v53, v5
v_dot2c_f32_bf16 v40, v42, v6
v_dot2c_f32_bf16 v44, v46, v6
v_dot2c_f32_bf16 v48, v50, v6
v_dot2c_f32_bf16 v52, v54, v6
v_dot2c_f32_bf16 v40, v43, v7
v_dot2c_f32_bf16 v44, v47, v7
v_dot2c_f32_bf16 v48, v51, v7
v_dot2c_f32_bf16 v52, v55, v7
v_add_f32_dpp v41, v40, v40 row_ror:8 row_mask:0xf bank_mask:0x3
v_add_f32_dpp v45, v44, v44 row_ror:8 row_mask:0xf bank_mask:0x3
v_add_f32_dpp v41, v48, v48 row_ror:8 row_mask:0xf bank_mask:0xc
v_add_f32_dpp v45, v52, v52 row_ror:8 row_mask:0xf bank_mask:0xc
s_nop 0
v_add_f32_dpp v9, v41, v41 row_shl:4 row_mask:0xf bank_mask:0x5
v_add_f32_dpp v9, v45, v45 row_shr:4 row_mask:0xf bank_mask:0xa
s_nop 1
v_add_f32_dpp v9, v9, v9 quad_perm:[1,0,3,2] row_mask:0xf bank_mask:0xf
s_nop 1
v_add_f32_dpp v9, v9, v9 quad_perm:[2,3,0,1] row_mask:0xf bank_mask:0xf
v_cvt_pk_bf16_f32 v9, 0, v9
v_mul_f32 v9, s66, v9
v_cvt_pk_bf16_f32 v9, 0, v9
s_xor_b32 s64, s65, 35840
s_cmpk_gt_u32 s69, 78
s_waitcnt vmcnt(6)
s_cbranch_scc1 L_d_81
s_waitcnt vmcnt(4)
L_d_81:
buffer_load_dwordx4 v[28:31], v1, s[44:47], s64 offen nt
v_dot2_f32_bf16 v56, v56, v4, 0
v_dot2_f32_bf16 v60, v60, v4, 0
v_dot2_f32_bf16 v64, v64, v4, 0
v_dot2_f32_bf16 v68, v68, v4, 0
v_dot2c_f32_bf16 v56, v57, v5
v_dot2c_f32_bf16 v60, v61, v5
v_dot2c_f32_bf16 v64, v65, v5
v_dot2c_f32_bf16 v68, v69, v5
v_dot2c_f32_bf16 v56, v58, v6
v_dot2c_f32_bf16 v60, v62, v6
v_dot2c_f32_bf16 v64, v66, v6
v_dot2c_f32_bf16 v68, v70, v6
v_dot2c_f32_bf16 v56, v59, v7
v_dot2c_f32_bf16 v60, v63, v7
v_dot2c_f32_bf16 v64, v67, v7
v_dot2c_f32_bf16 v68, v71, v7
v_add_f32_dpp v57, v56, v56 row_ror:8 row_mask:0xf bank_mask:0x3
v_add_f32_dpp v61, v60, v60 row_ror:8 row_mask:0xf bank_mask:0x3
v_add_f32_dpp v57, v64, v64 row_ror:8 row_mask:0xf bank_mask:0xc
v_add_f32_dpp v61, v68, v68 row_ror:8 row_mask:0xf bank_mask:0xc
s_nop 0
v_add_f32_dpp v10, v57, v57 row_shl:4 row_mask:0xf bank_mask:0x5
v_add_f32_dpp v10, v61, v61 row_shr:4 row_mask:0xf bank_mask:0xa
s_nop 1
v_add_f32_dpp v10, v10, v10 quad_perm:[1,0,3,2] row_mask:0xf bank_mask:0xf
s_nop 1
v_add_f32_dpp v10, v10, v10 quad_perm:[2,3,0,1] row_mask:0xf bank_mask:0xf
v_cvt_pk_bf16_f32 v10, 0, v10
v_mul_f32 v10, s66, v10
v_cvt_pk_bf16_f32 v10, 0, v10
s_xor_b32 s64, s65, 101376
s_cmpk_gt_u32 s69, 79
s_waitcnt vmcnt(6)
s_cbranch_scc1 L_d_82
s_waitcnt vmcnt(4)
L_d_82:
buffer_load_dwordx4 v[32:35], v1, s[44:47], s64 offen nt
v_dot2_f32_bf16 v72, v72, v4, 0
v_dot2_f32_bf16 v76, v76, v4, 0
v_dot2_f32_bf16 v80, v80, v4, 0
v_dot2_f32_bf16 v84, v84, v4, 0
v_dot2c_f32_bf16 v72, v73, v5
v_dot2c_f32_bf16 v76, v77, v5
v_dot2c_f32_bf16 v80, v81, v5
v_dot2c_f32_bf16 v84, v85, v5
v_dot2c_f32_bf16 v72, v74, v6
v_dot2c_f32_bf16 v76, v78, v6
v_dot2c_f32_bf16 v80, v82, v6
v_dot2c_f32_bf16 v84, v86, v6
v_dot2c_f32_bf16 v72, v75, v7
v_dot2c_f32_bf16 v76, v79, v7
v_dot2c_f32_bf16 v80, v83, v7
v_dot2c_f32_bf16 v84, v87, v7
v_add_f32_dpp v73, v72, v72 row_ror:8 row_mask:0xf bank_mask:0x3
v_add_f32_dpp v77, v76, v76 row_ror:8 row_mask:0xf bank_mask:0x3
v_add_f32_dpp v73, v80, v80 row_ror:8 row_mask:0xf bank_mask:0xc
v_add_f32_dpp v77, v84, v84 row_ror:8 row_mask:0xf bank_mask:0xc
s_nop 0
v_add_f32_dpp v11, v73, v73 row_shl:4 row_mask:0xf bank_mask:0x5
v_add_f32_dpp v11, v77, v77 row_shr:4 row_mask:0xf bank_mask:0xa
s_nop 1
v_add_f32_dpp v11, v11, v11 quad_perm:[1,0,3,2] row_mask:0xf bank_mask:0xf
s_nop 1
v_add_f32_dpp v11, v11, v11 quad_perm:[2,3,0,1] row_mask:0xf bank_mask:0xf
v_cvt_pk_bf16_f32 v11, 0, v11
v_mul_f32 v11, s66, v11
v_cvt_pk_bf16_f32 v11, 0, v11
s_xor_b32 s64, s65, 131072
s_cmpk_gt_u32 s69, 80
s_waitcnt vmcnt(6)
s_cbranch_scc1 L_d_83
s_waitcnt vmcnt(4)
L_d_83:
buffer_load_dwordx4 v[36:39], v1, s[44:47], s64 offen nt
v_dot2_f32_bf16 v88, v88, v4, 0
v_dot2_f32_bf16 v92, v92, v4, 0
v_dot2_f32_bf16 v96, v96, v4, 0
v_dot2_f32_bf16 v100, v100, v4, 0
v_dot2c_f32_bf16 v88, v89, v5
v_dot2c_f32_bf16 v92, v93, v5
v_dot2c_f32_bf16 v96, v97, v5
v_dot2c_f32_bf16 v100, v101, v5
v_dot2c_f32_bf16 v88, v90, v6
v_dot2c_f32_bf16 v92, v94, v6
v_dot2c_f32_bf16 v96, v98, v6
v_dot2c_f32_bf16 v100, v102, v6
v_dot2c_f32_bf16 v88, v91, v7
v_dot2c_f32_bf16 v92, v95, v7
v_dot2c_f32_bf16 v96, v99, v7
v_dot2c_f32_bf16 v100, v103, v7
v_add_f32_dpp v89, v88, v88 row_ror:8 row_mask:0xf bank_mask:0x3
v_add_f32_dpp v93, v92, v92 row_ror:8 row_mask:0xf bank_mask:0x3
v_add_f32_dpp v89, v96, v96 row_ror:8 row_mask:0xf bank_mask:0xc
v_add_f32_dpp v93, v100, v100 row_ror:8 row_mask:0xf bank_mask:0xc
s_nop 0
v_add_f32_dpp v12, v89, v89 row_shl:4 row_mask:0xf bank_mask:0x5
v_add_f32_dpp v12, v93, v93 row_shr:4 row_mask:0xf bank_mask:0xa
s_nop 1
v_add_f32_dpp v12, v12, v12 quad_perm:[1,0,3,2] row_mask:0xf bank_mask:0xf
s_nop 1
v_add_f32_dpp v12, v12, v12 quad_perm:[2,3,0,1] row_mask:0xf bank_mask:0xf
v_cvt_pk_bf16_f32 v12, 0, v12
v_mul_f32 v12, s66, v12
v_cvt_pk_bf16_f32 v12, 0, v12
s_xor_b32 s64, s65, 196608
s_cmpk_gt_u32 s69, 81
s_waitcnt vmcnt(6)
s_cbranch_scc1 L_d_84
s_waitcnt vmcnt(4)
L_d_84:
buffer_load_dwordx4 v[40:43], v1, s[44:47], s64 offen nt
v_dot2_f32_bf16 v104, v104, v4, 0
v_dot2_f32_bf16 v108, v108, v4, 0
v_dot2_f32_bf16 v112, v112, v4, 0
v_dot2_f32_bf16 v116, v116, v4, 0
v_dot2c_f32_bf16 v104, v105, v5
v_dot2c_f32_bf16 v108, v109, v5
v_dot2c_f32_bf16 v112, v113, v5
v_dot2c_f32_bf16 v116, v117, v5
v_dot2c_f32_bf16 v104, v106, v6
v_dot2c_f32_bf16 v108, v110, v6
v_dot2c_f32_bf16 v112, v114, v6
v_dot2c_f32_bf16 v116, v118, v6
v_dot2c_f32_bf16 v104, v107, v7
v_dot2c_f32_bf16 v108, v111, v7
v_dot2c_f32_bf16 v112, v115, v7
v_dot2c_f32_bf16 v116, v119, v7
v_add_f32_dpp v105, v104, v104 row_ror:8 row_mask:0xf bank_mask:0x3
v_add_f32_dpp v109, v108, v108 row_ror:8 row_mask:0xf bank_mask:0x3
v_add_f32_dpp v105, v112, v112 row_ror:8 row_mask:0xf bank_mask:0xc
v_add_f32_dpp v109, v116, v116 row_ror:8 row_mask:0xf bank_mask:0xc
s_nop 0
v_add_f32_dpp v13, v105, v105 row_shl:4 row_mask:0xf bank_mask:0x5
v_add_f32_dpp v13, v109, v109 row_shr:4 row_mask:0xf bank_mask:0xa
s_nop 1
v_add_f32_dpp v13, v13, v13 quad_perm:[1,0,3,2] row_mask:0xf bank_mask:0xf
s_nop 1
v_add_f32_dpp v13, v13, v13 quad_perm:[2,3,0,1] row_mask:0xf bank_mask:0xf
v_cvt_pk_bf16_f32 v13, 0, v13
v_mul_f32 v13, s66, v13
v_cvt_pk_bf16_f32 v13, 0, v13
s_xor_b32 s64, s65, 133120
s_cmpk_gt_u32 s69, 82
s_waitcnt vmcnt(6)
s_cbranch_scc1 L_d_85
s_waitcnt vmcnt(4)
L_d_85:
buffer_load_dwordx4 v[44:47], v1, s[44:47], s64 offen nt
v_dot2_f32_bf16 v120, v120, v4, 0
v_dot2_f32_bf16 v124, v124, v4, 0
v_dot2_f32_bf16 v128, v128, v4, 0
v_dot2_f32_bf16 v132, v132, v4, 0
v_dot2c_f32_bf16 v120, v121, v5
v_dot2c_f32_bf16 v124, v125, v5
v_dot2c_f32_bf16 v128, v129, v5
v_dot2c_f32_bf16 v132, v133, v5
v_dot2c_f32_bf16 v120, v122, v6
v_dot2c_f32_bf16 v124, v126, v6
v_dot2c_f32_bf16 v128, v130, v6
v_dot2c_f32_bf16 v132, v134, v6
v_dot2c_f32_bf16 v120, v123, v7
v_dot2c_f32_bf16 v124, v127, v7
v_dot2c_f32_bf16 v128, v131, v7
v_dot2c_f32_bf16 v132, v135, v7
v_add_f32_dpp v121, v120, v120 row_ror:8 row_mask:0xf bank_mask:0x3
v_add_f32_dpp v125, v124, v124 row_ror:8 row_mask:0xf bank_mask:0x3
v_add_f32_dpp v121, v128, v128 row_ror:8 row_mask:0xf bank_mask:0xc
v_add_f32_dpp v125, v132, v132 row_ror:8 row_mask:0xf bank_mask:0xc
s_nop 0
v_add_f32_dpp v14, v121, v121 row_shl:4 row_mask:0xf bank_mask:0x5
v_add_f32_dpp v14, v125, v125 row_shr:4 row_mask:0xf bank_mask:0xa
s_nop 1
v_add_f32_dpp v14, v14, v14 quad_perm:[1,0,3,2] row_mask:0xf bank_mask:0xf
s_nop 1
v_add_f32_dpp v14, v14, v14 quad_perm:[2,3,0,1] row_mask:0xf bank_mask:0xf
v_cvt_pk_bf16_f32 v14, 0, v14
v_mul_f32 v14, s66, v14
v_cvt_pk_bf16_f32 v14, 0, v14
s_xor_b32 s64, s65, 198656
s_cmpk_gt_u32 s69, 83
s_waitcnt vmcnt(6)
s_cbranch_scc1 L_d_86
s_waitcnt vmcnt(4)
L_d_86:
buffer_load_dwordx4 v[48:51], v1, s[44:47], s64 offen nt
v_dot2_f32_bf16 v136, v136, v4, 0
v_dot2_f32_bf16 v140, v140, v4, 0
v_dot2_f32_bf16 v144, v144, v4, 0
v_dot2_f32_bf16 v148, v148, v4, 0
v_dot2c_f32_bf16 v136, v137, v5
v_dot2c_f32_bf16 v140, v141, v5
v_dot2c_f32_bf16 v144, v145, v5
v_dot2c_f32_bf16 v148, v149, v5
v_dot2c_f32_bf16 v136, v138, v6
v_dot2c_f32_bf16 v140, v142, v6
v_dot2c_f32_bf16 v144, v146, v6
v_dot2c_f32_bf16 v148, v150, v6
v_dot2c_f32_bf16 v136, v139, v7
v_dot2c_f32_bf16 v140, v143, v7
v_dot2c_f32_bf16 v144, v147, v7
v_dot2c_f32_bf16 v148, v151, v7
v_add_f32_dpp v137, v136, v136 row_ror:8 row_mask:0xf bank_mask:0x3
v_add_f32_dpp v141, v140, v140 row_ror:8 row_mask:0xf bank_mask:0x3
v_add_f32_dpp v137, v144, v144 row_ror:8 row_mask:0xf bank_mask:0xc
v_add_f32_dpp v141, v148, v148 row_ror:8 row_mask:0xf bank_mask:0xc
s_nop 0
v_add_f32_dpp v15, v137, v137 row_shl:4 row_mask:0xf bank_mask:0x5
v_add_f32_dpp v15, v141, v141 row_shr:4 row_mask:0xf bank_mask:0xa
s_nop 1
v_add_f32_dpp v15, v15, v15 quad_perm:[1,0,3,2] row_mask:0xf bank_mask:0xf
s_nop 1
v_add_f32_dpp v15, v15, v15 quad_perm:[2,3,0,1] row_mask:0xf bank_mask:0xf
v_cvt_pk_bf16_f32 v15, 0, v15
v_mul_f32 v15, s66, v15
v_cvt_pk_bf16_f32 v15, 0, v15
s_xor_b32 s64, s65, 132096
s_cmpk_gt_u32 s69, 84
s_waitcnt vmcnt(6)
s_cbranch_scc1 L_d_87
s_waitcnt vmcnt(4)
L_d_87:
buffer_load_dwordx4 v[52:55], v1, s[44:47], s64 offen nt
v_dot2_f32_bf16 v152, v152, v4, 0
v_dot2_f32_bf16 v156, v156, v4, 0
v_dot2_f32_bf16 v160, v160, v4, 0
v_dot2_f32_bf16 v164, v164, v4, 0
v_dot2c_f32_bf16 v152, v153, v5
v_dot2c_f32_bf16 v156, v157, v5
v_dot2c_f32_bf16 v160, v161, v5
v_dot2c_f32_bf16 v164, v165, v5
v_dot2c_f32_bf16 v152, v154, v6
v_dot2c_f32_bf16 v156, v158, v6
v_dot2c_f32_bf16 v160, v162, v6
v_dot2c_f32_bf16 v164, v166, v6
v_dot2c_f32_bf16 v152, v155, v7
v_dot2c_f32_bf16 v156, v159, v7
v_dot2c_f32_bf16 v160, v163, v7
v_dot2c_f32_bf16 v164, v167, v7
v_add_f32_dpp v153, v152, v152 row_ror:8 row_mask:0xf bank_mask:0x3
v_add_f32_dpp v157, v156, v156 row_ror:8 row_mask:0xf bank_mask:0x3
v_add_f32_dpp v153, v160, v160 row_ror:8 row_mask:0xf bank_mask:0xc
v_add_f32_dpp v157, v164, v164 row_ror:8 row_mask:0xf bank_mask:0xc
s_nop 0
v_add_f32_dpp v16, v153, v153 row_shl:4 row_mask:0xf bank_mask:0x5
v_add_f32_dpp v16, v157, v157 row_shr:4 row_mask:0xf bank_mask:0xa
s_nop 1
v_add_f32_dpp v16, v16, v16 quad_perm:[1,0,3,2] row_mask:0xf bank_mask:0xf
s_nop 1
v_add_f32_dpp v16, v16, v16 quad_perm:[2,3,0,1] row_mask:0xf bank_mask:0xf
v_cvt_pk_bf16_f32 v16, 0, v16
v_mul_f32 v16, s66, v16
v_cvt_pk_bf16_f32 v16, 0, v16
s_xor_b32 s64, s65, 197632
s_cmpk_gt_u32 s69, 85
s_waitcnt vmcnt(6)
s_cbranch_scc1 L_d_88
s_waitcnt vmcnt(4)
L_d_88:
buffer_load_dwordx4 v[56:59], v1, s[44:47], s64 offen nt
v_dot2_f32_bf16 v168, v168, v4, 0
v_dot2_f32_bf16 v172, v172, v4, 0
v_dot2_f32_bf16 v176, v176, v4, 0
v_dot2_f32_bf16 v180, v180, v4, 0
v_dot2c_f32_bf16 v168, v169, v5
v_dot2c_f32_bf16 v172, v173, v5
v_dot2c_f32_bf16 v176, v177, v5
v_dot2c_f32_bf16 v180, v181, v5
v_dot2c_f32_bf16 v168, v170, v6
v_dot2c_f32_bf16 v172, v174, v6
v_dot2c_f32_bf16 v176, v178, v6
v_dot2c_f32_bf16 v180, v182, v6
v_dot2c_f32_bf16 v168, v171, v7
v_dot2c_f32_bf16 v172, v175, v7
v_dot2c_f32_bf16 v176, v179, v7
v_dot2c_f32_bf16 v180, v183, v7
v_add_f32_dpp v169, v168, v168 row_ror:8 row_mask:0xf bank_mask:0x3
v_add_f32_dpp v173, v172, v172 row_ror:8 row_mask:0xf bank_mask:0x3
v_add_f32_dpp v169, v176, v176 row_ror:8 row_mask:0xf bank_mask:0xc
v_add_f32_dpp v173, v180, v180 row_ror:8 row_mask:0xf bank_mask:0xc
s_nop 0
v_add_f32_dpp v18, v169, v169 row_shl:4 row_mask:0xf bank_mask:0x5
v_add_f32_dpp v18, v173, v173 row_shr:4 row_mask:0xf bank_mask:0xa
s_nop 1
v_add_f32_dpp v18, v18, v18 quad_perm:[1,0,3,2] row_mask:0xf bank_mask:0xf
s_nop 1
v_add_f32_dpp v18, v18, v18 quad_perm:[2,3,0,1] row_mask:0xf bank_mask:0xf
v_cvt_pk_bf16_f32 v18, 0, v18
v_mul_f32 v18, s66, v18
v_cvt_pk_bf16_f32 v18, 0, v18
s_xor_b32 s64, s65, 134144
s_cmpk_gt_u32 s69, 86
s_waitcnt vmcnt(6)
s_cbranch_scc1 L_d_89
s_waitcnt vmcnt(4)
L_d_89:
buffer_load_dwordx4 v[60:63], v1, s[44:47], s64 offen nt
v_dot2_f32_bf16 v184, v184, v4, 0
v_dot2_f32_bf16 v188, v188, v4, 0
v_dot2_f32_bf16 v192, v192, v4, 0
v_dot2_f32_bf16 v196, v196, v4, 0
v_dot2c_f32_bf16 v184, v185, v5
v_dot2c_f32_bf16 v188, v189, v5
v_dot2c_f32_bf16 v192, v193, v5
v_dot2c_f32_bf16 v196, v197, v5
v_dot2c_f32_bf16 v184, v186, v6
v_dot2c_f32_bf16 v188, v190, v6
v_dot2c_f32_bf16 v192, v194, v6
v_dot2c_f32_bf16 v196, v198, v6
v_dot2c_f32_bf16 v184, v187, v7
v_dot2c_f32_bf16 v188, v191, v7
v_dot2c_f32_bf16 v192, v195, v7
v_dot2c_f32_bf16 v196, v199, v7
v_add_f32_dpp v185, v184, v184 row_ror:8 row_mask:0xf bank_mask:0x3
v_add_f32_dpp v189, v188, v188 row_ror:8 row_mask:0xf bank_mask:0x3
v_add_f32_dpp v185, v192, v192 row_ror:8 row_mask:0xf bank_mask:0xc
v_add_f32_dpp v189, v196, v196 row_ror:8 row_mask:0xf bank_mask:0xc
s_nop 0
v_add_f32_dpp v19, v185, v185 row_shl:4 row_mask:0xf bank_mask:0x5
v_add_f32_dpp v19, v189, v189 row_shr:4 row_mask:0xf bank_mask:0xa
s_nop 1
v_add_f32_dpp v19, v19, v19 quad_perm:[1,0,3,2] row_mask:0xf bank_mask:0xf
s_nop 1
v_add_f32_dpp v19, v19, v19 quad_perm:[2,3,0,1] row_mask:0xf bank_mask:0xf
v_cvt_pk_bf16_f32 v19, 0, v19
v_mul_f32 v19, s66, v19
v_cvt_pk_bf16_f32 v19, 0, v19
s_xor_b32 s64, s65, 199680
s_cmpk_gt_u32 s69, 87
s_waitcnt vmcnt(6)
s_cbranch_scc1 L_d_90
s_waitcnt vmcnt(4)
L_d_90:
buffer_load_dwordx4 v[64:67], v1, s[44:47], s64 offen nt
v_dot2_f32_bf16 v200, v200, v4, 0
v_dot2_f32_bf16 v204, v204, v4, 0
v_dot2_f32_bf16 v208, v208, v4, 0
v_dot2_f32_bf16 v212, v212, v4, 0
v_dot2c_f32_bf16 v200, v201, v5
v_dot2c_f32_bf16 v204, v205, v5
v_dot2c_f32_bf16 v208, v209, v5
v_dot2c_f32_bf16 v212, v213, v5
v_dot2c_f32_bf16 v200, v202, v6
v_dot2c_f32_bf16 v204, v206, v6
v_dot2c_f32_bf16 v208, v210, v6
v_dot2c_f32_bf16 v212, v214, v6
v_dot2c_f32_bf16 v200, v203, v7
v_dot2c_f32_bf16 v204, v207, v7
v_dot2c_f32_bf16 v208, v211, v7
v_dot2c_f32_bf16 v212, v215, v7
v_add_f32_dpp v201, v200, v200 row_ror:8 row_mask:0xf bank_mask:0x3
v_add_f32_dpp v205, v204, v204 row_ror:8 row_mask:0xf bank_mask:0x3
v_add_f32_dpp v201, v208, v208 row_ror:8 row_mask:0xf bank_mask:0xc
v_add_f32_dpp v205, v212, v212 row_ror:8 row_mask:0xf bank_mask:0xc
s_nop 0
v_add_f32_dpp v20, v201, v201 row_shl:4 row_mask:0xf bank_mask:0x5
v_add_f32_dpp v20, v205, v205 row_shr:4 row_mask:0xf bank_mask:0xa
s_nop 1
v_add_f32_dpp v20, v20, v20 quad_perm:[1,0,3,2] row_mask:0xf bank_mask:0xf
s_nop 1
v_add_f32_dpp v20, v20, v20 quad_perm:[2,3,0,1] row_mask:0xf bank_mask:0xf
v_cvt_pk_bf16_f32 v20, 0, v20
v_mul_f32 v20, s66, v20
v_cvt_pk_bf16_f32 v20, 0, v20
s_xor_b32 s64, s65, 163840
s_cmpk_gt_u32 s69, 88
s_waitcnt vmcnt(6)
s_cbranch_scc1 L_d_91
s_waitcnt vmcnt(4)
L_d_91:
buffer_load_dwordx4 v[68:71], v1, s[44:47], s64 offen nt
v_dot2_f32_bf16 v216, v216, v4, 0
v_dot2_f32_bf16 v220, v220, v4, 0
v_dot2_f32_bf16 v224, v224, v4, 0
v_dot2_f32_bf16 v228, v228, v4, 0
v_dot2c_f32_bf16 v216, v217, v5
v_dot2c_f32_bf16 v220, v221, v5
v_dot2c_f32_bf16 v224, v225, v5
v_dot2c_f32_bf16 v228, v229, v5
v_dot2c_f32_bf16 v216, v218, v6
v_dot2c_f32_bf16 v220, v222, v6
v_dot2c_f32_bf16 v224, v226, v6
v_dot2c_f32_bf16 v228, v230, v6
v_dot2c_f32_bf16 v216, v219, v7
v_dot2c_f32_bf16 v220, v223, v7
v_dot2c_f32_bf16 v224, v227, v7
v_dot2c_f32_bf16 v228, v231, v7
v_add_f32_dpp v217, v216, v216 row_ror:8 row_mask:0xf bank_mask:0x3
v_add_f32_dpp v221, v220, v220 row_ror:8 row_mask:0xf bank_mask:0x3
v_add_f32_dpp v217, v224, v224 row_ror:8 row_mask:0xf bank_mask:0xc
v_add_f32_dpp v221, v228, v228 row_ror:8 row_mask:0xf bank_mask:0xc
s_nop 0
v_add_f32_dpp v21, v217, v217 row_shl:4 row_mask:0xf bank_mask:0x5
v_add_f32_dpp v21, v221, v221 row_shr:4 row_mask:0xf bank_mask:0xa
s_nop 1
v_add_f32_dpp v21, v21, v21 quad_perm:[1,0,3,2] row_mask:0xf bank_mask:0xf
s_nop 1
v_add_f32_dpp v21, v21, v21 quad_perm:[2,3,0,1] row_mask:0xf bank_mask:0xf
v_cvt_pk_bf16_f32 v21, 0, v21
v_mul_f32 v21, s66, v21
v_cvt_pk_bf16_f32 v21, 0, v21
s_xor_b32 s64, s65, 229376
s_cmpk_gt_u32 s69, 89
s_waitcnt vmcnt(6)
s_cbranch_scc1 L_d_92
s_waitcnt vmcnt(4)
L_d_92:
buffer_load_dwordx4 v[72:75], v1, s[44:47], s64 offen nt
v_dot2_f32_bf16 v232, v232, v4, 0
v_dot2_f32_bf16 v236, v236, v4, 0
v_dot2_f32_bf16 v240, v240, v4, 0
v_dot2_f32_bf16 v244, v244, v4, 0
v_dot2c_f32_bf16 v232, v233, v5
v_dot2c_f32_bf16 v236, v237, v5
v_dot2c_f32_bf16 v240, v241, v5
v_dot2c_f32_bf16 v244, v245, v5
v_dot2c_f32_bf16 v232, v234, v6
v_dot2c_f32_bf16 v236, v238, v6
v_dot2c_f32_bf16 v240, v242, v6
v_dot2c_f32_bf16 v244, v246, v6
v_dot2c_f32_bf16 v232, v235, v7
v_dot2c_f32_bf16 v236, v239, v7
v_dot2c_f32_bf16 v240, v243, v7
v_dot2c_f32_bf16 v244, v247, v7
v_add_f32_dpp v233, v232, v232 row_ror:8 row_mask:0xf bank_mask:0x3
v_add_f32_dpp v237, v236, v236 row_ror:8 row_mask:0xf bank_mask:0x3
v_add_f32_dpp v233, v240, v240 row_ror:8 row_mask:0xf bank_mask:0xc
v_add_f32_dpp v237, v244, v244 row_ror:8 row_mask:0xf bank_mask:0xc
s_nop 0
v_add_f32_dpp v22, v233, v233 row_shl:4 row_mask:0xf bank_mask:0x5
v_add_f32_dpp v22, v237, v237 row_shr:4 row_mask:0xf bank_mask:0xa
s_nop 1
v_add_f32_dpp v22, v22, v22 quad_perm:[1,0,3,2] row_mask:0xf bank_mask:0xf
s_nop 1
v_add_f32_dpp v22, v22, v22 quad_perm:[2,3,0,1] row_mask:0xf bank_mask:0xf
v_cvt_pk_bf16_f32 v22, 0, v22
v_mul_f32 v22, s66, v22
v_cvt_pk_bf16_f32 v22, 0, v22
s_xor_b32 s64, s65, 165888
s_cmpk_gt_u32 s69, 90
s_waitcnt vmcnt(6)
s_cbranch_scc1 L_d_93
s_waitcnt vmcnt(5)
L_d_93:
buffer_load_dwordx4 v[76:79], v1, s[44:47], s64 offen nt
v_lshl_add_u32 v80, v0, 4, s70
ds_read_b128 v[84:87], v80 offset:0
ds_read_b128 v[88:91], v80 offset:1024
s_waitcnt lgkmcnt(0)
v_dot2_f32_bf16 v248, v248, v4, 0
v_dot2_f32_bf16 v252, v252, v4, 0
v_dot2_f32_bf16 v84, v84, v4, 0
v_dot2_f32_bf16 v88, v88, v4, 0
v_dot2c_f32_bf16 v248, v249, v5
v_dot2c_f32_bf16 v252, v253, v5
v_dot2c_f32_bf16 v84, v85, v5
v_dot2c_f32_bf16 v88, v89, v5
v_dot2c_f32_bf16 v248, v250, v6
v_dot2c_f32_bf16 v252, v254, v6
v_dot2c_f32_bf16 v84, v86, v6
v_dot2c_f32_bf16 v88, v90, v6
v_dot2c_f32_bf16 v248, v251, v7
v_dot2c_f32_bf16 v252, v255, v7
v_dot2c_f32_bf16 v84, v87, v7
v_dot2c_f32_bf16 v88, v91, v7
v_add_f32_dpp v249, v248, v248 row_ror:8 row_mask:0xf bank_mask:0x3
v_add_f32_dpp v253, v252, v252 row_ror:8 row_mask:0xf bank_mask:0x3
v_add_f32_dpp v249, v84, v84 row_ror:8 row_mask:0xf bank_mask:0xc
v_add_f32_dpp v253, v88, v88 row_ror:8 row_mask:0xf bank_mask:0xc
s_nop 0
v_add_f32_dpp v23, v249, v249 row_shl:4 row_mask:0xf bank_mask:0x5
v_add_f32_dpp v23, v253, v253 row_shr:4 row_mask:0xf bank_mask:0xa
s_nop 1
v_add_f32_dpp v23, v23, v23 quad_perm:[1,0,3,2] row_mask:0xf bank_mask:0xf
s_nop 1
v_add_f32_dpp v23, v23, v23 quad_perm:[2,3,0,1] row_mask:0xf bank_mask:0xf
v_cvt_pk_bf16_f32 v23, 0, v23
v_mul_f32 v23, s66, v23
v_cvt_pk_bf16_f32 v23, 0, v23
s_xor_b32 s64, s65, 231424
s_cmpk_gt_u32 s69, 91
s_waitcnt vmcnt(6)
s_cbranch_scc1 L_d_94
s_waitcnt vmcnt(5)
L_d_94:
buffer_load_dwordx4 v[92:95], v1, s[44:47], s64 offen nt
v_max3_f32 v2, v17, v8, v9
v_max3_f32 v2, v2, v10, v11
v_max3_f32 v2, v2, v12, v13
v_max3_f32 v2, v2, v14, v15
v_max3_f32 v2, v2, v16, v18
v_max3_f32 v2, v2, v19, v20
v_max3_f32 v2, v2, v21, v22
v_max_f32 v2, v2, v23
v_max_f32 v2, 0xff7fffff, v2
s_nop 1
v_max_f32_dpp v2, v2, v2 row_ror:4 row_mask:0xf bank_mask:0xf
s_nop 1
v_max_f32_dpp v2, v2, v2 row_ror:8 row_mask:0xf bank_mask:0xf
v_mov_b32 v3, v2
s_nop 1
v_permlane16_swap_b32 v2, v3
s_nop 1
v_max_f32 v2, v2, v3
v_mov_b32 v3, v2
s_nop 1
v_permlane32_swap_b32 v2, v3
s_nop 1
v_max_f32 v2, v2, v3
s_mov_b32 s67, 0x3fb8aa3b
v_sub_f32 v17, v17, v2
v_sub_f32 v8, v8, v2
v_sub_f32 v9, v9, v2
v_sub_f32 v10, v10, v2
v_sub_f32 v11, v11, v2
v_sub_f32 v12, v12, v2
v_sub_f32 v13, v13, v2
v_sub_f32 v14, v14, v2
v_sub_f32 v15, v15, v2
v_sub_f32 v16, v16, v2
v_sub_f32 v18, v18, v2
v_sub_f32 v19, v19, v2
v_sub_f32 v20, v20, v2
v_sub_f32 v21, v21, v2
v_sub_f32 v22, v22, v2
v_sub_f32 v23, v23, v2
v_mul_f32 v17, s67, v17
v_mul_f32 v8, s67, v8
v_mul_f32 v9, s67, v9
v_mul_f32 v10, s67, v10
v_mul_f32 v11, s67, v11
v_mul_f32 v12, s67, v12
v_mul_f32 v13, s67, v13
v_mul_f32 v14, s67, v14
v_mul_f32 v15, s67, v15
v_mul_f32 v16, s67, v16
v_mul_f32 v18, s67, v18
v_mul_f32 v19, s67, v19
v_mul_f32 v20, s67, v20
v_mul_f32 v21, s67, v21
v_mul_f32 v22, s67, v22
v_mul_f32 v23, s67, v23
s_xor_b32 s64, s65, 164864
s_cmpk_gt_u32 s69, 92
s_waitcnt vmcnt(6)
s_cbranch_scc1 L_d_95
s_waitcnt vmcnt(5)
L_d_95:
buffer_load_dwordx4 v[116:119], v1, s[44:47], s64 offen nt
v_exp_f32 v17, v17
v_exp_f32 v8, v8
v_exp_f32 v9, v9
v_exp_f32 v10, v10
v_exp_f32 v11, v11
v_exp_f32 v12, v12
v_exp_f32 v13, v13
v_exp_f32 v14, v14
v_exp_f32 v15, v15
v_exp_f32 v16, v16
v_exp_f32 v18, v18
v_exp_f32 v19, v19
v_exp_f32 v20, v20
v_exp_f32 v21, v21
v_exp_f32 v22, v22
v_exp_f32 v23, v23
v_add_f32 v3, v17, v8
v_add_f32 v3, v3, v9
v_add_f32 v3, v3, v10
v_add_f32 v3, v3, v11
v_add_f32 v3, v3, v12
v_add_f32 v3, v3, v13
v_add_f32 v3, v3, v14
v_add_f32 v3, v3, v15
v_add_f32 v3, v3, v16
v_add_f32 v3, v3, v18
v_add_f32 v3, v3, v19
v_add_f32 v3, v3, v20
v_add_f32 v3, v3, v21
v_add_f32 v3, v3, v22
v_add_f32 v3, v3, v23
s_nop 1
v_add_f32_dpp v3, v3, v3 row_ror:4 row_mask:0xf bank_mask:0xf
s_nop 1
v_add_f32_dpp v3, v3, v3 row_ror:8 row_mask:0xf bank_mask:0xf
v_mov_b32 v96, v3
s_nop 1
v_permlane16_swap_b32 v3, v96
s_nop 1
v_add_f32 v3, v3, v96
v_mov_b32 v96, v3
s_nop 1
v_permlane32_swap_b32 v3, v96
s_nop 1
v_add_f32 v3, v3, v96
v_min_u32 v3, -2, v3
s_lshl_b32 s68, s34, 3
v_mov_b32 v96, s68
ds_write_b64 v96, v[2:3] offset:256
v_and_b32 v97, 15, v0
v_lshrrev_b32 v98, 1, v97
v_and_b32 v97, 1, v0
v_lshlrev_b32 v97, 4, v97
v_mov_b32 v99, 0xffff
v_lshlrev_b32 v97, v97, v99
v_cmp_eq_u32 vcc, 0, v98
s_nop 1
v_cndmask_b32 v4, 0, v97, vcc
v_cmp_eq_u32 vcc, 1, v98
s_nop 1
v_cndmask_b32 v5, 0, v97, vcc
v_cmp_eq_u32 vcc, 2, v98
s_nop 1
v_cndmask_b32 v6, 0, v97, vcc
v_cmp_eq_u32 vcc, 3, v98
s_nop 1
v_cndmask_b32 v7, 0, v97, vcc
s_xor_b32 s64, s65, 230400
s_cmpk_gt_u32 s69, 93
s_waitcnt vmcnt(6)
s_cbranch_scc1 L_d_96
s_waitcnt vmcnt(5)
L_d_96:
buffer_load_dwordx4 v[120:123], v1, s[44:47], s64 offen nt
v_mov_b32 v96, 0
s_mov_b32 s75, 0
L_poll_97:
ds_read_b128 v[100:103], v96 offset:256
ds_read_b128 v[104:107], v96 offset:272
s_waitcnt lgkmcnt(0)
v_max3_u32 v97, v101, v103, v105
v_max_u32 v97, v97, v107
v_cmp_eq_u32 vcc, -1, v97
s_cbranch_vccz L_pollx_98
s_add_u32 s75, s75, 1
s_cmp_lt_u32 s75, 0x1000000
s_cbranch_scc1 L_poll_97
L_pollx_98:
v_max3_f32 v97, v100, v102, v104
v_max_f32 v97, v97, v106
v_sub_f32 v100, v100, v97
v_sub_f32 v102, v102, v97
v_sub_f32 v104, v104, v97
v_sub_f32 v106, v106, v97
v_sub_f32 v2, v2, v97
v_mul_f32 v100, s67, v100
v_mul_f32 v102, s67, v102
v_mul_f32 v104, s67, v104
v_mul_f32 v106, s67, v106
v_mul_f32 v2, s67, v2
v_exp_f32 v100, v100
v_exp_f32 v102, v102
v_exp_f32 v104, v104
v_exp_f32 v106, v106
v_exp_f32 v2, v2
v_mul_f32 v3, v100, v101
v_fmac_f32 v3, v102, v103
v_fmac_f32 v3, v104, v105
v_fmac_f32 v3, v106, v107
v_rcp_f32 v3, v3
s_nop 0
v_mul_f32 v2, v2, v3
v_mul_f32 v17, v17, v2
v_mul_f32 v8, v8, v2
v_mul_f32 v9, v9, v2
v_mul_f32 v10, v10, v2
v_mul_f32 v11, v11, v2
v_mul_f32 v12, v12, v2
v_mul_f32 v13, v13, v2
v_mul_f32 v14, v14, v2
v_mul_f32 v15, v15, v2
v_mul_f32 v16, v16, v2
v_mul_f32 v18, v18, v2
v_mul_f32 v19, v19, v2
v_mul_f32 v20, v20, v2
v_mul_f32 v21, v21, v2
v_mul_f32 v22, v22, v2
v_mul_f32 v23, v23, v2
v_cvt_pk_bf16_f32 v17, v17, v17
v_cvt_pk_bf16_f32 v8, v8, v8
v_cvt_pk_bf16_f32 v9, v9, v9
v_cvt_pk_bf16_f32 v10, v10, v10
v_cvt_pk_bf16_f32 v11, v11, v11
v_cvt_pk_bf16_f32 v12, v12, v12
v_cvt_pk_bf16_f32 v13, v13, v13
v_cvt_pk_bf16_f32 v14, v14, v14
v_cvt_pk_bf16_f32 v15, v15, v15
v_cvt_pk_bf16_f32 v16, v16, v16
v_cvt_pk_bf16_f32 v18, v18, v18
v_cvt_pk_bf16_f32 v19, v19, v19
v_cvt_pk_bf16_f32 v20, v20, v20
v_cvt_pk_bf16_f32 v21, v21, v21
v_cvt_pk_bf16_f32 v22, v22, v22
v_cvt_pk_bf16_f32 v23, v23, v23
s_nop 1
s_and_b32 s62, s2, 7
s_lshl_b32 s62, s62, 9
s_add_u32 s62, s62, 1327104
s_lshr_b32 s63, s2, 3
s_lshl_b32 s63, s63, 2
s_add_u32 s63, s63, s62
s_cmp_eq_u32 s34, 0
s_cbranch_scc0 L_w_100
v_mov_b32 v124, 30
s_mov_b64 exec, 1
buffer_store_dword v124, off, s[36:39], s63 offset:0
s_mov_b64 exec, -1
L_w_100:
s_xor_b32 s64, s65, 166912
s_cmpk_gt_u32 s69, 94
s_waitcnt vmcnt(6)
s_cbranch_scc1 L_d_99
s_waitcnt vmcnt(5)
L_d_99:
buffer_load_dwordx4 v[128:131], v1, s[44:47], s64 offen nt
ds_read_b128 v[132:135], v80 offset:2048
ds_read_b128 v[136:139], v80 offset:3072
ds_read_b128 v[140:143], v80 offset:4096
ds_read_b128 v[144:147], v80 offset:5120
ds_read_b128 v[148:151], v80 offset:6144
ds_read_b128 v[152:155], v80 offset:7168
ds_read_b128 v[156:159], v80 offset:8192
ds_read_b128 v[160:163], v80 offset:9216
s_waitcnt lgkmcnt(0)
v_and_b32_dpp v100, v17, v4 row_newbcast:0 row_mask:0xf bank_mask:0xf
v_and_b32_dpp v101, v17, v5 row_newbcast:0 row_mask:0xf bank_mask:0xf
v_and_b32_dpp v102, v17, v6 row_newbcast:0 row_mask:0xf bank_mask:0xf
v_and_b32_dpp v103, v17, v7 row_newbcast:0 row_mask:0xf bank_mask:0xf
v_and_b32_dpp v104, v17, v4 row_newbcast:4 row_mask:0xf bank_mask:0xf
v_and_b32_dpp v105, v17, v5 row_newbcast:4 row_mask:0xf bank_mask:0xf
v_and_b32_dpp v106, v17, v6 row_newbcast:4 row_mask:0xf bank_mask:0xf
v_and_b32_dpp v107, v17, v7 row_newbcast:4 row_mask:0xf bank_mask:0xf
v_mfma_f32_16x16x32_bf16 v[108:111], v[100:103], v[132:135], 0
v_and_b32_dpp v100, v17, v4 row_newbcast:8 row_mask:0xf bank_mask:0xf
v_and_b32_dpp v101, v17, v5 row_newbcast:8 row_mask:0xf bank_mask:0xf
v_and_b32_dpp v102, v17, v6 row_newbcast:8 row_mask:0xf bank_mask:0xf
v_and_b32_dpp v103, v17, v7 row_newbcast:8 row_mask:0xf bank_mask:0xf
v_mfma_f32_16x16x32_bf16 v[108:111], v[104:107], v[136:139], v[108:111]
v_and_b32_dpp v104, v17, v4 row_newbcast:12 row_mask:0xf bank_mask:0xf
v_and_b32_dpp v105, v17, v5 row_newbcast:12 row_mask:0xf bank_mask:0xf
v_and_b32_dpp v106, v17, v6 row_newbcast:12 row_mask:0xf bank_mask:0xf
v_and_b32_dpp v107, v17, v7 row_newbcast:12 row_mask:0xf bank_mask:0xf
v_mfma_f32_16x16x32_bf16 v[108:111], v[100:103], v[140:143], v[108:111]
v_and_b32_dpp v100, v8, v4 row_newbcast:0 row_mask:0xf bank_mask:0xf
v_and_b32_dpp v101, v8, v5 row_newbcast:0 row_mask:0xf bank_mask:0xf
v_and_b32_dpp v102, v8, v6 row_newbcast:0 row_mask:0xf bank_mask:0xf
v_and_b32_dpp v103, v8, v7 row_newbcast:0 row_mask:0xf bank_mask:0xf
v_mfma_f32_16x16x32_bf16 v[108:111], v[104:107], v[144:147], v[108:111]
v_and_b32_dpp v104, v8, v4 row_newbcast:4 row_mask:0xf bank_mask:0xf
v_and_b32_dpp v105, v8, v5 row_newbcast:4 row_mask:0xf bank_mask:0xf
v_and_b32_dpp v106, v8, v6 row_newbcast:4 row_mask:0xf bank_mask:0xf
v_and_b32_dpp v107, v8, v7 row_newbcast:4 row_mask:0xf bank_mask:0xf
v_mfma_f32_16x16x32_bf16 v[108:111], v[100:103], v[148:151], v[108:111]
s_xor_b32 s64, s65, 232448
s_cmpk_gt_u32 s69, 95
s_waitcnt vmcnt(6)
s_cbranch_scc1 L_d_101
s_waitcnt vmcnt(5)
L_d_101:
buffer_load_dwordx4 v[164:167], v1, s[44:47], s64 offen nt
v_and_b32_dpp v100, v8, v4 row_newbcast:8 row_mask:0xf bank_mask:0xf
v_and_b32_dpp v101, v8, v5 row_newbcast:8 row_mask:0xf bank_mask:0xf
v_and_b32_dpp v102, v8, v6 row_newbcast:8 row_mask:0xf bank_mask:0xf
v_and_b32_dpp v103, v8, v7 row_newbcast:8 row_mask:0xf bank_mask:0xf
v_mfma_f32_16x16x32_bf16 v[108:111], v[104:107], v[152:155], v[108:111]
v_and_b32_dpp v104, v8, v4 row_newbcast:12 row_mask:0xf bank_mask:0xf
v_and_b32_dpp v105, v8, v5 row_newbcast:12 row_mask:0xf bank_mask:0xf
v_and_b32_dpp v106, v8, v6 row_newbcast:12 row_mask:0xf bank_mask:0xf
v_and_b32_dpp v107, v8, v7 row_newbcast:12 row_mask:0xf bank_mask:0xf
v_mfma_f32_16x16x32_bf16 v[108:111], v[100:103], v[156:159], v[108:111]
v_and_b32_dpp v100, v9, v4 row_newbcast:0 row_mask:0xf bank_mask:0xf
v_and_b32_dpp v101, v9, v5 row_newbcast:0 row_mask:0xf bank_mask:0xf
v_and_b32_dpp v102, v9, v6 row_newbcast:0 row_mask:0xf bank_mask:0xf
v_and_b32_dpp v103, v9, v7 row_newbcast:0 row_mask:0xf bank_mask:0xf
v_mfma_f32_16x16x32_bf16 v[108:111], v[104:107], v[160:163], v[108:111]
ds_read_b128 v[168:171], v80 offset:10240
ds_read_b128 v[172:175], v80 offset:11264
ds_read_b128 v[176:179], v80 offset:12288
ds_read_b128 v[180:183], v80 offset:13312
ds_read_b128 v[184:187], v80 offset:14336
s_waitcnt lgkmcnt(0)
v_and_b32_dpp v104, v9, v4 row_newbcast:4 row_mask:0xf bank_mask:0xf
v_and_b32_dpp v105, v9, v5 row_newbcast:4 row_mask:0xf bank_mask:0xf
v_and_b32_dpp v106, v9, v6 row_newbcast:4 row_mask:0xf bank_mask:0xf
v_and_b32_dpp v107, v9, v7 row_newbcast:4 row_mask:0xf bank_mask:0xf
v_mfma_f32_16x16x32_bf16 v[108:111], v[100:103], v[168:171], v[108:111]
v_and_b32_dpp v100, v9, v4 row_newbcast:8 row_mask:0xf bank_mask:0xf
v_and_b32_dpp v101, v9, v5 row_newbcast:8 row_mask:0xf bank_mask:0xf
v_and_b32_dpp v102, v9, v6 row_newbcast:8 row_mask:0xf bank_mask:0xf
v_and_b32_dpp v103, v9, v7 row_newbcast:8 row_mask:0xf bank_mask:0xf
v_mfma_f32_16x16x32_bf16 v[108:111], v[104:107], v[172:175], v[108:111]
s_xor_b32 s64, s65, 4096
s_cmpk_gt_u32 s69, 96
s_waitcnt vmcnt(6)
s_cbranch_scc1 L_d_102
s_waitcnt vmcnt(5)
L_d_102:
buffer_load_dwordx4 v[188:191], v1, s[44:47], s64 offen nt
v_and_b32_dpp v104, v9, v4 row_newbcast:12 row_mask:0xf bank_mask:0xf
v_and_b32_dpp v105, v9, v5 row_newbcast:12 row_mask:0xf bank_mask:0xf
v_and_b32_dpp v106, v9, v6 row_newbcast:12 row_mask:0xf bank_mask:0xf
v_and_b32_dpp v107, v9, v7 row_newbcast:12 row_mask:0xf bank_mask:0xf
v_mfma_f32_16x16x32_bf16 v[108:111], v[100:103], v[176:179], v[108:111]
v_and_b32_dpp v100, v10, v4 row_newbcast:0 row_mask:0xf bank_mask:0xf
v_and_b32_dpp v101, v10, v5 row_newbcast:0 row_mask:0xf bank_mask:0xf
v_and_b32_dpp v102, v10, v6 row_newbcast:0 row_mask:0xf bank_mask:0xf
v_and_b32_dpp v103, v10, v7 row_newbcast:0 row_mask:0xf bank_mask:0xf
v_mfma_f32_16x16x32_bf16 v[108:111], v[104:107], v[180:183], v[108:111]
v_and_b32_dpp v104, v10, v4 row_newbcast:4 row_mask:0xf bank_mask:0xf
v_and_b32_dpp v105, v10, v5 row_newbcast:4 row_mask:0xf bank_mask:0xf
v_and_b32_dpp v106, v10, v6 row_newbcast:4 row_mask:0xf bank_mask:0xf
v_and_b32_dpp v107, v10, v7 row_newbcast:4 row_mask:0xf bank_mask:0xf
v_mfma_f32_16x16x32_bf16 v[108:111], v[100:103], v[184:187], v[108:111]
v_and_b32_dpp v100, v10, v4 row_newbcast:8 row_mask:0xf bank_mask:0xf
v_and_b32_dpp v101, v10, v5 row_newbcast:8 row_mask:0xf bank_mask:0xf
v_and_b32_dpp v102, v10, v6 row_newbcast:8 row_mask:0xf bank_mask:0xf
v_and_b32_dpp v103, v10, v7 row_newbcast:8 row_mask:0xf bank_mask:0xf
v_mfma_f32_16x16x32_bf16 v[108:111], v[104:107], v[24:27], v[108:111]
v_and_b32_dpp v104, v10, v4 row_newbcast:12 row_mask:0xf bank_mask:0xf
v_and_b32_dpp v105, v10, v5 row_newbcast:12 row_mask:0xf bank_mask:0xf
v_and_b32_dpp v106, v10, v6 row_newbcast:12 row_mask:0xf bank_mask:0xf
v_and_b32_dpp v107, v10, v7 row_newbcast:12 row_mask:0xf bank_mask:0xf
v_mfma_f32_16x16x32_bf16 v[108:111], v[100:103], v[28:31], v[108:111]
s_xor_b32 s64, s65, 69632
s_cmpk_gt_u32 s69, 97
s_waitcnt vmcnt(6)
s_cbranch_scc1 L_d_103
s_waitcnt vmcnt(5)
L_d_103:
buffer_load_dwordx4 v[192:195], v1, s[44:47], s64 offen nt
v_and_b32_dpp v100, v11, v4 row_newbcast:0 row_mask:0xf bank_mask:0xf
v_and_b32_dpp v101, v11, v5 row_newbcast:0 row_mask:0xf bank_mask:0xf
v_and_b32_dpp v102, v11, v6 row_newbcast:0 row_mask:0xf bank_mask:0xf
v_and_b32_dpp v103, v11, v7 row_newbcast:0 row_mask:0xf bank_mask:0xf
v_mfma_f32_16x16x32_bf16 v[108:111], v[104:107], v[32:35], v[108:111]
v_and_b32_dpp v104, v11, v4 row_newbcast:4 row_mask:0xf bank_mask:0xf
v_and_b32_dpp v105, v11, v5 row_newbcast:4 row_mask:0xf bank_mask:0xf
v_and_b32_dpp v106, v11, v6 row_newbcast:4 row_mask:0xf bank_mask:0xf
v_and_b32_dpp v107, v11, v7 row_newbcast:4 row_mask:0xf bank_mask:0xf
v_mfma_f32_16x16x32_bf16 v[108:111], v[100:103], v[36:39], v[108:111]
v_and_b32_dpp v100, v11, v4 row_newbcast:8 row_mask:0xf bank_mask:0xf
v_and_b32_dpp v101, v11, v5 row_newbcast:8 row_mask:0xf bank_mask:0xf
v_and_b32_dpp v102, v11, v6 row_newbcast:8 row_mask:0xf bank_mask:0xf
v_and_b32_dpp v103, v11, v7 row_newbcast:8 row_mask:0xf bank_mask:0xf
v_mfma_f32_16x16x32_bf16 v[108:111], v[104:107], v[40:43], v[108:111]
v_and_b32_dpp v104, v11, v4 row_newbcast:12 row_mask:0xf bank_mask:0xf
v_and_b32_dpp v105, v11, v5 row_newbcast:12 row_mask:0xf bank_mask:0xf
v_and_b32_dpp v106, v11, v6 row_newbcast:12 row_mask:0xf bank_mask:0xf
v_and_b32_dpp v107, v11, v7 row_newbcast:12 row_mask:0xf bank_mask:0xf
v_mfma_f32_16x16x32_bf16 v[108:111], v[100:103], v[44:47], v[108:111]
v_and_b32_dpp v100, v12, v4 row_newbcast:0 row_mask:0xf bank_mask:0xf
v_and_b32_dpp v101, v12, v5 row_newbcast:0 row_mask:0xf bank_mask:0xf
v_and_b32_dpp v102, v12, v6 row_newbcast:0 row_mask:0xf bank_mask:0xf
v_and_b32_dpp v103, v12, v7 row_newbcast:0 row_mask:0xf bank_mask:0xf
v_mfma_f32_16x16x32_bf16 v[108:111], v[104:107], v[48:51], v[108:111]
s_xor_b32 s64, s65, 6144
s_cmpk_gt_u32 s69, 98
s_waitcnt vmcnt(6)
s_cbranch_scc1 L_d_104
s_waitcnt vmcnt(5)
L_d_104:
buffer_load_dwordx4 v[196:199], v1, s[44:47], s64 offen nt
v_and_b32_dpp v104, v12, v4 row_newbcast:4 row_mask:0xf bank_mask:0xf
v_and_b32_dpp v105, v12, v5 row_newbcast:4 row_mask:0xf bank_mask:0xf
v_and_b32_dpp v106, v12, v6 row_newbcast:4 row_mask:0xf bank_mask:0xf
v_and_b32_dpp v107, v12, v7 row_newbcast:4 row_mask:0xf bank_mask:0xf
v_mfma_f32_16x16x32_bf16 v[108:111], v[100:103], v[52:55], v[108:111]
v_and_b32_dpp v100, v12, v4 row_newbcast:8 row_mask:0xf bank_mask:0xf
v_and_b32_dpp v101, v12, v5 row_newbcast:8 row_mask:0xf bank_mask:0xf
v_and_b32_dpp v102, v12, v6 row_newbcast:8 row_mask:0xf bank_mask:0xf
v_and_b32_dpp v103, v12, v7 row_newbcast:8 row_mask:0xf bank_mask:0xf
v_mfma_f32_16x16x32_bf16 v[108:111], v[104:107], v[56:59], v[108:111]
v_and_b32_dpp v104, v12, v4 row_newbcast:12 row_mask:0xf bank_mask:0xf
v_and_b32_dpp v105, v12, v5 row_newbcast:12 row_mask:0xf bank_mask:0xf
v_and_b32_dpp v106, v12, v6 row_newbcast:12 row_mask:0xf bank_mask:0xf
v_and_b32_dpp v107, v12, v7 row_newbcast:12 row_mask:0xf bank_mask:0xf
v_mfma_f32_16x16x32_bf16 v[108:111], v[100:103], v[60:63], v[108:111]
v_and_b32_dpp v100, v13, v4 row_newbcast:0 row_mask:0xf bank_mask:0xf
v_and_b32_dpp v101, v13, v5 row_newbcast:0 row_mask:0xf bank_mask:0xf
v_and_b32_dpp v102, v13, v6 row_newbcast:0 row_mask:0xf bank_mask:0xf
v_and_b32_dpp v103, v13, v7 row_newbcast:0 row_mask:0xf bank_mask:0xf
v_mfma_f32_16x16x32_bf16 v[108:111], v[104:107], v[64:67], v[108:111]
v_and_b32_dpp v104, v13, v4 row_newbcast:4 row_mask:0xf bank_mask:0xf
v_and_b32_dpp v105, v13, v5 row_newbcast:4 row_mask:0xf bank_mask:0xf
v_and_b32_dpp v106, v13, v6 row_newbcast:4 row_mask:0xf bank_mask:0xf
v_and_b32_dpp v107, v13, v7 row_newbcast:4 row_mask:0xf bank_mask:0xf
v_mfma_f32_16x16x32_bf16 v[108:111], v[100:103], v[68:71], v[108:111]
s_xor_b32 s64, s65, 71680
s_cmpk_gt_u32 s69, 99
s_waitcnt vmcnt(6)
s_cbranch_scc1 L_d_105
s_waitcnt vmcnt(5)
L_d_105:
buffer_load_dwordx4 v[200:203], v1, s[44:47], s64 offen nt
v_and_b32_dpp v100, v13, v4 row_newbcast:8 row_mask:0xf bank_mask:0xf
v_and_b32_dpp v101, v13, v5 row_newbcast:8 row_mask:0xf bank_mask:0xf
v_and_b32_dpp v102, v13, v6 row_newbcast:8 row_mask:0xf bank_mask:0xf
v_and_b32_dpp v103, v13, v7 row_newbcast:8 row_mask:0xf bank_mask:0xf
v_mfma_f32_16x16x32_bf16 v[108:111], v[104:107], v[72:75], v[108:111]
v_and_b32_dpp v104, v13, v4 row_newbcast:12 row_mask:0xf bank_mask:0xf
v_and_b32_dpp v105, v13, v5 row_newbcast:12 row_mask:0xf bank_mask:0xf
v_and_b32_dpp v106, v13, v6 row_newbcast:12 row_mask:0xf bank_mask:0xf
v_and_b32_dpp v107, v13, v7 row_newbcast:12 row_mask:0xf bank_mask:0xf
v_mfma_f32_16x16x32_bf16 v[108:111], v[100:103], v[76:79], v[108:111]
v_and_b32_dpp v100, v14, v4 row_newbcast:0 row_mask:0xf bank_mask:0xf
v_and_b32_dpp v101, v14, v5 row_newbcast:0 row_mask:0xf bank_mask:0xf
v_and_b32_dpp v102, v14, v6 row_newbcast:0 row_mask:0xf bank_mask:0xf
v_and_b32_dpp v103, v14, v7 row_newbcast:0 row_mask:0xf bank_mask:0xf
v_mfma_f32_16x16x32_bf16 v[108:111], v[104:107], v[92:95], v[108:111]
v_and_b32_dpp v104, v14, v4 row_newbcast:4 row_mask:0xf bank_mask:0xf
v_and_b32_dpp v105, v14, v5 row_newbcast:4 row_mask:0xf bank_mask:0xf
v_and_b32_dpp v106, v14, v6 row_newbcast:4 row_mask:0xf bank_mask:0xf
v_and_b32_dpp v107, v14, v7 row_newbcast:4 row_mask:0xf bank_mask:0xf
v_mfma_f32_16x16x32_bf16 v[108:111], v[100:103], v[116:119], v[108:111]
s_xor_b32 s64, s65, 5120
s_cmpk_gt_u32 s69, 100
s_waitcnt vmcnt(6)
s_cbranch_scc1 L_d_106
s_waitcnt vmcnt(5)
L_d_106:
buffer_load_dwordx4 v[204:207], v1, s[44:47], s64 offen nt
v_and_b32_dpp v100, v14, v4 row_newbcast:8 row_mask:0xf bank_mask:0xf
v_and_b32_dpp v101, v14, v5 row_newbcast:8 row_mask:0xf bank_mask:0xf
v_and_b32_dpp v102, v14, v6 row_newbcast:8 row_mask:0xf bank_mask:0xf
v_and_b32_dpp v103, v14, v7 row_newbcast:8 row_mask:0xf bank_mask:0xf
v_mfma_f32_16x16x32_bf16 v[108:111], v[104:107], v[120:123], v[108:111]
s_xor_b32 s64, s65, 70656
s_cmpk_gt_u32 s69, 101
s_waitcnt vmcnt(6)
s_cbranch_scc1 L_d_107
s_waitcnt vmcnt(5)
L_d_107:
buffer_load_dwordx4 v[208:211], v1, s[44:47], s64 offen nt
v_and_b32_dpp v104, v14, v4 row_newbcast:12 row_mask:0xf bank_mask:0xf
v_and_b32_dpp v105, v14, v5 row_newbcast:12 row_mask:0xf bank_mask:0xf
v_and_b32_dpp v106, v14, v6 row_newbcast:12 row_mask:0xf bank_mask:0xf
v_and_b32_dpp v107, v14, v7 row_newbcast:12 row_mask:0xf bank_mask:0xf
v_mfma_f32_16x16x32_bf16 v[108:111], v[100:103], v[128:131], v[108:111]
s_cmp_eq_u32 s34, 1
s_cbranch_scc0 L_w_109
v_mov_b32 v124, 38
s_mov_b64 exec, 1
buffer_store_dword v124, off, s[36:39], s63 offset:0
s_mov_b64 exec, -1
L_w_109:
s_xor_b32 s64, s65, 7168
s_cmpk_gt_u32 s69, 102
s_waitcnt vmcnt(6)
s_cbranch_scc1 L_d_108
s_waitcnt vmcnt(5)
L_d_108:
buffer_load_dwordx4 v[212:215], v1, s[44:47], s64 offen nt
v_and_b32_dpp v100, v15, v4 row_newbcast:0 row_mask:0xf bank_mask:0xf
v_and_b32_dpp v101, v15, v5 row_newbcast:0 row_mask:0xf bank_mask:0xf
v_and_b32_dpp v102, v15, v6 row_newbcast:0 row_mask:0xf bank_mask:0xf
v_and_b32_dpp v103, v15, v7 row_newbcast:0 row_mask:0xf bank_mask:0xf
v_mfma_f32_16x16x32_bf16 v[108:111], v[104:107], v[164:167], v[108:111]
s_xor_b32 s64, s65, 72704
s_cmpk_gt_u32 s69, 103
s_waitcnt vmcnt(6)
s_cbranch_scc1 L_d_110
s_waitcnt vmcnt(5)
L_d_110:
buffer_load_dwordx4 v[216:219], v1, s[44:47], s64 offen nt
v_and_b32_dpp v104, v15, v4 row_newbcast:4 row_mask:0xf bank_mask:0xf
v_and_b32_dpp v105, v15, v5 row_newbcast:4 row_mask:0xf bank_mask:0xf
v_and_b32_dpp v106, v15, v6 row_newbcast:4 row_mask:0xf bank_mask:0xf
v_and_b32_dpp v107, v15, v7 row_newbcast:4 row_mask:0xf bank_mask:0xf
v_mfma_f32_16x16x32_bf16 v[108:111], v[100:103], v[188:191], v[108:111]
s_xor_b32 s64, s65, 36864
s_cmpk_gt_u32 s69, 104
s_waitcnt vmcnt(6)
s_cbranch_scc1 L_d_111
s_waitcnt vmcnt(5)
L_d_111:
buffer_load_dwordx4 v[220:223], v1, s[44:47], s64 offen nt
v_and_b32_dpp v100, v15, v4 row_newbcast:8 row_mask:0xf bank_mask:0xf
v_and_b32_dpp v101, v15, v5 row_newbcast:8 row_mask:0xf bank_mask:0xf
v_and_b32_dpp v102, v15, v6 row_newbcast:8 row_mask:0xf bank_mask:0xf
v_and_b32_dpp v103, v15, v7 row_newbcast:8 row_mask:0xf bank_mask:0xf
v_mfma_f32_16x16x32_bf16 v[108:111], v[104:107], v[192:195], v[108:111]
s_xor_b32 s64, s65, 102400
s_cmpk_gt_u32 s69, 105
s_waitcnt vmcnt(6)
s_cbranch_scc1 L_d_112
s_waitcnt vmcnt(5)
L_d_112:
buffer_load_dwordx4 v[224:227], v1, s[44:47], s64 offen nt
v_and_b32_dpp v104, v15, v4 row_newbcast:12 row_mask:0xf bank_mask:0xf
v_and_b32_dpp v105, v15, v5 row_newbcast:12 row_mask:0xf bank_mask:0xf
v_and_b32_dpp v106, v15, v6 row_newbcast:12 row_mask:0xf bank_mask:0xf
v_and_b32_dpp v107, v15, v7 row_newbcast:12 row_mask:0xf bank_mask:0xf
v_mfma_f32_16x16x32_bf16 v[108:111], v[100:103], v[196:199], v[108:111]
s_xor_b32 s64, s65, 38912
s_cmpk_gt_u32 s69, 106
s_waitcnt vmcnt(6)
s_cbranch_scc1 L_d_113
s_waitcnt vmcnt(5)
L_d_113:
buffer_load_dwordx4 v[228:231], v1, s[44:47], s64 offen nt
v_and_b32_dpp v100, v16, v4 row_newbcast:0 row_mask:0xf bank_mask:0xf
v_and_b32_dpp v101, v16, v5 row_newbcast:0 row_mask:0xf bank_mask:0xf
v_and_b32_dpp v102, v16, v6 row_newbcast:0 row_mask:0xf bank_mask:0xf
v_and_b32_dpp v103, v16, v7 row_newbcast:0 row_mask:0xf bank_mask:0xf
v_mfma_f32_16x16x32_bf16 v[108:111], v[104:107], v[200:203], v[108:111]
s_xor_b32 s64, s65, 104448
s_cmpk_gt_u32 s69, 107
s_waitcnt vmcnt(6)
s_cbranch_scc1 L_d_114
s_waitcnt vmcnt(5)
L_d_114:
buffer_load_dwordx4 v[232:235], v1, s[44:47], s64 offen nt
v_and_b32_dpp v104, v16, v4 row_newbcast:4 row_mask:0xf bank_mask:0xf
v_and_b32_dpp v105, v16, v5 row_newbcast:4 row_mask:0xf bank_mask:0xf
v_and_b32_dpp v106, v16, v6 row_newbcast:4 row_mask:0xf bank_mask:0xf
v_and_b32_dpp v107, v16, v7 row_newbcast:4 row_mask:0xf bank_mask:0xf
v_mfma_f32_16x16x32_bf16 v[108:111], v[100:103], v[204:207], v[108:111]
s_xor_b32 s64, s65, 37888
s_cmpk_gt_u32 s69, 108
s_waitcnt vmcnt(6)
s_cbranch_scc1 L_d_115
s_waitcnt vmcnt(5)
L_d_115:
buffer_load_dwordx4 v[236:239], v1, s[44:47], s64 offen nt
v_and_b32_dpp v100, v16, v4 row_newbcast:8 row_mask:0xf bank_mask:0xf
v_and_b32_dpp v101, v16, v5 row_newbcast:8 row_mask:0xf bank_mask:0xf
v_and_b32_dpp v102, v16, v6 row_newbcast:8 row_mask:0xf bank_mask:0xf
v_and_b32_dpp v103, v16, v7 row_newbcast:8 row_mask:0xf bank_mask:0xf
v_mfma_f32_16x16x32_bf16 v[108:111], v[104:107], v[208:211], v[108:111]
s_xor_b32 s64, s65, 103424
s_cmpk_gt_u32 s69, 109
s_waitcnt vmcnt(6)
s_cbranch_scc1 L_d_116
s_waitcnt vmcnt(5)
L_d_116:
buffer_load_dwordx4 v[240:243], v1, s[44:47], s64 offen nt
v_and_b32_dpp v104, v16, v4 row_newbcast:12 row_mask:0xf bank_mask:0xf
v_and_b32_dpp v105, v16, v5 row_newbcast:12 row_mask:0xf bank_mask:0xf
v_and_b32_dpp v106, v16, v6 row_newbcast:12 row_mask:0xf bank_mask:0xf
v_and_b32_dpp v107, v16, v7 row_newbcast:12 row_mask:0xf bank_mask:0xf
v_mfma_f32_16x16x32_bf16 v[108:111], v[100:103], v[212:215], v[108:111]
s_cmp_eq_u32 s34, 2
s_cbranch_scc0 L_w_118
v_mov_b32 v124, 46
s_mov_b64 exec, 1
buffer_store_dword v124, off, s[36:39], s63 offset:0
s_mov_b64 exec, -1
L_w_118:
s_xor_b32 s64, s65, 39936
s_cmpk_gt_u32 s69, 110
s_waitcnt vmcnt(6)
s_cbranch_scc1 L_d_117
s_waitcnt vmcnt(5)
L_d_117:
buffer_load_dwordx4 v[244:247], v1, s[44:47], s64 offen nt
v_and_b32_dpp v100, v18, v4 row_newbcast:0 row_mask:0xf bank_mask:0xf
v_and_b32_dpp v101, v18, v5 row_newbcast:0 row_mask:0xf bank_mask:0xf
v_and_b32_dpp v102, v18, v6 row_newbcast:0 row_mask:0xf bank_mask:0xf
v_and_b32_dpp v103, v18, v7 row_newbcast:0 row_mask:0xf bank_mask:0xf
v_mfma_f32_16x16x32_bf16 v[108:111], v[104:107], v[216:219], v[108:111]
s_xor_b32 s64, s65, 105472
s_cmpk_gt_u32 s69, 111
s_waitcnt vmcnt(6)
s_cbranch_scc1 L_d_119
s_waitcnt vmcnt(5)
L_d_119:
buffer_load_dwordx4 v[248:251], v1, s[44:47], s64 offen nt
v_and_b32_dpp v104, v18, v4 row_newbcast:4 row_mask:0xf bank_mask:0xf
v_and_b32_dpp v105, v18, v5 row_newbcast:4 row_mask:0xf bank_mask:0xf
v_and_b32_dpp v106, v18, v6 row_newbcast:4 row_mask:0xf bank_mask:0xf
v_and_b32_dpp v107, v18, v7 row_newbcast:4 row_mask:0xf bank_mask:0xf
v_mfma_f32_16x16x32_bf16 v[108:111], v[100:103], v[220:223], v[108:111]
s_xor_b32 s64, s65, 135168
s_waitcnt vmcnt(5)
buffer_load_dwordx4 v[252:255], v1, s[44:47], s64 offen nt
v_and_b32_dpp v100, v18, v4 row_newbcast:8 row_mask:0xf bank_mask:0xf
v_and_b32_dpp v101, v18, v5 row_newbcast:8 row_mask:0xf bank_mask:0xf
v_and_b32_dpp v102, v18, v6 row_newbcast:8 row_mask:0xf bank_mask:0xf
v_and_b32_dpp v103, v18, v7 row_newbcast:8 row_mask:0xf bank_mask:0xf
v_mfma_f32_16x16x32_bf16 v[108:111], v[104:107], v[224:227], v[108:111]
v_and_b32_dpp v104, v18, v4 row_newbcast:12 row_mask:0xf bank_mask:0xf
v_and_b32_dpp v105, v18, v5 row_newbcast:12 row_mask:0xf bank_mask:0xf
v_and_b32_dpp v106, v18, v6 row_newbcast:12 row_mask:0xf bank_mask:0xf
v_and_b32_dpp v107, v18, v7 row_newbcast:12 row_mask:0xf bank_mask:0xf
v_mfma_f32_16x16x32_bf16 v[108:111], v[100:103], v[228:231], v[108:111]
s_xor_b32 s64, s65, 200704
s_waitcnt vmcnt(5)
buffer_load_dwordx4 v[84:87], v1, s[44:47], s64 offen nt
v_and_b32_dpp v100, v19, v4 row_newbcast:0 row_mask:0xf bank_mask:0xf
v_and_b32_dpp v101, v19, v5 row_newbcast:0 row_mask:0xf bank_mask:0xf
v_and_b32_dpp v102, v19, v6 row_newbcast:0 row_mask:0xf bank_mask:0xf
v_and_b32_dpp v103, v19, v7 row_newbcast:0 row_mask:0xf bank_mask:0xf
v_mfma_f32_16x16x32_bf16 v[108:111], v[104:107], v[232:235], v[108:111]
s_xor_b32 s64, s65, 137216
s_waitcnt vmcnt(5)
buffer_load_dwordx4 v[88:91], v1, s[44:47], s64 offen nt
v_and_b32_dpp v104, v19, v4 row_newbcast:4 row_mask:0xf bank_mask:0xf
v_and_b32_dpp v105, v19, v5 row_newbcast:4 row_mask:0xf bank_mask:0xf
v_and_b32_dpp v106, v19, v6 row_newbcast:4 row_mask:0xf bank_mask:0xf
v_and_b32_dpp v107, v19, v7 row_newbcast:4 row_mask:0xf bank_mask:0xf
v_mfma_f32_16x16x32_bf16 v[108:111], v[100:103], v[236:239], v[108:111]
s_xor_b32 s64, s65, 202752
s_waitcnt vmcnt(5)
buffer_load_dwordx4 v[132:135], v1, s[44:47], s64 offen nt
v_and_b32_dpp v100, v19, v4 row_newbcast:8 row_mask:0xf bank_mask:0xf
v_and_b32_dpp v101, v19, v5 row_newbcast:8 row_mask:0xf bank_mask:0xf
v_and_b32_dpp v102, v19, v6 row_newbcast:8 row_mask:0xf bank_mask:0xf
v_and_b32_dpp v103, v19, v7 row_newbcast:8 row_mask:0xf bank_mask:0xf
v_mfma_f32_16x16x32_bf16 v[108:111], v[104:107], v[240:243], v[108:111]
s_xor_b32 s64, s65, 136192
s_waitcnt vmcnt(5)
buffer_load_dwordx4 v[136:139], v1, s[44:47], s64 offen nt
v_and_b32_dpp v104, v19, v4 row_newbcast:12 row_mask:0xf bank_mask:0xf
v_and_b32_dpp v105, v19, v5 row_newbcast:12 row_mask:0xf bank_mask:0xf
v_and_b32_dpp v106, v19, v6 row_newbcast:12 row_mask:0xf bank_mask:0xf
v_and_b32_dpp v107, v19, v7 row_newbcast:12 row_mask:0xf bank_mask:0xf
v_mfma_f32_16x16x32_bf16 v[108:111], v[100:103], v[244:247], v[108:111]
s_xor_b32 s64, s65, 201728
s_waitcnt vmcnt(5)
buffer_load_dwordx4 v[140:143], v1, s[44:47], s64 offen nt
v_and_b32_dpp v100, v20, v4 row_newbcast:0 row_mask:0xf bank_mask:0xf
v_and_b32_dpp v101, v20, v5 row_newbcast:0 row_mask:0xf bank_mask:0xf
v_and_b32_dpp v102, v20, v6 row_newbcast:0 row_mask:0xf bank_mask:0xf
v_and_b32_dpp v103, v20, v7 row_newbcast:0 row_mask:0xf bank_mask:0xf
v_mfma_f32_16x16x32_bf16 v[108:111], v[104:107], v[248:251], v[108:111]
s_cmp_eq_u32 s34, 3
s_cbranch_scc0 L_w_120
v_mov_b32 v124, 54
s_mov_b64 exec, 1
buffer_store_dword v124, off, s[36:39], s63 offset:0
s_mov_b64 exec, -1
L_w_120:
s_xor_b32 s64, s65, 138240
s_waitcnt vmcnt(5)
buffer_load_dwordx4 v[144:147], v1, s[44:47], s64 offen nt
v_and_b32_dpp v104, v20, v4 row_newbcast:4 row_mask:0xf bank_mask:0xf
v_and_b32_dpp v105, v20, v5 row_newbcast:4 row_mask:0xf bank_mask:0xf
v_and_b32_dpp v106, v20, v6 row_newbcast:4 row_mask:0xf bank_mask:0xf
v_and_b32_dpp v107, v20, v7 row_newbcast:4 row_mask:0xf bank_mask:0xf
v_mfma_f32_16x16x32_bf16 v[108:111], v[100:103], v[252:255], v[108:111]
s_xor_b32 s64, s65, 203776
s_waitcnt vmcnt(5)
buffer_load_dwordx4 v[148:151], v1, s[44:47], s64 offen nt
v_and_b32_dpp v100, v20, v4 row_newbcast:8 row_mask:0xf bank_mask:0xf
v_and_b32_dpp v101, v20, v5 row_newbcast:8 row_mask:0xf bank_mask:0xf
v_and_b32_dpp v102, v20, v6 row_newbcast:8 row_mask:0xf bank_mask:0xf
v_and_b32_dpp v103, v20, v7 row_newbcast:8 row_mask:0xf bank_mask:0xf
v_mfma_f32_16x16x32_bf16 v[108:111], v[104:107], v[84:87], v[108:111]
s_xor_b32 s64, s65, 167936
s_waitcnt vmcnt(7)
buffer_load_dwordx4 v[152:155], v1, s[44:47], s64 offen nt
s_xor_b32 s64, s65, 233472
s_waitcnt vmcnt(7)
buffer_load_dwordx4 v[156:159], v1, s[44:47], s64 offen nt
s_cmp_lt_u32 s2, 208
s_cbranch_scc0 L_hp_121
v_lshlrev_b32 v160, 2, v0
buffer_load_dword v161, v160, s[36:39], s62 offen offset:0 sc1
L_hp_121:
s_xor_b32 s64, s65, 169984
s_waitcnt vmcnt(7)
buffer_load_dwordx4 v[176:179], v1, s[44:47], s64 offen nt
v_and_b32_dpp v104, v20, v4 row_newbcast:12 row_mask:0xf bank_mask:0xf
v_and_b32_dpp v105, v20, v5 row_newbcast:12 row_mask:0xf bank_mask:0xf
v_and_b32_dpp v106, v20, v6 row_newbcast:12 row_mask:0xf bank_mask:0xf
v_and_b32_dpp v107, v20, v7 row_newbcast:12 row_mask:0xf bank_mask:0xf
v_mfma_f32_16x16x32_bf16 v[108:111], v[100:103], v[88:91], v[108:111]
s_xor_b32 s64, s65, 235520
s_waitcnt vmcnt(7)
buffer_load_dwordx4 v[180:183], v1, s[44:47], s64 offen nt
v_and_b32_dpp v100, v21, v4 row_newbcast:0 row_mask:0xf bank_mask:0xf
v_and_b32_dpp v101, v21, v5 row_newbcast:0 row_mask:0xf bank_mask:0xf
v_and_b32_dpp v102, v21, v6 row_newbcast:0 row_mask:0xf bank_mask:0xf
v_and_b32_dpp v103, v21, v7 row_newbcast:0 row_mask:0xf bank_mask:0xf
v_mfma_f32_16x16x32_bf16 v[108:111], v[104:107], v[132:135], v[108:111]
s_xor_b32 s64, s65, 168960
s_waitcnt vmcnt(7)
buffer_load_dwordx4 v[184:187], v1, s[44:47], s64 offen nt
v_and_b32_dpp v104, v21, v4 row_newbcast:4 row_mask:0xf bank_mask:0xf
v_and_b32_dpp v105, v21, v5 row_newbcast:4 row_mask:0xf bank_mask:0xf
v_and_b32_dpp v106, v21, v6 row_newbcast:4 row_mask:0xf bank_mask:0xf
v_and_b32_dpp v107, v21, v7 row_newbcast:4 row_mask:0xf bank_mask:0xf
v_mfma_f32_16x16x32_bf16 v[108:111], v[100:103], v[136:139], v[108:111]
s_xor_b32 s64, s65, 234496
s_waitcnt vmcnt(7)
buffer_load_dwordx4 v[24:27], v1, s[44:47], s64 offen nt
v_and_b32_dpp v100, v21, v4 row_newbcast:8 row_mask:0xf bank_mask:0xf
v_and_b32_dpp v101, v21, v5 row_newbcast:8 row_mask:0xf bank_mask:0xf
v_and_b32_dpp v102, v21, v6 row_newbcast:8 row_mask:0xf bank_mask:0xf
v_and_b32_dpp v103, v21, v7 row_newbcast:8 row_mask:0xf bank_mask:0xf
v_mfma_f32_16x16x32_bf16 v[108:111], v[104:107], v[140:143], v[108:111]
s_cmp_eq_u32 s34, 0
s_cbranch_scc0 L_w_122
v_mov_b32 v124, 62
s_mov_b64 exec, 1
buffer_store_dword v124, off, s[36:39], s63 offset:0
s_mov_b64 exec, -1
L_w_122:
s_xor_b32 s64, s65, 171008
s_waitcnt vmcnt(7)
buffer_load_dwordx4 v[28:31], v1, s[44:47], s64 offen nt
v_and_b32_dpp v104, v21, v4 row_newbcast:12 row_mask:0xf bank_mask:0xf
v_and_b32_dpp v105, v21, v5 row_newbcast:12 row_mask:0xf bank_mask:0xf
v_and_b32_dpp v106, v21, v6 row_newbcast:12 row_mask:0xf bank_mask:0xf
v_and_b32_dpp v107, v21, v7 row_newbcast:12 row_mask:0xf bank_mask:0xf
v_mfma_f32_16x16x32_bf16 v[108:111], v[100:103], v[144:147], v[108:111]
s_xor_b32 s64, s65, 236544
s_waitcnt vmcnt(7)
buffer_load_dwordx4 v[32:35], v1, s[44:47], s64 offen nt
v_and_b32_dpp v100, v22, v4 row_newbcast:0 row_mask:0xf bank_mask:0xf
v_and_b32_dpp v101, v22, v5 row_newbcast:0 row_mask:0xf bank_mask:0xf
v_and_b32_dpp v102, v22, v6 row_newbcast:0 row_mask:0xf bank_mask:0xf
v_and_b32_dpp v103, v22, v7 row_newbcast:0 row_mask:0xf bank_mask:0xf
v_mfma_f32_16x16x32_bf16 v[108:111], v[104:107], v[148:151], v[108:111]
s_cmp_lt_u32 s2, 208
s_cbranch_scc0 L_nohelp
v_lshrrev_b32 v172, 3, v0
v_sub_u32 v172, 63, v172
v_and_b32 v168, 7, v0
v_lshlrev_b32 v168, 7, v168
v_bfe_u32 v162, v172, 0, 1
v_lshl_or_b32 v168, v162, 16, v168
v_bfe_u32 v162, v172, 1, 1
v_lshl_or_b32 v168, v162, 11, v168
v_bfe_u32 v162, v172, 2, 1
v_lshl_or_b32 v168, v162, 10, v168
v_bfe_u32 v162, v172, 3, 1
v_lshl_or_b32 v168, v162, 15, v168
v_bfe_u32 v162, v172, 4, 1
v_lshl_or_b32 v168, v162, 17, v168
v_bfe_u32 v162, v172, 5, 1
v_lshl_or_b32 v168, v162, 12, v168
v_lshrrev_b32 v173, 3, v0
v_sub_u32 v173, 55, v173
v_and_b32 v169, 7, v0
v_lshlrev_b32 v169, 7, v169
v_bfe_u32 v162, v173, 0, 1
v_lshl_or_b32 v169, v162, 16, v169
v_bfe_u32 v162, v173, 1, 1
v_lshl_or_b32 v169, v162, 11, v169
v_bfe_u32 v162, v173, 2, 1
v_lshl_or_b32 v169, v162, 10, v169
v_bfe_u32 v162, v173, 3, 1
v_lshl_or_b32 v169, v162, 15, v169
v_bfe_u32 v162, v173, 4, 1
v_lshl_or_b32 v169, v162, 17, v169
v_bfe_u32 v162, v173, 5, 1
v_lshl_or_b32 v169, v162, 12, v169
s_lshr_b32 s71, s2, 3
v_subrev_u32 v163, s71, v0
v_and_b32 v163, 31, v163
s_waitcnt vmcnt(6)
v_mov_b32 v162, v161
s_nop 1
v_permlane32_swap_b32 v161, v162
v_add_u32 v161, 1, v161
v_max_u32 v161, 23, v161
v_cmp_eq_u32 vcc, -1, v162
v_mov_b32 v160, 0xff
s_nop 0
v_cndmask_b32 v161, v160, v161, vcc
v_lshl_or_b32 v161, v161, 5, v163
s_nop 1
v_min_u32_dpp v161, v161, v161 quad_perm:[1,0,3,2] row_mask:0xf bank_mask:0xf
s_nop 1
v_min_u32_dpp v161, v161, v161 quad_perm:[2,3,0,1] row_mask:0xf bank_mask:0xf
s_nop 1
v_min_u32_dpp v161, v161, v161 row_ror:4 row_mask:0xf bank_mask:0xf
s_nop 1
v_min_u32_dpp v161, v161, v161 row_ror:8 row_mask:0xf bank_mask:0xf
s_nop 1
v_readlane_b32 s76, v161, 0
v_readlane_b32 s66, v161, 16
s_min_u32 s76, s76, s66
s_lshr_b32 s66, s76, 5
s_cmp_lt_u32 s66, 50
s_cbranch_scc0 L_drain
s_mov_b32 s48, s8
s_mov_b32 s49, s9
s_mov_b32 s50, 0x10000000
s_mov_b32 s51, 0x20000
s_lshr_b32 s64, s2, 3
s_add_u32 s76, s76, s64
s_and_b32 s76, s76, 31
s_lshl_b32 s67, s76, 2
s_add_u32 s67, s67, s62
s_lshl_b32 s76, s76, 3
s_and_b32 s64, s2, 7
s_or_b32 s76, s76, s64
s_and_b32 s64, s34, 1
s_lshl_b32 s64, s64, 14
s_lshr_b32 s71, s34, 1
s_lshl_b32 s71, s71, 13
s_or_b32 s64, s64, s71
s_lshl_b32 s71, s76, 10
s_xor_b32 s64, s64, s71
s_or_b32 s64, s64, 0xC0000
s_lshl_b32 s76, s76, 20
s_xor_b32 s76, s76, s64
s_add_u32 s66, s66, 11
v_xor_b32 v169, s76, v169
v_cmp_lt_u32 vcc, s66, v173
s_or_b64 exec, vcc, 1
buffer_load_dword v171, v169, s[48:51], 0 offen
s_mov_b64 exec, -1
v_xor_b32 v168, s76, v168
v_cmp_lt_u32 vcc, s66, v172
s_or_b64 exec, vcc, 1
buffer_load_dword v170, v168, s[48:51], 0 offen
s_mov_b64 exec, -1
s_mov_b64 exec, 1
buffer_store_dword v1, off, s[36:39], s67 offset:128
s_mov_b64 exec, -1
s_waitcnt vmcnt(10)
v_and_b32_dpp v104, v22, v4 row_newbcast:4 row_mask:0xf bank_mask:0xf
v_and_b32_dpp v105, v22, v5 row_newbcast:4 row_mask:0xf bank_mask:0xf
v_and_b32_dpp v106, v22, v6 row_newbcast:4 row_mask:0xf bank_mask:0xf
v_and_b32_dpp v107, v22, v7 row_newbcast:4 row_mask:0xf bank_mask:0xf
v_mfma_f32_16x16x32_bf16 v[108:111], v[100:103], v[152:155], v[108:111]
s_waitcnt vmcnt(9)
v_and_b32_dpp v100, v22, v4 row_newbcast:8 row_mask:0xf bank_mask:0xf
v_and_b32_dpp v101, v22, v5 row_newbcast:8 row_mask:0xf bank_mask:0xf
v_and_b32_dpp v102, v22, v6 row_newbcast:8 row_mask:0xf bank_mask:0xf
v_and_b32_dpp v103, v22, v7 row_newbcast:8 row_mask:0xf bank_mask:0xf
v_mfma_f32_16x16x32_bf16 v[108:111], v[104:107], v[156:159], v[108:111]
s_waitcnt vmcnt(8)
v_and_b32_dpp v104, v22, v4 row_newbcast:12 row_mask:0xf bank_mask:0xf
v_and_b32_dpp v105, v22, v5 row_newbcast:12 row_mask:0xf bank_mask:0xf
v_and_b32_dpp v106, v22, v6 row_newbcast:12 row_mask:0xf bank_mask:0xf
v_and_b32_dpp v107, v22, v7 row_newbcast:12 row_mask:0xf bank_mask:0xf
v_mfma_f32_16x16x32_bf16 v[108:111], v[100:103], v[176:179], v[108:111]
s_waitcnt vmcnt(7)
v_and_b32_dpp v100, v23, v4 row_newbcast:0 row_mask:0xf bank_mask:0xf
v_and_b32_dpp v101, v23, v5 row_newbcast:0 row_mask:0xf bank_mask:0xf
v_and_b32_dpp v102, v23, v6 row_newbcast:0 row_mask:0xf bank_mask:0xf
v_and_b32_dpp v103, v23, v7 row_newbcast:0 row_mask:0xf bank_mask:0xf
v_mfma_f32_16x16x32_bf16 v[108:111], v[104:107], v[180:183], v[108:111]
s_waitcnt vmcnt(6)
v_and_b32_dpp v104, v23, v4 row_newbcast:4 row_mask:0xf bank_mask:0xf
v_and_b32_dpp v105, v23, v5 row_newbcast:4 row_mask:0xf bank_mask:0xf
v_and_b32_dpp v106, v23, v6 row_newbcast:4 row_mask:0xf bank_mask:0xf
v_and_b32_dpp v107, v23, v7 row_newbcast:4 row_mask:0xf bank_mask:0xf
v_mfma_f32_16x16x32_bf16 v[108:111], v[100:103], v[184:187], v[108:111]
s_waitcnt vmcnt(5)
v_and_b32_dpp v100, v23, v4 row_newbcast:8 row_mask:0xf bank_mask:0xf
v_and_b32_dpp v101, v23, v5 row_newbcast:8 row_mask:0xf bank_mask:0xf
v_and_b32_dpp v102, v23, v6 row_newbcast:8 row_mask:0xf bank_mask:0xf
v_and_b32_dpp v103, v23, v7 row_newbcast:8 row_mask:0xf bank_mask:0xf
v_mfma_f32_16x16x32_bf16 v[108:111], v[104:107], v[24:27], v[108:111]
s_waitcnt vmcnt(4)
v_and_b32_dpp v104, v23, v4 row_newbcast:12 row_mask:0xf bank_mask:0xf
v_and_b32_dpp v105, v23, v5 row_newbcast:12 row_mask:0xf bank_mask:0xf
v_and_b32_dpp v106, v23, v6 row_newbcast:12 row_mask:0xf bank_mask:0xf
v_and_b32_dpp v107, v23, v7 row_newbcast:12 row_mask:0xf bank_mask:0xf
v_mfma_f32_16x16x32_bf16 v[108:111], v[100:103], v[28:31], v[108:111]
s_waitcnt vmcnt(3)
v_mfma_f32_16x16x32_bf16 v[108:111], v[104:107], v[32:35], v[108:111]
s_branch L_drained
L_nohelp:
L_drain:
s_waitcnt vmcnt(7)
v_and_b32_dpp v104, v22, v4 row_newbcast:4 row_mask:0xf bank_mask:0xf
v_and_b32_dpp v105, v22, v5 row_newbcast:4 row_mask:0xf bank_mask:0xf
v_and_b32_dpp v106, v22, v6 row_newbcast:4 row_mask:0xf bank_mask:0xf
v_and_b32_dpp v107, v22, v7 row_newbcast:4 row_mask:0xf bank_mask:0xf
v_mfma_f32_16x16x32_bf16 v[108:111], v[100:103], v[152:155], v[108:111]
s_waitcnt vmcnt(6)
v_and_b32_dpp v100, v22, v4 row_newbcast:8 row_mask:0xf bank_mask:0xf
v_and_b32_dpp v101, v22, v5 row_newbcast:8 row_mask:0xf bank_mask:0xf
v_and_b32_dpp v102, v22, v6 row_newbcast:8 row_mask:0xf bank_mask:0xf
v_and_b32_dpp v103, v22, v7 row_newbcast:8 row_mask:0xf bank_mask:0xf
v_mfma_f32_16x16x32_bf16 v[108:111], v[104:107], v[156:159], v[108:111]
s_waitcnt vmcnt(5)
v_and_b32_dpp v104, v22, v4 row_newbcast:12 row_mask:0xf bank_mask:0xf
v_and_b32_dpp v105, v22, v5 row_newbcast:12 row_mask:0xf bank_mask:0xf
v_and_b32_dpp v106, v22, v6 row_newbcast:12 row_mask:0xf bank_mask:0xf
v_and_b32_dpp v107, v22, v7 row_newbcast:12 row_mask:0xf bank_mask:0xf
v_mfma_f32_16x16x32_bf16 v[108:111], v[100:103], v[176:179], v[108:111]
s_waitcnt vmcnt(4)
v_and_b32_dpp v100, v23, v4 row_newbcast:0 row_mask:0xf bank_mask:0xf
v_and_b32_dpp v101, v23, v5 row_newbcast:0 row_mask:0xf bank_mask:0xf
v_and_b32_dpp v102, v23, v6 row_newbcast:0 row_mask:0xf bank_mask:0xf
v_and_b32_dpp v103, v23, v7 row_newbcast:0 row_mask:0xf bank_mask:0xf
v_mfma_f32_16x16x32_bf16 v[108:111], v[104:107], v[180:183], v[108:111]
s_waitcnt vmcnt(3)
v_and_b32_dpp v104, v23, v4 row_newbcast:4 row_mask:0xf bank_mask:0xf
v_and_b32_dpp v105, v23, v5 row_newbcast:4 row_mask:0xf bank_mask:0xf
v_and_b32_dpp v106, v23, v6 row_newbcast:4 row_mask:0xf bank_mask:0xf
v_and_b32_dpp v107, v23, v7 row_newbcast:4 row_mask:0xf bank_mask:0xf
v_mfma_f32_16x16x32_bf16 v[108:111], v[100:103], v[184:187], v[108:111]
s_waitcnt vmcnt(2)
v_and_b32_dpp v100, v23, v4 row_newbcast:8 row_mask:0xf bank_mask:0xf
v_and_b32_dpp v101, v23, v5 row_newbcast:8 row_mask:0xf bank_mask:0xf
v_and_b32_dpp v102, v23, v6 row_newbcast:8 row_mask:0xf bank_mask:0xf
v_and_b32_dpp v103, v23, v7 row_newbcast:8 row_mask:0xf bank_mask:0xf
v_mfma_f32_16x16x32_bf16 v[108:111], v[104:107], v[24:27], v[108:111]
s_waitcnt vmcnt(1)
v_and_b32_dpp v104, v23, v4 row_newbcast:12 row_mask:0xf bank_mask:0xf
v_and_b32_dpp v105, v23, v5 row_newbcast:12 row_mask:0xf bank_mask:0xf
v_and_b32_dpp v106, v23, v6 row_newbcast:12 row_mask:0xf bank_mask:0xf
v_and_b32_dpp v107, v23, v7 row_newbcast:12 row_mask:0xf bank_mask:0xf
v_mfma_f32_16x16x32_bf16 v[108:111], v[100:103], v[28:31], v[108:111]
s_waitcnt vmcnt(0)
v_mfma_f32_16x16x32_bf16 v[108:111], v[104:107], v[32:35], v[108:111]
L_drained:
v_and_b32 v2, 15, v0
v_lshlrev_b32 v2, 5, v2
v_and_b32 v3, 16, v0
v_add_u32 v2, v2, v3
s_lshl_b32 s68, s34, 9
v_add_u32 v2, s68, v2
s_mov_b32 exec_hi, 0
s_nop 1
ds_write_b128 v2, v[108:111] offset:512
s_mov_b32 exec_hi, -1
v_lshlrev_b32 v1, 4, v0
s_waitcnt lgkmcnt(0)
s_barrier
v_mov_b32 v2, 0
ds_read_b32 v3, v2 offset:328
s_waitcnt lgkmcnt(0)
v_readfirstlane_b32 s35, v3
s_branch L_tail_s
L_fin:
L_end:
s_endpgm
L_code_end:
.section .rodata,"a"
.p2align 6
.amdhsa_kernel adaLN_cond__sliding_block_cached__glu_gated_glu__decode_kernel
  .amdhsa_next_free_vgpr 256
  .amdhsa_next_free_sgpr 102
  .amdhsa_accum_offset 256
  .amdhsa_group_segment_fixed_size 0
  .amdhsa_kernarg_size 112
  .amdhsa_user_sgpr_count 2
  .amdhsa_user_sgpr_kernarg_segment_ptr 1
  .amdhsa_system_sgpr_workgroup_id_x 1
  .amdhsa_float_denorm_mode_32 3
.end_amdhsa_kernel
```

```asm
; @launch grid=(256,1,1) block=(512,1,1) lds=131072
.amdgcn_target "amdgcn-amd-amdhsa--gfx950"
.text
.globl adaLN_cond__sliding_block_cached__glu_gated_glu__decode_kernel
.p2align 8
.type adaLN_cond__sliding_block_cached__glu_gated_glu__decode_kernel,@function
adaLN_cond__sliding_block_cached__glu_gated_glu__decode_kernel:
L_code_begin:
s_load_dwordx16 s[4:19], s[0:1], 0
s_load_dwordx8 s[20:27], s[0:1], 64
s_load_dwordx4 s[28:31], s[0:1], 96
s_cmpk_ge_u32 s2, 256
s_cbranch_scc1 L_end
v_lshrrev_b32 v1, 6, v0
v_and_b32 v0, 63, v0
v_readfirstlane_b32 s3, v1
v_lshlrev_b32 v1, 4, v0
s_lshl_b32 s64, s2, 20
s_add_u32 s64, s64, 0xC0000
s_mov_b32 s42, 0x40000
s_mov_b32 s43, 0x20000
s_and_b32 s34, s3, 3
s_cmp_ge_u32 s3, 4
s_cbranch_scc1 L_helper
s_and_b32 s65, s34, 1
s_lshl_b32 s65, s65, 14
s_lshr_b32 s66, s34, 1
s_lshl_b32 s66, s66, 13
s_or_b32 s65, s65, s66
s_lshl_b32 s66, s2, 10
s_xor_b32 s65, s65, s66
s_waitcnt lgkmcnt(0)
s_add_u32 s40, s6, s64
s_addc_u32 s41, s7, 0
s_add_u32 s44, s8, s64
s_addc_u32 s45, s9, 0
buffer_load_dwordx4 v[8:11], v1, s[40:43], s65 offen nt
s_xor_b32 s64, s65, 65536
buffer_load_dwordx4 v[12:15], v1, s[40:43], s64 offen nt
s_xor_b32 s64, s65, 2048
buffer_load_dwordx4 v[16:19], v1, s[40:43], s64 offen nt
s_xor_b32 s64, s65, 67584
buffer_load_dwordx4 v[20:23], v1, s[40:43], s64 offen nt
s_barrier
s_branch L_srest
L_helper:
s_setprio 2
v_lshlrev_b32 v2, 2, v0
s_cmp_eq_u32 s3, 7
s_cbranch_scc0 L_nopf
s_getpc_b64 s[60:61]
L_pc:
s_lshr_b32 s66, s2, 3
s_lshl_b32 s66, s66, 10
v_add_u32 v10, s66, v1
v_min_u32 v10, L_code_end-L_pc-16, v10
global_load_dwordx4 v[12:15], v10, s[60:61]
v_subrev_u32 v3, 16, v0
v_ashrrev_i32 v3, 31, v3
ds_write_b32 v2, v3 offset:256
L_nopf:
s_and_b32 s67, s2, 7
s_lshr_b32 s68, s2, 3
v_and_b32 v38, 7, v0
v_lshrrev_b32 v37, 3, v0
s_cmp_eq_u32 s34, 0
s_cbranch_scc0 L_p0a
s_mov_b32 s70, 6
s_lshl_b32 s67, s67, 1
s_add_u32 s66, s67, 14
v_min_u32 v38, 5, v38
v_cmp_lt_u32 vcc, 1, v38
v_add_u32 v36, s66, v38
s_nop 0
v_cndmask_b32 v38, v38, v36, vcc
s_branch L_p0b
L_p0a:
s_lshl_b32 s67, s67, 3
s_lshl_b32 s65, s2, 3
s_and_b32 s65, s65, 0xff
s_lshr_b32 s66, s2, 5
s_or_b32 s65, s65, s66
s_cmp_eq_u32 s34, 2
s_cselect_b32 s70, 1, 8
s_cselect_b32 s68, s65, s68
s_cselect_b32 s67, 0, s67
L_p0b:
v_lshl_add_u32 v37, s68, 4, v37
v_mul_u32_u24 v37, s70, v37
v_lshl_add_u32 v38, v37, 3, v38
v_add_lshl_u32 v38, v38, s67, 7
s_lshl_b32 s70, s70, 13
v_add_u32 v39, s70, v38
s_sub_u32 s64, s2, 112
s_cmp_lt_u32 s64, 32
s_waitcnt lgkmcnt(0)
s_barrier
s_cbranch_scc1 L_jan
s_cmp_eq_u32 s34, 3
s_cbranch_scc1 L_p0_123
s_cmp_eq_u32 s34, 0
s_cselect_b32 s62, s24, s10
s_cselect_b32 s63, s25, s11
s_cmp_eq_u32 s34, 2
s_cselect_b32 s62, s12, s62
s_cselect_b32 s63, s13, s63
global_load_dword v12, v38, s[62:63]
global_load_dword v13, v39, s[62:63]
L_p0_123:
L_nop0:
s_cmp_eq_u32 s34, 3
s_cselect_b32 s64, 16, 0
s_cmp_lt_u32 s2, s64
s_cbranch_scc0 L_nopc
v_mov_b32 v4, -1
v_mov_b32 v5, -1
v_mov_b32 v6, -1
v_mov_b32 v7, -1
s_and_b32 s66, s2, 7
s_lshl_b32 s66, s66, 11
s_and_b32 s65, s2, 8
s_lshl_b32 s65, s65, 7
s_add_u32 s66, s66, s65
v_add_u32 v8, s66, v1
global_store_dwordx4 v8, v[4:7], s[30:31] sc1
s_lshl_b32 s66, s2, 2
v_mov_b32 v3, s66
s_waitcnt vmcnt(0)
s_mov_b64 exec, 1
global_store_dword v3, v4, s[28:29] sc1
s_mov_b64 exec, -1
L_nopc:
s_cmp_eq_u32 s34, 3
s_cbranch_scc0 L_w_124
s_and_b32 s67, s2, 7
s_lshr_b32 s68, s2, 3
s_min_u32 s64, s67, 3
s_mul_i32 s65, s67, 5
s_add_u32 s64, s64, s65
s_cmp_lt_u32 s67, 3
s_cselect_b32 s65, 6, 5
L_w_124:
s_lshr_b32 s32, s2, 5
s_and_b32 s33, s2, 31
s_and_b32 s67, s2, 7
s_lshr_b32 s68, s2, 3
s_sub_u32 s68, s68, 26
s_min_u32 s74, s67, 3
s_mul_i32 s66, s67, 5
s_add_u32 s74, s74, s66
s_add_u32 s74, s74, s68
s_cmp_lt_u32 s67, 3
s_cselect_b32 s66, 6, 5
s_cmp_lt_u32 s68, s66
s_cselect_b32 s74, s74, -1
s_cmp_lt_u32 s2, 48
s_cselect_b32 s66, 2, 3
s_cselect_b32 s72, 14+26, 42+26
s_cmp_lt_u32 s2, 16
s_cselect_b32 s66, 1, s66
s_cselect_b32 s72, 26, s72
s_lshl_b32 s66, s67, s66
s_add_u32 s72, s72, s66
s_add_u32 s72, s72, s68
s_mov_b32 s36, s30
s_mov_b32 s37, s31
s_mov_b32 s38, 0x1d0000
s_mov_b32 s39, 0x20000
s_mov_b32 s52, s28
s_mov_b32 s53, s29
s_mov_b32 s54, 0x100
s_mov_b32 s55, 0x20000
v_mov_b32 v9, 1
s_cmp_lt_u32 s2, 112
s_cbranch_scc0 L_norole
L_gemm:
v_and_b32 v16, 7, v0
v_lshlrev_b32 v16, 10, v16
v_and_b32 v17, 8, v0
v_lshl_add_u32 v16, v17, 3, v16
v_and_b32 v17, 48, v0
v_add_u32 v16, v16, v17
s_lshl_b32 s67, s34, 8
v_lshrrev_b32 v19, 3, v0
v_and_b32 v17, 2, v19
v_and_b32 v18, 7, v0
v_xor_b32 v17, v17, v18
v_xor_b32 v18, 4, v17
v_lshlrev_b32 v17, 4, v17
v_lshlrev_b32 v18, 4, v18
s_cmp_lt_u32 s2, 48
s_cbranch_scc0 L_gq0
s_mov_b32 s40, s24
s_mov_b32 s41, s25
s_mov_b32 s42, 0x300000
s_mov_b32 s43, 0x20000
s_mov_b32 s48, s22
s_mov_b32 s49, s23
s_mov_b32 s50, 0x2000
s_mov_b32 s51, 0x20000
s_mov_b32 s70, 6144
s_lshl_b32 s64, s72, 7
s_branch L_g1
L_gq0:
s_mov_b32 s40, s10
s_mov_b32 s41, s11
s_mov_b32 s42, 0x400000
s_mov_b32 s43, 0x20000
s_mov_b32 s48, s4
s_mov_b32 s49, s5
s_mov_b32 s50, 0x2000
s_mov_b32 s51, 0x20000
s_mov_b32 s70, 8192
s_sub_u32 s64, s72, 48
s_lshl_b32 s64, s64, 7
L_g1:
buffer_load_dwordx4 v[192:195], v16, s[48:51], s67 offen offset:0
buffer_load_dwordx4 v[196:199], v16, s[48:51], s67 offen offset:128
v_mul_lo_u32 v19, s70, v19
v_add_u32 v17, v17, v19
v_add_u32 v18, v18, v19
s_lshl_b32 s66, s70, 7
s_mul_i32 s66, s66, s34
s_add_u32 s64, s64, s66
s_lshl_b32 s70, s70, 3
s_lshl_b32 s65, s34, 13
s_add_u32 s65, s65, 4096
s_cmp_lt_u32 s2, 16
s_cselect_b32 s71, 0, 2
s_cmp_ge_u32 s2, 48
s_cselect_b32 s71, 1, s71
s_add_u32 m0, s65, 0
s_nop 0
buffer_load_dwordx4 v17, s[40:43], s64 offen  lds
s_add_u32 s64, s64, s70
s_add_u32 m0, s65, 1024
s_nop 0
buffer_load_dwordx4 v18, s[40:43], s64 offen  lds
s_add_u32 s64, s64, s70
s_cmp_eq_u32 s71, 2
s_cbranch_scc0 L_pace_125
s_waitcnt vmcnt(1)
L_pace_125:
s_add_u32 m0, s65, 2048
s_nop 0
buffer_load_dwordx4 v17, s[40:43], s64 offen  lds
s_add_u32 s64, s64, s70
s_cmp_eq_u32 s71, 0
s_cbranch_scc1 L_pace_126
s_waitcnt vmcnt(2)
s_cmp_eq_u32 s71, 2
s_cbranch_scc0 L_pace_126
s_waitcnt vmcnt(1)
L_pace_126:
s_add_u32 m0, s65, 3072
s_nop 0
buffer_load_dwordx4 v18, s[40:43], s64 offen  lds
s_add_u32 s64, s64, s70
s_cmp_eq_u32 s71, 0
s_cbranch_scc1 L_pace_127
s_waitcnt vmcnt(2)
s_cmp_eq_u32 s71, 2
s_cbranch_scc0 L_pace_127
s_waitcnt vmcnt(1)
L_pace_127:
s_add_u32 m0, s65, 4096
s_nop 0
buffer_load_dwordx4 v17, s[40:43], s64 offen  lds
s_add_u32 s64, s64, s70
s_cmp_eq_u32 s71, 0
s_cbranch_scc1 L_pace_128
s_waitcnt vmcnt(2)
s_cmp_eq_u32 s71, 2
s_cbranch_scc0 L_pace_128
s_waitcnt vmcnt(1)
L_pace_128:
s_add_u32 m0, s65, 5120
s_nop 0
buffer_load_dwordx4 v18, s[40:43], s64 offen  lds
s_add_u32 s64, s64, s70
s_cmp_eq_u32 s71, 0
s_cbranch_scc1 L_pace_129
s_waitcnt vmcnt(2)
s_cmp_eq_u32 s71, 2
s_cbranch_scc0 L_pace_129
s_waitcnt vmcnt(1)
L_pace_129:
s_add_u32 m0, s65, 6144
s_nop 0
buffer_load_dwordx4 v17, s[40:43], s64 offen  lds
s_add_u32 s64, s64, s70
s_cmp_eq_u32 s71, 0
s_cbranch_scc1 L_pace_130
s_waitcnt vmcnt(2)
s_cmp_eq_u32 s71, 2
s_cbranch_scc0 L_pace_130
s_waitcnt vmcnt(1)
L_pace_130:
s_add_u32 m0, s65, 7168
s_nop 0
buffer_load_dwordx4 v18, s[40:43], s64 offen  lds
s_add_u32 s64, s64, s70
s_cmp_eq_u32 s71, 0
s_cbranch_scc1 L_pace_131
s_waitcnt vmcnt(2)
s_cmp_eq_u32 s71, 2
s_cbranch_scc0 L_pace_131
s_waitcnt vmcnt(1)
L_pace_131:
s_add_u32 m0, s65, 32768
s_nop 0
buffer_load_dwordx4 v17, s[40:43], s64 offen  lds
s_add_u32 s64, s64, s70
s_cmp_eq_u32 s71, 0
s_cbranch_scc1 L_pace_132
s_waitcnt vmcnt(2)
s_cmp_eq_u32 s71, 2
s_cbranch_scc0 L_pace_132
s_waitcnt vmcnt(1)
L_pace_132:
s_add_u32 m0, s65, 33792
s_nop 0
buffer_load_dwordx4 v18, s[40:43], s64 offen  lds
s_add_u32 s64, s64, s70
s_cmp_eq_u32 s71, 0
s_cbranch_scc1 L_pace_133
s_waitcnt vmcnt(2)
s_cmp_eq_u32 s71, 2
s_cbranch_scc0 L_pace_133
s_waitcnt vmcnt(1)
L_pace_133:
s_add_u32 m0, s65, 34816
s_nop 0
buffer_load_dwordx4 v17, s[40:43], s64 offen  lds
s_add_u32 s64, s64, s70
s_cmp_eq_u32 s71, 0
s_cbranch_scc1 L_pace_134
s_waitcnt vmcnt(2)
s_cmp_eq_u32 s71, 2
s_cbranch_scc0 L_pace_134
s_waitcnt vmcnt(1)
L_pace_134:
s_add_u32 m0, s65, 35840
s_nop 0
buffer_load_dwordx4 v18, s[40:43], s64 offen  lds
s_add_u32 s64, s64, s70
s_cmp_eq_u32 s71, 0
s_cbranch_scc1 L_pace_135
s_waitcnt vmcnt(2)
s_cmp_eq_u32 s71, 2
s_cbranch_scc0 L_pace_135
s_waitcnt vmcnt(1)
L_pace_135:
s_add_u32 m0, s65, 36864
s_nop 0
buffer_load_dwordx4 v17, s[40:43], s64 offen  lds
s_add_u32 s64, s64, s70
s_cmp_eq_u32 s71, 0
s_cbranch_scc1 L_pace_136
s_waitcnt vmcnt(2)
s_cmp_eq_u32 s71, 2
s_cbranch_scc0 L_pace_136
s_waitcnt vmcnt(1)
L_pace_136:
s_add_u32 m0, s65, 37888
s_nop 0
buffer_load_dwordx4 v18, s[40:43], s64 offen  lds
s_add_u32 s64, s64, s70
s_cmp_eq_u32 s71, 0
s_cbranch_scc1 L_pace_137
s_waitcnt vmcnt(2)
s_cmp_eq_u32 s71, 2
s_cbranch_scc0 L_pace_137
s_waitcnt vmcnt(1)
L_pace_137:
s_add_u32 m0, s65, 38912
s_nop 0
buffer_load_dwordx4 v17, s[40:43], s64 offen  lds
s_add_u32 s64, s64, s70
s_cmp_eq_u32 s71, 0
s_cbranch_scc1 L_pace_138
s_waitcnt vmcnt(2)
s_cmp_eq_u32 s71, 2
s_cbranch_scc0 L_pace_138
s_waitcnt vmcnt(1)
L_pace_138:
s_add_u32 m0, s65, 39936
s_nop 0
buffer_load_dwordx4 v18, s[40:43], s64 offen  lds
s_add_u32 s64, s64, s70
s_waitcnt vmcnt(16)
s_cmp_eq_u32 s34, 0
s_cselect_b32 s73, 48, 0x1000
v_and_b32 v30, 15, v0
v_lshlrev_b32 v30, 2, v30
s_cmp_ge_u32 s2, s73
s_cbranch_scc0 L_fl_139
buffer_load_dword v31, v30, s[52:55], 0 offen sc1
L_fl_139:
s_mov_b32 s68, 0xffff0000
s_cmp_lt_u32 s2, 48
s_cbranch_scc0 L_gq1
s_mov_b32 s66, 0xbfb8aa3b
v_lshlrev_b32 v20, 16, v192
v_and_b32 v21, s68, v192
v_mul_f32 v22, s66, v20
v_mul_f32 v23, s66, v21
v_exp_f32 v22, v22
v_exp_f32 v23, v23
s_nop 0
v_add_f32 v22, 1.0, v22
v_add_f32 v23, 1.0, v23
v_rcp_f32 v22, v22
v_rcp_f32 v23, v23
s_nop 0
v_mul_f32 v20, v20, v22
v_mul_f32 v21, v21, v23
v_cvt_pk_bf16_f32 v48, v20, v21
v_lshlrev_b32 v20, 16, v193
v_and_b32 v21, s68, v193
v_mul_f32 v22, s66, v20
v_mul_f32 v23, s66, v21
v_exp_f32 v22, v22
v_exp_f32 v23, v23
s_nop 0
v_add_f32 v22, 1.0, v22
v_add_f32 v23, 1.0, v23
v_rcp_f32 v22, v22
v_rcp_f32 v23, v23
s_nop 0
v_mul_f32 v20, v20, v22
v_mul_f32 v21, v21, v23
v_cvt_pk_bf16_f32 v49, v20, v21
v_lshlrev_b32 v20, 16, v194
v_and_b32 v21, s68, v194
v_mul_f32 v22, s66, v20
v_mul_f32 v23, s66, v21
v_exp_f32 v22, v22
v_exp_f32 v23, v23
s_nop 0
v_add_f32 v22, 1.0, v22
v_add_f32 v23, 1.0, v23
v_rcp_f32 v22, v22
v_rcp_f32 v23, v23
s_nop 0
v_mul_f32 v20, v20, v22
v_mul_f32 v21, v21, v23
v_cvt_pk_bf16_f32 v50, v20, v21
v_lshlrev_b32 v20, 16, v195
v_and_b32 v21, s68, v195
v_mul_f32 v22, s66, v20
v_mul_f32 v23, s66, v21
v_exp_f32 v22, v22
v_exp_f32 v23, v23
s_nop 0
v_add_f32 v22, 1.0, v22
v_add_f32 v23, 1.0, v23
v_rcp_f32 v22, v22
v_rcp_f32 v23, v23
s_nop 0
v_mul_f32 v20, v20, v22
v_mul_f32 v21, v21, v23
v_cvt_pk_bf16_f32 v51, v20, v21
v_lshlrev_b32 v20, 16, v196
v_and_b32 v21, s68, v196
v_mul_f32 v22, s66, v20
v_mul_f32 v23, s66, v21
v_exp_f32 v22, v22
v_exp_f32 v23, v23
s_nop 0
v_add_f32 v22, 1.0, v22
v_add_f32 v23, 1.0, v23
v_rcp_f32 v22, v22
v_rcp_f32 v23, v23
s_nop 0
v_mul_f32 v20, v20, v22
v_mul_f32 v21, v21, v23
v_cvt_pk_bf16_f32 v52, v20, v21
v_lshlrev_b32 v20, 16, v197
v_and_b32 v21, s68, v197
v_mul_f32 v22, s66, v20
v_mul_f32 v23, s66, v21
v_exp_f32 v22, v22
v_exp_f32 v23, v23
s_nop 0
v_add_f32 v22, 1.0, v22
v_add_f32 v23, 1.0, v23
v_rcp_f32 v22, v22
v_rcp_f32 v23, v23
s_nop 0
v_mul_f32 v20, v20, v22
v_mul_f32 v21, v21, v23
v_cvt_pk_bf16_f32 v53, v20, v21
v_lshlrev_b32 v20, 16, v198
v_and_b32 v21, s68, v198
v_mul_f32 v22, s66, v20
v_mul_f32 v23, s66, v21
v_exp_f32 v22, v22
v_exp_f32 v23, v23
s_nop 0
v_add_f32 v22, 1.0, v22
v_add_f32 v23, 1.0, v23
v_rcp_f32 v22, v22
v_rcp_f32 v23, v23
s_nop 0
v_mul_f32 v20, v20, v22
v_mul_f32 v21, v21, v23
v_cvt_pk_bf16_f32 v54, v20, v21
v_lshlrev_b32 v20, 16, v199
v_and_b32 v21, s68, v199
v_mul_f32 v22, s66, v20
v_mul_f32 v23, s66, v21
v_exp_f32 v22, v22
v_exp_f32 v23, v23
s_nop 0
v_add_f32 v22, 1.0, v22
v_add_f32 v23, 1.0, v23
v_rcp_f32 v22, v22
v_rcp_f32 v23, v23
s_nop 0
v_mul_f32 v20, v20, v22
v_mul_f32 v21, v21, v23
v_cvt_pk_bf16_f32 v55, v20, v21
s_branch L_g2
L_gq1:
v_and_b32 v32, 7, v0
v_lshlrev_b32 v32, 2, v32
v_lshlrev_b32 v96, 16, v192
v_and_b32 v97, s68, v192
v_lshlrev_b32 v98, 16, v193
v_and_b32 v99, s68, v193
v_lshlrev_b32 v100, 16, v194
v_and_b32 v101, s68, v194
v_lshlrev_b32 v102, 16, v195
v_and_b32 v103, s68, v195
v_lshlrev_b32 v104, 16, v196
v_and_b32 v105, s68, v196
v_lshlrev_b32 v106, 16, v197
v_and_b32 v107, s68, v197
v_lshlrev_b32 v108, 16, v198
v_and_b32 v109, s68, v198
v_lshlrev_b32 v110, 16, v199
v_and_b32 v111, s68, v199
v_add_f32 v20, v96, v97
v_add_f32 v20, v20, v98
v_add_f32 v20, v20, v99
v_add_f32 v20, v20, v100
v_add_f32 v20, v20, v101
v_add_f32 v20, v20, v102
v_add_f32 v20, v20, v103
v_add_f32 v20, v20, v104
v_add_f32 v20, v20, v105
v_add_f32 v20, v20, v106
v_add_f32 v20, v20, v107
v_add_f32 v20, v20, v108
v_add_f32 v20, v20, v109
v_add_f32 v20, v20, v110
v_add_f32 v20, v20, v111
s_nop 1
v_add_f32_dpp v20, v20, v20 row_ror:8 row_mask:0xf bank_mask:0xf
v_mov_b32 v22, v20
s_nop 1
v_permlane16_swap_b32 v20, v22
s_nop 1
v_add_f32 v20, v20, v22
v_mov_b32 v22, v20
s_nop 1
v_permlane32_swap_b32 v20, v22
s_nop 1
v_add_f32 v20, v20, v22
v_mul_f32 v20, 0x3c000000, v20
v_mov_b32 v21, 0
v_sub_f32 v22, v96, v20
v_fmac_f32 v21, v22, v22
v_sub_f32 v22, v97, v20
v_fmac_f32 v21, v22, v22
v_sub_f32 v22, v98, v20
v_fmac_f32 v21, v22, v22
v_sub_f32 v22, v99, v20
v_fmac_f32 v21, v22, v22
v_sub_f32 v22, v100, v20
v_fmac_f32 v21, v22, v22
v_sub_f32 v22, v101, v20
v_fmac_f32 v21, v22, v22
v_sub_f32 v22, v102, v20
v_fmac_f32 v21, v22, v22
v_sub_f32 v22, v103, v20
v_fmac_f32 v21, v22, v22
v_sub_f32 v22, v104, v20
v_fmac_f32 v21, v22, v22
v_sub_f32 v22, v105, v20
v_fmac_f32 v21, v22, v22
v_sub_f32 v22, v106, v20
v_fmac_f32 v21, v22, v22
v_sub_f32 v22, v107, v20
v_fmac_f32 v21, v22, v22
v_sub_f32 v22, v108, v20
v_fmac_f32 v21, v22, v22
v_sub_f32 v22, v109, v20
v_fmac_f32 v21, v22, v22
v_sub_f32 v22, v110, v20
v_fmac_f32 v21, v22, v22
v_sub_f32 v22, v111, v20
v_fmac_f32 v21, v22, v22
s_nop 1
v_add_f32_dpp v21, v21, v21 row_ror:8 row_mask:0xf bank_mask:0xf
v_mov_b32 v22, v21
s_nop 1
v_permlane16_swap_b32 v21, v22
s_nop 1
v_add_f32 v21, v21, v22
v_mov_b32 v22, v21
s_nop 1
v_permlane32_swap_b32 v21, v22
s_nop 1
v_add_f32 v21, v21, v22
v_lshlrev_b32 v22, 1, v32
s_lshl_b32 s66, s34, 6
v_add_u32 v23, s66, v22
ds_write_b64 v23, v[20:21] offset:0
v_mov_b32 v23, 0
s_waitcnt lgkmcnt(0)
s_mov_b64 exec, 1
ds_add_u32 v23, v9 offset:332
s_mov_b64 exec, -1
s_mov_b32 s75, 0
L_poll_140:
ds_read_b32 v24, v23 offset:332
s_waitcnt lgkmcnt(0)
v_cmp_gt_u32 vcc, 4, v24
s_cbranch_vccz L_pollx_141
s_add_u32 s75, s75, 1
s_cmp_lt_u32 s75, 0x1000000
s_cbranch_scc1 L_poll_140
L_pollx_141:
ds_read_b64 v[112:113], v22 offset:0
ds_read_b64 v[114:115], v22 offset:64
ds_read_b64 v[116:117], v22 offset:128
ds_read_b64 v[118:119], v22 offset:192
s_waitcnt lgkmcnt(0)
v_add_f32 v20, v112, v114
v_add_f32 v21, v116, v118
v_add_f32 v20, v20, v21
v_mul_f32 v20, 0x3e800000, v20
v_add_f32 v24, v113, v115
v_add_f32 v21, v117, v119
v_add_f32 v24, v24, v21
v_mov_b32 v21, 0
v_sub_f32 v22, v112, v20
v_fmac_f32 v21, v22, v22
v_sub_f32 v22, v114, v20
v_fmac_f32 v21, v22, v22
v_sub_f32 v22, v116, v20
v_fmac_f32 v21, v22, v22
v_sub_f32 v22, v118, v20
v_fmac_f32 v21, v22, v22
v_fmac_f32 v24, 0x43000000, v21
v_mul_f32 v24, 0x3b000000, v24
v_cvt_pk_bf16_f32 v24, 0, v24
v_cvt_pk_bf16_f32 v20, 0, v20
v_add_f32 v24, 0x3727c5ac, v24
v_cvt_pk_bf16_f32 v24, 0, v24
v_sqrt_f32 v24, v24
s_nop 0
v_cvt_pk_bf16_f32 v24, 0, v24
v_rcp_f32 v24, v24
s_nop 0
v_sub_f32 v96, v96, v20
v_cvt_pk_bf16_f32 v96, 0, v96
v_mul_f32 v96, v96, v24
v_cvt_pk_bf16_f32 v96, 0, v96
v_sub_f32 v97, v97, v20
v_cvt_pk_bf16_f32 v97, 0, v97
v_mul_f32 v97, v97, v24
v_cvt_pk_bf16_f32 v97, 0, v97
v_sub_f32 v98, v98, v20
v_cvt_pk_bf16_f32 v98, 0, v98
v_mul_f32 v98, v98, v24
v_cvt_pk_bf16_f32 v98, 0, v98
v_sub_f32 v99, v99, v20
v_cvt_pk_bf16_f32 v99, 0, v99
v_mul_f32 v99, v99, v24
v_cvt_pk_bf16_f32 v99, 0, v99
v_sub_f32 v100, v100, v20
v_cvt_pk_bf16_f32 v100, 0, v100
v_mul_f32 v100, v100, v24
v_cvt_pk_bf16_f32 v100, 0, v100
v_sub_f32 v101, v101, v20
v_cvt_pk_bf16_f32 v101, 0, v101
v_mul_f32 v101, v101, v24
v_cvt_pk_bf16_f32 v101, 0, v101
v_sub_f32 v102, v102, v20
v_cvt_pk_bf16_f32 v102, 0, v102
v_mul_f32 v102, v102, v24
v_cvt_pk_bf16_f32 v102, 0, v102
v_sub_f32 v103, v103, v20
v_cvt_pk_bf16_f32 v103, 0, v103
v_mul_f32 v103, v103, v24
v_cvt_pk_bf16_f32 v103, 0, v103
v_sub_f32 v104, v104, v20
v_cvt_pk_bf16_f32 v104, 0, v104
v_mul_f32 v104, v104, v24
v_cvt_pk_bf16_f32 v104, 0, v104
v_sub_f32 v105, v105, v20
v_cvt_pk_bf16_f32 v105, 0, v105
v_mul_f32 v105, v105, v24
v_cvt_pk_bf16_f32 v105, 0, v105
v_sub_f32 v106, v106, v20
v_cvt_pk_bf16_f32 v106, 0, v106
v_mul_f32 v106, v106, v24
v_cvt_pk_bf16_f32 v106, 0, v106
v_sub_f32 v107, v107, v20
v_cvt_pk_bf16_f32 v107, 0, v107
v_mul_f32 v107, v107, v24
v_cvt_pk_bf16_f32 v107, 0, v107
v_sub_f32 v108, v108, v20
v_cvt_pk_bf16_f32 v108, 0, v108
v_mul_f32 v108, v108, v24
v_cvt_pk_bf16_f32 v108, 0, v108
v_sub_f32 v109, v109, v20
v_cvt_pk_bf16_f32 v109, 0, v109
v_mul_f32 v109, v109, v24
v_cvt_pk_bf16_f32 v109, 0, v109
v_sub_f32 v110, v110, v20
v_cvt_pk_bf16_f32 v110, 0, v110
v_mul_f32 v110, v110, v24
v_cvt_pk_bf16_f32 v110, 0, v110
v_sub_f32 v111, v111, v20
v_cvt_pk_bf16_f32 v111, 0, v111
v_mul_f32 v111, v111, v24
v_cvt_pk_bf16_f32 v111, 0, v111
L_g2:
s_cmp_ge_u32 s2, s73
s_cbranch_scc0 L_fl_142
s_waitcnt vmcnt(0)
v_cmp_eq_u32 vcc, 0, v31
s_cbranch_vccz L_fl_142
s_mov_b32 s75, 0
L_poll_143:
buffer_load_dword v31, v30, s[52:55], 0 offen sc1
s_waitcnt vmcnt(0)
v_cmp_eq_u32 vcc, 0, v31
s_cbranch_vccz L_pollx_144
s_sleep 40
s_add_u32 s75, s75, 1
s_cmp_lt_u32 s75, 0x100000
s_cbranch_scc1 L_poll_143
L_pollx_144:
L_fl_142:
v_mov_b32 v20, 0
s_cmp_eq_u32 s34, 0
s_cbranch_scc0 L_w_145
ds_write_b32 v20, v9 offset:324
L_w_145:
v_lshrrev_b32 v18, 4, v0
v_bfe_u32 v19, v0, 2, 2
v_lshrrev_b32 v20, 1, v19
v_and_b32 v21, 1, v18
v_lshl_add_u32 v20, v21, 1, v20
v_lshlrev_b32 v20, 5, v20
v_lshl_add_u32 v20, v18, 10, v20
v_lshl_add_u32 v20, v19, 7, v20
v_and_b32 v21, 3, v0
v_lshl_add_u32 v20, v21, 3, v20
v_add_u32 v40, s65, v20
v_xor_b32 v41, 32, v40
v_xor_b32 v42, 64, v40
v_xor_b32 v43, 96, v40
s_waitcnt vmcnt(12) lgkmcnt(0)
ds_read_b64_tr_b16 v[128:129], v40 offset:0
ds_read_b64_tr_b16 v[130:131], v40 offset:512
ds_read_b64_tr_b16 v[132:133], v41 offset:0
ds_read_b64_tr_b16 v[134:135], v41 offset:512
ds_read_b64_tr_b16 v[136:137], v42 offset:0
ds_read_b64_tr_b16 v[138:139], v42 offset:512
ds_read_b64_tr_b16 v[140:141], v43 offset:0
ds_read_b64_tr_b16 v[142:143], v43 offset:512
s_waitcnt vmcnt(8) lgkmcnt(0)
ds_read_b64_tr_b16 v[144:145], v40 offset:4096
ds_read_b64_tr_b16 v[146:147], v40 offset:4608
ds_read_b64_tr_b16 v[148:149], v41 offset:4096
ds_read_b64_tr_b16 v[150:151], v41 offset:4608
ds_read_b64_tr_b16 v[152:153], v42 offset:4096
ds_read_b64_tr_b16 v[154:155], v42 offset:4608
ds_read_b64_tr_b16 v[156:157], v43 offset:4096
ds_read_b64_tr_b16 v[158:159], v43 offset:4608
s_waitcnt vmcnt(4) lgkmcnt(0)
ds_read_b64_tr_b16 v[160:161], v40 offset:32768
ds_read_b64_tr_b16 v[162:163], v40 offset:33280
ds_read_b64_tr_b16 v[164:165], v41 offset:32768
ds_read_b64_tr_b16 v[166:167], v41 offset:33280
ds_read_b64_tr_b16 v[168:169], v42 offset:32768
ds_read_b64_tr_b16 v[170:171], v42 offset:33280
ds_read_b64_tr_b16 v[172:173], v43 offset:32768
ds_read_b64_tr_b16 v[174:175], v43 offset:33280
s_waitcnt vmcnt(0) lgkmcnt(0)
ds_read_b64_tr_b16 v[176:177], v40 offset:36864
ds_read_b64_tr_b16 v[178:179], v40 offset:37376
ds_read_b64_tr_b16 v[180:181], v41 offset:36864
ds_read_b64_tr_b16 v[182:183], v41 offset:37376
ds_read_b64_tr_b16 v[184:185], v42 offset:36864
ds_read_b64_tr_b16 v[186:187], v42 offset:37376
ds_read_b64_tr_b16 v[188:189], v43 offset:36864
ds_read_b64_tr_b16 v[190:191], v43 offset:37376
s_waitcnt lgkmcnt(0)
s_cmp_eq_u32 s34, 2
s_cselect_b32 s73, 16, 0x1000
v_and_b32 v30, 31, v0
v_lshlrev_b32 v30, 2, v30
s_cmp_ge_u32 s2, s73
s_cbranch_scc0 L_fl_146
buffer_load_dword v31, v30, s[52:55], 0 offen offset:128 sc1
L_fl_146:
s_cmp_lt_u32 s2, 48
s_cbranch_scc1 L_g3
v_mov_b32 v20, 0
s_mov_b32 s75, 0
L_poll_147:
ds_read_b32 v22, v20 offset:324
s_waitcnt lgkmcnt(0)
v_cmp_eq_u32 vcc, 0, v22
s_cbranch_vccz L_pollx_148
s_sleep 1
s_add_u32 s75, s75, 1
s_cmp_lt_u32 s75, 0x1000000
s_cbranch_scc1 L_poll_147
L_pollx_148:
s_lshl_b32 s64, s34, 11
s_add_u32 s64, s64, 0
s_add_u32 s66, s64, 8192
s_mov_b32 s75, 0
L_poll_149:
buffer_load_dwordx4 v[192:195], v1, s[36:39], s64 offen offset:0 sc1
buffer_load_dwordx4 v[200:203], v1, s[36:39], s66 offen offset:0 sc1
buffer_load_dwordx4 v[196:199], v1, s[36:39], s64 offen offset:1024 sc1
buffer_load_dwordx4 v[204:207], v1, s[36:39], s66 offen offset:1024 sc1
s_waitcnt vmcnt(0)
v_max3_u32 v22, v192, v193, v194
v_max3_u32 v22, v22, v195, v196
v_max3_u32 v22, v22, v197, v198
v_max3_u32 v22, v22, v199, v200
v_max3_u32 v22, v22, v201, v202
v_max3_u32 v22, v22, v203, v204
v_max3_u32 v22, v22, v205, v206
v_max_u32 v22, v22, v207
v_cmp_eq_u32 vcc, -1, v22
s_cbranch_vccz L_pollx_150
s_sleep 16
s_add_u32 s75, s75, 1
s_cmp_lt_u32 s75, 0x100000
s_cbranch_scc1 L_poll_149
L_pollx_150:
v_lshlrev_b32 v20, 16, v200
v_and_b32 v21, s68, v200
v_add_f32 v20, 1.0, v20
v_add_f32 v21, 1.0, v21
v_cvt_pk_bf16_f32 v20, 0, v20
v_cvt_pk_bf16_f32 v21, 0, v21
v_mul_f32 v20, v20, v96
v_mul_f32 v21, v21, v97
v_cvt_pk_bf16_f32 v20, 0, v20
v_cvt_pk_bf16_f32 v21, 0, v21
v_lshlrev_b32 v22, 16, v192
v_and_b32 v23, s68, v192
v_add_f32 v20, v20, v22
v_add_f32 v21, v21, v23
v_cvt_pk_bf16_f32 v48, v20, v21
v_lshlrev_b32 v20, 16, v201
v_and_b32 v21, s68, v201
v_add_f32 v20, 1.0, v20
v_add_f32 v21, 1.0, v21
v_cvt_pk_bf16_f32 v20, 0, v20
v_cvt_pk_bf16_f32 v21, 0, v21
v_mul_f32 v20, v20, v98
v_mul_f32 v21, v21, v99
v_cvt_pk_bf16_f32 v20, 0, v20
v_cvt_pk_bf16_f32 v21, 0, v21
v_lshlrev_b32 v22, 16, v193
v_and_b32 v23, s68, v193
v_add_f32 v20, v20, v22
v_add_f32 v21, v21, v23
v_cvt_pk_bf16_f32 v49, v20, v21
v_lshlrev_b32 v20, 16, v202
v_and_b32 v21, s68, v202
v_add_f32 v20, 1.0, v20
v_add_f32 v21, 1.0, v21
v_cvt_pk_bf16_f32 v20, 0, v20
v_cvt_pk_bf16_f32 v21, 0, v21
v_mul_f32 v20, v20, v100
v_mul_f32 v21, v21, v101
v_cvt_pk_bf16_f32 v20, 0, v20
v_cvt_pk_bf16_f32 v21, 0, v21
v_lshlrev_b32 v22, 16, v194
v_and_b32 v23, s68, v194
v_add_f32 v20, v20, v22
v_add_f32 v21, v21, v23
v_cvt_pk_bf16_f32 v50, v20, v21
v_lshlrev_b32 v20, 16, v203
v_and_b32 v21, s68, v203
v_add_f32 v20, 1.0, v20
v_add_f32 v21, 1.0, v21
v_cvt_pk_bf16_f32 v20, 0, v20
v_cvt_pk_bf16_f32 v21, 0, v21
v_mul_f32 v20, v20, v102
v_mul_f32 v21, v21, v103
v_cvt_pk_bf16_f32 v20, 0, v20
v_cvt_pk_bf16_f32 v21, 0, v21
v_lshlrev_b32 v22, 16, v195
v_and_b32 v23, s68, v195
v_add_f32 v20, v20, v22
v_add_f32 v21, v21, v23
v_cvt_pk_bf16_f32 v51, v20, v21
v_lshlrev_b32 v20, 16, v204
v_and_b32 v21, s68, v204
v_add_f32 v20, 1.0, v20
v_add_f32 v21, 1.0, v21
v_cvt_pk_bf16_f32 v20, 0, v20
v_cvt_pk_bf16_f32 v21, 0, v21
v_mul_f32 v20, v20, v104
v_mul_f32 v21, v21, v105
v_cvt_pk_bf16_f32 v20, 0, v20
v_cvt_pk_bf16_f32 v21, 0, v21
v_lshlrev_b32 v22, 16, v196
v_and_b32 v23, s68, v196
v_add_f32 v20, v20, v22
v_add_f32 v21, v21, v23
v_cvt_pk_bf16_f32 v52, v20, v21
v_lshlrev_b32 v20, 16, v205
v_and_b32 v21, s68, v205
v_add_f32 v20, 1.0, v20
v_add_f32 v21, 1.0, v21
v_cvt_pk_bf16_f32 v20, 0, v20
v_cvt_pk_bf16_f32 v21, 0, v21
v_mul_f32 v20, v20, v106
v_mul_f32 v21, v21, v107
v_cvt_pk_bf16_f32 v20, 0, v20
v_cvt_pk_bf16_f32 v21, 0, v21
v_lshlrev_b32 v22, 16, v197
v_and_b32 v23, s68, v197
v_add_f32 v20, v20, v22
v_add_f32 v21, v21, v23
v_cvt_pk_bf16_f32 v53, v20, v21
v_lshlrev_b32 v20, 16, v206
v_and_b32 v21, s68, v206
v_add_f32 v20, 1.0, v20
v_add_f32 v21, 1.0, v21
v_cvt_pk_bf16_f32 v20, 0, v20
v_cvt_pk_bf16_f32 v21, 0, v21
v_mul_f32 v20, v20, v108
v_mul_f32 v21, v21, v109
v_cvt_pk_bf16_f32 v20, 0, v20
v_cvt_pk_bf16_f32 v21, 0, v21
v_lshlrev_b32 v22, 16, v198
v_and_b32 v23, s68, v198
v_add_f32 v20, v20, v22
v_add_f32 v21, v21, v23
v_cvt_pk_bf16_f32 v54, v20, v21
v_lshlrev_b32 v20, 16, v207
v_and_b32 v21, s68, v207
v_add_f32 v20, 1.0, v20
v_add_f32 v21, 1.0, v21
v_cvt_pk_bf16_f32 v20, 0, v20
v_cvt_pk_bf16_f32 v21, 0, v21
v_mul_f32 v20, v20, v110
v_mul_f32 v21, v21, v111
v_cvt_pk_bf16_f32 v20, 0, v20
v_cvt_pk_bf16_f32 v21, 0, v21
v_lshlrev_b32 v22, 16, v199
v_and_b32 v23, s68, v199
v_add_f32 v20, v20, v22
v_add_f32 v21, v21, v23
v_cvt_pk_bf16_f32 v55, v20, v21
L_g3:
s_cmp_ge_u32 s2, s73
s_cbranch_scc0 L_fl_151
s_waitcnt vmcnt(0)
v_cmp_eq_u32 vcc, 0, v31
s_cbranch_vccz L_fl_151
s_mov_b32 s75, 0
L_poll_152:
buffer_load_dword v31, v30, s[52:55], 0 offen offset:128 sc1
s_waitcnt vmcnt(0)
v_cmp_eq_u32 vcc, 0, v31
s_cbranch_vccz L_pollx_153
s_sleep 40
s_add_u32 s75, s75, 1
s_cmp_lt_u32 s75, 0x100000
s_cbranch_scc1 L_poll_152
L_pollx_153:
L_fl_151:
s_nop 1
v_mfma_f32_16x16x32_bf16 v[64:67], v[128:131], v[48:51], 0
v_mfma_f32_16x16x32_bf16 v[68:71], v[132:135], v[48:51], 0
v_mfma_f32_16x16x32_bf16 v[72:75], v[136:139], v[48:51], 0
v_mfma_f32_16x16x32_bf16 v[76:79], v[140:143], v[48:51], 0
v_mfma_f32_16x16x32_bf16 v[80:83], v[144:147], v[48:51], 0
v_mfma_f32_16x16x32_bf16 v[84:87], v[148:151], v[48:51], 0
v_mfma_f32_16x16x32_bf16 v[88:91], v[152:155], v[48:51], 0
v_mfma_f32_16x16x32_bf16 v[92:95], v[156:159], v[48:51], 0
v_mfma_f32_16x16x32_bf16 v[64:67], v[160:163], v[52:55], v[64:67]
v_mfma_f32_16x16x32_bf16 v[68:71], v[164:167], v[52:55], v[68:71]
v_mfma_f32_16x16x32_bf16 v[72:75], v[168:171], v[52:55], v[72:75]
v_mfma_f32_16x16x32_bf16 v[76:79], v[172:175], v[52:55], v[76:79]
v_mfma_f32_16x16x32_bf16 v[80:83], v[176:179], v[52:55], v[80:83]
v_mfma_f32_16x16x32_bf16 v[84:87], v[180:183], v[52:55], v[84:87]
v_mfma_f32_16x16x32_bf16 v[88:91], v[184:187], v[52:55], v[88:91]
v_mfma_f32_16x16x32_bf16 v[92:95], v[188:191], v[52:55], v[92:95]
v_and_b32 v20, 7, v0
v_mul_u32_u24 v20, 272, v20
v_and_b32 v21, 8, v0
v_lshl_add_u32 v20, v21, 3, v20
v_and_b32 v21, 48, v0
v_add_u32 v20, v20, v21
s_mul_i32 s64, s34, 8192
s_add_u32 s64, s64, 4096
v_add_u32 v20, s64, v20
s_nop 7
v_add_f32_dpp v24, v80, v64 row_ror:8 row_mask:0xf bank_mask:0x3
v_add_f32_dpp v24, v68, v84 row_ror:8 row_mask:0xf bank_mask:0xc
v_add_f32_dpp v25, v81, v65 row_ror:8 row_mask:0xf bank_mask:0x3
v_add_f32_dpp v25, v69, v85 row_ror:8 row_mask:0xf bank_mask:0xc
v_add_f32_dpp v26, v82, v66 row_ror:8 row_mask:0xf bank_mask:0x3
v_add_f32_dpp v26, v70, v86 row_ror:8 row_mask:0xf bank_mask:0xc
v_add_f32_dpp v27, v83, v67 row_ror:8 row_mask:0xf bank_mask:0x3
v_add_f32_dpp v27, v71, v87 row_ror:8 row_mask:0xf bank_mask:0xc
ds_write_b128 v20, v[24:27] offset:0
v_add_f32_dpp v28, v88, v72 row_ror:8 row_mask:0xf bank_mask:0x3
v_add_f32_dpp v28, v76, v92 row_ror:8 row_mask:0xf bank_mask:0xc
v_add_f32_dpp v29, v89, v73 row_ror:8 row_mask:0xf bank_mask:0x3
v_add_f32_dpp v29, v77, v93 row_ror:8 row_mask:0xf bank_mask:0xc
v_add_f32_dpp v30, v90, v74 row_ror:8 row_mask:0xf bank_mask:0x3
v_add_f32_dpp v30, v78, v94 row_ror:8 row_mask:0xf bank_mask:0xc
v_add_f32_dpp v31, v91, v75 row_ror:8 row_mask:0xf bank_mask:0x3
v_add_f32_dpp v31, v79, v95 row_ror:8 row_mask:0xf bank_mask:0xc
ds_write_b128 v20, v[28:31] offset:128
v_mov_b32 v20, 0
s_waitcnt lgkmcnt(0)
s_mov_b64 exec, 1
ds_add_u32 v20, v9 offset:320
s_mov_b64 exec, -1
s_cmp_eq_u32 s34, 0
s_cbranch_scc0 L_waitq
s_cmp_lt_u32 s2, 16
s_cbranch_scc0 L_gq2
v_and_b32 v21, 7, v0
v_lshrrev_b32 v22, 4, v0
v_and_b32 v23, 8, v0
v_lshrrev_b32 v23, 1, v23
v_add_u32 v22, v22, v23
v_mov_b32 v23, v1
s_lshl_b32 s64, s72, 10
s_add_u32 s64, s64, 0
s_branch L_g4
L_gq2:
v_lshrrev_b32 v21, 3, v0
v_and_b32 v22, 7, v0
s_mov_b32 s64, 10240
s_cmp_lt_u32 s2, 48
s_cselect_b32 s64, 22528, s64
s_mov_b32 s65, 12288
v_mul_lo_u32 v23, s65, v21
v_lshl_add_u32 v23, v22, 4, v23
s_lshl_b32 s66, s72, 7
s_add_u32 s64, s64, s66
L_g4:
v_mul_u32_u24 v21, 272, v21
v_lshl_add_u32 v21, v22, 5, v21
v_add_u32 v21, 4096, v21
s_mov_b32 s75, 0
L_poll_154:
ds_read_b32 v22, v20 offset:320
s_waitcnt lgkmcnt(0)
v_cmp_gt_u32 vcc, 4, v22
s_cbranch_vccz L_pollx_155
s_add_u32 s75, s75, 1
s_cmp_lt_u32 s75, 0x1000000
s_cbranch_scc1 L_poll_154
L_pollx_155:
ds_read_b128 v[64:67], v21 offset:0
ds_read_b128 v[68:71], v21 offset:16
ds_read_b128 v[72:75], v21 offset:8192
ds_read_b128 v[76:79], v21 offset:8208
ds_read_b128 v[80:83], v21 offset:16384
ds_read_b128 v[84:87], v21 offset:16400
ds_read_b128 v[88:91], v21 offset:24576
ds_read_b128 v[92:95], v21 offset:24592
s_waitcnt lgkmcnt(0)
v_add_f32 v64, v64, v72
v_add_f32 v65, v65, v73
v_add_f32 v66, v66, v74
v_add_f32 v67, v67, v75
v_add_f32 v68, v68, v76
v_add_f32 v69, v69, v77
v_add_f32 v70, v70, v78
v_add_f32 v71, v71, v79
v_add_f32 v64, v64, v80
v_add_f32 v65, v65, v81
v_add_f32 v66, v66, v82
v_add_f32 v67, v67, v83
v_add_f32 v68, v68, v84
v_add_f32 v69, v69, v85
v_add_f32 v70, v70, v86
v_add_f32 v71, v71, v87
v_add_f32 v64, v64, v88
v_add_f32 v65, v65, v89
v_add_f32 v66, v66, v90
v_add_f32 v67, v67, v91
v_add_f32 v68, v68, v92
v_add_f32 v69, v69, v93
v_add_f32 v70, v70, v94
v_add_f32 v71, v71, v95
v_cvt_pk_bf16_f32 v24, v64, v65
v_cvt_pk_bf16_f32 v25, v66, v67
v_cvt_pk_bf16_f32 v26, v68, v69
v_cvt_pk_bf16_f32 v27, v70, v71
v_min_u32 v24, -2, v24
v_min_u32 v25, -2, v25
v_min_u32 v26, -2, v26
v_min_u32 v27, -2, v27
buffer_store_dwordx4 v[24:27], v23, s[36:39], s64 offen sc1
s_branch L_waitq
L_jan:
v_mov_b32 v4, -1
v_mov_b32 v5, -1
v_mov_b32 v6, -1
v_mov_b32 v7, -1
s_lshl_b32 s67, s64, 2
s_add_u32 s67, s67, s34
s_cmp_lt_u32 s67, 32
s_cselect_b32 s66, 0, 933888
s_mul_i32 s65, s67, 3072
s_add_u32 s65, s65, s66
s_add_u32 s65, s65, 16384
v_add_u32 v8, s65, v1
global_store_dwordx4 v8, v[4:7], s[30:31] offset:0 sc1
global_store_dwordx4 v8, v[4:7], s[30:31] offset:1024 sc1
global_store_dwordx4 v8, v[4:7], s[30:31] offset:2048 sc1
s_and_b32 s66, s67, 64
s_add_u32 s67, s67, s66
s_lshl_b32 s67, s67, 7
s_add_u32 s67, s67, 1343488
v_and_b32 v8, 8, v0
v_lshlrev_b32 v8, 10, v8
v_and_b32 v10, 0x70, v1
v_add3_u32 v8, v8, v10, s67
s_mov_b64 exec, 0xffff
global_store_dwordx4 v8, v[4:7], s[30:31] sc1
s_mov_b64 exec, 1
s_load_dword s68, s[30:31], 0x48000
s_and_b32 s65, s34, 1
s_lshl_b32 s66, s65, 13
s_xor_b32 s67, s67, s66
s_xor_b32 s66, s67, 0x2000
s_waitcnt vmcnt(0) lgkmcnt(0)
s_mov_b64 exec, -1
s_cmp_eq_u32 s34, 3
s_cbranch_scc1 L_p0_156
s_cmp_eq_u32 s34, 0
s_cselect_b32 s62, s24, s10
s_cselect_b32 s63, s25, s11
s_cmp_eq_u32 s34, 2
s_cselect_b32 s62, s12, s62
s_cselect_b32 s63, s13, s63
global_load_dword v12, v38, s[62:63]
global_load_dword v13, v39, s[62:63]
L_p0_156:
s_mov_b64 exec, 1
s_mov_b32 s70, 0
s_load_dword s68, s[30:31], s67
L_race_157:
s_getreg_b32 s69, hwreg(HW_REG_IB_STS, 8, 4)
s_add_u32 s70, s70, 1
s_cmp_eq_u32 s69, 0
s_cbranch_scc0 L_race_157
s_waitcnt lgkmcnt(0)
s_mov_b32 s71, 0
s_load_dword s68, s[30:31], s66
L_race_158:
s_getreg_b32 s69, hwreg(HW_REG_IB_STS, 8, 4)
s_add_u32 s71, s71, 1
s_cmp_eq_u32 s69, 0
s_cbranch_scc0 L_race_158
s_waitcnt lgkmcnt(0)
s_cmp_lt_u32 s71, s70
s_cselect_b32 s70, 1, 0
s_xor_b32 s70, s70, s65
s_getreg_b32 s69, hwreg(HW_REG_XCC_ID, 2, 1)
s_xor_b32 s70, s70, s69
s_lshl_b32 s69, s69, 14
s_lshl_b32 s70, s70, 8
s_add_u32 s70, s70, s69
s_add_u32 s70, s70, 1
v_mov_b32 v9, s70
s_lshl_b32 s65, s64, 2
v_mov_b32 v8, s65
ds_add_rtn_u32 v11, v2, v9 offset:320
s_waitcnt lgkmcnt(0)
v_add_u32 v11, v11, v9
v_and_b32 v10, 0xff, v11
v_cmp_eq_u32 vcc, 4, v10
s_cbranch_vccz L_j_159
global_store_dword v8, v11, s[28:29] offset:128 sc1
L_j_159:
s_mov_b64 exec, -1
s_branch L_nop0
L_norole:
s_cmp_eq_u32 s74, -1
s_cbranch_scc1 L_waitq
L_waitq:
s_cmp_eq_u32 s74, -1
s_cselect_b64 vcc, 0, -1
s_cmp_lt_u32 s2, 112
s_cselect_b64 vcc, -1, vcc
s_mov_b32 s44, s12
s_mov_b32 s45, s13
s_mov_b32 s46, 0x400000
s_mov_b32 s47, 0x20000
v_lshrrev_b32 v18, 4, v0
v_and_b32 v16, 15, v0
v_xor_b32 v16, v16, v18
v_xor_b32 v17, 4, v16
v_lshlrev_b32 v19, 10, v18
v_lshl_add_u32 v22, v16, 4, v19
v_lshl_add_u32 v23, v17, 4, v19
v_and_b32 v19, 1, v18
v_lshlrev_b32 v19, 10, v19
v_lshrrev_b32 v18, 1, v18
v_lshl_add_u32 v18, v18, 11, v19
v_lshl_add_u32 v16, v16, 4, v18
v_lshl_add_u32 v17, v17, 4, v18
v_lshrrev_b32 v18, 4, v0
v_bfe_u32 v19, v0, 2, 2
v_and_b32 v20, 2, v0
v_lshlrev_b32 v20, 2, v20
v_xor_b32 v20, v20, v19
v_and_b32 v21, 1, v18
v_lshlrev_b32 v21, 2, v21
v_xor_b32 v20, v20, v21
v_lshlrev_b32 v20, 4, v20
v_lshl_add_u32 v20, v18, 10, v20
v_lshl_add_u32 v20, v19, 8, v20
v_and_b32 v21, 1, v0
v_lshl_add_u32 v20, v21, 3, v20
s_lshl_b32 s65, s34, 13
s_add_u32 s65, s65, 8192
v_add_u32 v40, s65, v20
v_xor_b32 v41, 16, v40
v_xor_b32 v42, 32, v40
v_xor_b32 v43, 48, v40
v_xor_b32 v44, 64, v40
v_xor_b32 v45, 80, v40
v_xor_b32 v46, 96, v40
v_xor_b32 v47, 112, v40
s_lshl_b32 s64, s33, 17
s_lshl_b32 s66, s34, 8
s_add_u32 s64, s64, s66
s_mov_b32 s68, 0
s_lshl_b32 s66, s68, 10
s_add_u32 s64, s64, s66
s_add_u32 m0, s65, 0
s_xor_b32 s66, s64, 0
buffer_load_dwordx4 v16, s[44:47], s66 offen  lds
s_add_u32 m0, s65, 1024
s_xor_b32 s66, s64, 8192
buffer_load_dwordx4 v17, s[44:47], s66 offen  lds
s_add_u32 m0, s65, 2048
s_xor_b32 s66, s64, 16384
buffer_load_dwordx4 v16, s[44:47], s66 offen  lds
s_waitcnt vmcnt(2)
s_add_u32 m0, s65, 3072
s_xor_b32 s66, s64, 24576
buffer_load_dwordx4 v17, s[44:47], s66 offen  lds
s_waitcnt vmcnt(2)
s_add_u32 m0, s65, 32768
s_xor_b32 s66, s64, 4096
buffer_load_dwordx4 v16, s[44:47], s66 offen  lds
s_waitcnt vmcnt(2)
s_add_u32 m0, s65, 33792
s_xor_b32 s66, s64, 12288
buffer_load_dwordx4 v17, s[44:47], s66 offen  lds
s_waitcnt vmcnt(2)
ds_read_b64_tr_b16 v[128:129], v40 offset:0
ds_read_b64_tr_b16 v[136:137], v41 offset:0
ds_read_b64_tr_b16 v[144:145], v42 offset:0
ds_read_b64_tr_b16 v[152:153], v43 offset:0
ds_read_b64_tr_b16 v[160:161], v44 offset:0
ds_read_b64_tr_b16 v[168:169], v45 offset:0
ds_read_b64_tr_b16 v[176:177], v46 offset:0
ds_read_b64_tr_b16 v[184:185], v47 offset:0
s_add_u32 m0, s65, 34816
s_xor_b32 s66, s64, 20480
buffer_load_dwordx4 v16, s[44:47], s66 offen  lds
s_waitcnt vmcnt(2)
s_add_u32 m0, s65, 35840
s_xor_b32 s66, s64, 28672
buffer_load_dwordx4 v17, s[44:47], s66 offen  lds
s_waitcnt vmcnt(2)
s_waitcnt lgkmcnt(0)
s_add_u32 m0, s65, 0
s_xor_b32 s66, s64, 32768
buffer_load_dwordx4 v16, s[44:47], s66 offen  lds
s_waitcnt vmcnt(2)
s_add_u32 m0, s65, 1024
s_xor_b32 s66, s64, 40960
buffer_load_dwordx4 v17, s[44:47], s66 offen  lds
s_waitcnt vmcnt(2)
ds_read_b64_tr_b16 v[130:131], v40 offset:32768
ds_read_b64_tr_b16 v[138:139], v41 offset:32768
ds_read_b64_tr_b16 v[146:147], v42 offset:32768
ds_read_b64_tr_b16 v[154:155], v43 offset:32768
ds_read_b64_tr_b16 v[162:163], v44 offset:32768
ds_read_b64_tr_b16 v[170:171], v45 offset:32768
ds_read_b64_tr_b16 v[178:179], v46 offset:32768
ds_read_b64_tr_b16 v[186:187], v47 offset:32768
s_add_u32 m0, s65, 2048
s_xor_b32 s66, s64, 49152
buffer_load_dwordx4 v16, s[44:47], s66 offen  lds
s_waitcnt vmcnt(2)
s_add_u32 m0, s65, 3072
s_xor_b32 s66, s64, 57344
buffer_load_dwordx4 v17, s[44:47], s66 offen  lds
s_waitcnt vmcnt(2)
s_waitcnt lgkmcnt(0)
s_add_u32 m0, s65, 32768
s_xor_b32 s66, s64, 36864
buffer_load_dwordx4 v16, s[44:47], s66 offen  lds
s_waitcnt vmcnt(2)
s_add_u32 m0, s65, 33792
s_xor_b32 s66, s64, 45056
buffer_load_dwordx4 v17, s[44:47], s66 offen  lds
s_waitcnt vmcnt(2)
ds_read_b64_tr_b16 v[132:133], v40 offset:0
ds_read_b64_tr_b16 v[140:141], v41 offset:0
ds_read_b64_tr_b16 v[148:149], v42 offset:0
ds_read_b64_tr_b16 v[156:157], v43 offset:0
ds_read_b64_tr_b16 v[164:165], v44 offset:0
ds_read_b64_tr_b16 v[172:173], v45 offset:0
ds_read_b64_tr_b16 v[180:181], v46 offset:0
ds_read_b64_tr_b16 v[188:189], v47 offset:0
s_add_u32 m0, s65, 34816
s_xor_b32 s66, s64, 53248
buffer_load_dwordx4 v16, s[44:47], s66 offen  lds
s_waitcnt vmcnt(2)
s_add_u32 m0, s65, 35840
s_xor_b32 s66, s64, 61440
buffer_load_dwordx4 v17, s[44:47], s66 offen  lds
s_waitcnt vmcnt(2)
s_waitcnt lgkmcnt(0)
s_add_u32 m0, s65, 0
s_xor_b32 s66, s64, 65536
buffer_load_dwordx4 v16, s[44:47], s66 offen  lds
s_waitcnt vmcnt(2)
s_add_u32 m0, s65, 1024
s_xor_b32 s66, s64, 73728
buffer_load_dwordx4 v17, s[44:47], s66 offen  lds
s_waitcnt vmcnt(2)
ds_read_b64_tr_b16 v[134:135], v40 offset:32768
ds_read_b64_tr_b16 v[142:143], v41 offset:32768
ds_read_b64_tr_b16 v[150:151], v42 offset:32768
ds_read_b64_tr_b16 v[158:159], v43 offset:32768
ds_read_b64_tr_b16 v[166:167], v44 offset:32768
ds_read_b64_tr_b16 v[174:175], v45 offset:32768
ds_read_b64_tr_b16 v[182:183], v46 offset:32768
ds_read_b64_tr_b16 v[190:191], v47 offset:32768
s_add_u32 m0, s65, 2048
s_xor_b32 s66, s64, 81920
buffer_load_dwordx4 v16, s[44:47], s66 offen  lds
s_waitcnt vmcnt(2)
s_add_u32 m0, s65, 3072
s_xor_b32 s66, s64, 90112
buffer_load_dwordx4 v17, s[44:47], s66 offen  lds
s_waitcnt vmcnt(2)
s_waitcnt lgkmcnt(0)
s_add_u32 m0, s65, 32768
s_xor_b32 s66, s64, 69632
buffer_load_dwordx4 v16, s[44:47], s66 offen  lds
s_waitcnt vmcnt(2)
s_add_u32 m0, s65, 33792
s_xor_b32 s66, s64, 77824
buffer_load_dwordx4 v17, s[44:47], s66 offen  lds
s_waitcnt vmcnt(2)
ds_read_b64_tr_b16 v[192:193], v40 offset:0
ds_read_b64_tr_b16 v[200:201], v41 offset:0
ds_read_b64_tr_b16 v[208:209], v42 offset:0
ds_read_b64_tr_b16 v[216:217], v43 offset:0
ds_read_b64_tr_b16 v[224:225], v44 offset:0
ds_read_b64_tr_b16 v[232:233], v45 offset:0
ds_read_b64_tr_b16 v[240:241], v46 offset:0
ds_read_b64_tr_b16 v[248:249], v47 offset:0
s_add_u32 m0, s65, 34816
s_xor_b32 s66, s64, 86016
buffer_load_dwordx4 v16, s[44:47], s66 offen  lds
s_waitcnt vmcnt(2)
s_add_u32 m0, s65, 35840
s_xor_b32 s66, s64, 94208
buffer_load_dwordx4 v17, s[44:47], s66 offen  lds
s_waitcnt vmcnt(2)
s_waitcnt lgkmcnt(0)
s_add_u32 m0, s65, 0
s_xor_b32 s66, s64, 98304
buffer_load_dwordx4 v16, s[44:47], s66 offen  lds
s_waitcnt vmcnt(2)
s_add_u32 m0, s65, 1024
s_xor_b32 s66, s64, 106496
buffer_load_dwordx4 v17, s[44:47], s66 offen  lds
s_waitcnt vmcnt(2)
ds_read_b64_tr_b16 v[194:195], v40 offset:32768
ds_read_b64_tr_b16 v[202:203], v41 offset:32768
ds_read_b64_tr_b16 v[210:211], v42 offset:32768
ds_read_b64_tr_b16 v[218:219], v43 offset:32768
ds_read_b64_tr_b16 v[226:227], v44 offset:32768
ds_read_b64_tr_b16 v[234:235], v45 offset:32768
ds_read_b64_tr_b16 v[242:243], v46 offset:32768
ds_read_b64_tr_b16 v[250:251], v47 offset:32768
v_and_b32 v24, 127, v2
buffer_load_dword v25, v24, s[52:55], 0 offen offset:128
s_add_u32 m0, s65, 2048
s_xor_b32 s66, s64, 114688
buffer_load_dwordx4 v16, s[44:47], s66 offen  lds
s_waitcnt vmcnt(2)
s_add_u32 m0, s65, 3072
s_xor_b32 s66, s64, 122880
buffer_load_dwordx4 v17, s[44:47], s66 offen  lds
s_waitcnt vmcnt(2)
s_waitcnt lgkmcnt(0)
s_add_u32 m0, s65, 32768
s_xor_b32 s66, s64, 102400
buffer_load_dwordx4 v16, s[44:47], s66 offen  lds
s_waitcnt vmcnt(2)
s_add_u32 m0, s65, 33792
s_xor_b32 s66, s64, 110592
buffer_load_dwordx4 v17, s[44:47], s66 offen  lds
s_waitcnt vmcnt(2)
ds_read_b64_tr_b16 v[196:197], v40 offset:0
ds_read_b64_tr_b16 v[204:205], v41 offset:0
ds_read_b64_tr_b16 v[212:213], v42 offset:0
ds_read_b64_tr_b16 v[220:221], v43 offset:0
ds_read_b64_tr_b16 v[228:229], v44 offset:0
ds_read_b64_tr_b16 v[236:237], v45 offset:0
ds_read_b64_tr_b16 v[244:245], v46 offset:0
ds_read_b64_tr_b16 v[252:253], v47 offset:0
s_add_u32 m0, s65, 34816
s_xor_b32 s66, s64, 118784
buffer_load_dwordx4 v16, s[44:47], s66 offen  lds
s_waitcnt vmcnt(2)
s_add_u32 m0, s65, 35840
s_xor_b32 s66, s64, 126976
buffer_load_dwordx4 v17, s[44:47], s66 offen  lds
s_waitcnt vmcnt(0)
ds_read_b64_tr_b16 v[198:199], v40 offset:32768
ds_read_b64_tr_b16 v[206:207], v41 offset:32768
ds_read_b64_tr_b16 v[214:215], v42 offset:32768
ds_read_b64_tr_b16 v[222:223], v43 offset:32768
ds_read_b64_tr_b16 v[230:231], v44 offset:32768
ds_read_b64_tr_b16 v[238:239], v45 offset:32768
ds_read_b64_tr_b16 v[246:247], v46 offset:32768
ds_read_b64_tr_b16 v[254:255], v47 offset:32768
s_waitcnt lgkmcnt(0)
v_cmp_eq_u32 vcc, 0, v25
s_cbranch_vccz L_tab_160
s_mov_b32 s75, 0
L_poll_161:
buffer_load_dword v25, v24, s[52:55], 0 offen offset:128 sc1
s_waitcnt vmcnt(0)
v_cmp_eq_u32 vcc, 0, v25
s_cbranch_vccz L_pollx_162
s_sleep 40
s_add_u32 s75, s75, 1
s_cmp_lt_u32 s75, 0x100000
s_cbranch_scc1 L_poll_161
L_pollx_162:
L_tab_160:
v_bfe_u32 v26, v25, 8, 3
v_lshrrev_b32 v25, 16, v25
s_nop 0
v_add_u32_dpp v26, v26, v26 quad_perm:[1,0,3,2] row_mask:0xf bank_mask:0xf
s_nop 1
v_add_u32_dpp v26, v26, v26 quad_perm:[2,3,0,1] row_mask:0xf bank_mask:0xf
s_nop 1
v_add_u32_dpp v26, v26, v26 row_ror:4 row_mask:0xf bank_mask:0xf
s_nop 1
v_add_u32_dpp v26, v26, v26 row_ror:8 row_mask:0xf bank_mask:0xf
s_nop 1
v_readlane_b32 s66, v26, 0
v_readlane_b32 s71, v26, 16
s_add_u32 s66, s66, s71
s_cmp_gt_u32 s66, 64
s_cselect_b32 s66, 1, 0
v_cmp_ne_u32 vcc, s66, v25
s_and_b32 s71, vcc_lo, 0xff
s_bcnt0_i32_b32 s66, s71
s_sub_u32 s66, s66, 24
v_mbcnt_lo_u32_b32 v24, s71, 0
v_sub_u32 v25, v0, v24
v_add_u32 v24, s66, v24
v_cndmask_b32 v24, v25, v24, vcc
v_bfe_u32 v25, v24, 1, 2
v_and_b32 v26, 1, v24
v_lshl_or_b32 v25, v26, 2, v25
v_lshlrev_b32 v25, v2, v25
s_nop 1
v_or_b32_dpp v25, v25, v25 quad_perm:[1,0,3,2] row_mask:0xf bank_mask:0xf
s_nop 1
v_or_b32_dpp v25, v25, v25 quad_perm:[2,3,0,1] row_mask:0xf bank_mask:0xf
s_nop 1
v_or_b32_dpp v25, v25, v25 row_shl:4 row_mask:0xf bank_mask:0xf
s_nop 1
v_readfirstlane_b32 s35, v25
s_mov_b64 exec, 1
ds_write_b32 v2, v25 offset:328
s_mov_b64 exec, -1
s_sub_u32 s64, s2, 144
s_cmp_lt_u32 s64, 64
s_cbranch_scc0 L_rp_163
s_cmp_eq_u32 s34, 0
s_cbranch_scc0 L_rp_163
s_mov_b32 s48, s4
s_mov_b32 s49, s5
s_mov_b32 s50, 0x2000
s_mov_b32 s51, 0x20000
v_and_b32 v5, 15, v0
v_and_b32 v6, 16, v0
v_lshl_add_u32 v5, v6, 1, v5
v_and_b32 v6, 32, v0
v_lshrrev_b32 v6, 1, v6
v_add_u32 v5, v5, v6
v_lshlrev_b32 v5, 1, v5
v_and_b32 v6, 0x7c, v5
s_lshl_b32 s65, s64, 7
s_and_b32 s66, s65, 0x380
s_lshr_b32 s64, s64, 3
s_mul_i32 s64, s64, 12288
s_add_u32 s64, s64, s66
s_add_u32 s64, s64, 24576
buffer_load_ushort v18, v5, s[48:51], s65 offen
s_mov_b32 s75, 0
L_poll_164:
buffer_load_dword v19, v6, s[36:39], s64 offen offset:0 sc1
buffer_load_dword v20, v6, s[36:39], s64 offen offset:3072 sc1
s_waitcnt vmcnt(0)
v_max_u32 v16, v19, v20
v_cmp_eq_u32 vcc, -1, v16
s_cbranch_vccz L_pollx_165
s_sleep 40
s_add_u32 s75, s75, 1
s_cmp_lt_u32 s75, 0x100000
s_cbranch_scc1 L_poll_164
L_pollx_165:
v_and_b32 v16, 1, v0
v_lshlrev_b32 v16, 4, v16
v_xor_b32 v16, 16, v16
v_lshlrev_b32 v18, 16, v18
v_lshlrev_b32 v19, v16, v19
v_and_b32 v19, 0xffff0000, v19
v_lshlrev_b32 v20, v16, v20
v_and_b32 v20, 0xffff0000, v20
ds_write_b32 v2, v18 offset:4096
ds_write_b32 v2, v19 offset:4352
ds_write_b32 v2, v20 offset:4608
L_rp_163:
v_lshlrev_b32 v10, 3, v0
s_lshl_b32 s64, s34, 8
s_add_u32 s64, s64, 2560
s_lshr_b32 s66, s68, 1
v_xor_b32 v12, s66, v0
v_mov_b32 v14, 0
v_bfe_u32 v11, v12, 0, 1
v_lshl_or_b32 v14, v11, 0, v14
v_bfe_u32 v11, v12, 1, 1
v_lshl_or_b32 v14, v11, 1, v14
v_bfe_u32 v11, v12, 2, 1
v_lshl_or_b32 v14, v11, 2, v14
v_bfe_u32 v11, v12, 3, 1
v_lshl_or_b32 v14, v11, 3, v14
v_bfe_u32 v11, v12, 4, 1
v_lshl_or_b32 v14, v11, 4, v14
v_bfe_u32 v11, v12, 5, 1
v_lshl_or_b32 v14, v11, 5, v14
v_and_b32 v11, 0x38, v14
v_and_b32 v12, 1, v14
v_lshl_add_u32 v11, v12, 2, v11
v_bfe_u32 v12, v14, 1, 2
v_add_u32 v11, v11, v12
v_lshl_add_u32 v11, v11, 2, s64
v_and_b32 v14, 1, v0
v_and_b32 v12, 48, v0
v_lshlrev_b32 v12, 1, v12
v_lshl_add_u32 v12, v14, 4, v12
v_add_u32 v12, s64, v12
v_mul_u32_u24 v15, 0xaaaa, v14
v_add_u32 v15, 0x4444, v15
v_mov_b32 v64, 0
v_mov_b32 v65, 0
v_mov_b32 v66, 0
v_mov_b32 v67, 0
v_mov_b32 v68, 0
v_mov_b32 v69, 0
v_mov_b32 v70, 0
v_mov_b32 v71, 0
v_mov_b32 v72, 0
v_mov_b32 v73, 0
v_mov_b32 v74, 0
v_mov_b32 v75, 0
v_mov_b32 v76, 0
v_mov_b32 v77, 0
v_mov_b32 v78, 0
v_mov_b32 v79, 0
v_mov_b32 v80, 0
v_mov_b32 v81, 0
v_mov_b32 v82, 0
v_mov_b32 v83, 0
v_mov_b32 v84, 0
v_mov_b32 v85, 0
v_mov_b32 v86, 0
v_mov_b32 v87, 0
v_mov_b32 v88, 0
v_mov_b32 v89, 0
v_mov_b32 v90, 0
v_mov_b32 v91, 0
v_mov_b32 v92, 0
v_mov_b32 v93, 0
v_mov_b32 v94, 0
v_mov_b32 v95, 0
s_lshl_b32 s64, s34, 3
s_lshr_b32 s64, s35, s64
v_bfe_u32 v13, v0, 3, 1
v_lshlrev_b32 v13, 2, v13
v_bfe_u32 v13, s64, v13, 3
v_and_b32 v14, 0x70, v1
v_lshl_add_u32 v13, v13, 12, v14
s_lshl_b32 s64, s34, 2
s_add_u32 s64, s64, s33
v_bfe_u32 v14, v0, 3, 1
v_lshl_add_u32 v14, v14, 1, s64
v_and_b32 v14, 31, v14
v_lshl_add_u32 v13, v14, 7, v13
s_lshl_b32 s69, s32, 15
s_add_u32 s69, s69, 1048576
s_waitcnt vmcnt(0) lgkmcnt(0)
s_barrier
ds_read_b64 v[20:21], v10 offset:512
ds_read_b64 v[22:23], v10 offset:1024
ds_read_b64 v[24:25], v10 offset:1536
ds_read_b64 v[26:27], v10 offset:2048
s_waitcnt lgkmcnt(2)
v_pk_add_f32 v[20:21], v[20:21], v[22:23]
s_waitcnt lgkmcnt(1)
v_pk_add_f32 v[20:21], v[20:21], v[24:25]
s_waitcnt lgkmcnt(0)
v_pk_add_f32 v[20:21], v[20:21], v[26:27]
v_cvt_pk_bf16_f32 v20, v20, v21
ds_write_b32 v11, v20
ds_read_b128 v[48:51], v12 offset:0
ds_read_b128 v[52:55], v12 offset:128
s_waitcnt lgkmcnt(1)
v_smfmac_f32_16x16x64_bf16 v[64:67], v[48:51], v[128:135], v15
v_smfmac_f32_16x16x64_bf16 v[68:71], v[48:51], v[136:143], v15
v_smfmac_f32_16x16x64_bf16 v[72:75], v[48:51], v[144:151], v15
v_smfmac_f32_16x16x64_bf16 v[76:79], v[48:51], v[152:159], v15
s_waitcnt lgkmcnt(0)
v_smfmac_f32_16x16x64_bf16 v[64:67], v[52:55], v[192:199], v15
v_smfmac_f32_16x16x64_bf16 v[68:71], v[52:55], v[200:207], v15
v_smfmac_f32_16x16x64_bf16 v[72:75], v[52:55], v[208:215], v15
v_smfmac_f32_16x16x64_bf16 v[76:79], v[52:55], v[216:223], v15
v_smfmac_f32_16x16x64_bf16 v[80:83], v[48:51], v[160:167], v15
v_smfmac_f32_16x16x64_bf16 v[84:87], v[48:51], v[168:175], v15
v_smfmac_f32_16x16x64_bf16 v[88:91], v[48:51], v[176:183], v15
v_smfmac_f32_16x16x64_bf16 v[92:95], v[48:51], v[184:191], v15
v_smfmac_f32_16x16x64_bf16 v[80:83], v[52:55], v[224:231], v15
v_add_f32 v64, v64, v65
v_smfmac_f32_16x16x64_bf16 v[84:87], v[52:55], v[232:239], v15
v_add_f32 v68, v68, v69
v_add_f32 v72, v72, v73
v_smfmac_f32_16x16x64_bf16 v[88:91], v[52:55], v[240:247], v15
v_add_f32 v76, v76, v77
v_cvt_pk_bf16_f32 v20, v64, v68
v_smfmac_f32_16x16x64_bf16 v[92:95], v[52:55], v[248:255], v15
v_cvt_pk_bf16_f32 v21, v72, v76
v_add_f32 v80, v80, v81
s_mov_b64 exec, 0xffff
v_add_f32 v84, v84, v85
v_cvt_pk_bf16_f32 v22, v80, v84
s_nop 0
v_add_f32 v88, v88, v89
s_nop 0
v_add_f32 v92, v92, v93
v_cvt_pk_bf16_f32 v23, v88, v92
buffer_store_dwordx4 v[20:23], v13, s[36:39], s69 offen sc1
s_mov_b64 exec, -1
s_sub_u32 s67, s2, 16
s_cmp_lt_u32 s67, 128
s_cbranch_scc0 L_nogp
s_and_b32 s66, s2, 7
s_min_u32 s64, s66, 3
s_mul_i32 s71, s66, 5
s_add_u32 s64, s64, s71
s_cmp_lt_u32 s66, 3
s_cselect_b32 s66, 5, 4
v_and_b32 v8, 7, v0
v_min_u32 v8, s66, v8
v_add_u32 v8, s64, v8
s_and_b32 s64, s67, 0xf8
s_lshl_b32 s64, s64, 2
s_lshl_b32 s66, s34, 3
s_add_u32 s64, s64, s66
v_lshrrev_b32 v9, 3, v0
v_add_u32 v9, s64, v9
v_mul_u32_u24 v9, 2752, v9
v_lshl_add_u32 v8, v8, 6, v9
global_load_dword v10, v8, s[16:17]
global_load_dword v11, v8, s[18:19]
s_and_b32 s66, s2, 7
s_min_u32 s70, s66, 3
s_mul_i32 s71, s66, 5
s_add_u32 s70, s70, s71
s_cmp_lt_u32 s66, 3
s_cselect_b32 s66, 6, 5
s_lshl_b32 s66, s66, 8
s_sub_u32 s66, s66, 1
s_lshr_b32 s71, s67, 3
s_lshl_b32 s71, s71, 2
s_add_u32 s71, s71, s34
s_mul_i32 s71, s71, 24
v_min_u32 v12, 23, v0
v_add_u32 v12, s71, v12
v_min_u32 v12, s66, v12
s_lshl_b32 s70, s70, 15
v_lshl_add_u32 v12, v12, 7, s70
global_load_dword v13, v12, s[20:21]
s_endpgm
L_nogp:
L_tail_s:
s_cmp_eq_u32 s74, -1
s_cbranch_scc0 L_ffn
s_cmp_eq_u32 s3, 0
s_cbranch_scc0 L_fin
s_sub_u32 s70, s2, 144
s_cmp_lt_u32 s70, 64
s_cbranch_scc0 L_fin
s_lshl_b32 s64, s70, 2
s_lshr_b32 s67, s35, s64
s_and_b32 s71, s67, 7
s_andn2_b32 s66, s70, 7
s_add_u32 s66, s66, s71
s_lshl_b32 s66, s66, 12
s_add_u32 s66, s66, 1048576
buffer_load_dwordx4 v[16:19], v1, s[36:39], s66 offen offset:0 sc1
buffer_load_dwordx4 v[20:23], v1, s[36:39], s66 offen offset:1024 sc1
buffer_load_dwordx4 v[24:27], v1, s[36:39], s66 offen offset:2048 sc1
buffer_load_dwordx4 v[28:31], v1, s[36:39], s66 offen offset:3072 sc1
v_mov_b32 v32, -1
v_mov_b32 v33, -1
v_mov_b32 v34, -1
v_mov_b32 v35, -1
s_and_b32 s64, s71, 6
s_lshl_b32 s64, s64, 12
s_and_b32 s65, s71, 1
s_lshl_b32 s65, s65, 15
s_or_b32 s64, s64, s65
s_lshr_b32 s65, s70, 3
s_lshl_b32 s65, s65, 16
s_add_u32 s64, s64, s65
s_lshr_b32 s65, s70, 4
s_lshl_b32 s65, s65, 2
s_and_b32 s67, s70, 7
s_add_u32 s65, s65, s67
s_lshl_b32 s65, s65, 7
s_add_u32 s64, s64, s65
s_add_u32 s64, s64, 1376256
s_add_u32 s65, s64, 4096
buffer_store_dwordx4 v[32:35], v1, s[36:39], s64 offen offset:0 sc1
buffer_store_dwordx4 v[32:35], v1, s[36:39], s64 offen offset:1024 sc1
buffer_store_dwordx4 v[32:35], v1, s[36:39], s64 offen offset:2048 sc1
buffer_store_dwordx4 v[32:35], v1, s[36:39], s64 offen offset:3072 sc1
buffer_store_dwordx4 v[32:35], v1, s[36:39], s65 offen offset:0 sc1
s_mov_b64 exec, 0xffffff
buffer_store_dwordx4 v[32:35], v1, s[36:39], s65 offen offset:1024 sc1
s_mov_b64 exec, -1
v_lshlrev_b32 v2, 2, v0
ds_read_b32 v8, v2 offset:4096
ds_read_b32 v9, v2 offset:4352
ds_read_b32 v10, v2 offset:4608
s_mov_b32 s56, s26
s_mov_b32 s57, s27
s_mov_b32 s58, 0x2000
s_mov_b32 s59, 0x20000
v_and_b32 v5, 15, v0
v_and_b32 v6, 16, v0
v_lshl_add_u32 v5, v6, 1, v5
v_and_b32 v6, 32, v0
v_lshrrev_b32 v6, 1, v6
v_add_u32 v5, v5, v6
v_lshlrev_b32 v5, 1, v5
v_and_b32 v6, 0x7c, v5
s_lshl_b32 s73, s70, 7
v_and_b32 v11, 1, v0
v_lshlrev_b32 v3, 4, v11
v_mov_b32 v7, 0x3f80
v_lshlrev_b32 v7, v3, v7
v_and_b32 v2, 4, v0
v_cmp_eq_u32 vcc, 0, v2
v_bfe_u32 v2, v0, 1, 1
v_mul_u32_u24 v43, 0xaaaa, v2
v_add_u32 v43, 0x4444, v43
v_cndmask_b32 v44, 0, v7, vcc
v_sub_u32 v45, v7, v44
v_mov_b32 v46, v44
v_mov_b32 v47, v45
v_mov_b32 v48, 0
v_mov_b32 v49, 0
v_mov_b32 v50, 0
v_mov_b32 v51, 0
v_mov_b32 v52, 0
v_mov_b32 v53, 0
v_mov_b32 v54, 0
v_mov_b32 v55, 0
s_add_u32 s68, s73, 1310720
s_mov_b32 s76, 0xaaaaaaaa
s_mov_b32 s77, 0xaaaaaaaa
v_cmp_gt_u32 vcc, 24, v0
v_mov_b32 v41, 0x40000000
v_lshl_add_u32 v12, v11, 13, v6
v_cndmask_b32 v41, v41, v1, vcc
s_mov_b32 s75, 0
s_waitcnt vmcnt(0) lgkmcnt(0)
buffer_load_dwordx4 v[16:19], v1, s[36:39], s66 offen offset:0 sc1
buffer_load_dwordx4 v[20:23], v1, s[36:39], s66 offen offset:1024 sc1
buffer_load_dwordx4 v[24:27], v1, s[36:39], s66 offen offset:2048 sc1
buffer_load_dwordx4 v[28:31], v1, s[36:39], s66 offen offset:3072 sc1
s_sleep 1
buffer_load_dwordx4 v[16:19], v1, s[36:39], s66 offen offset:0 sc1
buffer_load_dwordx4 v[20:23], v1, s[36:39], s66 offen offset:1024 sc1
buffer_load_dwordx4 v[24:27], v1, s[36:39], s66 offen offset:2048 sc1
buffer_load_dwordx4 v[28:31], v1, s[36:39], s66 offen offset:3072 sc1
s_sleep 1
buffer_load_dwordx4 v[16:19], v1, s[36:39], s66 offen offset:0 sc1
buffer_load_dwordx4 v[20:23], v1, s[36:39], s66 offen offset:1024 sc1
buffer_load_dwordx4 v[24:27], v1, s[36:39], s66 offen offset:2048 sc1
buffer_load_dwordx4 v[28:31], v1, s[36:39], s66 offen offset:3072 sc1
s_sleep 1
L_rn_168:
v_smfmac_f32_16x16x64_bf16 v[48:51], v[44:47], v[16:23], v43
v_smfmac_f32_16x16x64_bf16 v[48:51], v[44:47], v[24:31], v43
buffer_load_dwordx4 v[16:19], v1, s[36:39], s66 offen offset:0 sc1
buffer_load_dwordx4 v[20:23], v1, s[36:39], s66 offen offset:1024 sc1
buffer_load_dwordx4 v[24:27], v1, s[36:39], s66 offen offset:2048 sc1
buffer_load_dwordx4 v[28:31], v1, s[36:39], s66 offen offset:3072 sc1
s_add_u32 s75, s75, 1
s_and_b32 s78, s75, 15
s_nop 1
v_add_f32_dpp v13, v48, v48 row_ror:8 row_mask:0x3 bank_mask:0x3
v_add_f32_dpp v13, v49, v49 row_ror:8 row_mask:0x3 bank_mask:0xc
v_add_f32_dpp v13, v50, v50 row_ror:8 row_mask:0xc bank_mask:0x3
v_add_f32_dpp v13, v51, v51 row_ror:8 row_mask:0xc bank_mask:0xc
v_cmp_u_f32 vcc, v13, v13
s_cbranch_vccz L_rz_169
v_mov_b32 v48, 0
v_mov_b32 v49, 0
v_mov_b32 v50, 0
v_mov_b32 v51, 0
s_waitcnt vmcnt(12)
s_cbranch_scc1 L_rn_168
v_max3_u32 v2, v16, v17, v18
v_max3_u32 v2, v2, v19, v20
v_max3_u32 v2, v2, v21, v22
v_max3_u32 v2, v2, v23, v24
v_max3_u32 v2, v2, v25, v26
v_max3_u32 v2, v2, v27, v28
v_max3_u32 v2, v2, v29, v30
v_max_u32 v2, v2, v31
v_cmp_eq_u32 vcc, -1, v2
s_cbranch_vccz L_rx_167
s_cmp_lt_u32 s75, 0x100000
s_cbranch_scc1 L_rn_168
L_rx_167:
v_smfmac_f32_16x16x64_bf16 v[48:51], v[44:47], v[16:23], v43
v_smfmac_f32_16x16x64_bf16 v[48:51], v[44:47], v[24:31], v43
s_nop 7
v_add_f32_dpp v13, v48, v48 row_ror:8 row_mask:0x3 bank_mask:0x3
v_add_f32_dpp v13, v49, v49 row_ror:8 row_mask:0x3 bank_mask:0xc
v_add_f32_dpp v13, v50, v50 row_ror:8 row_mask:0xc bank_mask:0x3
v_add_f32_dpp v13, v51, v51 row_ror:8 row_mask:0xc bank_mask:0xc
L_rz_169:
v_fmac_f32 v8, v13, v9
s_nop 1
v_mov_b32_dpp v14, v8 quad_perm:[1,1,3,3] row_mask:0xf bank_mask:0xf
v_mov_b32_dpp v13, v8 quad_perm:[0,0,2,2] row_mask:0xf bank_mask:0xf
v_cvt_pk_bf16_f32 v13, v13, v14
buffer_store_dword v13, v12, s[36:39], s68 offen sc1
v_cvt_pk_bf16_f32 v8, 0, v8
buffer_load_dwordx4 v[64:67], v1, s[36:39], s64 offen offset:0 sc1
buffer_load_dwordx4 v[68:71], v1, s[36:39], s64 offen offset:1024 sc1
buffer_load_dwordx4 v[72:75], v1, s[36:39], s64 offen offset:2048 sc1
buffer_load_dwordx4 v[76:79], v1, s[36:39], s64 offen offset:3072 sc1
buffer_load_dwordx4 v[80:83], v1, s[36:39], s65 offen offset:0 sc1
buffer_load_dwordx4 v[84:87], v41, s[36:39], s65 offen offset:1024 sc1
s_mov_b32 s75, 0
s_waitcnt vmcnt(0)
buffer_load_dwordx4 v[64:67], v1, s[36:39], s64 offen offset:0 sc1
buffer_load_dwordx4 v[68:71], v1, s[36:39], s64 offen offset:1024 sc1
buffer_load_dwordx4 v[72:75], v1, s[36:39], s64 offen offset:2048 sc1
buffer_load_dwordx4 v[76:79], v1, s[36:39], s64 offen offset:3072 sc1
buffer_load_dwordx4 v[80:83], v1, s[36:39], s65 offen offset:0 sc1
buffer_load_dwordx4 v[84:87], v41, s[36:39], s65 offen offset:1024 sc1
s_sleep 1
buffer_load_dwordx4 v[64:67], v1, s[36:39], s64 offen offset:0 sc1
buffer_load_dwordx4 v[68:71], v1, s[36:39], s64 offen offset:1024 sc1
buffer_load_dwordx4 v[72:75], v1, s[36:39], s64 offen offset:2048 sc1
buffer_load_dwordx4 v[76:79], v1, s[36:39], s64 offen offset:3072 sc1
buffer_load_dwordx4 v[80:83], v1, s[36:39], s65 offen offset:0 sc1
buffer_load_dwordx4 v[84:87], v41, s[36:39], s65 offen offset:1024 sc1
s_sleep 1
L_rn_172:
v_smfmac_f32_16x16x64_bf16 v[52:55], v[44:47], v[64:71], v43
v_smfmac_f32_16x16x64_bf16 v[52:55], v[44:47], v[72:79], v43
v_smfmac_f32_16x16x64_bf16 v[52:55], v[44:47], v[80:87], v43
buffer_load_dwordx4 v[64:67], v1, s[36:39], s64 offen offset:0 sc1
buffer_load_dwordx4 v[68:71], v1, s[36:39], s64 offen offset:1024 sc1
buffer_load_dwordx4 v[72:75], v1, s[36:39], s64 offen offset:2048 sc1
buffer_load_dwordx4 v[76:79], v1, s[36:39], s64 offen offset:3072 sc1
buffer_load_dwordx4 v[80:83], v1, s[36:39], s65 offen offset:0 sc1
buffer_load_dwordx4 v[84:87], v41, s[36:39], s65 offen offset:1024 sc1
s_add_u32 s75, s75, 1
s_and_b32 s78, s75, 15
v_add_f32_dpp v13, v52, v52 row_ror:8 row_mask:0x3 bank_mask:0x3
v_add_f32_dpp v13, v53, v53 row_ror:8 row_mask:0x3 bank_mask:0xc
v_add_f32_dpp v13, v54, v54 row_ror:8 row_mask:0xc bank_mask:0x3
v_add_f32_dpp v13, v55, v55 row_ror:8 row_mask:0xc bank_mask:0xc
v_cmp_u_f32 vcc, v13, v13
s_cbranch_vccz L_rz_173
v_mov_b32 v52, 0
v_mov_b32 v53, 0
v_mov_b32 v54, 0
v_mov_b32 v55, 0
s_waitcnt vmcnt(12)
s_cbranch_scc1 L_rn_172
v_max3_u32 v2, v64, v65, v66
v_max3_u32 v2, v2, v67, v68
v_max3_u32 v2, v2, v69, v70
v_max3_u32 v2, v2, v71, v72
v_max3_u32 v2, v2, v73, v74
v_max3_u32 v2, v2, v75, v76
v_max3_u32 v2, v2, v77, v78
v_max3_u32 v2, v2, v79, v80
v_max3_u32 v2, v2, v81, v82
v_max3_u32 v2, v2, v83, v84
v_max3_u32 v2, v2, v85, v86
v_max_u32 v2, v2, v87
v_cmp_eq_u32 vcc, -1, v2
s_cbranch_vccz L_rx_171
s_cmp_lt_u32 s75, 0x100000
s_cbranch_scc1 L_rn_172
L_rx_171:
v_smfmac_f32_16x16x64_bf16 v[52:55], v[44:47], v[64:71], v43
v_smfmac_f32_16x16x64_bf16 v[52:55], v[44:47], v[72:79], v43
v_smfmac_f32_16x16x64_bf16 v[52:55], v[44:47], v[80:87], v43
s_nop 7
v_add_f32_dpp v13, v52, v52 row_ror:8 row_mask:0x3 bank_mask:0x3
v_add_f32_dpp v13, v53, v53 row_ror:8 row_mask:0x3 bank_mask:0xc
v_add_f32_dpp v13, v54, v54 row_ror:8 row_mask:0xc bank_mask:0x3
v_add_f32_dpp v13, v55, v55 row_ror:8 row_mask:0xc bank_mask:0xc
L_rz_173:
v_fmac_f32 v8, v13, v10
s_nop 1
v_mov_b32_dpp v14, v8 quad_perm:[1,1,3,3] row_mask:0xf bank_mask:0xf
s_not_b64 exec, s[76:77]
v_cvt_pk_bf16_f32 v13, v8, v14
buffer_store_dword v13, v6, s[56:59], s73 offen sc1
s_mov_b64 exec, -1
s_cmp_lt_u32 s70, 8
s_cbranch_scc0 L_fin2
s_mov_b64 exec, 0xffff
buffer_store_dwordx4 v[44:47], v1, s[36:39], s62 offen sc1
s_mov_b64 exec, -1
L_fin2:
s_endpgm
L_ffn:
s_mul_i32 s67, s3, 12288
s_add_u32 s67, s67, 25600
v_lshlrev_b32 v7, 3, v0
buffer_load_dwordx4 v[8:11], v1, s[36:39], s67 offen offset:0 sc1
buffer_load_dwordx4 v[12:15], v1, s[36:39], s67 offen offset:1024 sc1
s_cmp_lt_u32 s3, 4
s_cbranch_scc1 L_post_174
s_mov_b32 s40, s16
s_mov_b32 s41, s17
s_mov_b32 s42, 0x158000
s_mov_b32 s43, 0x20000
s_mov_b32 s56, s18
s_mov_b32 s57, s19
s_mov_b32 s58, 0x158000
s_mov_b32 s59, 0x20000
v_lshrrev_b32 v16, 2, v0
v_mul_u32_u24 v16, 2752, v16
v_and_b32 v17, 3, v0
v_lshrrev_b32 v18, 5, v0
v_xor_b32 v17, v17, v18
v_xor_b32 v18, 2, v17
v_lshl_add_u32 v17, v17, 4, v16
v_lshl_add_u32 v18, v18, 4, v16
s_mul_i32 s64, s34, 352256
s_lshl_b32 s65, s74, 6
s_add_u32 s64, s64, s65
s_lshl_b32 s65, s34, 13
s_add_u32 m0, s65, 4096
s_add_u32 s66, s64, 0
buffer_load_dwordx4 v17, s[40:43], s66 offen  lds
s_add_u32 m0, s65, 36864
s_add_u32 s66, s64, 0
buffer_load_dwordx4 v18, s[56:59], s66 offen  lds
s_add_u32 m0, s65, 5120
s_add_u32 s66, s64, 44032
buffer_load_dwordx4 v17, s[40:43], s66 offen  lds
s_add_u32 m0, s65, 37888
s_add_u32 s66, s64, 44032
buffer_load_dwordx4 v18, s[56:59], s66 offen  lds
s_add_u32 m0, s65, 6144
s_add_u32 s66, s64, 88064
buffer_load_dwordx4 v17, s[40:43], s66 offen  lds
s_add_u32 m0, s65, 38912
s_add_u32 s66, s64, 88064
buffer_load_dwordx4 v18, s[56:59], s66 offen  lds
s_add_u32 m0, s65, 7168
s_add_u32 s66, s64, 132096
buffer_load_dwordx4 v17, s[40:43], s66 offen  lds
s_add_u32 m0, s65, 39936
s_add_u32 s66, s64, 132096
buffer_load_dwordx4 v18, s[56:59], s66 offen  lds
s_add_u32 m0, s65, 8192
s_add_u32 s66, s64, 176128
buffer_load_dwordx4 v17, s[40:43], s66 offen  lds
s_add_u32 m0, s65, 40960
s_add_u32 s66, s64, 176128
buffer_load_dwordx4 v18, s[56:59], s66 offen  lds
s_add_u32 m0, s65, 9216
s_add_u32 s66, s64, 220160
buffer_load_dwordx4 v17, s[40:43], s66 offen  lds
s_add_u32 m0, s65, 41984
s_add_u32 s66, s64, 220160
buffer_load_dwordx4 v18, s[56:59], s66 offen  lds
s_add_u32 m0, s65, 10240
s_add_u32 s66, s64, 264192
buffer_load_dwordx4 v17, s[40:43], s66 offen  lds
s_add_u32 m0, s65, 43008
s_add_u32 s66, s64, 264192
buffer_load_dwordx4 v18, s[56:59], s66 offen  lds
s_add_u32 m0, s65, 11264
s_add_u32 s66, s64, 308224
buffer_load_dwordx4 v17, s[40:43], s66 offen  lds
s_add_u32 m0, s65, 44032
s_add_u32 s66, s64, 308224
buffer_load_dwordx4 v18, s[56:59], s66 offen  lds
s_waitcnt vmcnt(16)
s_branch L_post_175
L_post_174:
s_waitcnt vmcnt(0)
L_post_175:
v_max3_u32 v16, v8, v9, v10
v_max3_u32 v16, v16, v11, v12
v_max3_u32 v16, v16, v13, v14
v_max_u32 v16, v16, v15
v_cmp_eq_u32 vcc, -1, v16
s_cbranch_vccz L_cb_176
s_mov_b32 s75, 0
L_poll_177:
buffer_load_dwordx4 v[8:11], v1, s[36:39], s67 offen offset:0 sc1
buffer_load_dwordx4 v[12:15], v1, s[36:39], s67 offen offset:1024 sc1
s_waitcnt vmcnt(0)
v_max3_u32 v16, v8, v9, v10
v_max3_u32 v16, v16, v11, v12
v_max3_u32 v16, v16, v13, v14
v_max_u32 v16, v16, v15
v_cmp_eq_u32 vcc, -1, v16
s_cbranch_vccz L_pollx_178
s_add_u32 s75, s75, 1
s_cmp_lt_u32 s75, 0x100000
s_cbranch_scc1 L_poll_177
L_pollx_178:
L_cb_176:
s_mov_b32 s68, 0xffff0000
v_lshlrev_b32 v24, 16, v8
v_and_b32 v25, s68, v8
v_lshlrev_b32 v32, 16, v12
v_and_b32 v33, s68, v12
v_lshlrev_b32 v26, 16, v9
v_and_b32 v27, s68, v9
v_lshlrev_b32 v34, 16, v13
v_and_b32 v35, s68, v13
v_lshlrev_b32 v28, 16, v10
v_and_b32 v29, s68, v10
v_lshlrev_b32 v36, 16, v14
v_and_b32 v37, s68, v14
v_lshlrev_b32 v30, 16, v11
v_and_b32 v31, s68, v11
v_lshlrev_b32 v38, 16, v15
v_and_b32 v39, s68, v15
v_add_f32 v32, 1.0, v32
v_add_f32 v33, 1.0, v33
v_add_f32 v34, 1.0, v34
v_add_f32 v35, 1.0, v35
v_add_f32 v36, 1.0, v36
v_add_f32 v37, 1.0, v37
v_add_f32 v38, 1.0, v38
v_add_f32 v39, 1.0, v39
v_lshrrev_b32 v2, 3, v0
v_bfe_u32 v3, v0, 1, 3
v_and_b32 v4, 3, v3
s_lshl_b32 s64, s3, 1
v_xor_b32 v3, s64, v3
v_lshlrev_b32 v5, 10, v2
v_lshl_add_u32 v5, v4, 8, v5
v_lshl_add_u32 v5, v3, 4, v5
v_and_b32 v4, 1, v0
v_lshl_add_u32 v5, v4, 3, v5
v_add_u32 v5, 69632, v5
v_xor_b32 v6, 16, v5
v_mul_u32_u24 v16, 0xaaaa, v4
v_add_u32 v16, 0x4444, v16
v_lshrrev_b32 v2, 4, v0
v_bfe_u32 v3, v0, 3, 1
v_xor_b32 v7, v2, v0
v_lshlrev_b32 v7, 4, v7
v_add_u32 v7, 69632, v7
v_xor_b32 v8, 64, v7
v_and_b32 v4, 7, v0
v_and_b32 v9, 0x38, v0
v_lshlrev_b32 v9, 3, v9
v_lshl_add_u32 v9, v4, 1, v9
s_lshl_b32 s64, s34, 4
v_add_u32 v9, s64, v9
v_and_b32 v10, 12, v0
v_lshlrev_b32 v10, 5, v10
v_and_b32 v4, 1, v0
v_lshl_add_u32 v10, v4, 6, v10
v_lshl_add_u32 v10, v2, 4, v10
v_mov_b32 v17, 0xbfb8aa3b
v_mov_b32 v64, 0
v_mov_b32 v65, 0
v_mov_b32 v66, 0
v_mov_b32 v67, 0
s_lshl_b32 s64, s34, 3
s_lshr_b32 s64, s35, s64
v_lshlrev_b32 v3, 2, v3
v_bfe_u32 v3, s64, v3, 3
v_and_b32 v11, 6, v3
v_lshlrev_b32 v11, 12, v11
v_and_b32 v3, 1, v3
v_lshl_add_u32 v11, v3, 15, v11
v_lshl_add_u32 v11, v2, 17, v11
v_and_b32 v4, 240, v1
v_add_u32 v11, v11, v4
v_lshl_add_u32 v11, v2, 9, v11
s_lshl_b32 s64, s34, 8
v_add_u32 v11, s64, v11
s_lshl_b32 s69, s74, 7
s_add_u32 s69, s69, 1376256
s_add_u32 s72, s69, 65536
s_lshl_b32 s64, s3, 10
s_lshl_b32 s65, s2, 2
s_lshr_b32 s65, s35, s65
s_and_b32 s65, s65, 2
s_lshl_b32 s65, s65, 12
s_add_u32 s64, s64, s65
s_add_u32 s64, s64, 1310720
v_mov_b32 v14, 0xbb000000
v_mov_b32 v15, 0x3b000000
v_lshrrev_b32 v18, 4, v0
v_bfe_u32 v19, v0, 2, 2
v_bfe_u32 v20, v0, 1, 1
v_and_b32 v22, 1, v18
v_lshl_add_u32 v22, v20, 1, v22
v_xor_b32 v22, s34, v22
v_lshlrev_b32 v22, 4, v22
v_lshl_add_u32 v22, v20, 15, v22
v_lshl_add_u32 v22, v18, 9, v22
v_lshl_add_u32 v22, v19, 6, v22
v_and_b32 v20, 1, v0
v_lshl_add_u32 v22, v20, 3, v22
v_add_u32 v22, 4096, v22
s_lshr_b32 s73, s3, 2
s_waitcnt vmcnt(0)
s_barrier
buffer_load_dwordx4 v[56:59], v1, s[36:39], s64 offen sc1
s_cmp_eq_u32 s73, 0
s_cbranch_scc1 L_gu_180
ds_read_b64_tr_b16 v[128:129], v22 offset:0
ds_read_b64_tr_b16 v[130:131], v22 offset:256
ds_read_b64_tr_b16 v[132:133], v22 offset:2048
ds_read_b64_tr_b16 v[134:135], v22 offset:2304
ds_read_b64_tr_b16 v[136:137], v22 offset:4096
ds_read_b64_tr_b16 v[138:139], v22 offset:4352
ds_read_b64_tr_b16 v[140:141], v22 offset:6144
ds_read_b64_tr_b16 v[142:143], v22 offset:6400
ds_read_b64_tr_b16 v[144:145], v22 offset:8192
ds_read_b64_tr_b16 v[146:147], v22 offset:8448
ds_read_b64_tr_b16 v[148:149], v22 offset:10240
s_waitcnt lgkmcnt(4)
ds_read_b64_tr_b16 v[150:151], v22 offset:10496
ds_read_b64_tr_b16 v[152:153], v22 offset:12288
ds_read_b64_tr_b16 v[154:155], v22 offset:12544
ds_read_b64_tr_b16 v[156:157], v22 offset:14336
ds_read_b64_tr_b16 v[158:159], v22 offset:14592
ds_read_b64_tr_b16 v[160:161], v22 offset:16384
ds_read_b64_tr_b16 v[162:163], v22 offset:16640
ds_read_b64_tr_b16 v[164:165], v22 offset:18432
ds_read_b64_tr_b16 v[166:167], v22 offset:18688
ds_read_b64_tr_b16 v[168:169], v22 offset:20480
ds_read_b64_tr_b16 v[170:171], v22 offset:20736
s_waitcnt lgkmcnt(4)
ds_read_b64_tr_b16 v[172:173], v22 offset:22528
ds_read_b64_tr_b16 v[174:175], v22 offset:22784
ds_read_b64_tr_b16 v[176:177], v22 offset:24576
ds_read_b64_tr_b16 v[178:179], v22 offset:24832
ds_read_b64_tr_b16 v[180:181], v22 offset:26624
ds_read_b64_tr_b16 v[182:183], v22 offset:26880
ds_read_b64_tr_b16 v[184:185], v22 offset:28672
ds_read_b64_tr_b16 v[186:187], v22 offset:28928
ds_read_b64_tr_b16 v[188:189], v22 offset:30720
ds_read_b64_tr_b16 v[190:191], v22 offset:30976
v_add_u32 v68, 69632, v40
v_add_u32 v69, 69632, v41
v_add_u32 v70, 69632, v42
v_add_u32 v71, 69632, v43
v_add_u32 v72, 69632, v44
v_add_u32 v73, 69632, v45
v_add_u32 v74, 69632, v46
v_add_u32 v75, 69632, v47
L_gu_180:
s_cmp_lt_u32 s3, 4
s_cbranch_scc0 L_dma_181
s_mov_b32 s48, s20
s_mov_b32 s49, s21
s_mov_b32 s50, 0x158000
s_mov_b32 s51, 0x20000
v_lshrrev_b32 v18, 4, v0
v_and_b32 v16, 15, v0
v_xor_b32 v16, v16, v18
v_xor_b32 v17, 4, v16
v_lshlrev_b32 v19, 10, v18
v_lshl_add_u32 v22, v16, 4, v19
v_lshl_add_u32 v23, v17, 4, v19
s_lshl_b32 s76, s74, 15
s_lshl_b32 s66, s34, 8
s_add_u32 s76, s76, s66
s_lshl_b32 s77, s34, 13
s_add_u32 s77, s77, 77824
s_add_u32 m0, s77, 0
s_xor_b32 s66, s76, 0
buffer_load_dwordx4 v22, s[48:51], s66 offen  lds
s_add_u32 m0, s77, 1024
s_xor_b32 s66, s76, 8192
buffer_load_dwordx4 v23, s[48:51], s66 offen  lds
s_add_u32 m0, s77, 2048
s_xor_b32 s66, s76, 16384
buffer_load_dwordx4 v22, s[48:51], s66 offen  lds
s_add_u32 m0, s77, 3072
s_xor_b32 s66, s76, 24576
buffer_load_dwordx4 v23, s[48:51], s66 offen  lds
s_add_u32 m0, s77, 4096
s_xor_b32 s66, s76, 4096
buffer_load_dwordx4 v22, s[48:51], s66 offen  lds
s_add_u32 m0, s77, 5120
s_xor_b32 s66, s76, 12288
buffer_load_dwordx4 v23, s[48:51], s66 offen  lds
s_add_u32 m0, s77, 6144
s_xor_b32 s66, s76, 20480
buffer_load_dwordx4 v22, s[48:51], s66 offen  lds
s_waitcnt vmcnt(7)
s_branch L_dma_182
L_dma_181:
s_waitcnt vmcnt(0)
L_dma_182:
s_mov_b32 s73, 0x3f803f80
v_mov_b32 v20, 0
v_mov_b32 v21, 0
v_max3_u32 v12, v56, v57, v58
v_max_u32 v12, v12, v59
v_cmp_eq_u32 vcc, -1, v12
s_cbranch_vccz L_x_179
buffer_load_dwordx4 v[56:59], v1, s[36:39], s64 offen sc1
s_sleep 1
s_mov_b32 s75, 0
L_poll_183:
buffer_load_dwordx4 v[56:59], v1, s[36:39], s64 offen sc1
s_waitcnt vmcnt(1)
v_max3_u32 v12, v56, v57, v58
v_max_u32 v12, v12, v59
v_cmp_eq_u32 vcc, -1, v12
s_cbranch_vccz L_pollx_184
s_add_u32 s75, s75, 1
s_cmp_lt_u32 s75, 0x100000
s_cbranch_scc1 L_poll_183
L_pollx_184:
L_x_179:
v_dot2c_f32_bf16 v20, s73, v56
v_dot2c_f32_bf16 v21, v56, v56
v_dot2c_f32_bf16 v20, s73, v57
v_dot2c_f32_bf16 v21, v57, v57
v_dot2c_f32_bf16 v20, s73, v58
v_dot2c_f32_bf16 v21, v58, v58
v_dot2c_f32_bf16 v20, s73, v59
v_dot2c_f32_bf16 v21, v59, v59
v_lshlrev_b32 v40, 16, v56
v_and_b32 v41, s68, v56
v_lshlrev_b32 v42, 16, v57
v_permlane32_swap_b32 v20, v21
v_add_f32 v12, v20, v21
v_and_b32 v43, s68, v57
v_lshlrev_b32 v44, 16, v58
v_add_f32_dpp v12, v12, v12 quad_perm:[1,0,3,2] row_mask:0xf bank_mask:0xf
v_and_b32 v45, s68, v58
v_lshlrev_b32 v46, 16, v59
v_add_f32_dpp v12, v12, v12 quad_perm:[2,3,0,1] row_mask:0xf bank_mask:0xf
v_and_b32 v47, s68, v59
v_pk_mul_f32 v[48:49], v[40:41], v[32:33]
v_add_f32_dpp v12, v12, v12 row_ror:4 row_mask:0xf bank_mask:0xf
v_pk_mul_f32 v[50:51], v[42:43], v[34:35]
v_pk_mul_f32 v[52:53], v[44:45], v[36:37]
v_add_f32_dpp v12, v12, v12 row_ror:8 row_mask:0xf bank_mask:0xf
v_pk_mul_f32 v[54:55], v[46:47], v[38:39]
s_nop 0
v_add_f32_dpp v12, v12, v12 row_bcast:15 row_mask:0xa bank_mask:0xf
s_nop 0
v_readlane_b32 s70, v12, 16
v_readlane_b32 s71, v12, 48
s_nop 0
v_mul_f32 v12, s70, v14
v_mul_f32 v13, s71, v15
v_fma_f32 v13, -v12, v12, v13
v_max_f32 v13, 0, v13
v_add_f32 v13, 0x3727c5ac, v13
v_rsq_f32 v2, v13
v_pk_fma_f32 v[48:49], v[12:13], v[32:33], v[48:49] op_sel_hi:[0,1,1]
v_pk_fma_f32 v[50:51], v[12:13], v[34:35], v[50:51] op_sel_hi:[0,1,1]
v_pk_fma_f32 v[52:53], v[12:13], v[36:37], v[52:53] op_sel_hi:[0,1,1]
v_pk_fma_f32 v[54:55], v[12:13], v[38:39], v[54:55] op_sel_hi:[0,1,1]
v_pk_fma_f32 v[24:25], v[2:3], v[48:49], v[24:25] op_sel_hi:[0,1,1]
v_pk_fma_f32 v[28:29], v[2:3], v[52:53], v[28:29] op_sel_hi:[0,1,1]
v_pk_fma_f32 v[26:27], v[2:3], v[50:51], v[26:27] op_sel_hi:[0,1,1]
v_pk_fma_f32 v[30:31], v[2:3], v[54:55], v[30:31] op_sel_hi:[0,1,1]
v_cvt_pk_bf16_f32 v40, v24, v25
v_cvt_pk_bf16_f32 v41, v28, v29
ds_write_b64 v5, v[40:41]
v_cvt_pk_bf16_f32 v42, v26, v27
v_cvt_pk_bf16_f32 v43, v30, v31
ds_write_b64 v6, v[42:43]
s_cmp_lt_u32 s3, 4
s_cbranch_scc0 L_dma_185
s_mov_b32 s48, s20
s_mov_b32 s49, s21
s_mov_b32 s50, 0x158000
s_mov_b32 s51, 0x20000
s_add_u32 m0, s77, 7168
s_xor_b32 s66, s76, 28672
buffer_load_dwordx4 v23, s[48:51], s66 offen  lds
L_dma_185:
s_cmp_lt_u32 s3, 4
s_waitcnt lgkmcnt(0)
s_barrier
s_cbranch_scc1 L_bar_fin
ds_read_b128 v[192:195], v7 offset:0
ds_read_b128 v[196:199], v8 offset:1024
ds_read_b128 v[200:203], v7 offset:2048
ds_read_b128 v[204:207], v8 offset:3072
ds_read_b128 v[208:211], v7 offset:4096
ds_read_b128 v[212:215], v8 offset:5120
ds_read_b128 v[216:219], v7 offset:6144
ds_read_b128 v[220:223], v8 offset:7168
s_waitcnt lgkmcnt(7)
v_smfmac_f32_16x16x64_bf16 v[64:67], v[192:195], v[128:135], v16
s_waitcnt lgkmcnt(6)
v_smfmac_f32_16x16x64_bf16 v[64:67], v[196:199], v[136:143], v16
s_waitcnt lgkmcnt(5)
v_smfmac_f32_16x16x64_bf16 v[64:67], v[200:203], v[144:151], v16
s_waitcnt lgkmcnt(4)
v_smfmac_f32_16x16x64_bf16 v[64:67], v[204:207], v[152:159], v16
s_waitcnt lgkmcnt(3)
v_smfmac_f32_16x16x64_bf16 v[64:67], v[208:211], v[160:167], v16
s_waitcnt lgkmcnt(2)
v_smfmac_f32_16x16x64_bf16 v[64:67], v[212:215], v[168:175], v16
s_waitcnt lgkmcnt(1)
v_smfmac_f32_16x16x64_bf16 v[64:67], v[216:219], v[176:183], v16
s_waitcnt lgkmcnt(0)
v_smfmac_f32_16x16x64_bf16 v[64:67], v[220:223], v[184:191], v16
s_nop 7
v_add_f32 v66, v66, v67
v_add_f32 v64, v64, v65
v_mul_f32 v18, v64, v17
v_mul_f32_dpp v18, v66, v17 row_ror:8 row_mask:0xf bank_mask:0xc
v_exp_f32 v18, v18
v_mov_b32_dpp v66, v64 row_ror:8 row_mask:0xf bank_mask:0x3
v_add_f32 v18, 1.0, v18
v_rcp_f32 v18, v18
s_nop 0
v_mul_f32 v18, v18, v66
v_cvt_pk_bf16_f32 v18, v18, v18
ds_write_b16 v9, v18 offset:3584
s_waitcnt lgkmcnt(0)
s_barrier
ds_read_b128 v[48:51], v10 offset:3584
ds_read_b64_tr_b16 v[96:97], v68 offset:0
ds_read_b64_tr_b16 v[98:99], v68 offset:4096
ds_read_b64_tr_b16 v[100:101], v69 offset:0
ds_read_b64_tr_b16 v[102:103], v69 offset:4096
ds_read_b64_tr_b16 v[104:105], v70 offset:0
ds_read_b64_tr_b16 v[106:107], v70 offset:4096
ds_read_b64_tr_b16 v[108:109], v71 offset:0
ds_read_b64_tr_b16 v[110:111], v71 offset:4096
ds_read_b64_tr_b16 v[112:113], v72 offset:0
ds_read_b64_tr_b16 v[114:115], v72 offset:4096
ds_read_b64_tr_b16 v[116:117], v73 offset:0
ds_read_b64_tr_b16 v[118:119], v73 offset:4096
s_waitcnt lgkmcnt(10)
v_mfma_f32_16x16x32_bf16 v[192:195], v[48:51], v[96:99], 0
ds_read_b64_tr_b16 v[120:121], v74 offset:0
ds_read_b64_tr_b16 v[122:123], v74 offset:4096
s_waitcnt lgkmcnt(10)
v_mfma_f32_16x16x32_bf16 v[196:199], v[48:51], v[100:103], 0
ds_read_b64_tr_b16 v[124:125], v75 offset:0
ds_read_b64_tr_b16 v[126:127], v75 offset:4096
s_waitcnt lgkmcnt(10)
v_mfma_f32_16x16x32_bf16 v[200:203], v[48:51], v[104:107], 0
s_waitcnt lgkmcnt(8)
v_mfma_f32_16x16x32_bf16 v[204:207], v[48:51], v[108:111], 0
s_waitcnt lgkmcnt(6)
v_mfma_f32_16x16x32_bf16 v[208:211], v[48:51], v[112:115], 0
s_nop 0
v_cvt_pk_bf16_f32 v16, v192, v196
s_waitcnt lgkmcnt(4)
v_mfma_f32_16x16x32_bf16 v[212:215], v[48:51], v[116:119], 0
v_cvt_pk_bf16_f32 v20, v193, v197
s_waitcnt lgkmcnt(2)
v_mfma_f32_16x16x32_bf16 v[216:219], v[48:51], v[120:123], 0
v_cvt_pk_bf16_f32 v17, v200, v204
v_cvt_pk_bf16_f32 v21, v201, v205
s_waitcnt lgkmcnt(0)
v_mfma_f32_16x16x32_bf16 v[220:223], v[48:51], v[124:127], 0
s_nop 2
v_cvt_pk_bf16_f32 v18, v208, v212
v_cvt_pk_bf16_f32 v22, v209, v213
s_nop 2
v_cvt_pk_bf16_f32 v19, v216, v220
buffer_store_dwordx4 v[16:19], v11, s[36:39], s69 offen sc1
v_cvt_pk_bf16_f32 v23, v217, v221
buffer_store_dwordx4 v[20:23], v11, s[36:39], s72 offen sc1
s_endpgm
L_bar_fin:
s_waitcnt vmcnt(0)
s_barrier
s_endpgm
L_srest:
s_lshr_b32 s32, s2, 5
s_and_b32 s33, s2, 31
s_and_b32 s67, s2, 7
s_lshr_b32 s68, s2, 3
s_sub_u32 s68, s68, 26
s_min_u32 s74, s67, 3
s_mul_i32 s66, s67, 5
s_add_u32 s74, s74, s66
s_add_u32 s74, s74, s68
s_cmp_lt_u32 s67, 3
s_cselect_b32 s66, 6, 5
s_cmp_lt_u32 s68, s66
s_cselect_b32 s74, s74, -1
s_cmp_lt_u32 s2, 48
s_cselect_b32 s66, 2, 3
s_cselect_b32 s72, 14+26, 42+26
s_cmp_lt_u32 s2, 16
s_cselect_b32 s66, 1, s66
s_cselect_b32 s72, 26, s72
s_lshl_b32 s66, s67, s66
s_add_u32 s72, s72, s66
s_add_u32 s72, s72, s68
s_mov_b32 s36, s30
s_mov_b32 s37, s31
s_mov_b32 s38, 0x1d0000
s_mov_b32 s39, 0x20000
s_mov_b32 s52, s28
s_mov_b32 s53, s29
s_mov_b32 s54, 0x100
s_mov_b32 s55, 0x20000
s_mov_b32 s46, 0x40000
s_mov_b32 s47, 0x20000
s_cmp_eq_u32 s74, -1
s_mov_b32 s69, 30
s_cselect_b32 s69, 20, s69
s_cmp_lt_u32 s2, 144
s_cselect_b32 s69, 0, s69
s_cmp_lt_u32 s2, 112
s_cselect_b32 s69, 50, s69
s_cmp_lt_u32 s2, 48
s_cselect_b32 s69, 30, s69
s_cmp_lt_u32 s2, 16
s_cselect_b32 s69, 40, s69
s_and_b32 s66, s72, 7
s_cmp_eq_u32 s66, 3
s_cselect_b32 s66, 40, 0
s_cmp_lt_u32 s2, 112
s_cselect_b32 s66, s66, 0
s_add_u32 s69, s69, s66
s_xor_b32 s64, s65, 1024
s_cmpk_gt_u32 s69, 4
s_cbranch_scc1 L_d_1
s_waitcnt vmcnt(3)
L_d_1:
buffer_load_dwordx4 v[24:27], v1, s[40:43], s64 offen nt
s_xor_b32 s64, s65, 66560
s_cmpk_gt_u32 s69, 5
s_cbranch_scc1 L_d_2
s_waitcnt vmcnt(3)
L_d_2:
buffer_load_dwordx4 v[28:31], v1, s[40:43], s64 offen nt
s_xor_b32 s64, s65, 3072
s_cmpk_gt_u32 s69, 6
s_cbranch_scc1 L_d_3
s_waitcnt vmcnt(3)
L_d_3:
buffer_load_dwordx4 v[32:35], v1, s[40:43], s64 offen nt
s_xor_b32 s64, s65, 68608
s_cmpk_gt_u32 s69, 7
s_waitcnt vmcnt(6)
s_cbranch_scc1 L_d_4
s_waitcnt vmcnt(3)
L_d_4:
buffer_load_dwordx4 v[36:39], v1, s[40:43], s64 offen nt
s_xor_b32 s64, s65, 32768
s_cmpk_gt_u32 s69, 8
s_waitcnt vmcnt(6)
s_cbranch_scc1 L_d_5
s_waitcnt vmcnt(3)
L_d_5:
buffer_load_dwordx4 v[40:43], v1, s[40:43], s64 offen nt
s_xor_b32 s64, s65, 98304
s_cmpk_gt_u32 s69, 9
s_waitcnt vmcnt(6)
s_cbranch_scc1 L_d_6
s_waitcnt vmcnt(3)
L_d_6:
buffer_load_dwordx4 v[44:47], v1, s[40:43], s64 offen nt
s_xor_b32 s64, s65, 34816
s_cmpk_gt_u32 s69, 10
s_waitcnt vmcnt(6)
s_cbranch_scc1 L_d_7
s_waitcnt vmcnt(3)
L_d_7:
buffer_load_dwordx4 v[48:51], v1, s[40:43], s64 offen nt
s_xor_b32 s64, s65, 100352
s_cmpk_gt_u32 s69, 11
s_waitcnt vmcnt(6)
s_cbranch_scc1 L_d_8
s_waitcnt vmcnt(3)
L_d_8:
buffer_load_dwordx4 v[52:55], v1, s[40:43], s64 offen nt
s_xor_b32 s64, s65, 33792
s_cmpk_gt_u32 s69, 12
s_waitcnt vmcnt(6)
s_cbranch_scc1 L_d_9
s_waitcnt vmcnt(3)
L_d_9:
buffer_load_dwordx4 v[56:59], v1, s[40:43], s64 offen nt
s_xor_b32 s64, s65, 99328
s_cmpk_gt_u32 s69, 13
s_waitcnt vmcnt(6)
s_cbranch_scc1 L_d_10
s_waitcnt vmcnt(3)
L_d_10:
buffer_load_dwordx4 v[60:63], v1, s[40:43], s64 offen nt
s_xor_b32 s64, s65, 35840
s_cmpk_gt_u32 s69, 14
s_waitcnt vmcnt(6)
s_cbranch_scc1 L_d_11
s_waitcnt vmcnt(3)
L_d_11:
buffer_load_dwordx4 v[64:67], v1, s[40:43], s64 offen nt
s_xor_b32 s64, s65, 101376
s_cmpk_gt_u32 s69, 15
s_waitcnt vmcnt(6)
s_cbranch_scc1 L_d_12
s_waitcnt vmcnt(3)
L_d_12:
buffer_load_dwordx4 v[68:71], v1, s[40:43], s64 offen nt
s_xor_b32 s64, s65, 131072
s_cmpk_gt_u32 s69, 16
s_waitcnt vmcnt(6)
s_cbranch_scc1 L_d_13
s_waitcnt vmcnt(3)
L_d_13:
buffer_load_dwordx4 v[72:75], v1, s[40:43], s64 offen nt
s_xor_b32 s64, s65, 196608
s_cmpk_gt_u32 s69, 17
s_waitcnt vmcnt(6)
s_cbranch_scc1 L_d_14
s_waitcnt vmcnt(3)
L_d_14:
buffer_load_dwordx4 v[76:79], v1, s[40:43], s64 offen nt
s_xor_b32 s64, s65, 133120
s_cmpk_gt_u32 s69, 18
s_waitcnt vmcnt(6)
s_cbranch_scc1 L_d_15
s_waitcnt vmcnt(3)
L_d_15:
buffer_load_dwordx4 v[80:83], v1, s[40:43], s64 offen nt
s_xor_b32 s64, s65, 198656
s_cmpk_gt_u32 s69, 19
s_waitcnt vmcnt(6)
s_cbranch_scc1 L_d_16
s_waitcnt vmcnt(3)
L_d_16:
buffer_load_dwordx4 v[84:87], v1, s[40:43], s64 offen nt
s_xor_b32 s64, s65, 132096
s_cmpk_gt_u32 s69, 20
s_waitcnt vmcnt(6)
s_cbranch_scc1 L_d_17
s_waitcnt vmcnt(4)
L_d_17:
buffer_load_dwordx4 v[88:91], v1, s[40:43], s64 offen nt
s_xor_b32 s64, s65, 197632
s_cmpk_gt_u32 s69, 21
s_waitcnt vmcnt(6)
s_cbranch_scc1 L_d_18
s_waitcnt vmcnt(4)
L_d_18:
buffer_load_dwordx4 v[92:95], v1, s[40:43], s64 offen nt
s_xor_b32 s64, s65, 134144
s_cmpk_gt_u32 s69, 22
s_waitcnt vmcnt(6)
s_cbranch_scc1 L_d_19
s_waitcnt vmcnt(4)
L_d_19:
buffer_load_dwordx4 v[96:99], v1, s[40:43], s64 offen nt
s_xor_b32 s64, s65, 199680
s_cmpk_gt_u32 s69, 23
s_waitcnt vmcnt(6)
s_cbranch_scc1 L_d_20
s_waitcnt vmcnt(4)
L_d_20:
buffer_load_dwordx4 v[100:103], v1, s[40:43], s64 offen nt
s_xor_b32 s64, s65, 163840
s_cmpk_gt_u32 s69, 24
s_waitcnt vmcnt(6)
s_cbranch_scc1 L_d_21
s_waitcnt vmcnt(4)
L_d_21:
buffer_load_dwordx4 v[104:107], v1, s[40:43], s64 offen nt
s_xor_b32 s64, s65, 229376
s_cmpk_gt_u32 s69, 25
s_waitcnt vmcnt(6)
s_cbranch_scc1 L_d_22
s_waitcnt vmcnt(4)
L_d_22:
buffer_load_dwordx4 v[108:111], v1, s[40:43], s64 offen nt
s_xor_b32 s64, s65, 165888
s_cmpk_gt_u32 s69, 26
s_waitcnt vmcnt(6)
s_cbranch_scc1 L_d_23
s_waitcnt vmcnt(4)
L_d_23:
buffer_load_dwordx4 v[112:115], v1, s[40:43], s64 offen nt
s_xor_b32 s64, s65, 231424
s_cmpk_gt_u32 s69, 27
s_waitcnt vmcnt(6)
s_cbranch_scc1 L_d_24
s_waitcnt vmcnt(4)
L_d_24:
buffer_load_dwordx4 v[116:119], v1, s[40:43], s64 offen nt
s_xor_b32 s64, s65, 164864
s_cmpk_gt_u32 s69, 28
s_waitcnt vmcnt(6)
s_cbranch_scc1 L_d_25
s_waitcnt vmcnt(4)
L_d_25:
buffer_load_dwordx4 v[120:123], v1, s[40:43], s64 offen nt
s_xor_b32 s64, s65, 230400
s_cmpk_gt_u32 s69, 29
s_waitcnt vmcnt(6)
s_cbranch_scc1 L_d_26
s_waitcnt vmcnt(4)
L_d_26:
buffer_load_dwordx4 v[124:127], v1, s[40:43], s64 offen nt
s_xor_b32 s64, s65, 166912
s_cmpk_gt_u32 s69, 30
s_waitcnt vmcnt(6)
s_cbranch_scc1 L_d_27
s_waitcnt vmcnt(4)
L_d_27:
buffer_load_dwordx4 v[128:131], v1, s[40:43], s64 offen nt
s_xor_b32 s64, s65, 232448
s_cmpk_gt_u32 s69, 31
s_waitcnt vmcnt(6)
s_cbranch_scc1 L_d_28
s_waitcnt vmcnt(4)
L_d_28:
buffer_load_dwordx4 v[132:135], v1, s[40:43], s64 offen nt
s_xor_b32 s64, s65, 4096
s_cmpk_gt_u32 s69, 32
s_waitcnt vmcnt(6)
s_cbranch_scc1 L_d_29
s_waitcnt vmcnt(4)
L_d_29:
buffer_load_dwordx4 v[136:139], v1, s[40:43], s64 offen nt
s_xor_b32 s64, s65, 69632
s_cmpk_gt_u32 s69, 33
s_waitcnt vmcnt(6)
s_cbranch_scc1 L_d_30
s_waitcnt vmcnt(4)
L_d_30:
buffer_load_dwordx4 v[140:143], v1, s[40:43], s64 offen nt
s_xor_b32 s64, s65, 6144
s_cmpk_gt_u32 s69, 34
s_waitcnt vmcnt(6)
s_cbranch_scc1 L_d_31
s_waitcnt vmcnt(4)
L_d_31:
buffer_load_dwordx4 v[144:147], v1, s[40:43], s64 offen nt
s_xor_b32 s64, s65, 71680
s_cmpk_gt_u32 s69, 35
s_waitcnt vmcnt(6)
s_cbranch_scc1 L_d_32
s_waitcnt vmcnt(4)
L_d_32:
buffer_load_dwordx4 v[148:151], v1, s[40:43], s64 offen nt
s_xor_b32 s64, s65, 5120
s_cmpk_gt_u32 s69, 36
s_waitcnt vmcnt(6)
s_cbranch_scc1 L_d_33
s_waitcnt vmcnt(4)
L_d_33:
buffer_load_dwordx4 v[152:155], v1, s[40:43], s64 offen nt
s_xor_b32 s64, s65, 70656
s_cmpk_gt_u32 s69, 37
s_waitcnt vmcnt(6)
s_cbranch_scc1 L_d_34
s_waitcnt vmcnt(4)
L_d_34:
buffer_load_dwordx4 v[156:159], v1, s[40:43], s64 offen nt
s_xor_b32 s64, s65, 7168
s_cmpk_gt_u32 s69, 38
s_waitcnt vmcnt(6)
s_cbranch_scc1 L_d_35
s_waitcnt vmcnt(4)
L_d_35:
buffer_load_dwordx4 v[160:163], v1, s[40:43], s64 offen nt
s_xor_b32 s64, s65, 72704
s_cmpk_gt_u32 s69, 39
s_waitcnt vmcnt(6)
s_cbranch_scc1 L_d_36
s_waitcnt vmcnt(4)
L_d_36:
buffer_load_dwordx4 v[164:167], v1, s[40:43], s64 offen nt
s_xor_b32 s64, s65, 36864
s_cmpk_gt_u32 s69, 40
s_waitcnt vmcnt(6)
s_cbranch_scc1 L_d_37
s_waitcnt vmcnt(4)
L_d_37:
buffer_load_dwordx4 v[168:171], v1, s[40:43], s64 offen nt
s_xor_b32 s64, s65, 102400
s_cmpk_gt_u32 s69, 41
s_waitcnt vmcnt(6)
s_cbranch_scc1 L_d_38
s_waitcnt vmcnt(4)
L_d_38:
buffer_load_dwordx4 v[172:175], v1, s[40:43], s64 offen nt
s_xor_b32 s64, s65, 38912
s_cmpk_gt_u32 s69, 42
s_waitcnt vmcnt(6)
s_cbranch_scc1 L_d_39
s_waitcnt vmcnt(4)
L_d_39:
buffer_load_dwordx4 v[176:179], v1, s[40:43], s64 offen nt
s_xor_b32 s64, s65, 104448
s_cmpk_gt_u32 s69, 43
s_waitcnt vmcnt(6)
s_cbranch_scc1 L_d_40
s_waitcnt vmcnt(4)
L_d_40:
buffer_load_dwordx4 v[180:183], v1, s[40:43], s64 offen nt
s_xor_b32 s64, s65, 37888
s_cmpk_gt_u32 s69, 44
s_waitcnt vmcnt(6)
s_cbranch_scc1 L_d_41
s_waitcnt vmcnt(4)
L_d_41:
buffer_load_dwordx4 v[184:187], v1, s[40:43], s64 offen nt
s_xor_b32 s64, s65, 103424
s_cmpk_gt_u32 s69, 45
s_waitcnt vmcnt(6)
s_cbranch_scc1 L_d_42
s_waitcnt vmcnt(4)
L_d_42:
buffer_load_dwordx4 v[188:191], v1, s[40:43], s64 offen nt
s_xor_b32 s64, s65, 39936
s_cmpk_gt_u32 s69, 46
s_waitcnt vmcnt(6)
s_cbranch_scc1 L_d_43
s_waitcnt vmcnt(4)
L_d_43:
buffer_load_dwordx4 v[192:195], v1, s[40:43], s64 offen nt
s_xor_b32 s64, s65, 105472
s_cmpk_gt_u32 s69, 47
s_waitcnt vmcnt(6)
s_cbranch_scc1 L_d_44
s_waitcnt vmcnt(4)
L_d_44:
buffer_load_dwordx4 v[196:199], v1, s[40:43], s64 offen nt
s_xor_b32 s64, s65, 135168
s_cmpk_gt_u32 s69, 48
s_waitcnt vmcnt(6)
s_cbranch_scc1 L_d_45
s_waitcnt vmcnt(4)
L_d_45:
buffer_load_dwordx4 v[200:203], v1, s[40:43], s64 offen nt
s_xor_b32 s64, s65, 200704
s_cmpk_gt_u32 s69, 49
s_waitcnt vmcnt(6)
s_cbranch_scc1 L_d_46
s_waitcnt vmcnt(4)
L_d_46:
buffer_load_dwordx4 v[204:207], v1, s[40:43], s64 offen nt
s_xor_b32 s64, s65, 137216
s_cmpk_gt_u32 s69, 50
s_waitcnt vmcnt(6)
s_cbranch_scc1 L_d_47
s_waitcnt vmcnt(4)
L_d_47:
buffer_load_dwordx4 v[208:211], v1, s[40:43], s64 offen nt
s_xor_b32 s64, s65, 202752
s_cmpk_gt_u32 s69, 51
s_waitcnt vmcnt(6)
s_cbranch_scc1 L_d_48
s_waitcnt vmcnt(4)
L_d_48:
buffer_load_dwordx4 v[212:215], v1, s[40:43], s64 offen nt
s_xor_b32 s64, s65, 136192
s_cmpk_gt_u32 s69, 52
s_waitcnt vmcnt(6)
s_cbranch_scc1 L_d_49
s_waitcnt vmcnt(4)
L_d_49:
buffer_load_dwordx4 v[216:219], v1, s[40:43], s64 offen nt
s_xor_b32 s64, s65, 201728
s_cmpk_gt_u32 s69, 53
s_waitcnt vmcnt(6)
s_cbranch_scc1 L_d_50
s_waitcnt vmcnt(4)
L_d_50:
buffer_load_dwordx4 v[220:223], v1, s[40:43], s64 offen nt
s_xor_b32 s64, s65, 138240
s_cmpk_gt_u32 s69, 54
s_waitcnt vmcnt(6)
s_cbranch_scc1 L_d_51
s_waitcnt vmcnt(4)
L_d_51:
buffer_load_dwordx4 v[224:227], v1, s[40:43], s64 offen nt
s_xor_b32 s64, s65, 203776
s_cmpk_gt_u32 s69, 55
s_waitcnt vmcnt(6)
s_cbranch_scc1 L_d_52
s_waitcnt vmcnt(4)
L_d_52:
buffer_load_dwordx4 v[228:231], v1, s[40:43], s64 offen nt
s_cmp_eq_u32 s74, -1
s_mov_b32 s69, 80
s_cselect_b32 s69, 0, s69
s_cmp_lt_u32 s2, 144
s_cselect_b32 s69, 80, s69
s_cmp_lt_u32 s2, 112
s_cselect_b32 s69, 112, s69
s_cmp_lt_u32 s2, 48
s_cselect_b32 s69, 0, s69
s_cmp_lt_u32 s2, 16
s_cselect_b32 s69, 112, s69
s_xor_b32 s64, s65, 167936
s_cmpk_gt_u32 s69, 56
s_waitcnt vmcnt(6)
s_cbranch_scc1 L_d_53
s_waitcnt vmcnt(4)
L_d_53:
buffer_load_dwordx4 v[232:235], v1, s[40:43], s64 offen nt
s_xor_b32 s64, s65, 233472
s_cmpk_gt_u32 s69, 57
s_waitcnt vmcnt(6)
s_cbranch_scc1 L_d_54
s_waitcnt vmcnt(4)
L_d_54:
buffer_load_dwordx4 v[236:239], v1, s[40:43], s64 offen nt
s_xor_b32 s64, s65, 169984
s_cmpk_gt_u32 s69, 58
s_waitcnt vmcnt(6)
s_cbranch_scc1 L_d_55
s_waitcnt vmcnt(4)
L_d_55:
buffer_load_dwordx4 v[240:243], v1, s[40:43], s64 offen nt
v_and_b32 v2, 31, v0
v_lshlrev_b32 v2, 2, v2
buffer_load_dword v3, v2, s[52:55], 0 offen offset:128
s_xor_b32 s64, s65, 235520
s_cmpk_gt_u32 s69, 59
s_waitcnt vmcnt(6)
s_cbranch_scc1 L_d_56
s_waitcnt vmcnt(4)
L_d_56:
buffer_load_dwordx4 v[244:247], v1, s[40:43], s64 offen nt
s_xor_b32 s64, s65, 168960
s_cmpk_gt_u32 s69, 60
s_waitcnt vmcnt(6)
s_cbranch_scc1 L_d_57
s_waitcnt vmcnt(4)
L_d_57:
buffer_load_dwordx4 v[248:251], v1, s[40:43], s64 offen nt
s_xor_b32 s64, s65, 234496
s_cmpk_gt_u32 s69, 61
s_waitcnt vmcnt(6)
s_cbranch_scc1 L_d_58
s_waitcnt vmcnt(4)
L_d_58:
buffer_load_dwordx4 v[252:255], v1, s[40:43], s64 offen nt
s_mul_i32 s70, s34, 15360
s_add_u32 s70, s70, 69632
s_add_u32 m0, s70, 0
s_xor_b32 s64, s65, 171008
s_cmpk_gt_u32 s69, 62
s_waitcnt vmcnt(6)
s_cbranch_scc1 L_d_59
s_waitcnt vmcnt(4)
L_d_59:
buffer_load_dwordx4 v1, s[40:43], s64 offen nt lds
s_add_u32 m0, s70, 1024
s_xor_b32 s64, s65, 236544
s_cmpk_gt_u32 s69, 63
s_waitcnt vmcnt(6)
s_cbranch_scc1 L_d_60
s_waitcnt vmcnt(4)
L_d_60:
buffer_load_dwordx4 v1, s[40:43], s64 offen nt lds
s_add_u32 m0, s70, 2048
s_xor_b32 s64, s65, 0
s_cmpk_gt_u32 s69, 64
s_waitcnt vmcnt(6)
s_cbranch_scc1 L_d_61
s_waitcnt vmcnt(4)
L_d_61:
buffer_load_dwordx4 v1, s[44:47], s64 offen nt lds
s_add_u32 m0, s70, 3072
s_xor_b32 s64, s65, 65536
s_cmpk_gt_u32 s69, 65
s_waitcnt vmcnt(6)
s_cbranch_scc1 L_d_62
s_waitcnt vmcnt(4)
L_d_62:
buffer_load_dwordx4 v1, s[44:47], s64 offen nt lds
s_add_u32 m0, s70, 4096
s_xor_b32 s64, s65, 2048
s_cmpk_gt_u32 s69, 66
s_waitcnt vmcnt(6)
s_cbranch_scc1 L_d_63
s_waitcnt vmcnt(4)
L_d_63:
buffer_load_dwordx4 v1, s[44:47], s64 offen nt lds
s_add_u32 m0, s70, 5120
s_xor_b32 s64, s65, 67584
s_cmpk_gt_u32 s69, 67
s_waitcnt vmcnt(6)
s_cbranch_scc1 L_d_64
s_waitcnt vmcnt(4)
L_d_64:
buffer_load_dwordx4 v1, s[44:47], s64 offen nt lds
v_cmp_eq_u32 vcc, 0, v3
s_cbranch_vccz L_jf_66
s_mov_b32 s75, 0
L_poll_67:
v_and_b32 v2, 31, v0
v_lshlrev_b32 v2, 2, v2
buffer_load_dword v3, v2, s[52:55], 0 offen offset:128 sc1
s_waitcnt vmcnt(0)
v_cmp_eq_u32 vcc, 0, v3
s_cbranch_vccz L_pollx_68
s_sleep 40
s_add_u32 s75, s75, 1
s_cmp_lt_u32 s75, 0x100000
s_cbranch_scc1 L_poll_67
L_pollx_68:
L_jf_66:
s_mul_i32 s68, s32, 12288
s_lshl_b32 s67, s33, 8
s_add_u32 s68, s68, s67
s_add_u32 s68, s68, 16384
v_and_b32 v2, 0xf0, v1
buffer_load_dwordx4 v[4:7], v2, s[36:39], s68 offen sc1
s_add_u32 m0, s70, 6144
s_xor_b32 s64, s65, 1024
s_cmpk_gt_u32 s69, 68
s_waitcnt vmcnt(6)
s_cbranch_scc1 L_d_65
s_waitcnt vmcnt(4)
L_d_65:
buffer_load_dwordx4 v1, s[44:47], s64 offen nt lds
s_add_u32 m0, s70, 7168
s_xor_b32 s64, s65, 66560
s_cmpk_gt_u32 s69, 69
s_waitcnt vmcnt(6)
s_cbranch_scc1 L_d_69
s_waitcnt vmcnt(4)
L_d_69:
buffer_load_dwordx4 v1, s[44:47], s64 offen nt lds
s_add_u32 m0, s70, 8192
s_xor_b32 s64, s65, 3072
s_cmpk_gt_u32 s69, 70
s_waitcnt vmcnt(6)
s_cbranch_scc1 L_d_70
s_waitcnt vmcnt(4)
L_d_70:
buffer_load_dwordx4 v1, s[44:47], s64 offen nt lds
s_add_u32 m0, s70, 9216
s_xor_b32 s64, s65, 68608
s_cmpk_gt_u32 s69, 71
s_waitcnt vmcnt(6)
s_cbranch_scc1 L_d_71
s_waitcnt vmcnt(4)
L_d_71:
buffer_load_dwordx4 v1, s[44:47], s64 offen nt lds
s_add_u32 m0, s70, 10240
s_xor_b32 s64, s65, 32768
s_cmpk_gt_u32 s69, 72
s_waitcnt vmcnt(6)
s_cbranch_scc1 L_d_72
s_waitcnt vmcnt(4)
L_d_72:
buffer_load_dwordx4 v1, s[44:47], s64 offen nt lds
s_add_u32 m0, s70, 11264
s_xor_b32 s64, s65, 98304
s_cmpk_gt_u32 s69, 73
s_waitcnt vmcnt(6)
s_cbranch_scc1 L_d_73
s_waitcnt vmcnt(4)
L_d_73:
buffer_load_dwordx4 v1, s[44:47], s64 offen nt lds
s_add_u32 m0, s70, 12288
s_xor_b32 s64, s65, 34816
s_cmpk_gt_u32 s69, 74
s_waitcnt vmcnt(6)
s_cbranch_scc1 L_d_74
s_waitcnt vmcnt(4)
L_d_74:
buffer_load_dwordx4 v1, s[44:47], s64 offen nt lds
s_add_u32 m0, s70, 13312
s_xor_b32 s64, s65, 100352
s_cmpk_gt_u32 s69, 75
s_waitcnt vmcnt(6)
s_cbranch_scc1 L_d_75
s_waitcnt vmcnt(4)
L_d_75:
buffer_load_dwordx4 v1, s[44:47], s64 offen nt lds
s_add_u32 m0, s70, 14336
s_xor_b32 s64, s65, 33792
s_cmpk_gt_u32 s69, 76
s_waitcnt vmcnt(6)
s_cbranch_scc1 L_d_76
s_waitcnt vmcnt(4)
L_d_76:
buffer_load_dwordx4 v1, s[44:47], s64 offen nt lds
v_max3_u32 v3, v4, v5, v6
v_max_u32 v3, v3, v7
v_cmp_eq_u32 vcc, -1, v3
s_cbranch_vccz L_q_77
s_mov_b32 s75, 0
L_poll_78:
s_mul_i32 s68, s32, 12288
s_lshl_b32 s67, s33, 8
s_add_u32 s68, s68, s67
s_add_u32 s68, s68, 16384
v_and_b32 v2, 0xf0, v1
buffer_load_dwordx4 v[4:7], v2, s[36:39], s68 offen sc1
s_waitcnt vmcnt(0)
v_max3_u32 v3, v4, v5, v6
v_max_u32 v3, v3, v7
v_cmp_eq_u32 vcc, -1, v3
s_cbranch_vccz L_pollx_79
s_add_u32 s75, s75, 1
s_cmp_lt_u32 s75, 0x100000
s_cbranch_scc1 L_poll_78
L_pollx_79:
L_q_77:
s_mov_b32 s66, 0x3db504f3
v_dot2_f32_bf16 v8, v8, v4, 0
v_dot2_f32_bf16 v12, v12, v4, 0
v_dot2_f32_bf16 v16, v16, v4, 0
v_dot2_f32_bf16 v20, v20, v4, 0
v_dot2c_f32_bf16 v8, v9, v5
v_dot2c_f32_bf16 v12, v13, v5
v_dot2c_f32_bf16 v16, v17, v5
v_dot2c_f32_bf16 v20, v21, v5
v_dot2c_f32_bf16 v8, v10, v6
v_dot2c_f32_bf16 v12, v14, v6
v_dot2c_f32_bf16 v16, v18, v6
v_dot2c_f32_bf16 v20, v22, v6
v_dot2c_f32_bf16 v8, v11, v7
v_dot2c_f32_bf16 v12, v15, v7
v_dot2c_f32_bf16 v16, v19, v7
v_dot2c_f32_bf16 v20, v23, v7
v_add_f32_dpp v9, v8, v8 row_ror:8 row_mask:0xf bank_mask:0x3
v_add_f32_dpp v13, v12, v12 row_ror:8 row_mask:0xf bank_mask:0x3
v_add_f32_dpp v9, v16, v16 row_ror:8 row_mask:0xf bank_mask:0xc
v_add_f32_dpp v13, v20, v20 row_ror:8 row_mask:0xf bank_mask:0xc
s_nop 0
v_add_f32_dpp v17, v9, v9 row_shl:4 row_mask:0xf bank_mask:0x5
v_add_f32_dpp v17, v13, v13 row_shr:4 row_mask:0xf bank_mask:0xa
s_nop 1
v_add_f32_dpp v17, v17, v17 quad_perm:[1,0,3,2] row_mask:0xf bank_mask:0xf
s_nop 1
v_add_f32_dpp v17, v17, v17 quad_perm:[2,3,0,1] row_mask:0xf bank_mask:0xf
v_cvt_pk_bf16_f32 v17, 0, v17
v_mul_f32 v17, s66, v17
v_cvt_pk_bf16_f32 v17, 0, v17
v_dot2_f32_bf16 v24, v24, v4, 0
v_dot2_f32_bf16 v28, v28, v4, 0
v_dot2_f32_bf16 v32, v32, v4, 0
v_dot2_f32_bf16 v36, v36, v4, 0
v_dot2c_f32_bf16 v24, v25, v5
v_dot2c_f32_bf16 v28, v29, v5
v_dot2c_f32_bf16 v32, v33, v5
v_dot2c_f32_bf16 v36, v37, v5
v_dot2c_f32_bf16 v24, v26, v6
v_dot2c_f32_bf16 v28, v30, v6
v_dot2c_f32_bf16 v32, v34, v6
v_dot2c_f32_bf16 v36, v38, v6
v_dot2c_f32_bf16 v24, v27, v7
v_dot2c_f32_bf16 v28, v31, v7
v_dot2c_f32_bf16 v32, v35, v7
v_dot2c_f32_bf16 v36, v39, v7
v_add_f32_dpp v25, v24, v24 row_ror:8 row_mask:0xf bank_mask:0x3
v_add_f32_dpp v29, v28, v28 row_ror:8 row_mask:0xf bank_mask:0x3
v_add_f32_dpp v25, v32, v32 row_ror:8 row_mask:0xf bank_mask:0xc
v_add_f32_dpp v29, v36, v36 row_ror:8 row_mask:0xf bank_mask:0xc
s_nop 0
v_add_f32_dpp v8, v25, v25 row_shl:4 row_mask:0xf bank_mask:0x5
v_add_f32_dpp v8, v29, v29 row_shr:4 row_mask:0xf bank_mask:0xa
s_nop 1
v_add_f32_dpp v8, v8, v8 quad_perm:[1,0,3,2] row_mask:0xf bank_mask:0xf
s_nop 1
v_add_f32_dpp v8, v8, v8 quad_perm:[2,3,0,1] row_mask:0xf bank_mask:0xf
v_cvt_pk_bf16_f32 v8, 0, v8
v_mul_f32 v8, s66, v8
v_cvt_pk_bf16_f32 v8, 0, v8
s_xor_b32 s64, s65, 99328
s_cmpk_gt_u32 s69, 77
s_waitcnt vmcnt(6)
s_cbranch_scc1 L_d_80
s_waitcnt vmcnt(4)
L_d_80:
buffer_load_dwordx4 v[24:27], v1, s[44:47], s64 offen nt
v_dot2_f32_bf16 v40, v40, v4, 0
v_dot2_f32_bf16 v44, v44, v4, 0
v_dot2_f32_bf16 v48, v48, v4, 0
v_dot2_f32_bf16 v52, v52, v4, 0
v_dot2c_f32_bf16 v40, v41, v5
v_dot2c_f32_bf16 v44, v45, v5
v_dot2c_f32_bf16 v48, v49, v5
v_dot2c_f32_bf16 v52, v53, v5
v_dot2c_f32_bf16 v40, v42, v6
v_dot2c_f32_bf16 v44, v46, v6
v_dot2c_f32_bf16 v48, v50, v6
v_dot2c_f32_bf16 v52, v54, v6
v_dot2c_f32_bf16 v40, v43, v7
v_dot2c_f32_bf16 v44, v47, v7
v_dot2c_f32_bf16 v48, v51, v7
v_dot2c_f32_bf16 v52, v55, v7
v_add_f32_dpp v41, v40, v40 row_ror:8 row_mask:0xf bank_mask:0x3
v_add_f32_dpp v45, v44, v44 row_ror:8 row_mask:0xf bank_mask:0x3
v_add_f32_dpp v41, v48, v48 row_ror:8 row_mask:0xf bank_mask:0xc
v_add_f32_dpp v45, v52, v52 row_ror:8 row_mask:0xf bank_mask:0xc
s_nop 0
v_add_f32_dpp v9, v41, v41 row_shl:4 row_mask:0xf bank_mask:0x5
v_add_f32_dpp v9, v45, v45 row_shr:4 row_mask:0xf bank_mask:0xa
s_nop 1
v_add_f32_dpp v9, v9, v9 quad_perm:[1,0,3,2] row_mask:0xf bank_mask:0xf
s_nop 1
v_add_f32_dpp v9, v9, v9 quad_perm:[2,3,0,1] row_mask:0xf bank_mask:0xf
v_cvt_pk_bf16_f32 v9, 0, v9
v_mul_f32 v9, s66, v9
v_cvt_pk_bf16_f32 v9, 0, v9
s_xor_b32 s64, s65, 35840
s_cmpk_gt_u32 s69, 78
s_waitcnt vmcnt(6)
s_cbranch_scc1 L_d_81
s_waitcnt vmcnt(4)
L_d_81:
buffer_load_dwordx4 v[28:31], v1, s[44:47], s64 offen nt
v_dot2_f32_bf16 v56, v56, v4, 0
v_dot2_f32_bf16 v60, v60, v4, 0
v_dot2_f32_bf16 v64, v64, v4, 0
v_dot2_f32_bf16 v68, v68, v4, 0
v_dot2c_f32_bf16 v56, v57, v5
v_dot2c_f32_bf16 v60, v61, v5
v_dot2c_f32_bf16 v64, v65, v5
v_dot2c_f32_bf16 v68, v69, v5
v_dot2c_f32_bf16 v56, v58, v6
v_dot2c_f32_bf16 v60, v62, v6
v_dot2c_f32_bf16 v64, v66, v6
v_dot2c_f32_bf16 v68, v70, v6
v_dot2c_f32_bf16 v56, v59, v7
v_dot2c_f32_bf16 v60, v63, v7
v_dot2c_f32_bf16 v64, v67, v7
v_dot2c_f32_bf16 v68, v71, v7
v_add_f32_dpp v57, v56, v56 row_ror:8 row_mask:0xf bank_mask:0x3
v_add_f32_dpp v61, v60, v60 row_ror:8 row_mask:0xf bank_mask:0x3
v_add_f32_dpp v57, v64, v64 row_ror:8 row_mask:0xf bank_mask:0xc
v_add_f32_dpp v61, v68, v68 row_ror:8 row_mask:0xf bank_mask:0xc
s_nop 0
v_add_f32_dpp v10, v57, v57 row_shl:4 row_mask:0xf bank_mask:0x5
v_add_f32_dpp v10, v61, v61 row_shr:4 row_mask:0xf bank_mask:0xa
s_nop 1
v_add_f32_dpp v10, v10, v10 quad_perm:[1,0,3,2] row_mask:0xf bank_mask:0xf
s_nop 1
v_add_f32_dpp v10, v10, v10 quad_perm:[2,3,0,1] row_mask:0xf bank_mask:0xf
v_cvt_pk_bf16_f32 v10, 0, v10
v_mul_f32 v10, s66, v10
v_cvt_pk_bf16_f32 v10, 0, v10
s_xor_b32 s64, s65, 101376
s_cmpk_gt_u32 s69, 79
s_waitcnt vmcnt(6)
s_cbranch_scc1 L_d_82
s_waitcnt vmcnt(4)
L_d_82:
buffer_load_dwordx4 v[32:35], v1, s[44:47], s64 offen nt
v_dot2_f32_bf16 v72, v72, v4, 0
v_dot2_f32_bf16 v76, v76, v4, 0
v_dot2_f32_bf16 v80, v80, v4, 0
v_dot2_f32_bf16 v84, v84, v4, 0
v_dot2c_f32_bf16 v72, v73, v5
v_dot2c_f32_bf16 v76, v77, v5
v_dot2c_f32_bf16 v80, v81, v5
v_dot2c_f32_bf16 v84, v85, v5
v_dot2c_f32_bf16 v72, v74, v6
v_dot2c_f32_bf16 v76, v78, v6
v_dot2c_f32_bf16 v80, v82, v6
v_dot2c_f32_bf16 v84, v86, v6
v_dot2c_f32_bf16 v72, v75, v7
v_dot2c_f32_bf16 v76, v79, v7
v_dot2c_f32_bf16 v80, v83, v7
v_dot2c_f32_bf16 v84, v87, v7
v_add_f32_dpp v73, v72, v72 row_ror:8 row_mask:0xf bank_mask:0x3
v_add_f32_dpp v77, v76, v76 row_ror:8 row_mask:0xf bank_mask:0x3
v_add_f32_dpp v73, v80, v80 row_ror:8 row_mask:0xf bank_mask:0xc
v_add_f32_dpp v77, v84, v84 row_ror:8 row_mask:0xf bank_mask:0xc
s_nop 0
v_add_f32_dpp v11, v73, v73 row_shl:4 row_mask:0xf bank_mask:0x5
v_add_f32_dpp v11, v77, v77 row_shr:4 row_mask:0xf bank_mask:0xa
s_nop 1
v_add_f32_dpp v11, v11, v11 quad_perm:[1,0,3,2] row_mask:0xf bank_mask:0xf
s_nop 1
v_add_f32_dpp v11, v11, v11 quad_perm:[2,3,0,1] row_mask:0xf bank_mask:0xf
v_cvt_pk_bf16_f32 v11, 0, v11
v_mul_f32 v11, s66, v11
v_cvt_pk_bf16_f32 v11, 0, v11
s_xor_b32 s64, s65, 131072
s_cmpk_gt_u32 s69, 80
s_waitcnt vmcnt(6)
s_cbranch_scc1 L_d_83
s_waitcnt vmcnt(4)
L_d_83:
buffer_load_dwordx4 v[36:39], v1, s[44:47], s64 offen nt
v_dot2_f32_bf16 v88, v88, v4, 0
v_dot2_f32_bf16 v92, v92, v4, 0
v_dot2_f32_bf16 v96, v96, v4, 0
v_dot2_f32_bf16 v100, v100, v4, 0
v_dot2c_f32_bf16 v88, v89, v5
v_dot2c_f32_bf16 v92, v93, v5
v_dot2c_f32_bf16 v96, v97, v5
v_dot2c_f32_bf16 v100, v101, v5
v_dot2c_f32_bf16 v88, v90, v6
v_dot2c_f32_bf16 v92, v94, v6
v_dot2c_f32_bf16 v96, v98, v6
v_dot2c_f32_bf16 v100, v102, v6
v_dot2c_f32_bf16 v88, v91, v7
v_dot2c_f32_bf16 v92, v95, v7
v_dot2c_f32_bf16 v96, v99, v7
v_dot2c_f32_bf16 v100, v103, v7
v_add_f32_dpp v89, v88, v88 row_ror:8 row_mask:0xf bank_mask:0x3
v_add_f32_dpp v93, v92, v92 row_ror:8 row_mask:0xf bank_mask:0x3
v_add_f32_dpp v89, v96, v96 row_ror:8 row_mask:0xf bank_mask:0xc
v_add_f32_dpp v93, v100, v100 row_ror:8 row_mask:0xf bank_mask:0xc
s_nop 0
v_add_f32_dpp v12, v89, v89 row_shl:4 row_mask:0xf bank_mask:0x5
v_add_f32_dpp v12, v93, v93 row_shr:4 row_mask:0xf bank_mask:0xa
s_nop 1
v_add_f32_dpp v12, v12, v12 quad_perm:[1,0,3,2] row_mask:0xf bank_mask:0xf
s_nop 1
v_add_f32_dpp v12, v12, v12 quad_perm:[2,3,0,1] row_mask:0xf bank_mask:0xf
v_cvt_pk_bf16_f32 v12, 0, v12
v_mul_f32 v12, s66, v12
v_cvt_pk_bf16_f32 v12, 0, v12
s_xor_b32 s64, s65, 196608
s_cmpk_gt_u32 s69, 81
s_waitcnt vmcnt(6)
s_cbranch_scc1 L_d_84
s_waitcnt vmcnt(4)
L_d_84:
buffer_load_dwordx4 v[40:43], v1, s[44:47], s64 offen nt
v_dot2_f32_bf16 v104, v104, v4, 0
v_dot2_f32_bf16 v108, v108, v4, 0
v_dot2_f32_bf16 v112, v112, v4, 0
v_dot2_f32_bf16 v116, v116, v4, 0
v_dot2c_f32_bf16 v104, v105, v5
v_dot2c_f32_bf16 v108, v109, v5
v_dot2c_f32_bf16 v112, v113, v5
v_dot2c_f32_bf16 v116, v117, v5
v_dot2c_f32_bf16 v104, v106, v6
v_dot2c_f32_bf16 v108, v110, v6
v_dot2c_f32_bf16 v112, v114, v6
v_dot2c_f32_bf16 v116, v118, v6
v_dot2c_f32_bf16 v104, v107, v7
v_dot2c_f32_bf16 v108, v111, v7
v_dot2c_f32_bf16 v112, v115, v7
v_dot2c_f32_bf16 v116, v119, v7
v_add_f32_dpp v105, v104, v104 row_ror:8 row_mask:0xf bank_mask:0x3
v_add_f32_dpp v109, v108, v108 row_ror:8 row_mask:0xf bank_mask:0x3
v_add_f32_dpp v105, v112, v112 row_ror:8 row_mask:0xf bank_mask:0xc
v_add_f32_dpp v109, v116, v116 row_ror:8 row_mask:0xf bank_mask:0xc
s_nop 0
v_add_f32_dpp v13, v105, v105 row_shl:4 row_mask:0xf bank_mask:0x5
v_add_f32_dpp v13, v109, v109 row_shr:4 row_mask:0xf bank_mask:0xa
s_nop 1
v_add_f32_dpp v13, v13, v13 quad_perm:[1,0,3,2] row_mask:0xf bank_mask:0xf
s_nop 1
v_add_f32_dpp v13, v13, v13 quad_perm:[2,3,0,1] row_mask:0xf bank_mask:0xf
v_cvt_pk_bf16_f32 v13, 0, v13
v_mul_f32 v13, s66, v13
v_cvt_pk_bf16_f32 v13, 0, v13
s_xor_b32 s64, s65, 133120
s_cmpk_gt_u32 s69, 82
s_waitcnt vmcnt(6)
s_cbranch_scc1 L_d_85
s_waitcnt vmcnt(4)
L_d_85:
buffer_load_dwordx4 v[44:47], v1, s[44:47], s64 offen nt
v_dot2_f32_bf16 v120, v120, v4, 0
v_dot2_f32_bf16 v124, v124, v4, 0
v_dot2_f32_bf16 v128, v128, v4, 0
v_dot2_f32_bf16 v132, v132, v4, 0
v_dot2c_f32_bf16 v120, v121, v5
v_dot2c_f32_bf16 v124, v125, v5
v_dot2c_f32_bf16 v128, v129, v5
v_dot2c_f32_bf16 v132, v133, v5
v_dot2c_f32_bf16 v120, v122, v6
v_dot2c_f32_bf16 v124, v126, v6
v_dot2c_f32_bf16 v128, v130, v6
v_dot2c_f32_bf16 v132, v134, v6
v_dot2c_f32_bf16 v120, v123, v7
v_dot2c_f32_bf16 v124, v127, v7
v_dot2c_f32_bf16 v128, v131, v7
v_dot2c_f32_bf16 v132, v135, v7
v_add_f32_dpp v121, v120, v120 row_ror:8 row_mask:0xf bank_mask:0x3
v_add_f32_dpp v125, v124, v124 row_ror:8 row_mask:0xf bank_mask:0x3
v_add_f32_dpp v121, v128, v128 row_ror:8 row_mask:0xf bank_mask:0xc
v_add_f32_dpp v125, v132, v132 row_ror:8 row_mask:0xf bank_mask:0xc
s_nop 0
v_add_f32_dpp v14, v121, v121 row_shl:4 row_mask:0xf bank_mask:0x5
v_add_f32_dpp v14, v125, v125 row_shr:4 row_mask:0xf bank_mask:0xa
s_nop 1
v_add_f32_dpp v14, v14, v14 quad_perm:[1,0,3,2] row_mask:0xf bank_mask:0xf
s_nop 1
v_add_f32_dpp v14, v14, v14 quad_perm:[2,3,0,1] row_mask:0xf bank_mask:0xf
v_cvt_pk_bf16_f32 v14, 0, v14
v_mul_f32 v14, s66, v14
v_cvt_pk_bf16_f32 v14, 0, v14
s_xor_b32 s64, s65, 198656
s_cmpk_gt_u32 s69, 83
s_waitcnt vmcnt(6)
s_cbranch_scc1 L_d_86
s_waitcnt vmcnt(4)
L_d_86:
buffer_load_dwordx4 v[48:51], v1, s[44:47], s64 offen nt
v_dot2_f32_bf16 v136, v136, v4, 0
v_dot2_f32_bf16 v140, v140, v4, 0
v_dot2_f32_bf16 v144, v144, v4, 0
v_dot2_f32_bf16 v148, v148, v4, 0
v_dot2c_f32_bf16 v136, v137, v5
v_dot2c_f32_bf16 v140, v141, v5
v_dot2c_f32_bf16 v144, v145, v5
v_dot2c_f32_bf16 v148, v149, v5
v_dot2c_f32_bf16 v136, v138, v6
v_dot2c_f32_bf16 v140, v142, v6
v_dot2c_f32_bf16 v144, v146, v6
v_dot2c_f32_bf16 v148, v150, v6
v_dot2c_f32_bf16 v136, v139, v7
v_dot2c_f32_bf16 v140, v143, v7
v_dot2c_f32_bf16 v144, v147, v7
v_dot2c_f32_bf16 v148, v151, v7
v_add_f32_dpp v137, v136, v136 row_ror:8 row_mask:0xf bank_mask:0x3
v_add_f32_dpp v141, v140, v140 row_ror:8 row_mask:0xf bank_mask:0x3
v_add_f32_dpp v137, v144, v144 row_ror:8 row_mask:0xf bank_mask:0xc
v_add_f32_dpp v141, v148, v148 row_ror:8 row_mask:0xf bank_mask:0xc
s_nop 0
v_add_f32_dpp v15, v137, v137 row_shl:4 row_mask:0xf bank_mask:0x5
v_add_f32_dpp v15, v141, v141 row_shr:4 row_mask:0xf bank_mask:0xa
s_nop 1
v_add_f32_dpp v15, v15, v15 quad_perm:[1,0,3,2] row_mask:0xf bank_mask:0xf
s_nop 1
v_add_f32_dpp v15, v15, v15 quad_perm:[2,3,0,1] row_mask:0xf bank_mask:0xf
v_cvt_pk_bf16_f32 v15, 0, v15
v_mul_f32 v15, s66, v15
v_cvt_pk_bf16_f32 v15, 0, v15
s_xor_b32 s64, s65, 132096
s_cmpk_gt_u32 s69, 84
s_waitcnt vmcnt(6)
s_cbranch_scc1 L_d_87
s_waitcnt vmcnt(4)
L_d_87:
buffer_load_dwordx4 v[52:55], v1, s[44:47], s64 offen nt
v_dot2_f32_bf16 v152, v152, v4, 0
v_dot2_f32_bf16 v156, v156, v4, 0
v_dot2_f32_bf16 v160, v160, v4, 0
v_dot2_f32_bf16 v164, v164, v4, 0
v_dot2c_f32_bf16 v152, v153, v5
v_dot2c_f32_bf16 v156, v157, v5
v_dot2c_f32_bf16 v160, v161, v5
v_dot2c_f32_bf16 v164, v165, v5
v_dot2c_f32_bf16 v152, v154, v6
v_dot2c_f32_bf16 v156, v158, v6
v_dot2c_f32_bf16 v160, v162, v6
v_dot2c_f32_bf16 v164, v166, v6
v_dot2c_f32_bf16 v152, v155, v7
v_dot2c_f32_bf16 v156, v159, v7
v_dot2c_f32_bf16 v160, v163, v7
v_dot2c_f32_bf16 v164, v167, v7
v_add_f32_dpp v153, v152, v152 row_ror:8 row_mask:0xf bank_mask:0x3
v_add_f32_dpp v157, v156, v156 row_ror:8 row_mask:0xf bank_mask:0x3
v_add_f32_dpp v153, v160, v160 row_ror:8 row_mask:0xf bank_mask:0xc
v_add_f32_dpp v157, v164, v164 row_ror:8 row_mask:0xf bank_mask:0xc
s_nop 0
v_add_f32_dpp v16, v153, v153 row_shl:4 row_mask:0xf bank_mask:0x5
v_add_f32_dpp v16, v157, v157 row_shr:4 row_mask:0xf bank_mask:0xa
s_nop 1
v_add_f32_dpp v16, v16, v16 quad_perm:[1,0,3,2] row_mask:0xf bank_mask:0xf
s_nop 1
v_add_f32_dpp v16, v16, v16 quad_perm:[2,3,0,1] row_mask:0xf bank_mask:0xf
v_cvt_pk_bf16_f32 v16, 0, v16
v_mul_f32 v16, s66, v16
v_cvt_pk_bf16_f32 v16, 0, v16
s_xor_b32 s64, s65, 197632
s_cmpk_gt_u32 s69, 85
s_waitcnt vmcnt(6)
s_cbranch_scc1 L_d_88
s_waitcnt vmcnt(4)
L_d_88:
buffer_load_dwordx4 v[56:59], v1, s[44:47], s64 offen nt
v_dot2_f32_bf16 v168, v168, v4, 0
v_dot2_f32_bf16 v172, v172, v4, 0
v_dot2_f32_bf16 v176, v176, v4, 0
v_dot2_f32_bf16 v180, v180, v4, 0
v_dot2c_f32_bf16 v168, v169, v5
v_dot2c_f32_bf16 v172, v173, v5
v_dot2c_f32_bf16 v176, v177, v5
v_dot2c_f32_bf16 v180, v181, v5
v_dot2c_f32_bf16 v168, v170, v6
v_dot2c_f32_bf16 v172, v174, v6
v_dot2c_f32_bf16 v176, v178, v6
v_dot2c_f32_bf16 v180, v182, v6
v_dot2c_f32_bf16 v168, v171, v7
v_dot2c_f32_bf16 v172, v175, v7
v_dot2c_f32_bf16 v176, v179, v7
v_dot2c_f32_bf16 v180, v183, v7
v_add_f32_dpp v169, v168, v168 row_ror:8 row_mask:0xf bank_mask:0x3
v_add_f32_dpp v173, v172, v172 row_ror:8 row_mask:0xf bank_mask:0x3
v_add_f32_dpp v169, v176, v176 row_ror:8 row_mask:0xf bank_mask:0xc
v_add_f32_dpp v173, v180, v180 row_ror:8 row_mask:0xf bank_mask:0xc
s_nop 0
v_add_f32_dpp v18, v169, v169 row_shl:4 row_mask:0xf bank_mask:0x5
v_add_f32_dpp v18, v173, v173 row_shr:4 row_mask:0xf bank_mask:0xa
s_nop 1
v_add_f32_dpp v18, v18, v18 quad_perm:[1,0,3,2] row_mask:0xf bank_mask:0xf
s_nop 1
v_add_f32_dpp v18, v18, v18 quad_perm:[2,3,0,1] row_mask:0xf bank_mask:0xf
v_cvt_pk_bf16_f32 v18, 0, v18
v_mul_f32 v18, s66, v18
v_cvt_pk_bf16_f32 v18, 0, v18
s_xor_b32 s64, s65, 134144
s_cmpk_gt_u32 s69, 86
s_waitcnt vmcnt(6)
s_cbranch_scc1 L_d_89
s_waitcnt vmcnt(4)
L_d_89:
buffer_load_dwordx4 v[60:63], v1, s[44:47], s64 offen nt
v_dot2_f32_bf16 v184, v184, v4, 0
v_dot2_f32_bf16 v188, v188, v4, 0
v_dot2_f32_bf16 v192, v192, v4, 0
v_dot2_f32_bf16 v196, v196, v4, 0
v_dot2c_f32_bf16 v184, v185, v5
v_dot2c_f32_bf16 v188, v189, v5
v_dot2c_f32_bf16 v192, v193, v5
v_dot2c_f32_bf16 v196, v197, v5
v_dot2c_f32_bf16 v184, v186, v6
v_dot2c_f32_bf16 v188, v190, v6
v_dot2c_f32_bf16 v192, v194, v6
v_dot2c_f32_bf16 v196, v198, v6
v_dot2c_f32_bf16 v184, v187, v7
v_dot2c_f32_bf16 v188, v191, v7
v_dot2c_f32_bf16 v192, v195, v7
v_dot2c_f32_bf16 v196, v199, v7
v_add_f32_dpp v185, v184, v184 row_ror:8 row_mask:0xf bank_mask:0x3
v_add_f32_dpp v189, v188, v188 row_ror:8 row_mask:0xf bank_mask:0x3
v_add_f32_dpp v185, v192, v192 row_ror:8 row_mask:0xf bank_mask:0xc
v_add_f32_dpp v189, v196, v196 row_ror:8 row_mask:0xf bank_mask:0xc
s_nop 0
v_add_f32_dpp v19, v185, v185 row_shl:4 row_mask:0xf bank_mask:0x5
v_add_f32_dpp v19, v189, v189 row_shr:4 row_mask:0xf bank_mask:0xa
s_nop 1
v_add_f32_dpp v19, v19, v19 quad_perm:[1,0,3,2] row_mask:0xf bank_mask:0xf
s_nop 1
v_add_f32_dpp v19, v19, v19 quad_perm:[2,3,0,1] row_mask:0xf bank_mask:0xf
v_cvt_pk_bf16_f32 v19, 0, v19
v_mul_f32 v19, s66, v19
v_cvt_pk_bf16_f32 v19, 0, v19
s_xor_b32 s64, s65, 199680
s_cmpk_gt_u32 s69, 87
s_waitcnt vmcnt(6)
s_cbranch_scc1 L_d_90
s_waitcnt vmcnt(4)
L_d_90:
buffer_load_dwordx4 v[64:67], v1, s[44:47], s64 offen nt
v_dot2_f32_bf16 v200, v200, v4, 0
v_dot2_f32_bf16 v204, v204, v4, 0
v_dot2_f32_bf16 v208, v208, v4, 0
v_dot2_f32_bf16 v212, v212, v4, 0
v_dot2c_f32_bf16 v200, v201, v5
v_dot2c_f32_bf16 v204, v205, v5
v_dot2c_f32_bf16 v208, v209, v5
v_dot2c_f32_bf16 v212, v213, v5
v_dot2c_f32_bf16 v200, v202, v6
v_dot2c_f32_bf16 v204, v206, v6
v_dot2c_f32_bf16 v208, v210, v6
v_dot2c_f32_bf16 v212, v214, v6
v_dot2c_f32_bf16 v200, v203, v7
v_dot2c_f32_bf16 v204, v207, v7
v_dot2c_f32_bf16 v208, v211, v7
v_dot2c_f32_bf16 v212, v215, v7
v_add_f32_dpp v201, v200, v200 row_ror:8 row_mask:0xf bank_mask:0x3
v_add_f32_dpp v205, v204, v204 row_ror:8 row_mask:0xf bank_mask:0x3
v_add_f32_dpp v201, v208, v208 row_ror:8 row_mask:0xf bank_mask:0xc
v_add_f32_dpp v205, v212, v212 row_ror:8 row_mask:0xf bank_mask:0xc
s_nop 0
v_add_f32_dpp v20, v201, v201 row_shl:4 row_mask:0xf bank_mask:0x5
v_add_f32_dpp v20, v205, v205 row_shr:4 row_mask:0xf bank_mask:0xa
s_nop 1
v_add_f32_dpp v20, v20, v20 quad_perm:[1,0,3,2] row_mask:0xf bank_mask:0xf
s_nop 1
v_add_f32_dpp v20, v20, v20 quad_perm:[2,3,0,1] row_mask:0xf bank_mask:0xf
v_cvt_pk_bf16_f32 v20, 0, v20
v_mul_f32 v20, s66, v20
v_cvt_pk_bf16_f32 v20, 0, v20
s_xor_b32 s64, s65, 163840
s_cmpk_gt_u32 s69, 88
s_waitcnt vmcnt(6)
s_cbranch_scc1 L_d_91
s_waitcnt vmcnt(4)
L_d_91:
buffer_load_dwordx4 v[68:71], v1, s[44:47], s64 offen nt
v_dot2_f32_bf16 v216, v216, v4, 0
v_dot2_f32_bf16 v220, v220, v4, 0
v_dot2_f32_bf16 v224, v224, v4, 0
v_dot2_f32_bf16 v228, v228, v4, 0
v_dot2c_f32_bf16 v216, v217, v5
v_dot2c_f32_bf16 v220, v221, v5
v_dot2c_f32_bf16 v224, v225, v5
v_dot2c_f32_bf16 v228, v229, v5
v_dot2c_f32_bf16 v216, v218, v6
v_dot2c_f32_bf16 v220, v222, v6
v_dot2c_f32_bf16 v224, v226, v6
v_dot2c_f32_bf16 v228, v230, v6
v_dot2c_f32_bf16 v216, v219, v7
v_dot2c_f32_bf16 v220, v223, v7
v_dot2c_f32_bf16 v224, v227, v7
v_dot2c_f32_bf16 v228, v231, v7
v_add_f32_dpp v217, v216, v216 row_ror:8 row_mask:0xf bank_mask:0x3
v_add_f32_dpp v221, v220, v220 row_ror:8 row_mask:0xf bank_mask:0x3
v_add_f32_dpp v217, v224, v224 row_ror:8 row_mask:0xf bank_mask:0xc
v_add_f32_dpp v221, v228, v228 row_ror:8 row_mask:0xf bank_mask:0xc
s_nop 0
v_add_f32_dpp v21, v217, v217 row_shl:4 row_mask:0xf bank_mask:0x5
v_add_f32_dpp v21, v221, v221 row_shr:4 row_mask:0xf bank_mask:0xa
s_nop 1
v_add_f32_dpp v21, v21, v21 quad_perm:[1,0,3,2] row_mask:0xf bank_mask:0xf
s_nop 1
v_add_f32_dpp v21, v21, v21 quad_perm:[2,3,0,1] row_mask:0xf bank_mask:0xf
v_cvt_pk_bf16_f32 v21, 0, v21
v_mul_f32 v21, s66, v21
v_cvt_pk_bf16_f32 v21, 0, v21
s_xor_b32 s64, s65, 229376
s_cmpk_gt_u32 s69, 89
s_waitcnt vmcnt(6)
s_cbranch_scc1 L_d_92
s_waitcnt vmcnt(4)
L_d_92:
buffer_load_dwordx4 v[72:75], v1, s[44:47], s64 offen nt
v_dot2_f32_bf16 v232, v232, v4, 0
v_dot2_f32_bf16 v236, v236, v4, 0
v_dot2_f32_bf16 v240, v240, v4, 0
v_dot2_f32_bf16 v244, v244, v4, 0
v_dot2c_f32_bf16 v232, v233, v5
v_dot2c_f32_bf16 v236, v237, v5
v_dot2c_f32_bf16 v240, v241, v5
v_dot2c_f32_bf16 v244, v245, v5
v_dot2c_f32_bf16 v232, v234, v6
v_dot2c_f32_bf16 v236, v238, v6
v_dot2c_f32_bf16 v240, v242, v6
v_dot2c_f32_bf16 v244, v246, v6
v_dot2c_f32_bf16 v232, v235, v7
v_dot2c_f32_bf16 v236, v239, v7
v_dot2c_f32_bf16 v240, v243, v7
v_dot2c_f32_bf16 v244, v247, v7
v_add_f32_dpp v233, v232, v232 row_ror:8 row_mask:0xf bank_mask:0x3
v_add_f32_dpp v237, v236, v236 row_ror:8 row_mask:0xf bank_mask:0x3
v_add_f32_dpp v233, v240, v240 row_ror:8 row_mask:0xf bank_mask:0xc
v_add_f32_dpp v237, v244, v244 row_ror:8 row_mask:0xf bank_mask:0xc
s_nop 0
v_add_f32_dpp v22, v233, v233 row_shl:4 row_mask:0xf bank_mask:0x5
v_add_f32_dpp v22, v237, v237 row_shr:4 row_mask:0xf bank_mask:0xa
s_nop 1
v_add_f32_dpp v22, v22, v22 quad_perm:[1,0,3,2] row_mask:0xf bank_mask:0xf
s_nop 1
v_add_f32_dpp v22, v22, v22 quad_perm:[2,3,0,1] row_mask:0xf bank_mask:0xf
v_cvt_pk_bf16_f32 v22, 0, v22
v_mul_f32 v22, s66, v22
v_cvt_pk_bf16_f32 v22, 0, v22
s_xor_b32 s64, s65, 165888
s_cmpk_gt_u32 s69, 90
s_waitcnt vmcnt(6)
s_cbranch_scc1 L_d_93
s_waitcnt vmcnt(5)
L_d_93:
buffer_load_dwordx4 v[76:79], v1, s[44:47], s64 offen nt
v_lshl_add_u32 v80, v0, 4, s70
ds_read_b128 v[84:87], v80 offset:0
ds_read_b128 v[88:91], v80 offset:1024
s_waitcnt lgkmcnt(0)
v_dot2_f32_bf16 v248, v248, v4, 0
v_dot2_f32_bf16 v252, v252, v4, 0
v_dot2_f32_bf16 v84, v84, v4, 0
v_dot2_f32_bf16 v88, v88, v4, 0
v_dot2c_f32_bf16 v248, v249, v5
v_dot2c_f32_bf16 v252, v253, v5
v_dot2c_f32_bf16 v84, v85, v5
v_dot2c_f32_bf16 v88, v89, v5
v_dot2c_f32_bf16 v248, v250, v6
v_dot2c_f32_bf16 v252, v254, v6
v_dot2c_f32_bf16 v84, v86, v6
v_dot2c_f32_bf16 v88, v90, v6
v_dot2c_f32_bf16 v248, v251, v7
v_dot2c_f32_bf16 v252, v255, v7
v_dot2c_f32_bf16 v84, v87, v7
v_dot2c_f32_bf16 v88, v91, v7
v_add_f32_dpp v249, v248, v248 row_ror:8 row_mask:0xf bank_mask:0x3
v_add_f32_dpp v253, v252, v252 row_ror:8 row_mask:0xf bank_mask:0x3
v_add_f32_dpp v249, v84, v84 row_ror:8 row_mask:0xf bank_mask:0xc
v_add_f32_dpp v253, v88, v88 row_ror:8 row_mask:0xf bank_mask:0xc
s_nop 0
v_add_f32_dpp v23, v249, v249 row_shl:4 row_mask:0xf bank_mask:0x5
v_add_f32_dpp v23, v253, v253 row_shr:4 row_mask:0xf bank_mask:0xa
s_nop 1
v_add_f32_dpp v23, v23, v23 quad_perm:[1,0,3,2] row_mask:0xf bank_mask:0xf
s_nop 1
v_add_f32_dpp v23, v23, v23 quad_perm:[2,3,0,1] row_mask:0xf bank_mask:0xf
v_cvt_pk_bf16_f32 v23, 0, v23
v_mul_f32 v23, s66, v23
v_cvt_pk_bf16_f32 v23, 0, v23
s_xor_b32 s64, s65, 231424
s_cmpk_gt_u32 s69, 91
s_waitcnt vmcnt(6)
s_cbranch_scc1 L_d_94
s_waitcnt vmcnt(5)
L_d_94:
buffer_load_dwordx4 v[92:95], v1, s[44:47], s64 offen nt
v_max3_f32 v2, v17, v8, v9
v_max3_f32 v2, v2, v10, v11
v_max3_f32 v2, v2, v12, v13
v_max3_f32 v2, v2, v14, v15
v_max3_f32 v2, v2, v16, v18
v_max3_f32 v2, v2, v19, v20
v_max3_f32 v2, v2, v21, v22
v_max_f32 v2, v2, v23
v_max_f32 v2, 0xff7fffff, v2
s_nop 1
v_max_f32_dpp v2, v2, v2 row_ror:4 row_mask:0xf bank_mask:0xf
s_nop 1
v_max_f32_dpp v2, v2, v2 row_ror:8 row_mask:0xf bank_mask:0xf
v_mov_b32 v3, v2
s_nop 1
v_permlane16_swap_b32 v2, v3
s_nop 1
v_max_f32 v2, v2, v3
v_mov_b32 v3, v2
s_nop 1
v_permlane32_swap_b32 v2, v3
s_nop 1
v_max_f32 v2, v2, v3
s_mov_b32 s67, 0x3fb8aa3b
v_sub_f32 v17, v17, v2
v_sub_f32 v8, v8, v2
v_sub_f32 v9, v9, v2
v_sub_f32 v10, v10, v2
v_sub_f32 v11, v11, v2
v_sub_f32 v12, v12, v2
v_sub_f32 v13, v13, v2
v_sub_f32 v14, v14, v2
v_sub_f32 v15, v15, v2
v_sub_f32 v16, v16, v2
v_sub_f32 v18, v18, v2
v_sub_f32 v19, v19, v2
v_sub_f32 v20, v20, v2
v_sub_f32 v21, v21, v2
v_sub_f32 v22, v22, v2
v_sub_f32 v23, v23, v2
v_mul_f32 v17, s67, v17
v_mul_f32 v8, s67, v8
v_mul_f32 v9, s67, v9
v_mul_f32 v10, s67, v10
v_mul_f32 v11, s67, v11
v_mul_f32 v12, s67, v12
v_mul_f32 v13, s67, v13
v_mul_f32 v14, s67, v14
v_mul_f32 v15, s67, v15
v_mul_f32 v16, s67, v16
v_mul_f32 v18, s67, v18
v_mul_f32 v19, s67, v19
v_mul_f32 v20, s67, v20
v_mul_f32 v21, s67, v21
v_mul_f32 v22, s67, v22
v_mul_f32 v23, s67, v23
s_xor_b32 s64, s65, 164864
s_cmpk_gt_u32 s69, 92
s_waitcnt vmcnt(6)
s_cbranch_scc1 L_d_95
s_waitcnt vmcnt(5)
L_d_95:
buffer_load_dwordx4 v[116:119], v1, s[44:47], s64 offen nt
v_exp_f32 v17, v17
v_exp_f32 v8, v8
v_exp_f32 v9, v9
v_exp_f32 v10, v10
v_exp_f32 v11, v11
v_exp_f32 v12, v12
v_exp_f32 v13, v13
v_exp_f32 v14, v14
v_exp_f32 v15, v15
v_exp_f32 v16, v16
v_exp_f32 v18, v18
v_exp_f32 v19, v19
v_exp_f32 v20, v20
v_exp_f32 v21, v21
v_exp_f32 v22, v22
v_exp_f32 v23, v23
v_add_f32 v3, v17, v8
v_add_f32 v3, v3, v9
v_add_f32 v3, v3, v10
v_add_f32 v3, v3, v11
v_add_f32 v3, v3, v12
v_add_f32 v3, v3, v13
v_add_f32 v3, v3, v14
v_add_f32 v3, v3, v15
v_add_f32 v3, v3, v16
v_add_f32 v3, v3, v18
v_add_f32 v3, v3, v19
v_add_f32 v3, v3, v20
v_add_f32 v3, v3, v21
v_add_f32 v3, v3, v22
v_add_f32 v3, v3, v23
s_nop 1
v_add_f32_dpp v3, v3, v3 row_ror:4 row_mask:0xf bank_mask:0xf
s_nop 1
v_add_f32_dpp v3, v3, v3 row_ror:8 row_mask:0xf bank_mask:0xf
v_mov_b32 v96, v3
s_nop 1
v_permlane16_swap_b32 v3, v96
s_nop 1
v_add_f32 v3, v3, v96
v_mov_b32 v96, v3
s_nop 1
v_permlane32_swap_b32 v3, v96
s_nop 1
v_add_f32 v3, v3, v96
v_min_u32 v3, -2, v3
s_lshl_b32 s68, s34, 3
v_mov_b32 v96, s68
ds_write_b64 v96, v[2:3] offset:256
v_and_b32 v97, 15, v0
v_lshrrev_b32 v98, 1, v97
v_and_b32 v97, 1, v0
v_lshlrev_b32 v97, 4, v97
v_mov_b32 v99, 0xffff
v_lshlrev_b32 v97, v97, v99
v_cmp_eq_u32 vcc, 0, v98
s_nop 1
v_cndmask_b32 v4, 0, v97, vcc
v_cmp_eq_u32 vcc, 1, v98
s_nop 1
v_cndmask_b32 v5, 0, v97, vcc
v_cmp_eq_u32 vcc, 2, v98
s_nop 1
v_cndmask_b32 v6, 0, v97, vcc
v_cmp_eq_u32 vcc, 3, v98
s_nop 1
v_cndmask_b32 v7, 0, v97, vcc
s_xor_b32 s64, s65, 230400
s_cmpk_gt_u32 s69, 93
s_waitcnt vmcnt(6)
s_cbranch_scc1 L_d_96
s_waitcnt vmcnt(5)
L_d_96:
buffer_load_dwordx4 v[120:123], v1, s[44:47], s64 offen nt
v_mov_b32 v96, 0
s_mov_b32 s75, 0
L_poll_97:
ds_read_b128 v[100:103], v96 offset:256
ds_read_b128 v[104:107], v96 offset:272
s_waitcnt lgkmcnt(0)
v_max3_u32 v97, v101, v103, v105
v_max_u32 v97, v97, v107
v_cmp_eq_u32 vcc, -1, v97
s_cbranch_vccz L_pollx_98
s_add_u32 s75, s75, 1
s_cmp_lt_u32 s75, 0x1000000
s_cbranch_scc1 L_poll_97
L_pollx_98:
v_max3_f32 v97, v100, v102, v104
v_max_f32 v97, v97, v106
v_sub_f32 v100, v100, v97
v_sub_f32 v102, v102, v97
v_sub_f32 v104, v104, v97
v_sub_f32 v106, v106, v97
v_sub_f32 v2, v2, v97
v_mul_f32 v100, s67, v100
v_mul_f32 v102, s67, v102
v_mul_f32 v104, s67, v104
v_mul_f32 v106, s67, v106
v_mul_f32 v2, s67, v2
v_exp_f32 v100, v100
v_exp_f32 v102, v102
v_exp_f32 v104, v104
v_exp_f32 v106, v106
v_exp_f32 v2, v2
v_mul_f32 v3, v100, v101
v_fmac_f32 v3, v102, v103
v_fmac_f32 v3, v104, v105
v_fmac_f32 v3, v106, v107
v_rcp_f32 v3, v3
s_nop 0
v_mul_f32 v2, v2, v3
v_mul_f32 v17, v17, v2
v_mul_f32 v8, v8, v2
v_mul_f32 v9, v9, v2
v_mul_f32 v10, v10, v2
v_mul_f32 v11, v11, v2
v_mul_f32 v12, v12, v2
v_mul_f32 v13, v13, v2
v_mul_f32 v14, v14, v2
v_mul_f32 v15, v15, v2
v_mul_f32 v16, v16, v2
v_mul_f32 v18, v18, v2
v_mul_f32 v19, v19, v2
v_mul_f32 v20, v20, v2
v_mul_f32 v21, v21, v2
v_mul_f32 v22, v22, v2
v_mul_f32 v23, v23, v2
v_cvt_pk_bf16_f32 v17, v17, v17
v_cvt_pk_bf16_f32 v8, v8, v8
v_cvt_pk_bf16_f32 v9, v9, v9
v_cvt_pk_bf16_f32 v10, v10, v10
v_cvt_pk_bf16_f32 v11, v11, v11
v_cvt_pk_bf16_f32 v12, v12, v12
v_cvt_pk_bf16_f32 v13, v13, v13
v_cvt_pk_bf16_f32 v14, v14, v14
v_cvt_pk_bf16_f32 v15, v15, v15
v_cvt_pk_bf16_f32 v16, v16, v16
v_cvt_pk_bf16_f32 v18, v18, v18
v_cvt_pk_bf16_f32 v19, v19, v19
v_cvt_pk_bf16_f32 v20, v20, v20
v_cvt_pk_bf16_f32 v21, v21, v21
v_cvt_pk_bf16_f32 v22, v22, v22
v_cvt_pk_bf16_f32 v23, v23, v23
s_nop 1
s_and_b32 s62, s2, 7
s_lshl_b32 s62, s62, 9
s_add_u32 s62, s62, 1327104
s_lshr_b32 s63, s2, 3
s_lshl_b32 s63, s63, 2
s_add_u32 s63, s63, s62
s_cmp_eq_u32 s34, 0
s_cbranch_scc0 L_w_100
v_mov_b32 v124, 30
s_mov_b64 exec, 1
buffer_store_dword v124, off, s[36:39], s63 offset:0
s_mov_b64 exec, -1
L_w_100:
s_xor_b32 s64, s65, 166912
s_cmpk_gt_u32 s69, 94
s_waitcnt vmcnt(6)
s_cbranch_scc1 L_d_99
s_waitcnt vmcnt(5)
L_d_99:
buffer_load_dwordx4 v[128:131], v1, s[44:47], s64 offen nt
ds_read_b128 v[132:135], v80 offset:2048
ds_read_b128 v[136:139], v80 offset:3072
ds_read_b128 v[140:143], v80 offset:4096
ds_read_b128 v[144:147], v80 offset:5120
ds_read_b128 v[148:151], v80 offset:6144
ds_read_b128 v[152:155], v80 offset:7168
ds_read_b128 v[156:159], v80 offset:8192
ds_read_b128 v[160:163], v80 offset:9216
s_waitcnt lgkmcnt(0)
v_and_b32_dpp v100, v17, v4 row_newbcast:0 row_mask:0xf bank_mask:0xf
v_and_b32_dpp v101, v17, v5 row_newbcast:0 row_mask:0xf bank_mask:0xf
v_and_b32_dpp v102, v17, v6 row_newbcast:0 row_mask:0xf bank_mask:0xf
v_and_b32_dpp v103, v17, v7 row_newbcast:0 row_mask:0xf bank_mask:0xf
v_and_b32_dpp v104, v17, v4 row_newbcast:4 row_mask:0xf bank_mask:0xf
v_and_b32_dpp v105, v17, v5 row_newbcast:4 row_mask:0xf bank_mask:0xf
v_and_b32_dpp v106, v17, v6 row_newbcast:4 row_mask:0xf bank_mask:0xf
v_and_b32_dpp v107, v17, v7 row_newbcast:4 row_mask:0xf bank_mask:0xf
v_mfma_f32_16x16x32_bf16 v[108:111], v[100:103], v[132:135], 0
v_and_b32_dpp v100, v17, v4 row_newbcast:8 row_mask:0xf bank_mask:0xf
v_and_b32_dpp v101, v17, v5 row_newbcast:8 row_mask:0xf bank_mask:0xf
v_and_b32_dpp v102, v17, v6 row_newbcast:8 row_mask:0xf bank_mask:0xf
v_and_b32_dpp v103, v17, v7 row_newbcast:8 row_mask:0xf bank_mask:0xf
v_mfma_f32_16x16x32_bf16 v[108:111], v[104:107], v[136:139], v[108:111]
v_and_b32_dpp v104, v17, v4 row_newbcast:12 row_mask:0xf bank_mask:0xf
v_and_b32_dpp v105, v17, v5 row_newbcast:12 row_mask:0xf bank_mask:0xf
v_and_b32_dpp v106, v17, v6 row_newbcast:12 row_mask:0xf bank_mask:0xf
v_and_b32_dpp v107, v17, v7 row_newbcast:12 row_mask:0xf bank_mask:0xf
v_mfma_f32_16x16x32_bf16 v[108:111], v[100:103], v[140:143], v[108:111]
v_and_b32_dpp v100, v8, v4 row_newbcast:0 row_mask:0xf bank_mask:0xf
v_and_b32_dpp v101, v8, v5 row_newbcast:0 row_mask:0xf bank_mask:0xf
v_and_b32_dpp v102, v8, v6 row_newbcast:0 row_mask:0xf bank_mask:0xf
v_and_b32_dpp v103, v8, v7 row_newbcast:0 row_mask:0xf bank_mask:0xf
v_mfma_f32_16x16x32_bf16 v[108:111], v[104:107], v[144:147], v[108:111]
v_and_b32_dpp v104, v8, v4 row_newbcast:4 row_mask:0xf bank_mask:0xf
v_and_b32_dpp v105, v8, v5 row_newbcast:4 row_mask:0xf bank_mask:0xf
v_and_b32_dpp v106, v8, v6 row_newbcast:4 row_mask:0xf bank_mask:0xf
v_and_b32_dpp v107, v8, v7 row_newbcast:4 row_mask:0xf bank_mask:0xf
v_mfma_f32_16x16x32_bf16 v[108:111], v[100:103], v[148:151], v[108:111]
s_xor_b32 s64, s65, 232448
s_cmpk_gt_u32 s69, 95
s_waitcnt vmcnt(6)
s_cbranch_scc1 L_d_101
s_waitcnt vmcnt(5)
L_d_101:
buffer_load_dwordx4 v[164:167], v1, s[44:47], s64 offen nt
v_and_b32_dpp v100, v8, v4 row_newbcast:8 row_mask:0xf bank_mask:0xf
v_and_b32_dpp v101, v8, v5 row_newbcast:8 row_mask:0xf bank_mask:0xf
v_and_b32_dpp v102, v8, v6 row_newbcast:8 row_mask:0xf bank_mask:0xf
v_and_b32_dpp v103, v8, v7 row_newbcast:8 row_mask:0xf bank_mask:0xf
v_mfma_f32_16x16x32_bf16 v[108:111], v[104:107], v[152:155], v[108:111]
v_and_b32_dpp v104, v8, v4 row_newbcast:12 row_mask:0xf bank_mask:0xf
v_and_b32_dpp v105, v8, v5 row_newbcast:12 row_mask:0xf bank_mask:0xf
v_and_b32_dpp v106, v8, v6 row_newbcast:12 row_mask:0xf bank_mask:0xf
v_and_b32_dpp v107, v8, v7 row_newbcast:12 row_mask:0xf bank_mask:0xf
v_mfma_f32_16x16x32_bf16 v[108:111], v[100:103], v[156:159], v[108:111]
v_and_b32_dpp v100, v9, v4 row_newbcast:0 row_mask:0xf bank_mask:0xf
v_and_b32_dpp v101, v9, v5 row_newbcast:0 row_mask:0xf bank_mask:0xf
v_and_b32_dpp v102, v9, v6 row_newbcast:0 row_mask:0xf bank_mask:0xf
v_and_b32_dpp v103, v9, v7 row_newbcast:0 row_mask:0xf bank_mask:0xf
v_mfma_f32_16x16x32_bf16 v[108:111], v[104:107], v[160:163], v[108:111]
ds_read_b128 v[168:171], v80 offset:10240
ds_read_b128 v[172:175], v80 offset:11264
ds_read_b128 v[176:179], v80 offset:12288
ds_read_b128 v[180:183], v80 offset:13312
ds_read_b128 v[184:187], v80 offset:14336
s_waitcnt lgkmcnt(0)
v_and_b32_dpp v104, v9, v4 row_newbcast:4 row_mask:0xf bank_mask:0xf
v_and_b32_dpp v105, v9, v5 row_newbcast:4 row_mask:0xf bank_mask:0xf
v_and_b32_dpp v106, v9, v6 row_newbcast:4 row_mask:0xf bank_mask:0xf
v_and_b32_dpp v107, v9, v7 row_newbcast:4 row_mask:0xf bank_mask:0xf
v_mfma_f32_16x16x32_bf16 v[108:111], v[100:103], v[168:171], v[108:111]
v_and_b32_dpp v100, v9, v4 row_newbcast:8 row_mask:0xf bank_mask:0xf
v_and_b32_dpp v101, v9, v5 row_newbcast:8 row_mask:0xf bank_mask:0xf
v_and_b32_dpp v102, v9, v6 row_newbcast:8 row_mask:0xf bank_mask:0xf
v_and_b32_dpp v103, v9, v7 row_newbcast:8 row_mask:0xf bank_mask:0xf
v_mfma_f32_16x16x32_bf16 v[108:111], v[104:107], v[172:175], v[108:111]
s_xor_b32 s64, s65, 4096
s_cmpk_gt_u32 s69, 96
s_waitcnt vmcnt(6)
s_cbranch_scc1 L_d_102
s_waitcnt vmcnt(5)
L_d_102:
buffer_load_dwordx4 v[188:191], v1, s[44:47], s64 offen nt
v_and_b32_dpp v104, v9, v4 row_newbcast:12 row_mask:0xf bank_mask:0xf
v_and_b32_dpp v105, v9, v5 row_newbcast:12 row_mask:0xf bank_mask:0xf
v_and_b32_dpp v106, v9, v6 row_newbcast:12 row_mask:0xf bank_mask:0xf
v_and_b32_dpp v107, v9, v7 row_newbcast:12 row_mask:0xf bank_mask:0xf
v_mfma_f32_16x16x32_bf16 v[108:111], v[100:103], v[176:179], v[108:111]
v_and_b32_dpp v100, v10, v4 row_newbcast:0 row_mask:0xf bank_mask:0xf
v_and_b32_dpp v101, v10, v5 row_newbcast:0 row_mask:0xf bank_mask:0xf
v_and_b32_dpp v102, v10, v6 row_newbcast:0 row_mask:0xf bank_mask:0xf
v_and_b32_dpp v103, v10, v7 row_newbcast:0 row_mask:0xf bank_mask:0xf
v_mfma_f32_16x16x32_bf16 v[108:111], v[104:107], v[180:183], v[108:111]
v_and_b32_dpp v104, v10, v4 row_newbcast:4 row_mask:0xf bank_mask:0xf
v_and_b32_dpp v105, v10, v5 row_newbcast:4 row_mask:0xf bank_mask:0xf
v_and_b32_dpp v106, v10, v6 row_newbcast:4 row_mask:0xf bank_mask:0xf
v_and_b32_dpp v107, v10, v7 row_newbcast:4 row_mask:0xf bank_mask:0xf
v_mfma_f32_16x16x32_bf16 v[108:111], v[100:103], v[184:187], v[108:111]
v_and_b32_dpp v100, v10, v4 row_newbcast:8 row_mask:0xf bank_mask:0xf
v_and_b32_dpp v101, v10, v5 row_newbcast:8 row_mask:0xf bank_mask:0xf
v_and_b32_dpp v102, v10, v6 row_newbcast:8 row_mask:0xf bank_mask:0xf
v_and_b32_dpp v103, v10, v7 row_newbcast:8 row_mask:0xf bank_mask:0xf
v_mfma_f32_16x16x32_bf16 v[108:111], v[104:107], v[24:27], v[108:111]
v_and_b32_dpp v104, v10, v4 row_newbcast:12 row_mask:0xf bank_mask:0xf
v_and_b32_dpp v105, v10, v5 row_newbcast:12 row_mask:0xf bank_mask:0xf
v_and_b32_dpp v106, v10, v6 row_newbcast:12 row_mask:0xf bank_mask:0xf
v_and_b32_dpp v107, v10, v7 row_newbcast:12 row_mask:0xf bank_mask:0xf
v_mfma_f32_16x16x32_bf16 v[108:111], v[100:103], v[28:31], v[108:111]
s_xor_b32 s64, s65, 69632
s_cmpk_gt_u32 s69, 97
s_waitcnt vmcnt(6)
s_cbranch_scc1 L_d_103
s_waitcnt vmcnt(5)
L_d_103:
buffer_load_dwordx4 v[192:195], v1, s[44:47], s64 offen nt
v_and_b32_dpp v100, v11, v4 row_newbcast:0 row_mask:0xf bank_mask:0xf
v_and_b32_dpp v101, v11, v5 row_newbcast:0 row_mask:0xf bank_mask:0xf
v_and_b32_dpp v102, v11, v6 row_newbcast:0 row_mask:0xf bank_mask:0xf
v_and_b32_dpp v103, v11, v7 row_newbcast:0 row_mask:0xf bank_mask:0xf
v_mfma_f32_16x16x32_bf16 v[108:111], v[104:107], v[32:35], v[108:111]
v_and_b32_dpp v104, v11, v4 row_newbcast:4 row_mask:0xf bank_mask:0xf
v_and_b32_dpp v105, v11, v5 row_newbcast:4 row_mask:0xf bank_mask:0xf
v_and_b32_dpp v106, v11, v6 row_newbcast:4 row_mask:0xf bank_mask:0xf
v_and_b32_dpp v107, v11, v7 row_newbcast:4 row_mask:0xf bank_mask:0xf
v_mfma_f32_16x16x32_bf16 v[108:111], v[100:103], v[36:39], v[108:111]
v_and_b32_dpp v100, v11, v4 row_newbcast:8 row_mask:0xf bank_mask:0xf
v_and_b32_dpp v101, v11, v5 row_newbcast:8 row_mask:0xf bank_mask:0xf
v_and_b32_dpp v102, v11, v6 row_newbcast:8 row_mask:0xf bank_mask:0xf
v_and_b32_dpp v103, v11, v7 row_newbcast:8 row_mask:0xf bank_mask:0xf
v_mfma_f32_16x16x32_bf16 v[108:111], v[104:107], v[40:43], v[108:111]
v_and_b32_dpp v104, v11, v4 row_newbcast:12 row_mask:0xf bank_mask:0xf
v_and_b32_dpp v105, v11, v5 row_newbcast:12 row_mask:0xf bank_mask:0xf
v_and_b32_dpp v106, v11, v6 row_newbcast:12 row_mask:0xf bank_mask:0xf
v_and_b32_dpp v107, v11, v7 row_newbcast:12 row_mask:0xf bank_mask:0xf
v_mfma_f32_16x16x32_bf16 v[108:111], v[100:103], v[44:47], v[108:111]
v_and_b32_dpp v100, v12, v4 row_newbcast:0 row_mask:0xf bank_mask:0xf
v_and_b32_dpp v101, v12, v5 row_newbcast:0 row_mask:0xf bank_mask:0xf
v_and_b32_dpp v102, v12, v6 row_newbcast:0 row_mask:0xf bank_mask:0xf
v_and_b32_dpp v103, v12, v7 row_newbcast:0 row_mask:0xf bank_mask:0xf
v_mfma_f32_16x16x32_bf16 v[108:111], v[104:107], v[48:51], v[108:111]
s_xor_b32 s64, s65, 6144
s_cmpk_gt_u32 s69, 98
s_waitcnt vmcnt(6)
s_cbranch_scc1 L_d_104
s_waitcnt vmcnt(5)
L_d_104:
buffer_load_dwordx4 v[196:199], v1, s[44:47], s64 offen nt
v_and_b32_dpp v104, v12, v4 row_newbcast:4 row_mask:0xf bank_mask:0xf
v_and_b32_dpp v105, v12, v5 row_newbcast:4 row_mask:0xf bank_mask:0xf
v_and_b32_dpp v106, v12, v6 row_newbcast:4 row_mask:0xf bank_mask:0xf
v_and_b32_dpp v107, v12, v7 row_newbcast:4 row_mask:0xf bank_mask:0xf
v_mfma_f32_16x16x32_bf16 v[108:111], v[100:103], v[52:55], v[108:111]
v_and_b32_dpp v100, v12, v4 row_newbcast:8 row_mask:0xf bank_mask:0xf
v_and_b32_dpp v101, v12, v5 row_newbcast:8 row_mask:0xf bank_mask:0xf
v_and_b32_dpp v102, v12, v6 row_newbcast:8 row_mask:0xf bank_mask:0xf
v_and_b32_dpp v103, v12, v7 row_newbcast:8 row_mask:0xf bank_mask:0xf
v_mfma_f32_16x16x32_bf16 v[108:111], v[104:107], v[56:59], v[108:111]
v_and_b32_dpp v104, v12, v4 row_newbcast:12 row_mask:0xf bank_mask:0xf
v_and_b32_dpp v105, v12, v5 row_newbcast:12 row_mask:0xf bank_mask:0xf
v_and_b32_dpp v106, v12, v6 row_newbcast:12 row_mask:0xf bank_mask:0xf
v_and_b32_dpp v107, v12, v7 row_newbcast:12 row_mask:0xf bank_mask:0xf
v_mfma_f32_16x16x32_bf16 v[108:111], v[100:103], v[60:63], v[108:111]
v_and_b32_dpp v100, v13, v4 row_newbcast:0 row_mask:0xf bank_mask:0xf
v_and_b32_dpp v101, v13, v5 row_newbcast:0 row_mask:0xf bank_mask:0xf
v_and_b32_dpp v102, v13, v6 row_newbcast:0 row_mask:0xf bank_mask:0xf
v_and_b32_dpp v103, v13, v7 row_newbcast:0 row_mask:0xf bank_mask:0xf
v_mfma_f32_16x16x32_bf16 v[108:111], v[104:107], v[64:67], v[108:111]
v_and_b32_dpp v104, v13, v4 row_newbcast:4 row_mask:0xf bank_mask:0xf
v_and_b32_dpp v105, v13, v5 row_newbcast:4 row_mask:0xf bank_mask:0xf
v_and_b32_dpp v106, v13, v6 row_newbcast:4 row_mask:0xf bank_mask:0xf
v_and_b32_dpp v107, v13, v7 row_newbcast:4 row_mask:0xf bank_mask:0xf
v_mfma_f32_16x16x32_bf16 v[108:111], v[100:103], v[68:71], v[108:111]
s_xor_b32 s64, s65, 71680
s_cmpk_gt_u32 s69, 99
s_waitcnt vmcnt(6)
s_cbranch_scc1 L_d_105
s_waitcnt vmcnt(5)
L_d_105:
buffer_load_dwordx4 v[200:203], v1, s[44:47], s64 offen nt
v_and_b32_dpp v100, v13, v4 row_newbcast:8 row_mask:0xf bank_mask:0xf
v_and_b32_dpp v101, v13, v5 row_newbcast:8 row_mask:0xf bank_mask:0xf
v_and_b32_dpp v102, v13, v6 row_newbcast:8 row_mask:0xf bank_mask:0xf
v_and_b32_dpp v103, v13, v7 row_newbcast:8 row_mask:0xf bank_mask:0xf
v_mfma_f32_16x16x32_bf16 v[108:111], v[104:107], v[72:75], v[108:111]
v_and_b32_dpp v104, v13, v4 row_newbcast:12 row_mask:0xf bank_mask:0xf
v_and_b32_dpp v105, v13, v5 row_newbcast:12 row_mask:0xf bank_mask:0xf
v_and_b32_dpp v106, v13, v6 row_newbcast:12 row_mask:0xf bank_mask:0xf
v_and_b32_dpp v107, v13, v7 row_newbcast:12 row_mask:0xf bank_mask:0xf
v_mfma_f32_16x16x32_bf16 v[108:111], v[100:103], v[76:79], v[108:111]
v_and_b32_dpp v100, v14, v4 row_newbcast:0 row_mask:0xf bank_mask:0xf
v_and_b32_dpp v101, v14, v5 row_newbcast:0 row_mask:0xf bank_mask:0xf
v_and_b32_dpp v102, v14, v6 row_newbcast:0 row_mask:0xf bank_mask:0xf
v_and_b32_dpp v103, v14, v7 row_newbcast:0 row_mask:0xf bank_mask:0xf
v_mfma_f32_16x16x32_bf16 v[108:111], v[104:107], v[92:95], v[108:111]
v_and_b32_dpp v104, v14, v4 row_newbcast:4 row_mask:0xf bank_mask:0xf
v_and_b32_dpp v105, v14, v5 row_newbcast:4 row_mask:0xf bank_mask:0xf
v_and_b32_dpp v106, v14, v6 row_newbcast:4 row_mask:0xf bank_mask:0xf
v_and_b32_dpp v107, v14, v7 row_newbcast:4 row_mask:0xf bank_mask:0xf
v_mfma_f32_16x16x32_bf16 v[108:111], v[100:103], v[116:119], v[108:111]
s_xor_b32 s64, s65, 5120
s_cmpk_gt_u32 s69, 100
s_waitcnt vmcnt(6)
s_cbranch_scc1 L_d_106
s_waitcnt vmcnt(5)
L_d_106:
buffer_load_dwordx4 v[204:207], v1, s[44:47], s64 offen nt
v_and_b32_dpp v100, v14, v4 row_newbcast:8 row_mask:0xf bank_mask:0xf
v_and_b32_dpp v101, v14, v5 row_newbcast:8 row_mask:0xf bank_mask:0xf
v_and_b32_dpp v102, v14, v6 row_newbcast:8 row_mask:0xf bank_mask:0xf
v_and_b32_dpp v103, v14, v7 row_newbcast:8 row_mask:0xf bank_mask:0xf
v_mfma_f32_16x16x32_bf16 v[108:111], v[104:107], v[120:123], v[108:111]
s_xor_b32 s64, s65, 70656
s_cmpk_gt_u32 s69, 101
s_waitcnt vmcnt(6)
s_cbranch_scc1 L_d_107
s_waitcnt vmcnt(5)
L_d_107:
buffer_load_dwordx4 v[208:211], v1, s[44:47], s64 offen nt
v_and_b32_dpp v104, v14, v4 row_newbcast:12 row_mask:0xf bank_mask:0xf
v_and_b32_dpp v105, v14, v5 row_newbcast:12 row_mask:0xf bank_mask:0xf
v_and_b32_dpp v106, v14, v6 row_newbcast:12 row_mask:0xf bank_mask:0xf
v_and_b32_dpp v107, v14, v7 row_newbcast:12 row_mask:0xf bank_mask:0xf
v_mfma_f32_16x16x32_bf16 v[108:111], v[100:103], v[128:131], v[108:111]
s_cmp_eq_u32 s34, 1
s_cbranch_scc0 L_w_109
v_mov_b32 v124, 38
s_mov_b64 exec, 1
buffer_store_dword v124, off, s[36:39], s63 offset:0
s_mov_b64 exec, -1
L_w_109:
s_xor_b32 s64, s65, 7168
s_cmpk_gt_u32 s69, 102
s_waitcnt vmcnt(6)
s_cbranch_scc1 L_d_108
s_waitcnt vmcnt(5)
L_d_108:
buffer_load_dwordx4 v[212:215], v1, s[44:47], s64 offen nt
v_and_b32_dpp v100, v15, v4 row_newbcast:0 row_mask:0xf bank_mask:0xf
v_and_b32_dpp v101, v15, v5 row_newbcast:0 row_mask:0xf bank_mask:0xf
v_and_b32_dpp v102, v15, v6 row_newbcast:0 row_mask:0xf bank_mask:0xf
v_and_b32_dpp v103, v15, v7 row_newbcast:0 row_mask:0xf bank_mask:0xf
v_mfma_f32_16x16x32_bf16 v[108:111], v[104:107], v[164:167], v[108:111]
s_xor_b32 s64, s65, 72704
s_cmpk_gt_u32 s69, 103
s_waitcnt vmcnt(6)
s_cbranch_scc1 L_d_110
s_waitcnt vmcnt(5)
L_d_110:
buffer_load_dwordx4 v[216:219], v1, s[44:47], s64 offen nt
v_and_b32_dpp v104, v15, v4 row_newbcast:4 row_mask:0xf bank_mask:0xf
v_and_b32_dpp v105, v15, v5 row_newbcast:4 row_mask:0xf bank_mask:0xf
v_and_b32_dpp v106, v15, v6 row_newbcast:4 row_mask:0xf bank_mask:0xf
v_and_b32_dpp v107, v15, v7 row_newbcast:4 row_mask:0xf bank_mask:0xf
v_mfma_f32_16x16x32_bf16 v[108:111], v[100:103], v[188:191], v[108:111]
s_xor_b32 s64, s65, 36864
s_cmpk_gt_u32 s69, 104
s_waitcnt vmcnt(6)
s_cbranch_scc1 L_d_111
s_waitcnt vmcnt(5)
L_d_111:
buffer_load_dwordx4 v[220:223], v1, s[44:47], s64 offen nt
v_and_b32_dpp v100, v15, v4 row_newbcast:8 row_mask:0xf bank_mask:0xf
v_and_b32_dpp v101, v15, v5 row_newbcast:8 row_mask:0xf bank_mask:0xf
v_and_b32_dpp v102, v15, v6 row_newbcast:8 row_mask:0xf bank_mask:0xf
v_and_b32_dpp v103, v15, v7 row_newbcast:8 row_mask:0xf bank_mask:0xf
v_mfma_f32_16x16x32_bf16 v[108:111], v[104:107], v[192:195], v[108:111]
s_xor_b32 s64, s65, 102400
s_cmpk_gt_u32 s69, 105
s_waitcnt vmcnt(6)
s_cbranch_scc1 L_d_112
s_waitcnt vmcnt(5)
L_d_112:
buffer_load_dwordx4 v[224:227], v1, s[44:47], s64 offen nt
v_and_b32_dpp v104, v15, v4 row_newbcast:12 row_mask:0xf bank_mask:0xf
v_and_b32_dpp v105, v15, v5 row_newbcast:12 row_mask:0xf bank_mask:0xf
v_and_b32_dpp v106, v15, v6 row_newbcast:12 row_mask:0xf bank_mask:0xf
v_and_b32_dpp v107, v15, v7 row_newbcast:12 row_mask:0xf bank_mask:0xf
v_mfma_f32_16x16x32_bf16 v[108:111], v[100:103], v[196:199], v[108:111]
s_xor_b32 s64, s65, 38912
s_cmpk_gt_u32 s69, 106
s_waitcnt vmcnt(6)
s_cbranch_scc1 L_d_113
s_waitcnt vmcnt(5)
L_d_113:
buffer_load_dwordx4 v[228:231], v1, s[44:47], s64 offen nt
v_and_b32_dpp v100, v16, v4 row_newbcast:0 row_mask:0xf bank_mask:0xf
v_and_b32_dpp v101, v16, v5 row_newbcast:0 row_mask:0xf bank_mask:0xf
v_and_b32_dpp v102, v16, v6 row_newbcast:0 row_mask:0xf bank_mask:0xf
v_and_b32_dpp v103, v16, v7 row_newbcast:0 row_mask:0xf bank_mask:0xf
v_mfma_f32_16x16x32_bf16 v[108:111], v[104:107], v[200:203], v[108:111]
s_xor_b32 s64, s65, 104448
s_cmpk_gt_u32 s69, 107
s_waitcnt vmcnt(6)
s_cbranch_scc1 L_d_114
s_waitcnt vmcnt(5)
L_d_114:
buffer_load_dwordx4 v[232:235], v1, s[44:47], s64 offen nt
v_and_b32_dpp v104, v16, v4 row_newbcast:4 row_mask:0xf bank_mask:0xf
v_and_b32_dpp v105, v16, v5 row_newbcast:4 row_mask:0xf bank_mask:0xf
v_and_b32_dpp v106, v16, v6 row_newbcast:4 row_mask:0xf bank_mask:0xf
v_and_b32_dpp v107, v16, v7 row_newbcast:4 row_mask:0xf bank_mask:0xf
v_mfma_f32_16x16x32_bf16 v[108:111], v[100:103], v[204:207], v[108:111]
s_xor_b32 s64, s65, 37888
s_cmpk_gt_u32 s69, 108
s_waitcnt vmcnt(6)
s_cbranch_scc1 L_d_115
s_waitcnt vmcnt(5)
L_d_115:
buffer_load_dwordx4 v[236:239], v1, s[44:47], s64 offen nt
v_and_b32_dpp v100, v16, v4 row_newbcast:8 row_mask:0xf bank_mask:0xf
v_and_b32_dpp v101, v16, v5 row_newbcast:8 row_mask:0xf bank_mask:0xf
v_and_b32_dpp v102, v16, v6 row_newbcast:8 row_mask:0xf bank_mask:0xf
v_and_b32_dpp v103, v16, v7 row_newbcast:8 row_mask:0xf bank_mask:0xf
v_mfma_f32_16x16x32_bf16 v[108:111], v[104:107], v[208:211], v[108:111]
s_xor_b32 s64, s65, 103424
s_cmpk_gt_u32 s69, 109
s_waitcnt vmcnt(6)
s_cbranch_scc1 L_d_116
s_waitcnt vmcnt(5)
L_d_116:
buffer_load_dwordx4 v[240:243], v1, s[44:47], s64 offen nt
v_and_b32_dpp v104, v16, v4 row_newbcast:12 row_mask:0xf bank_mask:0xf
v_and_b32_dpp v105, v16, v5 row_newbcast:12 row_mask:0xf bank_mask:0xf
v_and_b32_dpp v106, v16, v6 row_newbcast:12 row_mask:0xf bank_mask:0xf
v_and_b32_dpp v107, v16, v7 row_newbcast:12 row_mask:0xf bank_mask:0xf
v_mfma_f32_16x16x32_bf16 v[108:111], v[100:103], v[212:215], v[108:111]
s_cmp_eq_u32 s34, 2
s_cbranch_scc0 L_w_118
v_mov_b32 v124, 46
s_mov_b64 exec, 1
buffer_store_dword v124, off, s[36:39], s63 offset:0
s_mov_b64 exec, -1
L_w_118:
s_xor_b32 s64, s65, 39936
s_cmpk_gt_u32 s69, 110
s_waitcnt vmcnt(6)
s_cbranch_scc1 L_d_117
s_waitcnt vmcnt(5)
L_d_117:
buffer_load_dwordx4 v[244:247], v1, s[44:47], s64 offen nt
v_and_b32_dpp v100, v18, v4 row_newbcast:0 row_mask:0xf bank_mask:0xf
v_and_b32_dpp v101, v18, v5 row_newbcast:0 row_mask:0xf bank_mask:0xf
v_and_b32_dpp v102, v18, v6 row_newbcast:0 row_mask:0xf bank_mask:0xf
v_and_b32_dpp v103, v18, v7 row_newbcast:0 row_mask:0xf bank_mask:0xf
v_mfma_f32_16x16x32_bf16 v[108:111], v[104:107], v[216:219], v[108:111]
s_xor_b32 s64, s65, 105472
s_cmpk_gt_u32 s69, 111
s_waitcnt vmcnt(6)
s_cbranch_scc1 L_d_119
s_waitcnt vmcnt(5)
L_d_119:
buffer_load_dwordx4 v[248:251], v1, s[44:47], s64 offen nt
v_and_b32_dpp v104, v18, v4 row_newbcast:4 row_mask:0xf bank_mask:0xf
v_and_b32_dpp v105, v18, v5 row_newbcast:4 row_mask:0xf bank_mask:0xf
v_and_b32_dpp v106, v18, v6 row_newbcast:4 row_mask:0xf bank_mask:0xf
v_and_b32_dpp v107, v18, v7 row_newbcast:4 row_mask:0xf bank_mask:0xf
v_mfma_f32_16x16x32_bf16 v[108:111], v[100:103], v[220:223], v[108:111]
s_xor_b32 s64, s65, 135168
s_waitcnt vmcnt(5)
buffer_load_dwordx4 v[252:255], v1, s[44:47], s64 offen nt
v_and_b32_dpp v100, v18, v4 row_newbcast:8 row_mask:0xf bank_mask:0xf
v_and_b32_dpp v101, v18, v5 row_newbcast:8 row_mask:0xf bank_mask:0xf
v_and_b32_dpp v102, v18, v6 row_newbcast:8 row_mask:0xf bank_mask:0xf
v_and_b32_dpp v103, v18, v7 row_newbcast:8 row_mask:0xf bank_mask:0xf
v_mfma_f32_16x16x32_bf16 v[108:111], v[104:107], v[224:227], v[108:111]
v_and_b32_dpp v104, v18, v4 row_newbcast:12 row_mask:0xf bank_mask:0xf
v_and_b32_dpp v105, v18, v5 row_newbcast:12 row_mask:0xf bank_mask:0xf
v_and_b32_dpp v106, v18, v6 row_newbcast:12 row_mask:0xf bank_mask:0xf
v_and_b32_dpp v107, v18, v7 row_newbcast:12 row_mask:0xf bank_mask:0xf
v_mfma_f32_16x16x32_bf16 v[108:111], v[100:103], v[228:231], v[108:111]
s_xor_b32 s64, s65, 200704
s_waitcnt vmcnt(5)
buffer_load_dwordx4 v[84:87], v1, s[44:47], s64 offen nt
v_and_b32_dpp v100, v19, v4 row_newbcast:0 row_mask:0xf bank_mask:0xf
v_and_b32_dpp v101, v19, v5 row_newbcast:0 row_mask:0xf bank_mask:0xf
v_and_b32_dpp v102, v19, v6 row_newbcast:0 row_mask:0xf bank_mask:0xf
v_and_b32_dpp v103, v19, v7 row_newbcast:0 row_mask:0xf bank_mask:0xf
v_mfma_f32_16x16x32_bf16 v[108:111], v[104:107], v[232:235], v[108:111]
s_xor_b32 s64, s65, 137216
s_waitcnt vmcnt(5)
buffer_load_dwordx4 v[88:91], v1, s[44:47], s64 offen nt
v_and_b32_dpp v104, v19, v4 row_newbcast:4 row_mask:0xf bank_mask:0xf
v_and_b32_dpp v105, v19, v5 row_newbcast:4 row_mask:0xf bank_mask:0xf
v_and_b32_dpp v106, v19, v6 row_newbcast:4 row_mask:0xf bank_mask:0xf
v_and_b32_dpp v107, v19, v7 row_newbcast:4 row_mask:0xf bank_mask:0xf
v_mfma_f32_16x16x32_bf16 v[108:111], v[100:103], v[236:239], v[108:111]
s_xor_b32 s64, s65, 202752
s_waitcnt vmcnt(5)
buffer_load_dwordx4 v[132:135], v1, s[44:47], s64 offen nt
v_and_b32_dpp v100, v19, v4 row_newbcast:8 row_mask:0xf bank_mask:0xf
v_and_b32_dpp v101, v19, v5 row_newbcast:8 row_mask:0xf bank_mask:0xf
v_and_b32_dpp v102, v19, v6 row_newbcast:8 row_mask:0xf bank_mask:0xf
v_and_b32_dpp v103, v19, v7 row_newbcast:8 row_mask:0xf bank_mask:0xf
v_mfma_f32_16x16x32_bf16 v[108:111], v[104:107], v[240:243], v[108:111]
s_xor_b32 s64, s65, 136192
s_waitcnt vmcnt(5)
buffer_load_dwordx4 v[136:139], v1, s[44:47], s64 offen nt
v_and_b32_dpp v104, v19, v4 row_newbcast:12 row_mask:0xf bank_mask:0xf
v_and_b32_dpp v105, v19, v5 row_newbcast:12 row_mask:0xf bank_mask:0xf
v_and_b32_dpp v106, v19, v6 row_newbcast:12 row_mask:0xf bank_mask:0xf
v_and_b32_dpp v107, v19, v7 row_newbcast:12 row_mask:0xf bank_mask:0xf
v_mfma_f32_16x16x32_bf16 v[108:111], v[100:103], v[244:247], v[108:111]
s_xor_b32 s64, s65, 201728
s_waitcnt vmcnt(5)
buffer_load_dwordx4 v[140:143], v1, s[44:47], s64 offen nt
v_and_b32_dpp v100, v20, v4 row_newbcast:0 row_mask:0xf bank_mask:0xf
v_and_b32_dpp v101, v20, v5 row_newbcast:0 row_mask:0xf bank_mask:0xf
v_and_b32_dpp v102, v20, v6 row_newbcast:0 row_mask:0xf bank_mask:0xf
v_and_b32_dpp v103, v20, v7 row_newbcast:0 row_mask:0xf bank_mask:0xf
v_mfma_f32_16x16x32_bf16 v[108:111], v[104:107], v[248:251], v[108:111]
s_cmp_eq_u32 s34, 3
s_cbranch_scc0 L_w_120
v_mov_b32 v124, 54
s_mov_b64 exec, 1
buffer_store_dword v124, off, s[36:39], s63 offset:0
s_mov_b64 exec, -1
L_w_120:
s_xor_b32 s64, s65, 138240
s_waitcnt vmcnt(5)
buffer_load_dwordx4 v[144:147], v1, s[44:47], s64 offen nt
v_and_b32_dpp v104, v20, v4 row_newbcast:4 row_mask:0xf bank_mask:0xf
v_and_b32_dpp v105, v20, v5 row_newbcast:4 row_mask:0xf bank_mask:0xf
v_and_b32_dpp v106, v20, v6 row_newbcast:4 row_mask:0xf bank_mask:0xf
v_and_b32_dpp v107, v20, v7 row_newbcast:4 row_mask:0xf bank_mask:0xf
v_mfma_f32_16x16x32_bf16 v[108:111], v[100:103], v[252:255], v[108:111]
s_xor_b32 s64, s65, 203776
s_waitcnt vmcnt(5)
buffer_load_dwordx4 v[148:151], v1, s[44:47], s64 offen nt
v_and_b32_dpp v100, v20, v4 row_newbcast:8 row_mask:0xf bank_mask:0xf
v_and_b32_dpp v101, v20, v5 row_newbcast:8 row_mask:0xf bank_mask:0xf
v_and_b32_dpp v102, v20, v6 row_newbcast:8 row_mask:0xf bank_mask:0xf
v_and_b32_dpp v103, v20, v7 row_newbcast:8 row_mask:0xf bank_mask:0xf
v_mfma_f32_16x16x32_bf16 v[108:111], v[104:107], v[84:87], v[108:111]
s_xor_b32 s64, s65, 167936
s_waitcnt vmcnt(7)
buffer_load_dwordx4 v[152:155], v1, s[44:47], s64 offen nt
s_xor_b32 s64, s65, 233472
s_waitcnt vmcnt(7)
buffer_load_dwordx4 v[156:159], v1, s[44:47], s64 offen nt
s_cmp_lt_u32 s2, 208
s_cbranch_scc0 L_hp_121
v_lshlrev_b32 v160, 2, v0
buffer_load_dword v161, v160, s[36:39], s62 offen offset:0 sc1
L_hp_121:
s_xor_b32 s64, s65, 169984
s_waitcnt vmcnt(7)
buffer_load_dwordx4 v[176:179], v1, s[44:47], s64 offen nt
v_and_b32_dpp v104, v20, v4 row_newbcast:12 row_mask:0xf bank_mask:0xf
v_and_b32_dpp v105, v20, v5 row_newbcast:12 row_mask:0xf bank_mask:0xf
v_and_b32_dpp v106, v20, v6 row_newbcast:12 row_mask:0xf bank_mask:0xf
v_and_b32_dpp v107, v20, v7 row_newbcast:12 row_mask:0xf bank_mask:0xf
v_mfma_f32_16x16x32_bf16 v[108:111], v[100:103], v[88:91], v[108:111]
s_xor_b32 s64, s65, 235520
s_waitcnt vmcnt(7)
buffer_load_dwordx4 v[180:183], v1, s[44:47], s64 offen nt
v_and_b32_dpp v100, v21, v4 row_newbcast:0 row_mask:0xf bank_mask:0xf
v_and_b32_dpp v101, v21, v5 row_newbcast:0 row_mask:0xf bank_mask:0xf
v_and_b32_dpp v102, v21, v6 row_newbcast:0 row_mask:0xf bank_mask:0xf
v_and_b32_dpp v103, v21, v7 row_newbcast:0 row_mask:0xf bank_mask:0xf
v_mfma_f32_16x16x32_bf16 v[108:111], v[104:107], v[132:135], v[108:111]
s_xor_b32 s64, s65, 168960
s_waitcnt vmcnt(7)
buffer_load_dwordx4 v[184:187], v1, s[44:47], s64 offen nt
v_and_b32_dpp v104, v21, v4 row_newbcast:4 row_mask:0xf bank_mask:0xf
v_and_b32_dpp v105, v21, v5 row_newbcast:4 row_mask:0xf bank_mask:0xf
v_and_b32_dpp v106, v21, v6 row_newbcast:4 row_mask:0xf bank_mask:0xf
v_and_b32_dpp v107, v21, v7 row_newbcast:4 row_mask:0xf bank_mask:0xf
v_mfma_f32_16x16x32_bf16 v[108:111], v[100:103], v[136:139], v[108:111]
s_xor_b32 s64, s65, 234496
s_waitcnt vmcnt(7)
buffer_load_dwordx4 v[24:27], v1, s[44:47], s64 offen nt
v_and_b32_dpp v100, v21, v4 row_newbcast:8 row_mask:0xf bank_mask:0xf
v_and_b32_dpp v101, v21, v5 row_newbcast:8 row_mask:0xf bank_mask:0xf
v_and_b32_dpp v102, v21, v6 row_newbcast:8 row_mask:0xf bank_mask:0xf
v_and_b32_dpp v103, v21, v7 row_newbcast:8 row_mask:0xf bank_mask:0xf
v_mfma_f32_16x16x32_bf16 v[108:111], v[104:107], v[140:143], v[108:111]
s_cmp_eq_u32 s34, 0
s_cbranch_scc0 L_w_122
v_mov_b32 v124, 62
s_mov_b64 exec, 1
buffer_store_dword v124, off, s[36:39], s63 offset:0
s_mov_b64 exec, -1
L_w_122:
s_xor_b32 s64, s65, 171008
s_waitcnt vmcnt(7)
buffer_load_dwordx4 v[28:31], v1, s[44:47], s64 offen nt
v_and_b32_dpp v104, v21, v4 row_newbcast:12 row_mask:0xf bank_mask:0xf
v_and_b32_dpp v105, v21, v5 row_newbcast:12 row_mask:0xf bank_mask:0xf
v_and_b32_dpp v106, v21, v6 row_newbcast:12 row_mask:0xf bank_mask:0xf
v_and_b32_dpp v107, v21, v7 row_newbcast:12 row_mask:0xf bank_mask:0xf
v_mfma_f32_16x16x32_bf16 v[108:111], v[100:103], v[144:147], v[108:111]
s_xor_b32 s64, s65, 236544
s_waitcnt vmcnt(7)
buffer_load_dwordx4 v[32:35], v1, s[44:47], s64 offen nt
v_and_b32_dpp v100, v22, v4 row_newbcast:0 row_mask:0xf bank_mask:0xf
v_and_b32_dpp v101, v22, v5 row_newbcast:0 row_mask:0xf bank_mask:0xf
v_and_b32_dpp v102, v22, v6 row_newbcast:0 row_mask:0xf bank_mask:0xf
v_and_b32_dpp v103, v22, v7 row_newbcast:0 row_mask:0xf bank_mask:0xf
v_mfma_f32_16x16x32_bf16 v[108:111], v[104:107], v[148:151], v[108:111]
s_cmp_lt_u32 s2, 208
s_cbranch_scc0 L_nohelp
v_lshrrev_b32 v172, 3, v0
v_sub_u32 v172, 63, v172
v_and_b32 v168, 7, v0
v_lshlrev_b32 v168, 7, v168
v_bfe_u32 v162, v172, 0, 1
v_lshl_or_b32 v168, v162, 16, v168
v_bfe_u32 v162, v172, 1, 1
v_lshl_or_b32 v168, v162, 11, v168
v_bfe_u32 v162, v172, 2, 1
v_lshl_or_b32 v168, v162, 10, v168
v_bfe_u32 v162, v172, 3, 1
v_lshl_or_b32 v168, v162, 15, v168
v_bfe_u32 v162, v172, 4, 1
v_lshl_or_b32 v168, v162, 17, v168
v_bfe_u32 v162, v172, 5, 1
v_lshl_or_b32 v168, v162, 12, v168
v_lshrrev_b32 v173, 3, v0
v_sub_u32 v173, 55, v173
v_and_b32 v169, 7, v0
v_lshlrev_b32 v169, 7, v169
v_bfe_u32 v162, v173, 0, 1
v_lshl_or_b32 v169, v162, 16, v169
v_bfe_u32 v162, v173, 1, 1
v_lshl_or_b32 v169, v162, 11, v169
v_bfe_u32 v162, v173, 2, 1
v_lshl_or_b32 v169, v162, 10, v169
v_bfe_u32 v162, v173, 3, 1
v_lshl_or_b32 v169, v162, 15, v169
v_bfe_u32 v162, v173, 4, 1
v_lshl_or_b32 v169, v162, 17, v169
v_bfe_u32 v162, v173, 5, 1
v_lshl_or_b32 v169, v162, 12, v169
s_lshr_b32 s71, s2, 3
v_subrev_u32 v163, s71, v0
v_and_b32 v163, 31, v163
s_waitcnt vmcnt(6)
v_mov_b32 v162, v161
s_nop 1
v_permlane32_swap_b32 v161, v162
v_add_u32 v161, 1, v161
v_max_u32 v161, 23, v161
v_cmp_eq_u32 vcc, -1, v162
v_mov_b32 v160, 0xff
s_nop 0
v_cndmask_b32 v161, v160, v161, vcc
v_lshl_or_b32 v161, v161, 5, v163
s_nop 1
v_min_u32_dpp v161, v161, v161 quad_perm:[1,0,3,2] row_mask:0xf bank_mask:0xf
s_nop 1
v_min_u32_dpp v161, v161, v161 quad_perm:[2,3,0,1] row_mask:0xf bank_mask:0xf
s_nop 1
v_min_u32_dpp v161, v161, v161 row_ror:4 row_mask:0xf bank_mask:0xf
s_nop 1
v_min_u32_dpp v161, v161, v161 row_ror:8 row_mask:0xf bank_mask:0xf
s_nop 1
v_readlane_b32 s76, v161, 0
v_readlane_b32 s66, v161, 16
s_min_u32 s76, s76, s66
s_lshr_b32 s66, s76, 5
s_cmp_lt_u32 s66, 50
s_cbranch_scc0 L_drain
s_mov_b32 s48, s8
s_mov_b32 s49, s9
s_mov_b32 s50, 0x10000000
s_mov_b32 s51, 0x20000
s_lshr_b32 s64, s2, 3
s_add_u32 s76, s76, s64
s_and_b32 s76, s76, 31
s_lshl_b32 s67, s76, 2
s_add_u32 s67, s67, s62
s_lshl_b32 s76, s76, 3
s_and_b32 s64, s2, 7
s_or_b32 s76, s76, s64
s_and_b32 s64, s34, 1
s_lshl_b32 s64, s64, 14
s_lshr_b32 s71, s34, 1
s_lshl_b32 s71, s71, 13
s_or_b32 s64, s64, s71
s_lshl_b32 s71, s76, 10
s_xor_b32 s64, s64, s71
s_or_b32 s64, s64, 0xC0000
s_lshl_b32 s76, s76, 20
s_xor_b32 s76, s76, s64
s_add_u32 s66, s66, 11
v_xor_b32 v169, s76, v169
v_cmp_lt_u32 vcc, s66, v173
s_or_b64 exec, vcc, 1
buffer_load_dword v171, v169, s[48:51], 0 offen
s_mov_b64 exec, -1
v_xor_b32 v168, s76, v168
v_cmp_lt_u32 vcc, s66, v172
s_or_b64 exec, vcc, 1
buffer_load_dword v170, v168, s[48:51], 0 offen
s_mov_b64 exec, -1
s_mov_b64 exec, 1
buffer_store_dword v1, off, s[36:39], s67 offset:128
s_mov_b64 exec, -1
s_waitcnt vmcnt(10)
v_and_b32_dpp v104, v22, v4 row_newbcast:4 row_mask:0xf bank_mask:0xf
v_and_b32_dpp v105, v22, v5 row_newbcast:4 row_mask:0xf bank_mask:0xf
v_and_b32_dpp v106, v22, v6 row_newbcast:4 row_mask:0xf bank_mask:0xf
v_and_b32_dpp v107, v22, v7 row_newbcast:4 row_mask:0xf bank_mask:0xf
v_mfma_f32_16x16x32_bf16 v[108:111], v[100:103], v[152:155], v[108:111]
s_waitcnt vmcnt(9)
v_and_b32_dpp v100, v22, v4 row_newbcast:8 row_mask:0xf bank_mask:0xf
v_and_b32_dpp v101, v22, v5 row_newbcast:8 row_mask:0xf bank_mask:0xf
v_and_b32_dpp v102, v22, v6 row_newbcast:8 row_mask:0xf bank_mask:0xf
v_and_b32_dpp v103, v22, v7 row_newbcast:8 row_mask:0xf bank_mask:0xf
v_mfma_f32_16x16x32_bf16 v[108:111], v[104:107], v[156:159], v[108:111]
s_waitcnt vmcnt(8)
v_and_b32_dpp v104, v22, v4 row_newbcast:12 row_mask:0xf bank_mask:0xf
v_and_b32_dpp v105, v22, v5 row_newbcast:12 row_mask:0xf bank_mask:0xf
v_and_b32_dpp v106, v22, v6 row_newbcast:12 row_mask:0xf bank_mask:0xf
v_and_b32_dpp v107, v22, v7 row_newbcast:12 row_mask:0xf bank_mask:0xf
v_mfma_f32_16x16x32_bf16 v[108:111], v[100:103], v[176:179], v[108:111]
s_waitcnt vmcnt(7)
v_and_b32_dpp v100, v23, v4 row_newbcast:0 row_mask:0xf bank_mask:0xf
v_and_b32_dpp v101, v23, v5 row_newbcast:0 row_mask:0xf bank_mask:0xf
v_and_b32_dpp v102, v23, v6 row_newbcast:0 row_mask:0xf bank_mask:0xf
v_and_b32_dpp v103, v23, v7 row_newbcast:0 row_mask:0xf bank_mask:0xf
v_mfma_f32_16x16x32_bf16 v[108:111], v[104:107], v[180:183], v[108:111]
s_waitcnt vmcnt(6)
v_and_b32_dpp v104, v23, v4 row_newbcast:4 row_mask:0xf bank_mask:0xf
v_and_b32_dpp v105, v23, v5 row_newbcast:4 row_mask:0xf bank_mask:0xf
v_and_b32_dpp v106, v23, v6 row_newbcast:4 row_mask:0xf bank_mask:0xf
v_and_b32_dpp v107, v23, v7 row_newbcast:4 row_mask:0xf bank_mask:0xf
v_mfma_f32_16x16x32_bf16 v[108:111], v[100:103], v[184:187], v[108:111]
s_waitcnt vmcnt(5)
v_and_b32_dpp v100, v23, v4 row_newbcast:8 row_mask:0xf bank_mask:0xf
v_and_b32_dpp v101, v23, v5 row_newbcast:8 row_mask:0xf bank_mask:0xf
v_and_b32_dpp v102, v23, v6 row_newbcast:8 row_mask:0xf bank_mask:0xf
v_and_b32_dpp v103, v23, v7 row_newbcast:8 row_mask:0xf bank_mask:0xf
v_mfma_f32_16x16x32_bf16 v[108:111], v[104:107], v[24:27], v[108:111]
s_waitcnt vmcnt(4)
v_and_b32_dpp v104, v23, v4 row_newbcast:12 row_mask:0xf bank_mask:0xf
v_and_b32_dpp v105, v23, v5 row_newbcast:12 row_mask:0xf bank_mask:0xf
v_and_b32_dpp v106, v23, v6 row_newbcast:12 row_mask:0xf bank_mask:0xf
v_and_b32_dpp v107, v23, v7 row_newbcast:12 row_mask:0xf bank_mask:0xf
v_mfma_f32_16x16x32_bf16 v[108:111], v[100:103], v[28:31], v[108:111]
s_waitcnt vmcnt(3)
v_mfma_f32_16x16x32_bf16 v[108:111], v[104:107], v[32:35], v[108:111]
s_branch L_drained
L_nohelp:
L_drain:
s_waitcnt vmcnt(7)
v_and_b32_dpp v104, v22, v4 row_newbcast:4 row_mask:0xf bank_mask:0xf
v_and_b32_dpp v105, v22, v5 row_newbcast:4 row_mask:0xf bank_mask:0xf
v_and_b32_dpp v106, v22, v6 row_newbcast:4 row_mask:0xf bank_mask:0xf
v_and_b32_dpp v107, v22, v7 row_newbcast:4 row_mask:0xf bank_mask:0xf
v_mfma_f32_16x16x32_bf16 v[108:111], v[100:103], v[152:155], v[108:111]
s_waitcnt vmcnt(6)
v_and_b32_dpp v100, v22, v4 row_newbcast:8 row_mask:0xf bank_mask:0xf
v_and_b32_dpp v101, v22, v5 row_newbcast:8 row_mask:0xf bank_mask:0xf
v_and_b32_dpp v102, v22, v6 row_newbcast:8 row_mask:0xf bank_mask:0xf
v_and_b32_dpp v103, v22, v7 row_newbcast:8 row_mask:0xf bank_mask:0xf
v_mfma_f32_16x16x32_bf16 v[108:111], v[104:107], v[156:159], v[108:111]
s_waitcnt vmcnt(5)
v_and_b32_dpp v104, v22, v4 row_newbcast:12 row_mask:0xf bank_mask:0xf
v_and_b32_dpp v105, v22, v5 row_newbcast:12 row_mask:0xf bank_mask:0xf
v_and_b32_dpp v106, v22, v6 row_newbcast:12 row_mask:0xf bank_mask:0xf
v_and_b32_dpp v107, v22, v7 row_newbcast:12 row_mask:0xf bank_mask:0xf
v_mfma_f32_16x16x32_bf16 v[108:111], v[100:103], v[176:179], v[108:111]
s_waitcnt vmcnt(4)
v_and_b32_dpp v100, v23, v4 row_newbcast:0 row_mask:0xf bank_mask:0xf
v_and_b32_dpp v101, v23, v5 row_newbcast:0 row_mask:0xf bank_mask:0xf
v_and_b32_dpp v102, v23, v6 row_newbcast:0 row_mask:0xf bank_mask:0xf
v_and_b32_dpp v103, v23, v7 row_newbcast:0 row_mask:0xf bank_mask:0xf
v_mfma_f32_16x16x32_bf16 v[108:111], v[104:107], v[180:183], v[108:111]
s_waitcnt vmcnt(3)
v_and_b32_dpp v104, v23, v4 row_newbcast:4 row_mask:0xf bank_mask:0xf
v_and_b32_dpp v105, v23, v5 row_newbcast:4 row_mask:0xf bank_mask:0xf
v_and_b32_dpp v106, v23, v6 row_newbcast:4 row_mask:0xf bank_mask:0xf
v_and_b32_dpp v107, v23, v7 row_newbcast:4 row_mask:0xf bank_mask:0xf
v_mfma_f32_16x16x32_bf16 v[108:111], v[100:103], v[184:187], v[108:111]
s_waitcnt vmcnt(2)
v_and_b32_dpp v100, v23, v4 row_newbcast:8 row_mask:0xf bank_mask:0xf
v_and_b32_dpp v101, v23, v5 row_newbcast:8 row_mask:0xf bank_mask:0xf
v_and_b32_dpp v102, v23, v6 row_newbcast:8 row_mask:0xf bank_mask:0xf
v_and_b32_dpp v103, v23, v7 row_newbcast:8 row_mask:0xf bank_mask:0xf
v_mfma_f32_16x16x32_bf16 v[108:111], v[104:107], v[24:27], v[108:111]
s_waitcnt vmcnt(1)
v_and_b32_dpp v104, v23, v4 row_newbcast:12 row_mask:0xf bank_mask:0xf
v_and_b32_dpp v105, v23, v5 row_newbcast:12 row_mask:0xf bank_mask:0xf
v_and_b32_dpp v106, v23, v6 row_newbcast:12 row_mask:0xf bank_mask:0xf
v_and_b32_dpp v107, v23, v7 row_newbcast:12 row_mask:0xf bank_mask:0xf
v_mfma_f32_16x16x32_bf16 v[108:111], v[100:103], v[28:31], v[108:111]
s_waitcnt vmcnt(0)
v_mfma_f32_16x16x32_bf16 v[108:111], v[104:107], v[32:35], v[108:111]
L_drained:
v_and_b32 v2, 15, v0
v_lshlrev_b32 v2, 5, v2
v_and_b32 v3, 16, v0
v_add_u32 v2, v2, v3
s_lshl_b32 s68, s34, 9
v_add_u32 v2, s68, v2
s_mov_b32 exec_hi, 0
s_nop 1
ds_write_b128 v2, v[108:111] offset:512
s_mov_b32 exec_hi, -1
v_lshlrev_b32 v1, 4, v0
s_waitcnt lgkmcnt(0)
s_barrier
v_mov_b32 v2, 0
ds_read_b32 v3, v2 offset:328
s_waitcnt lgkmcnt(0)
v_readfirstlane_b32 s35, v3
s_branch L_tail_s
L_fin:
L_end:
s_endpgm
L_code_end:
.section .rodata,"a"
.p2align 6
.amdhsa_kernel adaLN_cond__sliding_block_cached__glu_gated_glu__decode_kernel
  .amdhsa_next_free_vgpr 256
  .amdhsa_next_free_sgpr 102
  .amdhsa_accum_offset 256
  .amdhsa_group_segment_fixed_size 0
  .amdhsa_kernarg_size 112
  .amdhsa_user_sgpr_count 2
  .amdhsa_user_sgpr_kernarg_segment_ptr 1
  .amdhsa_system_sgpr_workgroup_id_x 1
  .amdhsa_float_denorm_mode_32 3
.end_amdhsa_kernel
```

```asm
; @launch grid=(256,1,1) block=(512,1,1) lds=131072
.amdgcn_target "amdgcn-amd-amdhsa--gfx950"
.text
.globl adaLN_cond__sliding_block_cached__glu_gated_glu__decode_kernel
.p2align 8
.type adaLN_cond__sliding_block_cached__glu_gated_glu__decode_kernel,@function
adaLN_cond__sliding_block_cached__glu_gated_glu__decode_kernel:
L_code_begin:
s_load_dwordx16 s[4:19], s[0:1], 0
s_load_dwordx8 s[20:27], s[0:1], 64
s_load_dwordx4 s[28:31], s[0:1], 96
s_cmpk_ge_u32 s2, 256
s_cbranch_scc1 L_end
v_lshrrev_b32 v1, 6, v0
v_and_b32 v0, 63, v0
v_readfirstlane_b32 s3, v1
v_lshlrev_b32 v1, 4, v0
s_lshl_b32 s64, s2, 20
s_add_u32 s64, s64, 0xC0000
s_mov_b32 s42, 0x40000
s_mov_b32 s43, 0x20000
s_and_b32 s34, s3, 3
s_cmp_ge_u32 s3, 4
s_cbranch_scc1 L_helper
s_and_b32 s65, s34, 1
s_lshl_b32 s65, s65, 14
s_lshr_b32 s66, s34, 1
s_lshl_b32 s66, s66, 13
s_or_b32 s65, s65, s66
s_lshl_b32 s66, s2, 10
s_xor_b32 s65, s65, s66
s_waitcnt lgkmcnt(0)
s_add_u32 s40, s6, s64
s_addc_u32 s41, s7, 0
s_add_u32 s44, s8, s64
s_addc_u32 s45, s9, 0
buffer_load_dwordx4 v[8:11], v1, s[40:43], s65 offen nt
s_xor_b32 s64, s65, 65536
buffer_load_dwordx4 v[12:15], v1, s[40:43], s64 offen nt
s_xor_b32 s64, s65, 2048
buffer_load_dwordx4 v[16:19], v1, s[40:43], s64 offen nt
s_xor_b32 s64, s65, 67584
buffer_load_dwordx4 v[20:23], v1, s[40:43], s64 offen nt
s_barrier
s_branch L_srest
L_helper:
s_setprio 2
v_lshlrev_b32 v2, 2, v0
s_cmp_eq_u32 s3, 7
s_cbranch_scc0 L_nopf
s_getpc_b64 s[60:61]
L_pc:
s_lshr_b32 s66, s2, 3
s_lshl_b32 s66, s66, 10
v_add_u32 v10, s66, v1
v_min_u32 v10, L_code_end-L_pc-16, v10
global_load_dwordx4 v[12:15], v10, s[60:61]
v_subrev_u32 v3, 16, v0
v_ashrrev_i32 v3, 31, v3
ds_write_b32 v2, v3 offset:256
L_nopf:
s_and_b32 s67, s2, 7
s_lshr_b32 s68, s2, 3
v_and_b32 v38, 7, v0
v_lshrrev_b32 v37, 3, v0
s_cmp_eq_u32 s34, 0
s_cbranch_scc0 L_p0a
s_mov_b32 s70, 6
s_lshl_b32 s67, s67, 1
s_add_u32 s66, s67, 14
v_min_u32 v38, 5, v38
v_cmp_lt_u32 vcc, 1, v38
v_add_u32 v36, s66, v38
s_nop 0
v_cndmask_b32 v38, v38, v36, vcc
s_branch L_p0b
L_p0a:
s_lshl_b32 s67, s67, 3
s_lshl_b32 s65, s2, 3
s_and_b32 s65, s65, 0xff
s_lshr_b32 s66, s2, 5
s_or_b32 s65, s65, s66
s_cmp_eq_u32 s34, 2
s_cselect_b32 s70, 1, 8
s_cselect_b32 s68, s65, s68
s_cselect_b32 s67, 0, s67
L_p0b:
v_lshl_add_u32 v37, s68, 4, v37
v_mul_u32_u24 v37, s70, v37
v_lshl_add_u32 v38, v37, 3, v38
v_add_lshl_u32 v38, v38, s67, 7
s_lshl_b32 s70, s70, 13
v_add_u32 v39, s70, v38
s_sub_u32 s64, s2, 112
s_cmp_lt_u32 s64, 32
s_waitcnt lgkmcnt(0)
s_barrier
s_cbranch_scc1 L_jan
s_cmp_eq_u32 s34, 3
s_cbranch_scc1 L_p0_125
s_cmp_eq_u32 s34, 0
s_cselect_b32 s62, s24, s10
s_cselect_b32 s63, s25, s11
s_cmp_eq_u32 s34, 2
s_cselect_b32 s62, s12, s62
s_cselect_b32 s63, s13, s63
global_load_dword v12, v38, s[62:63]
global_load_dword v13, v39, s[62:63]
L_p0_125:
L_nop0:
s_cmp_eq_u32 s34, 3
s_cselect_b32 s64, 16, 0
s_cmp_lt_u32 s2, s64
s_cbranch_scc0 L_nopc
v_mov_b32 v4, -1
v_mov_b32 v5, -1
v_mov_b32 v6, -1
v_mov_b32 v7, -1
s_and_b32 s66, s2, 7
s_lshl_b32 s66, s66, 11
s_and_b32 s65, s2, 8
s_lshl_b32 s65, s65, 7
s_add_u32 s66, s66, s65
v_add_u32 v8, s66, v1
global_store_dwordx4 v8, v[4:7], s[30:31] sc1
s_lshl_b32 s66, s2, 2
v_mov_b32 v3, s66
s_waitcnt vmcnt(0)
s_mov_b64 exec, 1
global_store_dword v3, v4, s[28:29] sc1
s_mov_b64 exec, -1
L_nopc:
s_cmp_eq_u32 s34, 3
s_cbranch_scc0 L_w_126
s_and_b32 s67, s2, 7
s_lshr_b32 s68, s2, 3
s_min_u32 s64, s67, 3
s_mul_i32 s65, s67, 5
s_add_u32 s64, s64, s65
s_cmp_lt_u32 s67, 3
s_cselect_b32 s65, 6, 5
L_w_126:
s_lshr_b32 s32, s2, 5
s_and_b32 s33, s2, 31
s_and_b32 s67, s2, 7
s_lshr_b32 s68, s2, 3
s_sub_u32 s68, s68, 26
s_min_u32 s74, s67, 3
s_mul_i32 s66, s67, 5
s_add_u32 s74, s74, s66
s_add_u32 s74, s74, s68
s_cmp_lt_u32 s67, 3
s_cselect_b32 s66, 6, 5
s_cmp_lt_u32 s68, s66
s_cselect_b32 s74, s74, -1
s_cmp_lt_u32 s2, 48
s_cselect_b32 s66, 2, 3
s_cselect_b32 s72, 14+26, 42+26
s_cmp_lt_u32 s2, 16
s_cselect_b32 s66, 1, s66
s_cselect_b32 s72, 26, s72
s_lshl_b32 s66, s67, s66
s_add_u32 s72, s72, s66
s_add_u32 s72, s72, s68
s_mov_b32 s36, s30
s_mov_b32 s37, s31
s_mov_b32 s38, 0x1d0000
s_mov_b32 s39, 0x20000
s_mov_b32 s52, s28
s_mov_b32 s53, s29
s_mov_b32 s54, 0x100
s_mov_b32 s55, 0x20000
v_mov_b32 v9, 1
s_cmp_lt_u32 s2, 112
s_cbranch_scc0 L_norole
L_gemm:
v_and_b32 v16, 7, v0
v_lshlrev_b32 v16, 10, v16
v_and_b32 v17, 8, v0
v_lshl_add_u32 v16, v17, 3, v16
v_and_b32 v17, 48, v0
v_add_u32 v16, v16, v17
s_lshl_b32 s67, s34, 8
v_lshrrev_b32 v19, 3, v0
v_and_b32 v17, 2, v19
v_and_b32 v18, 7, v0
v_xor_b32 v17, v17, v18
v_xor_b32 v18, 4, v17
v_lshlrev_b32 v17, 4, v17
v_lshlrev_b32 v18, 4, v18
s_cmp_lt_u32 s2, 48
s_cbranch_scc0 L_gq0
s_mov_b32 s40, s24
s_mov_b32 s41, s25
s_mov_b32 s42, 0x300000
s_mov_b32 s43, 0x20000
s_mov_b32 s48, s22
s_mov_b32 s49, s23
s_mov_b32 s50, 0x2000
s_mov_b32 s51, 0x20000
s_mov_b32 s70, 6144
s_lshl_b32 s64, s72, 7
s_branch L_g1
L_gq0:
s_mov_b32 s40, s10
s_mov_b32 s41, s11
s_mov_b32 s42, 0x400000
s_mov_b32 s43, 0x20000
s_mov_b32 s48, s4
s_mov_b32 s49, s5
s_mov_b32 s50, 0x2000
s_mov_b32 s51, 0x20000
s_mov_b32 s70, 8192
s_sub_u32 s64, s72, 48
s_lshl_b32 s64, s64, 7
L_g1:
buffer_load_dwordx4 v[192:195], v16, s[48:51], s67 offen offset:0
buffer_load_dwordx4 v[196:199], v16, s[48:51], s67 offen offset:128
v_mul_lo_u32 v19, s70, v19
v_add_u32 v17, v17, v19
v_add_u32 v18, v18, v19
s_lshl_b32 s66, s70, 7
s_mul_i32 s66, s66, s34
s_add_u32 s64, s64, s66
s_lshl_b32 s70, s70, 3
s_lshl_b32 s65, s34, 13
s_add_u32 s65, s65, 4096
s_cmp_lt_u32 s2, 16
s_cselect_b32 s71, 0, 2
s_cmp_ge_u32 s2, 48
s_cselect_b32 s71, 1, s71
s_add_u32 m0, s65, 0
s_nop 0
buffer_load_dwordx4 v17, s[40:43], s64 offen  lds
s_add_u32 s64, s64, s70
s_add_u32 m0, s65, 1024
s_nop 0
buffer_load_dwordx4 v18, s[40:43], s64 offen  lds
s_add_u32 s64, s64, s70
s_cmp_eq_u32 s71, 2
s_cbranch_scc0 L_pace_127
s_waitcnt vmcnt(1)
L_pace_127:
s_add_u32 m0, s65, 2048
s_nop 0
buffer_load_dwordx4 v17, s[40:43], s64 offen  lds
s_add_u32 s64, s64, s70
s_cmp_eq_u32 s71, 0
s_cbranch_scc1 L_pace_128
s_waitcnt vmcnt(2)
s_cmp_eq_u32 s71, 2
s_cbranch_scc0 L_pace_128
s_waitcnt vmcnt(1)
L_pace_128:
s_add_u32 m0, s65, 3072
s_nop 0
buffer_load_dwordx4 v18, s[40:43], s64 offen  lds
s_add_u32 s64, s64, s70
s_cmp_eq_u32 s71, 0
s_cbranch_scc1 L_pace_129
s_waitcnt vmcnt(2)
s_cmp_eq_u32 s71, 2
s_cbranch_scc0 L_pace_129
s_waitcnt vmcnt(1)
L_pace_129:
s_add_u32 m0, s65, 4096
s_nop 0
buffer_load_dwordx4 v17, s[40:43], s64 offen  lds
s_add_u32 s64, s64, s70
s_cmp_eq_u32 s71, 0
s_cbranch_scc1 L_pace_130
s_waitcnt vmcnt(2)
s_cmp_eq_u32 s71, 2
s_cbranch_scc0 L_pace_130
s_waitcnt vmcnt(1)
L_pace_130:
s_add_u32 m0, s65, 5120
s_nop 0
buffer_load_dwordx4 v18, s[40:43], s64 offen  lds
s_add_u32 s64, s64, s70
s_cmp_eq_u32 s71, 0
s_cbranch_scc1 L_pace_131
s_waitcnt vmcnt(2)
s_cmp_eq_u32 s71, 2
s_cbranch_scc0 L_pace_131
s_waitcnt vmcnt(1)
L_pace_131:
s_add_u32 m0, s65, 6144
s_nop 0
buffer_load_dwordx4 v17, s[40:43], s64 offen  lds
s_add_u32 s64, s64, s70
s_cmp_eq_u32 s71, 0
s_cbranch_scc1 L_pace_132
s_waitcnt vmcnt(2)
s_cmp_eq_u32 s71, 2
s_cbranch_scc0 L_pace_132
s_waitcnt vmcnt(1)
L_pace_132:
s_add_u32 m0, s65, 7168
s_nop 0
buffer_load_dwordx4 v18, s[40:43], s64 offen  lds
s_add_u32 s64, s64, s70
s_cmp_eq_u32 s71, 0
s_cbranch_scc1 L_pace_133
s_waitcnt vmcnt(2)
s_cmp_eq_u32 s71, 2
s_cbranch_scc0 L_pace_133
s_waitcnt vmcnt(1)
L_pace_133:
s_add_u32 m0, s65, 32768
s_nop 0
buffer_load_dwordx4 v17, s[40:43], s64 offen  lds
s_add_u32 s64, s64, s70
s_cmp_eq_u32 s71, 0
s_cbranch_scc1 L_pace_134
s_waitcnt vmcnt(2)
s_cmp_eq_u32 s71, 2
s_cbranch_scc0 L_pace_134
s_waitcnt vmcnt(1)
L_pace_134:
s_add_u32 m0, s65, 33792
s_nop 0
buffer_load_dwordx4 v18, s[40:43], s64 offen  lds
s_add_u32 s64, s64, s70
s_cmp_eq_u32 s71, 0
s_cbranch_scc1 L_pace_135
s_waitcnt vmcnt(2)
s_cmp_eq_u32 s71, 2
s_cbranch_scc0 L_pace_135
s_waitcnt vmcnt(1)
L_pace_135:
s_add_u32 m0, s65, 34816
s_nop 0
buffer_load_dwordx4 v17, s[40:43], s64 offen  lds
s_add_u32 s64, s64, s70
s_cmp_eq_u32 s71, 0
s_cbranch_scc1 L_pace_136
s_waitcnt vmcnt(2)
s_cmp_eq_u32 s71, 2
s_cbranch_scc0 L_pace_136
s_waitcnt vmcnt(1)
L_pace_136:
s_add_u32 m0, s65, 35840
s_nop 0
buffer_load_dwordx4 v18, s[40:43], s64 offen  lds
s_add_u32 s64, s64, s70
s_cmp_eq_u32 s71, 0
s_cbranch_scc1 L_pace_137
s_waitcnt vmcnt(2)
s_cmp_eq_u32 s71, 2
s_cbranch_scc0 L_pace_137
s_waitcnt vmcnt(1)
L_pace_137:
s_add_u32 m0, s65, 36864
s_nop 0
buffer_load_dwordx4 v17, s[40:43], s64 offen  lds
s_add_u32 s64, s64, s70
s_cmp_eq_u32 s71, 0
s_cbranch_scc1 L_pace_138
s_waitcnt vmcnt(2)
s_cmp_eq_u32 s71, 2
s_cbranch_scc0 L_pace_138
s_waitcnt vmcnt(1)
L_pace_138:
s_add_u32 m0, s65, 37888
s_nop 0
buffer_load_dwordx4 v18, s[40:43], s64 offen  lds
s_add_u32 s64, s64, s70
s_cmp_eq_u32 s71, 0
s_cbranch_scc1 L_pace_139
s_waitcnt vmcnt(2)
s_cmp_eq_u32 s71, 2
s_cbranch_scc0 L_pace_139
s_waitcnt vmcnt(1)
L_pace_139:
s_add_u32 m0, s65, 38912
s_nop 0
buffer_load_dwordx4 v17, s[40:43], s64 offen  lds
s_add_u32 s64, s64, s70
s_cmp_eq_u32 s71, 0
s_cbranch_scc1 L_pace_140
s_waitcnt vmcnt(2)
s_cmp_eq_u32 s71, 2
s_cbranch_scc0 L_pace_140
s_waitcnt vmcnt(1)
L_pace_140:
s_add_u32 m0, s65, 39936
s_nop 0
buffer_load_dwordx4 v18, s[40:43], s64 offen  lds
s_add_u32 s64, s64, s70
s_waitcnt vmcnt(16)
s_cmp_eq_u32 s34, 0
s_cselect_b32 s73, 48, 0x1000
v_and_b32 v30, 15, v0
v_lshlrev_b32 v30, 2, v30
s_cmp_ge_u32 s2, s73
s_cbranch_scc0 L_fl_141
buffer_load_dword v31, v30, s[52:55], 0 offen sc1
L_fl_141:
s_mov_b32 s68, 0xffff0000
s_cmp_lt_u32 s2, 48
s_cbranch_scc0 L_gq1
s_mov_b32 s66, 0xbfb8aa3b
v_lshlrev_b32 v20, 16, v192
v_and_b32 v21, s68, v192
v_mul_f32 v22, s66, v20
v_mul_f32 v23, s66, v21
v_exp_f32 v22, v22
v_exp_f32 v23, v23
s_nop 0
v_add_f32 v22, 1.0, v22
v_add_f32 v23, 1.0, v23
v_rcp_f32 v22, v22
v_rcp_f32 v23, v23
s_nop 0
v_mul_f32 v20, v20, v22
v_mul_f32 v21, v21, v23
v_cvt_pk_bf16_f32 v48, v20, v21
v_lshlrev_b32 v20, 16, v193
v_and_b32 v21, s68, v193
v_mul_f32 v22, s66, v20
v_mul_f32 v23, s66, v21
v_exp_f32 v22, v22
v_exp_f32 v23, v23
s_nop 0
v_add_f32 v22, 1.0, v22
v_add_f32 v23, 1.0, v23
v_rcp_f32 v22, v22
v_rcp_f32 v23, v23
s_nop 0
v_mul_f32 v20, v20, v22
v_mul_f32 v21, v21, v23
v_cvt_pk_bf16_f32 v49, v20, v21
v_lshlrev_b32 v20, 16, v194
v_and_b32 v21, s68, v194
v_mul_f32 v22, s66, v20
v_mul_f32 v23, s66, v21
v_exp_f32 v22, v22
v_exp_f32 v23, v23
s_nop 0
v_add_f32 v22, 1.0, v22
v_add_f32 v23, 1.0, v23
v_rcp_f32 v22, v22
v_rcp_f32 v23, v23
s_nop 0
v_mul_f32 v20, v20, v22
v_mul_f32 v21, v21, v23
v_cvt_pk_bf16_f32 v50, v20, v21
v_lshlrev_b32 v20, 16, v195
v_and_b32 v21, s68, v195
v_mul_f32 v22, s66, v20
v_mul_f32 v23, s66, v21
v_exp_f32 v22, v22
v_exp_f32 v23, v23
s_nop 0
v_add_f32 v22, 1.0, v22
v_add_f32 v23, 1.0, v23
v_rcp_f32 v22, v22
v_rcp_f32 v23, v23
s_nop 0
v_mul_f32 v20, v20, v22
v_mul_f32 v21, v21, v23
v_cvt_pk_bf16_f32 v51, v20, v21
v_lshlrev_b32 v20, 16, v196
v_and_b32 v21, s68, v196
v_mul_f32 v22, s66, v20
v_mul_f32 v23, s66, v21
v_exp_f32 v22, v22
v_exp_f32 v23, v23
s_nop 0
v_add_f32 v22, 1.0, v22
v_add_f32 v23, 1.0, v23
v_rcp_f32 v22, v22
v_rcp_f32 v23, v23
s_nop 0
v_mul_f32 v20, v20, v22
v_mul_f32 v21, v21, v23
v_cvt_pk_bf16_f32 v52, v20, v21
v_lshlrev_b32 v20, 16, v197
v_and_b32 v21, s68, v197
v_mul_f32 v22, s66, v20
v_mul_f32 v23, s66, v21
v_exp_f32 v22, v22
v_exp_f32 v23, v23
s_nop 0
v_add_f32 v22, 1.0, v22
v_add_f32 v23, 1.0, v23
v_rcp_f32 v22, v22
v_rcp_f32 v23, v23
s_nop 0
v_mul_f32 v20, v20, v22
v_mul_f32 v21, v21, v23
v_cvt_pk_bf16_f32 v53, v20, v21
v_lshlrev_b32 v20, 16, v198
v_and_b32 v21, s68, v198
v_mul_f32 v22, s66, v20
v_mul_f32 v23, s66, v21
v_exp_f32 v22, v22
v_exp_f32 v23, v23
s_nop 0
v_add_f32 v22, 1.0, v22
v_add_f32 v23, 1.0, v23
v_rcp_f32 v22, v22
v_rcp_f32 v23, v23
s_nop 0
v_mul_f32 v20, v20, v22
v_mul_f32 v21, v21, v23
v_cvt_pk_bf16_f32 v54, v20, v21
v_lshlrev_b32 v20, 16, v199
v_and_b32 v21, s68, v199
v_mul_f32 v22, s66, v20
v_mul_f32 v23, s66, v21
v_exp_f32 v22, v22
v_exp_f32 v23, v23
s_nop 0
v_add_f32 v22, 1.0, v22
v_add_f32 v23, 1.0, v23
v_rcp_f32 v22, v22
v_rcp_f32 v23, v23
s_nop 0
v_mul_f32 v20, v20, v22
v_mul_f32 v21, v21, v23
v_cvt_pk_bf16_f32 v55, v20, v21
s_branch L_g2
L_gq1:
v_and_b32 v32, 7, v0
v_lshlrev_b32 v32, 2, v32
v_lshlrev_b32 v96, 16, v192
v_and_b32 v97, s68, v192
v_lshlrev_b32 v98, 16, v193
v_and_b32 v99, s68, v193
v_lshlrev_b32 v100, 16, v194
v_and_b32 v101, s68, v194
v_lshlrev_b32 v102, 16, v195
v_and_b32 v103, s68, v195
v_lshlrev_b32 v104, 16, v196
v_and_b32 v105, s68, v196
v_lshlrev_b32 v106, 16, v197
v_and_b32 v107, s68, v197
v_lshlrev_b32 v108, 16, v198
v_and_b32 v109, s68, v198
v_lshlrev_b32 v110, 16, v199
v_and_b32 v111, s68, v199
v_add_f32 v20, v96, v97
v_add_f32 v20, v20, v98
v_add_f32 v20, v20, v99
v_add_f32 v20, v20, v100
v_add_f32 v20, v20, v101
v_add_f32 v20, v20, v102
v_add_f32 v20, v20, v103
v_add_f32 v20, v20, v104
v_add_f32 v20, v20, v105
v_add_f32 v20, v20, v106
v_add_f32 v20, v20, v107
v_add_f32 v20, v20, v108
v_add_f32 v20, v20, v109
v_add_f32 v20, v20, v110
v_add_f32 v20, v20, v111
s_nop 1
v_add_f32_dpp v20, v20, v20 row_ror:8 row_mask:0xf bank_mask:0xf
v_mov_b32 v22, v20
s_nop 1
v_permlane16_swap_b32 v20, v22
s_nop 1
v_add_f32 v20, v20, v22
v_mov_b32 v22, v20
s_nop 1
v_permlane32_swap_b32 v20, v22
s_nop 1
v_add_f32 v20, v20, v22
v_mul_f32 v20, 0x3c000000, v20
v_mov_b32 v21, 0
v_sub_f32 v22, v96, v20
v_fmac_f32 v21, v22, v22
v_sub_f32 v22, v97, v20
v_fmac_f32 v21, v22, v22
v_sub_f32 v22, v98, v20
v_fmac_f32 v21, v22, v22
v_sub_f32 v22, v99, v20
v_fmac_f32 v21, v22, v22
v_sub_f32 v22, v100, v20
v_fmac_f32 v21, v22, v22
v_sub_f32 v22, v101, v20
v_fmac_f32 v21, v22, v22
v_sub_f32 v22, v102, v20
v_fmac_f32 v21, v22, v22
v_sub_f32 v22, v103, v20
v_fmac_f32 v21, v22, v22
v_sub_f32 v22, v104, v20
v_fmac_f32 v21, v22, v22
v_sub_f32 v22, v105, v20
v_fmac_f32 v21, v22, v22
v_sub_f32 v22, v106, v20
v_fmac_f32 v21, v22, v22
v_sub_f32 v22, v107, v20
v_fmac_f32 v21, v22, v22
v_sub_f32 v22, v108, v20
v_fmac_f32 v21, v22, v22
v_sub_f32 v22, v109, v20
v_fmac_f32 v21, v22, v22
v_sub_f32 v22, v110, v20
v_fmac_f32 v21, v22, v22
v_sub_f32 v22, v111, v20
v_fmac_f32 v21, v22, v22
s_nop 1
v_add_f32_dpp v21, v21, v21 row_ror:8 row_mask:0xf bank_mask:0xf
v_mov_b32 v22, v21
s_nop 1
v_permlane16_swap_b32 v21, v22
s_nop 1
v_add_f32 v21, v21, v22
v_mov_b32 v22, v21
s_nop 1
v_permlane32_swap_b32 v21, v22
s_nop 1
v_add_f32 v21, v21, v22
v_lshlrev_b32 v22, 1, v32
s_lshl_b32 s66, s34, 6
v_add_u32 v23, s66, v22
ds_write_b64 v23, v[20:21] offset:0
v_mov_b32 v23, 0
s_waitcnt lgkmcnt(0)
s_mov_b64 exec, 1
ds_add_u32 v23, v9 offset:332
s_mov_b64 exec, -1
s_mov_b32 s75, 0
L_poll_142:
ds_read_b32 v24, v23 offset:332
s_waitcnt lgkmcnt(0)
v_cmp_gt_u32 vcc, 4, v24
s_cbranch_vccz L_pollx_143
s_add_u32 s75, s75, 1
s_cmp_lt_u32 s75, 0x1000000
s_cbranch_scc1 L_poll_142
L_pollx_143:
ds_read_b64 v[112:113], v22 offset:0
ds_read_b64 v[114:115], v22 offset:64
ds_read_b64 v[116:117], v22 offset:128
ds_read_b64 v[118:119], v22 offset:192
s_waitcnt lgkmcnt(0)
v_add_f32 v20, v112, v114
v_add_f32 v21, v116, v118
v_add_f32 v20, v20, v21
v_mul_f32 v20, 0x3e800000, v20
v_add_f32 v24, v113, v115
v_add_f32 v21, v117, v119
v_add_f32 v24, v24, v21
v_mov_b32 v21, 0
v_sub_f32 v22, v112, v20
v_fmac_f32 v21, v22, v22
v_sub_f32 v22, v114, v20
v_fmac_f32 v21, v22, v22
v_sub_f32 v22, v116, v20
v_fmac_f32 v21, v22, v22
v_sub_f32 v22, v118, v20
v_fmac_f32 v21, v22, v22
v_fmac_f32 v24, 0x43000000, v21
v_mul_f32 v24, 0x3b000000, v24
v_cvt_pk_bf16_f32 v24, 0, v24
v_cvt_pk_bf16_f32 v20, 0, v20
v_add_f32 v24, 0x3727c5ac, v24
v_cvt_pk_bf16_f32 v24, 0, v24
v_sqrt_f32 v24, v24
s_nop 0
v_cvt_pk_bf16_f32 v24, 0, v24
v_rcp_f32 v24, v24
s_nop 0
v_sub_f32 v96, v96, v20
v_cvt_pk_bf16_f32 v96, 0, v96
v_mul_f32 v96, v96, v24
v_cvt_pk_bf16_f32 v96, 0, v96
v_sub_f32 v97, v97, v20
v_cvt_pk_bf16_f32 v97, 0, v97
v_mul_f32 v97, v97, v24
v_cvt_pk_bf16_f32 v97, 0, v97
v_sub_f32 v98, v98, v20
v_cvt_pk_bf16_f32 v98, 0, v98
v_mul_f32 v98, v98, v24
v_cvt_pk_bf16_f32 v98, 0, v98
v_sub_f32 v99, v99, v20
v_cvt_pk_bf16_f32 v99, 0, v99
v_mul_f32 v99, v99, v24
v_cvt_pk_bf16_f32 v99, 0, v99
v_sub_f32 v100, v100, v20
v_cvt_pk_bf16_f32 v100, 0, v100
v_mul_f32 v100, v100, v24
v_cvt_pk_bf16_f32 v100, 0, v100
v_sub_f32 v101, v101, v20
v_cvt_pk_bf16_f32 v101, 0, v101
v_mul_f32 v101, v101, v24
v_cvt_pk_bf16_f32 v101, 0, v101
v_sub_f32 v102, v102, v20
v_cvt_pk_bf16_f32 v102, 0, v102
v_mul_f32 v102, v102, v24
v_cvt_pk_bf16_f32 v102, 0, v102
v_sub_f32 v103, v103, v20
v_cvt_pk_bf16_f32 v103, 0, v103
v_mul_f32 v103, v103, v24
v_cvt_pk_bf16_f32 v103, 0, v103
v_sub_f32 v104, v104, v20
v_cvt_pk_bf16_f32 v104, 0, v104
v_mul_f32 v104, v104, v24
v_cvt_pk_bf16_f32 v104, 0, v104
v_sub_f32 v105, v105, v20
v_cvt_pk_bf16_f32 v105, 0, v105
v_mul_f32 v105, v105, v24
v_cvt_pk_bf16_f32 v105, 0, v105
v_sub_f32 v106, v106, v20
v_cvt_pk_bf16_f32 v106, 0, v106
v_mul_f32 v106, v106, v24
v_cvt_pk_bf16_f32 v106, 0, v106
v_sub_f32 v107, v107, v20
v_cvt_pk_bf16_f32 v107, 0, v107
v_mul_f32 v107, v107, v24
v_cvt_pk_bf16_f32 v107, 0, v107
v_sub_f32 v108, v108, v20
v_cvt_pk_bf16_f32 v108, 0, v108
v_mul_f32 v108, v108, v24
v_cvt_pk_bf16_f32 v108, 0, v108
v_sub_f32 v109, v109, v20
v_cvt_pk_bf16_f32 v109, 0, v109
v_mul_f32 v109, v109, v24
v_cvt_pk_bf16_f32 v109, 0, v109
v_sub_f32 v110, v110, v20
v_cvt_pk_bf16_f32 v110, 0, v110
v_mul_f32 v110, v110, v24
v_cvt_pk_bf16_f32 v110, 0, v110
v_sub_f32 v111, v111, v20
v_cvt_pk_bf16_f32 v111, 0, v111
v_mul_f32 v111, v111, v24
v_cvt_pk_bf16_f32 v111, 0, v111
L_g2:
s_cmp_ge_u32 s2, s73
s_cbranch_scc0 L_fl_144
s_waitcnt vmcnt(0)
v_cmp_eq_u32 vcc, 0, v31
s_cbranch_vccz L_fl_144
s_mov_b32 s75, 0
L_poll_145:
buffer_load_dword v31, v30, s[52:55], 0 offen sc1
s_waitcnt vmcnt(0)
v_cmp_eq_u32 vcc, 0, v31
s_cbranch_vccz L_pollx_146
s_sleep 40
s_add_u32 s75, s75, 1
s_cmp_lt_u32 s75, 0x100000
s_cbranch_scc1 L_poll_145
L_pollx_146:
L_fl_144:
v_mov_b32 v20, 0
s_cmp_eq_u32 s34, 0
s_cbranch_scc0 L_w_147
ds_write_b32 v20, v9 offset:324
L_w_147:
v_lshrrev_b32 v18, 4, v0
v_bfe_u32 v19, v0, 2, 2
v_lshrrev_b32 v20, 1, v19
v_and_b32 v21, 1, v18
v_lshl_add_u32 v20, v21, 1, v20
v_lshlrev_b32 v20, 5, v20
v_lshl_add_u32 v20, v18, 10, v20
v_lshl_add_u32 v20, v19, 7, v20
v_and_b32 v21, 3, v0
v_lshl_add_u32 v20, v21, 3, v20
v_add_u32 v40, s65, v20
v_xor_b32 v41, 32, v40
v_xor_b32 v42, 64, v40
v_xor_b32 v43, 96, v40
s_waitcnt vmcnt(12) lgkmcnt(0)
ds_read_b64_tr_b16 v[128:129], v40 offset:0
ds_read_b64_tr_b16 v[130:131], v40 offset:512
ds_read_b64_tr_b16 v[132:133], v41 offset:0
ds_read_b64_tr_b16 v[134:135], v41 offset:512
ds_read_b64_tr_b16 v[136:137], v42 offset:0
ds_read_b64_tr_b16 v[138:139], v42 offset:512
ds_read_b64_tr_b16 v[140:141], v43 offset:0
ds_read_b64_tr_b16 v[142:143], v43 offset:512
s_waitcnt vmcnt(8) lgkmcnt(0)
ds_read_b64_tr_b16 v[144:145], v40 offset:4096
ds_read_b64_tr_b16 v[146:147], v40 offset:4608
ds_read_b64_tr_b16 v[148:149], v41 offset:4096
ds_read_b64_tr_b16 v[150:151], v41 offset:4608
ds_read_b64_tr_b16 v[152:153], v42 offset:4096
ds_read_b64_tr_b16 v[154:155], v42 offset:4608
ds_read_b64_tr_b16 v[156:157], v43 offset:4096
ds_read_b64_tr_b16 v[158:159], v43 offset:4608
s_waitcnt vmcnt(4) lgkmcnt(0)
ds_read_b64_tr_b16 v[160:161], v40 offset:32768
ds_read_b64_tr_b16 v[162:163], v40 offset:33280
ds_read_b64_tr_b16 v[164:165], v41 offset:32768
ds_read_b64_tr_b16 v[166:167], v41 offset:33280
ds_read_b64_tr_b16 v[168:169], v42 offset:32768
ds_read_b64_tr_b16 v[170:171], v42 offset:33280
ds_read_b64_tr_b16 v[172:173], v43 offset:32768
ds_read_b64_tr_b16 v[174:175], v43 offset:33280
s_waitcnt vmcnt(0) lgkmcnt(0)
ds_read_b64_tr_b16 v[176:177], v40 offset:36864
ds_read_b64_tr_b16 v[178:179], v40 offset:37376
ds_read_b64_tr_b16 v[180:181], v41 offset:36864
ds_read_b64_tr_b16 v[182:183], v41 offset:37376
ds_read_b64_tr_b16 v[184:185], v42 offset:36864
ds_read_b64_tr_b16 v[186:187], v42 offset:37376
ds_read_b64_tr_b16 v[188:189], v43 offset:36864
ds_read_b64_tr_b16 v[190:191], v43 offset:37376
s_waitcnt lgkmcnt(0)
s_cmp_eq_u32 s34, 2
s_cselect_b32 s73, 16, 0x1000
v_and_b32 v30, 31, v0
v_lshlrev_b32 v30, 2, v30
s_cmp_ge_u32 s2, s73
s_cbranch_scc0 L_fl_148
buffer_load_dword v31, v30, s[52:55], 0 offen offset:128 sc1
L_fl_148:
s_cmp_lt_u32 s2, 48
s_cbranch_scc1 L_g3
v_mov_b32 v20, 0
s_mov_b32 s75, 0
L_poll_149:
ds_read_b32 v22, v20 offset:324
s_waitcnt lgkmcnt(0)
v_cmp_eq_u32 vcc, 0, v22
s_cbranch_vccz L_pollx_150
s_sleep 1
s_add_u32 s75, s75, 1
s_cmp_lt_u32 s75, 0x1000000
s_cbranch_scc1 L_poll_149
L_pollx_150:
s_lshl_b32 s64, s34, 11
s_add_u32 s64, s64, 0
s_add_u32 s66, s64, 8192
s_mov_b32 s75, 0
L_poll_151:
buffer_load_dwordx4 v[192:195], v1, s[36:39], s64 offen offset:0 sc1
buffer_load_dwordx4 v[200:203], v1, s[36:39], s66 offen offset:0 sc1
buffer_load_dwordx4 v[196:199], v1, s[36:39], s64 offen offset:1024 sc1
buffer_load_dwordx4 v[204:207], v1, s[36:39], s66 offen offset:1024 sc1
s_waitcnt vmcnt(0)
v_max3_u32 v22, v192, v193, v194
v_max3_u32 v22, v22, v195, v196
v_max3_u32 v22, v22, v197, v198
v_max3_u32 v22, v22, v199, v200
v_max3_u32 v22, v22, v201, v202
v_max3_u32 v22, v22, v203, v204
v_max3_u32 v22, v22, v205, v206
v_max_u32 v22, v22, v207
v_cmp_eq_u32 vcc, -1, v22
s_cbranch_vccz L_pollx_152
s_sleep 16
s_add_u32 s75, s75, 1
s_cmp_lt_u32 s75, 0x100000
s_cbranch_scc1 L_poll_151
L_pollx_152:
v_lshlrev_b32 v20, 16, v200
v_and_b32 v21, s68, v200
v_add_f32 v20, 1.0, v20
v_add_f32 v21, 1.0, v21
v_cvt_pk_bf16_f32 v20, 0, v20
v_cvt_pk_bf16_f32 v21, 0, v21
v_mul_f32 v20, v20, v96
v_mul_f32 v21, v21, v97
v_cvt_pk_bf16_f32 v20, 0, v20
v_cvt_pk_bf16_f32 v21, 0, v21
v_lshlrev_b32 v22, 16, v192
v_and_b32 v23, s68, v192
v_add_f32 v20, v20, v22
v_add_f32 v21, v21, v23
v_cvt_pk_bf16_f32 v48, v20, v21
v_lshlrev_b32 v20, 16, v201
v_and_b32 v21, s68, v201
v_add_f32 v20, 1.0, v20
v_add_f32 v21, 1.0, v21
v_cvt_pk_bf16_f32 v20, 0, v20
v_cvt_pk_bf16_f32 v21, 0, v21
v_mul_f32 v20, v20, v98
v_mul_f32 v21, v21, v99
v_cvt_pk_bf16_f32 v20, 0, v20
v_cvt_pk_bf16_f32 v21, 0, v21
v_lshlrev_b32 v22, 16, v193
v_and_b32 v23, s68, v193
v_add_f32 v20, v20, v22
v_add_f32 v21, v21, v23
v_cvt_pk_bf16_f32 v49, v20, v21
v_lshlrev_b32 v20, 16, v202
v_and_b32 v21, s68, v202
v_add_f32 v20, 1.0, v20
v_add_f32 v21, 1.0, v21
v_cvt_pk_bf16_f32 v20, 0, v20
v_cvt_pk_bf16_f32 v21, 0, v21
v_mul_f32 v20, v20, v100
v_mul_f32 v21, v21, v101
v_cvt_pk_bf16_f32 v20, 0, v20
v_cvt_pk_bf16_f32 v21, 0, v21
v_lshlrev_b32 v22, 16, v194
v_and_b32 v23, s68, v194
v_add_f32 v20, v20, v22
v_add_f32 v21, v21, v23
v_cvt_pk_bf16_f32 v50, v20, v21
v_lshlrev_b32 v20, 16, v203
v_and_b32 v21, s68, v203
v_add_f32 v20, 1.0, v20
v_add_f32 v21, 1.0, v21
v_cvt_pk_bf16_f32 v20, 0, v20
v_cvt_pk_bf16_f32 v21, 0, v21
v_mul_f32 v20, v20, v102
v_mul_f32 v21, v21, v103
v_cvt_pk_bf16_f32 v20, 0, v20
v_cvt_pk_bf16_f32 v21, 0, v21
v_lshlrev_b32 v22, 16, v195
v_and_b32 v23, s68, v195
v_add_f32 v20, v20, v22
v_add_f32 v21, v21, v23
v_cvt_pk_bf16_f32 v51, v20, v21
v_lshlrev_b32 v20, 16, v204
v_and_b32 v21, s68, v204
v_add_f32 v20, 1.0, v20
v_add_f32 v21, 1.0, v21
v_cvt_pk_bf16_f32 v20, 0, v20
v_cvt_pk_bf16_f32 v21, 0, v21
v_mul_f32 v20, v20, v104
v_mul_f32 v21, v21, v105
v_cvt_pk_bf16_f32 v20, 0, v20
v_cvt_pk_bf16_f32 v21, 0, v21
v_lshlrev_b32 v22, 16, v196
v_and_b32 v23, s68, v196
v_add_f32 v20, v20, v22
v_add_f32 v21, v21, v23
v_cvt_pk_bf16_f32 v52, v20, v21
v_lshlrev_b32 v20, 16, v205
v_and_b32 v21, s68, v205
v_add_f32 v20, 1.0, v20
v_add_f32 v21, 1.0, v21
v_cvt_pk_bf16_f32 v20, 0, v20
v_cvt_pk_bf16_f32 v21, 0, v21
v_mul_f32 v20, v20, v106
v_mul_f32 v21, v21, v107
v_cvt_pk_bf16_f32 v20, 0, v20
v_cvt_pk_bf16_f32 v21, 0, v21
v_lshlrev_b32 v22, 16, v197
v_and_b32 v23, s68, v197
v_add_f32 v20, v20, v22
v_add_f32 v21, v21, v23
v_cvt_pk_bf16_f32 v53, v20, v21
v_lshlrev_b32 v20, 16, v206
v_and_b32 v21, s68, v206
v_add_f32 v20, 1.0, v20
v_add_f32 v21, 1.0, v21
v_cvt_pk_bf16_f32 v20, 0, v20
v_cvt_pk_bf16_f32 v21, 0, v21
v_mul_f32 v20, v20, v108
v_mul_f32 v21, v21, v109
v_cvt_pk_bf16_f32 v20, 0, v20
v_cvt_pk_bf16_f32 v21, 0, v21
v_lshlrev_b32 v22, 16, v198
v_and_b32 v23, s68, v198
v_add_f32 v20, v20, v22
v_add_f32 v21, v21, v23
v_cvt_pk_bf16_f32 v54, v20, v21
v_lshlrev_b32 v20, 16, v207
v_and_b32 v21, s68, v207
v_add_f32 v20, 1.0, v20
v_add_f32 v21, 1.0, v21
v_cvt_pk_bf16_f32 v20, 0, v20
v_cvt_pk_bf16_f32 v21, 0, v21
v_mul_f32 v20, v20, v110
v_mul_f32 v21, v21, v111
v_cvt_pk_bf16_f32 v20, 0, v20
v_cvt_pk_bf16_f32 v21, 0, v21
v_lshlrev_b32 v22, 16, v199
v_and_b32 v23, s68, v199
v_add_f32 v20, v20, v22
v_add_f32 v21, v21, v23
v_cvt_pk_bf16_f32 v55, v20, v21
L_g3:
s_cmp_ge_u32 s2, s73
s_cbranch_scc0 L_fl_153
s_waitcnt vmcnt(0)
v_cmp_eq_u32 vcc, 0, v31
s_cbranch_vccz L_fl_153
s_mov_b32 s75, 0
L_poll_154:
buffer_load_dword v31, v30, s[52:55], 0 offen offset:128 sc1
s_waitcnt vmcnt(0)
v_cmp_eq_u32 vcc, 0, v31
s_cbranch_vccz L_pollx_155
s_sleep 40
s_add_u32 s75, s75, 1
s_cmp_lt_u32 s75, 0x100000
s_cbranch_scc1 L_poll_154
L_pollx_155:
L_fl_153:
s_nop 1
v_mfma_f32_16x16x32_bf16 v[64:67], v[128:131], v[48:51], 0
v_mfma_f32_16x16x32_bf16 v[68:71], v[132:135], v[48:51], 0
v_mfma_f32_16x16x32_bf16 v[72:75], v[136:139], v[48:51], 0
v_mfma_f32_16x16x32_bf16 v[76:79], v[140:143], v[48:51], 0
v_mfma_f32_16x16x32_bf16 v[80:83], v[144:147], v[48:51], 0
v_mfma_f32_16x16x32_bf16 v[84:87], v[148:151], v[48:51], 0
v_mfma_f32_16x16x32_bf16 v[88:91], v[152:155], v[48:51], 0
v_mfma_f32_16x16x32_bf16 v[92:95], v[156:159], v[48:51], 0
v_mfma_f32_16x16x32_bf16 v[64:67], v[160:163], v[52:55], v[64:67]
v_mfma_f32_16x16x32_bf16 v[68:71], v[164:167], v[52:55], v[68:71]
v_mfma_f32_16x16x32_bf16 v[72:75], v[168:171], v[52:55], v[72:75]
v_mfma_f32_16x16x32_bf16 v[76:79], v[172:175], v[52:55], v[76:79]
v_mfma_f32_16x16x32_bf16 v[80:83], v[176:179], v[52:55], v[80:83]
v_mfma_f32_16x16x32_bf16 v[84:87], v[180:183], v[52:55], v[84:87]
v_mfma_f32_16x16x32_bf16 v[88:91], v[184:187], v[52:55], v[88:91]
v_mfma_f32_16x16x32_bf16 v[92:95], v[188:191], v[52:55], v[92:95]
v_and_b32 v20, 7, v0
v_mul_u32_u24 v20, 272, v20
v_and_b32 v21, 8, v0
v_lshl_add_u32 v20, v21, 3, v20
v_and_b32 v21, 48, v0
v_add_u32 v20, v20, v21
s_mul_i32 s64, s34, 8192
s_add_u32 s64, s64, 4096
v_add_u32 v20, s64, v20
s_nop 7
v_add_f32_dpp v24, v80, v64 row_ror:8 row_mask:0xf bank_mask:0x3
v_add_f32_dpp v24, v68, v84 row_ror:8 row_mask:0xf bank_mask:0xc
v_add_f32_dpp v25, v81, v65 row_ror:8 row_mask:0xf bank_mask:0x3
v_add_f32_dpp v25, v69, v85 row_ror:8 row_mask:0xf bank_mask:0xc
v_add_f32_dpp v26, v82, v66 row_ror:8 row_mask:0xf bank_mask:0x3
v_add_f32_dpp v26, v70, v86 row_ror:8 row_mask:0xf bank_mask:0xc
v_add_f32_dpp v27, v83, v67 row_ror:8 row_mask:0xf bank_mask:0x3
v_add_f32_dpp v27, v71, v87 row_ror:8 row_mask:0xf bank_mask:0xc
ds_write_b128 v20, v[24:27] offset:0
v_add_f32_dpp v28, v88, v72 row_ror:8 row_mask:0xf bank_mask:0x3
v_add_f32_dpp v28, v76, v92 row_ror:8 row_mask:0xf bank_mask:0xc
v_add_f32_dpp v29, v89, v73 row_ror:8 row_mask:0xf bank_mask:0x3
v_add_f32_dpp v29, v77, v93 row_ror:8 row_mask:0xf bank_mask:0xc
v_add_f32_dpp v30, v90, v74 row_ror:8 row_mask:0xf bank_mask:0x3
v_add_f32_dpp v30, v78, v94 row_ror:8 row_mask:0xf bank_mask:0xc
v_add_f32_dpp v31, v91, v75 row_ror:8 row_mask:0xf bank_mask:0x3
v_add_f32_dpp v31, v79, v95 row_ror:8 row_mask:0xf bank_mask:0xc
ds_write_b128 v20, v[28:31] offset:128
v_mov_b32 v20, 0
s_waitcnt lgkmcnt(0)
s_mov_b64 exec, 1
ds_add_u32 v20, v9 offset:320
s_mov_b64 exec, -1
s_cmp_eq_u32 s34, 0
s_cbranch_scc0 L_waitq
s_cmp_lt_u32 s2, 16
s_cbranch_scc0 L_gq2
v_and_b32 v21, 7, v0
v_lshrrev_b32 v22, 4, v0
v_and_b32 v23, 8, v0
v_lshrrev_b32 v23, 1, v23
v_add_u32 v22, v22, v23
v_mov_b32 v23, v1
s_lshl_b32 s64, s72, 10
s_add_u32 s64, s64, 0
s_branch L_g4
L_gq2:
v_lshrrev_b32 v21, 3, v0
v_and_b32 v22, 7, v0
s_mov_b32 s64, 10240
s_cmp_lt_u32 s2, 48
s_cselect_b32 s64, 22528, s64
s_mov_b32 s65, 12288
v_mul_lo_u32 v23, s65, v21
v_lshl_add_u32 v23, v22, 4, v23
s_lshl_b32 s66, s72, 7
s_add_u32 s64, s64, s66
L_g4:
v_mul_u32_u24 v21, 272, v21
v_lshl_add_u32 v21, v22, 5, v21
v_add_u32 v21, 4096, v21
s_mov_b32 s75, 0
L_poll_156:
ds_read_b32 v22, v20 offset:320
s_waitcnt lgkmcnt(0)
v_cmp_gt_u32 vcc, 4, v22
s_cbranch_vccz L_pollx_157
s_add_u32 s75, s75, 1
s_cmp_lt_u32 s75, 0x1000000
s_cbranch_scc1 L_poll_156
L_pollx_157:
ds_read_b128 v[64:67], v21 offset:0
ds_read_b128 v[68:71], v21 offset:16
ds_read_b128 v[72:75], v21 offset:8192
ds_read_b128 v[76:79], v21 offset:8208
ds_read_b128 v[80:83], v21 offset:16384
ds_read_b128 v[84:87], v21 offset:16400
ds_read_b128 v[88:91], v21 offset:24576
ds_read_b128 v[92:95], v21 offset:24592
s_waitcnt lgkmcnt(0)
v_add_f32 v64, v64, v72
v_add_f32 v65, v65, v73
v_add_f32 v66, v66, v74
v_add_f32 v67, v67, v75
v_add_f32 v68, v68, v76
v_add_f32 v69, v69, v77
v_add_f32 v70, v70, v78
v_add_f32 v71, v71, v79
v_add_f32 v64, v64, v80
v_add_f32 v65, v65, v81
v_add_f32 v66, v66, v82
v_add_f32 v67, v67, v83
v_add_f32 v68, v68, v84
v_add_f32 v69, v69, v85
v_add_f32 v70, v70, v86
v_add_f32 v71, v71, v87
v_add_f32 v64, v64, v88
v_add_f32 v65, v65, v89
v_add_f32 v66, v66, v90
v_add_f32 v67, v67, v91
v_add_f32 v68, v68, v92
v_add_f32 v69, v69, v93
v_add_f32 v70, v70, v94
v_add_f32 v71, v71, v95
v_cvt_pk_bf16_f32 v24, v64, v65
v_cvt_pk_bf16_f32 v25, v66, v67
v_cvt_pk_bf16_f32 v26, v68, v69
v_cvt_pk_bf16_f32 v27, v70, v71
v_min_u32 v24, -2, v24
v_min_u32 v25, -2, v25
v_min_u32 v26, -2, v26
v_min_u32 v27, -2, v27
buffer_store_dwordx4 v[24:27], v23, s[36:39], s64 offen sc1
s_branch L_waitq
L_jan:
v_mov_b32 v4, -1
v_mov_b32 v5, -1
v_mov_b32 v6, -1
v_mov_b32 v7, -1
s_lshl_b32 s67, s64, 2
s_add_u32 s67, s67, s34
s_cmp_lt_u32 s67, 32
s_cselect_b32 s66, 0, 933888
s_mul_i32 s65, s67, 3072
s_add_u32 s65, s65, s66
s_add_u32 s65, s65, 16384
v_add_u32 v8, s65, v1
global_store_dwordx4 v8, v[4:7], s[30:31] offset:0 sc1
global_store_dwordx4 v8, v[4:7], s[30:31] offset:1024 sc1
global_store_dwordx4 v8, v[4:7], s[30:31] offset:2048 sc1
s_and_b32 s66, s67, 64
s_add_u32 s67, s67, s66
s_lshl_b32 s67, s67, 7
s_add_u32 s67, s67, 1343488
v_and_b32 v8, 8, v0
v_lshlrev_b32 v8, 10, v8
v_and_b32 v10, 0x70, v1
v_add3_u32 v8, v8, v10, s67
s_mov_b64 exec, 0xffff
global_store_dwordx4 v8, v[4:7], s[30:31] sc1
s_mov_b64 exec, 1
s_load_dword s68, s[30:31], 0x48000
s_and_b32 s65, s34, 1
s_lshl_b32 s66, s65, 13
s_xor_b32 s67, s67, s66
s_xor_b32 s66, s67, 0x2000
s_waitcnt vmcnt(0) lgkmcnt(0)
s_mov_b64 exec, -1
s_cmp_eq_u32 s34, 3
s_cbranch_scc1 L_p0_158
s_cmp_eq_u32 s34, 0
s_cselect_b32 s62, s24, s10
s_cselect_b32 s63, s25, s11
s_cmp_eq_u32 s34, 2
s_cselect_b32 s62, s12, s62
s_cselect_b32 s63, s13, s63
global_load_dword v12, v38, s[62:63]
global_load_dword v13, v39, s[62:63]
L_p0_158:
s_mov_b64 exec, 1
s_mov_b32 s70, 0
s_load_dword s68, s[30:31], s67
L_race_159:
s_getreg_b32 s69, hwreg(HW_REG_IB_STS, 8, 4)
s_add_u32 s70, s70, 1
s_cmp_eq_u32 s69, 0
s_cbranch_scc0 L_race_159
s_waitcnt lgkmcnt(0)
s_mov_b32 s71, 0
s_load_dword s68, s[30:31], s66
L_race_160:
s_getreg_b32 s69, hwreg(HW_REG_IB_STS, 8, 4)
s_add_u32 s71, s71, 1
s_cmp_eq_u32 s69, 0
s_cbranch_scc0 L_race_160
s_waitcnt lgkmcnt(0)
s_cmp_lt_u32 s71, s70
s_cselect_b32 s70, 1, 0
s_xor_b32 s70, s70, s65
s_getreg_b32 s69, hwreg(HW_REG_XCC_ID, 2, 1)
s_xor_b32 s70, s70, s69
s_lshl_b32 s69, s69, 14
s_lshl_b32 s70, s70, 8
s_add_u32 s70, s70, s69
s_add_u32 s70, s70, 1
v_mov_b32 v9, s70
s_lshl_b32 s65, s64, 2
v_mov_b32 v8, s65
ds_add_rtn_u32 v11, v2, v9 offset:320
s_waitcnt lgkmcnt(0)
v_add_u32 v11, v11, v9
v_and_b32 v10, 0xff, v11
v_cmp_eq_u32 vcc, 4, v10
s_cbranch_vccz L_j_161
global_store_dword v8, v11, s[28:29] offset:128 sc1
L_j_161:
s_mov_b64 exec, -1
s_branch L_nop0
L_norole:
s_cmp_eq_u32 s74, -1
s_cbranch_scc1 L_waitq
L_waitq:
s_cmp_eq_u32 s74, -1
s_cselect_b64 vcc, 0, -1
s_cmp_lt_u32 s2, 112
s_cselect_b64 vcc, -1, vcc
s_mov_b32 s44, s12
s_mov_b32 s45, s13
s_mov_b32 s46, 0x400000
s_mov_b32 s47, 0x20000
v_lshrrev_b32 v18, 4, v0
v_and_b32 v16, 15, v0
v_xor_b32 v16, v16, v18
v_xor_b32 v17, 4, v16
v_lshlrev_b32 v19, 10, v18
v_lshl_add_u32 v22, v16, 4, v19
v_lshl_add_u32 v23, v17, 4, v19
v_and_b32 v19, 1, v18
v_lshlrev_b32 v19, 10, v19
v_lshrrev_b32 v18, 1, v18
v_lshl_add_u32 v18, v18, 11, v19
v_lshl_add_u32 v16, v16, 4, v18
v_lshl_add_u32 v17, v17, 4, v18
v_lshrrev_b32 v18, 4, v0
v_bfe_u32 v19, v0, 2, 2
v_and_b32 v20, 2, v0
v_lshlrev_b32 v20, 2, v20
v_xor_b32 v20, v20, v19
v_and_b32 v21, 1, v18
v_lshlrev_b32 v21, 2, v21
v_xor_b32 v20, v20, v21
v_lshlrev_b32 v20, 4, v20
v_lshl_add_u32 v20, v18, 10, v20
v_lshl_add_u32 v20, v19, 8, v20
v_and_b32 v21, 1, v0
v_lshl_add_u32 v20, v21, 3, v20
s_lshl_b32 s65, s34, 13
s_add_u32 s65, s65, 8192
v_add_u32 v40, s65, v20
v_xor_b32 v41, 16, v40
v_xor_b32 v42, 32, v40
v_xor_b32 v43, 48, v40
v_xor_b32 v44, 64, v40
v_xor_b32 v45, 80, v40
v_xor_b32 v46, 96, v40
v_xor_b32 v47, 112, v40
s_lshl_b32 s64, s33, 17
s_lshl_b32 s66, s34, 8
s_add_u32 s64, s64, s66
s_mov_b32 s68, 0
s_lshl_b32 s66, s68, 10
s_add_u32 s64, s64, s66
s_add_u32 m0, s65, 0
s_xor_b32 s66, s64, 0
buffer_load_dwordx4 v16, s[44:47], s66 offen  lds
s_add_u32 m0, s65, 1024
s_xor_b32 s66, s64, 8192
buffer_load_dwordx4 v17, s[44:47], s66 offen  lds
s_add_u32 m0, s65, 2048
s_xor_b32 s66, s64, 16384
buffer_load_dwordx4 v16, s[44:47], s66 offen  lds
s_waitcnt vmcnt(2)
s_add_u32 m0, s65, 3072
s_xor_b32 s66, s64, 24576
buffer_load_dwordx4 v17, s[44:47], s66 offen  lds
s_waitcnt vmcnt(2)
s_add_u32 m0, s65, 32768
s_xor_b32 s66, s64, 4096
buffer_load_dwordx4 v16, s[44:47], s66 offen  lds
s_waitcnt vmcnt(2)
s_add_u32 m0, s65, 33792
s_xor_b32 s66, s64, 12288
buffer_load_dwordx4 v17, s[44:47], s66 offen  lds
s_waitcnt vmcnt(2)
ds_read_b64_tr_b16 v[128:129], v40 offset:0
ds_read_b64_tr_b16 v[136:137], v41 offset:0
ds_read_b64_tr_b16 v[144:145], v42 offset:0
ds_read_b64_tr_b16 v[152:153], v43 offset:0
ds_read_b64_tr_b16 v[160:161], v44 offset:0
ds_read_b64_tr_b16 v[168:169], v45 offset:0
ds_read_b64_tr_b16 v[176:177], v46 offset:0
ds_read_b64_tr_b16 v[184:185], v47 offset:0
s_add_u32 m0, s65, 34816
s_xor_b32 s66, s64, 20480
buffer_load_dwordx4 v16, s[44:47], s66 offen  lds
s_waitcnt vmcnt(2)
s_add_u32 m0, s65, 35840
s_xor_b32 s66, s64, 28672
buffer_load_dwordx4 v17, s[44:47], s66 offen  lds
s_waitcnt vmcnt(2)
s_waitcnt lgkmcnt(0)
s_add_u32 m0, s65, 0
s_xor_b32 s66, s64, 32768
buffer_load_dwordx4 v16, s[44:47], s66 offen  lds
s_waitcnt vmcnt(2)
s_add_u32 m0, s65, 1024
s_xor_b32 s66, s64, 40960
buffer_load_dwordx4 v17, s[44:47], s66 offen  lds
s_waitcnt vmcnt(2)
ds_read_b64_tr_b16 v[130:131], v40 offset:32768
ds_read_b64_tr_b16 v[138:139], v41 offset:32768
ds_read_b64_tr_b16 v[146:147], v42 offset:32768
ds_read_b64_tr_b16 v[154:155], v43 offset:32768
ds_read_b64_tr_b16 v[162:163], v44 offset:32768
ds_read_b64_tr_b16 v[170:171], v45 offset:32768
ds_read_b64_tr_b16 v[178:179], v46 offset:32768
ds_read_b64_tr_b16 v[186:187], v47 offset:32768
s_add_u32 m0, s65, 2048
s_xor_b32 s66, s64, 49152
buffer_load_dwordx4 v16, s[44:47], s66 offen  lds
s_waitcnt vmcnt(2)
s_add_u32 m0, s65, 3072
s_xor_b32 s66, s64, 57344
buffer_load_dwordx4 v17, s[44:47], s66 offen  lds
s_waitcnt vmcnt(2)
s_waitcnt lgkmcnt(0)
s_add_u32 m0, s65, 32768
s_xor_b32 s66, s64, 36864
buffer_load_dwordx4 v16, s[44:47], s66 offen  lds
s_waitcnt vmcnt(2)
s_add_u32 m0, s65, 33792
s_xor_b32 s66, s64, 45056
buffer_load_dwordx4 v17, s[44:47], s66 offen  lds
s_waitcnt vmcnt(2)
ds_read_b64_tr_b16 v[132:133], v40 offset:0
ds_read_b64_tr_b16 v[140:141], v41 offset:0
ds_read_b64_tr_b16 v[148:149], v42 offset:0
ds_read_b64_tr_b16 v[156:157], v43 offset:0
ds_read_b64_tr_b16 v[164:165], v44 offset:0
ds_read_b64_tr_b16 v[172:173], v45 offset:0
ds_read_b64_tr_b16 v[180:181], v46 offset:0
ds_read_b64_tr_b16 v[188:189], v47 offset:0
s_add_u32 m0, s65, 34816
s_xor_b32 s66, s64, 53248
buffer_load_dwordx4 v16, s[44:47], s66 offen  lds
s_waitcnt vmcnt(2)
s_add_u32 m0, s65, 35840
s_xor_b32 s66, s64, 61440
buffer_load_dwordx4 v17, s[44:47], s66 offen  lds
s_waitcnt vmcnt(2)
s_waitcnt lgkmcnt(0)
s_add_u32 m0, s65, 0
s_xor_b32 s66, s64, 65536
buffer_load_dwordx4 v16, s[44:47], s66 offen  lds
s_waitcnt vmcnt(2)
s_add_u32 m0, s65, 1024
s_xor_b32 s66, s64, 73728
buffer_load_dwordx4 v17, s[44:47], s66 offen  lds
s_waitcnt vmcnt(2)
ds_read_b64_tr_b16 v[134:135], v40 offset:32768
ds_read_b64_tr_b16 v[142:143], v41 offset:32768
ds_read_b64_tr_b16 v[150:151], v42 offset:32768
ds_read_b64_tr_b16 v[158:159], v43 offset:32768
ds_read_b64_tr_b16 v[166:167], v44 offset:32768
ds_read_b64_tr_b16 v[174:175], v45 offset:32768
ds_read_b64_tr_b16 v[182:183], v46 offset:32768
ds_read_b64_tr_b16 v[190:191], v47 offset:32768
s_add_u32 m0, s65, 2048
s_xor_b32 s66, s64, 81920
buffer_load_dwordx4 v16, s[44:47], s66 offen  lds
s_waitcnt vmcnt(2)
s_add_u32 m0, s65, 3072
s_xor_b32 s66, s64, 90112
buffer_load_dwordx4 v17, s[44:47], s66 offen  lds
s_waitcnt vmcnt(2)
s_waitcnt lgkmcnt(0)
s_add_u32 m0, s65, 32768
s_xor_b32 s66, s64, 69632
buffer_load_dwordx4 v16, s[44:47], s66 offen  lds
s_waitcnt vmcnt(2)
s_add_u32 m0, s65, 33792
s_xor_b32 s66, s64, 77824
buffer_load_dwordx4 v17, s[44:47], s66 offen  lds
s_waitcnt vmcnt(2)
ds_read_b64_tr_b16 v[192:193], v40 offset:0
ds_read_b64_tr_b16 v[200:201], v41 offset:0
ds_read_b64_tr_b16 v[208:209], v42 offset:0
ds_read_b64_tr_b16 v[216:217], v43 offset:0
ds_read_b64_tr_b16 v[224:225], v44 offset:0
ds_read_b64_tr_b16 v[232:233], v45 offset:0
ds_read_b64_tr_b16 v[240:241], v46 offset:0
ds_read_b64_tr_b16 v[248:249], v47 offset:0
s_add_u32 m0, s65, 34816
s_xor_b32 s66, s64, 86016
buffer_load_dwordx4 v16, s[44:47], s66 offen  lds
s_waitcnt vmcnt(2)
s_add_u32 m0, s65, 35840
s_xor_b32 s66, s64, 94208
buffer_load_dwordx4 v17, s[44:47], s66 offen  lds
s_waitcnt vmcnt(2)
s_waitcnt lgkmcnt(0)
s_add_u32 m0, s65, 0
s_xor_b32 s66, s64, 98304
buffer_load_dwordx4 v16, s[44:47], s66 offen  lds
s_waitcnt vmcnt(2)
s_add_u32 m0, s65, 1024
s_xor_b32 s66, s64, 106496
buffer_load_dwordx4 v17, s[44:47], s66 offen  lds
s_waitcnt vmcnt(2)
ds_read_b64_tr_b16 v[194:195], v40 offset:32768
ds_read_b64_tr_b16 v[202:203], v41 offset:32768
ds_read_b64_tr_b16 v[210:211], v42 offset:32768
ds_read_b64_tr_b16 v[218:219], v43 offset:32768
ds_read_b64_tr_b16 v[226:227], v44 offset:32768
ds_read_b64_tr_b16 v[234:235], v45 offset:32768
ds_read_b64_tr_b16 v[242:243], v46 offset:32768
ds_read_b64_tr_b16 v[250:251], v47 offset:32768
v_and_b32 v24, 127, v2
buffer_load_dword v25, v24, s[52:55], 0 offen offset:128
s_add_u32 m0, s65, 2048
s_xor_b32 s66, s64, 114688
buffer_load_dwordx4 v16, s[44:47], s66 offen  lds
s_waitcnt vmcnt(2)
s_add_u32 m0, s65, 3072
s_xor_b32 s66, s64, 122880
buffer_load_dwordx4 v17, s[44:47], s66 offen  lds
s_waitcnt vmcnt(2)
s_waitcnt lgkmcnt(0)
s_add_u32 m0, s65, 32768
s_xor_b32 s66, s64, 102400
buffer_load_dwordx4 v16, s[44:47], s66 offen  lds
s_waitcnt vmcnt(2)
s_add_u32 m0, s65, 33792
s_xor_b32 s66, s64, 110592
buffer_load_dwordx4 v17, s[44:47], s66 offen  lds
s_waitcnt vmcnt(2)
ds_read_b64_tr_b16 v[196:197], v40 offset:0
ds_read_b64_tr_b16 v[204:205], v41 offset:0
ds_read_b64_tr_b16 v[212:213], v42 offset:0
ds_read_b64_tr_b16 v[220:221], v43 offset:0
ds_read_b64_tr_b16 v[228:229], v44 offset:0
ds_read_b64_tr_b16 v[236:237], v45 offset:0
ds_read_b64_tr_b16 v[244:245], v46 offset:0
ds_read_b64_tr_b16 v[252:253], v47 offset:0
s_add_u32 m0, s65, 34816
s_xor_b32 s66, s64, 118784
buffer_load_dwordx4 v16, s[44:47], s66 offen  lds
s_waitcnt vmcnt(2)
s_add_u32 m0, s65, 35840
s_xor_b32 s66, s64, 126976
buffer_load_dwordx4 v17, s[44:47], s66 offen  lds
s_waitcnt vmcnt(0)
ds_read_b64_tr_b16 v[198:199], v40 offset:32768
ds_read_b64_tr_b16 v[206:207], v41 offset:32768
ds_read_b64_tr_b16 v[214:215], v42 offset:32768
ds_read_b64_tr_b16 v[222:223], v43 offset:32768
ds_read_b64_tr_b16 v[230:231], v44 offset:32768
ds_read_b64_tr_b16 v[238:239], v45 offset:32768
ds_read_b64_tr_b16 v[246:247], v46 offset:32768
ds_read_b64_tr_b16 v[254:255], v47 offset:32768
s_waitcnt lgkmcnt(0)
v_cmp_eq_u32 vcc, 0, v25
s_cbranch_vccz L_tab_162
s_mov_b32 s75, 0
L_poll_163:
buffer_load_dword v25, v24, s[52:55], 0 offen offset:128 sc1
s_waitcnt vmcnt(0)
v_cmp_eq_u32 vcc, 0, v25
s_cbranch_vccz L_pollx_164
s_sleep 40
s_add_u32 s75, s75, 1
s_cmp_lt_u32 s75, 0x100000
s_cbranch_scc1 L_poll_163
L_pollx_164:
L_tab_162:
v_bfe_u32 v26, v25, 8, 3
v_lshrrev_b32 v25, 16, v25
s_nop 0
v_add_u32_dpp v26, v26, v26 quad_perm:[1,0,3,2] row_mask:0xf bank_mask:0xf
s_nop 1
v_add_u32_dpp v26, v26, v26 quad_perm:[2,3,0,1] row_mask:0xf bank_mask:0xf
s_nop 1
v_add_u32_dpp v26, v26, v26 row_ror:4 row_mask:0xf bank_mask:0xf
s_nop 1
v_add_u32_dpp v26, v26, v26 row_ror:8 row_mask:0xf bank_mask:0xf
s_nop 1
v_readlane_b32 s66, v26, 0
v_readlane_b32 s71, v26, 16
s_add_u32 s66, s66, s71
s_cmp_gt_u32 s66, 64
s_cselect_b32 s66, 1, 0
v_cmp_ne_u32 vcc, s66, v25
s_and_b32 s71, vcc_lo, 0xff
s_bcnt0_i32_b32 s66, s71
s_sub_u32 s66, s66, 24
v_mbcnt_lo_u32_b32 v24, s71, 0
v_sub_u32 v25, v0, v24
v_add_u32 v24, s66, v24
v_cndmask_b32 v24, v25, v24, vcc
v_bfe_u32 v25, v24, 1, 2
v_and_b32 v26, 1, v24
v_lshl_or_b32 v25, v26, 2, v25
v_lshlrev_b32 v25, v2, v25
s_nop 1
v_or_b32_dpp v25, v25, v25 quad_perm:[1,0,3,2] row_mask:0xf bank_mask:0xf
s_nop 1
v_or_b32_dpp v25, v25, v25 quad_perm:[2,3,0,1] row_mask:0xf bank_mask:0xf
s_nop 1
v_or_b32_dpp v25, v25, v25 row_shl:4 row_mask:0xf bank_mask:0xf
s_nop 1
v_readfirstlane_b32 s35, v25
s_mov_b64 exec, 1
ds_write_b32 v2, v25 offset:328
s_mov_b64 exec, -1
s_sub_u32 s64, s2, 144
s_cmp_lt_u32 s64, 64
s_cbranch_scc0 L_rp_165
s_cmp_eq_u32 s34, 0
s_cbranch_scc0 L_rp_165
s_mov_b32 s48, s4
s_mov_b32 s49, s5
s_mov_b32 s50, 0x2000
s_mov_b32 s51, 0x20000
v_and_b32 v5, 15, v0
v_and_b32 v6, 16, v0
v_lshl_add_u32 v5, v6, 1, v5
v_and_b32 v6, 32, v0
v_lshrrev_b32 v6, 1, v6
v_add_u32 v5, v5, v6
v_lshlrev_b32 v5, 1, v5
v_and_b32 v6, 0x7c, v5
s_lshl_b32 s65, s64, 7
s_and_b32 s66, s65, 0x380
s_lshr_b32 s64, s64, 3
s_mul_i32 s64, s64, 12288
s_add_u32 s64, s64, s66
s_add_u32 s64, s64, 24576
buffer_load_ushort v18, v5, s[48:51], s65 offen
s_mov_b32 s75, 0
L_poll_166:
buffer_load_dword v19, v6, s[36:39], s64 offen offset:0 sc1
buffer_load_dword v20, v6, s[36:39], s64 offen offset:3072 sc1
s_waitcnt vmcnt(0)
v_max_u32 v16, v19, v20
v_cmp_eq_u32 vcc, -1, v16
s_cbranch_vccz L_pollx_167
s_sleep 40
s_add_u32 s75, s75, 1
s_cmp_lt_u32 s75, 0x100000
s_cbranch_scc1 L_poll_166
L_pollx_167:
v_and_b32 v16, 1, v0
v_lshlrev_b32 v16, 4, v16
v_xor_b32 v16, 16, v16
v_lshlrev_b32 v18, 16, v18
v_lshlrev_b32 v19, v16, v19
v_and_b32 v19, 0xffff0000, v19
v_lshlrev_b32 v20, v16, v20
v_and_b32 v20, 0xffff0000, v20
ds_write_b32 v2, v18 offset:4096
ds_write_b32 v2, v19 offset:4352
ds_write_b32 v2, v20 offset:4608
L_rp_165:
v_lshlrev_b32 v10, 3, v0
s_lshl_b32 s64, s34, 8
s_add_u32 s64, s64, 2560
s_lshr_b32 s66, s68, 1
v_xor_b32 v12, s66, v0
v_mov_b32 v14, 0
v_bfe_u32 v11, v12, 0, 1
v_lshl_or_b32 v14, v11, 0, v14
v_bfe_u32 v11, v12, 1, 1
v_lshl_or_b32 v14, v11, 1, v14
v_bfe_u32 v11, v12, 2, 1
v_lshl_or_b32 v14, v11, 2, v14
v_bfe_u32 v11, v12, 3, 1
v_lshl_or_b32 v14, v11, 3, v14
v_bfe_u32 v11, v12, 4, 1
v_lshl_or_b32 v14, v11, 4, v14
v_bfe_u32 v11, v12, 5, 1
v_lshl_or_b32 v14, v11, 5, v14
v_and_b32 v11, 0x38, v14
v_and_b32 v12, 1, v14
v_lshl_add_u32 v11, v12, 2, v11
v_bfe_u32 v12, v14, 1, 2
v_add_u32 v11, v11, v12
v_lshl_add_u32 v11, v11, 2, s64
v_and_b32 v14, 1, v0
v_and_b32 v12, 48, v0
v_lshlrev_b32 v12, 1, v12
v_lshl_add_u32 v12, v14, 4, v12
v_add_u32 v12, s64, v12
v_mul_u32_u24 v15, 0xaaaa, v14
v_add_u32 v15, 0x4444, v15
v_mov_b32 v64, 0
v_mov_b32 v65, 0
v_mov_b32 v66, 0
v_mov_b32 v67, 0
v_mov_b32 v68, 0
v_mov_b32 v69, 0
v_mov_b32 v70, 0
v_mov_b32 v71, 0
v_mov_b32 v72, 0
v_mov_b32 v73, 0
v_mov_b32 v74, 0
v_mov_b32 v75, 0
v_mov_b32 v76, 0
v_mov_b32 v77, 0
v_mov_b32 v78, 0
v_mov_b32 v79, 0
v_mov_b32 v80, 0
v_mov_b32 v81, 0
v_mov_b32 v82, 0
v_mov_b32 v83, 0
v_mov_b32 v84, 0
v_mov_b32 v85, 0
v_mov_b32 v86, 0
v_mov_b32 v87, 0
v_mov_b32 v88, 0
v_mov_b32 v89, 0
v_mov_b32 v90, 0
v_mov_b32 v91, 0
v_mov_b32 v92, 0
v_mov_b32 v93, 0
v_mov_b32 v94, 0
v_mov_b32 v95, 0
s_lshl_b32 s64, s34, 3
s_lshr_b32 s64, s35, s64
v_bfe_u32 v13, v0, 3, 1
v_lshlrev_b32 v13, 2, v13
v_bfe_u32 v13, s64, v13, 3
v_and_b32 v14, 0x70, v1
v_lshl_add_u32 v13, v13, 12, v14
s_lshl_b32 s64, s34, 2
s_add_u32 s64, s64, s33
v_bfe_u32 v14, v0, 3, 1
v_lshl_add_u32 v14, v14, 1, s64
v_and_b32 v14, 31, v14
v_lshl_add_u32 v13, v14, 7, v13
s_lshl_b32 s69, s32, 15
s_add_u32 s69, s69, 1048576
s_waitcnt vmcnt(0) lgkmcnt(0)
s_barrier
ds_read_b64 v[20:21], v10 offset:512
ds_read_b64 v[22:23], v10 offset:1024
ds_read_b64 v[24:25], v10 offset:1536
ds_read_b64 v[26:27], v10 offset:2048
s_waitcnt lgkmcnt(2)
v_pk_add_f32 v[20:21], v[20:21], v[22:23]
s_waitcnt lgkmcnt(1)
v_pk_add_f32 v[20:21], v[20:21], v[24:25]
s_waitcnt lgkmcnt(0)
v_pk_add_f32 v[20:21], v[20:21], v[26:27]
v_cvt_pk_bf16_f32 v20, v20, v21
ds_write_b32 v11, v20
ds_read_b128 v[48:51], v12 offset:0
ds_read_b128 v[52:55], v12 offset:128
s_waitcnt lgkmcnt(1)
v_smfmac_f32_16x16x64_bf16 v[64:67], v[48:51], v[128:135], v15
v_smfmac_f32_16x16x64_bf16 v[68:71], v[48:51], v[136:143], v15
v_smfmac_f32_16x16x64_bf16 v[72:75], v[48:51], v[144:151], v15
v_smfmac_f32_16x16x64_bf16 v[76:79], v[48:51], v[152:159], v15
s_waitcnt lgkmcnt(0)
v_smfmac_f32_16x16x64_bf16 v[64:67], v[52:55], v[192:199], v15
v_smfmac_f32_16x16x64_bf16 v[68:71], v[52:55], v[200:207], v15
v_smfmac_f32_16x16x64_bf16 v[72:75], v[52:55], v[208:215], v15
v_smfmac_f32_16x16x64_bf16 v[76:79], v[52:55], v[216:223], v15
v_smfmac_f32_16x16x64_bf16 v[80:83], v[48:51], v[160:167], v15
v_smfmac_f32_16x16x64_bf16 v[84:87], v[48:51], v[168:175], v15
v_smfmac_f32_16x16x64_bf16 v[88:91], v[48:51], v[176:183], v15
v_smfmac_f32_16x16x64_bf16 v[92:95], v[48:51], v[184:191], v15
v_smfmac_f32_16x16x64_bf16 v[80:83], v[52:55], v[224:231], v15
v_add_f32 v64, v64, v65
v_smfmac_f32_16x16x64_bf16 v[84:87], v[52:55], v[232:239], v15
v_add_f32 v68, v68, v69
v_add_f32 v72, v72, v73
v_smfmac_f32_16x16x64_bf16 v[88:91], v[52:55], v[240:247], v15
v_add_f32 v76, v76, v77
v_cvt_pk_bf16_f32 v20, v64, v68
v_smfmac_f32_16x16x64_bf16 v[92:95], v[52:55], v[248:255], v15
v_cvt_pk_bf16_f32 v21, v72, v76
v_add_f32 v80, v80, v81
s_mov_b64 exec, 0xffff
v_add_f32 v84, v84, v85
v_cvt_pk_bf16_f32 v22, v80, v84
s_nop 0
v_add_f32 v88, v88, v89
s_nop 0
v_add_f32 v92, v92, v93
v_cvt_pk_bf16_f32 v23, v88, v92
buffer_store_dwordx4 v[20:23], v13, s[36:39], s69 offen sc1
s_mov_b64 exec, -1
s_sub_u32 s67, s2, 16
s_cmp_lt_u32 s67, 128
s_cbranch_scc0 L_nogp
s_and_b32 s66, s2, 7
s_min_u32 s64, s66, 3
s_mul_i32 s71, s66, 5
s_add_u32 s64, s64, s71
s_cmp_lt_u32 s66, 3
s_cselect_b32 s66, 5, 4
v_and_b32 v8, 7, v0
v_min_u32 v8, s66, v8
v_add_u32 v8, s64, v8
s_and_b32 s64, s67, 0xf8
s_lshl_b32 s64, s64, 2
s_lshl_b32 s66, s34, 3
s_add_u32 s64, s64, s66
v_lshrrev_b32 v9, 3, v0
v_add_u32 v9, s64, v9
v_mul_u32_u24 v9, 2752, v9
v_lshl_add_u32 v8, v8, 6, v9
global_load_dword v10, v8, s[16:17]
global_load_dword v11, v8, s[18:19]
s_and_b32 s66, s2, 7
s_min_u32 s70, s66, 3
s_mul_i32 s71, s66, 5
s_add_u32 s70, s70, s71
s_cmp_lt_u32 s66, 3
s_cselect_b32 s66, 6, 5
s_lshl_b32 s66, s66, 8
s_sub_u32 s66, s66, 1
s_lshr_b32 s71, s67, 3
s_lshl_b32 s71, s71, 2
s_add_u32 s71, s71, s34
s_mul_i32 s71, s71, 24
v_min_u32 v12, 23, v0
v_add_u32 v12, s71, v12
v_min_u32 v12, s66, v12
s_lshl_b32 s70, s70, 15
v_lshl_add_u32 v12, v12, 7, s70
global_load_dword v13, v12, s[20:21]
s_endpgm
L_nogp:
L_tail_s:
s_cmp_eq_u32 s74, -1
s_cbranch_scc0 L_ffn
s_cmp_eq_u32 s3, 0
s_cbranch_scc0 L_fin
s_sub_u32 s70, s2, 144
s_cmp_lt_u32 s70, 64
s_cbranch_scc0 L_fin
s_lshl_b32 s64, s70, 2
s_lshr_b32 s67, s35, s64
s_and_b32 s71, s67, 7
s_andn2_b32 s66, s70, 7
s_add_u32 s66, s66, s71
s_lshl_b32 s66, s66, 12
s_add_u32 s66, s66, 1048576
buffer_load_dwordx4 v[16:19], v1, s[36:39], s66 offen offset:0 sc1
buffer_load_dwordx4 v[20:23], v1, s[36:39], s66 offen offset:1024 sc1
buffer_load_dwordx4 v[24:27], v1, s[36:39], s66 offen offset:2048 sc1
buffer_load_dwordx4 v[28:31], v1, s[36:39], s66 offen offset:3072 sc1
v_mov_b32 v32, -1
v_mov_b32 v33, -1
v_mov_b32 v34, -1
v_mov_b32 v35, -1
s_and_b32 s64, s71, 6
s_lshl_b32 s64, s64, 12
s_and_b32 s65, s71, 1
s_lshl_b32 s65, s65, 15
s_or_b32 s64, s64, s65
s_lshr_b32 s65, s70, 3
s_lshl_b32 s65, s65, 16
s_add_u32 s64, s64, s65
s_lshr_b32 s65, s70, 4
s_lshl_b32 s65, s65, 2
s_and_b32 s67, s70, 7
s_add_u32 s65, s65, s67
s_lshl_b32 s65, s65, 7
s_add_u32 s64, s64, s65
s_add_u32 s64, s64, 1376256
s_add_u32 s65, s64, 4096
buffer_store_dwordx4 v[32:35], v1, s[36:39], s64 offen offset:0 sc1
buffer_store_dwordx4 v[32:35], v1, s[36:39], s64 offen offset:1024 sc1
buffer_store_dwordx4 v[32:35], v1, s[36:39], s64 offen offset:2048 sc1
buffer_store_dwordx4 v[32:35], v1, s[36:39], s64 offen offset:3072 sc1
buffer_store_dwordx4 v[32:35], v1, s[36:39], s65 offen offset:0 sc1
s_mov_b64 exec, 0xffffff
buffer_store_dwordx4 v[32:35], v1, s[36:39], s65 offen offset:1024 sc1
s_mov_b64 exec, -1
v_lshlrev_b32 v2, 2, v0
ds_read_b32 v8, v2 offset:4096
ds_read_b32 v9, v2 offset:4352
ds_read_b32 v10, v2 offset:4608
s_mov_b32 s56, s26
s_mov_b32 s57, s27
s_mov_b32 s58, 0x2000
s_mov_b32 s59, 0x20000
v_and_b32 v5, 15, v0
v_and_b32 v6, 16, v0
v_lshl_add_u32 v5, v6, 1, v5
v_and_b32 v6, 32, v0
v_lshrrev_b32 v6, 1, v6
v_add_u32 v5, v5, v6
v_lshlrev_b32 v5, 1, v5
v_and_b32 v6, 0x7c, v5
s_lshl_b32 s73, s70, 7
v_and_b32 v11, 1, v0
v_lshlrev_b32 v3, 4, v11
v_mov_b32 v7, 0x3f80
v_lshlrev_b32 v7, v3, v7
v_and_b32 v2, 4, v0
v_cmp_eq_u32 vcc, 0, v2
v_bfe_u32 v2, v0, 1, 1
v_mul_u32_u24 v43, 0xaaaa, v2
v_add_u32 v43, 0x4444, v43
v_cndmask_b32 v44, 0, v7, vcc
v_sub_u32 v45, v7, v44
v_mov_b32 v46, v44
v_mov_b32 v47, v45
v_mov_b32 v48, 0
v_mov_b32 v49, 0
v_mov_b32 v50, 0
v_mov_b32 v51, 0
v_mov_b32 v52, 0
v_mov_b32 v53, 0
v_mov_b32 v54, 0
v_mov_b32 v55, 0
s_add_u32 s68, s73, 1310720
s_mov_b32 s76, 0xaaaaaaaa
s_mov_b32 s77, 0xaaaaaaaa
v_cmp_gt_u32 vcc, 24, v0
v_mov_b32 v41, 0x40000000
v_lshl_add_u32 v12, v11, 13, v6
v_cndmask_b32 v41, v41, v1, vcc
s_mov_b32 s75, 0
s_waitcnt vmcnt(0) lgkmcnt(0)
buffer_load_dwordx4 v[16:19], v1, s[36:39], s66 offen offset:0 sc1
buffer_load_dwordx4 v[20:23], v1, s[36:39], s66 offen offset:1024 sc1
buffer_load_dwordx4 v[24:27], v1, s[36:39], s66 offen offset:2048 sc1
buffer_load_dwordx4 v[28:31], v1, s[36:39], s66 offen offset:3072 sc1
s_sleep 1
buffer_load_dwordx4 v[16:19], v1, s[36:39], s66 offen offset:0 sc1
buffer_load_dwordx4 v[20:23], v1, s[36:39], s66 offen offset:1024 sc1
buffer_load_dwordx4 v[24:27], v1, s[36:39], s66 offen offset:2048 sc1
buffer_load_dwordx4 v[28:31], v1, s[36:39], s66 offen offset:3072 sc1
s_sleep 1
buffer_load_dwordx4 v[16:19], v1, s[36:39], s66 offen offset:0 sc1
buffer_load_dwordx4 v[20:23], v1, s[36:39], s66 offen offset:1024 sc1
buffer_load_dwordx4 v[24:27], v1, s[36:39], s66 offen offset:2048 sc1
buffer_load_dwordx4 v[28:31], v1, s[36:39], s66 offen offset:3072 sc1
s_sleep 1
L_rn_170:
v_smfmac_f32_16x16x64_bf16 v[48:51], v[44:47], v[16:23], v43
v_smfmac_f32_16x16x64_bf16 v[48:51], v[44:47], v[24:31], v43
buffer_load_dwordx4 v[16:19], v1, s[36:39], s66 offen offset:0 sc1
buffer_load_dwordx4 v[20:23], v1, s[36:39], s66 offen offset:1024 sc1
buffer_load_dwordx4 v[24:27], v1, s[36:39], s66 offen offset:2048 sc1
buffer_load_dwordx4 v[28:31], v1, s[36:39], s66 offen offset:3072 sc1
s_add_u32 s75, s75, 1
s_and_b32 s78, s75, 15
s_nop 1
v_add_f32_dpp v13, v48, v48 row_ror:8 row_mask:0x3 bank_mask:0x3
v_add_f32_dpp v13, v49, v49 row_ror:8 row_mask:0x3 bank_mask:0xc
v_add_f32_dpp v13, v50, v50 row_ror:8 row_mask:0xc bank_mask:0x3
v_add_f32_dpp v13, v51, v51 row_ror:8 row_mask:0xc bank_mask:0xc
v_cmp_u_f32 vcc, v13, v13
s_cbranch_vccz L_rz_171
v_mov_b32 v48, 0
v_mov_b32 v49, 0
v_mov_b32 v50, 0
v_mov_b32 v51, 0
s_waitcnt vmcnt(12)
s_cbranch_scc1 L_rn_170
v_max3_u32 v2, v16, v17, v18
v_max3_u32 v2, v2, v19, v20
v_max3_u32 v2, v2, v21, v22
v_max3_u32 v2, v2, v23, v24
v_max3_u32 v2, v2, v25, v26
v_max3_u32 v2, v2, v27, v28
v_max3_u32 v2, v2, v29, v30
v_max_u32 v2, v2, v31
v_cmp_eq_u32 vcc, -1, v2
s_cbranch_vccz L_rx_169
s_cmp_lt_u32 s75, 0x100000
s_cbranch_scc1 L_rn_170
L_rx_169:
v_smfmac_f32_16x16x64_bf16 v[48:51], v[44:47], v[16:23], v43
v_smfmac_f32_16x16x64_bf16 v[48:51], v[44:47], v[24:31], v43
s_nop 7
v_add_f32_dpp v13, v48, v48 row_ror:8 row_mask:0x3 bank_mask:0x3
v_add_f32_dpp v13, v49, v49 row_ror:8 row_mask:0x3 bank_mask:0xc
v_add_f32_dpp v13, v50, v50 row_ror:8 row_mask:0xc bank_mask:0x3
v_add_f32_dpp v13, v51, v51 row_ror:8 row_mask:0xc bank_mask:0xc
L_rz_171:
v_fmac_f32 v8, v13, v9
s_nop 1
v_mov_b32_dpp v14, v8 quad_perm:[1,1,3,3] row_mask:0xf bank_mask:0xf
v_mov_b32_dpp v13, v8 quad_perm:[0,0,2,2] row_mask:0xf bank_mask:0xf
v_cvt_pk_bf16_f32 v13, v13, v14
buffer_store_dword v13, v12, s[36:39], s68 offen sc1
v_cvt_pk_bf16_f32 v8, 0, v8
buffer_load_dwordx4 v[64:67], v1, s[36:39], s64 offen offset:0 sc1
buffer_load_dwordx4 v[68:71], v1, s[36:39], s64 offen offset:1024 sc1
buffer_load_dwordx4 v[72:75], v1, s[36:39], s64 offen offset:2048 sc1
buffer_load_dwordx4 v[76:79], v1, s[36:39], s64 offen offset:3072 sc1
buffer_load_dwordx4 v[80:83], v1, s[36:39], s65 offen offset:0 sc1
buffer_load_dwordx4 v[84:87], v41, s[36:39], s65 offen offset:1024 sc1
s_mov_b32 s75, 0
s_waitcnt vmcnt(0)
buffer_load_dwordx4 v[64:67], v1, s[36:39], s64 offen offset:0 sc1
buffer_load_dwordx4 v[68:71], v1, s[36:39], s64 offen offset:1024 sc1
buffer_load_dwordx4 v[72:75], v1, s[36:39], s64 offen offset:2048 sc1
buffer_load_dwordx4 v[76:79], v1, s[36:39], s64 offen offset:3072 sc1
buffer_load_dwordx4 v[80:83], v1, s[36:39], s65 offen offset:0 sc1
buffer_load_dwordx4 v[84:87], v41, s[36:39], s65 offen offset:1024 sc1
s_sleep 1
buffer_load_dwordx4 v[64:67], v1, s[36:39], s64 offen offset:0 sc1
buffer_load_dwordx4 v[68:71], v1, s[36:39], s64 offen offset:1024 sc1
buffer_load_dwordx4 v[72:75], v1, s[36:39], s64 offen offset:2048 sc1
buffer_load_dwordx4 v[76:79], v1, s[36:39], s64 offen offset:3072 sc1
buffer_load_dwordx4 v[80:83], v1, s[36:39], s65 offen offset:0 sc1
buffer_load_dwordx4 v[84:87], v41, s[36:39], s65 offen offset:1024 sc1
s_sleep 1
L_rn_174:
v_smfmac_f32_16x16x64_bf16 v[52:55], v[44:47], v[64:71], v43
v_smfmac_f32_16x16x64_bf16 v[52:55], v[44:47], v[72:79], v43
v_smfmac_f32_16x16x64_bf16 v[52:55], v[44:47], v[80:87], v43
buffer_load_dwordx4 v[64:67], v1, s[36:39], s64 offen offset:0 sc1
buffer_load_dwordx4 v[68:71], v1, s[36:39], s64 offen offset:1024 sc1
buffer_load_dwordx4 v[72:75], v1, s[36:39], s64 offen offset:2048 sc1
buffer_load_dwordx4 v[76:79], v1, s[36:39], s64 offen offset:3072 sc1
buffer_load_dwordx4 v[80:83], v1, s[36:39], s65 offen offset:0 sc1
buffer_load_dwordx4 v[84:87], v41, s[36:39], s65 offen offset:1024 sc1
s_add_u32 s75, s75, 1
s_and_b32 s78, s75, 15
v_add_f32_dpp v13, v52, v52 row_ror:8 row_mask:0x3 bank_mask:0x3
v_add_f32_dpp v13, v53, v53 row_ror:8 row_mask:0x3 bank_mask:0xc
v_add_f32_dpp v13, v54, v54 row_ror:8 row_mask:0xc bank_mask:0x3
v_add_f32_dpp v13, v55, v55 row_ror:8 row_mask:0xc bank_mask:0xc
v_cmp_u_f32 vcc, v13, v13
s_cbranch_vccz L_rz_175
v_mov_b32 v52, 0
v_mov_b32 v53, 0
v_mov_b32 v54, 0
v_mov_b32 v55, 0
s_waitcnt vmcnt(12)
s_cbranch_scc1 L_rn_174
v_max3_u32 v2, v64, v65, v66
v_max3_u32 v2, v2, v67, v68
v_max3_u32 v2, v2, v69, v70
v_max3_u32 v2, v2, v71, v72
v_max3_u32 v2, v2, v73, v74
v_max3_u32 v2, v2, v75, v76
v_max3_u32 v2, v2, v77, v78
v_max3_u32 v2, v2, v79, v80
v_max3_u32 v2, v2, v81, v82
v_max3_u32 v2, v2, v83, v84
v_max3_u32 v2, v2, v85, v86
v_max_u32 v2, v2, v87
v_cmp_eq_u32 vcc, -1, v2
s_cbranch_vccz L_rx_173
s_cmp_lt_u32 s75, 0x100000
s_cbranch_scc1 L_rn_174
L_rx_173:
v_smfmac_f32_16x16x64_bf16 v[52:55], v[44:47], v[64:71], v43
v_smfmac_f32_16x16x64_bf16 v[52:55], v[44:47], v[72:79], v43
v_smfmac_f32_16x16x64_bf16 v[52:55], v[44:47], v[80:87], v43
s_nop 7
v_add_f32_dpp v13, v52, v52 row_ror:8 row_mask:0x3 bank_mask:0x3
v_add_f32_dpp v13, v53, v53 row_ror:8 row_mask:0x3 bank_mask:0xc
v_add_f32_dpp v13, v54, v54 row_ror:8 row_mask:0xc bank_mask:0x3
v_add_f32_dpp v13, v55, v55 row_ror:8 row_mask:0xc bank_mask:0xc
L_rz_175:
v_fmac_f32 v8, v13, v10
s_nop 1
v_mov_b32_dpp v14, v8 quad_perm:[1,1,3,3] row_mask:0xf bank_mask:0xf
s_not_b64 exec, s[76:77]
v_cvt_pk_bf16_f32 v13, v8, v14
buffer_store_dword v13, v6, s[56:59], s73 offen sc1
s_mov_b64 exec, -1
s_cmp_lt_u32 s70, 8
s_cbranch_scc0 L_fin2
s_mov_b64 exec, 0xffff
buffer_store_dwordx4 v[44:47], v1, s[36:39], s62 offen sc1
s_mov_b64 exec, -1
L_fin2:
s_endpgm
L_ffn:
s_mul_i32 s67, s3, 12288
s_add_u32 s67, s67, 25600
v_lshlrev_b32 v7, 3, v0
buffer_load_dwordx4 v[8:11], v1, s[36:39], s67 offen offset:0 sc1
buffer_load_dwordx4 v[12:15], v1, s[36:39], s67 offen offset:1024 sc1
s_cmp_lt_u32 s3, 4
s_cbranch_scc1 L_post_176
s_mov_b32 s40, s16
s_mov_b32 s41, s17
s_mov_b32 s42, 0x158000
s_mov_b32 s43, 0x20000
s_mov_b32 s56, s18
s_mov_b32 s57, s19
s_mov_b32 s58, 0x158000
s_mov_b32 s59, 0x20000
v_lshrrev_b32 v16, 2, v0
v_mul_u32_u24 v16, 2752, v16
v_and_b32 v17, 3, v0
v_lshrrev_b32 v18, 5, v0
v_xor_b32 v17, v17, v18
v_xor_b32 v18, 2, v17
v_lshl_add_u32 v17, v17, 4, v16
v_lshl_add_u32 v18, v18, 4, v16
s_mul_i32 s64, s34, 352256
s_lshl_b32 s65, s74, 6
s_add_u32 s64, s64, s65
s_lshl_b32 s65, s34, 13
s_add_u32 m0, s65, 4096
s_add_u32 s66, s64, 0
buffer_load_dwordx4 v17, s[40:43], s66 offen  lds
s_add_u32 m0, s65, 36864
s_add_u32 s66, s64, 0
buffer_load_dwordx4 v18, s[56:59], s66 offen  lds
s_add_u32 m0, s65, 5120
s_add_u32 s66, s64, 44032
buffer_load_dwordx4 v17, s[40:43], s66 offen  lds
s_add_u32 m0, s65, 37888
s_add_u32 s66, s64, 44032
buffer_load_dwordx4 v18, s[56:59], s66 offen  lds
s_add_u32 m0, s65, 6144
s_add_u32 s66, s64, 88064
buffer_load_dwordx4 v17, s[40:43], s66 offen  lds
s_add_u32 m0, s65, 38912
s_add_u32 s66, s64, 88064
buffer_load_dwordx4 v18, s[56:59], s66 offen  lds
s_add_u32 m0, s65, 7168
s_add_u32 s66, s64, 132096
buffer_load_dwordx4 v17, s[40:43], s66 offen  lds
s_add_u32 m0, s65, 39936
s_add_u32 s66, s64, 132096
buffer_load_dwordx4 v18, s[56:59], s66 offen  lds
s_add_u32 m0, s65, 8192
s_add_u32 s66, s64, 176128
buffer_load_dwordx4 v17, s[40:43], s66 offen  lds
s_add_u32 m0, s65, 40960
s_add_u32 s66, s64, 176128
buffer_load_dwordx4 v18, s[56:59], s66 offen  lds
s_add_u32 m0, s65, 9216
s_add_u32 s66, s64, 220160
buffer_load_dwordx4 v17, s[40:43], s66 offen  lds
s_add_u32 m0, s65, 41984
s_add_u32 s66, s64, 220160
buffer_load_dwordx4 v18, s[56:59], s66 offen  lds
s_add_u32 m0, s65, 10240
s_add_u32 s66, s64, 264192
buffer_load_dwordx4 v17, s[40:43], s66 offen  lds
s_add_u32 m0, s65, 43008
s_add_u32 s66, s64, 264192
buffer_load_dwordx4 v18, s[56:59], s66 offen  lds
s_add_u32 m0, s65, 11264
s_add_u32 s66, s64, 308224
buffer_load_dwordx4 v17, s[40:43], s66 offen  lds
s_add_u32 m0, s65, 44032
s_add_u32 s66, s64, 308224
buffer_load_dwordx4 v18, s[56:59], s66 offen  lds
s_waitcnt vmcnt(16)
s_branch L_post_177
L_post_176:
s_waitcnt vmcnt(0)
L_post_177:
v_max3_u32 v16, v8, v9, v10
v_max3_u32 v16, v16, v11, v12
v_max3_u32 v16, v16, v13, v14
v_max_u32 v16, v16, v15
v_cmp_eq_u32 vcc, -1, v16
s_cbranch_vccz L_cb_178
s_mov_b32 s75, 0
L_poll_179:
buffer_load_dwordx4 v[8:11], v1, s[36:39], s67 offen offset:0 sc1
buffer_load_dwordx4 v[12:15], v1, s[36:39], s67 offen offset:1024 sc1
s_waitcnt vmcnt(0)
v_max3_u32 v16, v8, v9, v10
v_max3_u32 v16, v16, v11, v12
v_max3_u32 v16, v16, v13, v14
v_max_u32 v16, v16, v15
v_cmp_eq_u32 vcc, -1, v16
s_cbranch_vccz L_pollx_180
s_add_u32 s75, s75, 1
s_cmp_lt_u32 s75, 0x100000
s_cbranch_scc1 L_poll_179
L_pollx_180:
L_cb_178:
s_mov_b32 s68, 0xffff0000
v_lshlrev_b32 v24, 16, v8
v_and_b32 v25, s68, v8
v_lshlrev_b32 v32, 16, v12
v_and_b32 v33, s68, v12
v_lshlrev_b32 v26, 16, v9
v_and_b32 v27, s68, v9
v_lshlrev_b32 v34, 16, v13
v_and_b32 v35, s68, v13
v_lshlrev_b32 v28, 16, v10
v_and_b32 v29, s68, v10
v_lshlrev_b32 v36, 16, v14
v_and_b32 v37, s68, v14
v_lshlrev_b32 v30, 16, v11
v_and_b32 v31, s68, v11
v_lshlrev_b32 v38, 16, v15
v_and_b32 v39, s68, v15
v_add_f32 v32, 1.0, v32
v_add_f32 v33, 1.0, v33
v_add_f32 v34, 1.0, v34
v_add_f32 v35, 1.0, v35
v_add_f32 v36, 1.0, v36
v_add_f32 v37, 1.0, v37
v_add_f32 v38, 1.0, v38
v_add_f32 v39, 1.0, v39
v_lshrrev_b32 v2, 3, v0
v_bfe_u32 v3, v0, 1, 3
v_and_b32 v4, 3, v3
s_lshl_b32 s64, s3, 1
v_xor_b32 v3, s64, v3
v_lshlrev_b32 v5, 10, v2
v_lshl_add_u32 v5, v4, 8, v5
v_lshl_add_u32 v5, v3, 4, v5
v_and_b32 v4, 1, v0
v_lshl_add_u32 v5, v4, 3, v5
v_add_u32 v5, 69632, v5
v_xor_b32 v6, 16, v5
v_mul_u32_u24 v16, 0xaaaa, v4
v_add_u32 v16, 0x4444, v16
v_lshrrev_b32 v2, 4, v0
v_bfe_u32 v3, v0, 3, 1
v_xor_b32 v7, v2, v0
v_lshlrev_b32 v7, 4, v7
v_add_u32 v7, 69632, v7
v_xor_b32 v8, 64, v7
v_and_b32 v4, 7, v0
v_and_b32 v9, 0x38, v0
v_lshlrev_b32 v9, 3, v9
v_lshl_add_u32 v9, v4, 1, v9
s_lshl_b32 s64, s34, 4
v_add_u32 v9, s64, v9
v_and_b32 v10, 12, v0
v_lshlrev_b32 v10, 5, v10
v_and_b32 v4, 1, v0
v_lshl_add_u32 v10, v4, 6, v10
v_lshl_add_u32 v10, v2, 4, v10
v_mov_b32 v17, 0xbfb8aa3b
v_mov_b32 v64, 0
v_mov_b32 v65, 0
v_mov_b32 v66, 0
v_mov_b32 v67, 0
s_lshl_b32 s64, s34, 3
s_lshr_b32 s64, s35, s64
v_lshlrev_b32 v3, 2, v3
v_bfe_u32 v3, s64, v3, 3
v_and_b32 v11, 6, v3
v_lshlrev_b32 v11, 12, v11
v_and_b32 v3, 1, v3
v_lshl_add_u32 v11, v3, 15, v11
v_lshl_add_u32 v11, v2, 17, v11
v_and_b32 v4, 240, v1
v_add_u32 v11, v11, v4
v_lshl_add_u32 v11, v2, 9, v11
s_lshl_b32 s64, s34, 8
v_add_u32 v11, s64, v11
s_lshl_b32 s69, s74, 7
s_add_u32 s69, s69, 1376256
s_add_u32 s72, s69, 65536
s_lshl_b32 s64, s3, 10
s_lshl_b32 s65, s2, 2
s_lshr_b32 s65, s35, s65
s_and_b32 s65, s65, 2
s_lshl_b32 s65, s65, 12
s_add_u32 s64, s64, s65
s_add_u32 s64, s64, 1310720
v_mov_b32 v14, 0xbb000000
v_mov_b32 v15, 0x3b000000
v_lshrrev_b32 v18, 4, v0
v_bfe_u32 v19, v0, 2, 2
v_bfe_u32 v20, v0, 1, 1
v_and_b32 v22, 1, v18
v_lshl_add_u32 v22, v20, 1, v22
v_xor_b32 v22, s34, v22
v_lshlrev_b32 v22, 4, v22
v_lshl_add_u32 v22, v20, 15, v22
v_lshl_add_u32 v22, v18, 9, v22
v_lshl_add_u32 v22, v19, 6, v22
v_and_b32 v20, 1, v0
v_lshl_add_u32 v22, v20, 3, v22
v_add_u32 v22, 4096, v22
s_lshr_b32 s73, s3, 2
s_waitcnt vmcnt(0)
s_barrier
buffer_load_dwordx4 v[56:59], v1, s[36:39], s64 offen sc1
s_cmp_eq_u32 s73, 0
s_cbranch_scc1 L_gu_182
ds_read_b64_tr_b16 v[128:129], v22 offset:0
ds_read_b64_tr_b16 v[130:131], v22 offset:256
ds_read_b64_tr_b16 v[132:133], v22 offset:2048
ds_read_b64_tr_b16 v[134:135], v22 offset:2304
ds_read_b64_tr_b16 v[136:137], v22 offset:4096
ds_read_b64_tr_b16 v[138:139], v22 offset:4352
ds_read_b64_tr_b16 v[140:141], v22 offset:6144
ds_read_b64_tr_b16 v[142:143], v22 offset:6400
ds_read_b64_tr_b16 v[144:145], v22 offset:8192
ds_read_b64_tr_b16 v[146:147], v22 offset:8448
ds_read_b64_tr_b16 v[148:149], v22 offset:10240
s_waitcnt lgkmcnt(4)
ds_read_b64_tr_b16 v[150:151], v22 offset:10496
ds_read_b64_tr_b16 v[152:153], v22 offset:12288
ds_read_b64_tr_b16 v[154:155], v22 offset:12544
ds_read_b64_tr_b16 v[156:157], v22 offset:14336
ds_read_b64_tr_b16 v[158:159], v22 offset:14592
ds_read_b64_tr_b16 v[160:161], v22 offset:16384
ds_read_b64_tr_b16 v[162:163], v22 offset:16640
ds_read_b64_tr_b16 v[164:165], v22 offset:18432
ds_read_b64_tr_b16 v[166:167], v22 offset:18688
ds_read_b64_tr_b16 v[168:169], v22 offset:20480
ds_read_b64_tr_b16 v[170:171], v22 offset:20736
s_waitcnt lgkmcnt(4)
ds_read_b64_tr_b16 v[172:173], v22 offset:22528
ds_read_b64_tr_b16 v[174:175], v22 offset:22784
ds_read_b64_tr_b16 v[176:177], v22 offset:24576
ds_read_b64_tr_b16 v[178:179], v22 offset:24832
ds_read_b64_tr_b16 v[180:181], v22 offset:26624
ds_read_b64_tr_b16 v[182:183], v22 offset:26880
ds_read_b64_tr_b16 v[184:185], v22 offset:28672
ds_read_b64_tr_b16 v[186:187], v22 offset:28928
ds_read_b64_tr_b16 v[188:189], v22 offset:30720
ds_read_b64_tr_b16 v[190:191], v22 offset:30976
v_add_u32 v68, 69632, v40
v_add_u32 v69, 69632, v41
v_add_u32 v70, 69632, v42
v_add_u32 v71, 69632, v43
v_add_u32 v72, 69632, v44
v_add_u32 v73, 69632, v45
v_add_u32 v74, 69632, v46
v_add_u32 v75, 69632, v47
L_gu_182:
s_cmp_lt_u32 s3, 4
s_cbranch_scc0 L_dma_183
s_mov_b32 s48, s20
s_mov_b32 s49, s21
s_mov_b32 s50, 0x158000
s_mov_b32 s51, 0x20000
v_lshrrev_b32 v18, 4, v0
v_and_b32 v16, 15, v0
v_xor_b32 v16, v16, v18
v_xor_b32 v17, 4, v16
v_lshlrev_b32 v19, 10, v18
v_lshl_add_u32 v22, v16, 4, v19
v_lshl_add_u32 v23, v17, 4, v19
s_lshl_b32 s76, s74, 15
s_lshl_b32 s66, s34, 8
s_add_u32 s76, s76, s66
s_lshl_b32 s77, s34, 13
s_add_u32 s77, s77, 77824
s_add_u32 m0, s77, 0
s_xor_b32 s66, s76, 0
buffer_load_dwordx4 v22, s[48:51], s66 offen  lds
s_add_u32 m0, s77, 1024
s_xor_b32 s66, s76, 8192
buffer_load_dwordx4 v23, s[48:51], s66 offen  lds
s_add_u32 m0, s77, 2048
s_xor_b32 s66, s76, 16384
buffer_load_dwordx4 v22, s[48:51], s66 offen  lds
s_add_u32 m0, s77, 3072
s_xor_b32 s66, s76, 24576
buffer_load_dwordx4 v23, s[48:51], s66 offen  lds
s_add_u32 m0, s77, 4096
s_xor_b32 s66, s76, 4096
buffer_load_dwordx4 v22, s[48:51], s66 offen  lds
s_add_u32 m0, s77, 5120
s_xor_b32 s66, s76, 12288
buffer_load_dwordx4 v23, s[48:51], s66 offen  lds
s_add_u32 m0, s77, 6144
s_xor_b32 s66, s76, 20480
buffer_load_dwordx4 v22, s[48:51], s66 offen  lds
s_waitcnt vmcnt(7)
s_branch L_dma_184
L_dma_183:
s_waitcnt vmcnt(0)
L_dma_184:
s_mov_b32 s73, 0x3f803f80
v_mov_b32 v20, 0
v_mov_b32 v21, 0
v_max3_u32 v12, v56, v57, v58
v_max_u32 v12, v12, v59
v_cmp_eq_u32 vcc, -1, v12
s_cbranch_vccz L_x_181
buffer_load_dwordx4 v[56:59], v1, s[36:39], s64 offen sc1
s_sleep 1
s_mov_b32 s75, 0
L_poll_185:
buffer_load_dwordx4 v[56:59], v1, s[36:39], s64 offen sc1
s_waitcnt vmcnt(1)
v_max3_u32 v12, v56, v57, v58
v_max_u32 v12, v12, v59
v_cmp_eq_u32 vcc, -1, v12
s_cbranch_vccz L_pollx_186
s_add_u32 s75, s75, 1
s_cmp_lt_u32 s75, 0x100000
s_cbranch_scc1 L_poll_185
L_pollx_186:
L_x_181:
v_dot2c_f32_bf16 v20, s73, v56
v_dot2c_f32_bf16 v21, v56, v56
v_dot2c_f32_bf16 v20, s73, v57
v_dot2c_f32_bf16 v21, v57, v57
v_dot2c_f32_bf16 v20, s73, v58
v_dot2c_f32_bf16 v21, v58, v58
v_dot2c_f32_bf16 v20, s73, v59
v_dot2c_f32_bf16 v21, v59, v59
v_lshlrev_b32 v40, 16, v56
v_and_b32 v41, s68, v56
v_lshlrev_b32 v42, 16, v57
v_permlane32_swap_b32 v20, v21
v_add_f32 v12, v20, v21
v_and_b32 v43, s68, v57
v_lshlrev_b32 v44, 16, v58
v_add_f32_dpp v12, v12, v12 quad_perm:[1,0,3,2] row_mask:0xf bank_mask:0xf
v_and_b32 v45, s68, v58
v_lshlrev_b32 v46, 16, v59
v_add_f32_dpp v12, v12, v12 quad_perm:[2,3,0,1] row_mask:0xf bank_mask:0xf
v_and_b32 v47, s68, v59
v_pk_mul_f32 v[48:49], v[40:41], v[32:33]
v_add_f32_dpp v12, v12, v12 row_ror:4 row_mask:0xf bank_mask:0xf
v_pk_mul_f32 v[50:51], v[42:43], v[34:35]
v_pk_mul_f32 v[52:53], v[44:45], v[36:37]
v_add_f32_dpp v12, v12, v12 row_ror:8 row_mask:0xf bank_mask:0xf
v_pk_mul_f32 v[54:55], v[46:47], v[38:39]
s_nop 0
v_add_f32_dpp v12, v12, v12 row_bcast:15 row_mask:0xa bank_mask:0xf
s_nop 0
v_readlane_b32 s70, v12, 16
v_readlane_b32 s71, v12, 48
s_nop 0
v_mul_f32 v12, s70, v14
v_mul_f32 v13, s71, v15
v_fma_f32 v13, -v12, v12, v13
v_max_f32 v13, 0, v13
v_add_f32 v13, 0x3727c5ac, v13
v_rsq_f32 v2, v13
v_pk_fma_f32 v[48:49], v[12:13], v[32:33], v[48:49] op_sel_hi:[0,1,1]
v_pk_fma_f32 v[50:51], v[12:13], v[34:35], v[50:51] op_sel_hi:[0,1,1]
v_pk_fma_f32 v[52:53], v[12:13], v[36:37], v[52:53] op_sel_hi:[0,1,1]
v_pk_fma_f32 v[54:55], v[12:13], v[38:39], v[54:55] op_sel_hi:[0,1,1]
v_pk_fma_f32 v[24:25], v[2:3], v[48:49], v[24:25] op_sel_hi:[0,1,1]
v_pk_fma_f32 v[28:29], v[2:3], v[52:53], v[28:29] op_sel_hi:[0,1,1]
v_pk_fma_f32 v[26:27], v[2:3], v[50:51], v[26:27] op_sel_hi:[0,1,1]
v_pk_fma_f32 v[30:31], v[2:3], v[54:55], v[30:31] op_sel_hi:[0,1,1]
v_cvt_pk_bf16_f32 v40, v24, v25
v_cvt_pk_bf16_f32 v41, v28, v29
ds_write_b64 v5, v[40:41]
v_cvt_pk_bf16_f32 v42, v26, v27
v_cvt_pk_bf16_f32 v43, v30, v31
ds_write_b64 v6, v[42:43]
s_cmp_lt_u32 s3, 4
s_cbranch_scc0 L_dma_187
s_mov_b32 s48, s20
s_mov_b32 s49, s21
s_mov_b32 s50, 0x158000
s_mov_b32 s51, 0x20000
s_add_u32 m0, s77, 7168
s_xor_b32 s66, s76, 28672
buffer_load_dwordx4 v23, s[48:51], s66 offen  lds
L_dma_187:
s_cmp_lt_u32 s3, 4
s_waitcnt lgkmcnt(0)
s_barrier
s_cbranch_scc1 L_bar_fin
ds_read_b128 v[192:195], v7 offset:0
ds_read_b128 v[196:199], v8 offset:1024
ds_read_b128 v[200:203], v7 offset:2048
ds_read_b128 v[204:207], v8 offset:3072
ds_read_b128 v[208:211], v7 offset:4096
ds_read_b128 v[212:215], v8 offset:5120
ds_read_b128 v[216:219], v7 offset:6144
ds_read_b128 v[220:223], v8 offset:7168
s_waitcnt lgkmcnt(7)
v_smfmac_f32_16x16x64_bf16 v[64:67], v[192:195], v[128:135], v16
s_waitcnt lgkmcnt(6)
v_smfmac_f32_16x16x64_bf16 v[64:67], v[196:199], v[136:143], v16
s_waitcnt lgkmcnt(5)
v_smfmac_f32_16x16x64_bf16 v[64:67], v[200:203], v[144:151], v16
s_waitcnt lgkmcnt(4)
v_smfmac_f32_16x16x64_bf16 v[64:67], v[204:207], v[152:159], v16
s_waitcnt lgkmcnt(3)
v_smfmac_f32_16x16x64_bf16 v[64:67], v[208:211], v[160:167], v16
s_waitcnt lgkmcnt(2)
v_smfmac_f32_16x16x64_bf16 v[64:67], v[212:215], v[168:175], v16
s_waitcnt lgkmcnt(1)
v_smfmac_f32_16x16x64_bf16 v[64:67], v[216:219], v[176:183], v16
s_waitcnt lgkmcnt(0)
v_smfmac_f32_16x16x64_bf16 v[64:67], v[220:223], v[184:191], v16
s_nop 7
v_add_f32 v66, v66, v67
v_add_f32 v64, v64, v65
v_mul_f32 v18, v64, v17
v_mul_f32_dpp v18, v66, v17 row_ror:8 row_mask:0xf bank_mask:0xc
v_exp_f32 v18, v18
v_mov_b32_dpp v66, v64 row_ror:8 row_mask:0xf bank_mask:0x3
v_add_f32 v18, 1.0, v18
v_rcp_f32 v18, v18
s_nop 0
v_mul_f32 v18, v18, v66
v_cvt_pk_bf16_f32 v18, v18, v18
ds_write_b16 v9, v18 offset:3584
s_waitcnt lgkmcnt(0)
s_barrier
ds_read_b128 v[48:51], v10 offset:3584
ds_read_b64_tr_b16 v[96:97], v68 offset:0
ds_read_b64_tr_b16 v[98:99], v68 offset:4096
ds_read_b64_tr_b16 v[100:101], v69 offset:0
ds_read_b64_tr_b16 v[102:103], v69 offset:4096
ds_read_b64_tr_b16 v[104:105], v70 offset:0
ds_read_b64_tr_b16 v[106:107], v70 offset:4096
ds_read_b64_tr_b16 v[108:109], v71 offset:0
ds_read_b64_tr_b16 v[110:111], v71 offset:4096
ds_read_b64_tr_b16 v[112:113], v72 offset:0
ds_read_b64_tr_b16 v[114:115], v72 offset:4096
ds_read_b64_tr_b16 v[116:117], v73 offset:0
ds_read_b64_tr_b16 v[118:119], v73 offset:4096
s_waitcnt lgkmcnt(10)
v_mfma_f32_16x16x32_bf16 v[192:195], v[48:51], v[96:99], 0
ds_read_b64_tr_b16 v[120:121], v74 offset:0
ds_read_b64_tr_b16 v[122:123], v74 offset:4096
s_waitcnt lgkmcnt(10)
v_mfma_f32_16x16x32_bf16 v[196:199], v[48:51], v[100:103], 0
ds_read_b64_tr_b16 v[124:125], v75 offset:0
ds_read_b64_tr_b16 v[126:127], v75 offset:4096
s_waitcnt lgkmcnt(10)
v_mfma_f32_16x16x32_bf16 v[200:203], v[48:51], v[104:107], 0
s_waitcnt lgkmcnt(8)
v_mfma_f32_16x16x32_bf16 v[204:207], v[48:51], v[108:111], 0
s_waitcnt lgkmcnt(6)
v_mfma_f32_16x16x32_bf16 v[208:211], v[48:51], v[112:115], 0
s_nop 0
v_cvt_pk_bf16_f32 v16, v192, v196
s_waitcnt lgkmcnt(4)
v_mfma_f32_16x16x32_bf16 v[212:215], v[48:51], v[116:119], 0
v_cvt_pk_bf16_f32 v20, v193, v197
s_waitcnt lgkmcnt(2)
v_mfma_f32_16x16x32_bf16 v[216:219], v[48:51], v[120:123], 0
v_cvt_pk_bf16_f32 v17, v200, v204
v_cvt_pk_bf16_f32 v21, v201, v205
s_waitcnt lgkmcnt(0)
v_mfma_f32_16x16x32_bf16 v[220:223], v[48:51], v[124:127], 0
s_nop 2
v_cvt_pk_bf16_f32 v18, v208, v212
v_cvt_pk_bf16_f32 v22, v209, v213
s_nop 2
v_cvt_pk_bf16_f32 v19, v216, v220
buffer_store_dwordx4 v[16:19], v11, s[36:39], s69 offen sc1
v_cvt_pk_bf16_f32 v23, v217, v221
buffer_store_dwordx4 v[20:23], v11, s[36:39], s72 offen sc1
s_endpgm
L_bar_fin:
s_waitcnt vmcnt(0)
s_barrier
s_endpgm
L_srest:
s_lshr_b32 s32, s2, 5
s_and_b32 s33, s2, 31
s_and_b32 s67, s2, 7
s_lshr_b32 s68, s2, 3
s_sub_u32 s68, s68, 26
s_min_u32 s74, s67, 3
s_mul_i32 s66, s67, 5
s_add_u32 s74, s74, s66
s_add_u32 s74, s74, s68
s_cmp_lt_u32 s67, 3
s_cselect_b32 s66, 6, 5
s_cmp_lt_u32 s68, s66
s_cselect_b32 s74, s74, -1
s_cmp_lt_u32 s2, 48
s_cselect_b32 s66, 2, 3
s_cselect_b32 s72, 14+26, 42+26
s_cmp_lt_u32 s2, 16
s_cselect_b32 s66, 1, s66
s_cselect_b32 s72, 26, s72
s_lshl_b32 s66, s67, s66
s_add_u32 s72, s72, s66
s_add_u32 s72, s72, s68
s_mov_b32 s36, s30
s_mov_b32 s37, s31
s_mov_b32 s38, 0x1d0000
s_mov_b32 s39, 0x20000
s_mov_b32 s52, s28
s_mov_b32 s53, s29
s_mov_b32 s54, 0x100
s_mov_b32 s55, 0x20000
s_mov_b32 s46, 0x40000
s_mov_b32 s47, 0x20000
s_cmp_eq_u32 s74, -1
s_mov_b32 s69, 30
s_cselect_b32 s69, 20, s69
s_cmp_lt_u32 s2, 144
s_cselect_b32 s69, 0, s69
s_cmp_lt_u32 s2, 112
s_cselect_b32 s69, 50, s69
s_cmp_lt_u32 s2, 48
s_cselect_b32 s69, 30, s69
s_cmp_lt_u32 s2, 16
s_cselect_b32 s69, 40, s69
s_and_b32 s66, s72, 7
s_cmp_eq_u32 s66, 3
s_cselect_b32 s66, 40, 0
s_cmp_lt_u32 s2, 112
s_cselect_b32 s66, s66, 0
s_add_u32 s69, s69, s66
s_xor_b32 s64, s65, 1024
s_cmpk_gt_u32 s69, 4
s_cbranch_scc1 L_d_1
s_waitcnt vmcnt(3)
L_d_1:
buffer_load_dwordx4 v[24:27], v1, s[40:43], s64 offen nt
s_xor_b32 s64, s65, 66560
s_cmpk_gt_u32 s69, 5
s_cbranch_scc1 L_d_2
s_waitcnt vmcnt(3)
L_d_2:
buffer_load_dwordx4 v[28:31], v1, s[40:43], s64 offen nt
s_xor_b32 s64, s65, 3072
s_cmpk_gt_u32 s69, 6
s_cbranch_scc1 L_d_3
s_waitcnt vmcnt(3)
L_d_3:
buffer_load_dwordx4 v[32:35], v1, s[40:43], s64 offen nt
s_xor_b32 s64, s65, 68608
s_cmpk_gt_u32 s69, 7
s_waitcnt vmcnt(6)
s_cbranch_scc1 L_d_4
s_waitcnt vmcnt(3)
L_d_4:
buffer_load_dwordx4 v[36:39], v1, s[40:43], s64 offen nt
s_xor_b32 s64, s65, 32768
s_cmpk_gt_u32 s69, 8
s_waitcnt vmcnt(6)
s_cbranch_scc1 L_d_5
s_waitcnt vmcnt(3)
L_d_5:
buffer_load_dwordx4 v[40:43], v1, s[40:43], s64 offen nt
s_xor_b32 s64, s65, 98304
s_cmpk_gt_u32 s69, 9
s_waitcnt vmcnt(6)
s_cbranch_scc1 L_d_6
s_waitcnt vmcnt(3)
L_d_6:
buffer_load_dwordx4 v[44:47], v1, s[40:43], s64 offen nt
s_xor_b32 s64, s65, 34816
s_cmpk_gt_u32 s69, 10
s_waitcnt vmcnt(6)
s_cbranch_scc1 L_d_7
s_waitcnt vmcnt(3)
L_d_7:
buffer_load_dwordx4 v[48:51], v1, s[40:43], s64 offen nt
s_xor_b32 s64, s65, 100352
s_cmpk_gt_u32 s69, 11
s_waitcnt vmcnt(6)
s_cbranch_scc1 L_d_8
s_waitcnt vmcnt(3)
L_d_8:
buffer_load_dwordx4 v[52:55], v1, s[40:43], s64 offen nt
s_xor_b32 s64, s65, 33792
s_cmpk_gt_u32 s69, 12
s_waitcnt vmcnt(6)
s_cbranch_scc1 L_d_9
s_waitcnt vmcnt(3)
L_d_9:
buffer_load_dwordx4 v[56:59], v1, s[40:43], s64 offen nt
s_xor_b32 s64, s65, 99328
s_cmpk_gt_u32 s69, 13
s_waitcnt vmcnt(6)
s_cbranch_scc1 L_d_10
s_waitcnt vmcnt(3)
L_d_10:
buffer_load_dwordx4 v[60:63], v1, s[40:43], s64 offen nt
s_xor_b32 s64, s65, 35840
s_cmpk_gt_u32 s69, 14
s_waitcnt vmcnt(6)
s_cbranch_scc1 L_d_11
s_waitcnt vmcnt(3)
L_d_11:
buffer_load_dwordx4 v[64:67], v1, s[40:43], s64 offen nt
s_xor_b32 s64, s65, 101376
s_cmpk_gt_u32 s69, 15
s_waitcnt vmcnt(6)
s_cbranch_scc1 L_d_12
s_waitcnt vmcnt(3)
L_d_12:
buffer_load_dwordx4 v[68:71], v1, s[40:43], s64 offen nt
s_xor_b32 s64, s65, 131072
s_cmpk_gt_u32 s69, 16
s_waitcnt vmcnt(6)
s_cbranch_scc1 L_d_13
s_waitcnt vmcnt(3)
L_d_13:
buffer_load_dwordx4 v[72:75], v1, s[40:43], s64 offen nt
s_xor_b32 s64, s65, 196608
s_cmpk_gt_u32 s69, 17
s_waitcnt vmcnt(6)
s_cbranch_scc1 L_d_14
s_waitcnt vmcnt(3)
L_d_14:
buffer_load_dwordx4 v[76:79], v1, s[40:43], s64 offen nt
s_xor_b32 s64, s65, 133120
s_cmpk_gt_u32 s69, 18
s_waitcnt vmcnt(6)
s_cbranch_scc1 L_d_15
s_waitcnt vmcnt(3)
L_d_15:
buffer_load_dwordx4 v[80:83], v1, s[40:43], s64 offen nt
s_xor_b32 s64, s65, 198656
s_cmpk_gt_u32 s69, 19
s_waitcnt vmcnt(6)
s_cbranch_scc1 L_d_16
s_waitcnt vmcnt(3)
L_d_16:
buffer_load_dwordx4 v[84:87], v1, s[40:43], s64 offen nt
s_xor_b32 s64, s65, 132096
s_cmpk_gt_u32 s69, 20
s_waitcnt vmcnt(6)
s_cbranch_scc1 L_d_17
s_waitcnt vmcnt(4)
L_d_17:
buffer_load_dwordx4 v[88:91], v1, s[40:43], s64 offen nt
s_xor_b32 s64, s65, 197632
s_cmpk_gt_u32 s69, 21
s_waitcnt vmcnt(6)
s_cbranch_scc1 L_d_18
s_waitcnt vmcnt(4)
L_d_18:
buffer_load_dwordx4 v[92:95], v1, s[40:43], s64 offen nt
s_xor_b32 s64, s65, 134144
s_cmpk_gt_u32 s69, 22
s_waitcnt vmcnt(6)
s_cbranch_scc1 L_d_19
s_waitcnt vmcnt(4)
L_d_19:
buffer_load_dwordx4 v[96:99], v1, s[40:43], s64 offen nt
s_xor_b32 s64, s65, 199680
s_cmpk_gt_u32 s69, 23
s_waitcnt vmcnt(6)
s_cbranch_scc1 L_d_20
s_waitcnt vmcnt(4)
L_d_20:
buffer_load_dwordx4 v[100:103], v1, s[40:43], s64 offen nt
s_xor_b32 s64, s65, 163840
s_cmpk_gt_u32 s69, 24
s_waitcnt vmcnt(6)
s_cbranch_scc1 L_d_21
s_waitcnt vmcnt(4)
L_d_21:
buffer_load_dwordx4 v[104:107], v1, s[40:43], s64 offen nt
s_xor_b32 s64, s65, 229376
s_cmpk_gt_u32 s69, 25
s_waitcnt vmcnt(6)
s_cbranch_scc1 L_d_22
s_waitcnt vmcnt(4)
L_d_22:
buffer_load_dwordx4 v[108:111], v1, s[40:43], s64 offen nt
s_xor_b32 s64, s65, 165888
s_cmpk_gt_u32 s69, 26
s_waitcnt vmcnt(6)
s_cbranch_scc1 L_d_23
s_waitcnt vmcnt(4)
L_d_23:
buffer_load_dwordx4 v[112:115], v1, s[40:43], s64 offen nt
s_xor_b32 s64, s65, 231424
s_cmpk_gt_u32 s69, 27
s_waitcnt vmcnt(6)
s_cbranch_scc1 L_d_24
s_waitcnt vmcnt(4)
L_d_24:
buffer_load_dwordx4 v[116:119], v1, s[40:43], s64 offen nt
s_xor_b32 s64, s65, 164864
s_cmpk_gt_u32 s69, 28
s_waitcnt vmcnt(6)
s_cbranch_scc1 L_d_25
s_waitcnt vmcnt(4)
L_d_25:
buffer_load_dwordx4 v[120:123], v1, s[40:43], s64 offen nt
s_xor_b32 s64, s65, 230400
s_cmpk_gt_u32 s69, 29
s_waitcnt vmcnt(6)
s_cbranch_scc1 L_d_26
s_waitcnt vmcnt(4)
L_d_26:
buffer_load_dwordx4 v[124:127], v1, s[40:43], s64 offen nt
s_xor_b32 s64, s65, 166912
s_cmpk_gt_u32 s69, 30
s_waitcnt vmcnt(6)
s_cbranch_scc1 L_d_27
s_waitcnt vmcnt(4)
L_d_27:
buffer_load_dwordx4 v[128:131], v1, s[40:43], s64 offen nt
s_xor_b32 s64, s65, 232448
s_cmpk_gt_u32 s69, 31
s_waitcnt vmcnt(6)
s_cbranch_scc1 L_d_28
s_waitcnt vmcnt(4)
L_d_28:
buffer_load_dwordx4 v[132:135], v1, s[40:43], s64 offen nt
s_xor_b32 s64, s65, 4096
s_cmpk_gt_u32 s69, 32
s_waitcnt vmcnt(6)
s_cbranch_scc1 L_d_29
s_waitcnt vmcnt(4)
L_d_29:
buffer_load_dwordx4 v[136:139], v1, s[40:43], s64 offen nt
s_xor_b32 s64, s65, 69632
s_cmpk_gt_u32 s69, 33
s_waitcnt vmcnt(6)
s_cbranch_scc1 L_d_30
s_waitcnt vmcnt(4)
L_d_30:
buffer_load_dwordx4 v[140:143], v1, s[40:43], s64 offen nt
s_xor_b32 s64, s65, 6144
s_cmpk_gt_u32 s69, 34
s_waitcnt vmcnt(6)
s_cbranch_scc1 L_d_31
s_waitcnt vmcnt(4)
L_d_31:
buffer_load_dwordx4 v[144:147], v1, s[40:43], s64 offen nt
s_xor_b32 s64, s65, 71680
s_cmpk_gt_u32 s69, 35
s_waitcnt vmcnt(6)
s_cbranch_scc1 L_d_32
s_waitcnt vmcnt(4)
L_d_32:
buffer_load_dwordx4 v[148:151], v1, s[40:43], s64 offen nt
s_xor_b32 s64, s65, 5120
s_cmpk_gt_u32 s69, 36
s_waitcnt vmcnt(6)
s_cbranch_scc1 L_d_33
s_waitcnt vmcnt(4)
L_d_33:
buffer_load_dwordx4 v[152:155], v1, s[40:43], s64 offen nt
s_xor_b32 s64, s65, 70656
s_cmpk_gt_u32 s69, 37
s_waitcnt vmcnt(6)
s_cbranch_scc1 L_d_34
s_waitcnt vmcnt(4)
L_d_34:
buffer_load_dwordx4 v[156:159], v1, s[40:43], s64 offen nt
s_xor_b32 s64, s65, 7168
s_cmpk_gt_u32 s69, 38
s_waitcnt vmcnt(6)
s_cbranch_scc1 L_d_35
s_waitcnt vmcnt(4)
L_d_35:
buffer_load_dwordx4 v[160:163], v1, s[40:43], s64 offen nt
s_xor_b32 s64, s65, 72704
s_cmpk_gt_u32 s69, 39
s_waitcnt vmcnt(6)
s_cbranch_scc1 L_d_36
s_waitcnt vmcnt(4)
L_d_36:
buffer_load_dwordx4 v[164:167], v1, s[40:43], s64 offen nt
s_xor_b32 s64, s65, 36864
s_cmpk_gt_u32 s69, 40
s_waitcnt vmcnt(6)
s_cbranch_scc1 L_d_37
s_waitcnt vmcnt(4)
L_d_37:
buffer_load_dwordx4 v[168:171], v1, s[40:43], s64 offen nt
s_xor_b32 s64, s65, 102400
s_cmpk_gt_u32 s69, 41
s_waitcnt vmcnt(6)
s_cbranch_scc1 L_d_38
s_waitcnt vmcnt(4)
L_d_38:
buffer_load_dwordx4 v[172:175], v1, s[40:43], s64 offen nt
s_xor_b32 s64, s65, 38912
s_cmpk_gt_u32 s69, 42
s_waitcnt vmcnt(6)
s_cbranch_scc1 L_d_39
s_waitcnt vmcnt(4)
L_d_39:
buffer_load_dwordx4 v[176:179], v1, s[40:43], s64 offen nt
s_xor_b32 s64, s65, 104448
s_cmpk_gt_u32 s69, 43
s_waitcnt vmcnt(6)
s_cbranch_scc1 L_d_40
s_waitcnt vmcnt(4)
L_d_40:
buffer_load_dwordx4 v[180:183], v1, s[40:43], s64 offen nt
s_xor_b32 s64, s65, 37888
s_cmpk_gt_u32 s69, 44
s_waitcnt vmcnt(6)
s_cbranch_scc1 L_d_41
s_waitcnt vmcnt(4)
L_d_41:
buffer_load_dwordx4 v[184:187], v1, s[40:43], s64 offen nt
s_xor_b32 s64, s65, 103424
s_cmpk_gt_u32 s69, 45
s_waitcnt vmcnt(6)
s_cbranch_scc1 L_d_42
s_waitcnt vmcnt(4)
L_d_42:
buffer_load_dwordx4 v[188:191], v1, s[40:43], s64 offen nt
s_xor_b32 s64, s65, 39936
s_cmpk_gt_u32 s69, 46
s_waitcnt vmcnt(6)
s_cbranch_scc1 L_d_43
s_waitcnt vmcnt(4)
L_d_43:
buffer_load_dwordx4 v[192:195], v1, s[40:43], s64 offen nt
s_xor_b32 s64, s65, 105472
s_cmpk_gt_u32 s69, 47
s_waitcnt vmcnt(6)
s_cbranch_scc1 L_d_44
s_waitcnt vmcnt(4)
L_d_44:
buffer_load_dwordx4 v[196:199], v1, s[40:43], s64 offen nt
s_xor_b32 s64, s65, 135168
s_cmpk_gt_u32 s69, 48
s_waitcnt vmcnt(6)
s_cbranch_scc1 L_d_45
s_waitcnt vmcnt(4)
L_d_45:
buffer_load_dwordx4 v[200:203], v1, s[40:43], s64 offen nt
s_xor_b32 s64, s65, 200704
s_cmpk_gt_u32 s69, 49
s_waitcnt vmcnt(6)
s_cbranch_scc1 L_d_46
s_waitcnt vmcnt(4)
L_d_46:
buffer_load_dwordx4 v[204:207], v1, s[40:43], s64 offen nt
s_xor_b32 s64, s65, 137216
s_cmpk_gt_u32 s69, 50
s_waitcnt vmcnt(6)
s_cbranch_scc1 L_d_47
s_waitcnt vmcnt(4)
L_d_47:
buffer_load_dwordx4 v[208:211], v1, s[40:43], s64 offen nt
s_xor_b32 s64, s65, 202752
s_cmpk_gt_u32 s69, 51
s_waitcnt vmcnt(6)
s_cbranch_scc1 L_d_48
s_waitcnt vmcnt(4)
L_d_48:
buffer_load_dwordx4 v[212:215], v1, s[40:43], s64 offen nt
s_xor_b32 s64, s65, 136192
s_cmpk_gt_u32 s69, 52
s_waitcnt vmcnt(6)
s_cbranch_scc1 L_d_49
s_waitcnt vmcnt(4)
L_d_49:
buffer_load_dwordx4 v[216:219], v1, s[40:43], s64 offen nt
s_xor_b32 s64, s65, 201728
s_cmpk_gt_u32 s69, 53
s_waitcnt vmcnt(6)
s_cbranch_scc1 L_d_50
s_waitcnt vmcnt(4)
L_d_50:
buffer_load_dwordx4 v[220:223], v1, s[40:43], s64 offen nt
s_xor_b32 s64, s65, 138240
s_cmpk_gt_u32 s69, 54
s_waitcnt vmcnt(6)
s_cbranch_scc1 L_d_51
s_waitcnt vmcnt(4)
L_d_51:
buffer_load_dwordx4 v[224:227], v1, s[40:43], s64 offen nt
s_xor_b32 s64, s65, 203776
s_cmpk_gt_u32 s69, 55
s_waitcnt vmcnt(6)
s_cbranch_scc1 L_d_52
s_waitcnt vmcnt(4)
L_d_52:
buffer_load_dwordx4 v[228:231], v1, s[40:43], s64 offen nt
s_cmp_eq_u32 s74, -1
s_mov_b32 s69, 80
s_cselect_b32 s69, 0, s69
s_cmp_lt_u32 s2, 144
s_cselect_b32 s69, 80, s69
s_cmp_lt_u32 s2, 112
s_cselect_b32 s69, 112, s69
s_cmp_lt_u32 s2, 48
s_cselect_b32 s69, 0, s69
s_cmp_lt_u32 s2, 16
s_cselect_b32 s69, 112, s69
s_xor_b32 s64, s65, 167936
s_cmpk_gt_u32 s69, 56
s_waitcnt vmcnt(6)
s_cbranch_scc1 L_d_53
s_waitcnt vmcnt(4)
L_d_53:
buffer_load_dwordx4 v[232:235], v1, s[40:43], s64 offen nt
s_xor_b32 s64, s65, 233472
s_cmpk_gt_u32 s69, 57
s_waitcnt vmcnt(6)
s_cbranch_scc1 L_d_54
s_waitcnt vmcnt(4)
L_d_54:
buffer_load_dwordx4 v[236:239], v1, s[40:43], s64 offen nt
s_xor_b32 s64, s65, 169984
s_cmpk_gt_u32 s69, 58
s_waitcnt vmcnt(6)
s_cbranch_scc1 L_d_55
s_waitcnt vmcnt(4)
L_d_55:
buffer_load_dwordx4 v[240:243], v1, s[40:43], s64 offen nt
v_and_b32 v2, 31, v0
v_lshlrev_b32 v2, 2, v2
buffer_load_dword v3, v2, s[52:55], 0 offen offset:128
s_xor_b32 s64, s65, 235520
s_cmpk_gt_u32 s69, 59
s_waitcnt vmcnt(6)
s_cbranch_scc1 L_d_56
s_waitcnt vmcnt(4)
L_d_56:
buffer_load_dwordx4 v[244:247], v1, s[40:43], s64 offen nt
s_xor_b32 s64, s65, 168960
s_cmpk_gt_u32 s69, 60
s_waitcnt vmcnt(6)
s_cbranch_scc1 L_d_57
s_waitcnt vmcnt(4)
L_d_57:
buffer_load_dwordx4 v[248:251], v1, s[40:43], s64 offen nt
s_xor_b32 s64, s65, 234496
s_cmpk_gt_u32 s69, 61
s_waitcnt vmcnt(6)
s_cbranch_scc1 L_d_58
s_waitcnt vmcnt(4)
L_d_58:
buffer_load_dwordx4 v[252:255], v1, s[40:43], s64 offen nt
s_mul_i32 s70, s34, 15360
s_add_u32 s70, s70, 69632
s_add_u32 m0, s70, 0
s_xor_b32 s64, s65, 171008
s_cmpk_gt_u32 s69, 62
s_waitcnt vmcnt(6)
s_cbranch_scc1 L_d_59
s_waitcnt vmcnt(4)
L_d_59:
buffer_load_dwordx4 v1, s[40:43], s64 offen nt lds
s_add_u32 m0, s70, 1024
s_xor_b32 s64, s65, 236544
s_cmpk_gt_u32 s69, 63
s_waitcnt vmcnt(6)
s_cbranch_scc1 L_d_60
s_waitcnt vmcnt(4)
L_d_60:
buffer_load_dwordx4 v1, s[40:43], s64 offen nt lds
s_add_u32 m0, s70, 2048
s_xor_b32 s64, s65, 0
s_cmpk_gt_u32 s69, 64
s_waitcnt vmcnt(6)
s_cbranch_scc1 L_d_61
s_waitcnt vmcnt(4)
L_d_61:
buffer_load_dwordx4 v1, s[44:47], s64 offen nt lds
s_add_u32 m0, s70, 3072
s_xor_b32 s64, s65, 65536
s_cmpk_gt_u32 s69, 65
s_waitcnt vmcnt(6)
s_cbranch_scc1 L_d_62
s_waitcnt vmcnt(4)
L_d_62:
buffer_load_dwordx4 v1, s[44:47], s64 offen nt lds
s_add_u32 m0, s70, 4096
s_xor_b32 s64, s65, 2048
s_cmpk_gt_u32 s69, 66
s_waitcnt vmcnt(6)
s_cbranch_scc1 L_d_63
s_waitcnt vmcnt(4)
L_d_63:
buffer_load_dwordx4 v1, s[44:47], s64 offen nt lds
s_add_u32 m0, s70, 5120
s_xor_b32 s64, s65, 67584
s_cmpk_gt_u32 s69, 67
s_waitcnt vmcnt(6)
s_cbranch_scc1 L_d_64
s_waitcnt vmcnt(4)
L_d_64:
buffer_load_dwordx4 v1, s[44:47], s64 offen nt lds
v_cmp_eq_u32 vcc, 0, v3
s_cbranch_vccz L_jf_66
s_mov_b32 s75, 0
L_poll_67:
v_and_b32 v2, 31, v0
v_lshlrev_b32 v2, 2, v2
buffer_load_dword v3, v2, s[52:55], 0 offen offset:128 sc1
s_waitcnt vmcnt(0)
v_cmp_eq_u32 vcc, 0, v3
s_cbranch_vccz L_pollx_68
s_sleep 40
s_add_u32 s75, s75, 1
s_cmp_lt_u32 s75, 0x100000
s_cbranch_scc1 L_poll_67
L_pollx_68:
L_jf_66:
s_mul_i32 s68, s32, 12288
s_lshl_b32 s67, s33, 8
s_add_u32 s68, s68, s67
s_add_u32 s68, s68, 16384
v_and_b32 v2, 0xf0, v1
buffer_load_dwordx4 v[4:7], v2, s[36:39], s68 offen sc1
s_add_u32 m0, s70, 6144
s_xor_b32 s64, s65, 1024
s_cmpk_gt_u32 s69, 68
s_waitcnt vmcnt(6)
s_cbranch_scc1 L_d_65
s_waitcnt vmcnt(4)
L_d_65:
buffer_load_dwordx4 v1, s[44:47], s64 offen nt lds
s_add_u32 m0, s70, 7168
s_xor_b32 s64, s65, 66560
s_cmpk_gt_u32 s69, 69
s_waitcnt vmcnt(6)
s_cbranch_scc1 L_d_69
s_waitcnt vmcnt(4)
L_d_69:
buffer_load_dwordx4 v1, s[44:47], s64 offen nt lds
s_add_u32 m0, s70, 8192
s_xor_b32 s64, s65, 3072
s_cmpk_gt_u32 s69, 70
s_waitcnt vmcnt(6)
s_cbranch_scc1 L_d_70
s_waitcnt vmcnt(4)
L_d_70:
buffer_load_dwordx4 v1, s[44:47], s64 offen nt lds
s_add_u32 m0, s70, 9216
s_xor_b32 s64, s65, 68608
s_cmpk_gt_u32 s69, 71
s_waitcnt vmcnt(6)
s_cbranch_scc1 L_d_71
s_waitcnt vmcnt(4)
L_d_71:
buffer_load_dwordx4 v1, s[44:47], s64 offen nt lds
s_add_u32 m0, s70, 10240
s_xor_b32 s64, s65, 32768
s_cmpk_gt_u32 s69, 72
s_waitcnt vmcnt(6)
s_cbranch_scc1 L_d_72
s_waitcnt vmcnt(4)
L_d_72:
buffer_load_dwordx4 v1, s[44:47], s64 offen nt lds
s_add_u32 m0, s70, 11264
s_xor_b32 s64, s65, 98304
s_cmpk_gt_u32 s69, 73
s_waitcnt vmcnt(6)
s_cbranch_scc1 L_d_73
s_waitcnt vmcnt(4)
L_d_73:
buffer_load_dwordx4 v1, s[44:47], s64 offen nt lds
s_add_u32 m0, s70, 12288
s_xor_b32 s64, s65, 34816
s_cmpk_gt_u32 s69, 74
s_waitcnt vmcnt(6)
s_cbranch_scc1 L_d_74
s_waitcnt vmcnt(4)
L_d_74:
buffer_load_dwordx4 v1, s[44:47], s64 offen nt lds
s_add_u32 m0, s70, 13312
s_xor_b32 s64, s65, 100352
s_cmpk_gt_u32 s69, 75
s_waitcnt vmcnt(6)
s_cbranch_scc1 L_d_75
s_waitcnt vmcnt(4)
L_d_75:
buffer_load_dwordx4 v1, s[44:47], s64 offen nt lds
s_add_u32 m0, s70, 14336
s_xor_b32 s64, s65, 33792
s_cmpk_gt_u32 s69, 76
s_waitcnt vmcnt(6)
s_cbranch_scc1 L_d_76
s_waitcnt vmcnt(4)
L_d_76:
buffer_load_dwordx4 v1, s[44:47], s64 offen nt lds
v_max3_u32 v3, v4, v5, v6
v_max_u32 v3, v3, v7
v_cmp_eq_u32 vcc, -1, v3
s_cbranch_vccz L_q_77
s_mov_b32 s75, 0
L_poll_78:
s_mul_i32 s68, s32, 12288
s_lshl_b32 s67, s33, 8
s_add_u32 s68, s68, s67
s_add_u32 s68, s68, 16384
v_and_b32 v2, 0xf0, v1
buffer_load_dwordx4 v[4:7], v2, s[36:39], s68 offen sc1
s_waitcnt vmcnt(0)
v_max3_u32 v3, v4, v5, v6
v_max_u32 v3, v3, v7
v_cmp_eq_u32 vcc, -1, v3
s_cbranch_vccz L_pollx_79
s_add_u32 s75, s75, 1
s_cmp_lt_u32 s75, 0x100000
s_cbranch_scc1 L_poll_78
L_pollx_79:
L_q_77:
s_mov_b32 s66, 0x3db504f3
v_dot2_f32_bf16 v8, v8, v4, 0
v_dot2_f32_bf16 v12, v12, v4, 0
v_dot2_f32_bf16 v16, v16, v4, 0
v_dot2_f32_bf16 v20, v20, v4, 0
v_dot2c_f32_bf16 v8, v9, v5
v_dot2c_f32_bf16 v12, v13, v5
v_dot2c_f32_bf16 v16, v17, v5
v_dot2c_f32_bf16 v20, v21, v5
v_dot2c_f32_bf16 v8, v10, v6
v_dot2c_f32_bf16 v12, v14, v6
v_dot2c_f32_bf16 v16, v18, v6
v_dot2c_f32_bf16 v20, v22, v6
v_dot2c_f32_bf16 v8, v11, v7
v_dot2c_f32_bf16 v12, v15, v7
v_dot2c_f32_bf16 v16, v19, v7
v_dot2c_f32_bf16 v20, v23, v7
v_add_f32_dpp v9, v8, v8 row_ror:8 row_mask:0xf bank_mask:0x3
v_add_f32_dpp v13, v12, v12 row_ror:8 row_mask:0xf bank_mask:0x3
v_add_f32_dpp v9, v16, v16 row_ror:8 row_mask:0xf bank_mask:0xc
v_add_f32_dpp v13, v20, v20 row_ror:8 row_mask:0xf bank_mask:0xc
s_nop 0
v_add_f32_dpp v17, v9, v9 row_shl:4 row_mask:0xf bank_mask:0x5
v_add_f32_dpp v17, v13, v13 row_shr:4 row_mask:0xf bank_mask:0xa
s_nop 1
v_add_f32_dpp v17, v17, v17 quad_perm:[1,0,3,2] row_mask:0xf bank_mask:0xf
s_nop 1
v_add_f32_dpp v17, v17, v17 quad_perm:[2,3,0,1] row_mask:0xf bank_mask:0xf
v_cvt_pk_bf16_f32 v17, 0, v17
v_mul_f32 v17, s66, v17
v_cvt_pk_bf16_f32 v17, 0, v17
v_dot2_f32_bf16 v24, v24, v4, 0
v_dot2_f32_bf16 v28, v28, v4, 0
v_dot2_f32_bf16 v32, v32, v4, 0
v_dot2_f32_bf16 v36, v36, v4, 0
v_dot2c_f32_bf16 v24, v25, v5
v_dot2c_f32_bf16 v28, v29, v5
v_dot2c_f32_bf16 v32, v33, v5
v_dot2c_f32_bf16 v36, v37, v5
v_dot2c_f32_bf16 v24, v26, v6
v_dot2c_f32_bf16 v28, v30, v6
v_dot2c_f32_bf16 v32, v34, v6
v_dot2c_f32_bf16 v36, v38, v6
v_dot2c_f32_bf16 v24, v27, v7
v_dot2c_f32_bf16 v28, v31, v7
v_dot2c_f32_bf16 v32, v35, v7
v_dot2c_f32_bf16 v36, v39, v7
v_add_f32_dpp v25, v24, v24 row_ror:8 row_mask:0xf bank_mask:0x3
v_add_f32_dpp v29, v28, v28 row_ror:8 row_mask:0xf bank_mask:0x3
v_add_f32_dpp v25, v32, v32 row_ror:8 row_mask:0xf bank_mask:0xc
v_add_f32_dpp v29, v36, v36 row_ror:8 row_mask:0xf bank_mask:0xc
s_nop 0
v_add_f32_dpp v8, v25, v25 row_shl:4 row_mask:0xf bank_mask:0x5
v_add_f32_dpp v8, v29, v29 row_shr:4 row_mask:0xf bank_mask:0xa
s_nop 1
v_add_f32_dpp v8, v8, v8 quad_perm:[1,0,3,2] row_mask:0xf bank_mask:0xf
s_nop 1
v_add_f32_dpp v8, v8, v8 quad_perm:[2,3,0,1] row_mask:0xf bank_mask:0xf
v_cvt_pk_bf16_f32 v8, 0, v8
v_mul_f32 v8, s66, v8
v_cvt_pk_bf16_f32 v8, 0, v8
s_xor_b32 s64, s65, 99328
s_cmpk_gt_u32 s69, 77
s_waitcnt vmcnt(6)
s_cbranch_scc1 L_d_80
s_waitcnt vmcnt(4)
L_d_80:
buffer_load_dwordx4 v[24:27], v1, s[44:47], s64 offen nt
v_dot2_f32_bf16 v40, v40, v4, 0
v_dot2_f32_bf16 v44, v44, v4, 0
v_dot2_f32_bf16 v48, v48, v4, 0
v_dot2_f32_bf16 v52, v52, v4, 0
v_dot2c_f32_bf16 v40, v41, v5
v_dot2c_f32_bf16 v44, v45, v5
v_dot2c_f32_bf16 v48, v49, v5
v_dot2c_f32_bf16 v52, v53, v5
v_dot2c_f32_bf16 v40, v42, v6
v_dot2c_f32_bf16 v44, v46, v6
v_dot2c_f32_bf16 v48, v50, v6
v_dot2c_f32_bf16 v52, v54, v6
v_dot2c_f32_bf16 v40, v43, v7
v_dot2c_f32_bf16 v44, v47, v7
v_dot2c_f32_bf16 v48, v51, v7
v_dot2c_f32_bf16 v52, v55, v7
v_add_f32_dpp v41, v40, v40 row_ror:8 row_mask:0xf bank_mask:0x3
v_add_f32_dpp v45, v44, v44 row_ror:8 row_mask:0xf bank_mask:0x3
v_add_f32_dpp v41, v48, v48 row_ror:8 row_mask:0xf bank_mask:0xc
v_add_f32_dpp v45, v52, v52 row_ror:8 row_mask:0xf bank_mask:0xc
s_nop 0
v_add_f32_dpp v9, v41, v41 row_shl:4 row_mask:0xf bank_mask:0x5
v_add_f32_dpp v9, v45, v45 row_shr:4 row_mask:0xf bank_mask:0xa
s_nop 1
v_add_f32_dpp v9, v9, v9 quad_perm:[1,0,3,2] row_mask:0xf bank_mask:0xf
s_nop 1
v_add_f32_dpp v9, v9, v9 quad_perm:[2,3,0,1] row_mask:0xf bank_mask:0xf
v_cvt_pk_bf16_f32 v9, 0, v9
v_mul_f32 v9, s66, v9
v_cvt_pk_bf16_f32 v9, 0, v9
s_and_b32 s62, s2, 7
s_lshl_b32 s62, s62, 9
s_add_u32 s62, s62, 1327104
s_lshr_b32 s63, s2, 3
s_lshl_b32 s63, s63, 2
s_add_u32 s63, s63, s62
s_cmp_eq_u32 s34, 0
s_cbranch_scc0 L_w_82
v_mov_b32 v2, 14
s_mov_b64 exec, 1
buffer_store_dword v2, off, s[36:39], s63 offset:0
s_mov_b64 exec, -1
L_w_82:
s_xor_b32 s64, s65, 35840
s_cmpk_gt_u32 s69, 78
s_waitcnt vmcnt(6)
s_cbranch_scc1 L_d_81
s_waitcnt vmcnt(4)
L_d_81:
buffer_load_dwordx4 v[28:31], v1, s[44:47], s64 offen nt
v_dot2_f32_bf16 v56, v56, v4, 0
v_dot2_f32_bf16 v60, v60, v4, 0
v_dot2_f32_bf16 v64, v64, v4, 0
v_dot2_f32_bf16 v68, v68, v4, 0
v_dot2c_f32_bf16 v56, v57, v5
v_dot2c_f32_bf16 v60, v61, v5
v_dot2c_f32_bf16 v64, v65, v5
v_dot2c_f32_bf16 v68, v69, v5
v_dot2c_f32_bf16 v56, v58, v6
v_dot2c_f32_bf16 v60, v62, v6
v_dot2c_f32_bf16 v64, v66, v6
v_dot2c_f32_bf16 v68, v70, v6
v_dot2c_f32_bf16 v56, v59, v7
v_dot2c_f32_bf16 v60, v63, v7
v_dot2c_f32_bf16 v64, v67, v7
v_dot2c_f32_bf16 v68, v71, v7
v_add_f32_dpp v57, v56, v56 row_ror:8 row_mask:0xf bank_mask:0x3
v_add_f32_dpp v61, v60, v60 row_ror:8 row_mask:0xf bank_mask:0x3
v_add_f32_dpp v57, v64, v64 row_ror:8 row_mask:0xf bank_mask:0xc
v_add_f32_dpp v61, v68, v68 row_ror:8 row_mask:0xf bank_mask:0xc
s_nop 0
v_add_f32_dpp v10, v57, v57 row_shl:4 row_mask:0xf bank_mask:0x5
v_add_f32_dpp v10, v61, v61 row_shr:4 row_mask:0xf bank_mask:0xa
s_nop 1
v_add_f32_dpp v10, v10, v10 quad_perm:[1,0,3,2] row_mask:0xf bank_mask:0xf
s_nop 1
v_add_f32_dpp v10, v10, v10 quad_perm:[2,3,0,1] row_mask:0xf bank_mask:0xf
v_cvt_pk_bf16_f32 v10, 0, v10
v_mul_f32 v10, s66, v10
v_cvt_pk_bf16_f32 v10, 0, v10
s_xor_b32 s64, s65, 101376
s_cmpk_gt_u32 s69, 79
s_waitcnt vmcnt(6)
s_cbranch_scc1 L_d_83
s_waitcnt vmcnt(4)
L_d_83:
buffer_load_dwordx4 v[32:35], v1, s[44:47], s64 offen nt
v_dot2_f32_bf16 v72, v72, v4, 0
v_dot2_f32_bf16 v76, v76, v4, 0
v_dot2_f32_bf16 v80, v80, v4, 0
v_dot2_f32_bf16 v84, v84, v4, 0
v_dot2c_f32_bf16 v72, v73, v5
v_dot2c_f32_bf16 v76, v77, v5
v_dot2c_f32_bf16 v80, v81, v5
v_dot2c_f32_bf16 v84, v85, v5
v_dot2c_f32_bf16 v72, v74, v6
v_dot2c_f32_bf16 v76, v78, v6
v_dot2c_f32_bf16 v80, v82, v6
v_dot2c_f32_bf16 v84, v86, v6
v_dot2c_f32_bf16 v72, v75, v7
v_dot2c_f32_bf16 v76, v79, v7
v_dot2c_f32_bf16 v80, v83, v7
v_dot2c_f32_bf16 v84, v87, v7
v_add_f32_dpp v73, v72, v72 row_ror:8 row_mask:0xf bank_mask:0x3
v_add_f32_dpp v77, v76, v76 row_ror:8 row_mask:0xf bank_mask:0x3
v_add_f32_dpp v73, v80, v80 row_ror:8 row_mask:0xf bank_mask:0xc
v_add_f32_dpp v77, v84, v84 row_ror:8 row_mask:0xf bank_mask:0xc
s_nop 0
v_add_f32_dpp v11, v73, v73 row_shl:4 row_mask:0xf bank_mask:0x5
v_add_f32_dpp v11, v77, v77 row_shr:4 row_mask:0xf bank_mask:0xa
s_nop 1
v_add_f32_dpp v11, v11, v11 quad_perm:[1,0,3,2] row_mask:0xf bank_mask:0xf
s_nop 1
v_add_f32_dpp v11, v11, v11 quad_perm:[2,3,0,1] row_mask:0xf bank_mask:0xf
v_cvt_pk_bf16_f32 v11, 0, v11
v_mul_f32 v11, s66, v11
v_cvt_pk_bf16_f32 v11, 0, v11
s_xor_b32 s64, s65, 131072
s_cmpk_gt_u32 s69, 80
s_waitcnt vmcnt(6)
s_cbranch_scc1 L_d_84
s_waitcnt vmcnt(4)
L_d_84:
buffer_load_dwordx4 v[36:39], v1, s[44:47], s64 offen nt
v_dot2_f32_bf16 v88, v88, v4, 0
v_dot2_f32_bf16 v92, v92, v4, 0
v_dot2_f32_bf16 v96, v96, v4, 0
v_dot2_f32_bf16 v100, v100, v4, 0
v_dot2c_f32_bf16 v88, v89, v5
v_dot2c_f32_bf16 v92, v93, v5
v_dot2c_f32_bf16 v96, v97, v5
v_dot2c_f32_bf16 v100, v101, v5
v_dot2c_f32_bf16 v88, v90, v6
v_dot2c_f32_bf16 v92, v94, v6
v_dot2c_f32_bf16 v96, v98, v6
v_dot2c_f32_bf16 v100, v102, v6
v_dot2c_f32_bf16 v88, v91, v7
v_dot2c_f32_bf16 v92, v95, v7
v_dot2c_f32_bf16 v96, v99, v7
v_dot2c_f32_bf16 v100, v103, v7
v_add_f32_dpp v89, v88, v88 row_ror:8 row_mask:0xf bank_mask:0x3
v_add_f32_dpp v93, v92, v92 row_ror:8 row_mask:0xf bank_mask:0x3
v_add_f32_dpp v89, v96, v96 row_ror:8 row_mask:0xf bank_mask:0xc
v_add_f32_dpp v93, v100, v100 row_ror:8 row_mask:0xf bank_mask:0xc
s_nop 0
v_add_f32_dpp v12, v89, v89 row_shl:4 row_mask:0xf bank_mask:0x5
v_add_f32_dpp v12, v93, v93 row_shr:4 row_mask:0xf bank_mask:0xa
s_nop 1
v_add_f32_dpp v12, v12, v12 quad_perm:[1,0,3,2] row_mask:0xf bank_mask:0xf
s_nop 1
v_add_f32_dpp v12, v12, v12 quad_perm:[2,3,0,1] row_mask:0xf bank_mask:0xf
v_cvt_pk_bf16_f32 v12, 0, v12
v_mul_f32 v12, s66, v12
v_cvt_pk_bf16_f32 v12, 0, v12
s_xor_b32 s64, s65, 196608
s_cmpk_gt_u32 s69, 81
s_waitcnt vmcnt(6)
s_cbranch_scc1 L_d_85
s_waitcnt vmcnt(4)
L_d_85:
buffer_load_dwordx4 v[40:43], v1, s[44:47], s64 offen nt
v_dot2_f32_bf16 v104, v104, v4, 0
v_dot2_f32_bf16 v108, v108, v4, 0
v_dot2_f32_bf16 v112, v112, v4, 0
v_dot2_f32_bf16 v116, v116, v4, 0
v_dot2c_f32_bf16 v104, v105, v5
v_dot2c_f32_bf16 v108, v109, v5
v_dot2c_f32_bf16 v112, v113, v5
v_dot2c_f32_bf16 v116, v117, v5
v_dot2c_f32_bf16 v104, v106, v6
v_dot2c_f32_bf16 v108, v110, v6
v_dot2c_f32_bf16 v112, v114, v6
v_dot2c_f32_bf16 v116, v118, v6
v_dot2c_f32_bf16 v104, v107, v7
v_dot2c_f32_bf16 v108, v111, v7
v_dot2c_f32_bf16 v112, v115, v7
v_dot2c_f32_bf16 v116, v119, v7
v_add_f32_dpp v105, v104, v104 row_ror:8 row_mask:0xf bank_mask:0x3
v_add_f32_dpp v109, v108, v108 row_ror:8 row_mask:0xf bank_mask:0x3
v_add_f32_dpp v105, v112, v112 row_ror:8 row_mask:0xf bank_mask:0xc
v_add_f32_dpp v109, v116, v116 row_ror:8 row_mask:0xf bank_mask:0xc
s_nop 0
v_add_f32_dpp v13, v105, v105 row_shl:4 row_mask:0xf bank_mask:0x5
v_add_f32_dpp v13, v109, v109 row_shr:4 row_mask:0xf bank_mask:0xa
s_nop 1
v_add_f32_dpp v13, v13, v13 quad_perm:[1,0,3,2] row_mask:0xf bank_mask:0xf
s_nop 1
v_add_f32_dpp v13, v13, v13 quad_perm:[2,3,0,1] row_mask:0xf bank_mask:0xf
v_cvt_pk_bf16_f32 v13, 0, v13
v_mul_f32 v13, s66, v13
v_cvt_pk_bf16_f32 v13, 0, v13
s_xor_b32 s64, s65, 133120
s_cmpk_gt_u32 s69, 82
s_waitcnt vmcnt(6)
s_cbranch_scc1 L_d_86
s_waitcnt vmcnt(4)
L_d_86:
buffer_load_dwordx4 v[44:47], v1, s[44:47], s64 offen nt
v_dot2_f32_bf16 v120, v120, v4, 0
v_dot2_f32_bf16 v124, v124, v4, 0
v_dot2_f32_bf16 v128, v128, v4, 0
v_dot2_f32_bf16 v132, v132, v4, 0
v_dot2c_f32_bf16 v120, v121, v5
v_dot2c_f32_bf16 v124, v125, v5
v_dot2c_f32_bf16 v128, v129, v5
v_dot2c_f32_bf16 v132, v133, v5
v_dot2c_f32_bf16 v120, v122, v6
v_dot2c_f32_bf16 v124, v126, v6
v_dot2c_f32_bf16 v128, v130, v6
v_dot2c_f32_bf16 v132, v134, v6
v_dot2c_f32_bf16 v120, v123, v7
v_dot2c_f32_bf16 v124, v127, v7
v_dot2c_f32_bf16 v128, v131, v7
v_dot2c_f32_bf16 v132, v135, v7
v_add_f32_dpp v121, v120, v120 row_ror:8 row_mask:0xf bank_mask:0x3
v_add_f32_dpp v125, v124, v124 row_ror:8 row_mask:0xf bank_mask:0x3
v_add_f32_dpp v121, v128, v128 row_ror:8 row_mask:0xf bank_mask:0xc
v_add_f32_dpp v125, v132, v132 row_ror:8 row_mask:0xf bank_mask:0xc
s_nop 0
v_add_f32_dpp v14, v121, v121 row_shl:4 row_mask:0xf bank_mask:0x5
v_add_f32_dpp v14, v125, v125 row_shr:4 row_mask:0xf bank_mask:0xa
s_nop 1
v_add_f32_dpp v14, v14, v14 quad_perm:[1,0,3,2] row_mask:0xf bank_mask:0xf
s_nop 1
v_add_f32_dpp v14, v14, v14 quad_perm:[2,3,0,1] row_mask:0xf bank_mask:0xf
v_cvt_pk_bf16_f32 v14, 0, v14
v_mul_f32 v14, s66, v14
v_cvt_pk_bf16_f32 v14, 0, v14
s_xor_b32 s64, s65, 198656
s_cmpk_gt_u32 s69, 83
s_waitcnt vmcnt(6)
s_cbranch_scc1 L_d_87
s_waitcnt vmcnt(4)
L_d_87:
buffer_load_dwordx4 v[48:51], v1, s[44:47], s64 offen nt
v_dot2_f32_bf16 v136, v136, v4, 0
v_dot2_f32_bf16 v140, v140, v4, 0
v_dot2_f32_bf16 v144, v144, v4, 0
v_dot2_f32_bf16 v148, v148, v4, 0
v_dot2c_f32_bf16 v136, v137, v5
v_dot2c_f32_bf16 v140, v141, v5
v_dot2c_f32_bf16 v144, v145, v5
v_dot2c_f32_bf16 v148, v149, v5
v_dot2c_f32_bf16 v136, v138, v6
v_dot2c_f32_bf16 v140, v142, v6
v_dot2c_f32_bf16 v144, v146, v6
v_dot2c_f32_bf16 v148, v150, v6
v_dot2c_f32_bf16 v136, v139, v7
v_dot2c_f32_bf16 v140, v143, v7
v_dot2c_f32_bf16 v144, v147, v7
v_dot2c_f32_bf16 v148, v151, v7
v_add_f32_dpp v137, v136, v136 row_ror:8 row_mask:0xf bank_mask:0x3
v_add_f32_dpp v141, v140, v140 row_ror:8 row_mask:0xf bank_mask:0x3
v_add_f32_dpp v137, v144, v144 row_ror:8 row_mask:0xf bank_mask:0xc
v_add_f32_dpp v141, v148, v148 row_ror:8 row_mask:0xf bank_mask:0xc
s_nop 0
v_add_f32_dpp v15, v137, v137 row_shl:4 row_mask:0xf bank_mask:0x5
v_add_f32_dpp v15, v141, v141 row_shr:4 row_mask:0xf bank_mask:0xa
s_nop 1
v_add_f32_dpp v15, v15, v15 quad_perm:[1,0,3,2] row_mask:0xf bank_mask:0xf
s_nop 1
v_add_f32_dpp v15, v15, v15 quad_perm:[2,3,0,1] row_mask:0xf bank_mask:0xf
v_cvt_pk_bf16_f32 v15, 0, v15
v_mul_f32 v15, s66, v15
v_cvt_pk_bf16_f32 v15, 0, v15
s_xor_b32 s64, s65, 132096
s_cmpk_gt_u32 s69, 84
s_waitcnt vmcnt(6)
s_cbranch_scc1 L_d_88
s_waitcnt vmcnt(4)
L_d_88:
buffer_load_dwordx4 v[52:55], v1, s[44:47], s64 offen nt
v_dot2_f32_bf16 v152, v152, v4, 0
v_dot2_f32_bf16 v156, v156, v4, 0
v_dot2_f32_bf16 v160, v160, v4, 0
v_dot2_f32_bf16 v164, v164, v4, 0
v_dot2c_f32_bf16 v152, v153, v5
v_dot2c_f32_bf16 v156, v157, v5
v_dot2c_f32_bf16 v160, v161, v5
v_dot2c_f32_bf16 v164, v165, v5
v_dot2c_f32_bf16 v152, v154, v6
v_dot2c_f32_bf16 v156, v158, v6
v_dot2c_f32_bf16 v160, v162, v6
v_dot2c_f32_bf16 v164, v166, v6
v_dot2c_f32_bf16 v152, v155, v7
v_dot2c_f32_bf16 v156, v159, v7
v_dot2c_f32_bf16 v160, v163, v7
v_dot2c_f32_bf16 v164, v167, v7
v_add_f32_dpp v153, v152, v152 row_ror:8 row_mask:0xf bank_mask:0x3
v_add_f32_dpp v157, v156, v156 row_ror:8 row_mask:0xf bank_mask:0x3
v_add_f32_dpp v153, v160, v160 row_ror:8 row_mask:0xf bank_mask:0xc
v_add_f32_dpp v157, v164, v164 row_ror:8 row_mask:0xf bank_mask:0xc
s_nop 0
v_add_f32_dpp v16, v153, v153 row_shl:4 row_mask:0xf bank_mask:0x5
v_add_f32_dpp v16, v157, v157 row_shr:4 row_mask:0xf bank_mask:0xa
s_nop 1
v_add_f32_dpp v16, v16, v16 quad_perm:[1,0,3,2] row_mask:0xf bank_mask:0xf
s_nop 1
v_add_f32_dpp v16, v16, v16 quad_perm:[2,3,0,1] row_mask:0xf bank_mask:0xf
v_cvt_pk_bf16_f32 v16, 0, v16
v_mul_f32 v16, s66, v16
v_cvt_pk_bf16_f32 v16, 0, v16
s_xor_b32 s64, s65, 197632
s_cmpk_gt_u32 s69, 85
s_waitcnt vmcnt(6)
s_cbranch_scc1 L_d_89
s_waitcnt vmcnt(4)
L_d_89:
buffer_load_dwordx4 v[56:59], v1, s[44:47], s64 offen nt
v_dot2_f32_bf16 v168, v168, v4, 0
v_dot2_f32_bf16 v172, v172, v4, 0
v_dot2_f32_bf16 v176, v176, v4, 0
v_dot2_f32_bf16 v180, v180, v4, 0
v_dot2c_f32_bf16 v168, v169, v5
v_dot2c_f32_bf16 v172, v173, v5
v_dot2c_f32_bf16 v176, v177, v5
v_dot2c_f32_bf16 v180, v181, v5
v_dot2c_f32_bf16 v168, v170, v6
v_dot2c_f32_bf16 v172, v174, v6
v_dot2c_f32_bf16 v176, v178, v6
v_dot2c_f32_bf16 v180, v182, v6
v_dot2c_f32_bf16 v168, v171, v7
v_dot2c_f32_bf16 v172, v175, v7
v_dot2c_f32_bf16 v176, v179, v7
v_dot2c_f32_bf16 v180, v183, v7
v_add_f32_dpp v169, v168, v168 row_ror:8 row_mask:0xf bank_mask:0x3
v_add_f32_dpp v173, v172, v172 row_ror:8 row_mask:0xf bank_mask:0x3
v_add_f32_dpp v169, v176, v176 row_ror:8 row_mask:0xf bank_mask:0xc
v_add_f32_dpp v173, v180, v180 row_ror:8 row_mask:0xf bank_mask:0xc
s_nop 0
v_add_f32_dpp v18, v169, v169 row_shl:4 row_mask:0xf bank_mask:0x5
v_add_f32_dpp v18, v173, v173 row_shr:4 row_mask:0xf bank_mask:0xa
s_nop 1
v_add_f32_dpp v18, v18, v18 quad_perm:[1,0,3,2] row_mask:0xf bank_mask:0xf
s_nop 1
v_add_f32_dpp v18, v18, v18 quad_perm:[2,3,0,1] row_mask:0xf bank_mask:0xf
v_cvt_pk_bf16_f32 v18, 0, v18
v_mul_f32 v18, s66, v18
v_cvt_pk_bf16_f32 v18, 0, v18
s_cmp_eq_u32 s34, 1
s_cbranch_scc0 L_w_91
v_mov_b32 v60, 22
s_mov_b64 exec, 1
buffer_store_dword v60, off, s[36:39], s63 offset:0
s_mov_b64 exec, -1
L_w_91:
s_xor_b32 s64, s65, 134144
s_cmpk_gt_u32 s69, 86
s_waitcnt vmcnt(6)
s_cbranch_scc1 L_d_90
s_waitcnt vmcnt(4)
L_d_90:
buffer_load_dwordx4 v[64:67], v1, s[44:47], s64 offen nt
v_dot2_f32_bf16 v184, v184, v4, 0
v_dot2_f32_bf16 v188, v188, v4, 0
v_dot2_f32_bf16 v192, v192, v4, 0
v_dot2_f32_bf16 v196, v196, v4, 0
v_dot2c_f32_bf16 v184, v185, v5
v_dot2c_f32_bf16 v188, v189, v5
v_dot2c_f32_bf16 v192, v193, v5
v_dot2c_f32_bf16 v196, v197, v5
v_dot2c_f32_bf16 v184, v186, v6
v_dot2c_f32_bf16 v188, v190, v6
v_dot2c_f32_bf16 v192, v194, v6
v_dot2c_f32_bf16 v196, v198, v6
v_dot2c_f32_bf16 v184, v187, v7
v_dot2c_f32_bf16 v188, v191, v7
v_dot2c_f32_bf16 v192, v195, v7
v_dot2c_f32_bf16 v196, v199, v7
v_add_f32_dpp v185, v184, v184 row_ror:8 row_mask:0xf bank_mask:0x3
v_add_f32_dpp v189, v188, v188 row_ror:8 row_mask:0xf bank_mask:0x3
v_add_f32_dpp v185, v192, v192 row_ror:8 row_mask:0xf bank_mask:0xc
v_add_f32_dpp v189, v196, v196 row_ror:8 row_mask:0xf bank_mask:0xc
s_nop 0
v_add_f32_dpp v19, v185, v185 row_shl:4 row_mask:0xf bank_mask:0x5
v_add_f32_dpp v19, v189, v189 row_shr:4 row_mask:0xf bank_mask:0xa
s_nop 1
v_add_f32_dpp v19, v19, v19 quad_perm:[1,0,3,2] row_mask:0xf bank_mask:0xf
s_nop 1
v_add_f32_dpp v19, v19, v19 quad_perm:[2,3,0,1] row_mask:0xf bank_mask:0xf
v_cvt_pk_bf16_f32 v19, 0, v19
v_mul_f32 v19, s66, v19
v_cvt_pk_bf16_f32 v19, 0, v19
s_xor_b32 s64, s65, 199680
s_cmpk_gt_u32 s69, 87
s_waitcnt vmcnt(6)
s_cbranch_scc1 L_d_92
s_waitcnt vmcnt(4)
L_d_92:
buffer_load_dwordx4 v[68:71], v1, s[44:47], s64 offen nt
v_dot2_f32_bf16 v200, v200, v4, 0
v_dot2_f32_bf16 v204, v204, v4, 0
v_dot2_f32_bf16 v208, v208, v4, 0
v_dot2_f32_bf16 v212, v212, v4, 0
v_dot2c_f32_bf16 v200, v201, v5
v_dot2c_f32_bf16 v204, v205, v5
v_dot2c_f32_bf16 v208, v209, v5
v_dot2c_f32_bf16 v212, v213, v5
v_dot2c_f32_bf16 v200, v202, v6
v_dot2c_f32_bf16 v204, v206, v6
v_dot2c_f32_bf16 v208, v210, v6
v_dot2c_f32_bf16 v212, v214, v6
v_dot2c_f32_bf16 v200, v203, v7
v_dot2c_f32_bf16 v204, v207, v7
v_dot2c_f32_bf16 v208, v211, v7
v_dot2c_f32_bf16 v212, v215, v7
v_add_f32_dpp v201, v200, v200 row_ror:8 row_mask:0xf bank_mask:0x3
v_add_f32_dpp v205, v204, v204 row_ror:8 row_mask:0xf bank_mask:0x3
v_add_f32_dpp v201, v208, v208 row_ror:8 row_mask:0xf bank_mask:0xc
v_add_f32_dpp v205, v212, v212 row_ror:8 row_mask:0xf bank_mask:0xc
s_nop 0
v_add_f32_dpp v20, v201, v201 row_shl:4 row_mask:0xf bank_mask:0x5
v_add_f32_dpp v20, v205, v205 row_shr:4 row_mask:0xf bank_mask:0xa
s_nop 1
v_add_f32_dpp v20, v20, v20 quad_perm:[1,0,3,2] row_mask:0xf bank_mask:0xf
s_nop 1
v_add_f32_dpp v20, v20, v20 quad_perm:[2,3,0,1] row_mask:0xf bank_mask:0xf
v_cvt_pk_bf16_f32 v20, 0, v20
v_mul_f32 v20, s66, v20
v_cvt_pk_bf16_f32 v20, 0, v20
s_xor_b32 s64, s65, 163840
s_cmpk_gt_u32 s69, 88
s_waitcnt vmcnt(6)
s_cbranch_scc1 L_d_93
s_waitcnt vmcnt(4)
L_d_93:
buffer_load_dwordx4 v[72:75], v1, s[44:47], s64 offen nt
v_dot2_f32_bf16 v216, v216, v4, 0
v_dot2_f32_bf16 v220, v220, v4, 0
v_dot2_f32_bf16 v224, v224, v4, 0
v_dot2_f32_bf16 v228, v228, v4, 0
v_dot2c_f32_bf16 v216, v217, v5
v_dot2c_f32_bf16 v220, v221, v5
v_dot2c_f32_bf16 v224, v225, v5
v_dot2c_f32_bf16 v228, v229, v5
v_dot2c_f32_bf16 v216, v218, v6
v_dot2c_f32_bf16 v220, v222, v6
v_dot2c_f32_bf16 v224, v226, v6
v_dot2c_f32_bf16 v228, v230, v6
v_dot2c_f32_bf16 v216, v219, v7
v_dot2c_f32_bf16 v220, v223, v7
v_dot2c_f32_bf16 v224, v227, v7
v_dot2c_f32_bf16 v228, v231, v7
v_add_f32_dpp v217, v216, v216 row_ror:8 row_mask:0xf bank_mask:0x3
v_add_f32_dpp v221, v220, v220 row_ror:8 row_mask:0xf bank_mask:0x3
v_add_f32_dpp v217, v224, v224 row_ror:8 row_mask:0xf bank_mask:0xc
v_add_f32_dpp v221, v228, v228 row_ror:8 row_mask:0xf bank_mask:0xc
s_nop 0
v_add_f32_dpp v21, v217, v217 row_shl:4 row_mask:0xf bank_mask:0x5
v_add_f32_dpp v21, v221, v221 row_shr:4 row_mask:0xf bank_mask:0xa
s_nop 1
v_add_f32_dpp v21, v21, v21 quad_perm:[1,0,3,2] row_mask:0xf bank_mask:0xf
s_nop 1
v_add_f32_dpp v21, v21, v21 quad_perm:[2,3,0,1] row_mask:0xf bank_mask:0xf
v_cvt_pk_bf16_f32 v21, 0, v21
v_mul_f32 v21, s66, v21
v_cvt_pk_bf16_f32 v21, 0, v21
s_xor_b32 s64, s65, 229376
s_cmpk_gt_u32 s69, 89
s_waitcnt vmcnt(6)
s_cbranch_scc1 L_d_94
s_waitcnt vmcnt(4)
L_d_94:
buffer_load_dwordx4 v[76:79], v1, s[44:47], s64 offen nt
v_dot2_f32_bf16 v232, v232, v4, 0
v_dot2_f32_bf16 v236, v236, v4, 0
v_dot2_f32_bf16 v240, v240, v4, 0
v_dot2_f32_bf16 v244, v244, v4, 0
v_dot2c_f32_bf16 v232, v233, v5
v_dot2c_f32_bf16 v236, v237, v5
v_dot2c_f32_bf16 v240, v241, v5
v_dot2c_f32_bf16 v244, v245, v5
v_dot2c_f32_bf16 v232, v234, v6
v_dot2c_f32_bf16 v236, v238, v6
v_dot2c_f32_bf16 v240, v242, v6
v_dot2c_f32_bf16 v244, v246, v6
v_dot2c_f32_bf16 v232, v235, v7
v_dot2c_f32_bf16 v236, v239, v7
v_dot2c_f32_bf16 v240, v243, v7
v_dot2c_f32_bf16 v244, v247, v7
v_add_f32_dpp v233, v232, v232 row_ror:8 row_mask:0xf bank_mask:0x3
v_add_f32_dpp v237, v236, v236 row_ror:8 row_mask:0xf bank_mask:0x3
v_add_f32_dpp v233, v240, v240 row_ror:8 row_mask:0xf bank_mask:0xc
v_add_f32_dpp v237, v244, v244 row_ror:8 row_mask:0xf bank_mask:0xc
s_nop 0
v_add_f32_dpp v22, v233, v233 row_shl:4 row_mask:0xf bank_mask:0x5
v_add_f32_dpp v22, v237, v237 row_shr:4 row_mask:0xf bank_mask:0xa
s_nop 1
v_add_f32_dpp v22, v22, v22 quad_perm:[1,0,3,2] row_mask:0xf bank_mask:0xf
s_nop 1
v_add_f32_dpp v22, v22, v22 quad_perm:[2,3,0,1] row_mask:0xf bank_mask:0xf
v_cvt_pk_bf16_f32 v22, 0, v22
v_mul_f32 v22, s66, v22
v_cvt_pk_bf16_f32 v22, 0, v22
s_xor_b32 s64, s65, 165888
s_cmpk_gt_u32 s69, 90
s_waitcnt vmcnt(6)
s_cbranch_scc1 L_d_95
s_waitcnt vmcnt(5)
L_d_95:
buffer_load_dwordx4 v[80:83], v1, s[44:47], s64 offen nt
v_lshl_add_u32 v84, v0, 4, s70
ds_read_b128 v[88:91], v84 offset:0
ds_read_b128 v[92:95], v84 offset:1024
s_waitcnt lgkmcnt(0)
v_dot2_f32_bf16 v248, v248, v4, 0
v_dot2_f32_bf16 v252, v252, v4, 0
v_dot2_f32_bf16 v88, v88, v4, 0
v_dot2_f32_bf16 v92, v92, v4, 0
v_dot2c_f32_bf16 v248, v249, v5
v_dot2c_f32_bf16 v252, v253, v5
v_dot2c_f32_bf16 v88, v89, v5
v_dot2c_f32_bf16 v92, v93, v5
v_dot2c_f32_bf16 v248, v250, v6
v_dot2c_f32_bf16 v252, v254, v6
v_dot2c_f32_bf16 v88, v90, v6
v_dot2c_f32_bf16 v92, v94, v6
v_dot2c_f32_bf16 v248, v251, v7
v_dot2c_f32_bf16 v252, v255, v7
v_dot2c_f32_bf16 v88, v91, v7
v_dot2c_f32_bf16 v92, v95, v7
v_add_f32_dpp v249, v248, v248 row_ror:8 row_mask:0xf bank_mask:0x3
v_add_f32_dpp v253, v252, v252 row_ror:8 row_mask:0xf bank_mask:0x3
v_add_f32_dpp v249, v88, v88 row_ror:8 row_mask:0xf bank_mask:0xc
v_add_f32_dpp v253, v92, v92 row_ror:8 row_mask:0xf bank_mask:0xc
s_nop 0
v_add_f32_dpp v23, v249, v249 row_shl:4 row_mask:0xf bank_mask:0x5
v_add_f32_dpp v23, v253, v253 row_shr:4 row_mask:0xf bank_mask:0xa
s_nop 1
v_add_f32_dpp v23, v23, v23 quad_perm:[1,0,3,2] row_mask:0xf bank_mask:0xf
s_nop 1
v_add_f32_dpp v23, v23, v23 quad_perm:[2,3,0,1] row_mask:0xf bank_mask:0xf
v_cvt_pk_bf16_f32 v23, 0, v23
v_mul_f32 v23, s66, v23
v_cvt_pk_bf16_f32 v23, 0, v23
s_xor_b32 s64, s65, 231424
s_cmpk_gt_u32 s69, 91
s_waitcnt vmcnt(6)
s_cbranch_scc1 L_d_96
s_waitcnt vmcnt(5)
L_d_96:
buffer_load_dwordx4 v[96:99], v1, s[44:47], s64 offen nt
v_max3_f32 v2, v17, v8, v9
v_max3_f32 v2, v2, v10, v11
v_max3_f32 v2, v2, v12, v13
v_max3_f32 v2, v2, v14, v15
v_max3_f32 v2, v2, v16, v18
v_max3_f32 v2, v2, v19, v20
v_max3_f32 v2, v2, v21, v22
v_max_f32 v2, v2, v23
v_max_f32 v2, 0xff7fffff, v2
s_nop 1
v_max_f32_dpp v2, v2, v2 row_ror:4 row_mask:0xf bank_mask:0xf
s_nop 1
v_max_f32_dpp v2, v2, v2 row_ror:8 row_mask:0xf bank_mask:0xf
v_mov_b32 v3, v2
s_nop 1
v_permlane16_swap_b32 v2, v3
s_nop 1
v_max_f32 v2, v2, v3
v_mov_b32 v3, v2
s_nop 1
v_permlane32_swap_b32 v2, v3
s_nop 1
v_max_f32 v2, v2, v3
s_mov_b32 s67, 0x3fb8aa3b
v_sub_f32 v17, v17, v2
v_sub_f32 v8, v8, v2
v_sub_f32 v9, v9, v2
v_sub_f32 v10, v10, v2
v_sub_f32 v11, v11, v2
v_sub_f32 v12, v12, v2
v_sub_f32 v13, v13, v2
v_sub_f32 v14, v14, v2
v_sub_f32 v15, v15, v2
v_sub_f32 v16, v16, v2
v_sub_f32 v18, v18, v2
v_sub_f32 v19, v19, v2
v_sub_f32 v20, v20, v2
v_sub_f32 v21, v21, v2
v_sub_f32 v22, v22, v2
v_sub_f32 v23, v23, v2
v_mul_f32 v17, s67, v17
v_mul_f32 v8, s67, v8
v_mul_f32 v9, s67, v9
v_mul_f32 v10, s67, v10
v_mul_f32 v11, s67, v11
v_mul_f32 v12, s67, v12
v_mul_f32 v13, s67, v13
v_mul_f32 v14, s67, v14
v_mul_f32 v15, s67, v15
v_mul_f32 v16, s67, v16
v_mul_f32 v18, s67, v18
v_mul_f32 v19, s67, v19
v_mul_f32 v20, s67, v20
v_mul_f32 v21, s67, v21
v_mul_f32 v22, s67, v22
v_mul_f32 v23, s67, v23
s_xor_b32 s64, s65, 164864
s_cmpk_gt_u32 s69, 92
s_waitcnt vmcnt(6)
s_cbranch_scc1 L_d_97
s_waitcnt vmcnt(5)
L_d_97:
buffer_load_dwordx4 v[120:123], v1, s[44:47], s64 offen nt
v_exp_f32 v17, v17
v_exp_f32 v8, v8
v_exp_f32 v9, v9
v_exp_f32 v10, v10
v_exp_f32 v11, v11
v_exp_f32 v12, v12
v_exp_f32 v13, v13
v_exp_f32 v14, v14
v_exp_f32 v15, v15
v_exp_f32 v16, v16
v_exp_f32 v18, v18
v_exp_f32 v19, v19
v_exp_f32 v20, v20
v_exp_f32 v21, v21
v_exp_f32 v22, v22
v_exp_f32 v23, v23
v_add_f32 v3, v17, v8
v_add_f32 v3, v3, v9
v_add_f32 v3, v3, v10
v_add_f32 v3, v3, v11
v_add_f32 v3, v3, v12
v_add_f32 v3, v3, v13
v_add_f32 v3, v3, v14
v_add_f32 v3, v3, v15
v_add_f32 v3, v3, v16
v_add_f32 v3, v3, v18
v_add_f32 v3, v3, v19
v_add_f32 v3, v3, v20
v_add_f32 v3, v3, v21
v_add_f32 v3, v3, v22
v_add_f32 v3, v3, v23
s_nop 1
v_add_f32_dpp v3, v3, v3 row_ror:4 row_mask:0xf bank_mask:0xf
s_nop 1
v_add_f32_dpp v3, v3, v3 row_ror:8 row_mask:0xf bank_mask:0xf
v_mov_b32 v100, v3
s_nop 1
v_permlane16_swap_b32 v3, v100
s_nop 1
v_add_f32 v3, v3, v100
v_mov_b32 v100, v3
s_nop 1
v_permlane32_swap_b32 v3, v100
s_nop 1
v_add_f32 v3, v3, v100
v_min_u32 v3, -2, v3
s_lshl_b32 s68, s34, 3
v_mov_b32 v100, s68
ds_write_b64 v100, v[2:3] offset:256
v_and_b32 v101, 15, v0
v_lshrrev_b32 v102, 1, v101
v_and_b32 v101, 1, v0
v_lshlrev_b32 v101, 4, v101
v_mov_b32 v103, 0xffff
v_lshlrev_b32 v101, v101, v103
v_cmp_eq_u32 vcc, 0, v102
s_nop 1
v_cndmask_b32 v4, 0, v101, vcc
v_cmp_eq_u32 vcc, 1, v102
s_nop 1
v_cndmask_b32 v5, 0, v101, vcc
v_cmp_eq_u32 vcc, 2, v102
s_nop 1
v_cndmask_b32 v6, 0, v101, vcc
v_cmp_eq_u32 vcc, 3, v102
s_nop 1
v_cndmask_b32 v7, 0, v101, vcc
s_xor_b32 s64, s65, 230400
s_cmpk_gt_u32 s69, 93
s_waitcnt vmcnt(6)
s_cbranch_scc1 L_d_98
s_waitcnt vmcnt(5)
L_d_98:
buffer_load_dwordx4 v[124:127], v1, s[44:47], s64 offen nt
v_mov_b32 v100, 0
s_mov_b32 s75, 0
L_poll_99:
ds_read_b128 v[104:107], v100 offset:256
ds_read_b128 v[108:111], v100 offset:272
s_waitcnt lgkmcnt(0)
v_max3_u32 v101, v105, v107, v109
v_max_u32 v101, v101, v111
v_cmp_eq_u32 vcc, -1, v101
s_cbranch_vccz L_pollx_100
s_add_u32 s75, s75, 1
s_cmp_lt_u32 s75, 0x1000000
s_cbranch_scc1 L_poll_99
L_pollx_100:
v_max3_f32 v101, v104, v106, v108
v_max_f32 v101, v101, v110
v_sub_f32 v104, v104, v101
v_sub_f32 v106, v106, v101
v_sub_f32 v108, v108, v101
v_sub_f32 v110, v110, v101
v_sub_f32 v2, v2, v101
v_mul_f32 v104, s67, v104
v_mul_f32 v106, s67, v106
v_mul_f32 v108, s67, v108
v_mul_f32 v110, s67, v110
v_mul_f32 v2, s67, v2
v_exp_f32 v104, v104
v_exp_f32 v106, v106
v_exp_f32 v108, v108
v_exp_f32 v110, v110
v_exp_f32 v2, v2
v_mul_f32 v3, v104, v105
v_fmac_f32 v3, v106, v107
v_fmac_f32 v3, v108, v109
v_fmac_f32 v3, v110, v111
v_rcp_f32 v3, v3
s_nop 0
v_mul_f32 v2, v2, v3
v_mul_f32 v17, v17, v2
v_mul_f32 v8, v8, v2
v_mul_f32 v9, v9, v2
v_mul_f32 v10, v10, v2
v_mul_f32 v11, v11, v2
v_mul_f32 v12, v12, v2
v_mul_f32 v13, v13, v2
v_mul_f32 v14, v14, v2
v_mul_f32 v15, v15, v2
v_mul_f32 v16, v16, v2
v_mul_f32 v18, v18, v2
v_mul_f32 v19, v19, v2
v_mul_f32 v20, v20, v2
v_mul_f32 v21, v21, v2
v_mul_f32 v22, v22, v2
v_mul_f32 v23, v23, v2
v_cvt_pk_bf16_f32 v17, v17, v17
v_cvt_pk_bf16_f32 v8, v8, v8
v_cvt_pk_bf16_f32 v9, v9, v9
v_cvt_pk_bf16_f32 v10, v10, v10
v_cvt_pk_bf16_f32 v11, v11, v11
v_cvt_pk_bf16_f32 v12, v12, v12
v_cvt_pk_bf16_f32 v13, v13, v13
v_cvt_pk_bf16_f32 v14, v14, v14
v_cvt_pk_bf16_f32 v15, v15, v15
v_cvt_pk_bf16_f32 v16, v16, v16
v_cvt_pk_bf16_f32 v18, v18, v18
v_cvt_pk_bf16_f32 v19, v19, v19
v_cvt_pk_bf16_f32 v20, v20, v20
v_cvt_pk_bf16_f32 v21, v21, v21
v_cvt_pk_bf16_f32 v22, v22, v22
v_cvt_pk_bf16_f32 v23, v23, v23
s_nop 1
s_cmp_eq_u32 s34, 2
s_cbranch_scc0 L_w_102
v_mov_b32 v60, 30
s_mov_b64 exec, 1
buffer_store_dword v60, off, s[36:39], s63 offset:0
s_mov_b64 exec, -1
L_w_102:
s_xor_b32 s64, s65, 166912
s_cmpk_gt_u32 s69, 94
s_waitcnt vmcnt(6)
s_cbranch_scc1 L_d_101
s_waitcnt vmcnt(5)
L_d_101:
buffer_load_dwordx4 v[128:131], v1, s[44:47], s64 offen nt
ds_read_b128 v[132:135], v84 offset:2048
ds_read_b128 v[136:139], v84 offset:3072
ds_read_b128 v[140:143], v84 offset:4096
ds_read_b128 v[144:147], v84 offset:5120
ds_read_b128 v[148:151], v84 offset:6144
ds_read_b128 v[152:155], v84 offset:7168
ds_read_b128 v[156:159], v84 offset:8192
ds_read_b128 v[160:163], v84 offset:9216
s_waitcnt lgkmcnt(0)
v_and_b32_dpp v104, v17, v4 row_newbcast:0 row_mask:0xf bank_mask:0xf
v_and_b32_dpp v105, v17, v5 row_newbcast:0 row_mask:0xf bank_mask:0xf
v_and_b32_dpp v106, v17, v6 row_newbcast:0 row_mask:0xf bank_mask:0xf
v_and_b32_dpp v107, v17, v7 row_newbcast:0 row_mask:0xf bank_mask:0xf
v_and_b32_dpp v108, v17, v4 row_newbcast:4 row_mask:0xf bank_mask:0xf
v_and_b32_dpp v109, v17, v5 row_newbcast:4 row_mask:0xf bank_mask:0xf
v_and_b32_dpp v110, v17, v6 row_newbcast:4 row_mask:0xf bank_mask:0xf
v_and_b32_dpp v111, v17, v7 row_newbcast:4 row_mask:0xf bank_mask:0xf
v_mfma_f32_16x16x32_bf16 v[112:115], v[104:107], v[132:135], 0
v_and_b32_dpp v104, v17, v4 row_newbcast:8 row_mask:0xf bank_mask:0xf
v_and_b32_dpp v105, v17, v5 row_newbcast:8 row_mask:0xf bank_mask:0xf
v_and_b32_dpp v106, v17, v6 row_newbcast:8 row_mask:0xf bank_mask:0xf
v_and_b32_dpp v107, v17, v7 row_newbcast:8 row_mask:0xf bank_mask:0xf
v_mfma_f32_16x16x32_bf16 v[112:115], v[108:111], v[136:139], v[112:115]
v_and_b32_dpp v108, v17, v4 row_newbcast:12 row_mask:0xf bank_mask:0xf
v_and_b32_dpp v109, v17, v5 row_newbcast:12 row_mask:0xf bank_mask:0xf
v_and_b32_dpp v110, v17, v6 row_newbcast:12 row_mask:0xf bank_mask:0xf
v_and_b32_dpp v111, v17, v7 row_newbcast:12 row_mask:0xf bank_mask:0xf
v_mfma_f32_16x16x32_bf16 v[112:115], v[104:107], v[140:143], v[112:115]
v_and_b32_dpp v104, v8, v4 row_newbcast:0 row_mask:0xf bank_mask:0xf
v_and_b32_dpp v105, v8, v5 row_newbcast:0 row_mask:0xf bank_mask:0xf
v_and_b32_dpp v106, v8, v6 row_newbcast:0 row_mask:0xf bank_mask:0xf
v_and_b32_dpp v107, v8, v7 row_newbcast:0 row_mask:0xf bank_mask:0xf
v_mfma_f32_16x16x32_bf16 v[112:115], v[108:111], v[144:147], v[112:115]
v_and_b32_dpp v108, v8, v4 row_newbcast:4 row_mask:0xf bank_mask:0xf
v_and_b32_dpp v109, v8, v5 row_newbcast:4 row_mask:0xf bank_mask:0xf
v_and_b32_dpp v110, v8, v6 row_newbcast:4 row_mask:0xf bank_mask:0xf
v_and_b32_dpp v111, v8, v7 row_newbcast:4 row_mask:0xf bank_mask:0xf
v_mfma_f32_16x16x32_bf16 v[112:115], v[104:107], v[148:151], v[112:115]
s_xor_b32 s64, s65, 232448
s_cmpk_gt_u32 s69, 95
s_waitcnt vmcnt(6)
s_cbranch_scc1 L_d_103
s_waitcnt vmcnt(5)
L_d_103:
buffer_load_dwordx4 v[164:167], v1, s[44:47], s64 offen nt
v_and_b32_dpp v104, v8, v4 row_newbcast:8 row_mask:0xf bank_mask:0xf
v_and_b32_dpp v105, v8, v5 row_newbcast:8 row_mask:0xf bank_mask:0xf
v_and_b32_dpp v106, v8, v6 row_newbcast:8 row_mask:0xf bank_mask:0xf
v_and_b32_dpp v107, v8, v7 row_newbcast:8 row_mask:0xf bank_mask:0xf
v_mfma_f32_16x16x32_bf16 v[112:115], v[108:111], v[152:155], v[112:115]
v_and_b32_dpp v108, v8, v4 row_newbcast:12 row_mask:0xf bank_mask:0xf
v_and_b32_dpp v109, v8, v5 row_newbcast:12 row_mask:0xf bank_mask:0xf
v_and_b32_dpp v110, v8, v6 row_newbcast:12 row_mask:0xf bank_mask:0xf
v_and_b32_dpp v111, v8, v7 row_newbcast:12 row_mask:0xf bank_mask:0xf
v_mfma_f32_16x16x32_bf16 v[112:115], v[104:107], v[156:159], v[112:115]
v_and_b32_dpp v104, v9, v4 row_newbcast:0 row_mask:0xf bank_mask:0xf
v_and_b32_dpp v105, v9, v5 row_newbcast:0 row_mask:0xf bank_mask:0xf
v_and_b32_dpp v106, v9, v6 row_newbcast:0 row_mask:0xf bank_mask:0xf
v_and_b32_dpp v107, v9, v7 row_newbcast:0 row_mask:0xf bank_mask:0xf
v_mfma_f32_16x16x32_bf16 v[112:115], v[108:111], v[160:163], v[112:115]
ds_read_b128 v[168:171], v84 offset:10240
ds_read_b128 v[172:175], v84 offset:11264
ds_read_b128 v[176:179], v84 offset:12288
ds_read_b128 v[180:183], v84 offset:13312
ds_read_b128 v[184:187], v84 offset:14336
s_waitcnt lgkmcnt(0)
v_and_b32_dpp v108, v9, v4 row_newbcast:4 row_mask:0xf bank_mask:0xf
v_and_b32_dpp v109, v9, v5 row_newbcast:4 row_mask:0xf bank_mask:0xf
v_and_b32_dpp v110, v9, v6 row_newbcast:4 row_mask:0xf bank_mask:0xf
v_and_b32_dpp v111, v9, v7 row_newbcast:4 row_mask:0xf bank_mask:0xf
v_mfma_f32_16x16x32_bf16 v[112:115], v[104:107], v[168:171], v[112:115]
v_and_b32_dpp v104, v9, v4 row_newbcast:8 row_mask:0xf bank_mask:0xf
v_and_b32_dpp v105, v9, v5 row_newbcast:8 row_mask:0xf bank_mask:0xf
v_and_b32_dpp v106, v9, v6 row_newbcast:8 row_mask:0xf bank_mask:0xf
v_and_b32_dpp v107, v9, v7 row_newbcast:8 row_mask:0xf bank_mask:0xf
v_mfma_f32_16x16x32_bf16 v[112:115], v[108:111], v[172:175], v[112:115]
s_xor_b32 s64, s65, 4096
s_cmpk_gt_u32 s69, 96
s_waitcnt vmcnt(6)
s_cbranch_scc1 L_d_104
s_waitcnt vmcnt(5)
L_d_104:
buffer_load_dwordx4 v[188:191], v1, s[44:47], s64 offen nt
v_and_b32_dpp v108, v9, v4 row_newbcast:12 row_mask:0xf bank_mask:0xf
v_and_b32_dpp v109, v9, v5 row_newbcast:12 row_mask:0xf bank_mask:0xf
v_and_b32_dpp v110, v9, v6 row_newbcast:12 row_mask:0xf bank_mask:0xf
v_and_b32_dpp v111, v9, v7 row_newbcast:12 row_mask:0xf bank_mask:0xf
v_mfma_f32_16x16x32_bf16 v[112:115], v[104:107], v[176:179], v[112:115]
v_and_b32_dpp v104, v10, v4 row_newbcast:0 row_mask:0xf bank_mask:0xf
v_and_b32_dpp v105, v10, v5 row_newbcast:0 row_mask:0xf bank_mask:0xf
v_and_b32_dpp v106, v10, v6 row_newbcast:0 row_mask:0xf bank_mask:0xf
v_and_b32_dpp v107, v10, v7 row_newbcast:0 row_mask:0xf bank_mask:0xf
v_mfma_f32_16x16x32_bf16 v[112:115], v[108:111], v[180:183], v[112:115]
v_and_b32_dpp v108, v10, v4 row_newbcast:4 row_mask:0xf bank_mask:0xf
v_and_b32_dpp v109, v10, v5 row_newbcast:4 row_mask:0xf bank_mask:0xf
v_and_b32_dpp v110, v10, v6 row_newbcast:4 row_mask:0xf bank_mask:0xf
v_and_b32_dpp v111, v10, v7 row_newbcast:4 row_mask:0xf bank_mask:0xf
v_mfma_f32_16x16x32_bf16 v[112:115], v[104:107], v[184:187], v[112:115]
v_and_b32_dpp v104, v10, v4 row_newbcast:8 row_mask:0xf bank_mask:0xf
v_and_b32_dpp v105, v10, v5 row_newbcast:8 row_mask:0xf bank_mask:0xf
v_and_b32_dpp v106, v10, v6 row_newbcast:8 row_mask:0xf bank_mask:0xf
v_and_b32_dpp v107, v10, v7 row_newbcast:8 row_mask:0xf bank_mask:0xf
v_mfma_f32_16x16x32_bf16 v[112:115], v[108:111], v[24:27], v[112:115]
v_and_b32_dpp v108, v10, v4 row_newbcast:12 row_mask:0xf bank_mask:0xf
v_and_b32_dpp v109, v10, v5 row_newbcast:12 row_mask:0xf bank_mask:0xf
v_and_b32_dpp v110, v10, v6 row_newbcast:12 row_mask:0xf bank_mask:0xf
v_and_b32_dpp v111, v10, v7 row_newbcast:12 row_mask:0xf bank_mask:0xf
v_mfma_f32_16x16x32_bf16 v[112:115], v[104:107], v[28:31], v[112:115]
s_xor_b32 s64, s65, 69632
s_cmpk_gt_u32 s69, 97
s_waitcnt vmcnt(6)
s_cbranch_scc1 L_d_105
s_waitcnt vmcnt(5)
L_d_105:
buffer_load_dwordx4 v[192:195], v1, s[44:47], s64 offen nt
v_and_b32_dpp v104, v11, v4 row_newbcast:0 row_mask:0xf bank_mask:0xf
v_and_b32_dpp v105, v11, v5 row_newbcast:0 row_mask:0xf bank_mask:0xf
v_and_b32_dpp v106, v11, v6 row_newbcast:0 row_mask:0xf bank_mask:0xf
v_and_b32_dpp v107, v11, v7 row_newbcast:0 row_mask:0xf bank_mask:0xf
v_mfma_f32_16x16x32_bf16 v[112:115], v[108:111], v[32:35], v[112:115]
v_and_b32_dpp v108, v11, v4 row_newbcast:4 row_mask:0xf bank_mask:0xf
v_and_b32_dpp v109, v11, v5 row_newbcast:4 row_mask:0xf bank_mask:0xf
v_and_b32_dpp v110, v11, v6 row_newbcast:4 row_mask:0xf bank_mask:0xf
v_and_b32_dpp v111, v11, v7 row_newbcast:4 row_mask:0xf bank_mask:0xf
v_mfma_f32_16x16x32_bf16 v[112:115], v[104:107], v[36:39], v[112:115]
v_and_b32_dpp v104, v11, v4 row_newbcast:8 row_mask:0xf bank_mask:0xf
v_and_b32_dpp v105, v11, v5 row_newbcast:8 row_mask:0xf bank_mask:0xf
v_and_b32_dpp v106, v11, v6 row_newbcast:8 row_mask:0xf bank_mask:0xf
v_and_b32_dpp v107, v11, v7 row_newbcast:8 row_mask:0xf bank_mask:0xf
v_mfma_f32_16x16x32_bf16 v[112:115], v[108:111], v[40:43], v[112:115]
v_and_b32_dpp v108, v11, v4 row_newbcast:12 row_mask:0xf bank_mask:0xf
v_and_b32_dpp v109, v11, v5 row_newbcast:12 row_mask:0xf bank_mask:0xf
v_and_b32_dpp v110, v11, v6 row_newbcast:12 row_mask:0xf bank_mask:0xf
v_and_b32_dpp v111, v11, v7 row_newbcast:12 row_mask:0xf bank_mask:0xf
v_mfma_f32_16x16x32_bf16 v[112:115], v[104:107], v[44:47], v[112:115]
v_and_b32_dpp v104, v12, v4 row_newbcast:0 row_mask:0xf bank_mask:0xf
v_and_b32_dpp v105, v12, v5 row_newbcast:0 row_mask:0xf bank_mask:0xf
v_and_b32_dpp v106, v12, v6 row_newbcast:0 row_mask:0xf bank_mask:0xf
v_and_b32_dpp v107, v12, v7 row_newbcast:0 row_mask:0xf bank_mask:0xf
v_mfma_f32_16x16x32_bf16 v[112:115], v[108:111], v[48:51], v[112:115]
s_xor_b32 s64, s65, 6144
s_cmpk_gt_u32 s69, 98
s_waitcnt vmcnt(6)
s_cbranch_scc1 L_d_106
s_waitcnt vmcnt(5)
L_d_106:
buffer_load_dwordx4 v[196:199], v1, s[44:47], s64 offen nt
v_and_b32_dpp v108, v12, v4 row_newbcast:4 row_mask:0xf bank_mask:0xf
v_and_b32_dpp v109, v12, v5 row_newbcast:4 row_mask:0xf bank_mask:0xf
v_and_b32_dpp v110, v12, v6 row_newbcast:4 row_mask:0xf bank_mask:0xf
v_and_b32_dpp v111, v12, v7 row_newbcast:4 row_mask:0xf bank_mask:0xf
v_mfma_f32_16x16x32_bf16 v[112:115], v[104:107], v[52:55], v[112:115]
v_and_b32_dpp v104, v12, v4 row_newbcast:8 row_mask:0xf bank_mask:0xf
v_and_b32_dpp v105, v12, v5 row_newbcast:8 row_mask:0xf bank_mask:0xf
v_and_b32_dpp v106, v12, v6 row_newbcast:8 row_mask:0xf bank_mask:0xf
v_and_b32_dpp v107, v12, v7 row_newbcast:8 row_mask:0xf bank_mask:0xf
v_mfma_f32_16x16x32_bf16 v[112:115], v[108:111], v[56:59], v[112:115]
v_and_b32_dpp v108, v12, v4 row_newbcast:12 row_mask:0xf bank_mask:0xf
v_and_b32_dpp v109, v12, v5 row_newbcast:12 row_mask:0xf bank_mask:0xf
v_and_b32_dpp v110, v12, v6 row_newbcast:12 row_mask:0xf bank_mask:0xf
v_and_b32_dpp v111, v12, v7 row_newbcast:12 row_mask:0xf bank_mask:0xf
v_mfma_f32_16x16x32_bf16 v[112:115], v[104:107], v[64:67], v[112:115]
v_and_b32_dpp v104, v13, v4 row_newbcast:0 row_mask:0xf bank_mask:0xf
v_and_b32_dpp v105, v13, v5 row_newbcast:0 row_mask:0xf bank_mask:0xf
v_and_b32_dpp v106, v13, v6 row_newbcast:0 row_mask:0xf bank_mask:0xf
v_and_b32_dpp v107, v13, v7 row_newbcast:0 row_mask:0xf bank_mask:0xf
v_mfma_f32_16x16x32_bf16 v[112:115], v[108:111], v[68:71], v[112:115]
v_and_b32_dpp v108, v13, v4 row_newbcast:4 row_mask:0xf bank_mask:0xf
v_and_b32_dpp v109, v13, v5 row_newbcast:4 row_mask:0xf bank_mask:0xf
v_and_b32_dpp v110, v13, v6 row_newbcast:4 row_mask:0xf bank_mask:0xf
v_and_b32_dpp v111, v13, v7 row_newbcast:4 row_mask:0xf bank_mask:0xf
v_mfma_f32_16x16x32_bf16 v[112:115], v[104:107], v[72:75], v[112:115]
s_xor_b32 s64, s65, 71680
s_cmpk_gt_u32 s69, 99
s_waitcnt vmcnt(6)
s_cbranch_scc1 L_d_107
s_waitcnt vmcnt(5)
L_d_107:
buffer_load_dwordx4 v[200:203], v1, s[44:47], s64 offen nt
v_and_b32_dpp v104, v13, v4 row_newbcast:8 row_mask:0xf bank_mask:0xf
v_and_b32_dpp v105, v13, v5 row_newbcast:8 row_mask:0xf bank_mask:0xf
v_and_b32_dpp v106, v13, v6 row_newbcast:8 row_mask:0xf bank_mask:0xf
v_and_b32_dpp v107, v13, v7 row_newbcast:8 row_mask:0xf bank_mask:0xf
v_mfma_f32_16x16x32_bf16 v[112:115], v[108:111], v[76:79], v[112:115]
v_and_b32_dpp v108, v13, v4 row_newbcast:12 row_mask:0xf bank_mask:0xf
v_and_b32_dpp v109, v13, v5 row_newbcast:12 row_mask:0xf bank_mask:0xf
v_and_b32_dpp v110, v13, v6 row_newbcast:12 row_mask:0xf bank_mask:0xf
v_and_b32_dpp v111, v13, v7 row_newbcast:12 row_mask:0xf bank_mask:0xf
v_mfma_f32_16x16x32_bf16 v[112:115], v[104:107], v[80:83], v[112:115]
v_and_b32_dpp v104, v14, v4 row_newbcast:0 row_mask:0xf bank_mask:0xf
v_and_b32_dpp v105, v14, v5 row_newbcast:0 row_mask:0xf bank_mask:0xf
v_and_b32_dpp v106, v14, v6 row_newbcast:0 row_mask:0xf bank_mask:0xf
v_and_b32_dpp v107, v14, v7 row_newbcast:0 row_mask:0xf bank_mask:0xf
v_mfma_f32_16x16x32_bf16 v[112:115], v[108:111], v[96:99], v[112:115]
v_and_b32_dpp v108, v14, v4 row_newbcast:4 row_mask:0xf bank_mask:0xf
v_and_b32_dpp v109, v14, v5 row_newbcast:4 row_mask:0xf bank_mask:0xf
v_and_b32_dpp v110, v14, v6 row_newbcast:4 row_mask:0xf bank_mask:0xf
v_and_b32_dpp v111, v14, v7 row_newbcast:4 row_mask:0xf bank_mask:0xf
v_mfma_f32_16x16x32_bf16 v[112:115], v[104:107], v[120:123], v[112:115]
s_xor_b32 s64, s65, 5120
s_cmpk_gt_u32 s69, 100
s_waitcnt vmcnt(6)
s_cbranch_scc1 L_d_108
s_waitcnt vmcnt(5)
L_d_108:
buffer_load_dwordx4 v[204:207], v1, s[44:47], s64 offen nt
v_and_b32_dpp v104, v14, v4 row_newbcast:8 row_mask:0xf bank_mask:0xf
v_and_b32_dpp v105, v14, v5 row_newbcast:8 row_mask:0xf bank_mask:0xf
v_and_b32_dpp v106, v14, v6 row_newbcast:8 row_mask:0xf bank_mask:0xf
v_and_b32_dpp v107, v14, v7 row_newbcast:8 row_mask:0xf bank_mask:0xf
v_mfma_f32_16x16x32_bf16 v[112:115], v[108:111], v[124:127], v[112:115]
s_xor_b32 s64, s65, 70656
s_cmpk_gt_u32 s69, 101
s_waitcnt vmcnt(6)
s_cbranch_scc1 L_d_109
s_waitcnt vmcnt(5)
L_d_109:
buffer_load_dwordx4 v[208:211], v1, s[44:47], s64 offen nt
v_and_b32_dpp v108, v14, v4 row_newbcast:12 row_mask:0xf bank_mask:0xf
v_and_b32_dpp v109, v14, v5 row_newbcast:12 row_mask:0xf bank_mask:0xf
v_and_b32_dpp v110, v14, v6 row_newbcast:12 row_mask:0xf bank_mask:0xf
v_and_b32_dpp v111, v14, v7 row_newbcast:12 row_mask:0xf bank_mask:0xf
v_mfma_f32_16x16x32_bf16 v[112:115], v[104:107], v[128:131], v[112:115]
s_cmp_eq_u32 s34, 3
s_cbranch_scc0 L_w_111
v_mov_b32 v60, 38
s_mov_b64 exec, 1
buffer_store_dword v60, off, s[36:39], s63 offset:0
s_mov_b64 exec, -1
L_w_111:
s_xor_b32 s64, s65, 7168
s_cmpk_gt_u32 s69, 102
s_waitcnt vmcnt(6)
s_cbranch_scc1 L_d_110
s_waitcnt vmcnt(5)
L_d_110:
buffer_load_dwordx4 v[212:215], v1, s[44:47], s64 offen nt
v_and_b32_dpp v104, v15, v4 row_newbcast:0 row_mask:0xf bank_mask:0xf
v_and_b32_dpp v105, v15, v5 row_newbcast:0 row_mask:0xf bank_mask:0xf
v_and_b32_dpp v106, v15, v6 row_newbcast:0 row_mask:0xf bank_mask:0xf
v_and_b32_dpp v107, v15, v7 row_newbcast:0 row_mask:0xf bank_mask:0xf
v_mfma_f32_16x16x32_bf16 v[112:115], v[108:111], v[164:167], v[112:115]
s_xor_b32 s64, s65, 72704
s_cmpk_gt_u32 s69, 103
s_waitcnt vmcnt(6)
s_cbranch_scc1 L_d_112
s_waitcnt vmcnt(5)
L_d_112:
buffer_load_dwordx4 v[216:219], v1, s[44:47], s64 offen nt
v_and_b32_dpp v108, v15, v4 row_newbcast:4 row_mask:0xf bank_mask:0xf
v_and_b32_dpp v109, v15, v5 row_newbcast:4 row_mask:0xf bank_mask:0xf
v_and_b32_dpp v110, v15, v6 row_newbcast:4 row_mask:0xf bank_mask:0xf
v_and_b32_dpp v111, v15, v7 row_newbcast:4 row_mask:0xf bank_mask:0xf
v_mfma_f32_16x16x32_bf16 v[112:115], v[104:107], v[188:191], v[112:115]
s_xor_b32 s64, s65, 36864
s_cmpk_gt_u32 s69, 104
s_waitcnt vmcnt(6)
s_cbranch_scc1 L_d_113
s_waitcnt vmcnt(5)
L_d_113:
buffer_load_dwordx4 v[220:223], v1, s[44:47], s64 offen nt
v_and_b32_dpp v104, v15, v4 row_newbcast:8 row_mask:0xf bank_mask:0xf
v_and_b32_dpp v105, v15, v5 row_newbcast:8 row_mask:0xf bank_mask:0xf
v_and_b32_dpp v106, v15, v6 row_newbcast:8 row_mask:0xf bank_mask:0xf
v_and_b32_dpp v107, v15, v7 row_newbcast:8 row_mask:0xf bank_mask:0xf
v_mfma_f32_16x16x32_bf16 v[112:115], v[108:111], v[192:195], v[112:115]
s_xor_b32 s64, s65, 102400
s_cmpk_gt_u32 s69, 105
s_waitcnt vmcnt(6)
s_cbranch_scc1 L_d_114
s_waitcnt vmcnt(5)
L_d_114:
buffer_load_dwordx4 v[224:227], v1, s[44:47], s64 offen nt
v_and_b32_dpp v108, v15, v4 row_newbcast:12 row_mask:0xf bank_mask:0xf
v_and_b32_dpp v109, v15, v5 row_newbcast:12 row_mask:0xf bank_mask:0xf
v_and_b32_dpp v110, v15, v6 row_newbcast:12 row_mask:0xf bank_mask:0xf
v_and_b32_dpp v111, v15, v7 row_newbcast:12 row_mask:0xf bank_mask:0xf
v_mfma_f32_16x16x32_bf16 v[112:115], v[104:107], v[196:199], v[112:115]
s_xor_b32 s64, s65, 38912
s_cmpk_gt_u32 s69, 106
s_waitcnt vmcnt(6)
s_cbranch_scc1 L_d_115
s_waitcnt vmcnt(5)
L_d_115:
buffer_load_dwordx4 v[228:231], v1, s[44:47], s64 offen nt
v_and_b32_dpp v104, v16, v4 row_newbcast:0 row_mask:0xf bank_mask:0xf
v_and_b32_dpp v105, v16, v5 row_newbcast:0 row_mask:0xf bank_mask:0xf
v_and_b32_dpp v106, v16, v6 row_newbcast:0 row_mask:0xf bank_mask:0xf
v_and_b32_dpp v107, v16, v7 row_newbcast:0 row_mask:0xf bank_mask:0xf
v_mfma_f32_16x16x32_bf16 v[112:115], v[108:111], v[200:203], v[112:115]
s_xor_b32 s64, s65, 104448
s_cmpk_gt_u32 s69, 107
s_waitcnt vmcnt(6)
s_cbranch_scc1 L_d_116
s_waitcnt vmcnt(5)
L_d_116:
buffer_load_dwordx4 v[232:235], v1, s[44:47], s64 offen nt
v_and_b32_dpp v108, v16, v4 row_newbcast:4 row_mask:0xf bank_mask:0xf
v_and_b32_dpp v109, v16, v5 row_newbcast:4 row_mask:0xf bank_mask:0xf
v_and_b32_dpp v110, v16, v6 row_newbcast:4 row_mask:0xf bank_mask:0xf
v_and_b32_dpp v111, v16, v7 row_newbcast:4 row_mask:0xf bank_mask:0xf
v_mfma_f32_16x16x32_bf16 v[112:115], v[104:107], v[204:207], v[112:115]
s_xor_b32 s64, s65, 37888
s_cmpk_gt_u32 s69, 108
s_waitcnt vmcnt(6)
s_cbranch_scc1 L_d_117
s_waitcnt vmcnt(5)
L_d_117:
buffer_load_dwordx4 v[236:239], v1, s[44:47], s64 offen nt
v_and_b32_dpp v104, v16, v4 row_newbcast:8 row_mask:0xf bank_mask:0xf
v_and_b32_dpp v105, v16, v5 row_newbcast:8 row_mask:0xf bank_mask:0xf
v_and_b32_dpp v106, v16, v6 row_newbcast:8 row_mask:0xf bank_mask:0xf
v_and_b32_dpp v107, v16, v7 row_newbcast:8 row_mask:0xf bank_mask:0xf
v_mfma_f32_16x16x32_bf16 v[112:115], v[108:111], v[208:211], v[112:115]
s_xor_b32 s64, s65, 103424
s_cmpk_gt_u32 s69, 109
s_waitcnt vmcnt(6)
s_cbranch_scc1 L_d_118
s_waitcnt vmcnt(5)
L_d_118:
buffer_load_dwordx4 v[240:243], v1, s[44:47], s64 offen nt
v_and_b32_dpp v108, v16, v4 row_newbcast:12 row_mask:0xf bank_mask:0xf
v_and_b32_dpp v109, v16, v5 row_newbcast:12 row_mask:0xf bank_mask:0xf
v_and_b32_dpp v110, v16, v6 row_newbcast:12 row_mask:0xf bank_mask:0xf
v_and_b32_dpp v111, v16, v7 row_newbcast:12 row_mask:0xf bank_mask:0xf
v_mfma_f32_16x16x32_bf16 v[112:115], v[104:107], v[212:215], v[112:115]
s_cmp_eq_u32 s34, 0
s_cbranch_scc0 L_w_120
v_mov_b32 v60, 46
s_mov_b64 exec, 1
buffer_store_dword v60, off, s[36:39], s63 offset:0
s_mov_b64 exec, -1
L_w_120:
s_xor_b32 s64, s65, 39936
s_cmpk_gt_u32 s69, 110
s_waitcnt vmcnt(6)
s_cbranch_scc1 L_d_119
s_waitcnt vmcnt(5)
L_d_119:
buffer_load_dwordx4 v[244:247], v1, s[44:47], s64 offen nt
v_and_b32_dpp v104, v18, v4 row_newbcast:0 row_mask:0xf bank_mask:0xf
v_and_b32_dpp v105, v18, v5 row_newbcast:0 row_mask:0xf bank_mask:0xf
v_and_b32_dpp v106, v18, v6 row_newbcast:0 row_mask:0xf bank_mask:0xf
v_and_b32_dpp v107, v18, v7 row_newbcast:0 row_mask:0xf bank_mask:0xf
v_mfma_f32_16x16x32_bf16 v[112:115], v[108:111], v[216:219], v[112:115]
s_xor_b32 s64, s65, 105472
s_cmpk_gt_u32 s69, 111
s_waitcnt vmcnt(6)
s_cbranch_scc1 L_d_121
s_waitcnt vmcnt(5)
L_d_121:
buffer_load_dwordx4 v[248:251], v1, s[44:47], s64 offen nt
v_and_b32_dpp v108, v18, v4 row_newbcast:4 row_mask:0xf bank_mask:0xf
v_and_b32_dpp v109, v18, v5 row_newbcast:4 row_mask:0xf bank_mask:0xf
v_and_b32_dpp v110, v18, v6 row_newbcast:4 row_mask:0xf bank_mask:0xf
v_and_b32_dpp v111, v18, v7 row_newbcast:4 row_mask:0xf bank_mask:0xf
v_mfma_f32_16x16x32_bf16 v[112:115], v[104:107], v[220:223], v[112:115]
s_xor_b32 s64, s65, 135168
s_waitcnt vmcnt(5)
buffer_load_dwordx4 v[252:255], v1, s[44:47], s64 offen nt
v_and_b32_dpp v104, v18, v4 row_newbcast:8 row_mask:0xf bank_mask:0xf
v_and_b32_dpp v105, v18, v5 row_newbcast:8 row_mask:0xf bank_mask:0xf
v_and_b32_dpp v106, v18, v6 row_newbcast:8 row_mask:0xf bank_mask:0xf
v_and_b32_dpp v107, v18, v7 row_newbcast:8 row_mask:0xf bank_mask:0xf
v_mfma_f32_16x16x32_bf16 v[112:115], v[108:111], v[224:227], v[112:115]
v_and_b32_dpp v108, v18, v4 row_newbcast:12 row_mask:0xf bank_mask:0xf
v_and_b32_dpp v109, v18, v5 row_newbcast:12 row_mask:0xf bank_mask:0xf
v_and_b32_dpp v110, v18, v6 row_newbcast:12 row_mask:0xf bank_mask:0xf
v_and_b32_dpp v111, v18, v7 row_newbcast:12 row_mask:0xf bank_mask:0xf
v_mfma_f32_16x16x32_bf16 v[112:115], v[104:107], v[228:231], v[112:115]
s_xor_b32 s64, s65, 200704
s_waitcnt vmcnt(5)
buffer_load_dwordx4 v[88:91], v1, s[44:47], s64 offen nt
v_and_b32_dpp v104, v19, v4 row_newbcast:0 row_mask:0xf bank_mask:0xf
v_and_b32_dpp v105, v19, v5 row_newbcast:0 row_mask:0xf bank_mask:0xf
v_and_b32_dpp v106, v19, v6 row_newbcast:0 row_mask:0xf bank_mask:0xf
v_and_b32_dpp v107, v19, v7 row_newbcast:0 row_mask:0xf bank_mask:0xf
v_mfma_f32_16x16x32_bf16 v[112:115], v[108:111], v[232:235], v[112:115]
s_xor_b32 s64, s65, 137216
s_waitcnt vmcnt(5)
buffer_load_dwordx4 v[92:95], v1, s[44:47], s64 offen nt
v_and_b32_dpp v108, v19, v4 row_newbcast:4 row_mask:0xf bank_mask:0xf
v_and_b32_dpp v109, v19, v5 row_newbcast:4 row_mask:0xf bank_mask:0xf
v_and_b32_dpp v110, v19, v6 row_newbcast:4 row_mask:0xf bank_mask:0xf
v_and_b32_dpp v111, v19, v7 row_newbcast:4 row_mask:0xf bank_mask:0xf
v_mfma_f32_16x16x32_bf16 v[112:115], v[104:107], v[236:239], v[112:115]
s_xor_b32 s64, s65, 202752
s_waitcnt vmcnt(5)
buffer_load_dwordx4 v[132:135], v1, s[44:47], s64 offen nt
v_and_b32_dpp v104, v19, v4 row_newbcast:8 row_mask:0xf bank_mask:0xf
v_and_b32_dpp v105, v19, v5 row_newbcast:8 row_mask:0xf bank_mask:0xf
v_and_b32_dpp v106, v19, v6 row_newbcast:8 row_mask:0xf bank_mask:0xf
v_and_b32_dpp v107, v19, v7 row_newbcast:8 row_mask:0xf bank_mask:0xf
v_mfma_f32_16x16x32_bf16 v[112:115], v[108:111], v[240:243], v[112:115]
s_xor_b32 s64, s65, 136192
s_waitcnt vmcnt(5)
buffer_load_dwordx4 v[136:139], v1, s[44:47], s64 offen nt
v_and_b32_dpp v108, v19, v4 row_newbcast:12 row_mask:0xf bank_mask:0xf
v_and_b32_dpp v109, v19, v5 row_newbcast:12 row_mask:0xf bank_mask:0xf
v_and_b32_dpp v110, v19, v6 row_newbcast:12 row_mask:0xf bank_mask:0xf
v_and_b32_dpp v111, v19, v7 row_newbcast:12 row_mask:0xf bank_mask:0xf
v_mfma_f32_16x16x32_bf16 v[112:115], v[104:107], v[244:247], v[112:115]
s_xor_b32 s64, s65, 201728
s_waitcnt vmcnt(5)
buffer_load_dwordx4 v[140:143], v1, s[44:47], s64 offen nt
v_and_b32_dpp v104, v20, v4 row_newbcast:0 row_mask:0xf bank_mask:0xf
v_and_b32_dpp v105, v20, v5 row_newbcast:0 row_mask:0xf bank_mask:0xf
v_and_b32_dpp v106, v20, v6 row_newbcast:0 row_mask:0xf bank_mask:0xf
v_and_b32_dpp v107, v20, v7 row_newbcast:0 row_mask:0xf bank_mask:0xf
v_mfma_f32_16x16x32_bf16 v[112:115], v[108:111], v[248:251], v[112:115]
s_cmp_eq_u32 s34, 1
s_cbranch_scc0 L_w_122
v_mov_b32 v60, 54
s_mov_b64 exec, 1
buffer_store_dword v60, off, s[36:39], s63 offset:0
s_mov_b64 exec, -1
L_w_122:
s_xor_b32 s64, s65, 138240
s_waitcnt vmcnt(5)
buffer_load_dwordx4 v[144:147], v1, s[44:47], s64 offen nt
v_and_b32_dpp v108, v20, v4 row_newbcast:4 row_mask:0xf bank_mask:0xf
v_and_b32_dpp v109, v20, v5 row_newbcast:4 row_mask:0xf bank_mask:0xf
v_and_b32_dpp v110, v20, v6 row_newbcast:4 row_mask:0xf bank_mask:0xf
v_and_b32_dpp v111, v20, v7 row_newbcast:4 row_mask:0xf bank_mask:0xf
v_mfma_f32_16x16x32_bf16 v[112:115], v[104:107], v[252:255], v[112:115]
s_xor_b32 s64, s65, 203776
s_waitcnt vmcnt(5)
buffer_load_dwordx4 v[148:151], v1, s[44:47], s64 offen nt
v_and_b32_dpp v104, v20, v4 row_newbcast:8 row_mask:0xf bank_mask:0xf
v_and_b32_dpp v105, v20, v5 row_newbcast:8 row_mask:0xf bank_mask:0xf
v_and_b32_dpp v106, v20, v6 row_newbcast:8 row_mask:0xf bank_mask:0xf
v_and_b32_dpp v107, v20, v7 row_newbcast:8 row_mask:0xf bank_mask:0xf
v_mfma_f32_16x16x32_bf16 v[112:115], v[108:111], v[88:91], v[112:115]
s_xor_b32 s64, s65, 167936
s_waitcnt vmcnt(7)
buffer_load_dwordx4 v[152:155], v1, s[44:47], s64 offen nt
s_xor_b32 s64, s65, 233472
s_waitcnt vmcnt(7)
buffer_load_dwordx4 v[156:159], v1, s[44:47], s64 offen nt
s_cmp_lt_u32 s2, 208
s_cbranch_scc0 L_hp_123
v_lshlrev_b32 v160, 2, v0
buffer_load_dword v161, v160, s[36:39], s62 offen offset:0 sc1
L_hp_123:
s_xor_b32 s64, s65, 169984
s_waitcnt vmcnt(7)
buffer_load_dwordx4 v[176:179], v1, s[44:47], s64 offen nt
v_and_b32_dpp v108, v20, v4 row_newbcast:12 row_mask:0xf bank_mask:0xf
v_and_b32_dpp v109, v20, v5 row_newbcast:12 row_mask:0xf bank_mask:0xf
v_and_b32_dpp v110, v20, v6 row_newbcast:12 row_mask:0xf bank_mask:0xf
v_and_b32_dpp v111, v20, v7 row_newbcast:12 row_mask:0xf bank_mask:0xf
v_mfma_f32_16x16x32_bf16 v[112:115], v[104:107], v[92:95], v[112:115]
s_xor_b32 s64, s65, 235520
s_waitcnt vmcnt(7)
buffer_load_dwordx4 v[180:183], v1, s[44:47], s64 offen nt
v_and_b32_dpp v104, v21, v4 row_newbcast:0 row_mask:0xf bank_mask:0xf
v_and_b32_dpp v105, v21, v5 row_newbcast:0 row_mask:0xf bank_mask:0xf
v_and_b32_dpp v106, v21, v6 row_newbcast:0 row_mask:0xf bank_mask:0xf
v_and_b32_dpp v107, v21, v7 row_newbcast:0 row_mask:0xf bank_mask:0xf
v_mfma_f32_16x16x32_bf16 v[112:115], v[108:111], v[132:135], v[112:115]
s_xor_b32 s64, s65, 168960
s_waitcnt vmcnt(7)
buffer_load_dwordx4 v[184:187], v1, s[44:47], s64 offen nt
v_and_b32_dpp v108, v21, v4 row_newbcast:4 row_mask:0xf bank_mask:0xf
v_and_b32_dpp v109, v21, v5 row_newbcast:4 row_mask:0xf bank_mask:0xf
v_and_b32_dpp v110, v21, v6 row_newbcast:4 row_mask:0xf bank_mask:0xf
v_and_b32_dpp v111, v21, v7 row_newbcast:4 row_mask:0xf bank_mask:0xf
v_mfma_f32_16x16x32_bf16 v[112:115], v[104:107], v[136:139], v[112:115]
s_xor_b32 s64, s65, 234496
s_waitcnt vmcnt(7)
buffer_load_dwordx4 v[24:27], v1, s[44:47], s64 offen nt
v_and_b32_dpp v104, v21, v4 row_newbcast:8 row_mask:0xf bank_mask:0xf
v_and_b32_dpp v105, v21, v5 row_newbcast:8 row_mask:0xf bank_mask:0xf
v_and_b32_dpp v106, v21, v6 row_newbcast:8 row_mask:0xf bank_mask:0xf
v_and_b32_dpp v107, v21, v7 row_newbcast:8 row_mask:0xf bank_mask:0xf
v_mfma_f32_16x16x32_bf16 v[112:115], v[108:111], v[140:143], v[112:115]
s_cmp_eq_u32 s34, 2
s_cbranch_scc0 L_w_124
v_mov_b32 v60, 62
s_mov_b64 exec, 1
buffer_store_dword v60, off, s[36:39], s63 offset:0
s_mov_b64 exec, -1
L_w_124:
s_xor_b32 s64, s65, 171008
s_waitcnt vmcnt(7)
buffer_load_dwordx4 v[28:31], v1, s[44:47], s64 offen nt
v_and_b32_dpp v108, v21, v4 row_newbcast:12 row_mask:0xf bank_mask:0xf
v_and_b32_dpp v109, v21, v5 row_newbcast:12 row_mask:0xf bank_mask:0xf
v_and_b32_dpp v110, v21, v6 row_newbcast:12 row_mask:0xf bank_mask:0xf
v_and_b32_dpp v111, v21, v7 row_newbcast:12 row_mask:0xf bank_mask:0xf
v_mfma_f32_16x16x32_bf16 v[112:115], v[104:107], v[144:147], v[112:115]
s_xor_b32 s64, s65, 236544
s_waitcnt vmcnt(7)
buffer_load_dwordx4 v[32:35], v1, s[44:47], s64 offen nt
v_and_b32_dpp v104, v22, v4 row_newbcast:0 row_mask:0xf bank_mask:0xf
v_and_b32_dpp v105, v22, v5 row_newbcast:0 row_mask:0xf bank_mask:0xf
v_and_b32_dpp v106, v22, v6 row_newbcast:0 row_mask:0xf bank_mask:0xf
v_and_b32_dpp v107, v22, v7 row_newbcast:0 row_mask:0xf bank_mask:0xf
v_mfma_f32_16x16x32_bf16 v[112:115], v[108:111], v[148:151], v[112:115]
s_cmp_lt_u32 s2, 208
s_cbranch_scc0 L_nohelp
v_lshrrev_b32 v172, 3, v0
v_sub_u32 v172, 63, v172
v_and_b32 v168, 7, v0
v_lshlrev_b32 v168, 7, v168
v_bfe_u32 v162, v172, 0, 1
v_lshl_or_b32 v168, v162, 16, v168
v_bfe_u32 v162, v172, 1, 1
v_lshl_or_b32 v168, v162, 11, v168
v_bfe_u32 v162, v172, 2, 1
v_lshl_or_b32 v168, v162, 10, v168
v_bfe_u32 v162, v172, 3, 1
v_lshl_or_b32 v168, v162, 15, v168
v_bfe_u32 v162, v172, 4, 1
v_lshl_or_b32 v168, v162, 17, v168
v_bfe_u32 v162, v172, 5, 1
v_lshl_or_b32 v168, v162, 12, v168
v_lshrrev_b32 v173, 3, v0
v_sub_u32 v173, 55, v173
v_and_b32 v169, 7, v0
v_lshlrev_b32 v169, 7, v169
v_bfe_u32 v162, v173, 0, 1
v_lshl_or_b32 v169, v162, 16, v169
v_bfe_u32 v162, v173, 1, 1
v_lshl_or_b32 v169, v162, 11, v169
v_bfe_u32 v162, v173, 2, 1
v_lshl_or_b32 v169, v162, 10, v169
v_bfe_u32 v162, v173, 3, 1
v_lshl_or_b32 v169, v162, 15, v169
v_bfe_u32 v162, v173, 4, 1
v_lshl_or_b32 v169, v162, 17, v169
v_bfe_u32 v162, v173, 5, 1
v_lshl_or_b32 v169, v162, 12, v169
s_lshr_b32 s71, s2, 3
v_subrev_u32 v163, s71, v0
v_and_b32 v163, 31, v163
s_waitcnt vmcnt(6)
v_mov_b32 v162, v161
s_nop 1
v_permlane32_swap_b32 v161, v162
v_add_u32 v161, 1, v161
v_max_u32 v161, 7, v161
v_cmp_eq_u32 vcc, -1, v162
v_mov_b32 v160, 0xff
s_nop 0
v_cndmask_b32 v161, v160, v161, vcc
v_lshl_or_b32 v161, v161, 5, v163
s_nop 1
v_min_u32_dpp v161, v161, v161 quad_perm:[1,0,3,2] row_mask:0xf bank_mask:0xf
s_nop 1
v_min_u32_dpp v161, v161, v161 quad_perm:[2,3,0,1] row_mask:0xf bank_mask:0xf
s_nop 1
v_min_u32_dpp v161, v161, v161 row_ror:4 row_mask:0xf bank_mask:0xf
s_nop 1
v_min_u32_dpp v161, v161, v161 row_ror:8 row_mask:0xf bank_mask:0xf
s_nop 1
v_readlane_b32 s76, v161, 0
v_readlane_b32 s66, v161, 16
s_min_u32 s76, s76, s66
s_lshr_b32 s66, s76, 5
s_cmp_lt_u32 s66, 50
s_cbranch_scc0 L_drain
s_mov_b32 s48, s8
s_mov_b32 s49, s9
s_mov_b32 s50, 0x10000000
s_mov_b32 s51, 0x20000
s_lshr_b32 s64, s2, 3
s_add_u32 s76, s76, s64
s_and_b32 s76, s76, 31
s_lshl_b32 s67, s76, 2
s_add_u32 s67, s67, s62
s_lshl_b32 s76, s76, 3
s_and_b32 s64, s2, 7
s_or_b32 s76, s76, s64
s_and_b32 s64, s34, 1
s_lshl_b32 s64, s64, 14
s_lshr_b32 s71, s34, 1
s_lshl_b32 s71, s71, 13
s_or_b32 s64, s64, s71
s_lshl_b32 s71, s76, 10
s_xor_b32 s64, s64, s71
s_or_b32 s64, s64, 0xC0000
s_lshl_b32 s76, s76, 20
s_xor_b32 s76, s76, s64
s_add_u32 s66, s66, 11
v_xor_b32 v169, s76, v169
v_cmp_lt_u32 vcc, s66, v173
s_or_b64 exec, vcc, 1
buffer_load_dword v171, v169, s[48:51], 0 offen
s_mov_b64 exec, -1
v_xor_b32 v168, s76, v168
v_cmp_lt_u32 vcc, s66, v172
s_or_b64 exec, vcc, 1
buffer_load_dword v170, v168, s[48:51], 0 offen
s_mov_b64 exec, -1
s_mov_b64 exec, 1
buffer_store_dword v1, off, s[36:39], s67 offset:128
s_mov_b64 exec, -1
s_waitcnt vmcnt(10)
v_and_b32_dpp v108, v22, v4 row_newbcast:4 row_mask:0xf bank_mask:0xf
v_and_b32_dpp v109, v22, v5 row_newbcast:4 row_mask:0xf bank_mask:0xf
v_and_b32_dpp v110, v22, v6 row_newbcast:4 row_mask:0xf bank_mask:0xf
v_and_b32_dpp v111, v22, v7 row_newbcast:4 row_mask:0xf bank_mask:0xf
v_mfma_f32_16x16x32_bf16 v[112:115], v[104:107], v[152:155], v[112:115]
s_waitcnt vmcnt(9)
v_and_b32_dpp v104, v22, v4 row_newbcast:8 row_mask:0xf bank_mask:0xf
v_and_b32_dpp v105, v22, v5 row_newbcast:8 row_mask:0xf bank_mask:0xf
v_and_b32_dpp v106, v22, v6 row_newbcast:8 row_mask:0xf bank_mask:0xf
v_and_b32_dpp v107, v22, v7 row_newbcast:8 row_mask:0xf bank_mask:0xf
v_mfma_f32_16x16x32_bf16 v[112:115], v[108:111], v[156:159], v[112:115]
s_waitcnt vmcnt(8)
v_and_b32_dpp v108, v22, v4 row_newbcast:12 row_mask:0xf bank_mask:0xf
v_and_b32_dpp v109, v22, v5 row_newbcast:12 row_mask:0xf bank_mask:0xf
v_and_b32_dpp v110, v22, v6 row_newbcast:12 row_mask:0xf bank_mask:0xf
v_and_b32_dpp v111, v22, v7 row_newbcast:12 row_mask:0xf bank_mask:0xf
v_mfma_f32_16x16x32_bf16 v[112:115], v[104:107], v[176:179], v[112:115]
s_waitcnt vmcnt(7)
v_and_b32_dpp v104, v23, v4 row_newbcast:0 row_mask:0xf bank_mask:0xf
v_and_b32_dpp v105, v23, v5 row_newbcast:0 row_mask:0xf bank_mask:0xf
v_and_b32_dpp v106, v23, v6 row_newbcast:0 row_mask:0xf bank_mask:0xf
v_and_b32_dpp v107, v23, v7 row_newbcast:0 row_mask:0xf bank_mask:0xf
v_mfma_f32_16x16x32_bf16 v[112:115], v[108:111], v[180:183], v[112:115]
s_waitcnt vmcnt(6)
v_and_b32_dpp v108, v23, v4 row_newbcast:4 row_mask:0xf bank_mask:0xf
v_and_b32_dpp v109, v23, v5 row_newbcast:4 row_mask:0xf bank_mask:0xf
v_and_b32_dpp v110, v23, v6 row_newbcast:4 row_mask:0xf bank_mask:0xf
v_and_b32_dpp v111, v23, v7 row_newbcast:4 row_mask:0xf bank_mask:0xf
v_mfma_f32_16x16x32_bf16 v[112:115], v[104:107], v[184:187], v[112:115]
s_waitcnt vmcnt(5)
v_and_b32_dpp v104, v23, v4 row_newbcast:8 row_mask:0xf bank_mask:0xf
v_and_b32_dpp v105, v23, v5 row_newbcast:8 row_mask:0xf bank_mask:0xf
v_and_b32_dpp v106, v23, v6 row_newbcast:8 row_mask:0xf bank_mask:0xf
v_and_b32_dpp v107, v23, v7 row_newbcast:8 row_mask:0xf bank_mask:0xf
v_mfma_f32_16x16x32_bf16 v[112:115], v[108:111], v[24:27], v[112:115]
s_waitcnt vmcnt(4)
v_and_b32_dpp v108, v23, v4 row_newbcast:12 row_mask:0xf bank_mask:0xf
v_and_b32_dpp v109, v23, v5 row_newbcast:12 row_mask:0xf bank_mask:0xf
v_and_b32_dpp v110, v23, v6 row_newbcast:12 row_mask:0xf bank_mask:0xf
v_and_b32_dpp v111, v23, v7 row_newbcast:12 row_mask:0xf bank_mask:0xf
v_mfma_f32_16x16x32_bf16 v[112:115], v[104:107], v[28:31], v[112:115]
s_waitcnt vmcnt(3)
v_mfma_f32_16x16x32_bf16 v[112:115], v[108:111], v[32:35], v[112:115]
s_branch L_drained
L_nohelp:
L_drain:
s_waitcnt vmcnt(7)
v_and_b32_dpp v108, v22, v4 row_newbcast:4 row_mask:0xf bank_mask:0xf
v_and_b32_dpp v109, v22, v5 row_newbcast:4 row_mask:0xf bank_mask:0xf
v_and_b32_dpp v110, v22, v6 row_newbcast:4 row_mask:0xf bank_mask:0xf
v_and_b32_dpp v111, v22, v7 row_newbcast:4 row_mask:0xf bank_mask:0xf
v_mfma_f32_16x16x32_bf16 v[112:115], v[104:107], v[152:155], v[112:115]
s_waitcnt vmcnt(6)
v_and_b32_dpp v104, v22, v4 row_newbcast:8 row_mask:0xf bank_mask:0xf
v_and_b32_dpp v105, v22, v5 row_newbcast:8 row_mask:0xf bank_mask:0xf
v_and_b32_dpp v106, v22, v6 row_newbcast:8 row_mask:0xf bank_mask:0xf
v_and_b32_dpp v107, v22, v7 row_newbcast:8 row_mask:0xf bank_mask:0xf
v_mfma_f32_16x16x32_bf16 v[112:115], v[108:111], v[156:159], v[112:115]
s_waitcnt vmcnt(5)
v_and_b32_dpp v108, v22, v4 row_newbcast:12 row_mask:0xf bank_mask:0xf
v_and_b32_dpp v109, v22, v5 row_newbcast:12 row_mask:0xf bank_mask:0xf
v_and_b32_dpp v110, v22, v6 row_newbcast:12 row_mask:0xf bank_mask:0xf
v_and_b32_dpp v111, v22, v7 row_newbcast:12 row_mask:0xf bank_mask:0xf
v_mfma_f32_16x16x32_bf16 v[112:115], v[104:107], v[176:179], v[112:115]
s_waitcnt vmcnt(4)
v_and_b32_dpp v104, v23, v4 row_newbcast:0 row_mask:0xf bank_mask:0xf
v_and_b32_dpp v105, v23, v5 row_newbcast:0 row_mask:0xf bank_mask:0xf
v_and_b32_dpp v106, v23, v6 row_newbcast:0 row_mask:0xf bank_mask:0xf
v_and_b32_dpp v107, v23, v7 row_newbcast:0 row_mask:0xf bank_mask:0xf
v_mfma_f32_16x16x32_bf16 v[112:115], v[108:111], v[180:183], v[112:115]
s_waitcnt vmcnt(3)
v_and_b32_dpp v108, v23, v4 row_newbcast:4 row_mask:0xf bank_mask:0xf
v_and_b32_dpp v109, v23, v5 row_newbcast:4 row_mask:0xf bank_mask:0xf
v_and_b32_dpp v110, v23, v6 row_newbcast:4 row_mask:0xf bank_mask:0xf
v_and_b32_dpp v111, v23, v7 row_newbcast:4 row_mask:0xf bank_mask:0xf
v_mfma_f32_16x16x32_bf16 v[112:115], v[104:107], v[184:187], v[112:115]
s_waitcnt vmcnt(2)
v_and_b32_dpp v104, v23, v4 row_newbcast:8 row_mask:0xf bank_mask:0xf
v_and_b32_dpp v105, v23, v5 row_newbcast:8 row_mask:0xf bank_mask:0xf
v_and_b32_dpp v106, v23, v6 row_newbcast:8 row_mask:0xf bank_mask:0xf
v_and_b32_dpp v107, v23, v7 row_newbcast:8 row_mask:0xf bank_mask:0xf
v_mfma_f32_16x16x32_bf16 v[112:115], v[108:111], v[24:27], v[112:115]
s_waitcnt vmcnt(1)
v_and_b32_dpp v108, v23, v4 row_newbcast:12 row_mask:0xf bank_mask:0xf
v_and_b32_dpp v109, v23, v5 row_newbcast:12 row_mask:0xf bank_mask:0xf
v_and_b32_dpp v110, v23, v6 row_newbcast:12 row_mask:0xf bank_mask:0xf
v_and_b32_dpp v111, v23, v7 row_newbcast:12 row_mask:0xf bank_mask:0xf
v_mfma_f32_16x16x32_bf16 v[112:115], v[104:107], v[28:31], v[112:115]
s_waitcnt vmcnt(0)
v_mfma_f32_16x16x32_bf16 v[112:115], v[108:111], v[32:35], v[112:115]
L_drained:
v_and_b32 v2, 15, v0
v_lshlrev_b32 v2, 5, v2
v_and_b32 v3, 16, v0
v_add_u32 v2, v2, v3
s_lshl_b32 s68, s34, 9
v_add_u32 v2, s68, v2
s_mov_b32 exec_hi, 0
s_nop 1
ds_write_b128 v2, v[112:115] offset:512
s_mov_b32 exec_hi, -1
v_lshlrev_b32 v1, 4, v0
s_waitcnt lgkmcnt(0)
s_barrier
v_mov_b32 v2, 0
ds_read_b32 v3, v2 offset:328
s_waitcnt lgkmcnt(0)
v_readfirstlane_b32 s35, v3
s_branch L_tail_s
L_fin:
L_end:
s_endpgm
L_code_end:
.section .rodata,"a"
.p2align 6
.amdhsa_kernel adaLN_cond__sliding_block_cached__glu_gated_glu__decode_kernel
  .amdhsa_next_free_vgpr 256
  .amdhsa_next_free_sgpr 102
  .amdhsa_accum_offset 256
  .amdhsa_group_segment_fixed_size 0
  .amdhsa_kernarg_size 112
  .amdhsa_user_sgpr_count 2
  .amdhsa_user_sgpr_kernarg_segment_ptr 1
  .amdhsa_system_sgpr_workgroup_id_x 1
  .amdhsa_float_denorm_mode_32 3
.end_amdhsa_kernel
```

```asm
; @launch grid=(256,1,1) block=(512,1,1) lds=131072
.amdgcn_target "amdgcn-amd-amdhsa--gfx950"
.text
.globl adaLN_cond__sliding_block_cached__glu_gated_glu__decode_kernel
.p2align 8
.type adaLN_cond__sliding_block_cached__glu_gated_glu__decode_kernel,@function
adaLN_cond__sliding_block_cached__glu_gated_glu__decode_kernel:
L_code_begin:
s_load_dwordx16 s[4:19], s[0:1], 0
s_load_dwordx8 s[20:27], s[0:1], 64
s_load_dwordx4 s[28:31], s[0:1], 96
s_cmpk_ge_u32 s2, 256
s_cbranch_scc1 L_end
v_lshrrev_b32 v1, 6, v0
v_and_b32 v0, 63, v0
v_readfirstlane_b32 s3, v1
v_lshlrev_b32 v1, 4, v0
s_lshl_b32 s64, s2, 20
s_add_u32 s64, s64, 0xC0000
s_mov_b32 s42, 0x40000
s_mov_b32 s43, 0x20000
s_and_b32 s34, s3, 3
s_cmp_ge_u32 s3, 4
s_cbranch_scc1 L_helper
s_and_b32 s65, s34, 1
s_lshl_b32 s65, s65, 14
s_lshr_b32 s66, s34, 1
s_lshl_b32 s66, s66, 13
s_or_b32 s65, s65, s66
s_lshl_b32 s66, s2, 10
s_xor_b32 s65, s65, s66
s_waitcnt lgkmcnt(0)
s_add_u32 s40, s6, s64
s_addc_u32 s41, s7, 0
s_add_u32 s44, s8, s64
s_addc_u32 s45, s9, 0
buffer_load_dwordx4 v[8:11], v1, s[40:43], s65 offen nt
s_xor_b32 s64, s65, 65536
buffer_load_dwordx4 v[12:15], v1, s[40:43], s64 offen nt
s_xor_b32 s64, s65, 2048
buffer_load_dwordx4 v[16:19], v1, s[40:43], s64 offen nt
s_xor_b32 s64, s65, 67584
buffer_load_dwordx4 v[20:23], v1, s[40:43], s64 offen nt
s_barrier
s_branch L_srest
L_helper:
s_setprio 2
v_lshlrev_b32 v2, 2, v0
s_cmp_eq_u32 s3, 7
s_cbranch_scc0 L_nopf
s_getpc_b64 s[60:61]
L_pc:
s_lshr_b32 s66, s2, 3
s_lshl_b32 s66, s66, 10
v_add_u32 v10, s66, v1
v_min_u32 v10, L_code_end-L_pc-16, v10
global_load_dwordx4 v[12:15], v10, s[60:61]
v_subrev_u32 v3, 16, v0
v_ashrrev_i32 v3, 31, v3
ds_write_b32 v2, v3 offset:256
L_nopf:
s_and_b32 s67, s2, 7
s_lshr_b32 s68, s2, 3
v_and_b32 v38, 7, v0
v_lshrrev_b32 v37, 3, v0
s_cmp_eq_u32 s34, 0
s_cbranch_scc0 L_p0a
s_mov_b32 s70, 6
s_lshl_b32 s67, s67, 1
s_add_u32 s66, s67, 14
v_min_u32 v38, 5, v38
v_cmp_lt_u32 vcc, 1, v38
v_add_u32 v36, s66, v38
s_nop 0
v_cndmask_b32 v38, v38, v36, vcc
s_branch L_p0b
L_p0a:
s_lshl_b32 s67, s67, 3
s_lshl_b32 s65, s2, 3
s_and_b32 s65, s65, 0xff
s_lshr_b32 s66, s2, 5
s_or_b32 s65, s65, s66
s_cmp_eq_u32 s34, 2
s_cselect_b32 s70, 1, 8
s_cselect_b32 s68, s65, s68
s_cselect_b32 s67, 0, s67
L_p0b:
v_lshl_add_u32 v37, s68, 4, v37
v_mul_u32_u24 v37, s70, v37
v_lshl_add_u32 v38, v37, 3, v38
v_add_lshl_u32 v38, v38, s67, 7
s_lshl_b32 s70, s70, 13
v_add_u32 v39, s70, v38
s_sub_u32 s64, s2, 112
s_cmp_lt_u32 s64, 32
s_waitcnt lgkmcnt(0)
s_barrier
s_cbranch_scc1 L_jan
s_cmp_eq_u32 s34, 3
s_cbranch_scc1 L_p0_125
s_cmp_eq_u32 s34, 0
s_cselect_b32 s62, s24, s10
s_cselect_b32 s63, s25, s11
s_cmp_eq_u32 s34, 2
s_cselect_b32 s62, s12, s62
s_cselect_b32 s63, s13, s63
global_load_dword v12, v38, s[62:63]
global_load_dword v13, v39, s[62:63]
L_p0_125:
L_nop0:
s_cmp_eq_u32 s34, 3
s_cselect_b32 s64, 16, 0
s_cmp_lt_u32 s2, s64
s_cbranch_scc0 L_nopc
v_mov_b32 v4, -1
v_mov_b32 v5, -1
v_mov_b32 v6, -1
v_mov_b32 v7, -1
s_and_b32 s66, s2, 7
s_lshl_b32 s66, s66, 11
s_and_b32 s65, s2, 8
s_lshl_b32 s65, s65, 7
s_add_u32 s66, s66, s65
v_add_u32 v8, s66, v1
global_store_dwordx4 v8, v[4:7], s[30:31] sc1
s_lshl_b32 s66, s2, 2
v_mov_b32 v3, s66
s_waitcnt vmcnt(0)
s_mov_b64 exec, 1
global_store_dword v3, v4, s[28:29] sc1
s_mov_b64 exec, -1
L_nopc:
s_cmp_eq_u32 s34, 3
s_cbranch_scc0 L_w_126
s_and_b32 s67, s2, 7
s_lshr_b32 s68, s2, 3
s_min_u32 s64, s67, 3
s_mul_i32 s65, s67, 5
s_add_u32 s64, s64, s65
s_cmp_lt_u32 s67, 3
s_cselect_b32 s65, 6, 5
L_w_126:
s_lshr_b32 s32, s2, 5
s_and_b32 s33, s2, 31
s_and_b32 s67, s2, 7
s_lshr_b32 s68, s2, 3
s_sub_u32 s68, s68, 26
s_min_u32 s74, s67, 3
s_mul_i32 s66, s67, 5
s_add_u32 s74, s74, s66
s_add_u32 s74, s74, s68
s_cmp_lt_u32 s67, 3
s_cselect_b32 s66, 6, 5
s_cmp_lt_u32 s68, s66
s_cselect_b32 s74, s74, -1
s_cmp_lt_u32 s2, 48
s_cselect_b32 s66, 2, 3
s_cselect_b32 s72, 14+26, 42+26
s_cmp_lt_u32 s2, 16
s_cselect_b32 s66, 1, s66
s_cselect_b32 s72, 26, s72
s_lshl_b32 s66, s67, s66
s_add_u32 s72, s72, s66
s_add_u32 s72, s72, s68
s_mov_b32 s36, s30
s_mov_b32 s37, s31
s_mov_b32 s38, 0x1d0000
s_mov_b32 s39, 0x20000
s_mov_b32 s52, s28
s_mov_b32 s53, s29
s_mov_b32 s54, 0x100
s_mov_b32 s55, 0x20000
v_mov_b32 v9, 1
s_cmp_lt_u32 s2, 112
s_cbranch_scc0 L_norole
L_gemm:
v_and_b32 v16, 7, v0
v_lshlrev_b32 v16, 10, v16
v_and_b32 v17, 8, v0
v_lshl_add_u32 v16, v17, 3, v16
v_and_b32 v17, 48, v0
v_add_u32 v16, v16, v17
s_lshl_b32 s67, s34, 8
v_lshrrev_b32 v19, 3, v0
v_and_b32 v17, 2, v19
v_and_b32 v18, 7, v0
v_xor_b32 v17, v17, v18
v_xor_b32 v18, 4, v17
v_lshlrev_b32 v17, 4, v17
v_lshlrev_b32 v18, 4, v18
s_cmp_lt_u32 s2, 48
s_cbranch_scc0 L_gq0
s_mov_b32 s40, s24
s_mov_b32 s41, s25
s_mov_b32 s42, 0x300000
s_mov_b32 s43, 0x20000
s_mov_b32 s48, s22
s_mov_b32 s49, s23
s_mov_b32 s50, 0x2000
s_mov_b32 s51, 0x20000
s_mov_b32 s70, 6144
s_lshl_b32 s64, s72, 7
s_branch L_g1
L_gq0:
s_mov_b32 s40, s10
s_mov_b32 s41, s11
s_mov_b32 s42, 0x400000
s_mov_b32 s43, 0x20000
s_mov_b32 s48, s4
s_mov_b32 s49, s5
s_mov_b32 s50, 0x2000
s_mov_b32 s51, 0x20000
s_mov_b32 s70, 8192
s_sub_u32 s64, s72, 48
s_lshl_b32 s64, s64, 7
L_g1:
buffer_load_dwordx4 v[192:195], v16, s[48:51], s67 offen offset:0
buffer_load_dwordx4 v[196:199], v16, s[48:51], s67 offen offset:128
v_mul_lo_u32 v19, s70, v19
v_add_u32 v17, v17, v19
v_add_u32 v18, v18, v19
s_lshl_b32 s66, s70, 7
s_mul_i32 s66, s66, s34
s_add_u32 s64, s64, s66
s_lshl_b32 s70, s70, 3
s_lshl_b32 s65, s34, 13
s_add_u32 s65, s65, 4096
s_cmp_lt_u32 s2, 16
s_cselect_b32 s71, 0, 2
s_cmp_ge_u32 s2, 48
s_cselect_b32 s71, 1, s71
s_add_u32 m0, s65, 0
s_nop 0
buffer_load_dwordx4 v17, s[40:43], s64 offen  lds
s_add_u32 s64, s64, s70
s_add_u32 m0, s65, 1024
s_nop 0
buffer_load_dwordx4 v18, s[40:43], s64 offen  lds
s_add_u32 s64, s64, s70
s_cmp_eq_u32 s71, 2
s_cbranch_scc0 L_pace_127
s_waitcnt vmcnt(1)
L_pace_127:
s_add_u32 m0, s65, 2048
s_nop 0
buffer_load_dwordx4 v17, s[40:43], s64 offen  lds
s_add_u32 s64, s64, s70
s_cmp_eq_u32 s71, 0
s_cbranch_scc1 L_pace_128
s_waitcnt vmcnt(2)
s_cmp_eq_u32 s71, 2
s_cbranch_scc0 L_pace_128
s_waitcnt vmcnt(1)
L_pace_128:
s_add_u32 m0, s65, 3072
s_nop 0
buffer_load_dwordx4 v18, s[40:43], s64 offen  lds
s_add_u32 s64, s64, s70
s_cmp_eq_u32 s71, 0
s_cbranch_scc1 L_pace_129
s_waitcnt vmcnt(2)
s_cmp_eq_u32 s71, 2
s_cbranch_scc0 L_pace_129
s_waitcnt vmcnt(1)
L_pace_129:
s_add_u32 m0, s65, 4096
s_nop 0
buffer_load_dwordx4 v17, s[40:43], s64 offen  lds
s_add_u32 s64, s64, s70
s_cmp_eq_u32 s71, 0
s_cbranch_scc1 L_pace_130
s_waitcnt vmcnt(2)
s_cmp_eq_u32 s71, 2
s_cbranch_scc0 L_pace_130
s_waitcnt vmcnt(1)
L_pace_130:
s_add_u32 m0, s65, 5120
s_nop 0
buffer_load_dwordx4 v18, s[40:43], s64 offen  lds
s_add_u32 s64, s64, s70
s_cmp_eq_u32 s71, 0
s_cbranch_scc1 L_pace_131
s_waitcnt vmcnt(2)
s_cmp_eq_u32 s71, 2
s_cbranch_scc0 L_pace_131
s_waitcnt vmcnt(1)
L_pace_131:
s_add_u32 m0, s65, 6144
s_nop 0
buffer_load_dwordx4 v17, s[40:43], s64 offen  lds
s_add_u32 s64, s64, s70
s_cmp_eq_u32 s71, 0
s_cbranch_scc1 L_pace_132
s_waitcnt vmcnt(2)
s_cmp_eq_u32 s71, 2
s_cbranch_scc0 L_pace_132
s_waitcnt vmcnt(1)
L_pace_132:
s_add_u32 m0, s65, 7168
s_nop 0
buffer_load_dwordx4 v18, s[40:43], s64 offen  lds
s_add_u32 s64, s64, s70
s_cmp_eq_u32 s71, 0
s_cbranch_scc1 L_pace_133
s_waitcnt vmcnt(2)
s_cmp_eq_u32 s71, 2
s_cbranch_scc0 L_pace_133
s_waitcnt vmcnt(1)
L_pace_133:
s_add_u32 m0, s65, 32768
s_nop 0
buffer_load_dwordx4 v17, s[40:43], s64 offen  lds
s_add_u32 s64, s64, s70
s_cmp_eq_u32 s71, 0
s_cbranch_scc1 L_pace_134
s_waitcnt vmcnt(2)
s_cmp_eq_u32 s71, 2
s_cbranch_scc0 L_pace_134
s_waitcnt vmcnt(1)
L_pace_134:
s_add_u32 m0, s65, 33792
s_nop 0
buffer_load_dwordx4 v18, s[40:43], s64 offen  lds
s_add_u32 s64, s64, s70
s_cmp_eq_u32 s71, 0
s_cbranch_scc1 L_pace_135
s_waitcnt vmcnt(2)
s_cmp_eq_u32 s71, 2
s_cbranch_scc0 L_pace_135
s_waitcnt vmcnt(1)
L_pace_135:
s_add_u32 m0, s65, 34816
s_nop 0
buffer_load_dwordx4 v17, s[40:43], s64 offen  lds
s_add_u32 s64, s64, s70
s_cmp_eq_u32 s71, 0
s_cbranch_scc1 L_pace_136
s_waitcnt vmcnt(2)
s_cmp_eq_u32 s71, 2
s_cbranch_scc0 L_pace_136
s_waitcnt vmcnt(1)
L_pace_136:
s_add_u32 m0, s65, 35840
s_nop 0
buffer_load_dwordx4 v18, s[40:43], s64 offen  lds
s_add_u32 s64, s64, s70
s_cmp_eq_u32 s71, 0
s_cbranch_scc1 L_pace_137
s_waitcnt vmcnt(2)
s_cmp_eq_u32 s71, 2
s_cbranch_scc0 L_pace_137
s_waitcnt vmcnt(1)
L_pace_137:
s_add_u32 m0, s65, 36864
s_nop 0
buffer_load_dwordx4 v17, s[40:43], s64 offen  lds
s_add_u32 s64, s64, s70
s_cmp_eq_u32 s71, 0
s_cbranch_scc1 L_pace_138
s_waitcnt vmcnt(2)
s_cmp_eq_u32 s71, 2
s_cbranch_scc0 L_pace_138
s_waitcnt vmcnt(1)
L_pace_138:
s_add_u32 m0, s65, 37888
s_nop 0
buffer_load_dwordx4 v18, s[40:43], s64 offen  lds
s_add_u32 s64, s64, s70
s_cmp_eq_u32 s71, 0
s_cbranch_scc1 L_pace_139
s_waitcnt vmcnt(2)
s_cmp_eq_u32 s71, 2
s_cbranch_scc0 L_pace_139
s_waitcnt vmcnt(1)
L_pace_139:
s_add_u32 m0, s65, 38912
s_nop 0
buffer_load_dwordx4 v17, s[40:43], s64 offen  lds
s_add_u32 s64, s64, s70
s_cmp_eq_u32 s71, 0
s_cbranch_scc1 L_pace_140
s_waitcnt vmcnt(2)
s_cmp_eq_u32 s71, 2
s_cbranch_scc0 L_pace_140
s_waitcnt vmcnt(1)
L_pace_140:
s_add_u32 m0, s65, 39936
s_nop 0
buffer_load_dwordx4 v18, s[40:43], s64 offen  lds
s_add_u32 s64, s64, s70
s_waitcnt vmcnt(16)
s_cmp_eq_u32 s34, 0
s_cselect_b32 s73, 48, 0x1000
v_and_b32 v30, 15, v0
v_lshlrev_b32 v30, 2, v30
s_cmp_ge_u32 s2, s73
s_cbranch_scc0 L_fl_141
buffer_load_dword v31, v30, s[52:55], 0 offen sc1
L_fl_141:
s_mov_b32 s68, 0xffff0000
s_cmp_lt_u32 s2, 48
s_cbranch_scc0 L_gq1
s_mov_b32 s66, 0xbfb8aa3b
v_lshlrev_b32 v20, 16, v192
v_and_b32 v21, s68, v192
v_mul_f32 v22, s66, v20
v_mul_f32 v23, s66, v21
v_exp_f32 v22, v22
v_exp_f32 v23, v23
s_nop 0
v_add_f32 v22, 1.0, v22
v_add_f32 v23, 1.0, v23
v_rcp_f32 v22, v22
v_rcp_f32 v23, v23
s_nop 0
v_mul_f32 v20, v20, v22
v_mul_f32 v21, v21, v23
v_cvt_pk_bf16_f32 v48, v20, v21
v_lshlrev_b32 v20, 16, v193
v_and_b32 v21, s68, v193
v_mul_f32 v22, s66, v20
v_mul_f32 v23, s66, v21
v_exp_f32 v22, v22
v_exp_f32 v23, v23
s_nop 0
v_add_f32 v22, 1.0, v22
v_add_f32 v23, 1.0, v23
v_rcp_f32 v22, v22
v_rcp_f32 v23, v23
s_nop 0
v_mul_f32 v20, v20, v22
v_mul_f32 v21, v21, v23
v_cvt_pk_bf16_f32 v49, v20, v21
v_lshlrev_b32 v20, 16, v194
v_and_b32 v21, s68, v194
v_mul_f32 v22, s66, v20
v_mul_f32 v23, s66, v21
v_exp_f32 v22, v22
v_exp_f32 v23, v23
s_nop 0
v_add_f32 v22, 1.0, v22
v_add_f32 v23, 1.0, v23
v_rcp_f32 v22, v22
v_rcp_f32 v23, v23
s_nop 0
v_mul_f32 v20, v20, v22
v_mul_f32 v21, v21, v23
v_cvt_pk_bf16_f32 v50, v20, v21
v_lshlrev_b32 v20, 16, v195
v_and_b32 v21, s68, v195
v_mul_f32 v22, s66, v20
v_mul_f32 v23, s66, v21
v_exp_f32 v22, v22
v_exp_f32 v23, v23
s_nop 0
v_add_f32 v22, 1.0, v22
v_add_f32 v23, 1.0, v23
v_rcp_f32 v22, v22
v_rcp_f32 v23, v23
s_nop 0
v_mul_f32 v20, v20, v22
v_mul_f32 v21, v21, v23
v_cvt_pk_bf16_f32 v51, v20, v21
v_lshlrev_b32 v20, 16, v196
v_and_b32 v21, s68, v196
v_mul_f32 v22, s66, v20
v_mul_f32 v23, s66, v21
v_exp_f32 v22, v22
v_exp_f32 v23, v23
s_nop 0
v_add_f32 v22, 1.0, v22
v_add_f32 v23, 1.0, v23
v_rcp_f32 v22, v22
v_rcp_f32 v23, v23
s_nop 0
v_mul_f32 v20, v20, v22
v_mul_f32 v21, v21, v23
v_cvt_pk_bf16_f32 v52, v20, v21
v_lshlrev_b32 v20, 16, v197
v_and_b32 v21, s68, v197
v_mul_f32 v22, s66, v20
v_mul_f32 v23, s66, v21
v_exp_f32 v22, v22
v_exp_f32 v23, v23
s_nop 0
v_add_f32 v22, 1.0, v22
v_add_f32 v23, 1.0, v23
v_rcp_f32 v22, v22
v_rcp_f32 v23, v23
s_nop 0
v_mul_f32 v20, v20, v22
v_mul_f32 v21, v21, v23
v_cvt_pk_bf16_f32 v53, v20, v21
v_lshlrev_b32 v20, 16, v198
v_and_b32 v21, s68, v198
v_mul_f32 v22, s66, v20
v_mul_f32 v23, s66, v21
v_exp_f32 v22, v22
v_exp_f32 v23, v23
s_nop 0
v_add_f32 v22, 1.0, v22
v_add_f32 v23, 1.0, v23
v_rcp_f32 v22, v22
v_rcp_f32 v23, v23
s_nop 0
v_mul_f32 v20, v20, v22
v_mul_f32 v21, v21, v23
v_cvt_pk_bf16_f32 v54, v20, v21
v_lshlrev_b32 v20, 16, v199
v_and_b32 v21, s68, v199
v_mul_f32 v22, s66, v20
v_mul_f32 v23, s66, v21
v_exp_f32 v22, v22
v_exp_f32 v23, v23
s_nop 0
v_add_f32 v22, 1.0, v22
v_add_f32 v23, 1.0, v23
v_rcp_f32 v22, v22
v_rcp_f32 v23, v23
s_nop 0
v_mul_f32 v20, v20, v22
v_mul_f32 v21, v21, v23
v_cvt_pk_bf16_f32 v55, v20, v21
s_branch L_g2
L_gq1:
v_and_b32 v32, 7, v0
v_lshlrev_b32 v32, 2, v32
v_lshlrev_b32 v96, 16, v192
v_and_b32 v97, s68, v192
v_lshlrev_b32 v98, 16, v193
v_and_b32 v99, s68, v193
v_lshlrev_b32 v100, 16, v194
v_and_b32 v101, s68, v194
v_lshlrev_b32 v102, 16, v195
v_and_b32 v103, s68, v195
v_lshlrev_b32 v104, 16, v196
v_and_b32 v105, s68, v196
v_lshlrev_b32 v106, 16, v197
v_and_b32 v107, s68, v197
v_lshlrev_b32 v108, 16, v198
v_and_b32 v109, s68, v198
v_lshlrev_b32 v110, 16, v199
v_and_b32 v111, s68, v199
v_add_f32 v20, v96, v97
v_add_f32 v20, v20, v98
v_add_f32 v20, v20, v99
v_add_f32 v20, v20, v100
v_add_f32 v20, v20, v101
v_add_f32 v20, v20, v102
v_add_f32 v20, v20, v103
v_add_f32 v20, v20, v104
v_add_f32 v20, v20, v105
v_add_f32 v20, v20, v106
v_add_f32 v20, v20, v107
v_add_f32 v20, v20, v108
v_add_f32 v20, v20, v109
v_add_f32 v20, v20, v110
v_add_f32 v20, v20, v111
s_nop 1
v_add_f32_dpp v20, v20, v20 row_ror:8 row_mask:0xf bank_mask:0xf
v_mov_b32 v22, v20
s_nop 1
v_permlane16_swap_b32 v20, v22
s_nop 1
v_add_f32 v20, v20, v22
v_mov_b32 v22, v20
s_nop 1
v_permlane32_swap_b32 v20, v22
s_nop 1
v_add_f32 v20, v20, v22
v_mul_f32 v20, 0x3c000000, v20
v_mov_b32 v21, 0
v_sub_f32 v22, v96, v20
v_fmac_f32 v21, v22, v22
v_sub_f32 v22, v97, v20
v_fmac_f32 v21, v22, v22
v_sub_f32 v22, v98, v20
v_fmac_f32 v21, v22, v22
v_sub_f32 v22, v99, v20
v_fmac_f32 v21, v22, v22
v_sub_f32 v22, v100, v20
v_fmac_f32 v21, v22, v22
v_sub_f32 v22, v101, v20
v_fmac_f32 v21, v22, v22
v_sub_f32 v22, v102, v20
v_fmac_f32 v21, v22, v22
v_sub_f32 v22, v103, v20
v_fmac_f32 v21, v22, v22
v_sub_f32 v22, v104, v20
v_fmac_f32 v21, v22, v22
v_sub_f32 v22, v105, v20
v_fmac_f32 v21, v22, v22
v_sub_f32 v22, v106, v20
v_fmac_f32 v21, v22, v22
v_sub_f32 v22, v107, v20
v_fmac_f32 v21, v22, v22
v_sub_f32 v22, v108, v20
v_fmac_f32 v21, v22, v22
v_sub_f32 v22, v109, v20
v_fmac_f32 v21, v22, v22
v_sub_f32 v22, v110, v20
v_fmac_f32 v21, v22, v22
v_sub_f32 v22, v111, v20
v_fmac_f32 v21, v22, v22
s_nop 1
v_add_f32_dpp v21, v21, v21 row_ror:8 row_mask:0xf bank_mask:0xf
v_mov_b32 v22, v21
s_nop 1
v_permlane16_swap_b32 v21, v22
s_nop 1
v_add_f32 v21, v21, v22
v_mov_b32 v22, v21
s_nop 1
v_permlane32_swap_b32 v21, v22
s_nop 1
v_add_f32 v21, v21, v22
v_lshlrev_b32 v22, 1, v32
s_lshl_b32 s66, s34, 6
v_add_u32 v23, s66, v22
ds_write_b64 v23, v[20:21] offset:0
v_mov_b32 v23, 0
s_waitcnt lgkmcnt(0)
s_mov_b64 exec, 1
ds_add_u32 v23, v9 offset:332
s_mov_b64 exec, -1
s_mov_b32 s75, 0
L_poll_142:
ds_read_b32 v24, v23 offset:332
s_waitcnt lgkmcnt(0)
v_cmp_gt_u32 vcc, 4, v24
s_cbranch_vccz L_pollx_143
s_add_u32 s75, s75, 1
s_cmp_lt_u32 s75, 0x1000000
s_cbranch_scc1 L_poll_142
L_pollx_143:
ds_read_b64 v[112:113], v22 offset:0
ds_read_b64 v[114:115], v22 offset:64
ds_read_b64 v[116:117], v22 offset:128
ds_read_b64 v[118:119], v22 offset:192
s_waitcnt lgkmcnt(0)
v_add_f32 v20, v112, v114
v_add_f32 v21, v116, v118
v_add_f32 v20, v20, v21
v_mul_f32 v20, 0x3e800000, v20
v_add_f32 v24, v113, v115
v_add_f32 v21, v117, v119
v_add_f32 v24, v24, v21
v_mov_b32 v21, 0
v_sub_f32 v22, v112, v20
v_fmac_f32 v21, v22, v22
v_sub_f32 v22, v114, v20
v_fmac_f32 v21, v22, v22
v_sub_f32 v22, v116, v20
v_fmac_f32 v21, v22, v22
v_sub_f32 v22, v118, v20
v_fmac_f32 v21, v22, v22
v_fmac_f32 v24, 0x43000000, v21
v_mul_f32 v24, 0x3b000000, v24
v_cvt_pk_bf16_f32 v24, 0, v24
v_cvt_pk_bf16_f32 v20, 0, v20
v_add_f32 v24, 0x3727c5ac, v24
v_cvt_pk_bf16_f32 v24, 0, v24
v_sqrt_f32 v24, v24
s_nop 0
v_cvt_pk_bf16_f32 v24, 0, v24
v_rcp_f32 v24, v24
s_nop 0
v_sub_f32 v96, v96, v20
v_cvt_pk_bf16_f32 v96, 0, v96
v_mul_f32 v96, v96, v24
v_cvt_pk_bf16_f32 v96, 0, v96
v_sub_f32 v97, v97, v20
v_cvt_pk_bf16_f32 v97, 0, v97
v_mul_f32 v97, v97, v24
v_cvt_pk_bf16_f32 v97, 0, v97
v_sub_f32 v98, v98, v20
v_cvt_pk_bf16_f32 v98, 0, v98
v_mul_f32 v98, v98, v24
v_cvt_pk_bf16_f32 v98, 0, v98
v_sub_f32 v99, v99, v20
v_cvt_pk_bf16_f32 v99, 0, v99
v_mul_f32 v99, v99, v24
v_cvt_pk_bf16_f32 v99, 0, v99
v_sub_f32 v100, v100, v20
v_cvt_pk_bf16_f32 v100, 0, v100
v_mul_f32 v100, v100, v24
v_cvt_pk_bf16_f32 v100, 0, v100
v_sub_f32 v101, v101, v20
v_cvt_pk_bf16_f32 v101, 0, v101
v_mul_f32 v101, v101, v24
v_cvt_pk_bf16_f32 v101, 0, v101
v_sub_f32 v102, v102, v20
v_cvt_pk_bf16_f32 v102, 0, v102
v_mul_f32 v102, v102, v24
v_cvt_pk_bf16_f32 v102, 0, v102
v_sub_f32 v103, v103, v20
v_cvt_pk_bf16_f32 v103, 0, v103
v_mul_f32 v103, v103, v24
v_cvt_pk_bf16_f32 v103, 0, v103
v_sub_f32 v104, v104, v20
v_cvt_pk_bf16_f32 v104, 0, v104
v_mul_f32 v104, v104, v24
v_cvt_pk_bf16_f32 v104, 0, v104
v_sub_f32 v105, v105, v20
v_cvt_pk_bf16_f32 v105, 0, v105
v_mul_f32 v105, v105, v24
v_cvt_pk_bf16_f32 v105, 0, v105
v_sub_f32 v106, v106, v20
v_cvt_pk_bf16_f32 v106, 0, v106
v_mul_f32 v106, v106, v24
v_cvt_pk_bf16_f32 v106, 0, v106
v_sub_f32 v107, v107, v20
v_cvt_pk_bf16_f32 v107, 0, v107
v_mul_f32 v107, v107, v24
v_cvt_pk_bf16_f32 v107, 0, v107
v_sub_f32 v108, v108, v20
v_cvt_pk_bf16_f32 v108, 0, v108
v_mul_f32 v108, v108, v24
v_cvt_pk_bf16_f32 v108, 0, v108
v_sub_f32 v109, v109, v20
v_cvt_pk_bf16_f32 v109, 0, v109
v_mul_f32 v109, v109, v24
v_cvt_pk_bf16_f32 v109, 0, v109
v_sub_f32 v110, v110, v20
v_cvt_pk_bf16_f32 v110, 0, v110
v_mul_f32 v110, v110, v24
v_cvt_pk_bf16_f32 v110, 0, v110
v_sub_f32 v111, v111, v20
v_cvt_pk_bf16_f32 v111, 0, v111
v_mul_f32 v111, v111, v24
v_cvt_pk_bf16_f32 v111, 0, v111
L_g2:
s_cmp_ge_u32 s2, s73
s_cbranch_scc0 L_fl_144
s_waitcnt vmcnt(0)
v_cmp_eq_u32 vcc, 0, v31
s_cbranch_vccz L_fl_144
s_mov_b32 s75, 0
L_poll_145:
buffer_load_dword v31, v30, s[52:55], 0 offen sc1
s_waitcnt vmcnt(0)
v_cmp_eq_u32 vcc, 0, v31
s_cbranch_vccz L_pollx_146
s_sleep 40
s_add_u32 s75, s75, 1
s_cmp_lt_u32 s75, 0x100000
s_cbranch_scc1 L_poll_145
L_pollx_146:
L_fl_144:
v_mov_b32 v20, 0
s_cmp_eq_u32 s34, 0
s_cbranch_scc0 L_w_147
ds_write_b32 v20, v9 offset:324
L_w_147:
v_lshrrev_b32 v18, 4, v0
v_bfe_u32 v19, v0, 2, 2
v_lshrrev_b32 v20, 1, v19
v_and_b32 v21, 1, v18
v_lshl_add_u32 v20, v21, 1, v20
v_lshlrev_b32 v20, 5, v20
v_lshl_add_u32 v20, v18, 10, v20
v_lshl_add_u32 v20, v19, 7, v20
v_and_b32 v21, 3, v0
v_lshl_add_u32 v20, v21, 3, v20
v_add_u32 v40, s65, v20
v_xor_b32 v41, 32, v40
v_xor_b32 v42, 64, v40
v_xor_b32 v43, 96, v40
s_waitcnt vmcnt(12) lgkmcnt(0)
ds_read_b64_tr_b16 v[128:129], v40 offset:0
ds_read_b64_tr_b16 v[130:131], v40 offset:512
ds_read_b64_tr_b16 v[132:133], v41 offset:0
ds_read_b64_tr_b16 v[134:135], v41 offset:512
ds_read_b64_tr_b16 v[136:137], v42 offset:0
ds_read_b64_tr_b16 v[138:139], v42 offset:512
ds_read_b64_tr_b16 v[140:141], v43 offset:0
ds_read_b64_tr_b16 v[142:143], v43 offset:512
s_waitcnt vmcnt(8) lgkmcnt(0)
ds_read_b64_tr_b16 v[144:145], v40 offset:4096
ds_read_b64_tr_b16 v[146:147], v40 offset:4608
ds_read_b64_tr_b16 v[148:149], v41 offset:4096
ds_read_b64_tr_b16 v[150:151], v41 offset:4608
ds_read_b64_tr_b16 v[152:153], v42 offset:4096
ds_read_b64_tr_b16 v[154:155], v42 offset:4608
ds_read_b64_tr_b16 v[156:157], v43 offset:4096
ds_read_b64_tr_b16 v[158:159], v43 offset:4608
s_waitcnt vmcnt(4) lgkmcnt(0)
ds_read_b64_tr_b16 v[160:161], v40 offset:32768
ds_read_b64_tr_b16 v[162:163], v40 offset:33280
ds_read_b64_tr_b16 v[164:165], v41 offset:32768
ds_read_b64_tr_b16 v[166:167], v41 offset:33280
ds_read_b64_tr_b16 v[168:169], v42 offset:32768
ds_read_b64_tr_b16 v[170:171], v42 offset:33280
ds_read_b64_tr_b16 v[172:173], v43 offset:32768
ds_read_b64_tr_b16 v[174:175], v43 offset:33280
s_waitcnt vmcnt(0) lgkmcnt(0)
ds_read_b64_tr_b16 v[176:177], v40 offset:36864
ds_read_b64_tr_b16 v[178:179], v40 offset:37376
ds_read_b64_tr_b16 v[180:181], v41 offset:36864
ds_read_b64_tr_b16 v[182:183], v41 offset:37376
ds_read_b64_tr_b16 v[184:185], v42 offset:36864
ds_read_b64_tr_b16 v[186:187], v42 offset:37376
ds_read_b64_tr_b16 v[188:189], v43 offset:36864
ds_read_b64_tr_b16 v[190:191], v43 offset:37376
s_waitcnt lgkmcnt(0)
s_cmp_eq_u32 s34, 2
s_cselect_b32 s73, 16, 0x1000
v_and_b32 v30, 31, v0
v_lshlrev_b32 v30, 2, v30
s_cmp_ge_u32 s2, s73
s_cbranch_scc0 L_fl_148
buffer_load_dword v31, v30, s[52:55], 0 offen offset:128 sc1
L_fl_148:
s_cmp_lt_u32 s2, 48
s_cbranch_scc1 L_g3
v_mov_b32 v20, 0
s_mov_b32 s75, 0
L_poll_149:
ds_read_b32 v22, v20 offset:324
s_waitcnt lgkmcnt(0)
v_cmp_eq_u32 vcc, 0, v22
s_cbranch_vccz L_pollx_150
s_sleep 1
s_add_u32 s75, s75, 1
s_cmp_lt_u32 s75, 0x1000000
s_cbranch_scc1 L_poll_149
L_pollx_150:
s_lshl_b32 s64, s34, 11
s_add_u32 s64, s64, 0
s_add_u32 s66, s64, 8192
s_mov_b32 s75, 0
L_poll_151:
buffer_load_dwordx4 v[192:195], v1, s[36:39], s64 offen offset:0 sc1
buffer_load_dwordx4 v[200:203], v1, s[36:39], s66 offen offset:0 sc1
buffer_load_dwordx4 v[196:199], v1, s[36:39], s64 offen offset:1024 sc1
buffer_load_dwordx4 v[204:207], v1, s[36:39], s66 offen offset:1024 sc1
s_waitcnt vmcnt(0)
v_max3_u32 v22, v192, v193, v194
v_max3_u32 v22, v22, v195, v196
v_max3_u32 v22, v22, v197, v198
v_max3_u32 v22, v22, v199, v200
v_max3_u32 v22, v22, v201, v202
v_max3_u32 v22, v22, v203, v204
v_max3_u32 v22, v22, v205, v206
v_max_u32 v22, v22, v207
v_cmp_eq_u32 vcc, -1, v22
s_cbranch_vccz L_pollx_152
s_sleep 16
s_add_u32 s75, s75, 1
s_cmp_lt_u32 s75, 0x100000
s_cbranch_scc1 L_poll_151
L_pollx_152:
v_lshlrev_b32 v20, 16, v200
v_and_b32 v21, s68, v200
v_add_f32 v20, 1.0, v20
v_add_f32 v21, 1.0, v21
v_cvt_pk_bf16_f32 v20, 0, v20
v_cvt_pk_bf16_f32 v21, 0, v21
v_mul_f32 v20, v20, v96
v_mul_f32 v21, v21, v97
v_cvt_pk_bf16_f32 v20, 0, v20
v_cvt_pk_bf16_f32 v21, 0, v21
v_lshlrev_b32 v22, 16, v192
v_and_b32 v23, s68, v192
v_add_f32 v20, v20, v22
v_add_f32 v21, v21, v23
v_cvt_pk_bf16_f32 v48, v20, v21
v_lshlrev_b32 v20, 16, v201
v_and_b32 v21, s68, v201
v_add_f32 v20, 1.0, v20
v_add_f32 v21, 1.0, v21
v_cvt_pk_bf16_f32 v20, 0, v20
v_cvt_pk_bf16_f32 v21, 0, v21
v_mul_f32 v20, v20, v98
v_mul_f32 v21, v21, v99
v_cvt_pk_bf16_f32 v20, 0, v20
v_cvt_pk_bf16_f32 v21, 0, v21
v_lshlrev_b32 v22, 16, v193
v_and_b32 v23, s68, v193
v_add_f32 v20, v20, v22
v_add_f32 v21, v21, v23
v_cvt_pk_bf16_f32 v49, v20, v21
v_lshlrev_b32 v20, 16, v202
v_and_b32 v21, s68, v202
v_add_f32 v20, 1.0, v20
v_add_f32 v21, 1.0, v21
v_cvt_pk_bf16_f32 v20, 0, v20
v_cvt_pk_bf16_f32 v21, 0, v21
v_mul_f32 v20, v20, v100
v_mul_f32 v21, v21, v101
v_cvt_pk_bf16_f32 v20, 0, v20
v_cvt_pk_bf16_f32 v21, 0, v21
v_lshlrev_b32 v22, 16, v194
v_and_b32 v23, s68, v194
v_add_f32 v20, v20, v22
v_add_f32 v21, v21, v23
v_cvt_pk_bf16_f32 v50, v20, v21
v_lshlrev_b32 v20, 16, v203
v_and_b32 v21, s68, v203
v_add_f32 v20, 1.0, v20
v_add_f32 v21, 1.0, v21
v_cvt_pk_bf16_f32 v20, 0, v20
v_cvt_pk_bf16_f32 v21, 0, v21
v_mul_f32 v20, v20, v102
v_mul_f32 v21, v21, v103
v_cvt_pk_bf16_f32 v20, 0, v20
v_cvt_pk_bf16_f32 v21, 0, v21
v_lshlrev_b32 v22, 16, v195
v_and_b32 v23, s68, v195
v_add_f32 v20, v20, v22
v_add_f32 v21, v21, v23
v_cvt_pk_bf16_f32 v51, v20, v21
v_lshlrev_b32 v20, 16, v204
v_and_b32 v21, s68, v204
v_add_f32 v20, 1.0, v20
v_add_f32 v21, 1.0, v21
v_cvt_pk_bf16_f32 v20, 0, v20
v_cvt_pk_bf16_f32 v21, 0, v21
v_mul_f32 v20, v20, v104
v_mul_f32 v21, v21, v105
v_cvt_pk_bf16_f32 v20, 0, v20
v_cvt_pk_bf16_f32 v21, 0, v21
v_lshlrev_b32 v22, 16, v196
v_and_b32 v23, s68, v196
v_add_f32 v20, v20, v22
v_add_f32 v21, v21, v23
v_cvt_pk_bf16_f32 v52, v20, v21
v_lshlrev_b32 v20, 16, v205
v_and_b32 v21, s68, v205
v_add_f32 v20, 1.0, v20
v_add_f32 v21, 1.0, v21
v_cvt_pk_bf16_f32 v20, 0, v20
v_cvt_pk_bf16_f32 v21, 0, v21
v_mul_f32 v20, v20, v106
v_mul_f32 v21, v21, v107
v_cvt_pk_bf16_f32 v20, 0, v20
v_cvt_pk_bf16_f32 v21, 0, v21
v_lshlrev_b32 v22, 16, v197
v_and_b32 v23, s68, v197
v_add_f32 v20, v20, v22
v_add_f32 v21, v21, v23
v_cvt_pk_bf16_f32 v53, v20, v21
v_lshlrev_b32 v20, 16, v206
v_and_b32 v21, s68, v206
v_add_f32 v20, 1.0, v20
v_add_f32 v21, 1.0, v21
v_cvt_pk_bf16_f32 v20, 0, v20
v_cvt_pk_bf16_f32 v21, 0, v21
v_mul_f32 v20, v20, v108
v_mul_f32 v21, v21, v109
v_cvt_pk_bf16_f32 v20, 0, v20
v_cvt_pk_bf16_f32 v21, 0, v21
v_lshlrev_b32 v22, 16, v198
v_and_b32 v23, s68, v198
v_add_f32 v20, v20, v22
v_add_f32 v21, v21, v23
v_cvt_pk_bf16_f32 v54, v20, v21
v_lshlrev_b32 v20, 16, v207
v_and_b32 v21, s68, v207
v_add_f32 v20, 1.0, v20
v_add_f32 v21, 1.0, v21
v_cvt_pk_bf16_f32 v20, 0, v20
v_cvt_pk_bf16_f32 v21, 0, v21
v_mul_f32 v20, v20, v110
v_mul_f32 v21, v21, v111
v_cvt_pk_bf16_f32 v20, 0, v20
v_cvt_pk_bf16_f32 v21, 0, v21
v_lshlrev_b32 v22, 16, v199
v_and_b32 v23, s68, v199
v_add_f32 v20, v20, v22
v_add_f32 v21, v21, v23
v_cvt_pk_bf16_f32 v55, v20, v21
L_g3:
s_cmp_ge_u32 s2, s73
s_cbranch_scc0 L_fl_153
s_waitcnt vmcnt(0)
v_cmp_eq_u32 vcc, 0, v31
s_cbranch_vccz L_fl_153
s_mov_b32 s75, 0
L_poll_154:
buffer_load_dword v31, v30, s[52:55], 0 offen offset:128 sc1
s_waitcnt vmcnt(0)
v_cmp_eq_u32 vcc, 0, v31
s_cbranch_vccz L_pollx_155
s_sleep 40
s_add_u32 s75, s75, 1
s_cmp_lt_u32 s75, 0x100000
s_cbranch_scc1 L_poll_154
L_pollx_155:
L_fl_153:
s_nop 1
v_mfma_f32_16x16x32_bf16 v[64:67], v[128:131], v[48:51], 0
v_mfma_f32_16x16x32_bf16 v[68:71], v[132:135], v[48:51], 0
v_mfma_f32_16x16x32_bf16 v[72:75], v[136:139], v[48:51], 0
v_mfma_f32_16x16x32_bf16 v[76:79], v[140:143], v[48:51], 0
v_mfma_f32_16x16x32_bf16 v[80:83], v[144:147], v[48:51], 0
v_mfma_f32_16x16x32_bf16 v[84:87], v[148:151], v[48:51], 0
v_mfma_f32_16x16x32_bf16 v[88:91], v[152:155], v[48:51], 0
v_mfma_f32_16x16x32_bf16 v[92:95], v[156:159], v[48:51], 0
v_mfma_f32_16x16x32_bf16 v[64:67], v[160:163], v[52:55], v[64:67]
v_mfma_f32_16x16x32_bf16 v[68:71], v[164:167], v[52:55], v[68:71]
v_mfma_f32_16x16x32_bf16 v[72:75], v[168:171], v[52:55], v[72:75]
v_mfma_f32_16x16x32_bf16 v[76:79], v[172:175], v[52:55], v[76:79]
v_mfma_f32_16x16x32_bf16 v[80:83], v[176:179], v[52:55], v[80:83]
v_mfma_f32_16x16x32_bf16 v[84:87], v[180:183], v[52:55], v[84:87]
v_mfma_f32_16x16x32_bf16 v[88:91], v[184:187], v[52:55], v[88:91]
v_mfma_f32_16x16x32_bf16 v[92:95], v[188:191], v[52:55], v[92:95]
v_and_b32 v20, 7, v0
v_mul_u32_u24 v20, 272, v20
v_and_b32 v21, 8, v0
v_lshl_add_u32 v20, v21, 3, v20
v_and_b32 v21, 48, v0
v_add_u32 v20, v20, v21
s_mul_i32 s64, s34, 8192
s_add_u32 s64, s64, 4096
v_add_u32 v20, s64, v20
s_nop 7
v_add_f32_dpp v24, v80, v64 row_ror:8 row_mask:0xf bank_mask:0x3
v_add_f32_dpp v24, v68, v84 row_ror:8 row_mask:0xf bank_mask:0xc
v_add_f32_dpp v25, v81, v65 row_ror:8 row_mask:0xf bank_mask:0x3
v_add_f32_dpp v25, v69, v85 row_ror:8 row_mask:0xf bank_mask:0xc
v_add_f32_dpp v26, v82, v66 row_ror:8 row_mask:0xf bank_mask:0x3
v_add_f32_dpp v26, v70, v86 row_ror:8 row_mask:0xf bank_mask:0xc
v_add_f32_dpp v27, v83, v67 row_ror:8 row_mask:0xf bank_mask:0x3
v_add_f32_dpp v27, v71, v87 row_ror:8 row_mask:0xf bank_mask:0xc
ds_write_b128 v20, v[24:27] offset:0
v_add_f32_dpp v28, v88, v72 row_ror:8 row_mask:0xf bank_mask:0x3
v_add_f32_dpp v28, v76, v92 row_ror:8 row_mask:0xf bank_mask:0xc
v_add_f32_dpp v29, v89, v73 row_ror:8 row_mask:0xf bank_mask:0x3
v_add_f32_dpp v29, v77, v93 row_ror:8 row_mask:0xf bank_mask:0xc
v_add_f32_dpp v30, v90, v74 row_ror:8 row_mask:0xf bank_mask:0x3
v_add_f32_dpp v30, v78, v94 row_ror:8 row_mask:0xf bank_mask:0xc
v_add_f32_dpp v31, v91, v75 row_ror:8 row_mask:0xf bank_mask:0x3
v_add_f32_dpp v31, v79, v95 row_ror:8 row_mask:0xf bank_mask:0xc
ds_write_b128 v20, v[28:31] offset:128
v_mov_b32 v20, 0
s_waitcnt lgkmcnt(0)
s_mov_b64 exec, 1
ds_add_u32 v20, v9 offset:320
s_mov_b64 exec, -1
s_cmp_eq_u32 s34, 0
s_cbranch_scc0 L_waitq
s_cmp_lt_u32 s2, 16
s_cbranch_scc0 L_gq2
v_and_b32 v21, 7, v0
v_lshrrev_b32 v22, 4, v0
v_and_b32 v23, 8, v0
v_lshrrev_b32 v23, 1, v23
v_add_u32 v22, v22, v23
v_mov_b32 v23, v1
s_lshl_b32 s64, s72, 10
s_add_u32 s64, s64, 0
s_branch L_g4
L_gq2:
v_lshrrev_b32 v21, 3, v0
v_and_b32 v22, 7, v0
s_mov_b32 s64, 10240
s_cmp_lt_u32 s2, 48
s_cselect_b32 s64, 22528, s64
s_mov_b32 s65, 12288
v_mul_lo_u32 v23, s65, v21
v_lshl_add_u32 v23, v22, 4, v23
s_lshl_b32 s66, s72, 7
s_add_u32 s64, s64, s66
L_g4:
v_mul_u32_u24 v21, 272, v21
v_lshl_add_u32 v21, v22, 5, v21
v_add_u32 v21, 4096, v21
s_mov_b32 s75, 0
L_poll_156:
ds_read_b32 v22, v20 offset:320
s_waitcnt lgkmcnt(0)
v_cmp_gt_u32 vcc, 4, v22
s_cbranch_vccz L_pollx_157
s_add_u32 s75, s75, 1
s_cmp_lt_u32 s75, 0x1000000
s_cbranch_scc1 L_poll_156
L_pollx_157:
ds_read_b128 v[64:67], v21 offset:0
ds_read_b128 v[68:71], v21 offset:16
ds_read_b128 v[72:75], v21 offset:8192
ds_read_b128 v[76:79], v21 offset:8208
ds_read_b128 v[80:83], v21 offset:16384
ds_read_b128 v[84:87], v21 offset:16400
ds_read_b128 v[88:91], v21 offset:24576
ds_read_b128 v[92:95], v21 offset:24592
s_waitcnt lgkmcnt(0)
v_add_f32 v64, v64, v72
v_add_f32 v65, v65, v73
v_add_f32 v66, v66, v74
v_add_f32 v67, v67, v75
v_add_f32 v68, v68, v76
v_add_f32 v69, v69, v77
v_add_f32 v70, v70, v78
v_add_f32 v71, v71, v79
v_add_f32 v64, v64, v80
v_add_f32 v65, v65, v81
v_add_f32 v66, v66, v82
v_add_f32 v67, v67, v83
v_add_f32 v68, v68, v84
v_add_f32 v69, v69, v85
v_add_f32 v70, v70, v86
v_add_f32 v71, v71, v87
v_add_f32 v64, v64, v88
v_add_f32 v65, v65, v89
v_add_f32 v66, v66, v90
v_add_f32 v67, v67, v91
v_add_f32 v68, v68, v92
v_add_f32 v69, v69, v93
v_add_f32 v70, v70, v94
v_add_f32 v71, v71, v95
v_cvt_pk_bf16_f32 v24, v64, v65
v_cvt_pk_bf16_f32 v25, v66, v67
v_cvt_pk_bf16_f32 v26, v68, v69
v_cvt_pk_bf16_f32 v27, v70, v71
v_min_u32 v24, -2, v24
v_min_u32 v25, -2, v25
v_min_u32 v26, -2, v26
v_min_u32 v27, -2, v27
buffer_store_dwordx4 v[24:27], v23, s[36:39], s64 offen sc1
s_branch L_waitq
L_jan:
v_mov_b32 v4, -1
v_mov_b32 v5, -1
v_mov_b32 v6, -1
v_mov_b32 v7, -1
s_lshl_b32 s67, s64, 2
s_add_u32 s67, s67, s34
s_cmp_lt_u32 s67, 32
s_cselect_b32 s66, 0, 933888
s_mul_i32 s65, s67, 3072
s_add_u32 s65, s65, s66
s_add_u32 s65, s65, 16384
v_add_u32 v8, s65, v1
global_store_dwordx4 v8, v[4:7], s[30:31] offset:0 sc1
global_store_dwordx4 v8, v[4:7], s[30:31] offset:1024 sc1
global_store_dwordx4 v8, v[4:7], s[30:31] offset:2048 sc1
s_and_b32 s66, s67, 64
s_add_u32 s67, s67, s66
s_lshl_b32 s67, s67, 7
s_add_u32 s67, s67, 1343488
v_and_b32 v8, 8, v0
v_lshlrev_b32 v8, 10, v8
v_and_b32 v10, 0x70, v1
v_add3_u32 v8, v8, v10, s67
s_mov_b64 exec, 0xffff
global_store_dwordx4 v8, v[4:7], s[30:31] sc1
s_mov_b64 exec, 1
s_load_dword s68, s[30:31], 0x48000
s_and_b32 s65, s34, 1
s_lshl_b32 s66, s65, 13
s_xor_b32 s67, s67, s66
s_xor_b32 s66, s67, 0x2000
s_waitcnt vmcnt(0) lgkmcnt(0)
s_mov_b64 exec, -1
s_cmp_eq_u32 s34, 3
s_cbranch_scc1 L_p0_158
s_cmp_eq_u32 s34, 0
s_cselect_b32 s62, s24, s10
s_cselect_b32 s63, s25, s11
s_cmp_eq_u32 s34, 2
s_cselect_b32 s62, s12, s62
s_cselect_b32 s63, s13, s63
global_load_dword v12, v38, s[62:63]
global_load_dword v13, v39, s[62:63]
L_p0_158:
s_mov_b64 exec, 1
s_mov_b32 s70, 0
s_load_dword s68, s[30:31], s67
L_race_159:
s_getreg_b32 s69, hwreg(HW_REG_IB_STS, 8, 4)
s_add_u32 s70, s70, 1
s_cmp_eq_u32 s69, 0
s_cbranch_scc0 L_race_159
s_waitcnt lgkmcnt(0)
s_mov_b32 s71, 0
s_load_dword s68, s[30:31], s66
L_race_160:
s_getreg_b32 s69, hwreg(HW_REG_IB_STS, 8, 4)
s_add_u32 s71, s71, 1
s_cmp_eq_u32 s69, 0
s_cbranch_scc0 L_race_160
s_waitcnt lgkmcnt(0)
s_cmp_lt_u32 s71, s70
s_cselect_b32 s70, 1, 0
s_xor_b32 s70, s70, s65
s_getreg_b32 s69, hwreg(HW_REG_XCC_ID, 2, 1)
s_xor_b32 s70, s70, s69
s_lshl_b32 s69, s69, 14
s_lshl_b32 s70, s70, 8
s_add_u32 s70, s70, s69
s_add_u32 s70, s70, 1
v_mov_b32 v9, s70
s_lshl_b32 s65, s64, 2
v_mov_b32 v8, s65
ds_add_rtn_u32 v11, v2, v9 offset:320
s_waitcnt lgkmcnt(0)
v_add_u32 v11, v11, v9
v_and_b32 v10, 0xff, v11
v_cmp_eq_u32 vcc, 4, v10
s_cbranch_vccz L_j_161
global_store_dword v8, v11, s[28:29] offset:128 sc1
L_j_161:
s_mov_b64 exec, -1
s_branch L_nop0
L_norole:
s_cmp_eq_u32 s74, -1
s_cbranch_scc1 L_waitq
L_waitq:
s_cmp_eq_u32 s74, -1
s_cselect_b64 vcc, 0, -1
s_cmp_lt_u32 s2, 112
s_cselect_b64 vcc, -1, vcc
s_mov_b32 s44, s12
s_mov_b32 s45, s13
s_mov_b32 s46, 0x400000
s_mov_b32 s47, 0x20000
v_lshrrev_b32 v18, 4, v0
v_and_b32 v16, 15, v0
v_xor_b32 v16, v16, v18
v_xor_b32 v17, 4, v16
v_lshlrev_b32 v19, 10, v18
v_lshl_add_u32 v22, v16, 4, v19
v_lshl_add_u32 v23, v17, 4, v19
v_and_b32 v19, 1, v18
v_lshlrev_b32 v19, 10, v19
v_lshrrev_b32 v18, 1, v18
v_lshl_add_u32 v18, v18, 11, v19
v_lshl_add_u32 v16, v16, 4, v18
v_lshl_add_u32 v17, v17, 4, v18
v_lshrrev_b32 v18, 4, v0
v_bfe_u32 v19, v0, 2, 2
v_and_b32 v20, 2, v0
v_lshlrev_b32 v20, 2, v20
v_xor_b32 v20, v20, v19
v_and_b32 v21, 1, v18
v_lshlrev_b32 v21, 2, v21
v_xor_b32 v20, v20, v21
v_lshlrev_b32 v20, 4, v20
v_lshl_add_u32 v20, v18, 10, v20
v_lshl_add_u32 v20, v19, 8, v20
v_and_b32 v21, 1, v0
v_lshl_add_u32 v20, v21, 3, v20
s_lshl_b32 s65, s34, 13
s_add_u32 s65, s65, 8192
v_add_u32 v40, s65, v20
v_xor_b32 v41, 16, v40
v_xor_b32 v42, 32, v40
v_xor_b32 v43, 48, v40
v_xor_b32 v44, 64, v40
v_xor_b32 v45, 80, v40
v_xor_b32 v46, 96, v40
v_xor_b32 v47, 112, v40
s_lshl_b32 s64, s33, 17
s_lshl_b32 s66, s34, 8
s_add_u32 s64, s64, s66
s_mov_b32 s68, 0
s_lshl_b32 s66, s68, 10
s_add_u32 s64, s64, s66
s_add_u32 m0, s65, 0
s_xor_b32 s66, s64, 0
buffer_load_dwordx4 v16, s[44:47], s66 offen  lds
s_add_u32 m0, s65, 1024
s_xor_b32 s66, s64, 8192
buffer_load_dwordx4 v17, s[44:47], s66 offen  lds
s_add_u32 m0, s65, 2048
s_xor_b32 s66, s64, 16384
buffer_load_dwordx4 v16, s[44:47], s66 offen  lds
s_waitcnt vmcnt(2)
s_add_u32 m0, s65, 3072
s_xor_b32 s66, s64, 24576
buffer_load_dwordx4 v17, s[44:47], s66 offen  lds
s_waitcnt vmcnt(2)
s_add_u32 m0, s65, 32768
s_xor_b32 s66, s64, 4096
buffer_load_dwordx4 v16, s[44:47], s66 offen  lds
s_waitcnt vmcnt(2)
s_add_u32 m0, s65, 33792
s_xor_b32 s66, s64, 12288
buffer_load_dwordx4 v17, s[44:47], s66 offen  lds
s_waitcnt vmcnt(2)
ds_read_b64_tr_b16 v[128:129], v40 offset:0
ds_read_b64_tr_b16 v[136:137], v41 offset:0
ds_read_b64_tr_b16 v[144:145], v42 offset:0
ds_read_b64_tr_b16 v[152:153], v43 offset:0
ds_read_b64_tr_b16 v[160:161], v44 offset:0
ds_read_b64_tr_b16 v[168:169], v45 offset:0
ds_read_b64_tr_b16 v[176:177], v46 offset:0
ds_read_b64_tr_b16 v[184:185], v47 offset:0
s_add_u32 m0, s65, 34816
s_xor_b32 s66, s64, 20480
buffer_load_dwordx4 v16, s[44:47], s66 offen  lds
s_waitcnt vmcnt(2)
s_add_u32 m0, s65, 35840
s_xor_b32 s66, s64, 28672
buffer_load_dwordx4 v17, s[44:47], s66 offen  lds
s_waitcnt vmcnt(2)
s_waitcnt lgkmcnt(0)
s_add_u32 m0, s65, 0
s_xor_b32 s66, s64, 32768
buffer_load_dwordx4 v16, s[44:47], s66 offen  lds
s_waitcnt vmcnt(2)
s_add_u32 m0, s65, 1024
s_xor_b32 s66, s64, 40960
buffer_load_dwordx4 v17, s[44:47], s66 offen  lds
s_waitcnt vmcnt(2)
ds_read_b64_tr_b16 v[130:131], v40 offset:32768
ds_read_b64_tr_b16 v[138:139], v41 offset:32768
ds_read_b64_tr_b16 v[146:147], v42 offset:32768
ds_read_b64_tr_b16 v[154:155], v43 offset:32768
ds_read_b64_tr_b16 v[162:163], v44 offset:32768
ds_read_b64_tr_b16 v[170:171], v45 offset:32768
ds_read_b64_tr_b16 v[178:179], v46 offset:32768
ds_read_b64_tr_b16 v[186:187], v47 offset:32768
s_add_u32 m0, s65, 2048
s_xor_b32 s66, s64, 49152
buffer_load_dwordx4 v16, s[44:47], s66 offen  lds
s_waitcnt vmcnt(2)
s_add_u32 m0, s65, 3072
s_xor_b32 s66, s64, 57344
buffer_load_dwordx4 v17, s[44:47], s66 offen  lds
s_waitcnt vmcnt(2)
s_waitcnt lgkmcnt(0)
s_add_u32 m0, s65, 32768
s_xor_b32 s66, s64, 36864
buffer_load_dwordx4 v16, s[44:47], s66 offen  lds
s_waitcnt vmcnt(2)
s_add_u32 m0, s65, 33792
s_xor_b32 s66, s64, 45056
buffer_load_dwordx4 v17, s[44:47], s66 offen  lds
s_waitcnt vmcnt(2)
ds_read_b64_tr_b16 v[132:133], v40 offset:0
ds_read_b64_tr_b16 v[140:141], v41 offset:0
ds_read_b64_tr_b16 v[148:149], v42 offset:0
ds_read_b64_tr_b16 v[156:157], v43 offset:0
ds_read_b64_tr_b16 v[164:165], v44 offset:0
ds_read_b64_tr_b16 v[172:173], v45 offset:0
ds_read_b64_tr_b16 v[180:181], v46 offset:0
ds_read_b64_tr_b16 v[188:189], v47 offset:0
s_add_u32 m0, s65, 34816
s_xor_b32 s66, s64, 53248
buffer_load_dwordx4 v16, s[44:47], s66 offen  lds
s_waitcnt vmcnt(2)
s_add_u32 m0, s65, 35840
s_xor_b32 s66, s64, 61440
buffer_load_dwordx4 v17, s[44:47], s66 offen  lds
s_waitcnt vmcnt(2)
s_waitcnt lgkmcnt(0)
s_add_u32 m0, s65, 0
s_xor_b32 s66, s64, 65536
buffer_load_dwordx4 v16, s[44:47], s66 offen  lds
s_waitcnt vmcnt(2)
s_add_u32 m0, s65, 1024
s_xor_b32 s66, s64, 73728
buffer_load_dwordx4 v17, s[44:47], s66 offen  lds
s_waitcnt vmcnt(2)
ds_read_b64_tr_b16 v[134:135], v40 offset:32768
ds_read_b64_tr_b16 v[142:143], v41 offset:32768
ds_read_b64_tr_b16 v[150:151], v42 offset:32768
ds_read_b64_tr_b16 v[158:159], v43 offset:32768
ds_read_b64_tr_b16 v[166:167], v44 offset:32768
ds_read_b64_tr_b16 v[174:175], v45 offset:32768
ds_read_b64_tr_b16 v[182:183], v46 offset:32768
ds_read_b64_tr_b16 v[190:191], v47 offset:32768
s_add_u32 m0, s65, 2048
s_xor_b32 s66, s64, 81920
buffer_load_dwordx4 v16, s[44:47], s66 offen  lds
s_waitcnt vmcnt(2)
s_add_u32 m0, s65, 3072
s_xor_b32 s66, s64, 90112
buffer_load_dwordx4 v17, s[44:47], s66 offen  lds
s_waitcnt vmcnt(2)
s_waitcnt lgkmcnt(0)
s_add_u32 m0, s65, 32768
s_xor_b32 s66, s64, 69632
buffer_load_dwordx4 v16, s[44:47], s66 offen  lds
s_waitcnt vmcnt(2)
s_add_u32 m0, s65, 33792
s_xor_b32 s66, s64, 77824
buffer_load_dwordx4 v17, s[44:47], s66 offen  lds
s_waitcnt vmcnt(2)
ds_read_b64_tr_b16 v[192:193], v40 offset:0
ds_read_b64_tr_b16 v[200:201], v41 offset:0
ds_read_b64_tr_b16 v[208:209], v42 offset:0
ds_read_b64_tr_b16 v[216:217], v43 offset:0
ds_read_b64_tr_b16 v[224:225], v44 offset:0
ds_read_b64_tr_b16 v[232:233], v45 offset:0
ds_read_b64_tr_b16 v[240:241], v46 offset:0
ds_read_b64_tr_b16 v[248:249], v47 offset:0
s_add_u32 m0, s65, 34816
s_xor_b32 s66, s64, 86016
buffer_load_dwordx4 v16, s[44:47], s66 offen  lds
s_waitcnt vmcnt(2)
s_add_u32 m0, s65, 35840
s_xor_b32 s66, s64, 94208
buffer_load_dwordx4 v17, s[44:47], s66 offen  lds
s_waitcnt vmcnt(2)
s_waitcnt lgkmcnt(0)
s_add_u32 m0, s65, 0
s_xor_b32 s66, s64, 98304
buffer_load_dwordx4 v16, s[44:47], s66 offen  lds
s_waitcnt vmcnt(2)
s_add_u32 m0, s65, 1024
s_xor_b32 s66, s64, 106496
buffer_load_dwordx4 v17, s[44:47], s66 offen  lds
s_waitcnt vmcnt(2)
ds_read_b64_tr_b16 v[194:195], v40 offset:32768
ds_read_b64_tr_b16 v[202:203], v41 offset:32768
ds_read_b64_tr_b16 v[210:211], v42 offset:32768
ds_read_b64_tr_b16 v[218:219], v43 offset:32768
ds_read_b64_tr_b16 v[226:227], v44 offset:32768
ds_read_b64_tr_b16 v[234:235], v45 offset:32768
ds_read_b64_tr_b16 v[242:243], v46 offset:32768
ds_read_b64_tr_b16 v[250:251], v47 offset:32768
v_and_b32 v24, 127, v2
buffer_load_dword v25, v24, s[52:55], 0 offen offset:128
s_add_u32 m0, s65, 2048
s_xor_b32 s66, s64, 114688
buffer_load_dwordx4 v16, s[44:47], s66 offen  lds
s_waitcnt vmcnt(2)
s_add_u32 m0, s65, 3072
s_xor_b32 s66, s64, 122880
buffer_load_dwordx4 v17, s[44:47], s66 offen  lds
s_waitcnt vmcnt(2)
s_waitcnt lgkmcnt(0)
s_add_u32 m0, s65, 32768
s_xor_b32 s66, s64, 102400
buffer_load_dwordx4 v16, s[44:47], s66 offen  lds
s_waitcnt vmcnt(2)
s_add_u32 m0, s65, 33792
s_xor_b32 s66, s64, 110592
buffer_load_dwordx4 v17, s[44:47], s66 offen  lds
s_waitcnt vmcnt(2)
ds_read_b64_tr_b16 v[196:197], v40 offset:0
ds_read_b64_tr_b16 v[204:205], v41 offset:0
ds_read_b64_tr_b16 v[212:213], v42 offset:0
ds_read_b64_tr_b16 v[220:221], v43 offset:0
ds_read_b64_tr_b16 v[228:229], v44 offset:0
ds_read_b64_tr_b16 v[236:237], v45 offset:0
ds_read_b64_tr_b16 v[244:245], v46 offset:0
ds_read_b64_tr_b16 v[252:253], v47 offset:0
s_add_u32 m0, s65, 34816
s_xor_b32 s66, s64, 118784
buffer_load_dwordx4 v16, s[44:47], s66 offen  lds
s_waitcnt vmcnt(2)
s_add_u32 m0, s65, 35840
s_xor_b32 s66, s64, 126976
buffer_load_dwordx4 v17, s[44:47], s66 offen  lds
s_waitcnt vmcnt(0)
ds_read_b64_tr_b16 v[198:199], v40 offset:32768
ds_read_b64_tr_b16 v[206:207], v41 offset:32768
ds_read_b64_tr_b16 v[214:215], v42 offset:32768
ds_read_b64_tr_b16 v[222:223], v43 offset:32768
ds_read_b64_tr_b16 v[230:231], v44 offset:32768
ds_read_b64_tr_b16 v[238:239], v45 offset:32768
ds_read_b64_tr_b16 v[246:247], v46 offset:32768
ds_read_b64_tr_b16 v[254:255], v47 offset:32768
s_waitcnt lgkmcnt(0)
v_cmp_eq_u32 vcc, 0, v25
s_cbranch_vccz L_tab_162
s_mov_b32 s75, 0
L_poll_163:
buffer_load_dword v25, v24, s[52:55], 0 offen offset:128 sc1
s_waitcnt vmcnt(0)
v_cmp_eq_u32 vcc, 0, v25
s_cbranch_vccz L_pollx_164
s_sleep 40
s_add_u32 s75, s75, 1
s_cmp_lt_u32 s75, 0x100000
s_cbranch_scc1 L_poll_163
L_pollx_164:
L_tab_162:
v_bfe_u32 v26, v25, 8, 3
v_lshrrev_b32 v25, 16, v25
s_nop 0
v_add_u32_dpp v26, v26, v26 quad_perm:[1,0,3,2] row_mask:0xf bank_mask:0xf
s_nop 1
v_add_u32_dpp v26, v26, v26 quad_perm:[2,3,0,1] row_mask:0xf bank_mask:0xf
s_nop 1
v_add_u32_dpp v26, v26, v26 row_ror:4 row_mask:0xf bank_mask:0xf
s_nop 1
v_add_u32_dpp v26, v26, v26 row_ror:8 row_mask:0xf bank_mask:0xf
s_nop 1
v_readlane_b32 s66, v26, 0
v_readlane_b32 s71, v26, 16
s_add_u32 s66, s66, s71
s_cmp_gt_u32 s66, 64
s_cselect_b32 s66, 1, 0
v_cmp_ne_u32 vcc, s66, v25
s_and_b32 s71, vcc_lo, 0xff
s_bcnt0_i32_b32 s66, s71
s_sub_u32 s66, s66, 24
v_mbcnt_lo_u32_b32 v24, s71, 0
v_sub_u32 v25, v0, v24
v_add_u32 v24, s66, v24
v_cndmask_b32 v24, v25, v24, vcc
v_bfe_u32 v25, v24, 1, 2
v_and_b32 v26, 1, v24
v_lshl_or_b32 v25, v26, 2, v25
v_lshlrev_b32 v25, v2, v25
s_nop 1
v_or_b32_dpp v25, v25, v25 quad_perm:[1,0,3,2] row_mask:0xf bank_mask:0xf
s_nop 1
v_or_b32_dpp v25, v25, v25 quad_perm:[2,3,0,1] row_mask:0xf bank_mask:0xf
s_nop 1
v_or_b32_dpp v25, v25, v25 row_shl:4 row_mask:0xf bank_mask:0xf
s_nop 1
v_readfirstlane_b32 s35, v25
s_mov_b64 exec, 1
ds_write_b32 v2, v25 offset:328
s_mov_b64 exec, -1
s_sub_u32 s64, s2, 144
s_cmp_lt_u32 s64, 64
s_cbranch_scc0 L_rp_165
s_cmp_eq_u32 s34, 0
s_cbranch_scc0 L_rp_165
s_mov_b32 s48, s4
s_mov_b32 s49, s5
s_mov_b32 s50, 0x2000
s_mov_b32 s51, 0x20000
v_and_b32 v5, 15, v0
v_and_b32 v6, 16, v0
v_lshl_add_u32 v5, v6, 1, v5
v_and_b32 v6, 32, v0
v_lshrrev_b32 v6, 1, v6
v_add_u32 v5, v5, v6
v_lshlrev_b32 v5, 1, v5
v_and_b32 v6, 0x7c, v5
s_lshl_b32 s65, s64, 7
s_and_b32 s66, s65, 0x380
s_lshr_b32 s64, s64, 3
s_mul_i32 s64, s64, 12288
s_add_u32 s64, s64, s66
s_add_u32 s64, s64, 24576
buffer_load_ushort v18, v5, s[48:51], s65 offen
s_mov_b32 s75, 0
L_poll_166:
buffer_load_dword v19, v6, s[36:39], s64 offen offset:0 sc1
buffer_load_dword v20, v6, s[36:39], s64 offen offset:3072 sc1
s_waitcnt vmcnt(0)
v_max_u32 v16, v19, v20
v_cmp_eq_u32 vcc, -1, v16
s_cbranch_vccz L_pollx_167
s_sleep 40
s_add_u32 s75, s75, 1
s_cmp_lt_u32 s75, 0x100000
s_cbranch_scc1 L_poll_166
L_pollx_167:
v_and_b32 v16, 1, v0
v_lshlrev_b32 v16, 4, v16
v_xor_b32 v16, 16, v16
v_lshlrev_b32 v18, 16, v18
v_lshlrev_b32 v19, v16, v19
v_and_b32 v19, 0xffff0000, v19
v_lshlrev_b32 v20, v16, v20
v_and_b32 v20, 0xffff0000, v20
ds_write_b32 v2, v18 offset:4096
ds_write_b32 v2, v19 offset:4352
ds_write_b32 v2, v20 offset:4608
L_rp_165:
v_lshlrev_b32 v10, 3, v0
s_lshl_b32 s64, s34, 8
s_add_u32 s64, s64, 2560
s_lshr_b32 s66, s68, 1
v_xor_b32 v12, s66, v0
v_mov_b32 v14, 0
v_bfe_u32 v11, v12, 0, 1
v_lshl_or_b32 v14, v11, 0, v14
v_bfe_u32 v11, v12, 1, 1
v_lshl_or_b32 v14, v11, 1, v14
v_bfe_u32 v11, v12, 2, 1
v_lshl_or_b32 v14, v11, 2, v14
v_bfe_u32 v11, v12, 3, 1
v_lshl_or_b32 v14, v11, 3, v14
v_bfe_u32 v11, v12, 4, 1
v_lshl_or_b32 v14, v11, 4, v14
v_bfe_u32 v11, v12, 5, 1
v_lshl_or_b32 v14, v11, 5, v14
v_and_b32 v11, 0x38, v14
v_and_b32 v12, 1, v14
v_lshl_add_u32 v11, v12, 2, v11
v_bfe_u32 v12, v14, 1, 2
v_add_u32 v11, v11, v12
v_lshl_add_u32 v11, v11, 2, s64
v_and_b32 v14, 1, v0
v_and_b32 v12, 48, v0
v_lshlrev_b32 v12, 1, v12
v_lshl_add_u32 v12, v14, 4, v12
v_add_u32 v12, s64, v12
v_mul_u32_u24 v15, 0xaaaa, v14
v_add_u32 v15, 0x4444, v15
v_mov_b32 v64, 0
v_mov_b32 v65, 0
v_mov_b32 v66, 0
v_mov_b32 v67, 0
v_mov_b32 v68, 0
v_mov_b32 v69, 0
v_mov_b32 v70, 0
v_mov_b32 v71, 0
v_mov_b32 v72, 0
v_mov_b32 v73, 0
v_mov_b32 v74, 0
v_mov_b32 v75, 0
v_mov_b32 v76, 0
v_mov_b32 v77, 0
v_mov_b32 v78, 0
v_mov_b32 v79, 0
v_mov_b32 v80, 0
v_mov_b32 v81, 0
v_mov_b32 v82, 0
v_mov_b32 v83, 0
v_mov_b32 v84, 0
v_mov_b32 v85, 0
v_mov_b32 v86, 0
v_mov_b32 v87, 0
v_mov_b32 v88, 0
v_mov_b32 v89, 0
v_mov_b32 v90, 0
v_mov_b32 v91, 0
v_mov_b32 v92, 0
v_mov_b32 v93, 0
v_mov_b32 v94, 0
v_mov_b32 v95, 0
s_lshl_b32 s64, s34, 3
s_lshr_b32 s64, s35, s64
v_bfe_u32 v13, v0, 3, 1
v_lshlrev_b32 v13, 2, v13
v_bfe_u32 v13, s64, v13, 3
v_and_b32 v14, 0x70, v1
v_lshl_add_u32 v13, v13, 12, v14
s_lshl_b32 s64, s34, 2
s_add_u32 s64, s64, s33
v_bfe_u32 v14, v0, 3, 1
v_lshl_add_u32 v14, v14, 1, s64
v_and_b32 v14, 31, v14
v_lshl_add_u32 v13, v14, 7, v13
s_lshl_b32 s69, s32, 15
s_add_u32 s69, s69, 1048576
s_waitcnt vmcnt(0) lgkmcnt(0)
s_barrier
ds_read_b64 v[20:21], v10 offset:512
ds_read_b64 v[22:23], v10 offset:1024
ds_read_b64 v[24:25], v10 offset:1536
ds_read_b64 v[26:27], v10 offset:2048
s_waitcnt lgkmcnt(2)
v_pk_add_f32 v[20:21], v[20:21], v[22:23]
s_waitcnt lgkmcnt(1)
v_pk_add_f32 v[20:21], v[20:21], v[24:25]
s_waitcnt lgkmcnt(0)
v_pk_add_f32 v[20:21], v[20:21], v[26:27]
v_cvt_pk_bf16_f32 v20, v20, v21
ds_write_b32 v11, v20
ds_read_b128 v[48:51], v12 offset:0
ds_read_b128 v[52:55], v12 offset:128
s_waitcnt lgkmcnt(1)
v_smfmac_f32_16x16x64_bf16 v[64:67], v[48:51], v[128:135], v15
v_smfmac_f32_16x16x64_bf16 v[68:71], v[48:51], v[136:143], v15
v_smfmac_f32_16x16x64_bf16 v[72:75], v[48:51], v[144:151], v15
v_smfmac_f32_16x16x64_bf16 v[76:79], v[48:51], v[152:159], v15
s_waitcnt lgkmcnt(0)
v_smfmac_f32_16x16x64_bf16 v[64:67], v[52:55], v[192:199], v15
v_smfmac_f32_16x16x64_bf16 v[68:71], v[52:55], v[200:207], v15
v_smfmac_f32_16x16x64_bf16 v[72:75], v[52:55], v[208:215], v15
v_smfmac_f32_16x16x64_bf16 v[76:79], v[52:55], v[216:223], v15
v_smfmac_f32_16x16x64_bf16 v[80:83], v[48:51], v[160:167], v15
v_smfmac_f32_16x16x64_bf16 v[84:87], v[48:51], v[168:175], v15
v_smfmac_f32_16x16x64_bf16 v[88:91], v[48:51], v[176:183], v15
v_smfmac_f32_16x16x64_bf16 v[92:95], v[48:51], v[184:191], v15
v_smfmac_f32_16x16x64_bf16 v[80:83], v[52:55], v[224:231], v15
v_add_f32 v64, v64, v65
v_smfmac_f32_16x16x64_bf16 v[84:87], v[52:55], v[232:239], v15
v_add_f32 v68, v68, v69
v_add_f32 v72, v72, v73
v_smfmac_f32_16x16x64_bf16 v[88:91], v[52:55], v[240:247], v15
v_add_f32 v76, v76, v77
v_cvt_pk_bf16_f32 v20, v64, v68
v_smfmac_f32_16x16x64_bf16 v[92:95], v[52:55], v[248:255], v15
v_cvt_pk_bf16_f32 v21, v72, v76
v_add_f32 v80, v80, v81
s_mov_b64 exec, 0xffff
v_add_f32 v84, v84, v85
v_cvt_pk_bf16_f32 v22, v80, v84
s_nop 0
v_add_f32 v88, v88, v89
s_nop 0
v_add_f32 v92, v92, v93
v_cvt_pk_bf16_f32 v23, v88, v92
buffer_store_dwordx4 v[20:23], v13, s[36:39], s69 offen sc1
s_mov_b64 exec, -1
s_sub_u32 s67, s2, 16
s_cmp_lt_u32 s67, 128
s_cbranch_scc0 L_nogp
s_and_b32 s66, s2, 7
s_min_u32 s64, s66, 3
s_mul_i32 s71, s66, 5
s_add_u32 s64, s64, s71
s_cmp_lt_u32 s66, 3
s_cselect_b32 s66, 5, 4
v_and_b32 v8, 7, v0
v_min_u32 v8, s66, v8
v_add_u32 v8, s64, v8
s_and_b32 s64, s67, 0xf8
s_lshl_b32 s64, s64, 2
s_lshl_b32 s66, s34, 3
s_add_u32 s64, s64, s66
v_lshrrev_b32 v9, 3, v0
v_add_u32 v9, s64, v9
v_mul_u32_u24 v9, 2752, v9
v_lshl_add_u32 v8, v8, 6, v9
global_load_dword v10, v8, s[16:17]
global_load_dword v11, v8, s[18:19]
s_and_b32 s66, s2, 7
s_min_u32 s70, s66, 3
s_mul_i32 s71, s66, 5
s_add_u32 s70, s70, s71
s_cmp_lt_u32 s66, 3
s_cselect_b32 s66, 6, 5
s_lshl_b32 s66, s66, 8
s_sub_u32 s66, s66, 1
s_lshr_b32 s71, s67, 3
s_lshl_b32 s71, s71, 2
s_add_u32 s71, s71, s34
s_mul_i32 s71, s71, 24
v_min_u32 v12, 23, v0
v_add_u32 v12, s71, v12
v_min_u32 v12, s66, v12
s_lshl_b32 s70, s70, 15
v_lshl_add_u32 v12, v12, 7, s70
global_load_dword v13, v12, s[20:21]
s_endpgm
L_nogp:
L_tail_s:
s_cmp_eq_u32 s74, -1
s_cbranch_scc0 L_ffn
s_cmp_eq_u32 s3, 0
s_cbranch_scc0 L_fin
s_sub_u32 s70, s2, 144
s_cmp_lt_u32 s70, 64
s_cbranch_scc0 L_fin
s_lshl_b32 s64, s70, 2
s_lshr_b32 s67, s35, s64
s_and_b32 s71, s67, 7
s_andn2_b32 s66, s70, 7
s_add_u32 s66, s66, s71
s_lshl_b32 s66, s66, 12
s_add_u32 s66, s66, 1048576
buffer_load_dwordx4 v[16:19], v1, s[36:39], s66 offen offset:0 sc1
buffer_load_dwordx4 v[20:23], v1, s[36:39], s66 offen offset:1024 sc1
buffer_load_dwordx4 v[24:27], v1, s[36:39], s66 offen offset:2048 sc1
buffer_load_dwordx4 v[28:31], v1, s[36:39], s66 offen offset:3072 sc1
v_mov_b32 v32, -1
v_mov_b32 v33, -1
v_mov_b32 v34, -1
v_mov_b32 v35, -1
s_and_b32 s64, s71, 6
s_lshl_b32 s64, s64, 12
s_and_b32 s65, s71, 1
s_lshl_b32 s65, s65, 15
s_or_b32 s64, s64, s65
s_lshr_b32 s65, s70, 3
s_lshl_b32 s65, s65, 16
s_add_u32 s64, s64, s65
s_lshr_b32 s65, s70, 4
s_lshl_b32 s65, s65, 2
s_and_b32 s67, s70, 7
s_add_u32 s65, s65, s67
s_lshl_b32 s65, s65, 7
s_add_u32 s64, s64, s65
s_add_u32 s64, s64, 1376256
s_add_u32 s65, s64, 4096
buffer_store_dwordx4 v[32:35], v1, s[36:39], s64 offen offset:0 sc1
buffer_store_dwordx4 v[32:35], v1, s[36:39], s64 offen offset:1024 sc1
buffer_store_dwordx4 v[32:35], v1, s[36:39], s64 offen offset:2048 sc1
buffer_store_dwordx4 v[32:35], v1, s[36:39], s64 offen offset:3072 sc1
buffer_store_dwordx4 v[32:35], v1, s[36:39], s65 offen offset:0 sc1
s_mov_b64 exec, 0xffffff
buffer_store_dwordx4 v[32:35], v1, s[36:39], s65 offen offset:1024 sc1
s_mov_b64 exec, -1
v_lshlrev_b32 v2, 2, v0
ds_read_b32 v8, v2 offset:4096
ds_read_b32 v9, v2 offset:4352
ds_read_b32 v10, v2 offset:4608
s_mov_b32 s56, s26
s_mov_b32 s57, s27
s_mov_b32 s58, 0x2000
s_mov_b32 s59, 0x20000
v_and_b32 v5, 15, v0
v_and_b32 v6, 16, v0
v_lshl_add_u32 v5, v6, 1, v5
v_and_b32 v6, 32, v0
v_lshrrev_b32 v6, 1, v6
v_add_u32 v5, v5, v6
v_lshlrev_b32 v5, 1, v5
v_and_b32 v6, 0x7c, v5
s_lshl_b32 s73, s70, 7
v_and_b32 v11, 1, v0
v_lshlrev_b32 v3, 4, v11
v_mov_b32 v7, 0x3f80
v_lshlrev_b32 v7, v3, v7
v_and_b32 v2, 4, v0
v_cmp_eq_u32 vcc, 0, v2
v_bfe_u32 v2, v0, 1, 1
v_mul_u32_u24 v43, 0xaaaa, v2
v_add_u32 v43, 0x4444, v43
v_cndmask_b32 v44, 0, v7, vcc
v_sub_u32 v45, v7, v44
v_mov_b32 v46, v44
v_mov_b32 v47, v45
v_mov_b32 v48, 0
v_mov_b32 v49, 0
v_mov_b32 v50, 0
v_mov_b32 v51, 0
v_mov_b32 v52, 0
v_mov_b32 v53, 0
v_mov_b32 v54, 0
v_mov_b32 v55, 0
s_add_u32 s68, s73, 1310720
s_mov_b32 s76, 0xaaaaaaaa
s_mov_b32 s77, 0xaaaaaaaa
v_cmp_gt_u32 vcc, 24, v0
v_mov_b32 v41, 0x40000000
v_lshl_add_u32 v12, v11, 13, v6
v_cndmask_b32 v41, v41, v1, vcc
s_mov_b32 s75, 0
s_waitcnt vmcnt(0) lgkmcnt(0)
buffer_load_dwordx4 v[16:19], v1, s[36:39], s66 offen offset:0 sc1
buffer_load_dwordx4 v[20:23], v1, s[36:39], s66 offen offset:1024 sc1
buffer_load_dwordx4 v[24:27], v1, s[36:39], s66 offen offset:2048 sc1
buffer_load_dwordx4 v[28:31], v1, s[36:39], s66 offen offset:3072 sc1
s_sleep 1
buffer_load_dwordx4 v[16:19], v1, s[36:39], s66 offen offset:0 sc1
buffer_load_dwordx4 v[20:23], v1, s[36:39], s66 offen offset:1024 sc1
buffer_load_dwordx4 v[24:27], v1, s[36:39], s66 offen offset:2048 sc1
buffer_load_dwordx4 v[28:31], v1, s[36:39], s66 offen offset:3072 sc1
s_sleep 1
buffer_load_dwordx4 v[16:19], v1, s[36:39], s66 offen offset:0 sc1
buffer_load_dwordx4 v[20:23], v1, s[36:39], s66 offen offset:1024 sc1
buffer_load_dwordx4 v[24:27], v1, s[36:39], s66 offen offset:2048 sc1
buffer_load_dwordx4 v[28:31], v1, s[36:39], s66 offen offset:3072 sc1
s_sleep 1
L_rn_170:
v_smfmac_f32_16x16x64_bf16 v[48:51], v[44:47], v[16:23], v43
v_smfmac_f32_16x16x64_bf16 v[48:51], v[44:47], v[24:31], v43
buffer_load_dwordx4 v[16:19], v1, s[36:39], s66 offen offset:0 sc1
buffer_load_dwordx4 v[20:23], v1, s[36:39], s66 offen offset:1024 sc1
buffer_load_dwordx4 v[24:27], v1, s[36:39], s66 offen offset:2048 sc1
buffer_load_dwordx4 v[28:31], v1, s[36:39], s66 offen offset:3072 sc1
s_add_u32 s75, s75, 1
s_and_b32 s78, s75, 15
s_nop 1
v_add_f32_dpp v13, v48, v48 row_ror:8 row_mask:0x3 bank_mask:0x3
v_add_f32_dpp v13, v49, v49 row_ror:8 row_mask:0x3 bank_mask:0xc
v_add_f32_dpp v13, v50, v50 row_ror:8 row_mask:0xc bank_mask:0x3
v_add_f32_dpp v13, v51, v51 row_ror:8 row_mask:0xc bank_mask:0xc
v_cmp_u_f32 vcc, v13, v13
s_cbranch_vccz L_rz_171
v_mov_b32 v48, 0
v_mov_b32 v49, 0
v_mov_b32 v50, 0
v_mov_b32 v51, 0
s_waitcnt vmcnt(12)
s_cbranch_scc1 L_rn_170
v_max3_u32 v2, v16, v17, v18
v_max3_u32 v2, v2, v19, v20
v_max3_u32 v2, v2, v21, v22
v_max3_u32 v2, v2, v23, v24
v_max3_u32 v2, v2, v25, v26
v_max3_u32 v2, v2, v27, v28
v_max3_u32 v2, v2, v29, v30
v_max_u32 v2, v2, v31
v_cmp_eq_u32 vcc, -1, v2
s_cbranch_vccz L_rx_169
s_cmp_lt_u32 s75, 0x100000
s_cbranch_scc1 L_rn_170
L_rx_169:
v_smfmac_f32_16x16x64_bf16 v[48:51], v[44:47], v[16:23], v43
v_smfmac_f32_16x16x64_bf16 v[48:51], v[44:47], v[24:31], v43
s_nop 7
v_add_f32_dpp v13, v48, v48 row_ror:8 row_mask:0x3 bank_mask:0x3
v_add_f32_dpp v13, v49, v49 row_ror:8 row_mask:0x3 bank_mask:0xc
v_add_f32_dpp v13, v50, v50 row_ror:8 row_mask:0xc bank_mask:0x3
v_add_f32_dpp v13, v51, v51 row_ror:8 row_mask:0xc bank_mask:0xc
L_rz_171:
v_fmac_f32 v8, v13, v9
s_nop 1
v_mov_b32_dpp v14, v8 quad_perm:[1,1,3,3] row_mask:0xf bank_mask:0xf
v_mov_b32_dpp v13, v8 quad_perm:[0,0,2,2] row_mask:0xf bank_mask:0xf
v_cvt_pk_bf16_f32 v13, v13, v14
buffer_store_dword v13, v12, s[36:39], s68 offen sc1
v_cvt_pk_bf16_f32 v8, 0, v8
buffer_load_dwordx4 v[64:67], v1, s[36:39], s64 offen offset:0 sc1
buffer_load_dwordx4 v[68:71], v1, s[36:39], s64 offen offset:1024 sc1
buffer_load_dwordx4 v[72:75], v1, s[36:39], s64 offen offset:2048 sc1
buffer_load_dwordx4 v[76:79], v1, s[36:39], s64 offen offset:3072 sc1
buffer_load_dwordx4 v[80:83], v1, s[36:39], s65 offen offset:0 sc1
buffer_load_dwordx4 v[84:87], v41, s[36:39], s65 offen offset:1024 sc1
s_mov_b32 s75, 0
s_waitcnt vmcnt(0)
buffer_load_dwordx4 v[64:67], v1, s[36:39], s64 offen offset:0 sc1
buffer_load_dwordx4 v[68:71], v1, s[36:39], s64 offen offset:1024 sc1
buffer_load_dwordx4 v[72:75], v1, s[36:39], s64 offen offset:2048 sc1
buffer_load_dwordx4 v[76:79], v1, s[36:39], s64 offen offset:3072 sc1
buffer_load_dwordx4 v[80:83], v1, s[36:39], s65 offen offset:0 sc1
buffer_load_dwordx4 v[84:87], v41, s[36:39], s65 offen offset:1024 sc1
s_sleep 1
buffer_load_dwordx4 v[64:67], v1, s[36:39], s64 offen offset:0 sc1
buffer_load_dwordx4 v[68:71], v1, s[36:39], s64 offen offset:1024 sc1
buffer_load_dwordx4 v[72:75], v1, s[36:39], s64 offen offset:2048 sc1
buffer_load_dwordx4 v[76:79], v1, s[36:39], s64 offen offset:3072 sc1
buffer_load_dwordx4 v[80:83], v1, s[36:39], s65 offen offset:0 sc1
buffer_load_dwordx4 v[84:87], v41, s[36:39], s65 offen offset:1024 sc1
s_sleep 1
L_rn_174:
v_smfmac_f32_16x16x64_bf16 v[52:55], v[44:47], v[64:71], v43
v_smfmac_f32_16x16x64_bf16 v[52:55], v[44:47], v[72:79], v43
v_smfmac_f32_16x16x64_bf16 v[52:55], v[44:47], v[80:87], v43
buffer_load_dwordx4 v[64:67], v1, s[36:39], s64 offen offset:0 sc1
buffer_load_dwordx4 v[68:71], v1, s[36:39], s64 offen offset:1024 sc1
buffer_load_dwordx4 v[72:75], v1, s[36:39], s64 offen offset:2048 sc1
buffer_load_dwordx4 v[76:79], v1, s[36:39], s64 offen offset:3072 sc1
buffer_load_dwordx4 v[80:83], v1, s[36:39], s65 offen offset:0 sc1
buffer_load_dwordx4 v[84:87], v41, s[36:39], s65 offen offset:1024 sc1
s_add_u32 s75, s75, 1
s_and_b32 s78, s75, 15
v_add_f32_dpp v13, v52, v52 row_ror:8 row_mask:0x3 bank_mask:0x3
v_add_f32_dpp v13, v53, v53 row_ror:8 row_mask:0x3 bank_mask:0xc
v_add_f32_dpp v13, v54, v54 row_ror:8 row_mask:0xc bank_mask:0x3
v_add_f32_dpp v13, v55, v55 row_ror:8 row_mask:0xc bank_mask:0xc
v_cmp_u_f32 vcc, v13, v13
s_cbranch_vccz L_rz_175
v_mov_b32 v52, 0
v_mov_b32 v53, 0
v_mov_b32 v54, 0
v_mov_b32 v55, 0
s_waitcnt vmcnt(12)
s_cbranch_scc1 L_rn_174
v_max3_u32 v2, v64, v65, v66
v_max3_u32 v2, v2, v67, v68
v_max3_u32 v2, v2, v69, v70
v_max3_u32 v2, v2, v71, v72
v_max3_u32 v2, v2, v73, v74
v_max3_u32 v2, v2, v75, v76
v_max3_u32 v2, v2, v77, v78
v_max3_u32 v2, v2, v79, v80
v_max3_u32 v2, v2, v81, v82
v_max3_u32 v2, v2, v83, v84
v_max3_u32 v2, v2, v85, v86
v_max_u32 v2, v2, v87
v_cmp_eq_u32 vcc, -1, v2
s_cbranch_vccz L_rx_173
s_cmp_lt_u32 s75, 0x100000
s_cbranch_scc1 L_rn_174
L_rx_173:
v_smfmac_f32_16x16x64_bf16 v[52:55], v[44:47], v[64:71], v43
v_smfmac_f32_16x16x64_bf16 v[52:55], v[44:47], v[72:79], v43
v_smfmac_f32_16x16x64_bf16 v[52:55], v[44:47], v[80:87], v43
s_nop 7
v_add_f32_dpp v13, v52, v52 row_ror:8 row_mask:0x3 bank_mask:0x3
v_add_f32_dpp v13, v53, v53 row_ror:8 row_mask:0x3 bank_mask:0xc
v_add_f32_dpp v13, v54, v54 row_ror:8 row_mask:0xc bank_mask:0x3
v_add_f32_dpp v13, v55, v55 row_ror:8 row_mask:0xc bank_mask:0xc
L_rz_175:
v_fmac_f32 v8, v13, v10
s_nop 1
v_mov_b32_dpp v14, v8 quad_perm:[1,1,3,3] row_mask:0xf bank_mask:0xf
s_not_b64 exec, s[76:77]
v_cvt_pk_bf16_f32 v13, v8, v14
buffer_store_dword v13, v6, s[56:59], s73 offen sc1
s_mov_b64 exec, -1
s_cmp_lt_u32 s70, 8
s_cbranch_scc0 L_fin2
s_mov_b64 exec, 0xffff
buffer_store_dwordx4 v[44:47], v1, s[36:39], s62 offen sc1
s_mov_b64 exec, -1
L_fin2:
s_endpgm
L_ffn:
s_mul_i32 s67, s3, 12288
s_add_u32 s67, s67, 25600
v_lshlrev_b32 v7, 3, v0
buffer_load_dwordx4 v[8:11], v1, s[36:39], s67 offen offset:0 sc1
buffer_load_dwordx4 v[12:15], v1, s[36:39], s67 offen offset:1024 sc1
s_cmp_lt_u32 s3, 4
s_cbranch_scc1 L_post_176
s_mov_b32 s40, s16
s_mov_b32 s41, s17
s_mov_b32 s42, 0x158000
s_mov_b32 s43, 0x20000
s_mov_b32 s56, s18
s_mov_b32 s57, s19
s_mov_b32 s58, 0x158000
s_mov_b32 s59, 0x20000
v_lshrrev_b32 v16, 2, v0
v_mul_u32_u24 v16, 2752, v16
v_and_b32 v17, 3, v0
v_lshrrev_b32 v18, 5, v0
v_xor_b32 v17, v17, v18
v_xor_b32 v18, 2, v17
v_lshl_add_u32 v17, v17, 4, v16
v_lshl_add_u32 v18, v18, 4, v16
s_mul_i32 s64, s34, 352256
s_lshl_b32 s65, s74, 6
s_add_u32 s64, s64, s65
s_lshl_b32 s65, s34, 13
s_add_u32 m0, s65, 4096
s_add_u32 s66, s64, 0
buffer_load_dwordx4 v17, s[40:43], s66 offen  lds
s_add_u32 m0, s65, 36864
s_add_u32 s66, s64, 0
buffer_load_dwordx4 v18, s[56:59], s66 offen  lds
s_add_u32 m0, s65, 5120
s_add_u32 s66, s64, 44032
buffer_load_dwordx4 v17, s[40:43], s66 offen  lds
s_add_u32 m0, s65, 37888
s_add_u32 s66, s64, 44032
buffer_load_dwordx4 v18, s[56:59], s66 offen  lds
s_add_u32 m0, s65, 6144
s_add_u32 s66, s64, 88064
buffer_load_dwordx4 v17, s[40:43], s66 offen  lds
s_add_u32 m0, s65, 38912
s_add_u32 s66, s64, 88064
buffer_load_dwordx4 v18, s[56:59], s66 offen  lds
s_add_u32 m0, s65, 7168
s_add_u32 s66, s64, 132096
buffer_load_dwordx4 v17, s[40:43], s66 offen  lds
s_add_u32 m0, s65, 39936
s_add_u32 s66, s64, 132096
buffer_load_dwordx4 v18, s[56:59], s66 offen  lds
s_add_u32 m0, s65, 8192
s_add_u32 s66, s64, 176128
buffer_load_dwordx4 v17, s[40:43], s66 offen  lds
s_add_u32 m0, s65, 40960
s_add_u32 s66, s64, 176128
buffer_load_dwordx4 v18, s[56:59], s66 offen  lds
s_add_u32 m0, s65, 9216
s_add_u32 s66, s64, 220160
buffer_load_dwordx4 v17, s[40:43], s66 offen  lds
s_add_u32 m0, s65, 41984
s_add_u32 s66, s64, 220160
buffer_load_dwordx4 v18, s[56:59], s66 offen  lds
s_add_u32 m0, s65, 10240
s_add_u32 s66, s64, 264192
buffer_load_dwordx4 v17, s[40:43], s66 offen  lds
s_add_u32 m0, s65, 43008
s_add_u32 s66, s64, 264192
buffer_load_dwordx4 v18, s[56:59], s66 offen  lds
s_add_u32 m0, s65, 11264
s_add_u32 s66, s64, 308224
buffer_load_dwordx4 v17, s[40:43], s66 offen  lds
s_add_u32 m0, s65, 44032
s_add_u32 s66, s64, 308224
buffer_load_dwordx4 v18, s[56:59], s66 offen  lds
s_waitcnt vmcnt(16)
s_branch L_post_177
L_post_176:
s_waitcnt vmcnt(0)
L_post_177:
v_max3_u32 v16, v8, v9, v10
v_max3_u32 v16, v16, v11, v12
v_max3_u32 v16, v16, v13, v14
v_max_u32 v16, v16, v15
v_cmp_eq_u32 vcc, -1, v16
s_cbranch_vccz L_cb_178
s_mov_b32 s75, 0
L_poll_179:
buffer_load_dwordx4 v[8:11], v1, s[36:39], s67 offen offset:0 sc1
buffer_load_dwordx4 v[12:15], v1, s[36:39], s67 offen offset:1024 sc1
s_waitcnt vmcnt(0)
v_max3_u32 v16, v8, v9, v10
v_max3_u32 v16, v16, v11, v12
v_max3_u32 v16, v16, v13, v14
v_max_u32 v16, v16, v15
v_cmp_eq_u32 vcc, -1, v16
s_cbranch_vccz L_pollx_180
s_add_u32 s75, s75, 1
s_cmp_lt_u32 s75, 0x100000
s_cbranch_scc1 L_poll_179
L_pollx_180:
L_cb_178:
s_mov_b32 s68, 0xffff0000
v_lshlrev_b32 v24, 16, v8
v_and_b32 v25, s68, v8
v_lshlrev_b32 v32, 16, v12
v_and_b32 v33, s68, v12
v_lshlrev_b32 v26, 16, v9
v_and_b32 v27, s68, v9
v_lshlrev_b32 v34, 16, v13
v_and_b32 v35, s68, v13
v_lshlrev_b32 v28, 16, v10
v_and_b32 v29, s68, v10
v_lshlrev_b32 v36, 16, v14
v_and_b32 v37, s68, v14
v_lshlrev_b32 v30, 16, v11
v_and_b32 v31, s68, v11
v_lshlrev_b32 v38, 16, v15
v_and_b32 v39, s68, v15
v_add_f32 v32, 1.0, v32
v_add_f32 v33, 1.0, v33
v_add_f32 v34, 1.0, v34
v_add_f32 v35, 1.0, v35
v_add_f32 v36, 1.0, v36
v_add_f32 v37, 1.0, v37
v_add_f32 v38, 1.0, v38
v_add_f32 v39, 1.0, v39
v_lshrrev_b32 v2, 3, v0
v_bfe_u32 v3, v0, 1, 3
v_and_b32 v4, 3, v3
s_lshl_b32 s64, s3, 1
v_xor_b32 v3, s64, v3
v_lshlrev_b32 v5, 10, v2
v_lshl_add_u32 v5, v4, 8, v5
v_lshl_add_u32 v5, v3, 4, v5
v_and_b32 v4, 1, v0
v_lshl_add_u32 v5, v4, 3, v5
v_add_u32 v5, 69632, v5
v_xor_b32 v6, 16, v5
v_mul_u32_u24 v16, 0xaaaa, v4
v_add_u32 v16, 0x4444, v16
v_lshrrev_b32 v2, 4, v0
v_bfe_u32 v3, v0, 3, 1
v_xor_b32 v7, v2, v0
v_lshlrev_b32 v7, 4, v7
v_add_u32 v7, 69632, v7
v_xor_b32 v8, 64, v7
v_and_b32 v4, 7, v0
v_and_b32 v9, 0x38, v0
v_lshlrev_b32 v9, 3, v9
v_lshl_add_u32 v9, v4, 1, v9
s_lshl_b32 s64, s34, 4
v_add_u32 v9, s64, v9
v_and_b32 v10, 12, v0
v_lshlrev_b32 v10, 5, v10
v_and_b32 v4, 1, v0
v_lshl_add_u32 v10, v4, 6, v10
v_lshl_add_u32 v10, v2, 4, v10
v_mov_b32 v17, 0xbfb8aa3b
v_mov_b32 v64, 0
v_mov_b32 v65, 0
v_mov_b32 v66, 0
v_mov_b32 v67, 0
s_lshl_b32 s64, s34, 3
s_lshr_b32 s64, s35, s64
v_lshlrev_b32 v3, 2, v3
v_bfe_u32 v3, s64, v3, 3
v_and_b32 v11, 6, v3
v_lshlrev_b32 v11, 12, v11
v_and_b32 v3, 1, v3
v_lshl_add_u32 v11, v3, 15, v11
v_lshl_add_u32 v11, v2, 17, v11
v_and_b32 v4, 240, v1
v_add_u32 v11, v11, v4
v_lshl_add_u32 v11, v2, 9, v11
s_lshl_b32 s64, s34, 8
v_add_u32 v11, s64, v11
s_lshl_b32 s69, s74, 7
s_add_u32 s69, s69, 1376256
s_add_u32 s72, s69, 65536
s_lshl_b32 s64, s3, 10
s_lshl_b32 s65, s2, 2
s_lshr_b32 s65, s35, s65
s_and_b32 s65, s65, 2
s_lshl_b32 s65, s65, 12
s_add_u32 s64, s64, s65
s_add_u32 s64, s64, 1310720
v_mov_b32 v14, 0xbb000000
v_mov_b32 v15, 0x3b000000
v_lshrrev_b32 v18, 4, v0
v_bfe_u32 v19, v0, 2, 2
v_bfe_u32 v20, v0, 1, 1
v_and_b32 v22, 1, v18
v_lshl_add_u32 v22, v20, 1, v22
v_xor_b32 v22, s34, v22
v_lshlrev_b32 v22, 4, v22
v_lshl_add_u32 v22, v20, 15, v22
v_lshl_add_u32 v22, v18, 9, v22
v_lshl_add_u32 v22, v19, 6, v22
v_and_b32 v20, 1, v0
v_lshl_add_u32 v22, v20, 3, v22
v_add_u32 v22, 4096, v22
s_lshr_b32 s73, s3, 2
s_waitcnt vmcnt(0)
s_barrier
buffer_load_dwordx4 v[56:59], v1, s[36:39], s64 offen sc1
s_cmp_eq_u32 s73, 0
s_cbranch_scc1 L_gu_182
ds_read_b64_tr_b16 v[128:129], v22 offset:0
ds_read_b64_tr_b16 v[130:131], v22 offset:256
ds_read_b64_tr_b16 v[132:133], v22 offset:2048
ds_read_b64_tr_b16 v[134:135], v22 offset:2304
ds_read_b64_tr_b16 v[136:137], v22 offset:4096
ds_read_b64_tr_b16 v[138:139], v22 offset:4352
ds_read_b64_tr_b16 v[140:141], v22 offset:6144
ds_read_b64_tr_b16 v[142:143], v22 offset:6400
ds_read_b64_tr_b16 v[144:145], v22 offset:8192
ds_read_b64_tr_b16 v[146:147], v22 offset:8448
ds_read_b64_tr_b16 v[148:149], v22 offset:10240
s_waitcnt lgkmcnt(4)
ds_read_b64_tr_b16 v[150:151], v22 offset:10496
ds_read_b64_tr_b16 v[152:153], v22 offset:12288
ds_read_b64_tr_b16 v[154:155], v22 offset:12544
ds_read_b64_tr_b16 v[156:157], v22 offset:14336
ds_read_b64_tr_b16 v[158:159], v22 offset:14592
ds_read_b64_tr_b16 v[160:161], v22 offset:16384
ds_read_b64_tr_b16 v[162:163], v22 offset:16640
ds_read_b64_tr_b16 v[164:165], v22 offset:18432
ds_read_b64_tr_b16 v[166:167], v22 offset:18688
ds_read_b64_tr_b16 v[168:169], v22 offset:20480
ds_read_b64_tr_b16 v[170:171], v22 offset:20736
s_waitcnt lgkmcnt(4)
ds_read_b64_tr_b16 v[172:173], v22 offset:22528
ds_read_b64_tr_b16 v[174:175], v22 offset:22784
ds_read_b64_tr_b16 v[176:177], v22 offset:24576
ds_read_b64_tr_b16 v[178:179], v22 offset:24832
ds_read_b64_tr_b16 v[180:181], v22 offset:26624
ds_read_b64_tr_b16 v[182:183], v22 offset:26880
ds_read_b64_tr_b16 v[184:185], v22 offset:28672
ds_read_b64_tr_b16 v[186:187], v22 offset:28928
ds_read_b64_tr_b16 v[188:189], v22 offset:30720
ds_read_b64_tr_b16 v[190:191], v22 offset:30976
L_gu_182:
s_cmp_lt_u32 s3, 4
s_cbranch_scc0 L_dma_183
s_mov_b32 s48, s20
s_mov_b32 s49, s21
s_mov_b32 s50, 0x158000
s_mov_b32 s51, 0x20000
v_lshrrev_b32 v18, 4, v0
v_and_b32 v16, 15, v0
v_xor_b32 v16, v16, v18
v_xor_b32 v17, 4, v16
v_lshlrev_b32 v19, 10, v18
v_lshl_add_u32 v22, v16, 4, v19
v_lshl_add_u32 v23, v17, 4, v19
s_lshl_b32 s76, s74, 15
s_lshl_b32 s66, s34, 8
s_add_u32 s76, s76, s66
s_lshl_b32 s77, s34, 13
s_add_u32 s77, s77, 77824
v_bfe_u32 v19, v0, 2, 2
v_and_b32 v16, 2, v0
v_lshlrev_b32 v16, 2, v16
v_xor_b32 v16, v16, v19
v_and_b32 v17, 1, v18
v_lshlrev_b32 v17, 2, v17
v_xor_b32 v16, v16, v17
v_lshlrev_b32 v16, 4, v16
v_lshl_add_u32 v16, v18, 10, v16
v_lshl_add_u32 v16, v19, 8, v16
v_and_b32 v17, 1, v0
v_lshl_add_u32 v16, v17, 3, v16
v_add_u32 v68, s77, v16
v_xor_b32 v69, 16, v68
v_xor_b32 v70, 32, v68
v_xor_b32 v71, 48, v68
v_xor_b32 v72, 64, v68
v_xor_b32 v73, 80, v68
v_xor_b32 v74, 96, v68
v_xor_b32 v75, 112, v68
s_add_u32 m0, s77, 0
s_xor_b32 s66, s76, 0
buffer_load_dwordx4 v22, s[48:51], s66 offen  lds
s_add_u32 m0, s77, 1024
s_xor_b32 s66, s76, 8192
buffer_load_dwordx4 v23, s[48:51], s66 offen  lds
s_add_u32 m0, s77, 2048
s_xor_b32 s66, s76, 16384
buffer_load_dwordx4 v22, s[48:51], s66 offen  lds
s_add_u32 m0, s77, 3072
s_xor_b32 s66, s76, 24576
buffer_load_dwordx4 v23, s[48:51], s66 offen  lds
s_add_u32 m0, s77, 4096
s_xor_b32 s66, s76, 4096
buffer_load_dwordx4 v22, s[48:51], s66 offen  lds
s_add_u32 m0, s77, 5120
s_xor_b32 s66, s76, 12288
buffer_load_dwordx4 v23, s[48:51], s66 offen  lds
s_add_u32 m0, s77, 6144
s_xor_b32 s66, s76, 20480
buffer_load_dwordx4 v22, s[48:51], s66 offen  lds
s_waitcnt vmcnt(7)
s_branch L_dma_184
L_dma_183:
s_waitcnt vmcnt(0)
L_dma_184:
s_mov_b32 s73, 0x3f803f80
v_mov_b32 v20, 0
v_mov_b32 v21, 0
v_max3_u32 v12, v56, v57, v58
v_max_u32 v12, v12, v59
v_cmp_eq_u32 vcc, -1, v12
s_cbranch_vccz L_x_181
buffer_load_dwordx4 v[56:59], v1, s[36:39], s64 offen sc1
s_sleep 1
s_mov_b32 s75, 0
L_poll_185:
buffer_load_dwordx4 v[56:59], v1, s[36:39], s64 offen sc1
s_waitcnt vmcnt(1)
v_max3_u32 v12, v56, v57, v58
v_max_u32 v12, v12, v59
v_cmp_eq_u32 vcc, -1, v12
s_cbranch_vccz L_pollx_186
s_add_u32 s75, s75, 1
s_cmp_lt_u32 s75, 0x100000
s_cbranch_scc1 L_poll_185
L_pollx_186:
L_x_181:
v_dot2c_f32_bf16 v20, s73, v56
v_dot2c_f32_bf16 v21, v56, v56
v_dot2c_f32_bf16 v20, s73, v57
v_dot2c_f32_bf16 v21, v57, v57
v_dot2c_f32_bf16 v20, s73, v58
v_dot2c_f32_bf16 v21, v58, v58
v_dot2c_f32_bf16 v20, s73, v59
v_dot2c_f32_bf16 v21, v59, v59
v_lshlrev_b32 v40, 16, v56
v_and_b32 v41, s68, v56
v_lshlrev_b32 v42, 16, v57
v_permlane32_swap_b32 v20, v21
v_add_f32 v12, v20, v21
v_and_b32 v43, s68, v57
v_lshlrev_b32 v44, 16, v58
v_add_f32_dpp v12, v12, v12 quad_perm:[1,0,3,2] row_mask:0xf bank_mask:0xf
v_and_b32 v45, s68, v58
v_lshlrev_b32 v46, 16, v59
v_add_f32_dpp v12, v12, v12 quad_perm:[2,3,0,1] row_mask:0xf bank_mask:0xf
v_and_b32 v47, s68, v59
v_pk_mul_f32 v[48:49], v[40:41], v[32:33]
v_add_f32_dpp v12, v12, v12 row_ror:4 row_mask:0xf bank_mask:0xf
v_pk_mul_f32 v[50:51], v[42:43], v[34:35]
v_pk_mul_f32 v[52:53], v[44:45], v[36:37]
v_add_f32_dpp v12, v12, v12 row_ror:8 row_mask:0xf bank_mask:0xf
v_pk_mul_f32 v[54:55], v[46:47], v[38:39]
s_nop 0
v_add_f32_dpp v12, v12, v12 row_bcast:15 row_mask:0xa bank_mask:0xf
s_nop 0
v_readlane_b32 s70, v12, 16
v_readlane_b32 s71, v12, 48
s_nop 0
v_mul_f32 v12, s70, v14
v_mul_f32 v13, s71, v15
v_fma_f32 v13, -v12, v12, v13
v_max_f32 v13, 0, v13
v_add_f32 v13, 0x3727c5ac, v13
v_rsq_f32 v2, v13
v_pk_fma_f32 v[48:49], v[12:13], v[32:33], v[48:49] op_sel_hi:[0,1,1]
v_pk_fma_f32 v[50:51], v[12:13], v[34:35], v[50:51] op_sel_hi:[0,1,1]
v_pk_fma_f32 v[52:53], v[12:13], v[36:37], v[52:53] op_sel_hi:[0,1,1]
v_pk_fma_f32 v[54:55], v[12:13], v[38:39], v[54:55] op_sel_hi:[0,1,1]
v_pk_fma_f32 v[24:25], v[2:3], v[48:49], v[24:25] op_sel_hi:[0,1,1]
v_pk_fma_f32 v[28:29], v[2:3], v[52:53], v[28:29] op_sel_hi:[0,1,1]
v_pk_fma_f32 v[26:27], v[2:3], v[50:51], v[26:27] op_sel_hi:[0,1,1]
v_pk_fma_f32 v[30:31], v[2:3], v[54:55], v[30:31] op_sel_hi:[0,1,1]
v_cvt_pk_bf16_f32 v40, v24, v25
v_cvt_pk_bf16_f32 v41, v28, v29
ds_write_b64 v5, v[40:41]
v_cvt_pk_bf16_f32 v42, v26, v27
v_cvt_pk_bf16_f32 v43, v30, v31
ds_write_b64 v6, v[42:43]
s_cmp_lt_u32 s3, 4
s_cbranch_scc0 L_dma_187
s_mov_b32 s48, s20
s_mov_b32 s49, s21
s_mov_b32 s50, 0x158000
s_mov_b32 s51, 0x20000
s_add_u32 m0, s77, 7168
s_xor_b32 s66, s76, 28672
buffer_load_dwordx4 v23, s[48:51], s66 offen  lds
L_dma_187:
s_cmp_lt_u32 s3, 4
s_waitcnt lgkmcnt(0)
s_barrier
s_cbranch_scc1 L_bar_fin
ds_read_b128 v[192:195], v7 offset:0
ds_read_b128 v[196:199], v8 offset:1024
ds_read_b128 v[200:203], v7 offset:2048
ds_read_b128 v[204:207], v8 offset:3072
ds_read_b128 v[208:211], v7 offset:4096
ds_read_b128 v[212:215], v8 offset:5120
ds_read_b128 v[216:219], v7 offset:6144
ds_read_b128 v[220:223], v8 offset:7168
s_waitcnt lgkmcnt(7)
v_smfmac_f32_16x16x64_bf16 v[64:67], v[192:195], v[128:135], v16
s_waitcnt lgkmcnt(6)
v_smfmac_f32_16x16x64_bf16 v[64:67], v[196:199], v[136:143], v16
s_waitcnt lgkmcnt(5)
v_smfmac_f32_16x16x64_bf16 v[64:67], v[200:203], v[144:151], v16
s_waitcnt lgkmcnt(4)
v_smfmac_f32_16x16x64_bf16 v[64:67], v[204:207], v[152:159], v16
s_waitcnt lgkmcnt(3)
v_smfmac_f32_16x16x64_bf16 v[64:67], v[208:211], v[160:167], v16
s_waitcnt lgkmcnt(2)
v_smfmac_f32_16x16x64_bf16 v[64:67], v[212:215], v[168:175], v16
s_waitcnt lgkmcnt(1)
v_smfmac_f32_16x16x64_bf16 v[64:67], v[216:219], v[176:183], v16
s_waitcnt lgkmcnt(0)
v_smfmac_f32_16x16x64_bf16 v[64:67], v[220:223], v[184:191], v16
s_nop 7
v_add_f32 v66, v66, v67
v_add_f32 v64, v64, v65
v_mul_f32 v18, v64, v17
v_mul_f32_dpp v18, v66, v17 row_ror:8 row_mask:0xf bank_mask:0xc
v_exp_f32 v18, v18
v_mov_b32_dpp v66, v64 row_ror:8 row_mask:0xf bank_mask:0x3
v_add_f32 v18, 1.0, v18
v_rcp_f32 v18, v18
s_nop 0
v_mul_f32 v18, v18, v66
v_cvt_pk_bf16_f32 v18, v18, v18
ds_write_b16 v9, v18 offset:3584
s_waitcnt lgkmcnt(0)
s_barrier
s_endpgm
L_bar_fin:
s_waitcnt vmcnt(0)
ds_read_b64_tr_b16 v[96:97], v68 offset:0
ds_read_b64_tr_b16 v[98:99], v68 offset:4096
ds_read_b64_tr_b16 v[100:101], v69 offset:0
ds_read_b64_tr_b16 v[102:103], v69 offset:4096
ds_read_b64_tr_b16 v[104:105], v70 offset:0
ds_read_b64_tr_b16 v[106:107], v70 offset:4096
ds_read_b64_tr_b16 v[108:109], v71 offset:0
ds_read_b64_tr_b16 v[110:111], v71 offset:4096
ds_read_b64_tr_b16 v[112:113], v72 offset:0
ds_read_b64_tr_b16 v[114:115], v72 offset:4096
ds_read_b64_tr_b16 v[116:117], v73 offset:0
s_waitcnt lgkmcnt(4)
ds_read_b64_tr_b16 v[118:119], v73 offset:4096
ds_read_b64_tr_b16 v[120:121], v74 offset:0
ds_read_b64_tr_b16 v[122:123], v74 offset:4096
ds_read_b64_tr_b16 v[124:125], v75 offset:0
ds_read_b64_tr_b16 v[126:127], v75 offset:4096
s_waitcnt lgkmcnt(0)
s_barrier
ds_read_b128 v[48:51], v10 offset:3584
s_waitcnt lgkmcnt(0)
v_mfma_f32_16x16x32_bf16 v[192:195], v[48:51], v[96:99], 0
v_mfma_f32_16x16x32_bf16 v[196:199], v[48:51], v[100:103], 0
v_mfma_f32_16x16x32_bf16 v[200:203], v[48:51], v[104:107], 0
s_nop 1
v_mfma_f32_16x16x32_bf16 v[204:207], v[48:51], v[108:111], 0
s_nop 1
v_mfma_f32_16x16x32_bf16 v[208:211], v[48:51], v[112:115], 0
s_nop 0
v_cvt_pk_bf16_f32 v16, v192, v196
v_mfma_f32_16x16x32_bf16 v[212:215], v[48:51], v[116:119], 0
v_cvt_pk_bf16_f32 v20, v193, v197
v_mfma_f32_16x16x32_bf16 v[216:219], v[48:51], v[120:123], 0
v_cvt_pk_bf16_f32 v17, v200, v204
v_cvt_pk_bf16_f32 v21, v201, v205
v_mfma_f32_16x16x32_bf16 v[220:223], v[48:51], v[124:127], 0
s_nop 2
v_cvt_pk_bf16_f32 v18, v208, v212
v_cvt_pk_bf16_f32 v22, v209, v213
s_nop 2
v_cvt_pk_bf16_f32 v19, v216, v220
buffer_store_dwordx4 v[16:19], v11, s[36:39], s69 offen sc1
v_cvt_pk_bf16_f32 v23, v217, v221
buffer_store_dwordx4 v[20:23], v11, s[36:39], s72 offen sc1
s_endpgm
s_endpgm
L_srest:
s_lshr_b32 s32, s2, 5
s_and_b32 s33, s2, 31
s_and_b32 s67, s2, 7
s_lshr_b32 s68, s2, 3
s_sub_u32 s68, s68, 26
s_min_u32 s74, s67, 3
s_mul_i32 s66, s67, 5
s_add_u32 s74, s74, s66
s_add_u32 s74, s74, s68
s_cmp_lt_u32 s67, 3
s_cselect_b32 s66, 6, 5
s_cmp_lt_u32 s68, s66
s_cselect_b32 s74, s74, -1
s_cmp_lt_u32 s2, 48
s_cselect_b32 s66, 2, 3
s_cselect_b32 s72, 14+26, 42+26
s_cmp_lt_u32 s2, 16
s_cselect_b32 s66, 1, s66
s_cselect_b32 s72, 26, s72
s_lshl_b32 s66, s67, s66
s_add_u32 s72, s72, s66
s_add_u32 s72, s72, s68
s_mov_b32 s36, s30
s_mov_b32 s37, s31
s_mov_b32 s38, 0x1d0000
s_mov_b32 s39, 0x20000
s_mov_b32 s52, s28
s_mov_b32 s53, s29
s_mov_b32 s54, 0x100
s_mov_b32 s55, 0x20000
s_mov_b32 s46, 0x40000
s_mov_b32 s47, 0x20000
s_cmp_eq_u32 s74, -1
s_mov_b32 s69, 30
s_cselect_b32 s69, 20, s69
s_cmp_lt_u32 s2, 144
s_cselect_b32 s69, 0, s69
s_cmp_lt_u32 s2, 112
s_cselect_b32 s69, 50, s69
s_cmp_lt_u32 s2, 48
s_cselect_b32 s69, 30, s69
s_cmp_lt_u32 s2, 16
s_cselect_b32 s69, 40, s69
s_and_b32 s66, s72, 7
s_cmp_eq_u32 s66, 3
s_cselect_b32 s66, 40, 0
s_cmp_lt_u32 s2, 112
s_cselect_b32 s66, s66, 0
s_add_u32 s69, s69, s66
s_xor_b32 s64, s65, 1024
s_cmpk_gt_u32 s69, 4
s_cbranch_scc1 L_d_1
s_waitcnt vmcnt(3)
L_d_1:
buffer_load_dwordx4 v[24:27], v1, s[40:43], s64 offen nt
s_xor_b32 s64, s65, 66560
s_cmpk_gt_u32 s69, 5
s_cbranch_scc1 L_d_2
s_waitcnt vmcnt(3)
L_d_2:
buffer_load_dwordx4 v[28:31], v1, s[40:43], s64 offen nt
s_xor_b32 s64, s65, 3072
s_cmpk_gt_u32 s69, 6
s_cbranch_scc1 L_d_3
s_waitcnt vmcnt(3)
L_d_3:
buffer_load_dwordx4 v[32:35], v1, s[40:43], s64 offen nt
s_xor_b32 s64, s65, 68608
s_cmpk_gt_u32 s69, 7
s_waitcnt vmcnt(6)
s_cbranch_scc1 L_d_4
s_waitcnt vmcnt(3)
L_d_4:
buffer_load_dwordx4 v[36:39], v1, s[40:43], s64 offen nt
s_xor_b32 s64, s65, 32768
s_cmpk_gt_u32 s69, 8
s_waitcnt vmcnt(6)
s_cbranch_scc1 L_d_5
s_waitcnt vmcnt(3)
L_d_5:
buffer_load_dwordx4 v[40:43], v1, s[40:43], s64 offen nt
s_xor_b32 s64, s65, 98304
s_cmpk_gt_u32 s69, 9
s_waitcnt vmcnt(6)
s_cbranch_scc1 L_d_6
s_waitcnt vmcnt(3)
L_d_6:
buffer_load_dwordx4 v[44:47], v1, s[40:43], s64 offen nt
s_xor_b32 s64, s65, 34816
s_cmpk_gt_u32 s69, 10
s_waitcnt vmcnt(6)
s_cbranch_scc1 L_d_7
s_waitcnt vmcnt(3)
L_d_7:
buffer_load_dwordx4 v[48:51], v1, s[40:43], s64 offen nt
s_xor_b32 s64, s65, 100352
s_cmpk_gt_u32 s69, 11
s_waitcnt vmcnt(6)
s_cbranch_scc1 L_d_8
s_waitcnt vmcnt(3)
L_d_8:
buffer_load_dwordx4 v[52:55], v1, s[40:43], s64 offen nt
s_xor_b32 s64, s65, 33792
s_cmpk_gt_u32 s69, 12
s_waitcnt vmcnt(6)
s_cbranch_scc1 L_d_9
s_waitcnt vmcnt(3)
L_d_9:
buffer_load_dwordx4 v[56:59], v1, s[40:43], s64 offen nt
s_xor_b32 s64, s65, 99328
s_cmpk_gt_u32 s69, 13
s_waitcnt vmcnt(6)
s_cbranch_scc1 L_d_10
s_waitcnt vmcnt(3)
L_d_10:
buffer_load_dwordx4 v[60:63], v1, s[40:43], s64 offen nt
s_xor_b32 s64, s65, 35840
s_cmpk_gt_u32 s69, 14
s_waitcnt vmcnt(6)
s_cbranch_scc1 L_d_11
s_waitcnt vmcnt(3)
L_d_11:
buffer_load_dwordx4 v[64:67], v1, s[40:43], s64 offen nt
s_xor_b32 s64, s65, 101376
s_cmpk_gt_u32 s69, 15
s_waitcnt vmcnt(6)
s_cbranch_scc1 L_d_12
s_waitcnt vmcnt(3)
L_d_12:
buffer_load_dwordx4 v[68:71], v1, s[40:43], s64 offen nt
s_xor_b32 s64, s65, 131072
s_cmpk_gt_u32 s69, 16
s_waitcnt vmcnt(6)
s_cbranch_scc1 L_d_13
s_waitcnt vmcnt(3)
L_d_13:
buffer_load_dwordx4 v[72:75], v1, s[40:43], s64 offen nt
s_xor_b32 s64, s65, 196608
s_cmpk_gt_u32 s69, 17
s_waitcnt vmcnt(6)
s_cbranch_scc1 L_d_14
s_waitcnt vmcnt(3)
L_d_14:
buffer_load_dwordx4 v[76:79], v1, s[40:43], s64 offen nt
s_xor_b32 s64, s65, 133120
s_cmpk_gt_u32 s69, 18
s_waitcnt vmcnt(6)
s_cbranch_scc1 L_d_15
s_waitcnt vmcnt(3)
L_d_15:
buffer_load_dwordx4 v[80:83], v1, s[40:43], s64 offen nt
s_xor_b32 s64, s65, 198656
s_cmpk_gt_u32 s69, 19
s_waitcnt vmcnt(6)
s_cbranch_scc1 L_d_16
s_waitcnt vmcnt(3)
L_d_16:
buffer_load_dwordx4 v[84:87], v1, s[40:43], s64 offen nt
s_xor_b32 s64, s65, 132096
s_cmpk_gt_u32 s69, 20
s_waitcnt vmcnt(6)
s_cbranch_scc1 L_d_17
s_waitcnt vmcnt(4)
L_d_17:
buffer_load_dwordx4 v[88:91], v1, s[40:43], s64 offen nt
s_xor_b32 s64, s65, 197632
s_cmpk_gt_u32 s69, 21
s_waitcnt vmcnt(6)
s_cbranch_scc1 L_d_18
s_waitcnt vmcnt(4)
L_d_18:
buffer_load_dwordx4 v[92:95], v1, s[40:43], s64 offen nt
s_xor_b32 s64, s65, 134144
s_cmpk_gt_u32 s69, 22
s_waitcnt vmcnt(6)
s_cbranch_scc1 L_d_19
s_waitcnt vmcnt(4)
L_d_19:
buffer_load_dwordx4 v[96:99], v1, s[40:43], s64 offen nt
s_xor_b32 s64, s65, 199680
s_cmpk_gt_u32 s69, 23
s_waitcnt vmcnt(6)
s_cbranch_scc1 L_d_20
s_waitcnt vmcnt(4)
L_d_20:
buffer_load_dwordx4 v[100:103], v1, s[40:43], s64 offen nt
s_xor_b32 s64, s65, 163840
s_cmpk_gt_u32 s69, 24
s_waitcnt vmcnt(6)
s_cbranch_scc1 L_d_21
s_waitcnt vmcnt(4)
L_d_21:
buffer_load_dwordx4 v[104:107], v1, s[40:43], s64 offen nt
s_xor_b32 s64, s65, 229376
s_cmpk_gt_u32 s69, 25
s_waitcnt vmcnt(6)
s_cbranch_scc1 L_d_22
s_waitcnt vmcnt(4)
L_d_22:
buffer_load_dwordx4 v[108:111], v1, s[40:43], s64 offen nt
s_xor_b32 s64, s65, 165888
s_cmpk_gt_u32 s69, 26
s_waitcnt vmcnt(6)
s_cbranch_scc1 L_d_23
s_waitcnt vmcnt(4)
L_d_23:
buffer_load_dwordx4 v[112:115], v1, s[40:43], s64 offen nt
s_xor_b32 s64, s65, 231424
s_cmpk_gt_u32 s69, 27
s_waitcnt vmcnt(6)
s_cbranch_scc1 L_d_24
s_waitcnt vmcnt(4)
L_d_24:
buffer_load_dwordx4 v[116:119], v1, s[40:43], s64 offen nt
s_xor_b32 s64, s65, 164864
s_cmpk_gt_u32 s69, 28
s_waitcnt vmcnt(6)
s_cbranch_scc1 L_d_25
s_waitcnt vmcnt(4)
L_d_25:
buffer_load_dwordx4 v[120:123], v1, s[40:43], s64 offen nt
s_xor_b32 s64, s65, 230400
s_cmpk_gt_u32 s69, 29
s_waitcnt vmcnt(6)
s_cbranch_scc1 L_d_26
s_waitcnt vmcnt(4)
L_d_26:
buffer_load_dwordx4 v[124:127], v1, s[40:43], s64 offen nt
s_xor_b32 s64, s65, 166912
s_cmpk_gt_u32 s69, 30
s_waitcnt vmcnt(6)
s_cbranch_scc1 L_d_27
s_waitcnt vmcnt(4)
L_d_27:
buffer_load_dwordx4 v[128:131], v1, s[40:43], s64 offen nt
s_xor_b32 s64, s65, 232448
s_cmpk_gt_u32 s69, 31
s_waitcnt vmcnt(6)
s_cbranch_scc1 L_d_28
s_waitcnt vmcnt(4)
L_d_28:
buffer_load_dwordx4 v[132:135], v1, s[40:43], s64 offen nt
s_xor_b32 s64, s65, 4096
s_cmpk_gt_u32 s69, 32
s_waitcnt vmcnt(6)
s_cbranch_scc1 L_d_29
s_waitcnt vmcnt(4)
L_d_29:
buffer_load_dwordx4 v[136:139], v1, s[40:43], s64 offen nt
s_xor_b32 s64, s65, 69632
s_cmpk_gt_u32 s69, 33
s_waitcnt vmcnt(6)
s_cbranch_scc1 L_d_30
s_waitcnt vmcnt(4)
L_d_30:
buffer_load_dwordx4 v[140:143], v1, s[40:43], s64 offen nt
s_xor_b32 s64, s65, 6144
s_cmpk_gt_u32 s69, 34
s_waitcnt vmcnt(6)
s_cbranch_scc1 L_d_31
s_waitcnt vmcnt(4)
L_d_31:
buffer_load_dwordx4 v[144:147], v1, s[40:43], s64 offen nt
s_xor_b32 s64, s65, 71680
s_cmpk_gt_u32 s69, 35
s_waitcnt vmcnt(6)
s_cbranch_scc1 L_d_32
s_waitcnt vmcnt(4)
L_d_32:
buffer_load_dwordx4 v[148:151], v1, s[40:43], s64 offen nt
s_xor_b32 s64, s65, 5120
s_cmpk_gt_u32 s69, 36
s_waitcnt vmcnt(6)
s_cbranch_scc1 L_d_33
s_waitcnt vmcnt(4)
L_d_33:
buffer_load_dwordx4 v[152:155], v1, s[40:43], s64 offen nt
s_xor_b32 s64, s65, 70656
s_cmpk_gt_u32 s69, 37
s_waitcnt vmcnt(6)
s_cbranch_scc1 L_d_34
s_waitcnt vmcnt(4)
L_d_34:
buffer_load_dwordx4 v[156:159], v1, s[40:43], s64 offen nt
s_xor_b32 s64, s65, 7168
s_cmpk_gt_u32 s69, 38
s_waitcnt vmcnt(6)
s_cbranch_scc1 L_d_35
s_waitcnt vmcnt(4)
L_d_35:
buffer_load_dwordx4 v[160:163], v1, s[40:43], s64 offen nt
s_xor_b32 s64, s65, 72704
s_cmpk_gt_u32 s69, 39
s_waitcnt vmcnt(6)
s_cbranch_scc1 L_d_36
s_waitcnt vmcnt(4)
L_d_36:
buffer_load_dwordx4 v[164:167], v1, s[40:43], s64 offen nt
s_xor_b32 s64, s65, 36864
s_cmpk_gt_u32 s69, 40
s_waitcnt vmcnt(6)
s_cbranch_scc1 L_d_37
s_waitcnt vmcnt(4)
L_d_37:
buffer_load_dwordx4 v[168:171], v1, s[40:43], s64 offen nt
s_xor_b32 s64, s65, 102400
s_cmpk_gt_u32 s69, 41
s_waitcnt vmcnt(6)
s_cbranch_scc1 L_d_38
s_waitcnt vmcnt(4)
L_d_38:
buffer_load_dwordx4 v[172:175], v1, s[40:43], s64 offen nt
s_xor_b32 s64, s65, 38912
s_cmpk_gt_u32 s69, 42
s_waitcnt vmcnt(6)
s_cbranch_scc1 L_d_39
s_waitcnt vmcnt(4)
L_d_39:
buffer_load_dwordx4 v[176:179], v1, s[40:43], s64 offen nt
s_xor_b32 s64, s65, 104448
s_cmpk_gt_u32 s69, 43
s_waitcnt vmcnt(6)
s_cbranch_scc1 L_d_40
s_waitcnt vmcnt(4)
L_d_40:
buffer_load_dwordx4 v[180:183], v1, s[40:43], s64 offen nt
s_xor_b32 s64, s65, 37888
s_cmpk_gt_u32 s69, 44
s_waitcnt vmcnt(6)
s_cbranch_scc1 L_d_41
s_waitcnt vmcnt(4)
L_d_41:
buffer_load_dwordx4 v[184:187], v1, s[40:43], s64 offen nt
s_xor_b32 s64, s65, 103424
s_cmpk_gt_u32 s69, 45
s_waitcnt vmcnt(6)
s_cbranch_scc1 L_d_42
s_waitcnt vmcnt(4)
L_d_42:
buffer_load_dwordx4 v[188:191], v1, s[40:43], s64 offen nt
s_xor_b32 s64, s65, 39936
s_cmpk_gt_u32 s69, 46
s_waitcnt vmcnt(6)
s_cbranch_scc1 L_d_43
s_waitcnt vmcnt(4)
L_d_43:
buffer_load_dwordx4 v[192:195], v1, s[40:43], s64 offen nt
s_xor_b32 s64, s65, 105472
s_cmpk_gt_u32 s69, 47
s_waitcnt vmcnt(6)
s_cbranch_scc1 L_d_44
s_waitcnt vmcnt(4)
L_d_44:
buffer_load_dwordx4 v[196:199], v1, s[40:43], s64 offen nt
s_xor_b32 s64, s65, 135168
s_cmpk_gt_u32 s69, 48
s_waitcnt vmcnt(6)
s_cbranch_scc1 L_d_45
s_waitcnt vmcnt(4)
L_d_45:
buffer_load_dwordx4 v[200:203], v1, s[40:43], s64 offen nt
s_xor_b32 s64, s65, 200704
s_cmpk_gt_u32 s69, 49
s_waitcnt vmcnt(6)
s_cbranch_scc1 L_d_46
s_waitcnt vmcnt(4)
L_d_46:
buffer_load_dwordx4 v[204:207], v1, s[40:43], s64 offen nt
s_xor_b32 s64, s65, 137216
s_cmpk_gt_u32 s69, 50
s_waitcnt vmcnt(6)
s_cbranch_scc1 L_d_47
s_waitcnt vmcnt(4)
L_d_47:
buffer_load_dwordx4 v[208:211], v1, s[40:43], s64 offen nt
s_xor_b32 s64, s65, 202752
s_cmpk_gt_u32 s69, 51
s_waitcnt vmcnt(6)
s_cbranch_scc1 L_d_48
s_waitcnt vmcnt(4)
L_d_48:
buffer_load_dwordx4 v[212:215], v1, s[40:43], s64 offen nt
s_xor_b32 s64, s65, 136192
s_cmpk_gt_u32 s69, 52
s_waitcnt vmcnt(6)
s_cbranch_scc1 L_d_49
s_waitcnt vmcnt(4)
L_d_49:
buffer_load_dwordx4 v[216:219], v1, s[40:43], s64 offen nt
s_xor_b32 s64, s65, 201728
s_cmpk_gt_u32 s69, 53
s_waitcnt vmcnt(6)
s_cbranch_scc1 L_d_50
s_waitcnt vmcnt(4)
L_d_50:
buffer_load_dwordx4 v[220:223], v1, s[40:43], s64 offen nt
s_xor_b32 s64, s65, 138240
s_cmpk_gt_u32 s69, 54
s_waitcnt vmcnt(6)
s_cbranch_scc1 L_d_51
s_waitcnt vmcnt(4)
L_d_51:
buffer_load_dwordx4 v[224:227], v1, s[40:43], s64 offen nt
s_xor_b32 s64, s65, 203776
s_cmpk_gt_u32 s69, 55
s_waitcnt vmcnt(6)
s_cbranch_scc1 L_d_52
s_waitcnt vmcnt(4)
L_d_52:
buffer_load_dwordx4 v[228:231], v1, s[40:43], s64 offen nt
s_cmp_eq_u32 s74, -1
s_mov_b32 s69, 80
s_cselect_b32 s69, 0, s69
s_cmp_lt_u32 s2, 144
s_cselect_b32 s69, 80, s69
s_cmp_lt_u32 s2, 112
s_cselect_b32 s69, 112, s69
s_cmp_lt_u32 s2, 48
s_cselect_b32 s69, 0, s69
s_cmp_lt_u32 s2, 16
s_cselect_b32 s69, 112, s69
s_xor_b32 s64, s65, 167936
s_cmpk_gt_u32 s69, 56
s_waitcnt vmcnt(6)
s_cbranch_scc1 L_d_53
s_waitcnt vmcnt(4)
L_d_53:
buffer_load_dwordx4 v[232:235], v1, s[40:43], s64 offen nt
s_xor_b32 s64, s65, 233472
s_cmpk_gt_u32 s69, 57
s_waitcnt vmcnt(6)
s_cbranch_scc1 L_d_54
s_waitcnt vmcnt(4)
L_d_54:
buffer_load_dwordx4 v[236:239], v1, s[40:43], s64 offen nt
s_xor_b32 s64, s65, 169984
s_cmpk_gt_u32 s69, 58
s_waitcnt vmcnt(6)
s_cbranch_scc1 L_d_55
s_waitcnt vmcnt(4)
L_d_55:
buffer_load_dwordx4 v[240:243], v1, s[40:43], s64 offen nt
v_and_b32 v2, 31, v0
v_lshlrev_b32 v2, 2, v2
buffer_load_dword v3, v2, s[52:55], 0 offen offset:128
s_xor_b32 s64, s65, 235520
s_cmpk_gt_u32 s69, 59
s_waitcnt vmcnt(6)
s_cbranch_scc1 L_d_56
s_waitcnt vmcnt(4)
L_d_56:
buffer_load_dwordx4 v[244:247], v1, s[40:43], s64 offen nt
s_xor_b32 s64, s65, 168960
s_cmpk_gt_u32 s69, 60
s_waitcnt vmcnt(6)
s_cbranch_scc1 L_d_57
s_waitcnt vmcnt(4)
L_d_57:
buffer_load_dwordx4 v[248:251], v1, s[40:43], s64 offen nt
s_xor_b32 s64, s65, 234496
s_cmpk_gt_u32 s69, 61
s_waitcnt vmcnt(6)
s_cbranch_scc1 L_d_58
s_waitcnt vmcnt(4)
L_d_58:
buffer_load_dwordx4 v[252:255], v1, s[40:43], s64 offen nt
s_mul_i32 s70, s34, 15360
s_add_u32 s70, s70, 69632
s_add_u32 m0, s70, 0
s_xor_b32 s64, s65, 171008
s_cmpk_gt_u32 s69, 62
s_waitcnt vmcnt(6)
s_cbranch_scc1 L_d_59
s_waitcnt vmcnt(4)
L_d_59:
buffer_load_dwordx4 v1, s[40:43], s64 offen nt lds
s_add_u32 m0, s70, 1024
s_xor_b32 s64, s65, 236544
s_cmpk_gt_u32 s69, 63
s_waitcnt vmcnt(6)
s_cbranch_scc1 L_d_60
s_waitcnt vmcnt(4)
L_d_60:
buffer_load_dwordx4 v1, s[40:43], s64 offen nt lds
s_add_u32 m0, s70, 2048
s_xor_b32 s64, s65, 0
s_cmpk_gt_u32 s69, 64
s_waitcnt vmcnt(6)
s_cbranch_scc1 L_d_61
s_waitcnt vmcnt(4)
L_d_61:
buffer_load_dwordx4 v1, s[44:47], s64 offen nt lds
s_add_u32 m0, s70, 3072
s_xor_b32 s64, s65, 65536
s_cmpk_gt_u32 s69, 65
s_waitcnt vmcnt(6)
s_cbranch_scc1 L_d_62
s_waitcnt vmcnt(4)
L_d_62:
buffer_load_dwordx4 v1, s[44:47], s64 offen nt lds
s_add_u32 m0, s70, 4096
s_xor_b32 s64, s65, 2048
s_cmpk_gt_u32 s69, 66
s_waitcnt vmcnt(6)
s_cbranch_scc1 L_d_63
s_waitcnt vmcnt(4)
L_d_63:
buffer_load_dwordx4 v1, s[44:47], s64 offen nt lds
s_add_u32 m0, s70, 5120
s_xor_b32 s64, s65, 67584
s_cmpk_gt_u32 s69, 67
s_waitcnt vmcnt(6)
s_cbranch_scc1 L_d_64
s_waitcnt vmcnt(4)
L_d_64:
buffer_load_dwordx4 v1, s[44:47], s64 offen nt lds
v_cmp_eq_u32 vcc, 0, v3
s_cbranch_vccz L_jf_66
s_mov_b32 s75, 0
L_poll_67:
v_and_b32 v2, 31, v0
v_lshlrev_b32 v2, 2, v2
buffer_load_dword v3, v2, s[52:55], 0 offen offset:128 sc1
s_waitcnt vmcnt(0)
v_cmp_eq_u32 vcc, 0, v3
s_cbranch_vccz L_pollx_68
s_sleep 40
s_add_u32 s75, s75, 1
s_cmp_lt_u32 s75, 0x100000
s_cbranch_scc1 L_poll_67
L_pollx_68:
L_jf_66:
s_mul_i32 s68, s32, 12288
s_lshl_b32 s67, s33, 8
s_add_u32 s68, s68, s67
s_add_u32 s68, s68, 16384
v_and_b32 v2, 0xf0, v1
buffer_load_dwordx4 v[4:7], v2, s[36:39], s68 offen sc1
s_add_u32 m0, s70, 6144
s_xor_b32 s64, s65, 1024
s_cmpk_gt_u32 s69, 68
s_waitcnt vmcnt(6)
s_cbranch_scc1 L_d_65
s_waitcnt vmcnt(4)
L_d_65:
buffer_load_dwordx4 v1, s[44:47], s64 offen nt lds
s_add_u32 m0, s70, 7168
s_xor_b32 s64, s65, 66560
s_cmpk_gt_u32 s69, 69
s_waitcnt vmcnt(6)
s_cbranch_scc1 L_d_69
s_waitcnt vmcnt(4)
L_d_69:
buffer_load_dwordx4 v1, s[44:47], s64 offen nt lds
s_add_u32 m0, s70, 8192
s_xor_b32 s64, s65, 3072
s_cmpk_gt_u32 s69, 70
s_waitcnt vmcnt(6)
s_cbranch_scc1 L_d_70
s_waitcnt vmcnt(4)
L_d_70:
buffer_load_dwordx4 v1, s[44:47], s64 offen nt lds
s_add_u32 m0, s70, 9216
s_xor_b32 s64, s65, 68608
s_cmpk_gt_u32 s69, 71
s_waitcnt vmcnt(6)
s_cbranch_scc1 L_d_71
s_waitcnt vmcnt(4)
L_d_71:
buffer_load_dwordx4 v1, s[44:47], s64 offen nt lds
s_add_u32 m0, s70, 10240
s_xor_b32 s64, s65, 32768
s_cmpk_gt_u32 s69, 72
s_waitcnt vmcnt(6)
s_cbranch_scc1 L_d_72
s_waitcnt vmcnt(4)
L_d_72:
buffer_load_dwordx4 v1, s[44:47], s64 offen nt lds
s_add_u32 m0, s70, 11264
s_xor_b32 s64, s65, 98304
s_cmpk_gt_u32 s69, 73
s_waitcnt vmcnt(6)
s_cbranch_scc1 L_d_73
s_waitcnt vmcnt(4)
L_d_73:
buffer_load_dwordx4 v1, s[44:47], s64 offen nt lds
s_add_u32 m0, s70, 12288
s_xor_b32 s64, s65, 34816
s_cmpk_gt_u32 s69, 74
s_waitcnt vmcnt(6)
s_cbranch_scc1 L_d_74
s_waitcnt vmcnt(4)
L_d_74:
buffer_load_dwordx4 v1, s[44:47], s64 offen nt lds
s_add_u32 m0, s70, 13312
s_xor_b32 s64, s65, 100352
s_cmpk_gt_u32 s69, 75
s_waitcnt vmcnt(6)
s_cbranch_scc1 L_d_75
s_waitcnt vmcnt(4)
L_d_75:
buffer_load_dwordx4 v1, s[44:47], s64 offen nt lds
s_add_u32 m0, s70, 14336
s_xor_b32 s64, s65, 33792
s_cmpk_gt_u32 s69, 76
s_waitcnt vmcnt(6)
s_cbranch_scc1 L_d_76
s_waitcnt vmcnt(4)
L_d_76:
buffer_load_dwordx4 v1, s[44:47], s64 offen nt lds
v_max3_u32 v3, v4, v5, v6
v_max_u32 v3, v3, v7
v_cmp_eq_u32 vcc, -1, v3
s_cbranch_vccz L_q_77
s_mov_b32 s75, 0
L_poll_78:
s_mul_i32 s68, s32, 12288
s_lshl_b32 s67, s33, 8
s_add_u32 s68, s68, s67
s_add_u32 s68, s68, 16384
v_and_b32 v2, 0xf0, v1
buffer_load_dwordx4 v[4:7], v2, s[36:39], s68 offen sc1
s_waitcnt vmcnt(0)
v_max3_u32 v3, v4, v5, v6
v_max_u32 v3, v3, v7
v_cmp_eq_u32 vcc, -1, v3
s_cbranch_vccz L_pollx_79
s_add_u32 s75, s75, 1
s_cmp_lt_u32 s75, 0x100000
s_cbranch_scc1 L_poll_78
L_pollx_79:
L_q_77:
s_mov_b32 s66, 0x3db504f3
v_dot2_f32_bf16 v8, v8, v4, 0
v_dot2_f32_bf16 v12, v12, v4, 0
v_dot2_f32_bf16 v16, v16, v4, 0
v_dot2_f32_bf16 v20, v20, v4, 0
v_dot2c_f32_bf16 v8, v9, v5
v_dot2c_f32_bf16 v12, v13, v5
v_dot2c_f32_bf16 v16, v17, v5
v_dot2c_f32_bf16 v20, v21, v5
v_dot2c_f32_bf16 v8, v10, v6
v_dot2c_f32_bf16 v12, v14, v6
v_dot2c_f32_bf16 v16, v18, v6
v_dot2c_f32_bf16 v20, v22, v6
v_dot2c_f32_bf16 v8, v11, v7
v_dot2c_f32_bf16 v12, v15, v7
v_dot2c_f32_bf16 v16, v19, v7
v_dot2c_f32_bf16 v20, v23, v7
v_add_f32_dpp v9, v8, v8 row_ror:8 row_mask:0xf bank_mask:0x3
v_add_f32_dpp v13, v12, v12 row_ror:8 row_mask:0xf bank_mask:0x3
v_add_f32_dpp v9, v16, v16 row_ror:8 row_mask:0xf bank_mask:0xc
v_add_f32_dpp v13, v20, v20 row_ror:8 row_mask:0xf bank_mask:0xc
s_nop 0
v_add_f32_dpp v17, v9, v9 row_shl:4 row_mask:0xf bank_mask:0x5
v_add_f32_dpp v17, v13, v13 row_shr:4 row_mask:0xf bank_mask:0xa
s_nop 1
v_add_f32_dpp v17, v17, v17 quad_perm:[1,0,3,2] row_mask:0xf bank_mask:0xf
s_nop 1
v_add_f32_dpp v17, v17, v17 quad_perm:[2,3,0,1] row_mask:0xf bank_mask:0xf
v_cvt_pk_bf16_f32 v17, 0, v17
v_mul_f32 v17, s66, v17
v_cvt_pk_bf16_f32 v17, 0, v17
v_dot2_f32_bf16 v24, v24, v4, 0
v_dot2_f32_bf16 v28, v28, v4, 0
v_dot2_f32_bf16 v32, v32, v4, 0
v_dot2_f32_bf16 v36, v36, v4, 0
v_dot2c_f32_bf16 v24, v25, v5
v_dot2c_f32_bf16 v28, v29, v5
v_dot2c_f32_bf16 v32, v33, v5
v_dot2c_f32_bf16 v36, v37, v5
v_dot2c_f32_bf16 v24, v26, v6
v_dot2c_f32_bf16 v28, v30, v6
v_dot2c_f32_bf16 v32, v34, v6
v_dot2c_f32_bf16 v36, v38, v6
v_dot2c_f32_bf16 v24, v27, v7
v_dot2c_f32_bf16 v28, v31, v7
v_dot2c_f32_bf16 v32, v35, v7
v_dot2c_f32_bf16 v36, v39, v7
v_add_f32_dpp v25, v24, v24 row_ror:8 row_mask:0xf bank_mask:0x3
v_add_f32_dpp v29, v28, v28 row_ror:8 row_mask:0xf bank_mask:0x3
v_add_f32_dpp v25, v32, v32 row_ror:8 row_mask:0xf bank_mask:0xc
v_add_f32_dpp v29, v36, v36 row_ror:8 row_mask:0xf bank_mask:0xc
s_nop 0
v_add_f32_dpp v8, v25, v25 row_shl:4 row_mask:0xf bank_mask:0x5
v_add_f32_dpp v8, v29, v29 row_shr:4 row_mask:0xf bank_mask:0xa
s_nop 1
v_add_f32_dpp v8, v8, v8 quad_perm:[1,0,3,2] row_mask:0xf bank_mask:0xf
s_nop 1
v_add_f32_dpp v8, v8, v8 quad_perm:[2,3,0,1] row_mask:0xf bank_mask:0xf
v_cvt_pk_bf16_f32 v8, 0, v8
v_mul_f32 v8, s66, v8
v_cvt_pk_bf16_f32 v8, 0, v8
s_xor_b32 s64, s65, 99328
s_cmpk_gt_u32 s69, 77
s_waitcnt vmcnt(6)
s_cbranch_scc1 L_d_80
s_waitcnt vmcnt(4)
L_d_80:
buffer_load_dwordx4 v[24:27], v1, s[44:47], s64 offen nt
v_dot2_f32_bf16 v40, v40, v4, 0
v_dot2_f32_bf16 v44, v44, v4, 0
v_dot2_f32_bf16 v48, v48, v4, 0
v_dot2_f32_bf16 v52, v52, v4, 0
v_dot2c_f32_bf16 v40, v41, v5
v_dot2c_f32_bf16 v44, v45, v5
v_dot2c_f32_bf16 v48, v49, v5
v_dot2c_f32_bf16 v52, v53, v5
v_dot2c_f32_bf16 v40, v42, v6
v_dot2c_f32_bf16 v44, v46, v6
v_dot2c_f32_bf16 v48, v50, v6
v_dot2c_f32_bf16 v52, v54, v6
v_dot2c_f32_bf16 v40, v43, v7
v_dot2c_f32_bf16 v44, v47, v7
v_dot2c_f32_bf16 v48, v51, v7
v_dot2c_f32_bf16 v52, v55, v7
v_add_f32_dpp v41, v40, v40 row_ror:8 row_mask:0xf bank_mask:0x3
v_add_f32_dpp v45, v44, v44 row_ror:8 row_mask:0xf bank_mask:0x3
v_add_f32_dpp v41, v48, v48 row_ror:8 row_mask:0xf bank_mask:0xc
v_add_f32_dpp v45, v52, v52 row_ror:8 row_mask:0xf bank_mask:0xc
s_nop 0
v_add_f32_dpp v9, v41, v41 row_shl:4 row_mask:0xf bank_mask:0x5
v_add_f32_dpp v9, v45, v45 row_shr:4 row_mask:0xf bank_mask:0xa
s_nop 1
v_add_f32_dpp v9, v9, v9 quad_perm:[1,0,3,2] row_mask:0xf bank_mask:0xf
s_nop 1
v_add_f32_dpp v9, v9, v9 quad_perm:[2,3,0,1] row_mask:0xf bank_mask:0xf
v_cvt_pk_bf16_f32 v9, 0, v9
v_mul_f32 v9, s66, v9
v_cvt_pk_bf16_f32 v9, 0, v9
s_and_b32 s62, s2, 7
s_lshl_b32 s62, s62, 9
s_add_u32 s62, s62, 1327104
s_lshr_b32 s63, s2, 3
s_lshl_b32 s63, s63, 2
s_add_u32 s63, s63, s62
s_cmp_eq_u32 s34, 0
s_cbranch_scc0 L_w_82
v_mov_b32 v2, 14
s_mov_b64 exec, 1
buffer_store_dword v2, off, s[36:39], s63 offset:0
s_mov_b64 exec, -1
L_w_82:
s_xor_b32 s64, s65, 35840
s_cmpk_gt_u32 s69, 78
s_waitcnt vmcnt(6)
s_cbranch_scc1 L_d_81
s_waitcnt vmcnt(4)
L_d_81:
buffer_load_dwordx4 v[28:31], v1, s[44:47], s64 offen nt
v_dot2_f32_bf16 v56, v56, v4, 0
v_dot2_f32_bf16 v60, v60, v4, 0
v_dot2_f32_bf16 v64, v64, v4, 0
v_dot2_f32_bf16 v68, v68, v4, 0
v_dot2c_f32_bf16 v56, v57, v5
v_dot2c_f32_bf16 v60, v61, v5
v_dot2c_f32_bf16 v64, v65, v5
v_dot2c_f32_bf16 v68, v69, v5
v_dot2c_f32_bf16 v56, v58, v6
v_dot2c_f32_bf16 v60, v62, v6
v_dot2c_f32_bf16 v64, v66, v6
v_dot2c_f32_bf16 v68, v70, v6
v_dot2c_f32_bf16 v56, v59, v7
v_dot2c_f32_bf16 v60, v63, v7
v_dot2c_f32_bf16 v64, v67, v7
v_dot2c_f32_bf16 v68, v71, v7
v_add_f32_dpp v57, v56, v56 row_ror:8 row_mask:0xf bank_mask:0x3
v_add_f32_dpp v61, v60, v60 row_ror:8 row_mask:0xf bank_mask:0x3
v_add_f32_dpp v57, v64, v64 row_ror:8 row_mask:0xf bank_mask:0xc
v_add_f32_dpp v61, v68, v68 row_ror:8 row_mask:0xf bank_mask:0xc
s_nop 0
v_add_f32_dpp v10, v57, v57 row_shl:4 row_mask:0xf bank_mask:0x5
v_add_f32_dpp v10, v61, v61 row_shr:4 row_mask:0xf bank_mask:0xa
s_nop 1
v_add_f32_dpp v10, v10, v10 quad_perm:[1,0,3,2] row_mask:0xf bank_mask:0xf
s_nop 1
v_add_f32_dpp v10, v10, v10 quad_perm:[2,3,0,1] row_mask:0xf bank_mask:0xf
v_cvt_pk_bf16_f32 v10, 0, v10
v_mul_f32 v10, s66, v10
v_cvt_pk_bf16_f32 v10, 0, v10
s_xor_b32 s64, s65, 101376
s_cmpk_gt_u32 s69, 79
s_waitcnt vmcnt(6)
s_cbranch_scc1 L_d_83
s_waitcnt vmcnt(4)
L_d_83:
buffer_load_dwordx4 v[32:35], v1, s[44:47], s64 offen nt
v_dot2_f32_bf16 v72, v72, v4, 0
v_dot2_f32_bf16 v76, v76, v4, 0
v_dot2_f32_bf16 v80, v80, v4, 0
v_dot2_f32_bf16 v84, v84, v4, 0
v_dot2c_f32_bf16 v72, v73, v5
v_dot2c_f32_bf16 v76, v77, v5
v_dot2c_f32_bf16 v80, v81, v5
v_dot2c_f32_bf16 v84, v85, v5
v_dot2c_f32_bf16 v72, v74, v6
v_dot2c_f32_bf16 v76, v78, v6
v_dot2c_f32_bf16 v80, v82, v6
v_dot2c_f32_bf16 v84, v86, v6
v_dot2c_f32_bf16 v72, v75, v7
v_dot2c_f32_bf16 v76, v79, v7
v_dot2c_f32_bf16 v80, v83, v7
v_dot2c_f32_bf16 v84, v87, v7
v_add_f32_dpp v73, v72, v72 row_ror:8 row_mask:0xf bank_mask:0x3
v_add_f32_dpp v77, v76, v76 row_ror:8 row_mask:0xf bank_mask:0x3
v_add_f32_dpp v73, v80, v80 row_ror:8 row_mask:0xf bank_mask:0xc
v_add_f32_dpp v77, v84, v84 row_ror:8 row_mask:0xf bank_mask:0xc
s_nop 0
v_add_f32_dpp v11, v73, v73 row_shl:4 row_mask:0xf bank_mask:0x5
v_add_f32_dpp v11, v77, v77 row_shr:4 row_mask:0xf bank_mask:0xa
s_nop 1
v_add_f32_dpp v11, v11, v11 quad_perm:[1,0,3,2] row_mask:0xf bank_mask:0xf
s_nop 1
v_add_f32_dpp v11, v11, v11 quad_perm:[2,3,0,1] row_mask:0xf bank_mask:0xf
v_cvt_pk_bf16_f32 v11, 0, v11
v_mul_f32 v11, s66, v11
v_cvt_pk_bf16_f32 v11, 0, v11
s_xor_b32 s64, s65, 131072
s_cmpk_gt_u32 s69, 80
s_waitcnt vmcnt(6)
s_cbranch_scc1 L_d_84
s_waitcnt vmcnt(4)
L_d_84:
buffer_load_dwordx4 v[36:39], v1, s[44:47], s64 offen nt
v_dot2_f32_bf16 v88, v88, v4, 0
v_dot2_f32_bf16 v92, v92, v4, 0
v_dot2_f32_bf16 v96, v96, v4, 0
v_dot2_f32_bf16 v100, v100, v4, 0
v_dot2c_f32_bf16 v88, v89, v5
v_dot2c_f32_bf16 v92, v93, v5
v_dot2c_f32_bf16 v96, v97, v5
v_dot2c_f32_bf16 v100, v101, v5
v_dot2c_f32_bf16 v88, v90, v6
v_dot2c_f32_bf16 v92, v94, v6
v_dot2c_f32_bf16 v96, v98, v6
v_dot2c_f32_bf16 v100, v102, v6
v_dot2c_f32_bf16 v88, v91, v7
v_dot2c_f32_bf16 v92, v95, v7
v_dot2c_f32_bf16 v96, v99, v7
v_dot2c_f32_bf16 v100, v103, v7
v_add_f32_dpp v89, v88, v88 row_ror:8 row_mask:0xf bank_mask:0x3
v_add_f32_dpp v93, v92, v92 row_ror:8 row_mask:0xf bank_mask:0x3
v_add_f32_dpp v89, v96, v96 row_ror:8 row_mask:0xf bank_mask:0xc
v_add_f32_dpp v93, v100, v100 row_ror:8 row_mask:0xf bank_mask:0xc
s_nop 0
v_add_f32_dpp v12, v89, v89 row_shl:4 row_mask:0xf bank_mask:0x5
v_add_f32_dpp v12, v93, v93 row_shr:4 row_mask:0xf bank_mask:0xa
s_nop 1
v_add_f32_dpp v12, v12, v12 quad_perm:[1,0,3,2] row_mask:0xf bank_mask:0xf
s_nop 1
v_add_f32_dpp v12, v12, v12 quad_perm:[2,3,0,1] row_mask:0xf bank_mask:0xf
v_cvt_pk_bf16_f32 v12, 0, v12
v_mul_f32 v12, s66, v12
v_cvt_pk_bf16_f32 v12, 0, v12
s_xor_b32 s64, s65, 196608
s_cmpk_gt_u32 s69, 81
s_waitcnt vmcnt(6)
s_cbranch_scc1 L_d_85
s_waitcnt vmcnt(4)
L_d_85:
buffer_load_dwordx4 v[40:43], v1, s[44:47], s64 offen nt
v_dot2_f32_bf16 v104, v104, v4, 0
v_dot2_f32_bf16 v108, v108, v4, 0
v_dot2_f32_bf16 v112, v112, v4, 0
v_dot2_f32_bf16 v116, v116, v4, 0
v_dot2c_f32_bf16 v104, v105, v5
v_dot2c_f32_bf16 v108, v109, v5
v_dot2c_f32_bf16 v112, v113, v5
v_dot2c_f32_bf16 v116, v117, v5
v_dot2c_f32_bf16 v104, v106, v6
v_dot2c_f32_bf16 v108, v110, v6
v_dot2c_f32_bf16 v112, v114, v6
v_dot2c_f32_bf16 v116, v118, v6
v_dot2c_f32_bf16 v104, v107, v7
v_dot2c_f32_bf16 v108, v111, v7
v_dot2c_f32_bf16 v112, v115, v7
v_dot2c_f32_bf16 v116, v119, v7
v_add_f32_dpp v105, v104, v104 row_ror:8 row_mask:0xf bank_mask:0x3
v_add_f32_dpp v109, v108, v108 row_ror:8 row_mask:0xf bank_mask:0x3
v_add_f32_dpp v105, v112, v112 row_ror:8 row_mask:0xf bank_mask:0xc
v_add_f32_dpp v109, v116, v116 row_ror:8 row_mask:0xf bank_mask:0xc
s_nop 0
v_add_f32_dpp v13, v105, v105 row_shl:4 row_mask:0xf bank_mask:0x5
v_add_f32_dpp v13, v109, v109 row_shr:4 row_mask:0xf bank_mask:0xa
s_nop 1
v_add_f32_dpp v13, v13, v13 quad_perm:[1,0,3,2] row_mask:0xf bank_mask:0xf
s_nop 1
v_add_f32_dpp v13, v13, v13 quad_perm:[2,3,0,1] row_mask:0xf bank_mask:0xf
v_cvt_pk_bf16_f32 v13, 0, v13
v_mul_f32 v13, s66, v13
v_cvt_pk_bf16_f32 v13, 0, v13
s_xor_b32 s64, s65, 133120
s_cmpk_gt_u32 s69, 82
s_waitcnt vmcnt(6)
s_cbranch_scc1 L_d_86
s_waitcnt vmcnt(4)
L_d_86:
buffer_load_dwordx4 v[44:47], v1, s[44:47], s64 offen nt
v_dot2_f32_bf16 v120, v120, v4, 0
v_dot2_f32_bf16 v124, v124, v4, 0
v_dot2_f32_bf16 v128, v128, v4, 0
v_dot2_f32_bf16 v132, v132, v4, 0
v_dot2c_f32_bf16 v120, v121, v5
v_dot2c_f32_bf16 v124, v125, v5
v_dot2c_f32_bf16 v128, v129, v5
v_dot2c_f32_bf16 v132, v133, v5
v_dot2c_f32_bf16 v120, v122, v6
v_dot2c_f32_bf16 v124, v126, v6
v_dot2c_f32_bf16 v128, v130, v6
v_dot2c_f32_bf16 v132, v134, v6
v_dot2c_f32_bf16 v120, v123, v7
v_dot2c_f32_bf16 v124, v127, v7
v_dot2c_f32_bf16 v128, v131, v7
v_dot2c_f32_bf16 v132, v135, v7
v_add_f32_dpp v121, v120, v120 row_ror:8 row_mask:0xf bank_mask:0x3
v_add_f32_dpp v125, v124, v124 row_ror:8 row_mask:0xf bank_mask:0x3
v_add_f32_dpp v121, v128, v128 row_ror:8 row_mask:0xf bank_mask:0xc
v_add_f32_dpp v125, v132, v132 row_ror:8 row_mask:0xf bank_mask:0xc
s_nop 0
v_add_f32_dpp v14, v121, v121 row_shl:4 row_mask:0xf bank_mask:0x5
v_add_f32_dpp v14, v125, v125 row_shr:4 row_mask:0xf bank_mask:0xa
s_nop 1
v_add_f32_dpp v14, v14, v14 quad_perm:[1,0,3,2] row_mask:0xf bank_mask:0xf
s_nop 1
v_add_f32_dpp v14, v14, v14 quad_perm:[2,3,0,1] row_mask:0xf bank_mask:0xf
v_cvt_pk_bf16_f32 v14, 0, v14
v_mul_f32 v14, s66, v14
v_cvt_pk_bf16_f32 v14, 0, v14
s_xor_b32 s64, s65, 198656
s_cmpk_gt_u32 s69, 83
s_waitcnt vmcnt(6)
s_cbranch_scc1 L_d_87
s_waitcnt vmcnt(4)
L_d_87:
buffer_load_dwordx4 v[48:51], v1, s[44:47], s64 offen nt
v_dot2_f32_bf16 v136, v136, v4, 0
v_dot2_f32_bf16 v140, v140, v4, 0
v_dot2_f32_bf16 v144, v144, v4, 0
v_dot2_f32_bf16 v148, v148, v4, 0
v_dot2c_f32_bf16 v136, v137, v5
v_dot2c_f32_bf16 v140, v141, v5
v_dot2c_f32_bf16 v144, v145, v5
v_dot2c_f32_bf16 v148, v149, v5
v_dot2c_f32_bf16 v136, v138, v6
v_dot2c_f32_bf16 v140, v142, v6
v_dot2c_f32_bf16 v144, v146, v6
v_dot2c_f32_bf16 v148, v150, v6
v_dot2c_f32_bf16 v136, v139, v7
v_dot2c_f32_bf16 v140, v143, v7
v_dot2c_f32_bf16 v144, v147, v7
v_dot2c_f32_bf16 v148, v151, v7
v_add_f32_dpp v137, v136, v136 row_ror:8 row_mask:0xf bank_mask:0x3
v_add_f32_dpp v141, v140, v140 row_ror:8 row_mask:0xf bank_mask:0x3
v_add_f32_dpp v137, v144, v144 row_ror:8 row_mask:0xf bank_mask:0xc
v_add_f32_dpp v141, v148, v148 row_ror:8 row_mask:0xf bank_mask:0xc
s_nop 0
v_add_f32_dpp v15, v137, v137 row_shl:4 row_mask:0xf bank_mask:0x5
v_add_f32_dpp v15, v141, v141 row_shr:4 row_mask:0xf bank_mask:0xa
s_nop 1
v_add_f32_dpp v15, v15, v15 quad_perm:[1,0,3,2] row_mask:0xf bank_mask:0xf
s_nop 1
v_add_f32_dpp v15, v15, v15 quad_perm:[2,3,0,1] row_mask:0xf bank_mask:0xf
v_cvt_pk_bf16_f32 v15, 0, v15
v_mul_f32 v15, s66, v15
v_cvt_pk_bf16_f32 v15, 0, v15
s_xor_b32 s64, s65, 132096
s_cmpk_gt_u32 s69, 84
s_waitcnt vmcnt(6)
s_cbranch_scc1 L_d_88
s_waitcnt vmcnt(4)
L_d_88:
buffer_load_dwordx4 v[52:55], v1, s[44:47], s64 offen nt
v_dot2_f32_bf16 v152, v152, v4, 0
v_dot2_f32_bf16 v156, v156, v4, 0
v_dot2_f32_bf16 v160, v160, v4, 0
v_dot2_f32_bf16 v164, v164, v4, 0
v_dot2c_f32_bf16 v152, v153, v5
v_dot2c_f32_bf16 v156, v157, v5
v_dot2c_f32_bf16 v160, v161, v5
v_dot2c_f32_bf16 v164, v165, v5
v_dot2c_f32_bf16 v152, v154, v6
v_dot2c_f32_bf16 v156, v158, v6
v_dot2c_f32_bf16 v160, v162, v6
v_dot2c_f32_bf16 v164, v166, v6
v_dot2c_f32_bf16 v152, v155, v7
v_dot2c_f32_bf16 v156, v159, v7
v_dot2c_f32_bf16 v160, v163, v7
v_dot2c_f32_bf16 v164, v167, v7
v_add_f32_dpp v153, v152, v152 row_ror:8 row_mask:0xf bank_mask:0x3
v_add_f32_dpp v157, v156, v156 row_ror:8 row_mask:0xf bank_mask:0x3
v_add_f32_dpp v153, v160, v160 row_ror:8 row_mask:0xf bank_mask:0xc
v_add_f32_dpp v157, v164, v164 row_ror:8 row_mask:0xf bank_mask:0xc
s_nop 0
v_add_f32_dpp v16, v153, v153 row_shl:4 row_mask:0xf bank_mask:0x5
v_add_f32_dpp v16, v157, v157 row_shr:4 row_mask:0xf bank_mask:0xa
s_nop 1
v_add_f32_dpp v16, v16, v16 quad_perm:[1,0,3,2] row_mask:0xf bank_mask:0xf
s_nop 1
v_add_f32_dpp v16, v16, v16 quad_perm:[2,3,0,1] row_mask:0xf bank_mask:0xf
v_cvt_pk_bf16_f32 v16, 0, v16
v_mul_f32 v16, s66, v16
v_cvt_pk_bf16_f32 v16, 0, v16
s_xor_b32 s64, s65, 197632
s_cmpk_gt_u32 s69, 85
s_waitcnt vmcnt(6)
s_cbranch_scc1 L_d_89
s_waitcnt vmcnt(4)
L_d_89:
buffer_load_dwordx4 v[56:59], v1, s[44:47], s64 offen nt
v_dot2_f32_bf16 v168, v168, v4, 0
v_dot2_f32_bf16 v172, v172, v4, 0
v_dot2_f32_bf16 v176, v176, v4, 0
v_dot2_f32_bf16 v180, v180, v4, 0
v_dot2c_f32_bf16 v168, v169, v5
v_dot2c_f32_bf16 v172, v173, v5
v_dot2c_f32_bf16 v176, v177, v5
v_dot2c_f32_bf16 v180, v181, v5
v_dot2c_f32_bf16 v168, v170, v6
v_dot2c_f32_bf16 v172, v174, v6
v_dot2c_f32_bf16 v176, v178, v6
v_dot2c_f32_bf16 v180, v182, v6
v_dot2c_f32_bf16 v168, v171, v7
v_dot2c_f32_bf16 v172, v175, v7
v_dot2c_f32_bf16 v176, v179, v7
v_dot2c_f32_bf16 v180, v183, v7
v_add_f32_dpp v169, v168, v168 row_ror:8 row_mask:0xf bank_mask:0x3
v_add_f32_dpp v173, v172, v172 row_ror:8 row_mask:0xf bank_mask:0x3
v_add_f32_dpp v169, v176, v176 row_ror:8 row_mask:0xf bank_mask:0xc
v_add_f32_dpp v173, v180, v180 row_ror:8 row_mask:0xf bank_mask:0xc
s_nop 0
v_add_f32_dpp v18, v169, v169 row_shl:4 row_mask:0xf bank_mask:0x5
v_add_f32_dpp v18, v173, v173 row_shr:4 row_mask:0xf bank_mask:0xa
s_nop 1
v_add_f32_dpp v18, v18, v18 quad_perm:[1,0,3,2] row_mask:0xf bank_mask:0xf
s_nop 1
v_add_f32_dpp v18, v18, v18 quad_perm:[2,3,0,1] row_mask:0xf bank_mask:0xf
v_cvt_pk_bf16_f32 v18, 0, v18
v_mul_f32 v18, s66, v18
v_cvt_pk_bf16_f32 v18, 0, v18
s_cmp_eq_u32 s34, 1
s_cbranch_scc0 L_w_91
v_mov_b32 v60, 22
s_mov_b64 exec, 1
buffer_store_dword v60, off, s[36:39], s63 offset:0
s_mov_b64 exec, -1
L_w_91:
s_xor_b32 s64, s65, 134144
s_cmpk_gt_u32 s69, 86
s_waitcnt vmcnt(6)
s_cbranch_scc1 L_d_90
s_waitcnt vmcnt(4)
L_d_90:
buffer_load_dwordx4 v[64:67], v1, s[44:47], s64 offen nt
v_dot2_f32_bf16 v184, v184, v4, 0
v_dot2_f32_bf16 v188, v188, v4, 0
v_dot2_f32_bf16 v192, v192, v4, 0
v_dot2_f32_bf16 v196, v196, v4, 0
v_dot2c_f32_bf16 v184, v185, v5
v_dot2c_f32_bf16 v188, v189, v5
v_dot2c_f32_bf16 v192, v193, v5
v_dot2c_f32_bf16 v196, v197, v5
v_dot2c_f32_bf16 v184, v186, v6
v_dot2c_f32_bf16 v188, v190, v6
v_dot2c_f32_bf16 v192, v194, v6
v_dot2c_f32_bf16 v196, v198, v6
v_dot2c_f32_bf16 v184, v187, v7
v_dot2c_f32_bf16 v188, v191, v7
v_dot2c_f32_bf16 v192, v195, v7
v_dot2c_f32_bf16 v196, v199, v7
v_add_f32_dpp v185, v184, v184 row_ror:8 row_mask:0xf bank_mask:0x3
v_add_f32_dpp v189, v188, v188 row_ror:8 row_mask:0xf bank_mask:0x3
v_add_f32_dpp v185, v192, v192 row_ror:8 row_mask:0xf bank_mask:0xc
v_add_f32_dpp v189, v196, v196 row_ror:8 row_mask:0xf bank_mask:0xc
s_nop 0
v_add_f32_dpp v19, v185, v185 row_shl:4 row_mask:0xf bank_mask:0x5
v_add_f32_dpp v19, v189, v189 row_shr:4 row_mask:0xf bank_mask:0xa
s_nop 1
v_add_f32_dpp v19, v19, v19 quad_perm:[1,0,3,2] row_mask:0xf bank_mask:0xf
s_nop 1
v_add_f32_dpp v19, v19, v19 quad_perm:[2,3,0,1] row_mask:0xf bank_mask:0xf
v_cvt_pk_bf16_f32 v19, 0, v19
v_mul_f32 v19, s66, v19
v_cvt_pk_bf16_f32 v19, 0, v19
s_xor_b32 s64, s65, 199680
s_cmpk_gt_u32 s69, 87
s_waitcnt vmcnt(6)
s_cbranch_scc1 L_d_92
s_waitcnt vmcnt(4)
L_d_92:
buffer_load_dwordx4 v[68:71], v1, s[44:47], s64 offen nt
v_dot2_f32_bf16 v200, v200, v4, 0
v_dot2_f32_bf16 v204, v204, v4, 0
v_dot2_f32_bf16 v208, v208, v4, 0
v_dot2_f32_bf16 v212, v212, v4, 0
v_dot2c_f32_bf16 v200, v201, v5
v_dot2c_f32_bf16 v204, v205, v5
v_dot2c_f32_bf16 v208, v209, v5
v_dot2c_f32_bf16 v212, v213, v5
v_dot2c_f32_bf16 v200, v202, v6
v_dot2c_f32_bf16 v204, v206, v6
v_dot2c_f32_bf16 v208, v210, v6
v_dot2c_f32_bf16 v212, v214, v6
v_dot2c_f32_bf16 v200, v203, v7
v_dot2c_f32_bf16 v204, v207, v7
v_dot2c_f32_bf16 v208, v211, v7
v_dot2c_f32_bf16 v212, v215, v7
v_add_f32_dpp v201, v200, v200 row_ror:8 row_mask:0xf bank_mask:0x3
v_add_f32_dpp v205, v204, v204 row_ror:8 row_mask:0xf bank_mask:0x3
v_add_f32_dpp v201, v208, v208 row_ror:8 row_mask:0xf bank_mask:0xc
v_add_f32_dpp v205, v212, v212 row_ror:8 row_mask:0xf bank_mask:0xc
s_nop 0
v_add_f32_dpp v20, v201, v201 row_shl:4 row_mask:0xf bank_mask:0x5
v_add_f32_dpp v20, v205, v205 row_shr:4 row_mask:0xf bank_mask:0xa
s_nop 1
v_add_f32_dpp v20, v20, v20 quad_perm:[1,0,3,2] row_mask:0xf bank_mask:0xf
s_nop 1
v_add_f32_dpp v20, v20, v20 quad_perm:[2,3,0,1] row_mask:0xf bank_mask:0xf
v_cvt_pk_bf16_f32 v20, 0, v20
v_mul_f32 v20, s66, v20
v_cvt_pk_bf16_f32 v20, 0, v20
s_xor_b32 s64, s65, 163840
s_cmpk_gt_u32 s69, 88
s_waitcnt vmcnt(6)
s_cbranch_scc1 L_d_93
s_waitcnt vmcnt(4)
L_d_93:
buffer_load_dwordx4 v[72:75], v1, s[44:47], s64 offen nt
v_dot2_f32_bf16 v216, v216, v4, 0
v_dot2_f32_bf16 v220, v220, v4, 0
v_dot2_f32_bf16 v224, v224, v4, 0
v_dot2_f32_bf16 v228, v228, v4, 0
v_dot2c_f32_bf16 v216, v217, v5
v_dot2c_f32_bf16 v220, v221, v5
v_dot2c_f32_bf16 v224, v225, v5
v_dot2c_f32_bf16 v228, v229, v5
v_dot2c_f32_bf16 v216, v218, v6
v_dot2c_f32_bf16 v220, v222, v6
v_dot2c_f32_bf16 v224, v226, v6
v_dot2c_f32_bf16 v228, v230, v6
v_dot2c_f32_bf16 v216, v219, v7
v_dot2c_f32_bf16 v220, v223, v7
v_dot2c_f32_bf16 v224, v227, v7
v_dot2c_f32_bf16 v228, v231, v7
v_add_f32_dpp v217, v216, v216 row_ror:8 row_mask:0xf bank_mask:0x3
v_add_f32_dpp v221, v220, v220 row_ror:8 row_mask:0xf bank_mask:0x3
v_add_f32_dpp v217, v224, v224 row_ror:8 row_mask:0xf bank_mask:0xc
v_add_f32_dpp v221, v228, v228 row_ror:8 row_mask:0xf bank_mask:0xc
s_nop 0
v_add_f32_dpp v21, v217, v217 row_shl:4 row_mask:0xf bank_mask:0x5
v_add_f32_dpp v21, v221, v221 row_shr:4 row_mask:0xf bank_mask:0xa
s_nop 1
v_add_f32_dpp v21, v21, v21 quad_perm:[1,0,3,2] row_mask:0xf bank_mask:0xf
s_nop 1
v_add_f32_dpp v21, v21, v21 quad_perm:[2,3,0,1] row_mask:0xf bank_mask:0xf
v_cvt_pk_bf16_f32 v21, 0, v21
v_mul_f32 v21, s66, v21
v_cvt_pk_bf16_f32 v21, 0, v21
s_xor_b32 s64, s65, 229376
s_cmpk_gt_u32 s69, 89
s_waitcnt vmcnt(6)
s_cbranch_scc1 L_d_94
s_waitcnt vmcnt(4)
L_d_94:
buffer_load_dwordx4 v[76:79], v1, s[44:47], s64 offen nt
v_dot2_f32_bf16 v232, v232, v4, 0
v_dot2_f32_bf16 v236, v236, v4, 0
v_dot2_f32_bf16 v240, v240, v4, 0
v_dot2_f32_bf16 v244, v244, v4, 0
v_dot2c_f32_bf16 v232, v233, v5
v_dot2c_f32_bf16 v236, v237, v5
v_dot2c_f32_bf16 v240, v241, v5
v_dot2c_f32_bf16 v244, v245, v5
v_dot2c_f32_bf16 v232, v234, v6
v_dot2c_f32_bf16 v236, v238, v6
v_dot2c_f32_bf16 v240, v242, v6
v_dot2c_f32_bf16 v244, v246, v6
v_dot2c_f32_bf16 v232, v235, v7
v_dot2c_f32_bf16 v236, v239, v7
v_dot2c_f32_bf16 v240, v243, v7
v_dot2c_f32_bf16 v244, v247, v7
v_add_f32_dpp v233, v232, v232 row_ror:8 row_mask:0xf bank_mask:0x3
v_add_f32_dpp v237, v236, v236 row_ror:8 row_mask:0xf bank_mask:0x3
v_add_f32_dpp v233, v240, v240 row_ror:8 row_mask:0xf bank_mask:0xc
v_add_f32_dpp v237, v244, v244 row_ror:8 row_mask:0xf bank_mask:0xc
s_nop 0
v_add_f32_dpp v22, v233, v233 row_shl:4 row_mask:0xf bank_mask:0x5
v_add_f32_dpp v22, v237, v237 row_shr:4 row_mask:0xf bank_mask:0xa
s_nop 1
v_add_f32_dpp v22, v22, v22 quad_perm:[1,0,3,2] row_mask:0xf bank_mask:0xf
s_nop 1
v_add_f32_dpp v22, v22, v22 quad_perm:[2,3,0,1] row_mask:0xf bank_mask:0xf
v_cvt_pk_bf16_f32 v22, 0, v22
v_mul_f32 v22, s66, v22
v_cvt_pk_bf16_f32 v22, 0, v22
s_xor_b32 s64, s65, 165888
s_cmpk_gt_u32 s69, 90
s_waitcnt vmcnt(6)
s_cbranch_scc1 L_d_95
s_waitcnt vmcnt(5)
L_d_95:
buffer_load_dwordx4 v[80:83], v1, s[44:47], s64 offen nt
v_lshl_add_u32 v84, v0, 4, s70
ds_read_b128 v[88:91], v84 offset:0
ds_read_b128 v[92:95], v84 offset:1024
s_waitcnt lgkmcnt(0)
v_dot2_f32_bf16 v248, v248, v4, 0
v_dot2_f32_bf16 v252, v252, v4, 0
v_dot2_f32_bf16 v88, v88, v4, 0
v_dot2_f32_bf16 v92, v92, v4, 0
v_dot2c_f32_bf16 v248, v249, v5
v_dot2c_f32_bf16 v252, v253, v5
v_dot2c_f32_bf16 v88, v89, v5
v_dot2c_f32_bf16 v92, v93, v5
v_dot2c_f32_bf16 v248, v250, v6
v_dot2c_f32_bf16 v252, v254, v6
v_dot2c_f32_bf16 v88, v90, v6
v_dot2c_f32_bf16 v92, v94, v6
v_dot2c_f32_bf16 v248, v251, v7
v_dot2c_f32_bf16 v252, v255, v7
v_dot2c_f32_bf16 v88, v91, v7
v_dot2c_f32_bf16 v92, v95, v7
v_add_f32_dpp v249, v248, v248 row_ror:8 row_mask:0xf bank_mask:0x3
v_add_f32_dpp v253, v252, v252 row_ror:8 row_mask:0xf bank_mask:0x3
v_add_f32_dpp v249, v88, v88 row_ror:8 row_mask:0xf bank_mask:0xc
v_add_f32_dpp v253, v92, v92 row_ror:8 row_mask:0xf bank_mask:0xc
s_nop 0
v_add_f32_dpp v23, v249, v249 row_shl:4 row_mask:0xf bank_mask:0x5
v_add_f32_dpp v23, v253, v253 row_shr:4 row_mask:0xf bank_mask:0xa
s_nop 1
v_add_f32_dpp v23, v23, v23 quad_perm:[1,0,3,2] row_mask:0xf bank_mask:0xf
s_nop 1
v_add_f32_dpp v23, v23, v23 quad_perm:[2,3,0,1] row_mask:0xf bank_mask:0xf
v_cvt_pk_bf16_f32 v23, 0, v23
v_mul_f32 v23, s66, v23
v_cvt_pk_bf16_f32 v23, 0, v23
s_xor_b32 s64, s65, 231424
s_cmpk_gt_u32 s69, 91
s_waitcnt vmcnt(6)
s_cbranch_scc1 L_d_96
s_waitcnt vmcnt(5)
L_d_96:
buffer_load_dwordx4 v[96:99], v1, s[44:47], s64 offen nt
v_max3_f32 v2, v17, v8, v9
v_max3_f32 v2, v2, v10, v11
v_max3_f32 v2, v2, v12, v13
v_max3_f32 v2, v2, v14, v15
v_max3_f32 v2, v2, v16, v18
v_max3_f32 v2, v2, v19, v20
v_max3_f32 v2, v2, v21, v22
v_max_f32 v2, v2, v23
v_max_f32 v2, 0xff7fffff, v2
s_nop 1
v_max_f32_dpp v2, v2, v2 row_ror:4 row_mask:0xf bank_mask:0xf
s_nop 1
v_max_f32_dpp v2, v2, v2 row_ror:8 row_mask:0xf bank_mask:0xf
v_mov_b32 v3, v2
s_nop 1
v_permlane16_swap_b32 v2, v3
s_nop 1
v_max_f32 v2, v2, v3
v_mov_b32 v3, v2
s_nop 1
v_permlane32_swap_b32 v2, v3
s_nop 1
v_max_f32 v2, v2, v3
s_mov_b32 s67, 0x3fb8aa3b
v_sub_f32 v17, v17, v2
v_sub_f32 v8, v8, v2
v_sub_f32 v9, v9, v2
v_sub_f32 v10, v10, v2
v_sub_f32 v11, v11, v2
v_sub_f32 v12, v12, v2
v_sub_f32 v13, v13, v2
v_sub_f32 v14, v14, v2
v_sub_f32 v15, v15, v2
v_sub_f32 v16, v16, v2
v_sub_f32 v18, v18, v2
v_sub_f32 v19, v19, v2
v_sub_f32 v20, v20, v2
v_sub_f32 v21, v21, v2
v_sub_f32 v22, v22, v2
v_sub_f32 v23, v23, v2
v_mul_f32 v17, s67, v17
v_mul_f32 v8, s67, v8
v_mul_f32 v9, s67, v9
v_mul_f32 v10, s67, v10
v_mul_f32 v11, s67, v11
v_mul_f32 v12, s67, v12
v_mul_f32 v13, s67, v13
v_mul_f32 v14, s67, v14
v_mul_f32 v15, s67, v15
v_mul_f32 v16, s67, v16
v_mul_f32 v18, s67, v18
v_mul_f32 v19, s67, v19
v_mul_f32 v20, s67, v20
v_mul_f32 v21, s67, v21
v_mul_f32 v22, s67, v22
v_mul_f32 v23, s67, v23
s_xor_b32 s64, s65, 164864
s_cmpk_gt_u32 s69, 92
s_waitcnt vmcnt(6)
s_cbranch_scc1 L_d_97
s_waitcnt vmcnt(5)
L_d_97:
buffer_load_dwordx4 v[120:123], v1, s[44:47], s64 offen nt
v_exp_f32 v17, v17
v_exp_f32 v8, v8
v_exp_f32 v9, v9
v_exp_f32 v10, v10
v_exp_f32 v11, v11
v_exp_f32 v12, v12
v_exp_f32 v13, v13
v_exp_f32 v14, v14
v_exp_f32 v15, v15
v_exp_f32 v16, v16
v_exp_f32 v18, v18
v_exp_f32 v19, v19
v_exp_f32 v20, v20
v_exp_f32 v21, v21
v_exp_f32 v22, v22
v_exp_f32 v23, v23
v_add_f32 v3, v17, v8
v_add_f32 v3, v3, v9
v_add_f32 v3, v3, v10
v_add_f32 v3, v3, v11
v_add_f32 v3, v3, v12
v_add_f32 v3, v3, v13
v_add_f32 v3, v3, v14
v_add_f32 v3, v3, v15
v_add_f32 v3, v3, v16
v_add_f32 v3, v3, v18
v_add_f32 v3, v3, v19
v_add_f32 v3, v3, v20
v_add_f32 v3, v3, v21
v_add_f32 v3, v3, v22
v_add_f32 v3, v3, v23
s_nop 1
v_add_f32_dpp v3, v3, v3 row_ror:4 row_mask:0xf bank_mask:0xf
s_nop 1
v_add_f32_dpp v3, v3, v3 row_ror:8 row_mask:0xf bank_mask:0xf
v_mov_b32 v100, v3
s_nop 1
v_permlane16_swap_b32 v3, v100
s_nop 1
v_add_f32 v3, v3, v100
v_mov_b32 v100, v3
s_nop 1
v_permlane32_swap_b32 v3, v100
s_nop 1
v_add_f32 v3, v3, v100
v_min_u32 v3, -2, v3
s_lshl_b32 s68, s34, 3
v_mov_b32 v100, s68
ds_write_b64 v100, v[2:3] offset:256
v_and_b32 v101, 15, v0
v_lshrrev_b32 v102, 1, v101
v_and_b32 v101, 1, v0
v_lshlrev_b32 v101, 4, v101
v_mov_b32 v103, 0xffff
v_lshlrev_b32 v101, v101, v103
v_cmp_eq_u32 vcc, 0, v102
s_nop 1
v_cndmask_b32 v4, 0, v101, vcc
v_cmp_eq_u32 vcc, 1, v102
s_nop 1
v_cndmask_b32 v5, 0, v101, vcc
v_cmp_eq_u32 vcc, 2, v102
s_nop 1
v_cndmask_b32 v6, 0, v101, vcc
v_cmp_eq_u32 vcc, 3, v102
s_nop 1
v_cndmask_b32 v7, 0, v101, vcc
s_xor_b32 s64, s65, 230400
s_cmpk_gt_u32 s69, 93
s_waitcnt vmcnt(6)
s_cbranch_scc1 L_d_98
s_waitcnt vmcnt(5)
L_d_98:
buffer_load_dwordx4 v[124:127], v1, s[44:47], s64 offen nt
v_mov_b32 v100, 0
s_mov_b32 s75, 0
L_poll_99:
ds_read_b128 v[104:107], v100 offset:256
ds_read_b128 v[108:111], v100 offset:272
s_waitcnt lgkmcnt(0)
v_max3_u32 v101, v105, v107, v109
v_max_u32 v101, v101, v111
v_cmp_eq_u32 vcc, -1, v101
s_cbranch_vccz L_pollx_100
s_add_u32 s75, s75, 1
s_cmp_lt_u32 s75, 0x1000000
s_cbranch_scc1 L_poll_99
L_pollx_100:
v_max3_f32 v101, v104, v106, v108
v_max_f32 v101, v101, v110
v_sub_f32 v104, v104, v101
v_sub_f32 v106, v106, v101
v_sub_f32 v108, v108, v101
v_sub_f32 v110, v110, v101
v_sub_f32 v2, v2, v101
v_mul_f32 v104, s67, v104
v_mul_f32 v106, s67, v106
v_mul_f32 v108, s67, v108
v_mul_f32 v110, s67, v110
v_mul_f32 v2, s67, v2
v_exp_f32 v104, v104
v_exp_f32 v106, v106
v_exp_f32 v108, v108
v_exp_f32 v110, v110
v_exp_f32 v2, v2
v_mul_f32 v3, v104, v105
v_fmac_f32 v3, v106, v107
v_fmac_f32 v3, v108, v109
v_fmac_f32 v3, v110, v111
v_rcp_f32 v3, v3
s_nop 0
v_mul_f32 v2, v2, v3
v_mul_f32 v17, v17, v2
v_mul_f32 v8, v8, v2
v_mul_f32 v9, v9, v2
v_mul_f32 v10, v10, v2
v_mul_f32 v11, v11, v2
v_mul_f32 v12, v12, v2
v_mul_f32 v13, v13, v2
v_mul_f32 v14, v14, v2
v_mul_f32 v15, v15, v2
v_mul_f32 v16, v16, v2
v_mul_f32 v18, v18, v2
v_mul_f32 v19, v19, v2
v_mul_f32 v20, v20, v2
v_mul_f32 v21, v21, v2
v_mul_f32 v22, v22, v2
v_mul_f32 v23, v23, v2
v_cvt_pk_bf16_f32 v17, v17, v17
v_cvt_pk_bf16_f32 v8, v8, v8
v_cvt_pk_bf16_f32 v9, v9, v9
v_cvt_pk_bf16_f32 v10, v10, v10
v_cvt_pk_bf16_f32 v11, v11, v11
v_cvt_pk_bf16_f32 v12, v12, v12
v_cvt_pk_bf16_f32 v13, v13, v13
v_cvt_pk_bf16_f32 v14, v14, v14
v_cvt_pk_bf16_f32 v15, v15, v15
v_cvt_pk_bf16_f32 v16, v16, v16
v_cvt_pk_bf16_f32 v18, v18, v18
v_cvt_pk_bf16_f32 v19, v19, v19
v_cvt_pk_bf16_f32 v20, v20, v20
v_cvt_pk_bf16_f32 v21, v21, v21
v_cvt_pk_bf16_f32 v22, v22, v22
v_cvt_pk_bf16_f32 v23, v23, v23
s_nop 1
s_cmp_eq_u32 s34, 2
s_cbranch_scc0 L_w_102
v_mov_b32 v60, 30
s_mov_b64 exec, 1
buffer_store_dword v60, off, s[36:39], s63 offset:0
s_mov_b64 exec, -1
L_w_102:
s_xor_b32 s64, s65, 166912
s_cmpk_gt_u32 s69, 94
s_waitcnt vmcnt(6)
s_cbranch_scc1 L_d_101
s_waitcnt vmcnt(5)
L_d_101:
buffer_load_dwordx4 v[128:131], v1, s[44:47], s64 offen nt
ds_read_b128 v[132:135], v84 offset:2048
ds_read_b128 v[136:139], v84 offset:3072
ds_read_b128 v[140:143], v84 offset:4096
ds_read_b128 v[144:147], v84 offset:5120
ds_read_b128 v[148:151], v84 offset:6144
ds_read_b128 v[152:155], v84 offset:7168
ds_read_b128 v[156:159], v84 offset:8192
ds_read_b128 v[160:163], v84 offset:9216
s_waitcnt lgkmcnt(0)
v_and_b32_dpp v104, v17, v4 row_newbcast:0 row_mask:0xf bank_mask:0xf
v_and_b32_dpp v105, v17, v5 row_newbcast:0 row_mask:0xf bank_mask:0xf
v_and_b32_dpp v106, v17, v6 row_newbcast:0 row_mask:0xf bank_mask:0xf
v_and_b32_dpp v107, v17, v7 row_newbcast:0 row_mask:0xf bank_mask:0xf
v_and_b32_dpp v108, v17, v4 row_newbcast:4 row_mask:0xf bank_mask:0xf
v_and_b32_dpp v109, v17, v5 row_newbcast:4 row_mask:0xf bank_mask:0xf
v_and_b32_dpp v110, v17, v6 row_newbcast:4 row_mask:0xf bank_mask:0xf
v_and_b32_dpp v111, v17, v7 row_newbcast:4 row_mask:0xf bank_mask:0xf
v_mfma_f32_16x16x32_bf16 v[112:115], v[104:107], v[132:135], 0
v_and_b32_dpp v104, v17, v4 row_newbcast:8 row_mask:0xf bank_mask:0xf
v_and_b32_dpp v105, v17, v5 row_newbcast:8 row_mask:0xf bank_mask:0xf
v_and_b32_dpp v106, v17, v6 row_newbcast:8 row_mask:0xf bank_mask:0xf
v_and_b32_dpp v107, v17, v7 row_newbcast:8 row_mask:0xf bank_mask:0xf
v_mfma_f32_16x16x32_bf16 v[112:115], v[108:111], v[136:139], v[112:115]
v_and_b32_dpp v108, v17, v4 row_newbcast:12 row_mask:0xf bank_mask:0xf
v_and_b32_dpp v109, v17, v5 row_newbcast:12 row_mask:0xf bank_mask:0xf
v_and_b32_dpp v110, v17, v6 row_newbcast:12 row_mask:0xf bank_mask:0xf
v_and_b32_dpp v111, v17, v7 row_newbcast:12 row_mask:0xf bank_mask:0xf
v_mfma_f32_16x16x32_bf16 v[112:115], v[104:107], v[140:143], v[112:115]
v_and_b32_dpp v104, v8, v4 row_newbcast:0 row_mask:0xf bank_mask:0xf
v_and_b32_dpp v105, v8, v5 row_newbcast:0 row_mask:0xf bank_mask:0xf
v_and_b32_dpp v106, v8, v6 row_newbcast:0 row_mask:0xf bank_mask:0xf
v_and_b32_dpp v107, v8, v7 row_newbcast:0 row_mask:0xf bank_mask:0xf
v_mfma_f32_16x16x32_bf16 v[112:115], v[108:111], v[144:147], v[112:115]
v_and_b32_dpp v108, v8, v4 row_newbcast:4 row_mask:0xf bank_mask:0xf
v_and_b32_dpp v109, v8, v5 row_newbcast:4 row_mask:0xf bank_mask:0xf
v_and_b32_dpp v110, v8, v6 row_newbcast:4 row_mask:0xf bank_mask:0xf
v_and_b32_dpp v111, v8, v7 row_newbcast:4 row_mask:0xf bank_mask:0xf
v_mfma_f32_16x16x32_bf16 v[112:115], v[104:107], v[148:151], v[112:115]
s_xor_b32 s64, s65, 232448
s_cmpk_gt_u32 s69, 95
s_waitcnt vmcnt(6)
s_cbranch_scc1 L_d_103
s_waitcnt vmcnt(5)
L_d_103:
buffer_load_dwordx4 v[164:167], v1, s[44:47], s64 offen nt
v_and_b32_dpp v104, v8, v4 row_newbcast:8 row_mask:0xf bank_mask:0xf
v_and_b32_dpp v105, v8, v5 row_newbcast:8 row_mask:0xf bank_mask:0xf
v_and_b32_dpp v106, v8, v6 row_newbcast:8 row_mask:0xf bank_mask:0xf
v_and_b32_dpp v107, v8, v7 row_newbcast:8 row_mask:0xf bank_mask:0xf
v_mfma_f32_16x16x32_bf16 v[112:115], v[108:111], v[152:155], v[112:115]
v_and_b32_dpp v108, v8, v4 row_newbcast:12 row_mask:0xf bank_mask:0xf
v_and_b32_dpp v109, v8, v5 row_newbcast:12 row_mask:0xf bank_mask:0xf
v_and_b32_dpp v110, v8, v6 row_newbcast:12 row_mask:0xf bank_mask:0xf
v_and_b32_dpp v111, v8, v7 row_newbcast:12 row_mask:0xf bank_mask:0xf
v_mfma_f32_16x16x32_bf16 v[112:115], v[104:107], v[156:159], v[112:115]
v_and_b32_dpp v104, v9, v4 row_newbcast:0 row_mask:0xf bank_mask:0xf
v_and_b32_dpp v105, v9, v5 row_newbcast:0 row_mask:0xf bank_mask:0xf
v_and_b32_dpp v106, v9, v6 row_newbcast:0 row_mask:0xf bank_mask:0xf
v_and_b32_dpp v107, v9, v7 row_newbcast:0 row_mask:0xf bank_mask:0xf
v_mfma_f32_16x16x32_bf16 v[112:115], v[108:111], v[160:163], v[112:115]
ds_read_b128 v[168:171], v84 offset:10240
ds_read_b128 v[172:175], v84 offset:11264
ds_read_b128 v[176:179], v84 offset:12288
ds_read_b128 v[180:183], v84 offset:13312
ds_read_b128 v[184:187], v84 offset:14336
s_waitcnt lgkmcnt(0)
v_and_b32_dpp v108, v9, v4 row_newbcast:4 row_mask:0xf bank_mask:0xf
v_and_b32_dpp v109, v9, v5 row_newbcast:4 row_mask:0xf bank_mask:0xf
v_and_b32_dpp v110, v9, v6 row_newbcast:4 row_mask:0xf bank_mask:0xf
v_and_b32_dpp v111, v9, v7 row_newbcast:4 row_mask:0xf bank_mask:0xf
v_mfma_f32_16x16x32_bf16 v[112:115], v[104:107], v[168:171], v[112:115]
v_and_b32_dpp v104, v9, v4 row_newbcast:8 row_mask:0xf bank_mask:0xf
v_and_b32_dpp v105, v9, v5 row_newbcast:8 row_mask:0xf bank_mask:0xf
v_and_b32_dpp v106, v9, v6 row_newbcast:8 row_mask:0xf bank_mask:0xf
v_and_b32_dpp v107, v9, v7 row_newbcast:8 row_mask:0xf bank_mask:0xf
v_mfma_f32_16x16x32_bf16 v[112:115], v[108:111], v[172:175], v[112:115]
s_xor_b32 s64, s65, 4096
s_cmpk_gt_u32 s69, 96
s_waitcnt vmcnt(6)
s_cbranch_scc1 L_d_104
s_waitcnt vmcnt(5)
L_d_104:
buffer_load_dwordx4 v[188:191], v1, s[44:47], s64 offen nt
v_and_b32_dpp v108, v9, v4 row_newbcast:12 row_mask:0xf bank_mask:0xf
v_and_b32_dpp v109, v9, v5 row_newbcast:12 row_mask:0xf bank_mask:0xf
v_and_b32_dpp v110, v9, v6 row_newbcast:12 row_mask:0xf bank_mask:0xf
v_and_b32_dpp v111, v9, v7 row_newbcast:12 row_mask:0xf bank_mask:0xf
v_mfma_f32_16x16x32_bf16 v[112:115], v[104:107], v[176:179], v[112:115]
v_and_b32_dpp v104, v10, v4 row_newbcast:0 row_mask:0xf bank_mask:0xf
v_and_b32_dpp v105, v10, v5 row_newbcast:0 row_mask:0xf bank_mask:0xf
v_and_b32_dpp v106, v10, v6 row_newbcast:0 row_mask:0xf bank_mask:0xf
v_and_b32_dpp v107, v10, v7 row_newbcast:0 row_mask:0xf bank_mask:0xf
v_mfma_f32_16x16x32_bf16 v[112:115], v[108:111], v[180:183], v[112:115]
v_and_b32_dpp v108, v10, v4 row_newbcast:4 row_mask:0xf bank_mask:0xf
v_and_b32_dpp v109, v10, v5 row_newbcast:4 row_mask:0xf bank_mask:0xf
v_and_b32_dpp v110, v10, v6 row_newbcast:4 row_mask:0xf bank_mask:0xf
v_and_b32_dpp v111, v10, v7 row_newbcast:4 row_mask:0xf bank_mask:0xf
v_mfma_f32_16x16x32_bf16 v[112:115], v[104:107], v[184:187], v[112:115]
v_and_b32_dpp v104, v10, v4 row_newbcast:8 row_mask:0xf bank_mask:0xf
v_and_b32_dpp v105, v10, v5 row_newbcast:8 row_mask:0xf bank_mask:0xf
v_and_b32_dpp v106, v10, v6 row_newbcast:8 row_mask:0xf bank_mask:0xf
v_and_b32_dpp v107, v10, v7 row_newbcast:8 row_mask:0xf bank_mask:0xf
v_mfma_f32_16x16x32_bf16 v[112:115], v[108:111], v[24:27], v[112:115]
v_and_b32_dpp v108, v10, v4 row_newbcast:12 row_mask:0xf bank_mask:0xf
v_and_b32_dpp v109, v10, v5 row_newbcast:12 row_mask:0xf bank_mask:0xf
v_and_b32_dpp v110, v10, v6 row_newbcast:12 row_mask:0xf bank_mask:0xf
v_and_b32_dpp v111, v10, v7 row_newbcast:12 row_mask:0xf bank_mask:0xf
v_mfma_f32_16x16x32_bf16 v[112:115], v[104:107], v[28:31], v[112:115]
s_xor_b32 s64, s65, 69632
s_cmpk_gt_u32 s69, 97
s_waitcnt vmcnt(6)
s_cbranch_scc1 L_d_105
s_waitcnt vmcnt(5)
L_d_105:
buffer_load_dwordx4 v[192:195], v1, s[44:47], s64 offen nt
v_and_b32_dpp v104, v11, v4 row_newbcast:0 row_mask:0xf bank_mask:0xf
v_and_b32_dpp v105, v11, v5 row_newbcast:0 row_mask:0xf bank_mask:0xf
v_and_b32_dpp v106, v11, v6 row_newbcast:0 row_mask:0xf bank_mask:0xf
v_and_b32_dpp v107, v11, v7 row_newbcast:0 row_mask:0xf bank_mask:0xf
v_mfma_f32_16x16x32_bf16 v[112:115], v[108:111], v[32:35], v[112:115]
v_and_b32_dpp v108, v11, v4 row_newbcast:4 row_mask:0xf bank_mask:0xf
v_and_b32_dpp v109, v11, v5 row_newbcast:4 row_mask:0xf bank_mask:0xf
v_and_b32_dpp v110, v11, v6 row_newbcast:4 row_mask:0xf bank_mask:0xf
v_and_b32_dpp v111, v11, v7 row_newbcast:4 row_mask:0xf bank_mask:0xf
v_mfma_f32_16x16x32_bf16 v[112:115], v[104:107], v[36:39], v[112:115]
v_and_b32_dpp v104, v11, v4 row_newbcast:8 row_mask:0xf bank_mask:0xf
v_and_b32_dpp v105, v11, v5 row_newbcast:8 row_mask:0xf bank_mask:0xf
v_and_b32_dpp v106, v11, v6 row_newbcast:8 row_mask:0xf bank_mask:0xf
v_and_b32_dpp v107, v11, v7 row_newbcast:8 row_mask:0xf bank_mask:0xf
v_mfma_f32_16x16x32_bf16 v[112:115], v[108:111], v[40:43], v[112:115]
v_and_b32_dpp v108, v11, v4 row_newbcast:12 row_mask:0xf bank_mask:0xf
v_and_b32_dpp v109, v11, v5 row_newbcast:12 row_mask:0xf bank_mask:0xf
v_and_b32_dpp v110, v11, v6 row_newbcast:12 row_mask:0xf bank_mask:0xf
v_and_b32_dpp v111, v11, v7 row_newbcast:12 row_mask:0xf bank_mask:0xf
v_mfma_f32_16x16x32_bf16 v[112:115], v[104:107], v[44:47], v[112:115]
v_and_b32_dpp v104, v12, v4 row_newbcast:0 row_mask:0xf bank_mask:0xf
v_and_b32_dpp v105, v12, v5 row_newbcast:0 row_mask:0xf bank_mask:0xf
v_and_b32_dpp v106, v12, v6 row_newbcast:0 row_mask:0xf bank_mask:0xf
v_and_b32_dpp v107, v12, v7 row_newbcast:0 row_mask:0xf bank_mask:0xf
v_mfma_f32_16x16x32_bf16 v[112:115], v[108:111], v[48:51], v[112:115]
s_xor_b32 s64, s65, 6144
s_cmpk_gt_u32 s69, 98
s_waitcnt vmcnt(6)
s_cbranch_scc1 L_d_106
s_waitcnt vmcnt(5)
L_d_106:
buffer_load_dwordx4 v[196:199], v1, s[44:47], s64 offen nt
v_and_b32_dpp v108, v12, v4 row_newbcast:4 row_mask:0xf bank_mask:0xf
v_and_b32_dpp v109, v12, v5 row_newbcast:4 row_mask:0xf bank_mask:0xf
v_and_b32_dpp v110, v12, v6 row_newbcast:4 row_mask:0xf bank_mask:0xf
v_and_b32_dpp v111, v12, v7 row_newbcast:4 row_mask:0xf bank_mask:0xf
v_mfma_f32_16x16x32_bf16 v[112:115], v[104:107], v[52:55], v[112:115]
v_and_b32_dpp v104, v12, v4 row_newbcast:8 row_mask:0xf bank_mask:0xf
v_and_b32_dpp v105, v12, v5 row_newbcast:8 row_mask:0xf bank_mask:0xf
v_and_b32_dpp v106, v12, v6 row_newbcast:8 row_mask:0xf bank_mask:0xf
v_and_b32_dpp v107, v12, v7 row_newbcast:8 row_mask:0xf bank_mask:0xf
v_mfma_f32_16x16x32_bf16 v[112:115], v[108:111], v[56:59], v[112:115]
v_and_b32_dpp v108, v12, v4 row_newbcast:12 row_mask:0xf bank_mask:0xf
v_and_b32_dpp v109, v12, v5 row_newbcast:12 row_mask:0xf bank_mask:0xf
v_and_b32_dpp v110, v12, v6 row_newbcast:12 row_mask:0xf bank_mask:0xf
v_and_b32_dpp v111, v12, v7 row_newbcast:12 row_mask:0xf bank_mask:0xf
v_mfma_f32_16x16x32_bf16 v[112:115], v[104:107], v[64:67], v[112:115]
v_and_b32_dpp v104, v13, v4 row_newbcast:0 row_mask:0xf bank_mask:0xf
v_and_b32_dpp v105, v13, v5 row_newbcast:0 row_mask:0xf bank_mask:0xf
v_and_b32_dpp v106, v13, v6 row_newbcast:0 row_mask:0xf bank_mask:0xf
v_and_b32_dpp v107, v13, v7 row_newbcast:0 row_mask:0xf bank_mask:0xf
v_mfma_f32_16x16x32_bf16 v[112:115], v[108:111], v[68:71], v[112:115]
v_and_b32_dpp v108, v13, v4 row_newbcast:4 row_mask:0xf bank_mask:0xf
v_and_b32_dpp v109, v13, v5 row_newbcast:4 row_mask:0xf bank_mask:0xf
v_and_b32_dpp v110, v13, v6 row_newbcast:4 row_mask:0xf bank_mask:0xf
v_and_b32_dpp v111, v13, v7 row_newbcast:4 row_mask:0xf bank_mask:0xf
v_mfma_f32_16x16x32_bf16 v[112:115], v[104:107], v[72:75], v[112:115]
s_xor_b32 s64, s65, 71680
s_cmpk_gt_u32 s69, 99
s_waitcnt vmcnt(6)
s_cbranch_scc1 L_d_107
s_waitcnt vmcnt(5)
L_d_107:
buffer_load_dwordx4 v[200:203], v1, s[44:47], s64 offen nt
v_and_b32_dpp v104, v13, v4 row_newbcast:8 row_mask:0xf bank_mask:0xf
v_and_b32_dpp v105, v13, v5 row_newbcast:8 row_mask:0xf bank_mask:0xf
v_and_b32_dpp v106, v13, v6 row_newbcast:8 row_mask:0xf bank_mask:0xf
v_and_b32_dpp v107, v13, v7 row_newbcast:8 row_mask:0xf bank_mask:0xf
v_mfma_f32_16x16x32_bf16 v[112:115], v[108:111], v[76:79], v[112:115]
v_and_b32_dpp v108, v13, v4 row_newbcast:12 row_mask:0xf bank_mask:0xf
v_and_b32_dpp v109, v13, v5 row_newbcast:12 row_mask:0xf bank_mask:0xf
v_and_b32_dpp v110, v13, v6 row_newbcast:12 row_mask:0xf bank_mask:0xf
v_and_b32_dpp v111, v13, v7 row_newbcast:12 row_mask:0xf bank_mask:0xf
v_mfma_f32_16x16x32_bf16 v[112:115], v[104:107], v[80:83], v[112:115]
v_and_b32_dpp v104, v14, v4 row_newbcast:0 row_mask:0xf bank_mask:0xf
v_and_b32_dpp v105, v14, v5 row_newbcast:0 row_mask:0xf bank_mask:0xf
v_and_b32_dpp v106, v14, v6 row_newbcast:0 row_mask:0xf bank_mask:0xf
v_and_b32_dpp v107, v14, v7 row_newbcast:0 row_mask:0xf bank_mask:0xf
v_mfma_f32_16x16x32_bf16 v[112:115], v[108:111], v[96:99], v[112:115]
v_and_b32_dpp v108, v14, v4 row_newbcast:4 row_mask:0xf bank_mask:0xf
v_and_b32_dpp v109, v14, v5 row_newbcast:4 row_mask:0xf bank_mask:0xf
v_and_b32_dpp v110, v14, v6 row_newbcast:4 row_mask:0xf bank_mask:0xf
v_and_b32_dpp v111, v14, v7 row_newbcast:4 row_mask:0xf bank_mask:0xf
v_mfma_f32_16x16x32_bf16 v[112:115], v[104:107], v[120:123], v[112:115]
s_xor_b32 s64, s65, 5120
s_cmpk_gt_u32 s69, 100
s_waitcnt vmcnt(6)
s_cbranch_scc1 L_d_108
s_waitcnt vmcnt(5)
L_d_108:
buffer_load_dwordx4 v[204:207], v1, s[44:47], s64 offen nt
v_and_b32_dpp v104, v14, v4 row_newbcast:8 row_mask:0xf bank_mask:0xf
v_and_b32_dpp v105, v14, v5 row_newbcast:8 row_mask:0xf bank_mask:0xf
v_and_b32_dpp v106, v14, v6 row_newbcast:8 row_mask:0xf bank_mask:0xf
v_and_b32_dpp v107, v14, v7 row_newbcast:8 row_mask:0xf bank_mask:0xf
v_mfma_f32_16x16x32_bf16 v[112:115], v[108:111], v[124:127], v[112:115]
s_xor_b32 s64, s65, 70656
s_cmpk_gt_u32 s69, 101
s_waitcnt vmcnt(6)
s_cbranch_scc1 L_d_109
s_waitcnt vmcnt(5)
L_d_109:
buffer_load_dwordx4 v[208:211], v1, s[44:47], s64 offen nt
v_and_b32_dpp v108, v14, v4 row_newbcast:12 row_mask:0xf bank_mask:0xf
v_and_b32_dpp v109, v14, v5 row_newbcast:12 row_mask:0xf bank_mask:0xf
v_and_b32_dpp v110, v14, v6 row_newbcast:12 row_mask:0xf bank_mask:0xf
v_and_b32_dpp v111, v14, v7 row_newbcast:12 row_mask:0xf bank_mask:0xf
v_mfma_f32_16x16x32_bf16 v[112:115], v[104:107], v[128:131], v[112:115]
s_cmp_eq_u32 s34, 3
s_cbranch_scc0 L_w_111
v_mov_b32 v60, 38
s_mov_b64 exec, 1
buffer_store_dword v60, off, s[36:39], s63 offset:0
s_mov_b64 exec, -1
L_w_111:
s_xor_b32 s64, s65, 7168
s_cmpk_gt_u32 s69, 102
s_waitcnt vmcnt(6)
s_cbranch_scc1 L_d_110
s_waitcnt vmcnt(5)
L_d_110:
buffer_load_dwordx4 v[212:215], v1, s[44:47], s64 offen nt
v_and_b32_dpp v104, v15, v4 row_newbcast:0 row_mask:0xf bank_mask:0xf
v_and_b32_dpp v105, v15, v5 row_newbcast:0 row_mask:0xf bank_mask:0xf
v_and_b32_dpp v106, v15, v6 row_newbcast:0 row_mask:0xf bank_mask:0xf
v_and_b32_dpp v107, v15, v7 row_newbcast:0 row_mask:0xf bank_mask:0xf
v_mfma_f32_16x16x32_bf16 v[112:115], v[108:111], v[164:167], v[112:115]
s_xor_b32 s64, s65, 72704
s_cmpk_gt_u32 s69, 103
s_waitcnt vmcnt(6)
s_cbranch_scc1 L_d_112
s_waitcnt vmcnt(5)
L_d_112:
buffer_load_dwordx4 v[216:219], v1, s[44:47], s64 offen nt
v_and_b32_dpp v108, v15, v4 row_newbcast:4 row_mask:0xf bank_mask:0xf
v_and_b32_dpp v109, v15, v5 row_newbcast:4 row_mask:0xf bank_mask:0xf
v_and_b32_dpp v110, v15, v6 row_newbcast:4 row_mask:0xf bank_mask:0xf
v_and_b32_dpp v111, v15, v7 row_newbcast:4 row_mask:0xf bank_mask:0xf
v_mfma_f32_16x16x32_bf16 v[112:115], v[104:107], v[188:191], v[112:115]
s_xor_b32 s64, s65, 36864
s_cmpk_gt_u32 s69, 104
s_waitcnt vmcnt(6)
s_cbranch_scc1 L_d_113
s_waitcnt vmcnt(5)
L_d_113:
buffer_load_dwordx4 v[220:223], v1, s[44:47], s64 offen nt
v_and_b32_dpp v104, v15, v4 row_newbcast:8 row_mask:0xf bank_mask:0xf
v_and_b32_dpp v105, v15, v5 row_newbcast:8 row_mask:0xf bank_mask:0xf
v_and_b32_dpp v106, v15, v6 row_newbcast:8 row_mask:0xf bank_mask:0xf
v_and_b32_dpp v107, v15, v7 row_newbcast:8 row_mask:0xf bank_mask:0xf
v_mfma_f32_16x16x32_bf16 v[112:115], v[108:111], v[192:195], v[112:115]
s_xor_b32 s64, s65, 102400
s_cmpk_gt_u32 s69, 105
s_waitcnt vmcnt(6)
s_cbranch_scc1 L_d_114
s_waitcnt vmcnt(5)
L_d_114:
buffer_load_dwordx4 v[224:227], v1, s[44:47], s64 offen nt
v_and_b32_dpp v108, v15, v4 row_newbcast:12 row_mask:0xf bank_mask:0xf
v_and_b32_dpp v109, v15, v5 row_newbcast:12 row_mask:0xf bank_mask:0xf
v_and_b32_dpp v110, v15, v6 row_newbcast:12 row_mask:0xf bank_mask:0xf
v_and_b32_dpp v111, v15, v7 row_newbcast:12 row_mask:0xf bank_mask:0xf
v_mfma_f32_16x16x32_bf16 v[112:115], v[104:107], v[196:199], v[112:115]
s_xor_b32 s64, s65, 38912
s_cmpk_gt_u32 s69, 106
s_waitcnt vmcnt(6)
s_cbranch_scc1 L_d_115
s_waitcnt vmcnt(5)
L_d_115:
buffer_load_dwordx4 v[228:231], v1, s[44:47], s64 offen nt
v_and_b32_dpp v104, v16, v4 row_newbcast:0 row_mask:0xf bank_mask:0xf
v_and_b32_dpp v105, v16, v5 row_newbcast:0 row_mask:0xf bank_mask:0xf
v_and_b32_dpp v106, v16, v6 row_newbcast:0 row_mask:0xf bank_mask:0xf
v_and_b32_dpp v107, v16, v7 row_newbcast:0 row_mask:0xf bank_mask:0xf
v_mfma_f32_16x16x32_bf16 v[112:115], v[108:111], v[200:203], v[112:115]
s_xor_b32 s64, s65, 104448
s_cmpk_gt_u32 s69, 107
s_waitcnt vmcnt(6)
s_cbranch_scc1 L_d_116
s_waitcnt vmcnt(5)
L_d_116:
buffer_load_dwordx4 v[232:235], v1, s[44:47], s64 offen nt
v_and_b32_dpp v108, v16, v4 row_newbcast:4 row_mask:0xf bank_mask:0xf
v_and_b32_dpp v109, v16, v5 row_newbcast:4 row_mask:0xf bank_mask:0xf
v_and_b32_dpp v110, v16, v6 row_newbcast:4 row_mask:0xf bank_mask:0xf
v_and_b32_dpp v111, v16, v7 row_newbcast:4 row_mask:0xf bank_mask:0xf
v_mfma_f32_16x16x32_bf16 v[112:115], v[104:107], v[204:207], v[112:115]
s_xor_b32 s64, s65, 37888
s_cmpk_gt_u32 s69, 108
s_waitcnt vmcnt(6)
s_cbranch_scc1 L_d_117
s_waitcnt vmcnt(5)
L_d_117:
buffer_load_dwordx4 v[236:239], v1, s[44:47], s64 offen nt
v_and_b32_dpp v104, v16, v4 row_newbcast:8 row_mask:0xf bank_mask:0xf
v_and_b32_dpp v105, v16, v5 row_newbcast:8 row_mask:0xf bank_mask:0xf
v_and_b32_dpp v106, v16, v6 row_newbcast:8 row_mask:0xf bank_mask:0xf
v_and_b32_dpp v107, v16, v7 row_newbcast:8 row_mask:0xf bank_mask:0xf
v_mfma_f32_16x16x32_bf16 v[112:115], v[108:111], v[208:211], v[112:115]
s_xor_b32 s64, s65, 103424
s_cmpk_gt_u32 s69, 109
s_waitcnt vmcnt(6)
s_cbranch_scc1 L_d_118
s_waitcnt vmcnt(5)
L_d_118:
buffer_load_dwordx4 v[240:243], v1, s[44:47], s64 offen nt
v_and_b32_dpp v108, v16, v4 row_newbcast:12 row_mask:0xf bank_mask:0xf
v_and_b32_dpp v109, v16, v5 row_newbcast:12 row_mask:0xf bank_mask:0xf
v_and_b32_dpp v110, v16, v6 row_newbcast:12 row_mask:0xf bank_mask:0xf
v_and_b32_dpp v111, v16, v7 row_newbcast:12 row_mask:0xf bank_mask:0xf
v_mfma_f32_16x16x32_bf16 v[112:115], v[104:107], v[212:215], v[112:115]
s_cmp_eq_u32 s34, 0
s_cbranch_scc0 L_w_120
v_mov_b32 v60, 46
s_mov_b64 exec, 1
buffer_store_dword v60, off, s[36:39], s63 offset:0
s_mov_b64 exec, -1
L_w_120:
s_xor_b32 s64, s65, 39936
s_cmpk_gt_u32 s69, 110
s_waitcnt vmcnt(6)
s_cbranch_scc1 L_d_119
s_waitcnt vmcnt(5)
L_d_119:
buffer_load_dwordx4 v[244:247], v1, s[44:47], s64 offen nt
v_and_b32_dpp v104, v18, v4 row_newbcast:0 row_mask:0xf bank_mask:0xf
v_and_b32_dpp v105, v18, v5 row_newbcast:0 row_mask:0xf bank_mask:0xf
v_and_b32_dpp v106, v18, v6 row_newbcast:0 row_mask:0xf bank_mask:0xf
v_and_b32_dpp v107, v18, v7 row_newbcast:0 row_mask:0xf bank_mask:0xf
v_mfma_f32_16x16x32_bf16 v[112:115], v[108:111], v[216:219], v[112:115]
s_xor_b32 s64, s65, 105472
s_cmpk_gt_u32 s69, 111
s_waitcnt vmcnt(6)
s_cbranch_scc1 L_d_121
s_waitcnt vmcnt(5)
L_d_121:
buffer_load_dwordx4 v[248:251], v1, s[44:47], s64 offen nt
v_and_b32_dpp v108, v18, v4 row_newbcast:4 row_mask:0xf bank_mask:0xf
v_and_b32_dpp v109, v18, v5 row_newbcast:4 row_mask:0xf bank_mask:0xf
v_and_b32_dpp v110, v18, v6 row_newbcast:4 row_mask:0xf bank_mask:0xf
v_and_b32_dpp v111, v18, v7 row_newbcast:4 row_mask:0xf bank_mask:0xf
v_mfma_f32_16x16x32_bf16 v[112:115], v[104:107], v[220:223], v[112:115]
s_xor_b32 s64, s65, 135168
s_waitcnt vmcnt(5)
buffer_load_dwordx4 v[252:255], v1, s[44:47], s64 offen nt
v_and_b32_dpp v104, v18, v4 row_newbcast:8 row_mask:0xf bank_mask:0xf
v_and_b32_dpp v105, v18, v5 row_newbcast:8 row_mask:0xf bank_mask:0xf
v_and_b32_dpp v106, v18, v6 row_newbcast:8 row_mask:0xf bank_mask:0xf
v_and_b32_dpp v107, v18, v7 row_newbcast:8 row_mask:0xf bank_mask:0xf
v_mfma_f32_16x16x32_bf16 v[112:115], v[108:111], v[224:227], v[112:115]
v_and_b32_dpp v108, v18, v4 row_newbcast:12 row_mask:0xf bank_mask:0xf
v_and_b32_dpp v109, v18, v5 row_newbcast:12 row_mask:0xf bank_mask:0xf
v_and_b32_dpp v110, v18, v6 row_newbcast:12 row_mask:0xf bank_mask:0xf
v_and_b32_dpp v111, v18, v7 row_newbcast:12 row_mask:0xf bank_mask:0xf
v_mfma_f32_16x16x32_bf16 v[112:115], v[104:107], v[228:231], v[112:115]
s_xor_b32 s64, s65, 200704
s_waitcnt vmcnt(5)
buffer_load_dwordx4 v[88:91], v1, s[44:47], s64 offen nt
v_and_b32_dpp v104, v19, v4 row_newbcast:0 row_mask:0xf bank_mask:0xf
v_and_b32_dpp v105, v19, v5 row_newbcast:0 row_mask:0xf bank_mask:0xf
v_and_b32_dpp v106, v19, v6 row_newbcast:0 row_mask:0xf bank_mask:0xf
v_and_b32_dpp v107, v19, v7 row_newbcast:0 row_mask:0xf bank_mask:0xf
v_mfma_f32_16x16x32_bf16 v[112:115], v[108:111], v[232:235], v[112:115]
s_xor_b32 s64, s65, 137216
s_waitcnt vmcnt(5)
buffer_load_dwordx4 v[92:95], v1, s[44:47], s64 offen nt
v_and_b32_dpp v108, v19, v4 row_newbcast:4 row_mask:0xf bank_mask:0xf
v_and_b32_dpp v109, v19, v5 row_newbcast:4 row_mask:0xf bank_mask:0xf
v_and_b32_dpp v110, v19, v6 row_newbcast:4 row_mask:0xf bank_mask:0xf
v_and_b32_dpp v111, v19, v7 row_newbcast:4 row_mask:0xf bank_mask:0xf
v_mfma_f32_16x16x32_bf16 v[112:115], v[104:107], v[236:239], v[112:115]
s_xor_b32 s64, s65, 202752
s_waitcnt vmcnt(5)
buffer_load_dwordx4 v[132:135], v1, s[44:47], s64 offen nt
v_and_b32_dpp v104, v19, v4 row_newbcast:8 row_mask:0xf bank_mask:0xf
v_and_b32_dpp v105, v19, v5 row_newbcast:8 row_mask:0xf bank_mask:0xf
v_and_b32_dpp v106, v19, v6 row_newbcast:8 row_mask:0xf bank_mask:0xf
v_and_b32_dpp v107, v19, v7 row_newbcast:8 row_mask:0xf bank_mask:0xf
v_mfma_f32_16x16x32_bf16 v[112:115], v[108:111], v[240:243], v[112:115]
s_xor_b32 s64, s65, 136192
s_waitcnt vmcnt(5)
buffer_load_dwordx4 v[136:139], v1, s[44:47], s64 offen nt
v_and_b32_dpp v108, v19, v4 row_newbcast:12 row_mask:0xf bank_mask:0xf
v_and_b32_dpp v109, v19, v5 row_newbcast:12 row_mask:0xf bank_mask:0xf
v_and_b32_dpp v110, v19, v6 row_newbcast:12 row_mask:0xf bank_mask:0xf
v_and_b32_dpp v111, v19, v7 row_newbcast:12 row_mask:0xf bank_mask:0xf
v_mfma_f32_16x16x32_bf16 v[112:115], v[104:107], v[244:247], v[112:115]
s_xor_b32 s64, s65, 201728
s_waitcnt vmcnt(5)
buffer_load_dwordx4 v[140:143], v1, s[44:47], s64 offen nt
v_and_b32_dpp v104, v20, v4 row_newbcast:0 row_mask:0xf bank_mask:0xf
v_and_b32_dpp v105, v20, v5 row_newbcast:0 row_mask:0xf bank_mask:0xf
v_and_b32_dpp v106, v20, v6 row_newbcast:0 row_mask:0xf bank_mask:0xf
v_and_b32_dpp v107, v20, v7 row_newbcast:0 row_mask:0xf bank_mask:0xf
v_mfma_f32_16x16x32_bf16 v[112:115], v[108:111], v[248:251], v[112:115]
s_cmp_eq_u32 s34, 1
s_cbranch_scc0 L_w_122
v_mov_b32 v60, 54
s_mov_b64 exec, 1
buffer_store_dword v60, off, s[36:39], s63 offset:0
s_mov_b64 exec, -1
L_w_122:
s_xor_b32 s64, s65, 138240
s_waitcnt vmcnt(5)
buffer_load_dwordx4 v[144:147], v1, s[44:47], s64 offen nt
v_and_b32_dpp v108, v20, v4 row_newbcast:4 row_mask:0xf bank_mask:0xf
v_and_b32_dpp v109, v20, v5 row_newbcast:4 row_mask:0xf bank_mask:0xf
v_and_b32_dpp v110, v20, v6 row_newbcast:4 row_mask:0xf bank_mask:0xf
v_and_b32_dpp v111, v20, v7 row_newbcast:4 row_mask:0xf bank_mask:0xf
v_mfma_f32_16x16x32_bf16 v[112:115], v[104:107], v[252:255], v[112:115]
s_xor_b32 s64, s65, 203776
s_waitcnt vmcnt(5)
buffer_load_dwordx4 v[148:151], v1, s[44:47], s64 offen nt
v_and_b32_dpp v104, v20, v4 row_newbcast:8 row_mask:0xf bank_mask:0xf
v_and_b32_dpp v105, v20, v5 row_newbcast:8 row_mask:0xf bank_mask:0xf
v_and_b32_dpp v106, v20, v6 row_newbcast:8 row_mask:0xf bank_mask:0xf
v_and_b32_dpp v107, v20, v7 row_newbcast:8 row_mask:0xf bank_mask:0xf
v_mfma_f32_16x16x32_bf16 v[112:115], v[108:111], v[88:91], v[112:115]
s_xor_b32 s64, s65, 167936
s_waitcnt vmcnt(7)
buffer_load_dwordx4 v[152:155], v1, s[44:47], s64 offen nt
s_xor_b32 s64, s65, 233472
s_waitcnt vmcnt(7)
buffer_load_dwordx4 v[156:159], v1, s[44:47], s64 offen nt
s_cmp_lt_u32 s2, 208
s_cbranch_scc0 L_hp_123
v_lshlrev_b32 v160, 2, v0
buffer_load_dword v161, v160, s[36:39], s62 offen offset:0 sc1
L_hp_123:
s_xor_b32 s64, s65, 169984
s_waitcnt vmcnt(7)
buffer_load_dwordx4 v[176:179], v1, s[44:47], s64 offen nt
v_and_b32_dpp v108, v20, v4 row_newbcast:12 row_mask:0xf bank_mask:0xf
v_and_b32_dpp v109, v20, v5 row_newbcast:12 row_mask:0xf bank_mask:0xf
v_and_b32_dpp v110, v20, v6 row_newbcast:12 row_mask:0xf bank_mask:0xf
v_and_b32_dpp v111, v20, v7 row_newbcast:12 row_mask:0xf bank_mask:0xf
v_mfma_f32_16x16x32_bf16 v[112:115], v[104:107], v[92:95], v[112:115]
s_xor_b32 s64, s65, 235520
s_waitcnt vmcnt(7)
buffer_load_dwordx4 v[180:183], v1, s[44:47], s64 offen nt
v_and_b32_dpp v104, v21, v4 row_newbcast:0 row_mask:0xf bank_mask:0xf
v_and_b32_dpp v105, v21, v5 row_newbcast:0 row_mask:0xf bank_mask:0xf
v_and_b32_dpp v106, v21, v6 row_newbcast:0 row_mask:0xf bank_mask:0xf
v_and_b32_dpp v107, v21, v7 row_newbcast:0 row_mask:0xf bank_mask:0xf
v_mfma_f32_16x16x32_bf16 v[112:115], v[108:111], v[132:135], v[112:115]
s_xor_b32 s64, s65, 168960
s_waitcnt vmcnt(7)
buffer_load_dwordx4 v[184:187], v1, s[44:47], s64 offen nt
v_and_b32_dpp v108, v21, v4 row_newbcast:4 row_mask:0xf bank_mask:0xf
v_and_b32_dpp v109, v21, v5 row_newbcast:4 row_mask:0xf bank_mask:0xf
v_and_b32_dpp v110, v21, v6 row_newbcast:4 row_mask:0xf bank_mask:0xf
v_and_b32_dpp v111, v21, v7 row_newbcast:4 row_mask:0xf bank_mask:0xf
v_mfma_f32_16x16x32_bf16 v[112:115], v[104:107], v[136:139], v[112:115]
s_xor_b32 s64, s65, 234496
s_waitcnt vmcnt(7)
buffer_load_dwordx4 v[24:27], v1, s[44:47], s64 offen nt
v_and_b32_dpp v104, v21, v4 row_newbcast:8 row_mask:0xf bank_mask:0xf
v_and_b32_dpp v105, v21, v5 row_newbcast:8 row_mask:0xf bank_mask:0xf
v_and_b32_dpp v106, v21, v6 row_newbcast:8 row_mask:0xf bank_mask:0xf
v_and_b32_dpp v107, v21, v7 row_newbcast:8 row_mask:0xf bank_mask:0xf
v_mfma_f32_16x16x32_bf16 v[112:115], v[108:111], v[140:143], v[112:115]
s_cmp_eq_u32 s34, 2
s_cbranch_scc0 L_w_124
v_mov_b32 v60, 62
s_mov_b64 exec, 1
buffer_store_dword v60, off, s[36:39], s63 offset:0
s_mov_b64 exec, -1
L_w_124:
s_xor_b32 s64, s65, 171008
s_waitcnt vmcnt(7)
buffer_load_dwordx4 v[28:31], v1, s[44:47], s64 offen nt
v_and_b32_dpp v108, v21, v4 row_newbcast:12 row_mask:0xf bank_mask:0xf
v_and_b32_dpp v109, v21, v5 row_newbcast:12 row_mask:0xf bank_mask:0xf
v_and_b32_dpp v110, v21, v6 row_newbcast:12 row_mask:0xf bank_mask:0xf
v_and_b32_dpp v111, v21, v7 row_newbcast:12 row_mask:0xf bank_mask:0xf
v_mfma_f32_16x16x32_bf16 v[112:115], v[104:107], v[144:147], v[112:115]
s_xor_b32 s64, s65, 236544
s_waitcnt vmcnt(7)
buffer_load_dwordx4 v[32:35], v1, s[44:47], s64 offen nt
v_and_b32_dpp v104, v22, v4 row_newbcast:0 row_mask:0xf bank_mask:0xf
v_and_b32_dpp v105, v22, v5 row_newbcast:0 row_mask:0xf bank_mask:0xf
v_and_b32_dpp v106, v22, v6 row_newbcast:0 row_mask:0xf bank_mask:0xf
v_and_b32_dpp v107, v22, v7 row_newbcast:0 row_mask:0xf bank_mask:0xf
v_mfma_f32_16x16x32_bf16 v[112:115], v[108:111], v[148:151], v[112:115]
s_cmp_lt_u32 s2, 208
s_cbranch_scc0 L_nohelp
v_lshrrev_b32 v172, 3, v0
v_sub_u32 v172, 63, v172
v_and_b32 v168, 7, v0
v_lshlrev_b32 v168, 7, v168
v_bfe_u32 v162, v172, 0, 1
v_lshl_or_b32 v168, v162, 16, v168
v_bfe_u32 v162, v172, 1, 1
v_lshl_or_b32 v168, v162, 11, v168
v_bfe_u32 v162, v172, 2, 1
v_lshl_or_b32 v168, v162, 10, v168
v_bfe_u32 v162, v172, 3, 1
v_lshl_or_b32 v168, v162, 15, v168
v_bfe_u32 v162, v172, 4, 1
v_lshl_or_b32 v168, v162, 17, v168
v_bfe_u32 v162, v172, 5, 1
v_lshl_or_b32 v168, v162, 12, v168
v_lshrrev_b32 v173, 3, v0
v_sub_u32 v173, 55, v173
v_and_b32 v169, 7, v0
v_lshlrev_b32 v169, 7, v169
v_bfe_u32 v162, v173, 0, 1
v_lshl_or_b32 v169, v162, 16, v169
v_bfe_u32 v162, v173, 1, 1
v_lshl_or_b32 v169, v162, 11, v169
v_bfe_u32 v162, v173, 2, 1
v_lshl_or_b32 v169, v162, 10, v169
v_bfe_u32 v162, v173, 3, 1
v_lshl_or_b32 v169, v162, 15, v169
v_bfe_u32 v162, v173, 4, 1
v_lshl_or_b32 v169, v162, 17, v169
v_bfe_u32 v162, v173, 5, 1
v_lshl_or_b32 v169, v162, 12, v169
s_lshr_b32 s71, s2, 3
v_subrev_u32 v163, s71, v0
v_and_b32 v163, 31, v163
s_waitcnt vmcnt(6)
v_mov_b32 v162, v161
s_nop 1
v_permlane32_swap_b32 v161, v162
v_add_u32 v161, 1, v161
v_max_u32 v161, 7, v161
v_cmp_eq_u32 vcc, -1, v162
v_mov_b32 v160, 0xff
s_nop 0
v_cndmask_b32 v161, v160, v161, vcc
v_lshl_or_b32 v161, v161, 5, v163
s_nop 1
v_min_u32_dpp v161, v161, v161 quad_perm:[1,0,3,2] row_mask:0xf bank_mask:0xf
s_nop 1
v_min_u32_dpp v161, v161, v161 quad_perm:[2,3,0,1] row_mask:0xf bank_mask:0xf
s_nop 1
v_min_u32_dpp v161, v161, v161 row_ror:4 row_mask:0xf bank_mask:0xf
s_nop 1
v_min_u32_dpp v161, v161, v161 row_ror:8 row_mask:0xf bank_mask:0xf
s_nop 1
v_readlane_b32 s76, v161, 0
v_readlane_b32 s66, v161, 16
s_min_u32 s76, s76, s66
s_lshr_b32 s66, s76, 5
s_cmp_lt_u32 s66, 50
s_cbranch_scc0 L_drain
s_mov_b32 s48, s8
s_mov_b32 s49, s9
s_mov_b32 s50, 0x10000000
s_mov_b32 s51, 0x20000
s_lshr_b32 s64, s2, 3
s_add_u32 s76, s76, s64
s_and_b32 s76, s76, 31
s_lshl_b32 s67, s76, 2
s_add_u32 s67, s67, s62
s_lshl_b32 s76, s76, 3
s_and_b32 s64, s2, 7
s_or_b32 s76, s76, s64
s_and_b32 s64, s34, 1
s_lshl_b32 s64, s64, 14
s_lshr_b32 s71, s34, 1
s_lshl_b32 s71, s71, 13
s_or_b32 s64, s64, s71
s_lshl_b32 s71, s76, 10
s_xor_b32 s64, s64, s71
s_or_b32 s64, s64, 0xC0000
s_lshl_b32 s76, s76, 20
s_xor_b32 s76, s76, s64
s_add_u32 s66, s66, 11
v_xor_b32 v169, s76, v169
v_cmp_lt_u32 vcc, s66, v173
s_or_b64 exec, vcc, 1
buffer_load_dword v171, v169, s[48:51], 0 offen
s_mov_b64 exec, -1
v_xor_b32 v168, s76, v168
v_cmp_lt_u32 vcc, s66, v172
s_or_b64 exec, vcc, 1
buffer_load_dword v170, v168, s[48:51], 0 offen
s_mov_b64 exec, -1
s_mov_b64 exec, 1
buffer_store_dword v1, off, s[36:39], s67 offset:128
s_mov_b64 exec, -1
s_waitcnt vmcnt(10)
v_and_b32_dpp v108, v22, v4 row_newbcast:4 row_mask:0xf bank_mask:0xf
v_and_b32_dpp v109, v22, v5 row_newbcast:4 row_mask:0xf bank_mask:0xf
v_and_b32_dpp v110, v22, v6 row_newbcast:4 row_mask:0xf bank_mask:0xf
v_and_b32_dpp v111, v22, v7 row_newbcast:4 row_mask:0xf bank_mask:0xf
v_mfma_f32_16x16x32_bf16 v[112:115], v[104:107], v[152:155], v[112:115]
s_waitcnt vmcnt(9)
v_and_b32_dpp v104, v22, v4 row_newbcast:8 row_mask:0xf bank_mask:0xf
v_and_b32_dpp v105, v22, v5 row_newbcast:8 row_mask:0xf bank_mask:0xf
v_and_b32_dpp v106, v22, v6 row_newbcast:8 row_mask:0xf bank_mask:0xf
v_and_b32_dpp v107, v22, v7 row_newbcast:8 row_mask:0xf bank_mask:0xf
v_mfma_f32_16x16x32_bf16 v[112:115], v[108:111], v[156:159], v[112:115]
s_waitcnt vmcnt(8)
v_and_b32_dpp v108, v22, v4 row_newbcast:12 row_mask:0xf bank_mask:0xf
v_and_b32_dpp v109, v22, v5 row_newbcast:12 row_mask:0xf bank_mask:0xf
v_and_b32_dpp v110, v22, v6 row_newbcast:12 row_mask:0xf bank_mask:0xf
v_and_b32_dpp v111, v22, v7 row_newbcast:12 row_mask:0xf bank_mask:0xf
v_mfma_f32_16x16x32_bf16 v[112:115], v[104:107], v[176:179], v[112:115]
s_waitcnt vmcnt(7)
v_and_b32_dpp v104, v23, v4 row_newbcast:0 row_mask:0xf bank_mask:0xf
v_and_b32_dpp v105, v23, v5 row_newbcast:0 row_mask:0xf bank_mask:0xf
v_and_b32_dpp v106, v23, v6 row_newbcast:0 row_mask:0xf bank_mask:0xf
v_and_b32_dpp v107, v23, v7 row_newbcast:0 row_mask:0xf bank_mask:0xf
v_mfma_f32_16x16x32_bf16 v[112:115], v[108:111], v[180:183], v[112:115]
s_waitcnt vmcnt(6)
v_and_b32_dpp v108, v23, v4 row_newbcast:4 row_mask:0xf bank_mask:0xf
v_and_b32_dpp v109, v23, v5 row_newbcast:4 row_mask:0xf bank_mask:0xf
v_and_b32_dpp v110, v23, v6 row_newbcast:4 row_mask:0xf bank_mask:0xf
v_and_b32_dpp v111, v23, v7 row_newbcast:4 row_mask:0xf bank_mask:0xf
v_mfma_f32_16x16x32_bf16 v[112:115], v[104:107], v[184:187], v[112:115]
s_waitcnt vmcnt(5)
v_and_b32_dpp v104, v23, v4 row_newbcast:8 row_mask:0xf bank_mask:0xf
v_and_b32_dpp v105, v23, v5 row_newbcast:8 row_mask:0xf bank_mask:0xf
v_and_b32_dpp v106, v23, v6 row_newbcast:8 row_mask:0xf bank_mask:0xf
v_and_b32_dpp v107, v23, v7 row_newbcast:8 row_mask:0xf bank_mask:0xf
v_mfma_f32_16x16x32_bf16 v[112:115], v[108:111], v[24:27], v[112:115]
s_waitcnt vmcnt(4)
v_and_b32_dpp v108, v23, v4 row_newbcast:12 row_mask:0xf bank_mask:0xf
v_and_b32_dpp v109, v23, v5 row_newbcast:12 row_mask:0xf bank_mask:0xf
v_and_b32_dpp v110, v23, v6 row_newbcast:12 row_mask:0xf bank_mask:0xf
v_and_b32_dpp v111, v23, v7 row_newbcast:12 row_mask:0xf bank_mask:0xf
v_mfma_f32_16x16x32_bf16 v[112:115], v[104:107], v[28:31], v[112:115]
s_waitcnt vmcnt(3)
v_mfma_f32_16x16x32_bf16 v[112:115], v[108:111], v[32:35], v[112:115]
s_branch L_drained
L_nohelp:
L_drain:
s_waitcnt vmcnt(7)
v_and_b32_dpp v108, v22, v4 row_newbcast:4 row_mask:0xf bank_mask:0xf
v_and_b32_dpp v109, v22, v5 row_newbcast:4 row_mask:0xf bank_mask:0xf
v_and_b32_dpp v110, v22, v6 row_newbcast:4 row_mask:0xf bank_mask:0xf
v_and_b32_dpp v111, v22, v7 row_newbcast:4 row_mask:0xf bank_mask:0xf
v_mfma_f32_16x16x32_bf16 v[112:115], v[104:107], v[152:155], v[112:115]
s_waitcnt vmcnt(6)
v_and_b32_dpp v104, v22, v4 row_newbcast:8 row_mask:0xf bank_mask:0xf
v_and_b32_dpp v105, v22, v5 row_newbcast:8 row_mask:0xf bank_mask:0xf
v_and_b32_dpp v106, v22, v6 row_newbcast:8 row_mask:0xf bank_mask:0xf
v_and_b32_dpp v107, v22, v7 row_newbcast:8 row_mask:0xf bank_mask:0xf
v_mfma_f32_16x16x32_bf16 v[112:115], v[108:111], v[156:159], v[112:115]
s_waitcnt vmcnt(5)
v_and_b32_dpp v108, v22, v4 row_newbcast:12 row_mask:0xf bank_mask:0xf
v_and_b32_dpp v109, v22, v5 row_newbcast:12 row_mask:0xf bank_mask:0xf
v_and_b32_dpp v110, v22, v6 row_newbcast:12 row_mask:0xf bank_mask:0xf
v_and_b32_dpp v111, v22, v7 row_newbcast:12 row_mask:0xf bank_mask:0xf
v_mfma_f32_16x16x32_bf16 v[112:115], v[104:107], v[176:179], v[112:115]
s_waitcnt vmcnt(4)
v_and_b32_dpp v104, v23, v4 row_newbcast:0 row_mask:0xf bank_mask:0xf
v_and_b32_dpp v105, v23, v5 row_newbcast:0 row_mask:0xf bank_mask:0xf
v_and_b32_dpp v106, v23, v6 row_newbcast:0 row_mask:0xf bank_mask:0xf
v_and_b32_dpp v107, v23, v7 row_newbcast:0 row_mask:0xf bank_mask:0xf
v_mfma_f32_16x16x32_bf16 v[112:115], v[108:111], v[180:183], v[112:115]
s_waitcnt vmcnt(3)
v_and_b32_dpp v108, v23, v4 row_newbcast:4 row_mask:0xf bank_mask:0xf
v_and_b32_dpp v109, v23, v5 row_newbcast:4 row_mask:0xf bank_mask:0xf
v_and_b32_dpp v110, v23, v6 row_newbcast:4 row_mask:0xf bank_mask:0xf
v_and_b32_dpp v111, v23, v7 row_newbcast:4 row_mask:0xf bank_mask:0xf
v_mfma_f32_16x16x32_bf16 v[112:115], v[104:107], v[184:187], v[112:115]
s_waitcnt vmcnt(2)
v_and_b32_dpp v104, v23, v4 row_newbcast:8 row_mask:0xf bank_mask:0xf
v_and_b32_dpp v105, v23, v5 row_newbcast:8 row_mask:0xf bank_mask:0xf
v_and_b32_dpp v106, v23, v6 row_newbcast:8 row_mask:0xf bank_mask:0xf
v_and_b32_dpp v107, v23, v7 row_newbcast:8 row_mask:0xf bank_mask:0xf
v_mfma_f32_16x16x32_bf16 v[112:115], v[108:111], v[24:27], v[112:115]
s_waitcnt vmcnt(1)
v_and_b32_dpp v108, v23, v4 row_newbcast:12 row_mask:0xf bank_mask:0xf
v_and_b32_dpp v109, v23, v5 row_newbcast:12 row_mask:0xf bank_mask:0xf
v_and_b32_dpp v110, v23, v6 row_newbcast:12 row_mask:0xf bank_mask:0xf
v_and_b32_dpp v111, v23, v7 row_newbcast:12 row_mask:0xf bank_mask:0xf
v_mfma_f32_16x16x32_bf16 v[112:115], v[104:107], v[28:31], v[112:115]
s_waitcnt vmcnt(0)
v_mfma_f32_16x16x32_bf16 v[112:115], v[108:111], v[32:35], v[112:115]
L_drained:
v_and_b32 v2, 15, v0
v_lshlrev_b32 v2, 5, v2
v_and_b32 v3, 16, v0
v_add_u32 v2, v2, v3
s_lshl_b32 s68, s34, 9
v_add_u32 v2, s68, v2
s_mov_b32 exec_hi, 0
s_nop 1
ds_write_b128 v2, v[112:115] offset:512
s_mov_b32 exec_hi, -1
v_lshlrev_b32 v1, 4, v0
s_waitcnt lgkmcnt(0)
s_barrier
v_mov_b32 v2, 0
ds_read_b32 v3, v2 offset:328
s_waitcnt lgkmcnt(0)
v_readfirstlane_b32 s35, v3
s_branch L_tail_s
L_fin:
L_end:
s_endpgm
L_code_end:
.section .rodata,"a"
.p2align 6
.amdhsa_kernel adaLN_cond__sliding_block_cached__glu_gated_glu__decode_kernel
  .amdhsa_next_free_vgpr 256
  .amdhsa_next_free_sgpr 102
  .amdhsa_accum_offset 256
  .amdhsa_group_segment_fixed_size 0
  .amdhsa_kernarg_size 112
  .amdhsa_user_sgpr_count 2
  .amdhsa_user_sgpr_kernarg_segment_ptr 1
  .amdhsa_system_sgpr_workgroup_id_x 1
  .amdhsa_float_denorm_mode_32 3
.end_amdhsa_kernel
```

```asm
; @launch grid=(256,1,1) block=(512,1,1) lds=131072
.amdgcn_target "amdgcn-amd-amdhsa--gfx950"
.text
.globl adaLN_cond__sliding_block_cached__glu_gated_glu__decode_kernel
.p2align 8
.type adaLN_cond__sliding_block_cached__glu_gated_glu__decode_kernel,@function
adaLN_cond__sliding_block_cached__glu_gated_glu__decode_kernel:
L_code_begin:
s_load_dwordx16 s[4:19], s[0:1], 0
s_load_dwordx8 s[20:27], s[0:1], 64
s_load_dwordx4 s[28:31], s[0:1], 96
s_cmpk_ge_u32 s2, 256
s_cbranch_scc1 L_end
v_lshrrev_b32 v1, 6, v0
v_and_b32 v0, 63, v0
v_readfirstlane_b32 s3, v1
v_lshlrev_b32 v1, 4, v0
s_lshl_b32 s64, s2, 20
s_add_u32 s64, s64, 0xC0000
s_mov_b32 s42, 0x40000
s_mov_b32 s43, 0x20000
s_and_b32 s34, s3, 3
s_cmp_ge_u32 s3, 4
s_cbranch_scc1 L_helper
s_and_b32 s65, s34, 1
s_lshl_b32 s65, s65, 14
s_lshr_b32 s66, s34, 1
s_lshl_b32 s66, s66, 13
s_or_b32 s65, s65, s66
s_lshl_b32 s66, s2, 10
s_xor_b32 s65, s65, s66
s_waitcnt lgkmcnt(0)
s_add_u32 s40, s6, s64
s_addc_u32 s41, s7, 0
s_add_u32 s44, s8, s64
s_addc_u32 s45, s9, 0
buffer_load_dwordx4 v[8:11], v1, s[40:43], s65 offen nt
s_xor_b32 s64, s65, 65536
buffer_load_dwordx4 v[12:15], v1, s[40:43], s64 offen nt
s_xor_b32 s64, s65, 2048
buffer_load_dwordx4 v[16:19], v1, s[40:43], s64 offen nt
s_xor_b32 s64, s65, 67584
buffer_load_dwordx4 v[20:23], v1, s[40:43], s64 offen nt
s_barrier
s_branch L_srest
L_helper:
s_setprio 2
v_lshlrev_b32 v2, 2, v0
s_cmp_eq_u32 s3, 7
s_cbranch_scc0 L_nopf
s_getpc_b64 s[60:61]
L_pc:
s_lshr_b32 s66, s2, 3
s_lshl_b32 s66, s66, 10
v_add_u32 v10, s66, v1
v_min_u32 v10, L_code_end-L_pc-16, v10
global_load_dwordx4 v[12:15], v10, s[60:61]
v_subrev_u32 v3, 16, v0
v_ashrrev_i32 v3, 31, v3
ds_write_b32 v2, v3 offset:256
L_nopf:
s_and_b32 s67, s2, 7
s_lshr_b32 s68, s2, 3
v_and_b32 v38, 7, v0
v_lshrrev_b32 v37, 3, v0
s_cmp_eq_u32 s34, 0
s_cbranch_scc0 L_p0a
s_mov_b32 s70, 6
s_lshl_b32 s67, s67, 1
s_add_u32 s66, s67, 14
v_min_u32 v38, 5, v38
v_cmp_lt_u32 vcc, 1, v38
v_add_u32 v36, s66, v38
s_nop 0
v_cndmask_b32 v38, v38, v36, vcc
s_branch L_p0b
L_p0a:
s_lshl_b32 s67, s67, 3
s_lshl_b32 s65, s2, 3
s_and_b32 s65, s65, 0xff
s_lshr_b32 s66, s2, 5
s_or_b32 s65, s65, s66
s_cmp_eq_u32 s34, 2
s_cselect_b32 s70, 1, 8
s_cselect_b32 s68, s65, s68
s_cselect_b32 s67, 0, s67
L_p0b:
v_lshl_add_u32 v37, s68, 4, v37
v_mul_u32_u24 v37, s70, v37
v_lshl_add_u32 v38, v37, 3, v38
v_add_lshl_u32 v38, v38, s67, 7
s_lshl_b32 s70, s70, 13
v_add_u32 v39, s70, v38
s_sub_u32 s64, s2, 112
s_cmp_lt_u32 s64, 32
s_waitcnt lgkmcnt(0)
s_barrier
s_cbranch_scc1 L_jan
s_cmp_eq_u32 s34, 3
s_cbranch_scc1 L_p0_125
s_cmp_eq_u32 s34, 0
s_cselect_b32 s62, s24, s10
s_cselect_b32 s63, s25, s11
s_cmp_eq_u32 s34, 2
s_cselect_b32 s62, s12, s62
s_cselect_b32 s63, s13, s63
global_load_dword v12, v38, s[62:63]
global_load_dword v13, v39, s[62:63]
L_p0_125:
L_nop0:
s_cmp_eq_u32 s34, 3
s_cselect_b32 s64, 16, 0
s_cmp_lt_u32 s2, s64
s_cbranch_scc0 L_nopc
v_mov_b32 v4, -1
v_mov_b32 v5, -1
v_mov_b32 v6, -1
v_mov_b32 v7, -1
s_and_b32 s66, s2, 7
s_lshl_b32 s66, s66, 11
s_and_b32 s65, s2, 8
s_lshl_b32 s65, s65, 7
s_add_u32 s66, s66, s65
v_add_u32 v8, s66, v1
global_store_dwordx4 v8, v[4:7], s[30:31] sc1
s_lshl_b32 s66, s2, 2
v_mov_b32 v3, s66
s_waitcnt vmcnt(0)
s_mov_b64 exec, 1
global_store_dword v3, v4, s[28:29] sc1
s_mov_b64 exec, -1
L_nopc:
s_cmp_eq_u32 s34, 3
s_cbranch_scc0 L_w_126
s_and_b32 s67, s2, 7
s_lshr_b32 s68, s2, 3
s_min_u32 s64, s67, 3
s_mul_i32 s65, s67, 5
s_add_u32 s64, s64, s65
s_cmp_lt_u32 s67, 3
s_cselect_b32 s65, 6, 5
L_w_126:
s_lshr_b32 s32, s2, 5
s_and_b32 s33, s2, 31
s_and_b32 s67, s2, 7
s_lshr_b32 s68, s2, 3
s_sub_u32 s68, s68, 26
s_min_u32 s74, s67, 3
s_mul_i32 s66, s67, 5
s_add_u32 s74, s74, s66
s_add_u32 s74, s74, s68
s_cmp_lt_u32 s67, 3
s_cselect_b32 s66, 6, 5
s_cmp_lt_u32 s68, s66
s_cselect_b32 s74, s74, -1
s_cmp_lt_u32 s2, 48
s_cselect_b32 s66, 2, 3
s_cselect_b32 s72, 14+26, 42+26
s_cmp_lt_u32 s2, 16
s_cselect_b32 s66, 1, s66
s_cselect_b32 s72, 26, s72
s_lshl_b32 s66, s67, s66
s_add_u32 s72, s72, s66
s_add_u32 s72, s72, s68
s_mov_b32 s36, s30
s_mov_b32 s37, s31
s_mov_b32 s38, 0x1d0000
s_mov_b32 s39, 0x20000
s_mov_b32 s52, s28
s_mov_b32 s53, s29
s_mov_b32 s54, 0x100
s_mov_b32 s55, 0x20000
v_mov_b32 v9, 1
s_cmp_lt_u32 s2, 112
s_cbranch_scc0 L_norole
L_gemm:
v_and_b32 v16, 7, v0
v_lshlrev_b32 v16, 10, v16
v_and_b32 v17, 8, v0
v_lshl_add_u32 v16, v17, 3, v16
v_and_b32 v17, 48, v0
v_add_u32 v16, v16, v17
s_lshl_b32 s67, s34, 8
v_lshrrev_b32 v19, 3, v0
v_and_b32 v17, 2, v19
v_and_b32 v18, 7, v0
v_xor_b32 v17, v17, v18
v_xor_b32 v18, 4, v17
v_lshlrev_b32 v17, 4, v17
v_lshlrev_b32 v18, 4, v18
s_cmp_lt_u32 s2, 48
s_cbranch_scc0 L_gq0
s_mov_b32 s40, s24
s_mov_b32 s41, s25
s_mov_b32 s42, 0x300000
s_mov_b32 s43, 0x20000
s_mov_b32 s48, s22
s_mov_b32 s49, s23
s_mov_b32 s50, 0x2000
s_mov_b32 s51, 0x20000
s_mov_b32 s70, 6144
s_lshl_b32 s64, s72, 7
s_branch L_g1
L_gq0:
s_mov_b32 s40, s10
s_mov_b32 s41, s11
s_mov_b32 s42, 0x400000
s_mov_b32 s43, 0x20000
s_mov_b32 s48, s4
s_mov_b32 s49, s5
s_mov_b32 s50, 0x2000
s_mov_b32 s51, 0x20000
s_mov_b32 s70, 8192
s_sub_u32 s64, s72, 48
s_lshl_b32 s64, s64, 7
L_g1:
buffer_load_dwordx4 v[192:195], v16, s[48:51], s67 offen offset:0
buffer_load_dwordx4 v[196:199], v16, s[48:51], s67 offen offset:128
v_mul_lo_u32 v19, s70, v19
v_add_u32 v17, v17, v19
v_add_u32 v18, v18, v19
s_lshl_b32 s66, s70, 7
s_mul_i32 s66, s66, s34
s_add_u32 s64, s64, s66
s_lshl_b32 s70, s70, 3
s_lshl_b32 s65, s34, 13
s_add_u32 s65, s65, 4096
s_cmp_lt_u32 s2, 16
s_cselect_b32 s71, 0, 2
s_cmp_ge_u32 s2, 48
s_cselect_b32 s71, 1, s71
s_add_u32 m0, s65, 0
s_nop 0
buffer_load_dwordx4 v17, s[40:43], s64 offen  lds
s_add_u32 s64, s64, s70
s_add_u32 m0, s65, 1024
s_nop 0
buffer_load_dwordx4 v18, s[40:43], s64 offen  lds
s_add_u32 s64, s64, s70
s_cmp_eq_u32 s71, 2
s_cbranch_scc0 L_pace_127
s_waitcnt vmcnt(1)
L_pace_127:
s_add_u32 m0, s65, 2048
s_nop 0
buffer_load_dwordx4 v17, s[40:43], s64 offen  lds
s_add_u32 s64, s64, s70
s_cmp_eq_u32 s71, 0
s_cbranch_scc1 L_pace_128
s_waitcnt vmcnt(2)
s_cmp_eq_u32 s71, 2
s_cbranch_scc0 L_pace_128
s_waitcnt vmcnt(1)
L_pace_128:
s_add_u32 m0, s65, 3072
s_nop 0
buffer_load_dwordx4 v18, s[40:43], s64 offen  lds
s_add_u32 s64, s64, s70
s_cmp_eq_u32 s71, 0
s_cbranch_scc1 L_pace_129
s_waitcnt vmcnt(2)
s_cmp_eq_u32 s71, 2
s_cbranch_scc0 L_pace_129
s_waitcnt vmcnt(1)
L_pace_129:
s_add_u32 m0, s65, 4096
s_nop 0
buffer_load_dwordx4 v17, s[40:43], s64 offen  lds
s_add_u32 s64, s64, s70
s_cmp_eq_u32 s71, 0
s_cbranch_scc1 L_pace_130
s_waitcnt vmcnt(2)
s_cmp_eq_u32 s71, 2
s_cbranch_scc0 L_pace_130
s_waitcnt vmcnt(1)
L_pace_130:
s_add_u32 m0, s65, 5120
s_nop 0
buffer_load_dwordx4 v18, s[40:43], s64 offen  lds
s_add_u32 s64, s64, s70
s_cmp_eq_u32 s71, 0
s_cbranch_scc1 L_pace_131
s_waitcnt vmcnt(2)
s_cmp_eq_u32 s71, 2
s_cbranch_scc0 L_pace_131
s_waitcnt vmcnt(1)
L_pace_131:
s_add_u32 m0, s65, 6144
s_nop 0
buffer_load_dwordx4 v17, s[40:43], s64 offen  lds
s_add_u32 s64, s64, s70
s_cmp_eq_u32 s71, 0
s_cbranch_scc1 L_pace_132
s_waitcnt vmcnt(2)
s_cmp_eq_u32 s71, 2
s_cbranch_scc0 L_pace_132
s_waitcnt vmcnt(1)
L_pace_132:
s_add_u32 m0, s65, 7168
s_nop 0
buffer_load_dwordx4 v18, s[40:43], s64 offen  lds
s_add_u32 s64, s64, s70
s_cmp_eq_u32 s71, 0
s_cbranch_scc1 L_pace_133
s_waitcnt vmcnt(2)
s_cmp_eq_u32 s71, 2
s_cbranch_scc0 L_pace_133
s_waitcnt vmcnt(1)
L_pace_133:
s_add_u32 m0, s65, 32768
s_nop 0
buffer_load_dwordx4 v17, s[40:43], s64 offen  lds
s_add_u32 s64, s64, s70
s_cmp_eq_u32 s71, 0
s_cbranch_scc1 L_pace_134
s_waitcnt vmcnt(2)
s_cmp_eq_u32 s71, 2
s_cbranch_scc0 L_pace_134
s_waitcnt vmcnt(1)
L_pace_134:
s_add_u32 m0, s65, 33792
s_nop 0
buffer_load_dwordx4 v18, s[40:43], s64 offen  lds
s_add_u32 s64, s64, s70
s_cmp_eq_u32 s71, 0
s_cbranch_scc1 L_pace_135
s_waitcnt vmcnt(2)
s_cmp_eq_u32 s71, 2
s_cbranch_scc0 L_pace_135
s_waitcnt vmcnt(1)
L_pace_135:
s_add_u32 m0, s65, 34816
s_nop 0
buffer_load_dwordx4 v17, s[40:43], s64 offen  lds
s_add_u32 s64, s64, s70
s_cmp_eq_u32 s71, 0
s_cbranch_scc1 L_pace_136
s_waitcnt vmcnt(2)
s_cmp_eq_u32 s71, 2
s_cbranch_scc0 L_pace_136
s_waitcnt vmcnt(1)
L_pace_136:
s_add_u32 m0, s65, 35840
s_nop 0
buffer_load_dwordx4 v18, s[40:43], s64 offen  lds
s_add_u32 s64, s64, s70
s_cmp_eq_u32 s71, 0
s_cbranch_scc1 L_pace_137
s_waitcnt vmcnt(2)
s_cmp_eq_u32 s71, 2
s_cbranch_scc0 L_pace_137
s_waitcnt vmcnt(1)
L_pace_137:
s_add_u32 m0, s65, 36864
s_nop 0
buffer_load_dwordx4 v17, s[40:43], s64 offen  lds
s_add_u32 s64, s64, s70
s_cmp_eq_u32 s71, 0
s_cbranch_scc1 L_pace_138
s_waitcnt vmcnt(2)
s_cmp_eq_u32 s71, 2
s_cbranch_scc0 L_pace_138
s_waitcnt vmcnt(1)
L_pace_138:
s_add_u32 m0, s65, 37888
s_nop 0
buffer_load_dwordx4 v18, s[40:43], s64 offen  lds
s_add_u32 s64, s64, s70
s_cmp_eq_u32 s71, 0
s_cbranch_scc1 L_pace_139
s_waitcnt vmcnt(2)
s_cmp_eq_u32 s71, 2
s_cbranch_scc0 L_pace_139
s_waitcnt vmcnt(1)
L_pace_139:
s_add_u32 m0, s65, 38912
s_nop 0
buffer_load_dwordx4 v17, s[40:43], s64 offen  lds
s_add_u32 s64, s64, s70
s_cmp_eq_u32 s71, 0
s_cbranch_scc1 L_pace_140
s_waitcnt vmcnt(2)
s_cmp_eq_u32 s71, 2
s_cbranch_scc0 L_pace_140
s_waitcnt vmcnt(1)
L_pace_140:
s_add_u32 m0, s65, 39936
s_nop 0
buffer_load_dwordx4 v18, s[40:43], s64 offen  lds
s_add_u32 s64, s64, s70
s_waitcnt vmcnt(16)
s_cmp_eq_u32 s34, 0
s_cselect_b32 s73, 48, 0x1000
v_and_b32 v30, 15, v0
v_lshlrev_b32 v30, 2, v30
s_cmp_ge_u32 s2, s73
s_cbranch_scc0 L_fl_141
buffer_load_dword v31, v30, s[52:55], 0 offen sc1
L_fl_141:
s_mov_b32 s68, 0xffff0000
s_cmp_lt_u32 s2, 48
s_cbranch_scc0 L_gq1
s_mov_b32 s66, 0xbfb8aa3b
v_lshlrev_b32 v20, 16, v192
v_and_b32 v21, s68, v192
v_mul_f32 v22, s66, v20
v_mul_f32 v23, s66, v21
v_exp_f32 v22, v22
v_exp_f32 v23, v23
s_nop 0
v_add_f32 v22, 1.0, v22
v_add_f32 v23, 1.0, v23
v_rcp_f32 v22, v22
v_rcp_f32 v23, v23
s_nop 0
v_mul_f32 v20, v20, v22
v_mul_f32 v21, v21, v23
v_cvt_pk_bf16_f32 v48, v20, v21
v_lshlrev_b32 v20, 16, v193
v_and_b32 v21, s68, v193
v_mul_f32 v22, s66, v20
v_mul_f32 v23, s66, v21
v_exp_f32 v22, v22
v_exp_f32 v23, v23
s_nop 0
v_add_f32 v22, 1.0, v22
v_add_f32 v23, 1.0, v23
v_rcp_f32 v22, v22
v_rcp_f32 v23, v23
s_nop 0
v_mul_f32 v20, v20, v22
v_mul_f32 v21, v21, v23
v_cvt_pk_bf16_f32 v49, v20, v21
v_lshlrev_b32 v20, 16, v194
v_and_b32 v21, s68, v194
v_mul_f32 v22, s66, v20
v_mul_f32 v23, s66, v21
v_exp_f32 v22, v22
v_exp_f32 v23, v23
s_nop 0
v_add_f32 v22, 1.0, v22
v_add_f32 v23, 1.0, v23
v_rcp_f32 v22, v22
v_rcp_f32 v23, v23
s_nop 0
v_mul_f32 v20, v20, v22
v_mul_f32 v21, v21, v23
v_cvt_pk_bf16_f32 v50, v20, v21
v_lshlrev_b32 v20, 16, v195
v_and_b32 v21, s68, v195
v_mul_f32 v22, s66, v20
v_mul_f32 v23, s66, v21
v_exp_f32 v22, v22
v_exp_f32 v23, v23
s_nop 0
v_add_f32 v22, 1.0, v22
v_add_f32 v23, 1.0, v23
v_rcp_f32 v22, v22
v_rcp_f32 v23, v23
s_nop 0
v_mul_f32 v20, v20, v22
v_mul_f32 v21, v21, v23
v_cvt_pk_bf16_f32 v51, v20, v21
v_lshlrev_b32 v20, 16, v196
v_and_b32 v21, s68, v196
v_mul_f32 v22, s66, v20
v_mul_f32 v23, s66, v21
v_exp_f32 v22, v22
v_exp_f32 v23, v23
s_nop 0
v_add_f32 v22, 1.0, v22
v_add_f32 v23, 1.0, v23
v_rcp_f32 v22, v22
v_rcp_f32 v23, v23
s_nop 0
v_mul_f32 v20, v20, v22
v_mul_f32 v21, v21, v23
v_cvt_pk_bf16_f32 v52, v20, v21
v_lshlrev_b32 v20, 16, v197
v_and_b32 v21, s68, v197
v_mul_f32 v22, s66, v20
v_mul_f32 v23, s66, v21
v_exp_f32 v22, v22
v_exp_f32 v23, v23
s_nop 0
v_add_f32 v22, 1.0, v22
v_add_f32 v23, 1.0, v23
v_rcp_f32 v22, v22
v_rcp_f32 v23, v23
s_nop 0
v_mul_f32 v20, v20, v22
v_mul_f32 v21, v21, v23
v_cvt_pk_bf16_f32 v53, v20, v21
v_lshlrev_b32 v20, 16, v198
v_and_b32 v21, s68, v198
v_mul_f32 v22, s66, v20
v_mul_f32 v23, s66, v21
v_exp_f32 v22, v22
v_exp_f32 v23, v23
s_nop 0
v_add_f32 v22, 1.0, v22
v_add_f32 v23, 1.0, v23
v_rcp_f32 v22, v22
v_rcp_f32 v23, v23
s_nop 0
v_mul_f32 v20, v20, v22
v_mul_f32 v21, v21, v23
v_cvt_pk_bf16_f32 v54, v20, v21
v_lshlrev_b32 v20, 16, v199
v_and_b32 v21, s68, v199
v_mul_f32 v22, s66, v20
v_mul_f32 v23, s66, v21
v_exp_f32 v22, v22
v_exp_f32 v23, v23
s_nop 0
v_add_f32 v22, 1.0, v22
v_add_f32 v23, 1.0, v23
v_rcp_f32 v22, v22
v_rcp_f32 v23, v23
s_nop 0
v_mul_f32 v20, v20, v22
v_mul_f32 v21, v21, v23
v_cvt_pk_bf16_f32 v55, v20, v21
s_branch L_g2
L_gq1:
v_and_b32 v32, 7, v0
v_lshlrev_b32 v32, 2, v32
v_lshlrev_b32 v96, 16, v192
v_and_b32 v97, s68, v192
v_lshlrev_b32 v98, 16, v193
v_and_b32 v99, s68, v193
v_lshlrev_b32 v100, 16, v194
v_and_b32 v101, s68, v194
v_lshlrev_b32 v102, 16, v195
v_and_b32 v103, s68, v195
v_lshlrev_b32 v104, 16, v196
v_and_b32 v105, s68, v196
v_lshlrev_b32 v106, 16, v197
v_and_b32 v107, s68, v197
v_lshlrev_b32 v108, 16, v198
v_and_b32 v109, s68, v198
v_lshlrev_b32 v110, 16, v199
v_and_b32 v111, s68, v199
v_add_f32 v20, v96, v97
v_add_f32 v20, v20, v98
v_add_f32 v20, v20, v99
v_add_f32 v20, v20, v100
v_add_f32 v20, v20, v101
v_add_f32 v20, v20, v102
v_add_f32 v20, v20, v103
v_add_f32 v20, v20, v104
v_add_f32 v20, v20, v105
v_add_f32 v20, v20, v106
v_add_f32 v20, v20, v107
v_add_f32 v20, v20, v108
v_add_f32 v20, v20, v109
v_add_f32 v20, v20, v110
v_add_f32 v20, v20, v111
s_nop 1
v_add_f32_dpp v20, v20, v20 row_ror:8 row_mask:0xf bank_mask:0xf
v_mov_b32 v22, v20
s_nop 1
v_permlane16_swap_b32 v20, v22
s_nop 1
v_add_f32 v20, v20, v22
v_mov_b32 v22, v20
s_nop 1
v_permlane32_swap_b32 v20, v22
s_nop 1
v_add_f32 v20, v20, v22
v_mul_f32 v20, 0x3c000000, v20
v_mov_b32 v21, 0
v_sub_f32 v22, v96, v20
v_fmac_f32 v21, v22, v22
v_sub_f32 v22, v97, v20
v_fmac_f32 v21, v22, v22
v_sub_f32 v22, v98, v20
v_fmac_f32 v21, v22, v22
v_sub_f32 v22, v99, v20
v_fmac_f32 v21, v22, v22
v_sub_f32 v22, v100, v20
v_fmac_f32 v21, v22, v22
v_sub_f32 v22, v101, v20
v_fmac_f32 v21, v22, v22
v_sub_f32 v22, v102, v20
v_fmac_f32 v21, v22, v22
v_sub_f32 v22, v103, v20
v_fmac_f32 v21, v22, v22
v_sub_f32 v22, v104, v20
v_fmac_f32 v21, v22, v22
v_sub_f32 v22, v105, v20
v_fmac_f32 v21, v22, v22
v_sub_f32 v22, v106, v20
v_fmac_f32 v21, v22, v22
v_sub_f32 v22, v107, v20
v_fmac_f32 v21, v22, v22
v_sub_f32 v22, v108, v20
v_fmac_f32 v21, v22, v22
v_sub_f32 v22, v109, v20
v_fmac_f32 v21, v22, v22
v_sub_f32 v22, v110, v20
v_fmac_f32 v21, v22, v22
v_sub_f32 v22, v111, v20
v_fmac_f32 v21, v22, v22
s_nop 1
v_add_f32_dpp v21, v21, v21 row_ror:8 row_mask:0xf bank_mask:0xf
v_mov_b32 v22, v21
s_nop 1
v_permlane16_swap_b32 v21, v22
s_nop 1
v_add_f32 v21, v21, v22
v_mov_b32 v22, v21
s_nop 1
v_permlane32_swap_b32 v21, v22
s_nop 1
v_add_f32 v21, v21, v22
v_lshlrev_b32 v22, 1, v32
s_lshl_b32 s66, s34, 6
v_add_u32 v23, s66, v22
ds_write_b64 v23, v[20:21] offset:0
v_mov_b32 v23, 0
s_waitcnt lgkmcnt(0)
s_mov_b64 exec, 1
ds_add_u32 v23, v9 offset:332
s_mov_b64 exec, -1
s_mov_b32 s75, 0
L_poll_142:
ds_read_b32 v24, v23 offset:332
s_waitcnt lgkmcnt(0)
v_cmp_gt_u32 vcc, 4, v24
s_cbranch_vccz L_pollx_143
s_add_u32 s75, s75, 1
s_cmp_lt_u32 s75, 0x1000000
s_cbranch_scc1 L_poll_142
L_pollx_143:
ds_read_b64 v[112:113], v22 offset:0
ds_read_b64 v[114:115], v22 offset:64
ds_read_b64 v[116:117], v22 offset:128
ds_read_b64 v[118:119], v22 offset:192
s_waitcnt lgkmcnt(0)
v_add_f32 v20, v112, v114
v_add_f32 v21, v116, v118
v_add_f32 v20, v20, v21
v_mul_f32 v20, 0x3e800000, v20
v_add_f32 v24, v113, v115
v_add_f32 v21, v117, v119
v_add_f32 v24, v24, v21
v_mov_b32 v21, 0
v_sub_f32 v22, v112, v20
v_fmac_f32 v21, v22, v22
v_sub_f32 v22, v114, v20
v_fmac_f32 v21, v22, v22
v_sub_f32 v22, v116, v20
v_fmac_f32 v21, v22, v22
v_sub_f32 v22, v118, v20
v_fmac_f32 v21, v22, v22
v_fmac_f32 v24, 0x43000000, v21
v_mul_f32 v24, 0x3b000000, v24
v_cvt_pk_bf16_f32 v24, 0, v24
v_cvt_pk_bf16_f32 v20, 0, v20
v_add_f32 v24, 0x3727c5ac, v24
v_cvt_pk_bf16_f32 v24, 0, v24
v_sqrt_f32 v24, v24
s_nop 0
v_cvt_pk_bf16_f32 v24, 0, v24
v_rcp_f32 v24, v24
s_nop 0
v_sub_f32 v96, v96, v20
v_cvt_pk_bf16_f32 v96, 0, v96
v_mul_f32 v96, v96, v24
v_cvt_pk_bf16_f32 v96, 0, v96
v_sub_f32 v97, v97, v20
v_cvt_pk_bf16_f32 v97, 0, v97
v_mul_f32 v97, v97, v24
v_cvt_pk_bf16_f32 v97, 0, v97
v_sub_f32 v98, v98, v20
v_cvt_pk_bf16_f32 v98, 0, v98
v_mul_f32 v98, v98, v24
v_cvt_pk_bf16_f32 v98, 0, v98
v_sub_f32 v99, v99, v20
v_cvt_pk_bf16_f32 v99, 0, v99
v_mul_f32 v99, v99, v24
v_cvt_pk_bf16_f32 v99, 0, v99
v_sub_f32 v100, v100, v20
v_cvt_pk_bf16_f32 v100, 0, v100
v_mul_f32 v100, v100, v24
v_cvt_pk_bf16_f32 v100, 0, v100
v_sub_f32 v101, v101, v20
v_cvt_pk_bf16_f32 v101, 0, v101
v_mul_f32 v101, v101, v24
v_cvt_pk_bf16_f32 v101, 0, v101
v_sub_f32 v102, v102, v20
v_cvt_pk_bf16_f32 v102, 0, v102
v_mul_f32 v102, v102, v24
v_cvt_pk_bf16_f32 v102, 0, v102
v_sub_f32 v103, v103, v20
v_cvt_pk_bf16_f32 v103, 0, v103
v_mul_f32 v103, v103, v24
v_cvt_pk_bf16_f32 v103, 0, v103
v_sub_f32 v104, v104, v20
v_cvt_pk_bf16_f32 v104, 0, v104
v_mul_f32 v104, v104, v24
v_cvt_pk_bf16_f32 v104, 0, v104
v_sub_f32 v105, v105, v20
v_cvt_pk_bf16_f32 v105, 0, v105
v_mul_f32 v105, v105, v24
v_cvt_pk_bf16_f32 v105, 0, v105
v_sub_f32 v106, v106, v20
v_cvt_pk_bf16_f32 v106, 0, v106
v_mul_f32 v106, v106, v24
v_cvt_pk_bf16_f32 v106, 0, v106
v_sub_f32 v107, v107, v20
v_cvt_pk_bf16_f32 v107, 0, v107
v_mul_f32 v107, v107, v24
v_cvt_pk_bf16_f32 v107, 0, v107
v_sub_f32 v108, v108, v20
v_cvt_pk_bf16_f32 v108, 0, v108
v_mul_f32 v108, v108, v24
v_cvt_pk_bf16_f32 v108, 0, v108
v_sub_f32 v109, v109, v20
v_cvt_pk_bf16_f32 v109, 0, v109
v_mul_f32 v109, v109, v24
v_cvt_pk_bf16_f32 v109, 0, v109
v_sub_f32 v110, v110, v20
v_cvt_pk_bf16_f32 v110, 0, v110
v_mul_f32 v110, v110, v24
v_cvt_pk_bf16_f32 v110, 0, v110
v_sub_f32 v111, v111, v20
v_cvt_pk_bf16_f32 v111, 0, v111
v_mul_f32 v111, v111, v24
v_cvt_pk_bf16_f32 v111, 0, v111
L_g2:
s_cmp_ge_u32 s2, s73
s_cbranch_scc0 L_fl_144
s_waitcnt vmcnt(0)
v_cmp_eq_u32 vcc, 0, v31
s_cbranch_vccz L_fl_144
s_mov_b32 s75, 0
L_poll_145:
buffer_load_dword v31, v30, s[52:55], 0 offen sc1
s_waitcnt vmcnt(0)
v_cmp_eq_u32 vcc, 0, v31
s_cbranch_vccz L_pollx_146
s_sleep 40
s_add_u32 s75, s75, 1
s_cmp_lt_u32 s75, 0x100000
s_cbranch_scc1 L_poll_145
L_pollx_146:
L_fl_144:
v_mov_b32 v20, 0
s_cmp_eq_u32 s34, 0
s_cbranch_scc0 L_w_147
ds_write_b32 v20, v9 offset:324
L_w_147:
v_lshrrev_b32 v18, 4, v0
v_bfe_u32 v19, v0, 2, 2
v_lshrrev_b32 v20, 1, v19
v_and_b32 v21, 1, v18
v_lshl_add_u32 v20, v21, 1, v20
v_lshlrev_b32 v20, 5, v20
v_lshl_add_u32 v20, v18, 10, v20
v_lshl_add_u32 v20, v19, 7, v20
v_and_b32 v21, 3, v0
v_lshl_add_u32 v20, v21, 3, v20
v_add_u32 v40, s65, v20
v_xor_b32 v41, 32, v40
v_xor_b32 v42, 64, v40
v_xor_b32 v43, 96, v40
s_waitcnt vmcnt(12) lgkmcnt(0)
ds_read_b64_tr_b16 v[128:129], v40 offset:0
ds_read_b64_tr_b16 v[130:131], v40 offset:512
ds_read_b64_tr_b16 v[132:133], v41 offset:0
ds_read_b64_tr_b16 v[134:135], v41 offset:512
ds_read_b64_tr_b16 v[136:137], v42 offset:0
ds_read_b64_tr_b16 v[138:139], v42 offset:512
ds_read_b64_tr_b16 v[140:141], v43 offset:0
ds_read_b64_tr_b16 v[142:143], v43 offset:512
s_waitcnt vmcnt(8) lgkmcnt(0)
ds_read_b64_tr_b16 v[144:145], v40 offset:4096
ds_read_b64_tr_b16 v[146:147], v40 offset:4608
ds_read_b64_tr_b16 v[148:149], v41 offset:4096
ds_read_b64_tr_b16 v[150:151], v41 offset:4608
ds_read_b64_tr_b16 v[152:153], v42 offset:4096
ds_read_b64_tr_b16 v[154:155], v42 offset:4608
ds_read_b64_tr_b16 v[156:157], v43 offset:4096
ds_read_b64_tr_b16 v[158:159], v43 offset:4608
s_waitcnt vmcnt(4) lgkmcnt(0)
ds_read_b64_tr_b16 v[160:161], v40 offset:32768
ds_read_b64_tr_b16 v[162:163], v40 offset:33280
ds_read_b64_tr_b16 v[164:165], v41 offset:32768
ds_read_b64_tr_b16 v[166:167], v41 offset:33280
ds_read_b64_tr_b16 v[168:169], v42 offset:32768
ds_read_b64_tr_b16 v[170:171], v42 offset:33280
ds_read_b64_tr_b16 v[172:173], v43 offset:32768
ds_read_b64_tr_b16 v[174:175], v43 offset:33280
s_waitcnt vmcnt(0) lgkmcnt(0)
ds_read_b64_tr_b16 v[176:177], v40 offset:36864
ds_read_b64_tr_b16 v[178:179], v40 offset:37376
ds_read_b64_tr_b16 v[180:181], v41 offset:36864
ds_read_b64_tr_b16 v[182:183], v41 offset:37376
ds_read_b64_tr_b16 v[184:185], v42 offset:36864
ds_read_b64_tr_b16 v[186:187], v42 offset:37376
ds_read_b64_tr_b16 v[188:189], v43 offset:36864
ds_read_b64_tr_b16 v[190:191], v43 offset:37376
s_waitcnt lgkmcnt(0)
s_cmp_eq_u32 s34, 2
s_cselect_b32 s73, 16, 0x1000
v_and_b32 v30, 31, v0
v_lshlrev_b32 v30, 2, v30
s_cmp_ge_u32 s2, s73
s_cbranch_scc0 L_fl_148
buffer_load_dword v31, v30, s[52:55], 0 offen offset:128 sc1
L_fl_148:
s_cmp_lt_u32 s2, 48
s_cbranch_scc1 L_g3
v_mov_b32 v20, 0
s_mov_b32 s75, 0
L_poll_149:
ds_read_b32 v22, v20 offset:324
s_waitcnt lgkmcnt(0)
v_cmp_eq_u32 vcc, 0, v22
s_cbranch_vccz L_pollx_150
s_sleep 1
s_add_u32 s75, s75, 1
s_cmp_lt_u32 s75, 0x1000000
s_cbranch_scc1 L_poll_149
L_pollx_150:
s_lshl_b32 s64, s34, 11
s_add_u32 s64, s64, 0
s_add_u32 s66, s64, 8192
s_mov_b32 s75, 0
L_poll_151:
buffer_load_dwordx4 v[192:195], v1, s[36:39], s64 offen offset:0 sc1
buffer_load_dwordx4 v[200:203], v1, s[36:39], s66 offen offset:0 sc1
buffer_load_dwordx4 v[196:199], v1, s[36:39], s64 offen offset:1024 sc1
buffer_load_dwordx4 v[204:207], v1, s[36:39], s66 offen offset:1024 sc1
s_waitcnt vmcnt(0)
v_max3_u32 v22, v192, v193, v194
v_max3_u32 v22, v22, v195, v196
v_max3_u32 v22, v22, v197, v198
v_max3_u32 v22, v22, v199, v200
v_max3_u32 v22, v22, v201, v202
v_max3_u32 v22, v22, v203, v204
v_max3_u32 v22, v22, v205, v206
v_max_u32 v22, v22, v207
v_cmp_eq_u32 vcc, -1, v22
s_cbranch_vccz L_pollx_152
s_sleep 16
s_add_u32 s75, s75, 1
s_cmp_lt_u32 s75, 0x100000
s_cbranch_scc1 L_poll_151
L_pollx_152:
v_lshlrev_b32 v20, 16, v200
v_and_b32 v21, s68, v200
v_add_f32 v20, 1.0, v20
v_add_f32 v21, 1.0, v21
v_cvt_pk_bf16_f32 v20, 0, v20
v_cvt_pk_bf16_f32 v21, 0, v21
v_mul_f32 v20, v20, v96
v_mul_f32 v21, v21, v97
v_cvt_pk_bf16_f32 v20, 0, v20
v_cvt_pk_bf16_f32 v21, 0, v21
v_lshlrev_b32 v22, 16, v192
v_and_b32 v23, s68, v192
v_add_f32 v20, v20, v22
v_add_f32 v21, v21, v23
v_cvt_pk_bf16_f32 v48, v20, v21
v_lshlrev_b32 v20, 16, v201
v_and_b32 v21, s68, v201
v_add_f32 v20, 1.0, v20
v_add_f32 v21, 1.0, v21
v_cvt_pk_bf16_f32 v20, 0, v20
v_cvt_pk_bf16_f32 v21, 0, v21
v_mul_f32 v20, v20, v98
v_mul_f32 v21, v21, v99
v_cvt_pk_bf16_f32 v20, 0, v20
v_cvt_pk_bf16_f32 v21, 0, v21
v_lshlrev_b32 v22, 16, v193
v_and_b32 v23, s68, v193
v_add_f32 v20, v20, v22
v_add_f32 v21, v21, v23
v_cvt_pk_bf16_f32 v49, v20, v21
v_lshlrev_b32 v20, 16, v202
v_and_b32 v21, s68, v202
v_add_f32 v20, 1.0, v20
v_add_f32 v21, 1.0, v21
v_cvt_pk_bf16_f32 v20, 0, v20
v_cvt_pk_bf16_f32 v21, 0, v21
v_mul_f32 v20, v20, v100
v_mul_f32 v21, v21, v101
v_cvt_pk_bf16_f32 v20, 0, v20
v_cvt_pk_bf16_f32 v21, 0, v21
v_lshlrev_b32 v22, 16, v194
v_and_b32 v23, s68, v194
v_add_f32 v20, v20, v22
v_add_f32 v21, v21, v23
v_cvt_pk_bf16_f32 v50, v20, v21
v_lshlrev_b32 v20, 16, v203
v_and_b32 v21, s68, v203
v_add_f32 v20, 1.0, v20
v_add_f32 v21, 1.0, v21
v_cvt_pk_bf16_f32 v20, 0, v20
v_cvt_pk_bf16_f32 v21, 0, v21
v_mul_f32 v20, v20, v102
v_mul_f32 v21, v21, v103
v_cvt_pk_bf16_f32 v20, 0, v20
v_cvt_pk_bf16_f32 v21, 0, v21
v_lshlrev_b32 v22, 16, v195
v_and_b32 v23, s68, v195
v_add_f32 v20, v20, v22
v_add_f32 v21, v21, v23
v_cvt_pk_bf16_f32 v51, v20, v21
v_lshlrev_b32 v20, 16, v204
v_and_b32 v21, s68, v204
v_add_f32 v20, 1.0, v20
v_add_f32 v21, 1.0, v21
v_cvt_pk_bf16_f32 v20, 0, v20
v_cvt_pk_bf16_f32 v21, 0, v21
v_mul_f32 v20, v20, v104
v_mul_f32 v21, v21, v105
v_cvt_pk_bf16_f32 v20, 0, v20
v_cvt_pk_bf16_f32 v21, 0, v21
v_lshlrev_b32 v22, 16, v196
v_and_b32 v23, s68, v196
v_add_f32 v20, v20, v22
v_add_f32 v21, v21, v23
v_cvt_pk_bf16_f32 v52, v20, v21
v_lshlrev_b32 v20, 16, v205
v_and_b32 v21, s68, v205
v_add_f32 v20, 1.0, v20
v_add_f32 v21, 1.0, v21
v_cvt_pk_bf16_f32 v20, 0, v20
v_cvt_pk_bf16_f32 v21, 0, v21
v_mul_f32 v20, v20, v106
v_mul_f32 v21, v21, v107
v_cvt_pk_bf16_f32 v20, 0, v20
v_cvt_pk_bf16_f32 v21, 0, v21
v_lshlrev_b32 v22, 16, v197
v_and_b32 v23, s68, v197
v_add_f32 v20, v20, v22
v_add_f32 v21, v21, v23
v_cvt_pk_bf16_f32 v53, v20, v21
v_lshlrev_b32 v20, 16, v206
v_and_b32 v21, s68, v206
v_add_f32 v20, 1.0, v20
v_add_f32 v21, 1.0, v21
v_cvt_pk_bf16_f32 v20, 0, v20
v_cvt_pk_bf16_f32 v21, 0, v21
v_mul_f32 v20, v20, v108
v_mul_f32 v21, v21, v109
v_cvt_pk_bf16_f32 v20, 0, v20
v_cvt_pk_bf16_f32 v21, 0, v21
v_lshlrev_b32 v22, 16, v198
v_and_b32 v23, s68, v198
v_add_f32 v20, v20, v22
v_add_f32 v21, v21, v23
v_cvt_pk_bf16_f32 v54, v20, v21
v_lshlrev_b32 v20, 16, v207
v_and_b32 v21, s68, v207
v_add_f32 v20, 1.0, v20
v_add_f32 v21, 1.0, v21
v_cvt_pk_bf16_f32 v20, 0, v20
v_cvt_pk_bf16_f32 v21, 0, v21
v_mul_f32 v20, v20, v110
v_mul_f32 v21, v21, v111
v_cvt_pk_bf16_f32 v20, 0, v20
v_cvt_pk_bf16_f32 v21, 0, v21
v_lshlrev_b32 v22, 16, v199
v_and_b32 v23, s68, v199
v_add_f32 v20, v20, v22
v_add_f32 v21, v21, v23
v_cvt_pk_bf16_f32 v55, v20, v21
L_g3:
s_cmp_ge_u32 s2, s73
s_cbranch_scc0 L_fl_153
s_waitcnt vmcnt(0)
v_cmp_eq_u32 vcc, 0, v31
s_cbranch_vccz L_fl_153
s_mov_b32 s75, 0
L_poll_154:
buffer_load_dword v31, v30, s[52:55], 0 offen offset:128 sc1
s_waitcnt vmcnt(0)
v_cmp_eq_u32 vcc, 0, v31
s_cbranch_vccz L_pollx_155
s_sleep 40
s_add_u32 s75, s75, 1
s_cmp_lt_u32 s75, 0x100000
s_cbranch_scc1 L_poll_154
L_pollx_155:
L_fl_153:
s_nop 1
v_mfma_f32_16x16x32_bf16 v[64:67], v[128:131], v[48:51], 0
v_mfma_f32_16x16x32_bf16 v[68:71], v[132:135], v[48:51], 0
v_mfma_f32_16x16x32_bf16 v[72:75], v[136:139], v[48:51], 0
v_mfma_f32_16x16x32_bf16 v[76:79], v[140:143], v[48:51], 0
v_mfma_f32_16x16x32_bf16 v[80:83], v[144:147], v[48:51], 0
v_mfma_f32_16x16x32_bf16 v[84:87], v[148:151], v[48:51], 0
v_mfma_f32_16x16x32_bf16 v[88:91], v[152:155], v[48:51], 0
v_mfma_f32_16x16x32_bf16 v[92:95], v[156:159], v[48:51], 0
v_mfma_f32_16x16x32_bf16 v[64:67], v[160:163], v[52:55], v[64:67]
v_mfma_f32_16x16x32_bf16 v[68:71], v[164:167], v[52:55], v[68:71]
v_mfma_f32_16x16x32_bf16 v[72:75], v[168:171], v[52:55], v[72:75]
v_mfma_f32_16x16x32_bf16 v[76:79], v[172:175], v[52:55], v[76:79]
v_mfma_f32_16x16x32_bf16 v[80:83], v[176:179], v[52:55], v[80:83]
v_mfma_f32_16x16x32_bf16 v[84:87], v[180:183], v[52:55], v[84:87]
v_mfma_f32_16x16x32_bf16 v[88:91], v[184:187], v[52:55], v[88:91]
v_mfma_f32_16x16x32_bf16 v[92:95], v[188:191], v[52:55], v[92:95]
v_and_b32 v20, 7, v0
v_mul_u32_u24 v20, 272, v20
v_and_b32 v21, 8, v0
v_lshl_add_u32 v20, v21, 3, v20
v_and_b32 v21, 48, v0
v_add_u32 v20, v20, v21
s_mul_i32 s64, s34, 8192
s_add_u32 s64, s64, 4096
v_add_u32 v20, s64, v20
s_nop 7
v_add_f32_dpp v24, v80, v64 row_ror:8 row_mask:0xf bank_mask:0x3
v_add_f32_dpp v24, v68, v84 row_ror:8 row_mask:0xf bank_mask:0xc
v_add_f32_dpp v25, v81, v65 row_ror:8 row_mask:0xf bank_mask:0x3
v_add_f32_dpp v25, v69, v85 row_ror:8 row_mask:0xf bank_mask:0xc
v_add_f32_dpp v26, v82, v66 row_ror:8 row_mask:0xf bank_mask:0x3
v_add_f32_dpp v26, v70, v86 row_ror:8 row_mask:0xf bank_mask:0xc
v_add_f32_dpp v27, v83, v67 row_ror:8 row_mask:0xf bank_mask:0x3
v_add_f32_dpp v27, v71, v87 row_ror:8 row_mask:0xf bank_mask:0xc
ds_write_b128 v20, v[24:27] offset:0
v_add_f32_dpp v28, v88, v72 row_ror:8 row_mask:0xf bank_mask:0x3
v_add_f32_dpp v28, v76, v92 row_ror:8 row_mask:0xf bank_mask:0xc
v_add_f32_dpp v29, v89, v73 row_ror:8 row_mask:0xf bank_mask:0x3
v_add_f32_dpp v29, v77, v93 row_ror:8 row_mask:0xf bank_mask:0xc
v_add_f32_dpp v30, v90, v74 row_ror:8 row_mask:0xf bank_mask:0x3
v_add_f32_dpp v30, v78, v94 row_ror:8 row_mask:0xf bank_mask:0xc
v_add_f32_dpp v31, v91, v75 row_ror:8 row_mask:0xf bank_mask:0x3
v_add_f32_dpp v31, v79, v95 row_ror:8 row_mask:0xf bank_mask:0xc
ds_write_b128 v20, v[28:31] offset:128
v_mov_b32 v20, 0
s_waitcnt lgkmcnt(0)
s_mov_b64 exec, 1
ds_add_u32 v20, v9 offset:320
s_mov_b64 exec, -1
s_cmp_eq_u32 s34, 0
s_cbranch_scc0 L_waitq
s_cmp_lt_u32 s2, 16
s_cbranch_scc0 L_gq2
v_and_b32 v21, 7, v0
v_lshrrev_b32 v22, 4, v0
v_and_b32 v23, 8, v0
v_lshrrev_b32 v23, 1, v23
v_add_u32 v22, v22, v23
v_mov_b32 v23, v1
s_lshl_b32 s64, s72, 10
s_add_u32 s64, s64, 0
s_branch L_g4
L_gq2:
v_lshrrev_b32 v21, 3, v0
v_and_b32 v22, 7, v0
s_mov_b32 s64, 10240
s_cmp_lt_u32 s2, 48
s_cselect_b32 s64, 22528, s64
s_mov_b32 s65, 12288
v_mul_lo_u32 v23, s65, v21
v_lshl_add_u32 v23, v22, 4, v23
s_lshl_b32 s66, s72, 7
s_add_u32 s64, s64, s66
L_g4:
v_mul_u32_u24 v21, 272, v21
v_lshl_add_u32 v21, v22, 5, v21
v_add_u32 v21, 4096, v21
s_mov_b32 s75, 0
L_poll_156:
ds_read_b32 v22, v20 offset:320
s_waitcnt lgkmcnt(0)
v_cmp_gt_u32 vcc, 4, v22
s_cbranch_vccz L_pollx_157
s_add_u32 s75, s75, 1
s_cmp_lt_u32 s75, 0x1000000
s_cbranch_scc1 L_poll_156
L_pollx_157:
ds_read_b128 v[64:67], v21 offset:0
ds_read_b128 v[68:71], v21 offset:16
ds_read_b128 v[72:75], v21 offset:8192
ds_read_b128 v[76:79], v21 offset:8208
ds_read_b128 v[80:83], v21 offset:16384
ds_read_b128 v[84:87], v21 offset:16400
ds_read_b128 v[88:91], v21 offset:24576
ds_read_b128 v[92:95], v21 offset:24592
s_waitcnt lgkmcnt(0)
v_add_f32 v64, v64, v72
v_add_f32 v65, v65, v73
v_add_f32 v66, v66, v74
v_add_f32 v67, v67, v75
v_add_f32 v68, v68, v76
v_add_f32 v69, v69, v77
v_add_f32 v70, v70, v78
v_add_f32 v71, v71, v79
v_add_f32 v64, v64, v80
v_add_f32 v65, v65, v81
v_add_f32 v66, v66, v82
v_add_f32 v67, v67, v83
v_add_f32 v68, v68, v84
v_add_f32 v69, v69, v85
v_add_f32 v70, v70, v86
v_add_f32 v71, v71, v87
v_add_f32 v64, v64, v88
v_add_f32 v65, v65, v89
v_add_f32 v66, v66, v90
v_add_f32 v67, v67, v91
v_add_f32 v68, v68, v92
v_add_f32 v69, v69, v93
v_add_f32 v70, v70, v94
v_add_f32 v71, v71, v95
v_cvt_pk_bf16_f32 v24, v64, v65
v_cvt_pk_bf16_f32 v25, v66, v67
v_cvt_pk_bf16_f32 v26, v68, v69
v_cvt_pk_bf16_f32 v27, v70, v71
v_min_u32 v24, -2, v24
v_min_u32 v25, -2, v25
v_min_u32 v26, -2, v26
v_min_u32 v27, -2, v27
buffer_store_dwordx4 v[24:27], v23, s[36:39], s64 offen sc1
s_branch L_waitq
L_jan:
v_mov_b32 v4, -1
v_mov_b32 v5, -1
v_mov_b32 v6, -1
v_mov_b32 v7, -1
s_lshl_b32 s67, s64, 2
s_add_u32 s67, s67, s34
s_cmp_lt_u32 s67, 32
s_cselect_b32 s66, 0, 933888
s_mul_i32 s65, s67, 3072
s_add_u32 s65, s65, s66
s_add_u32 s65, s65, 16384
v_add_u32 v8, s65, v1
global_store_dwordx4 v8, v[4:7], s[30:31] offset:0 sc1
global_store_dwordx4 v8, v[4:7], s[30:31] offset:1024 sc1
global_store_dwordx4 v8, v[4:7], s[30:31] offset:2048 sc1
s_and_b32 s66, s67, 64
s_add_u32 s67, s67, s66
s_lshl_b32 s67, s67, 7
s_add_u32 s67, s67, 1343488
v_and_b32 v8, 8, v0
v_lshlrev_b32 v8, 10, v8
v_and_b32 v10, 0x70, v1
v_add3_u32 v8, v8, v10, s67
s_mov_b64 exec, 0xffff
global_store_dwordx4 v8, v[4:7], s[30:31] sc1
s_mov_b64 exec, 1
s_load_dword s68, s[30:31], 0x48000
s_and_b32 s65, s34, 1
s_lshl_b32 s66, s65, 13
s_xor_b32 s67, s67, s66
s_xor_b32 s66, s67, 0x2000
s_waitcnt vmcnt(0) lgkmcnt(0)
s_mov_b64 exec, -1
s_cmp_eq_u32 s34, 3
s_cbranch_scc1 L_p0_158
s_cmp_eq_u32 s34, 0
s_cselect_b32 s62, s24, s10
s_cselect_b32 s63, s25, s11
s_cmp_eq_u32 s34, 2
s_cselect_b32 s62, s12, s62
s_cselect_b32 s63, s13, s63
global_load_dword v12, v38, s[62:63]
global_load_dword v13, v39, s[62:63]
L_p0_158:
s_mov_b64 exec, 1
s_mov_b32 s70, 0
s_load_dword s68, s[30:31], s67
L_race_159:
s_getreg_b32 s69, hwreg(HW_REG_IB_STS, 8, 4)
s_add_u32 s70, s70, 1
s_cmp_eq_u32 s69, 0
s_cbranch_scc0 L_race_159
s_waitcnt lgkmcnt(0)
s_mov_b32 s71, 0
s_load_dword s68, s[30:31], s66
L_race_160:
s_getreg_b32 s69, hwreg(HW_REG_IB_STS, 8, 4)
s_add_u32 s71, s71, 1
s_cmp_eq_u32 s69, 0
s_cbranch_scc0 L_race_160
s_waitcnt lgkmcnt(0)
s_cmp_lt_u32 s71, s70
s_cselect_b32 s70, 1, 0
s_xor_b32 s70, s70, s65
s_getreg_b32 s69, hwreg(HW_REG_XCC_ID, 2, 1)
s_xor_b32 s70, s70, s69
s_lshl_b32 s69, s69, 14
s_lshl_b32 s70, s70, 8
s_add_u32 s70, s70, s69
s_add_u32 s70, s70, 1
v_mov_b32 v9, s70
s_lshl_b32 s65, s64, 2
v_mov_b32 v8, s65
ds_add_rtn_u32 v11, v2, v9 offset:320
s_waitcnt lgkmcnt(0)
v_add_u32 v11, v11, v9
v_and_b32 v10, 0xff, v11
v_cmp_eq_u32 vcc, 4, v10
s_cbranch_vccz L_j_161
global_store_dword v8, v11, s[28:29] offset:128 sc1
L_j_161:
s_mov_b64 exec, -1
s_branch L_nop0
L_norole:
s_cmp_eq_u32 s74, -1
s_cbranch_scc1 L_waitq
L_waitq:
s_cmp_eq_u32 s74, -1
s_cselect_b64 vcc, 0, -1
s_cmp_lt_u32 s2, 112
s_cselect_b64 vcc, -1, vcc
s_mov_b32 s44, s12
s_mov_b32 s45, s13
s_mov_b32 s46, 0x400000
s_mov_b32 s47, 0x20000
v_lshrrev_b32 v18, 4, v0
v_and_b32 v16, 15, v0
v_xor_b32 v16, v16, v18
v_xor_b32 v17, 4, v16
v_lshlrev_b32 v19, 10, v18
v_lshl_add_u32 v22, v16, 4, v19
v_lshl_add_u32 v23, v17, 4, v19
v_and_b32 v19, 1, v18
v_lshlrev_b32 v19, 10, v19
v_lshrrev_b32 v18, 1, v18
v_lshl_add_u32 v18, v18, 11, v19
v_lshl_add_u32 v16, v16, 4, v18
v_lshl_add_u32 v17, v17, 4, v18
v_lshrrev_b32 v18, 4, v0
v_bfe_u32 v19, v0, 2, 2
v_and_b32 v20, 2, v0
v_lshlrev_b32 v20, 2, v20
v_xor_b32 v20, v20, v19
v_and_b32 v21, 1, v18
v_lshlrev_b32 v21, 2, v21
v_xor_b32 v20, v20, v21
v_lshlrev_b32 v20, 4, v20
v_lshl_add_u32 v20, v18, 10, v20
v_lshl_add_u32 v20, v19, 8, v20
v_and_b32 v21, 1, v0
v_lshl_add_u32 v20, v21, 3, v20
s_lshl_b32 s65, s34, 13
s_add_u32 s65, s65, 8192
v_add_u32 v40, s65, v20
v_xor_b32 v41, 16, v40
v_xor_b32 v42, 32, v40
v_xor_b32 v43, 48, v40
v_xor_b32 v44, 64, v40
v_xor_b32 v45, 80, v40
v_xor_b32 v46, 96, v40
v_xor_b32 v47, 112, v40
s_lshl_b32 s64, s33, 17
s_lshl_b32 s66, s34, 8
s_add_u32 s64, s64, s66
s_mov_b32 s68, 0
s_lshl_b32 s66, s68, 10
s_add_u32 s64, s64, s66
s_add_u32 m0, s65, 0
s_xor_b32 s66, s64, 0
buffer_load_dwordx4 v16, s[44:47], s66 offen  lds
s_add_u32 m0, s65, 1024
s_xor_b32 s66, s64, 8192
buffer_load_dwordx4 v17, s[44:47], s66 offen  lds
s_add_u32 m0, s65, 2048
s_xor_b32 s66, s64, 16384
buffer_load_dwordx4 v16, s[44:47], s66 offen  lds
s_waitcnt vmcnt(2)
s_add_u32 m0, s65, 3072
s_xor_b32 s66, s64, 24576
buffer_load_dwordx4 v17, s[44:47], s66 offen  lds
s_waitcnt vmcnt(2)
s_add_u32 m0, s65, 32768
s_xor_b32 s66, s64, 4096
buffer_load_dwordx4 v16, s[44:47], s66 offen  lds
s_waitcnt vmcnt(2)
s_add_u32 m0, s65, 33792
s_xor_b32 s66, s64, 12288
buffer_load_dwordx4 v17, s[44:47], s66 offen  lds
s_waitcnt vmcnt(2)
ds_read_b64_tr_b16 v[128:129], v40 offset:0
ds_read_b64_tr_b16 v[136:137], v41 offset:0
ds_read_b64_tr_b16 v[144:145], v42 offset:0
ds_read_b64_tr_b16 v[152:153], v43 offset:0
ds_read_b64_tr_b16 v[160:161], v44 offset:0
ds_read_b64_tr_b16 v[168:169], v45 offset:0
ds_read_b64_tr_b16 v[176:177], v46 offset:0
ds_read_b64_tr_b16 v[184:185], v47 offset:0
s_add_u32 m0, s65, 34816
s_xor_b32 s66, s64, 20480
buffer_load_dwordx4 v16, s[44:47], s66 offen  lds
s_waitcnt vmcnt(2)
s_add_u32 m0, s65, 35840
s_xor_b32 s66, s64, 28672
buffer_load_dwordx4 v17, s[44:47], s66 offen  lds
s_waitcnt vmcnt(2)
s_waitcnt lgkmcnt(0)
s_add_u32 m0, s65, 0
s_xor_b32 s66, s64, 32768
buffer_load_dwordx4 v16, s[44:47], s66 offen  lds
s_waitcnt vmcnt(2)
s_add_u32 m0, s65, 1024
s_xor_b32 s66, s64, 40960
buffer_load_dwordx4 v17, s[44:47], s66 offen  lds
s_waitcnt vmcnt(2)
ds_read_b64_tr_b16 v[130:131], v40 offset:32768
ds_read_b64_tr_b16 v[138:139], v41 offset:32768
ds_read_b64_tr_b16 v[146:147], v42 offset:32768
ds_read_b64_tr_b16 v[154:155], v43 offset:32768
ds_read_b64_tr_b16 v[162:163], v44 offset:32768
ds_read_b64_tr_b16 v[170:171], v45 offset:32768
ds_read_b64_tr_b16 v[178:179], v46 offset:32768
ds_read_b64_tr_b16 v[186:187], v47 offset:32768
s_add_u32 m0, s65, 2048
s_xor_b32 s66, s64, 49152
buffer_load_dwordx4 v16, s[44:47], s66 offen  lds
s_waitcnt vmcnt(2)
s_add_u32 m0, s65, 3072
s_xor_b32 s66, s64, 57344
buffer_load_dwordx4 v17, s[44:47], s66 offen  lds
s_waitcnt vmcnt(2)
s_waitcnt lgkmcnt(0)
s_add_u32 m0, s65, 32768
s_xor_b32 s66, s64, 36864
buffer_load_dwordx4 v16, s[44:47], s66 offen  lds
s_waitcnt vmcnt(2)
s_add_u32 m0, s65, 33792
s_xor_b32 s66, s64, 45056
buffer_load_dwordx4 v17, s[44:47], s66 offen  lds
s_waitcnt vmcnt(2)
ds_read_b64_tr_b16 v[132:133], v40 offset:0
ds_read_b64_tr_b16 v[140:141], v41 offset:0
ds_read_b64_tr_b16 v[148:149], v42 offset:0
ds_read_b64_tr_b16 v[156:157], v43 offset:0
ds_read_b64_tr_b16 v[164:165], v44 offset:0
ds_read_b64_tr_b16 v[172:173], v45 offset:0
ds_read_b64_tr_b16 v[180:181], v46 offset:0
ds_read_b64_tr_b16 v[188:189], v47 offset:0
s_add_u32 m0, s65, 34816
s_xor_b32 s66, s64, 53248
buffer_load_dwordx4 v16, s[44:47], s66 offen  lds
s_waitcnt vmcnt(2)
s_add_u32 m0, s65, 35840
s_xor_b32 s66, s64, 61440
buffer_load_dwordx4 v17, s[44:47], s66 offen  lds
s_waitcnt vmcnt(2)
s_waitcnt lgkmcnt(0)
s_add_u32 m0, s65, 0
s_xor_b32 s66, s64, 65536
buffer_load_dwordx4 v16, s[44:47], s66 offen  lds
s_waitcnt vmcnt(2)
s_add_u32 m0, s65, 1024
s_xor_b32 s66, s64, 73728
buffer_load_dwordx4 v17, s[44:47], s66 offen  lds
s_waitcnt vmcnt(2)
ds_read_b64_tr_b16 v[134:135], v40 offset:32768
ds_read_b64_tr_b16 v[142:143], v41 offset:32768
ds_read_b64_tr_b16 v[150:151], v42 offset:32768
ds_read_b64_tr_b16 v[158:159], v43 offset:32768
ds_read_b64_tr_b16 v[166:167], v44 offset:32768
ds_read_b64_tr_b16 v[174:175], v45 offset:32768
ds_read_b64_tr_b16 v[182:183], v46 offset:32768
ds_read_b64_tr_b16 v[190:191], v47 offset:32768
s_add_u32 m0, s65, 2048
s_xor_b32 s66, s64, 81920
buffer_load_dwordx4 v16, s[44:47], s66 offen  lds
s_waitcnt vmcnt(2)
s_add_u32 m0, s65, 3072
s_xor_b32 s66, s64, 90112
buffer_load_dwordx4 v17, s[44:47], s66 offen  lds
s_waitcnt vmcnt(2)
s_waitcnt lgkmcnt(0)
s_add_u32 m0, s65, 32768
s_xor_b32 s66, s64, 69632
buffer_load_dwordx4 v16, s[44:47], s66 offen  lds
s_waitcnt vmcnt(2)
s_add_u32 m0, s65, 33792
s_xor_b32 s66, s64, 77824
buffer_load_dwordx4 v17, s[44:47], s66 offen  lds
s_waitcnt vmcnt(2)
ds_read_b64_tr_b16 v[192:193], v40 offset:0
ds_read_b64_tr_b16 v[200:201], v41 offset:0
ds_read_b64_tr_b16 v[208:209], v42 offset:0
ds_read_b64_tr_b16 v[216:217], v43 offset:0
ds_read_b64_tr_b16 v[224:225], v44 offset:0
ds_read_b64_tr_b16 v[232:233], v45 offset:0
ds_read_b64_tr_b16 v[240:241], v46 offset:0
ds_read_b64_tr_b16 v[248:249], v47 offset:0
s_add_u32 m0, s65, 34816
s_xor_b32 s66, s64, 86016
buffer_load_dwordx4 v16, s[44:47], s66 offen  lds
s_waitcnt vmcnt(2)
s_add_u32 m0, s65, 35840
s_xor_b32 s66, s64, 94208
buffer_load_dwordx4 v17, s[44:47], s66 offen  lds
s_waitcnt vmcnt(2)
s_waitcnt lgkmcnt(0)
s_add_u32 m0, s65, 0
s_xor_b32 s66, s64, 98304
buffer_load_dwordx4 v16, s[44:47], s66 offen  lds
s_waitcnt vmcnt(2)
s_add_u32 m0, s65, 1024
s_xor_b32 s66, s64, 106496
buffer_load_dwordx4 v17, s[44:47], s66 offen  lds
s_waitcnt vmcnt(2)
ds_read_b64_tr_b16 v[194:195], v40 offset:32768
ds_read_b64_tr_b16 v[202:203], v41 offset:32768
ds_read_b64_tr_b16 v[210:211], v42 offset:32768
ds_read_b64_tr_b16 v[218:219], v43 offset:32768
ds_read_b64_tr_b16 v[226:227], v44 offset:32768
ds_read_b64_tr_b16 v[234:235], v45 offset:32768
ds_read_b64_tr_b16 v[242:243], v46 offset:32768
ds_read_b64_tr_b16 v[250:251], v47 offset:32768
v_and_b32 v24, 127, v2
buffer_load_dword v25, v24, s[52:55], 0 offen offset:128
s_add_u32 m0, s65, 2048
s_xor_b32 s66, s64, 114688
buffer_load_dwordx4 v16, s[44:47], s66 offen  lds
s_waitcnt vmcnt(2)
s_add_u32 m0, s65, 3072
s_xor_b32 s66, s64, 122880
buffer_load_dwordx4 v17, s[44:47], s66 offen  lds
s_waitcnt vmcnt(2)
s_waitcnt lgkmcnt(0)
s_add_u32 m0, s65, 32768
s_xor_b32 s66, s64, 102400
buffer_load_dwordx4 v16, s[44:47], s66 offen  lds
s_waitcnt vmcnt(2)
s_add_u32 m0, s65, 33792
s_xor_b32 s66, s64, 110592
buffer_load_dwordx4 v17, s[44:47], s66 offen  lds
s_waitcnt vmcnt(2)
ds_read_b64_tr_b16 v[196:197], v40 offset:0
ds_read_b64_tr_b16 v[204:205], v41 offset:0
ds_read_b64_tr_b16 v[212:213], v42 offset:0
ds_read_b64_tr_b16 v[220:221], v43 offset:0
ds_read_b64_tr_b16 v[228:229], v44 offset:0
ds_read_b64_tr_b16 v[236:237], v45 offset:0
ds_read_b64_tr_b16 v[244:245], v46 offset:0
ds_read_b64_tr_b16 v[252:253], v47 offset:0
s_add_u32 m0, s65, 34816
s_xor_b32 s66, s64, 118784
buffer_load_dwordx4 v16, s[44:47], s66 offen  lds
s_waitcnt vmcnt(2)
s_add_u32 m0, s65, 35840
s_xor_b32 s66, s64, 126976
buffer_load_dwordx4 v17, s[44:47], s66 offen  lds
s_waitcnt vmcnt(0)
ds_read_b64_tr_b16 v[198:199], v40 offset:32768
ds_read_b64_tr_b16 v[206:207], v41 offset:32768
ds_read_b64_tr_b16 v[214:215], v42 offset:32768
ds_read_b64_tr_b16 v[222:223], v43 offset:32768
ds_read_b64_tr_b16 v[230:231], v44 offset:32768
ds_read_b64_tr_b16 v[238:239], v45 offset:32768
ds_read_b64_tr_b16 v[246:247], v46 offset:32768
ds_read_b64_tr_b16 v[254:255], v47 offset:32768
s_waitcnt lgkmcnt(0)
v_cmp_eq_u32 vcc, 0, v25
s_cbranch_vccz L_tab_162
s_mov_b32 s75, 0
L_poll_163:
buffer_load_dword v25, v24, s[52:55], 0 offen offset:128 sc1
s_waitcnt vmcnt(0)
v_cmp_eq_u32 vcc, 0, v25
s_cbranch_vccz L_pollx_164
s_sleep 40
s_add_u32 s75, s75, 1
s_cmp_lt_u32 s75, 0x100000
s_cbranch_scc1 L_poll_163
L_pollx_164:
L_tab_162:
v_bfe_u32 v26, v25, 8, 3
v_lshrrev_b32 v25, 16, v25
s_nop 0
v_add_u32_dpp v26, v26, v26 quad_perm:[1,0,3,2] row_mask:0xf bank_mask:0xf
s_nop 1
v_add_u32_dpp v26, v26, v26 quad_perm:[2,3,0,1] row_mask:0xf bank_mask:0xf
s_nop 1
v_add_u32_dpp v26, v26, v26 row_ror:4 row_mask:0xf bank_mask:0xf
s_nop 1
v_add_u32_dpp v26, v26, v26 row_ror:8 row_mask:0xf bank_mask:0xf
s_nop 1
v_readlane_b32 s66, v26, 0
v_readlane_b32 s71, v26, 16
s_add_u32 s66, s66, s71
s_cmp_gt_u32 s66, 64
s_cselect_b32 s66, 1, 0
v_cmp_ne_u32 vcc, s66, v25
s_and_b32 s71, vcc_lo, 0xff
s_bcnt0_i32_b32 s66, s71
s_sub_u32 s66, s66, 24
v_mbcnt_lo_u32_b32 v24, s71, 0
v_sub_u32 v25, v0, v24
v_add_u32 v24, s66, v24
v_cndmask_b32 v24, v25, v24, vcc
v_bfe_u32 v25, v24, 1, 2
v_and_b32 v26, 1, v24
v_lshl_or_b32 v25, v26, 2, v25
v_lshlrev_b32 v25, v2, v25
s_nop 1
v_or_b32_dpp v25, v25, v25 quad_perm:[1,0,3,2] row_mask:0xf bank_mask:0xf
s_nop 1
v_or_b32_dpp v25, v25, v25 quad_perm:[2,3,0,1] row_mask:0xf bank_mask:0xf
s_nop 1
v_or_b32_dpp v25, v25, v25 row_shl:4 row_mask:0xf bank_mask:0xf
s_nop 1
v_readfirstlane_b32 s35, v25
s_mov_b64 exec, 1
ds_write_b32 v2, v25 offset:328
s_mov_b64 exec, -1
s_sub_u32 s64, s2, 144
s_cmp_lt_u32 s64, 64
s_cbranch_scc0 L_rp_165
s_cmp_eq_u32 s34, 0
s_cbranch_scc0 L_rp_165
s_mov_b32 s48, s4
s_mov_b32 s49, s5
s_mov_b32 s50, 0x2000
s_mov_b32 s51, 0x20000
v_and_b32 v5, 15, v0
v_and_b32 v6, 16, v0
v_lshl_add_u32 v5, v6, 1, v5
v_and_b32 v6, 32, v0
v_lshrrev_b32 v6, 1, v6
v_add_u32 v5, v5, v6
v_lshlrev_b32 v5, 1, v5
v_and_b32 v6, 0x7c, v5
s_lshl_b32 s65, s64, 7
s_and_b32 s66, s65, 0x380
s_lshr_b32 s64, s64, 3
s_mul_i32 s64, s64, 12288
s_add_u32 s64, s64, s66
s_add_u32 s64, s64, 24576
buffer_load_ushort v18, v5, s[48:51], s65 offen
s_mov_b32 s75, 0
L_poll_166:
buffer_load_dword v19, v6, s[36:39], s64 offen offset:0 sc1
buffer_load_dword v20, v6, s[36:39], s64 offen offset:3072 sc1
s_waitcnt vmcnt(0)
v_max_u32 v16, v19, v20
v_cmp_eq_u32 vcc, -1, v16
s_cbranch_vccz L_pollx_167
s_sleep 40
s_add_u32 s75, s75, 1
s_cmp_lt_u32 s75, 0x100000
s_cbranch_scc1 L_poll_166
L_pollx_167:
v_and_b32 v16, 1, v0
v_lshlrev_b32 v16, 4, v16
v_xor_b32 v16, 16, v16
v_lshlrev_b32 v18, 16, v18
v_lshlrev_b32 v19, v16, v19
v_and_b32 v19, 0xffff0000, v19
v_lshlrev_b32 v20, v16, v20
v_and_b32 v20, 0xffff0000, v20
ds_write_b32 v2, v18 offset:4096
ds_write_b32 v2, v19 offset:4352
ds_write_b32 v2, v20 offset:4608
L_rp_165:
v_lshlrev_b32 v10, 3, v0
s_lshl_b32 s64, s34, 8
s_add_u32 s64, s64, 2560
s_lshr_b32 s66, s68, 1
v_xor_b32 v12, s66, v0
v_mov_b32 v14, 0
v_bfe_u32 v11, v12, 0, 1
v_lshl_or_b32 v14, v11, 0, v14
v_bfe_u32 v11, v12, 1, 1
v_lshl_or_b32 v14, v11, 1, v14
v_bfe_u32 v11, v12, 2, 1
v_lshl_or_b32 v14, v11, 2, v14
v_bfe_u32 v11, v12, 3, 1
v_lshl_or_b32 v14, v11, 3, v14
v_bfe_u32 v11, v12, 4, 1
v_lshl_or_b32 v14, v11, 4, v14
v_bfe_u32 v11, v12, 5, 1
v_lshl_or_b32 v14, v11, 5, v14
v_and_b32 v11, 0x38, v14
v_and_b32 v12, 1, v14
v_lshl_add_u32 v11, v12, 2, v11
v_bfe_u32 v12, v14, 1, 2
v_add_u32 v11, v11, v12
v_lshl_add_u32 v11, v11, 2, s64
v_and_b32 v14, 1, v0
v_and_b32 v12, 48, v0
v_lshlrev_b32 v12, 1, v12
v_lshl_add_u32 v12, v14, 4, v12
v_add_u32 v12, s64, v12
v_mul_u32_u24 v15, 0xaaaa, v14
v_add_u32 v15, 0x4444, v15
v_mov_b32 v64, 0
v_mov_b32 v65, 0
v_mov_b32 v66, 0
v_mov_b32 v67, 0
v_mov_b32 v68, 0
v_mov_b32 v69, 0
v_mov_b32 v70, 0
v_mov_b32 v71, 0
v_mov_b32 v72, 0
v_mov_b32 v73, 0
v_mov_b32 v74, 0
v_mov_b32 v75, 0
v_mov_b32 v76, 0
v_mov_b32 v77, 0
v_mov_b32 v78, 0
v_mov_b32 v79, 0
v_mov_b32 v80, 0
v_mov_b32 v81, 0
v_mov_b32 v82, 0
v_mov_b32 v83, 0
v_mov_b32 v84, 0
v_mov_b32 v85, 0
v_mov_b32 v86, 0
v_mov_b32 v87, 0
v_mov_b32 v88, 0
v_mov_b32 v89, 0
v_mov_b32 v90, 0
v_mov_b32 v91, 0
v_mov_b32 v92, 0
v_mov_b32 v93, 0
v_mov_b32 v94, 0
v_mov_b32 v95, 0
s_lshl_b32 s64, s34, 3
s_lshr_b32 s64, s35, s64
v_bfe_u32 v13, v0, 3, 1
v_lshlrev_b32 v13, 2, v13
v_bfe_u32 v13, s64, v13, 3
v_and_b32 v14, 0x70, v1
v_lshl_add_u32 v13, v13, 12, v14
s_lshl_b32 s64, s34, 2
s_add_u32 s64, s64, s33
v_bfe_u32 v14, v0, 3, 1
v_lshl_add_u32 v14, v14, 1, s64
v_and_b32 v14, 31, v14
v_lshl_add_u32 v13, v14, 7, v13
s_lshl_b32 s69, s32, 15
s_add_u32 s69, s69, 1048576
s_waitcnt vmcnt(0) lgkmcnt(0)
s_barrier
ds_read_b64 v[20:21], v10 offset:512
ds_read_b64 v[22:23], v10 offset:1024
ds_read_b64 v[24:25], v10 offset:1536
ds_read_b64 v[26:27], v10 offset:2048
s_waitcnt lgkmcnt(2)
v_pk_add_f32 v[20:21], v[20:21], v[22:23]
s_waitcnt lgkmcnt(1)
v_pk_add_f32 v[20:21], v[20:21], v[24:25]
s_waitcnt lgkmcnt(0)
v_pk_add_f32 v[20:21], v[20:21], v[26:27]
v_cvt_pk_bf16_f32 v20, v20, v21
ds_write_b32 v11, v20
ds_read_b128 v[48:51], v12 offset:0
ds_read_b128 v[52:55], v12 offset:128
s_waitcnt lgkmcnt(1)
v_smfmac_f32_16x16x64_bf16 v[64:67], v[48:51], v[128:135], v15
v_smfmac_f32_16x16x64_bf16 v[68:71], v[48:51], v[136:143], v15
v_smfmac_f32_16x16x64_bf16 v[72:75], v[48:51], v[144:151], v15
v_smfmac_f32_16x16x64_bf16 v[76:79], v[48:51], v[152:159], v15
s_waitcnt lgkmcnt(0)
v_smfmac_f32_16x16x64_bf16 v[64:67], v[52:55], v[192:199], v15
v_smfmac_f32_16x16x64_bf16 v[68:71], v[52:55], v[200:207], v15
v_smfmac_f32_16x16x64_bf16 v[72:75], v[52:55], v[208:215], v15
v_smfmac_f32_16x16x64_bf16 v[76:79], v[52:55], v[216:223], v15
v_smfmac_f32_16x16x64_bf16 v[80:83], v[48:51], v[160:167], v15
v_smfmac_f32_16x16x64_bf16 v[84:87], v[48:51], v[168:175], v15
v_smfmac_f32_16x16x64_bf16 v[88:91], v[48:51], v[176:183], v15
v_smfmac_f32_16x16x64_bf16 v[92:95], v[48:51], v[184:191], v15
v_smfmac_f32_16x16x64_bf16 v[80:83], v[52:55], v[224:231], v15
v_add_f32 v64, v64, v65
v_smfmac_f32_16x16x64_bf16 v[84:87], v[52:55], v[232:239], v15
v_add_f32 v68, v68, v69
v_add_f32 v72, v72, v73
v_smfmac_f32_16x16x64_bf16 v[88:91], v[52:55], v[240:247], v15
v_add_f32 v76, v76, v77
v_cvt_pk_bf16_f32 v20, v64, v68
v_smfmac_f32_16x16x64_bf16 v[92:95], v[52:55], v[248:255], v15
v_cvt_pk_bf16_f32 v21, v72, v76
v_add_f32 v80, v80, v81
s_mov_b64 exec, 0xffff
v_add_f32 v84, v84, v85
v_cvt_pk_bf16_f32 v22, v80, v84
s_nop 0
v_add_f32 v88, v88, v89
s_nop 0
v_add_f32 v92, v92, v93
v_cvt_pk_bf16_f32 v23, v88, v92
buffer_store_dwordx4 v[20:23], v13, s[36:39], s69 offen sc1
s_mov_b64 exec, -1
s_sub_u32 s67, s2, 16
s_cmp_lt_u32 s67, 128
s_cbranch_scc0 L_nogp
s_and_b32 s66, s2, 7
s_min_u32 s64, s66, 3
s_mul_i32 s71, s66, 5
s_add_u32 s64, s64, s71
s_cmp_lt_u32 s66, 3
s_cselect_b32 s66, 5, 4
v_and_b32 v8, 7, v0
v_min_u32 v8, s66, v8
v_add_u32 v8, s64, v8
s_and_b32 s64, s67, 0xf8
s_lshl_b32 s64, s64, 2
s_lshl_b32 s66, s34, 3
s_add_u32 s64, s64, s66
v_lshrrev_b32 v9, 3, v0
v_add_u32 v9, s64, v9
v_mul_u32_u24 v9, 2752, v9
v_lshl_add_u32 v8, v8, 6, v9
global_load_dword v10, v8, s[16:17]
global_load_dword v11, v8, s[18:19]
s_and_b32 s66, s2, 7
s_min_u32 s70, s66, 3
s_mul_i32 s71, s66, 5
s_add_u32 s70, s70, s71
s_cmp_lt_u32 s66, 3
s_cselect_b32 s66, 6, 5
s_lshl_b32 s66, s66, 8
s_sub_u32 s66, s66, 1
s_lshr_b32 s71, s67, 3
s_lshl_b32 s71, s71, 2
s_add_u32 s71, s71, s34
s_mul_i32 s71, s71, 24
v_min_u32 v12, 23, v0
v_add_u32 v12, s71, v12
v_min_u32 v12, s66, v12
s_lshl_b32 s70, s70, 15
v_lshl_add_u32 v12, v12, 7, s70
global_load_dword v13, v12, s[20:21]
s_endpgm
L_nogp:
L_tail_s:
s_cmp_eq_u32 s74, -1
s_cbranch_scc0 L_ffn
s_cmp_eq_u32 s3, 0
s_cbranch_scc0 L_fin
s_sub_u32 s70, s2, 144
s_cmp_lt_u32 s70, 64
s_cbranch_scc0 L_fin
s_lshl_b32 s64, s70, 2
s_lshr_b32 s67, s35, s64
s_and_b32 s71, s67, 7
s_andn2_b32 s66, s70, 7
s_add_u32 s66, s66, s71
s_lshl_b32 s66, s66, 12
s_add_u32 s66, s66, 1048576
buffer_load_dwordx4 v[16:19], v1, s[36:39], s66 offen offset:0 sc1
buffer_load_dwordx4 v[20:23], v1, s[36:39], s66 offen offset:1024 sc1
buffer_load_dwordx4 v[24:27], v1, s[36:39], s66 offen offset:2048 sc1
buffer_load_dwordx4 v[28:31], v1, s[36:39], s66 offen offset:3072 sc1
v_mov_b32 v32, -1
v_mov_b32 v33, -1
v_mov_b32 v34, -1
v_mov_b32 v35, -1
s_and_b32 s64, s71, 6
s_lshl_b32 s64, s64, 12
s_and_b32 s65, s71, 1
s_lshl_b32 s65, s65, 15
s_or_b32 s64, s64, s65
s_lshr_b32 s65, s70, 3
s_lshl_b32 s65, s65, 16
s_add_u32 s64, s64, s65
s_lshr_b32 s65, s70, 4
s_lshl_b32 s65, s65, 2
s_and_b32 s67, s70, 7
s_add_u32 s65, s65, s67
s_lshl_b32 s65, s65, 7
s_add_u32 s64, s64, s65
s_add_u32 s64, s64, 1376256
s_add_u32 s65, s64, 4096
buffer_store_dwordx4 v[32:35], v1, s[36:39], s64 offen offset:0 sc1
buffer_store_dwordx4 v[32:35], v1, s[36:39], s64 offen offset:1024 sc1
buffer_store_dwordx4 v[32:35], v1, s[36:39], s64 offen offset:2048 sc1
buffer_store_dwordx4 v[32:35], v1, s[36:39], s64 offen offset:3072 sc1
buffer_store_dwordx4 v[32:35], v1, s[36:39], s65 offen offset:0 sc1
s_mov_b64 exec, 0xffffff
buffer_store_dwordx4 v[32:35], v1, s[36:39], s65 offen offset:1024 sc1
s_mov_b64 exec, -1
v_lshlrev_b32 v2, 2, v0
ds_read_b32 v8, v2 offset:4096
ds_read_b32 v9, v2 offset:4352
ds_read_b32 v10, v2 offset:4608
s_mov_b32 s56, s26
s_mov_b32 s57, s27
s_mov_b32 s58, 0x2000
s_mov_b32 s59, 0x20000
v_and_b32 v5, 15, v0
v_and_b32 v6, 16, v0
v_lshl_add_u32 v5, v6, 1, v5
v_and_b32 v6, 32, v0
v_lshrrev_b32 v6, 1, v6
v_add_u32 v5, v5, v6
v_lshlrev_b32 v5, 1, v5
v_and_b32 v6, 0x7c, v5
s_lshl_b32 s73, s70, 7
v_and_b32 v11, 1, v0
v_lshlrev_b32 v3, 4, v11
v_mov_b32 v7, 0x3f80
v_lshlrev_b32 v7, v3, v7
v_and_b32 v2, 4, v0
v_cmp_eq_u32 vcc, 0, v2
v_bfe_u32 v2, v0, 1, 1
v_mul_u32_u24 v43, 0xaaaa, v2
v_add_u32 v43, 0x4444, v43
v_cndmask_b32 v44, 0, v7, vcc
v_sub_u32 v45, v7, v44
v_mov_b32 v46, v44
v_mov_b32 v47, v45
v_mov_b32 v48, 0
v_mov_b32 v49, 0
v_mov_b32 v50, 0
v_mov_b32 v51, 0
v_mov_b32 v52, 0
v_mov_b32 v53, 0
v_mov_b32 v54, 0
v_mov_b32 v55, 0
s_add_u32 s68, s73, 1310720
s_mov_b32 s76, 0xaaaaaaaa
s_mov_b32 s77, 0xaaaaaaaa
v_cmp_gt_u32 vcc, 24, v0
v_mov_b32 v41, 0x40000000
v_lshl_add_u32 v12, v11, 13, v6
v_cndmask_b32 v41, v41, v1, vcc
s_mov_b32 s75, 0
s_waitcnt vmcnt(0) lgkmcnt(0)
buffer_load_dwordx4 v[16:19], v1, s[36:39], s66 offen offset:0 sc1
buffer_load_dwordx4 v[20:23], v1, s[36:39], s66 offen offset:1024 sc1
buffer_load_dwordx4 v[24:27], v1, s[36:39], s66 offen offset:2048 sc1
buffer_load_dwordx4 v[28:31], v1, s[36:39], s66 offen offset:3072 sc1
s_sleep 1
buffer_load_dwordx4 v[16:19], v1, s[36:39], s66 offen offset:0 sc1
buffer_load_dwordx4 v[20:23], v1, s[36:39], s66 offen offset:1024 sc1
buffer_load_dwordx4 v[24:27], v1, s[36:39], s66 offen offset:2048 sc1
buffer_load_dwordx4 v[28:31], v1, s[36:39], s66 offen offset:3072 sc1
s_sleep 1
buffer_load_dwordx4 v[16:19], v1, s[36:39], s66 offen offset:0 sc1
buffer_load_dwordx4 v[20:23], v1, s[36:39], s66 offen offset:1024 sc1
buffer_load_dwordx4 v[24:27], v1, s[36:39], s66 offen offset:2048 sc1
buffer_load_dwordx4 v[28:31], v1, s[36:39], s66 offen offset:3072 sc1
s_sleep 1
L_rn_170:
v_smfmac_f32_16x16x64_bf16 v[48:51], v[44:47], v[16:23], v43
v_smfmac_f32_16x16x64_bf16 v[48:51], v[44:47], v[24:31], v43
buffer_load_dwordx4 v[16:19], v1, s[36:39], s66 offen offset:0 sc1
buffer_load_dwordx4 v[20:23], v1, s[36:39], s66 offen offset:1024 sc1
buffer_load_dwordx4 v[24:27], v1, s[36:39], s66 offen offset:2048 sc1
buffer_load_dwordx4 v[28:31], v1, s[36:39], s66 offen offset:3072 sc1
s_add_u32 s75, s75, 1
s_and_b32 s78, s75, 15
s_nop 1
v_add_f32_dpp v13, v48, v48 row_ror:8 row_mask:0x3 bank_mask:0x3
v_add_f32_dpp v13, v49, v49 row_ror:8 row_mask:0x3 bank_mask:0xc
v_add_f32_dpp v13, v50, v50 row_ror:8 row_mask:0xc bank_mask:0x3
v_add_f32_dpp v13, v51, v51 row_ror:8 row_mask:0xc bank_mask:0xc
v_cmp_u_f32 vcc, v13, v13
s_cbranch_vccz L_rz_171
v_mov_b32 v48, 0
v_mov_b32 v49, 0
v_mov_b32 v50, 0
v_mov_b32 v51, 0
s_waitcnt vmcnt(12)
s_cbranch_scc1 L_rn_170
v_max3_u32 v2, v16, v17, v18
v_max3_u32 v2, v2, v19, v20
v_max3_u32 v2, v2, v21, v22
v_max3_u32 v2, v2, v23, v24
v_max3_u32 v2, v2, v25, v26
v_max3_u32 v2, v2, v27, v28
v_max3_u32 v2, v2, v29, v30
v_max_u32 v2, v2, v31
v_cmp_eq_u32 vcc, -1, v2
s_cbranch_vccz L_rx_169
s_cmp_lt_u32 s75, 0x100000
s_cbranch_scc1 L_rn_170
L_rx_169:
v_smfmac_f32_16x16x64_bf16 v[48:51], v[44:47], v[16:23], v43
v_smfmac_f32_16x16x64_bf16 v[48:51], v[44:47], v[24:31], v43
s_nop 7
v_add_f32_dpp v13, v48, v48 row_ror:8 row_mask:0x3 bank_mask:0x3
v_add_f32_dpp v13, v49, v49 row_ror:8 row_mask:0x3 bank_mask:0xc
v_add_f32_dpp v13, v50, v50 row_ror:8 row_mask:0xc bank_mask:0x3
v_add_f32_dpp v13, v51, v51 row_ror:8 row_mask:0xc bank_mask:0xc
L_rz_171:
v_fmac_f32 v8, v13, v9
s_nop 1
v_mov_b32_dpp v14, v8 quad_perm:[1,1,3,3] row_mask:0xf bank_mask:0xf
v_mov_b32_dpp v13, v8 quad_perm:[0,0,2,2] row_mask:0xf bank_mask:0xf
v_cvt_pk_bf16_f32 v13, v13, v14
buffer_store_dword v13, v12, s[36:39], s68 offen sc1
v_cvt_pk_bf16_f32 v8, 0, v8
buffer_load_dwordx4 v[64:67], v1, s[36:39], s64 offen offset:0 sc1
buffer_load_dwordx4 v[68:71], v1, s[36:39], s64 offen offset:1024 sc1
buffer_load_dwordx4 v[72:75], v1, s[36:39], s64 offen offset:2048 sc1
buffer_load_dwordx4 v[76:79], v1, s[36:39], s64 offen offset:3072 sc1
buffer_load_dwordx4 v[80:83], v1, s[36:39], s65 offen offset:0 sc1
buffer_load_dwordx4 v[84:87], v41, s[36:39], s65 offen offset:1024 sc1
s_mov_b32 s75, 0
s_waitcnt vmcnt(0)
buffer_load_dwordx4 v[64:67], v1, s[36:39], s64 offen offset:0 sc1
buffer_load_dwordx4 v[68:71], v1, s[36:39], s64 offen offset:1024 sc1
buffer_load_dwordx4 v[72:75], v1, s[36:39], s64 offen offset:2048 sc1
buffer_load_dwordx4 v[76:79], v1, s[36:39], s64 offen offset:3072 sc1
buffer_load_dwordx4 v[80:83], v1, s[36:39], s65 offen offset:0 sc1
buffer_load_dwordx4 v[84:87], v41, s[36:39], s65 offen offset:1024 sc1
s_sleep 1
buffer_load_dwordx4 v[64:67], v1, s[36:39], s64 offen offset:0 sc1
buffer_load_dwordx4 v[68:71], v1, s[36:39], s64 offen offset:1024 sc1
buffer_load_dwordx4 v[72:75], v1, s[36:39], s64 offen offset:2048 sc1
buffer_load_dwordx4 v[76:79], v1, s[36:39], s64 offen offset:3072 sc1
buffer_load_dwordx4 v[80:83], v1, s[36:39], s65 offen offset:0 sc1
buffer_load_dwordx4 v[84:87], v41, s[36:39], s65 offen offset:1024 sc1
s_sleep 1
L_rn_174:
v_smfmac_f32_16x16x64_bf16 v[52:55], v[44:47], v[64:71], v43
v_smfmac_f32_16x16x64_bf16 v[52:55], v[44:47], v[72:79], v43
v_smfmac_f32_16x16x64_bf16 v[52:55], v[44:47], v[80:87], v43
buffer_load_dwordx4 v[64:67], v1, s[36:39], s64 offen offset:0 sc1
buffer_load_dwordx4 v[68:71], v1, s[36:39], s64 offen offset:1024 sc1
buffer_load_dwordx4 v[72:75], v1, s[36:39], s64 offen offset:2048 sc1
buffer_load_dwordx4 v[76:79], v1, s[36:39], s64 offen offset:3072 sc1
buffer_load_dwordx4 v[80:83], v1, s[36:39], s65 offen offset:0 sc1
buffer_load_dwordx4 v[84:87], v41, s[36:39], s65 offen offset:1024 sc1
s_add_u32 s75, s75, 1
s_and_b32 s78, s75, 15
v_add_f32_dpp v13, v52, v52 row_ror:8 row_mask:0x3 bank_mask:0x3
v_add_f32_dpp v13, v53, v53 row_ror:8 row_mask:0x3 bank_mask:0xc
v_add_f32_dpp v13, v54, v54 row_ror:8 row_mask:0xc bank_mask:0x3
v_add_f32_dpp v13, v55, v55 row_ror:8 row_mask:0xc bank_mask:0xc
v_cmp_u_f32 vcc, v13, v13
s_cbranch_vccz L_rz_175
v_mov_b32 v52, 0
v_mov_b32 v53, 0
v_mov_b32 v54, 0
v_mov_b32 v55, 0
s_waitcnt vmcnt(12)
s_cbranch_scc1 L_rn_174
v_max3_u32 v2, v64, v65, v66
v_max3_u32 v2, v2, v67, v68
v_max3_u32 v2, v2, v69, v70
v_max3_u32 v2, v2, v71, v72
v_max3_u32 v2, v2, v73, v74
v_max3_u32 v2, v2, v75, v76
v_max3_u32 v2, v2, v77, v78
v_max3_u32 v2, v2, v79, v80
v_max3_u32 v2, v2, v81, v82
v_max3_u32 v2, v2, v83, v84
v_max3_u32 v2, v2, v85, v86
v_max_u32 v2, v2, v87
v_cmp_eq_u32 vcc, -1, v2
s_cbranch_vccz L_rx_173
s_cmp_lt_u32 s75, 0x100000
s_cbranch_scc1 L_rn_174
L_rx_173:
v_smfmac_f32_16x16x64_bf16 v[52:55], v[44:47], v[64:71], v43
v_smfmac_f32_16x16x64_bf16 v[52:55], v[44:47], v[72:79], v43
v_smfmac_f32_16x16x64_bf16 v[52:55], v[44:47], v[80:87], v43
s_nop 7
v_add_f32_dpp v13, v52, v52 row_ror:8 row_mask:0x3 bank_mask:0x3
v_add_f32_dpp v13, v53, v53 row_ror:8 row_mask:0x3 bank_mask:0xc
v_add_f32_dpp v13, v54, v54 row_ror:8 row_mask:0xc bank_mask:0x3
v_add_f32_dpp v13, v55, v55 row_ror:8 row_mask:0xc bank_mask:0xc
L_rz_175:
v_fmac_f32 v8, v13, v10
s_nop 1
v_mov_b32_dpp v14, v8 quad_perm:[1,1,3,3] row_mask:0xf bank_mask:0xf
s_not_b64 exec, s[76:77]
v_cvt_pk_bf16_f32 v13, v8, v14
buffer_store_dword v13, v6, s[56:59], s73 offen sc1
s_mov_b64 exec, -1
s_cmp_lt_u32 s70, 8
s_cbranch_scc0 L_fin2
s_mov_b64 exec, 0xffff
buffer_store_dwordx4 v[44:47], v1, s[36:39], s62 offen sc1
s_mov_b64 exec, -1
L_fin2:
s_endpgm
L_ffn:
s_mul_i32 s67, s3, 12288
s_add_u32 s67, s67, 25600
v_lshlrev_b32 v7, 3, v0
buffer_load_dwordx4 v[8:11], v1, s[36:39], s67 offen offset:0 sc1
buffer_load_dwordx4 v[12:15], v1, s[36:39], s67 offen offset:1024 sc1
s_cmp_lt_u32 s3, 4
s_cbranch_scc1 L_post_176
s_mov_b32 s40, s16
s_mov_b32 s41, s17
s_mov_b32 s42, 0x158000
s_mov_b32 s43, 0x20000
s_mov_b32 s56, s18
s_mov_b32 s57, s19
s_mov_b32 s58, 0x158000
s_mov_b32 s59, 0x20000
v_lshrrev_b32 v16, 2, v0
v_mul_u32_u24 v16, 2752, v16
v_and_b32 v17, 3, v0
v_lshrrev_b32 v18, 5, v0
v_xor_b32 v17, v17, v18
v_xor_b32 v18, 2, v17
v_lshl_add_u32 v17, v17, 4, v16
v_lshl_add_u32 v18, v18, 4, v16
s_mul_i32 s64, s34, 352256
s_lshl_b32 s65, s74, 6
s_add_u32 s64, s64, s65
s_lshl_b32 s65, s34, 13
s_add_u32 m0, s65, 4096
s_add_u32 s66, s64, 0
buffer_load_dwordx4 v17, s[40:43], s66 offen  lds
s_add_u32 m0, s65, 36864
s_add_u32 s66, s64, 0
buffer_load_dwordx4 v18, s[56:59], s66 offen  lds
s_add_u32 m0, s65, 5120
s_add_u32 s66, s64, 44032
buffer_load_dwordx4 v17, s[40:43], s66 offen  lds
s_add_u32 m0, s65, 37888
s_add_u32 s66, s64, 44032
buffer_load_dwordx4 v18, s[56:59], s66 offen  lds
s_add_u32 m0, s65, 6144
s_add_u32 s66, s64, 88064
buffer_load_dwordx4 v17, s[40:43], s66 offen  lds
s_add_u32 m0, s65, 38912
s_add_u32 s66, s64, 88064
buffer_load_dwordx4 v18, s[56:59], s66 offen  lds
s_add_u32 m0, s65, 7168
s_add_u32 s66, s64, 132096
buffer_load_dwordx4 v17, s[40:43], s66 offen  lds
s_add_u32 m0, s65, 39936
s_add_u32 s66, s64, 132096
buffer_load_dwordx4 v18, s[56:59], s66 offen  lds
s_add_u32 m0, s65, 8192
s_add_u32 s66, s64, 176128
buffer_load_dwordx4 v17, s[40:43], s66 offen  lds
s_add_u32 m0, s65, 40960
s_add_u32 s66, s64, 176128
buffer_load_dwordx4 v18, s[56:59], s66 offen  lds
s_add_u32 m0, s65, 9216
s_add_u32 s66, s64, 220160
buffer_load_dwordx4 v17, s[40:43], s66 offen  lds
s_add_u32 m0, s65, 41984
s_add_u32 s66, s64, 220160
buffer_load_dwordx4 v18, s[56:59], s66 offen  lds
s_add_u32 m0, s65, 10240
s_add_u32 s66, s64, 264192
buffer_load_dwordx4 v17, s[40:43], s66 offen  lds
s_add_u32 m0, s65, 43008
s_add_u32 s66, s64, 264192
buffer_load_dwordx4 v18, s[56:59], s66 offen  lds
s_add_u32 m0, s65, 11264
s_add_u32 s66, s64, 308224
buffer_load_dwordx4 v17, s[40:43], s66 offen  lds
s_add_u32 m0, s65, 44032
s_add_u32 s66, s64, 308224
buffer_load_dwordx4 v18, s[56:59], s66 offen  lds
s_waitcnt vmcnt(16)
s_branch L_post_177
L_post_176:
s_waitcnt vmcnt(0)
L_post_177:
v_max3_u32 v16, v8, v9, v10
v_max3_u32 v16, v16, v11, v12
v_max3_u32 v16, v16, v13, v14
v_max_u32 v16, v16, v15
v_cmp_eq_u32 vcc, -1, v16
s_cbranch_vccz L_cb_178
s_mov_b32 s75, 0
L_poll_179:
buffer_load_dwordx4 v[8:11], v1, s[36:39], s67 offen offset:0 sc1
buffer_load_dwordx4 v[12:15], v1, s[36:39], s67 offen offset:1024 sc1
s_waitcnt vmcnt(0)
v_max3_u32 v16, v8, v9, v10
v_max3_u32 v16, v16, v11, v12
v_max3_u32 v16, v16, v13, v14
v_max_u32 v16, v16, v15
v_cmp_eq_u32 vcc, -1, v16
s_cbranch_vccz L_pollx_180
s_add_u32 s75, s75, 1
s_cmp_lt_u32 s75, 0x100000
s_cbranch_scc1 L_poll_179
L_pollx_180:
L_cb_178:
s_mov_b32 s68, 0xffff0000
v_lshlrev_b32 v24, 16, v8
v_and_b32 v25, s68, v8
v_lshlrev_b32 v32, 16, v12
v_and_b32 v33, s68, v12
v_lshlrev_b32 v26, 16, v9
v_and_b32 v27, s68, v9
v_lshlrev_b32 v34, 16, v13
v_and_b32 v35, s68, v13
v_lshlrev_b32 v28, 16, v10
v_and_b32 v29, s68, v10
v_lshlrev_b32 v36, 16, v14
v_and_b32 v37, s68, v14
v_lshlrev_b32 v30, 16, v11
v_and_b32 v31, s68, v11
v_lshlrev_b32 v38, 16, v15
v_and_b32 v39, s68, v15
v_add_f32 v32, 1.0, v32
v_add_f32 v33, 1.0, v33
v_add_f32 v34, 1.0, v34
v_add_f32 v35, 1.0, v35
v_add_f32 v36, 1.0, v36
v_add_f32 v37, 1.0, v37
v_add_f32 v38, 1.0, v38
v_add_f32 v39, 1.0, v39
v_lshrrev_b32 v2, 3, v0
v_bfe_u32 v3, v0, 1, 3
v_and_b32 v4, 3, v3
s_lshl_b32 s64, s3, 1
v_xor_b32 v3, s64, v3
v_lshlrev_b32 v5, 10, v2
v_lshl_add_u32 v5, v4, 8, v5
v_lshl_add_u32 v5, v3, 4, v5
v_and_b32 v4, 1, v0
v_lshl_add_u32 v5, v4, 3, v5
v_add_u32 v5, 69632, v5
v_xor_b32 v6, 16, v5
v_mul_u32_u24 v16, 0xaaaa, v4
v_add_u32 v16, 0x4444, v16
v_lshrrev_b32 v2, 4, v0
v_bfe_u32 v3, v0, 3, 1
v_xor_b32 v7, v2, v0
v_lshlrev_b32 v7, 4, v7
v_add_u32 v7, 69632, v7
v_xor_b32 v8, 64, v7
v_and_b32 v4, 7, v0
v_and_b32 v9, 0x38, v0
v_lshlrev_b32 v9, 3, v9
v_lshl_add_u32 v9, v4, 1, v9
s_lshl_b32 s64, s34, 4
v_add_u32 v9, s64, v9
v_and_b32 v10, 12, v0
v_lshlrev_b32 v10, 5, v10
v_and_b32 v4, 1, v0
v_lshl_add_u32 v10, v4, 6, v10
v_lshl_add_u32 v10, v2, 4, v10
v_mov_b32 v17, 0xbfb8aa3b
v_mov_b32 v64, 0
v_mov_b32 v65, 0
v_mov_b32 v66, 0
v_mov_b32 v67, 0
s_lshl_b32 s64, s34, 3
s_lshr_b32 s64, s35, s64
v_lshlrev_b32 v3, 2, v3
v_bfe_u32 v3, s64, v3, 3
v_and_b32 v11, 6, v3
v_lshlrev_b32 v11, 12, v11
v_and_b32 v3, 1, v3
v_lshl_add_u32 v11, v3, 15, v11
v_lshl_add_u32 v11, v2, 17, v11
v_and_b32 v4, 240, v1
v_add_u32 v11, v11, v4
v_lshl_add_u32 v11, v2, 9, v11
s_lshl_b32 s64, s34, 8
v_add_u32 v11, s64, v11
s_lshl_b32 s69, s74, 7
s_add_u32 s69, s69, 1376256
s_add_u32 s72, s69, 65536
s_lshl_b32 s64, s3, 10
s_lshl_b32 s65, s2, 2
s_lshr_b32 s65, s35, s65
s_and_b32 s65, s65, 2
s_lshl_b32 s65, s65, 12
s_add_u32 s64, s64, s65
s_add_u32 s64, s64, 1310720
v_mov_b32 v14, 0xbb000000
v_mov_b32 v15, 0x3b000000
v_lshrrev_b32 v18, 4, v0
v_bfe_u32 v19, v0, 2, 2
v_bfe_u32 v20, v0, 1, 1
v_and_b32 v22, 1, v18
v_lshl_add_u32 v22, v20, 1, v22
v_xor_b32 v22, s34, v22
v_lshlrev_b32 v22, 4, v22
v_lshl_add_u32 v22, v20, 15, v22
v_lshl_add_u32 v22, v18, 9, v22
v_lshl_add_u32 v22, v19, 6, v22
v_and_b32 v20, 1, v0
v_lshl_add_u32 v22, v20, 3, v22
v_add_u32 v22, 4096, v22
s_lshr_b32 s73, s3, 2
s_waitcnt vmcnt(0)
s_barrier
buffer_load_dwordx4 v[56:59], v1, s[36:39], s64 offen sc1
s_cmp_eq_u32 s73, 0
s_cbranch_scc1 L_gu_182
ds_read_b64_tr_b16 v[128:129], v22 offset:0
ds_read_b64_tr_b16 v[130:131], v22 offset:256
ds_read_b64_tr_b16 v[132:133], v22 offset:2048
ds_read_b64_tr_b16 v[134:135], v22 offset:2304
ds_read_b64_tr_b16 v[136:137], v22 offset:4096
ds_read_b64_tr_b16 v[138:139], v22 offset:4352
ds_read_b64_tr_b16 v[140:141], v22 offset:6144
ds_read_b64_tr_b16 v[142:143], v22 offset:6400
ds_read_b64_tr_b16 v[144:145], v22 offset:8192
ds_read_b64_tr_b16 v[146:147], v22 offset:8448
ds_read_b64_tr_b16 v[148:149], v22 offset:10240
s_waitcnt lgkmcnt(4)
ds_read_b64_tr_b16 v[150:151], v22 offset:10496
ds_read_b64_tr_b16 v[152:153], v22 offset:12288
ds_read_b64_tr_b16 v[154:155], v22 offset:12544
ds_read_b64_tr_b16 v[156:157], v22 offset:14336
ds_read_b64_tr_b16 v[158:159], v22 offset:14592
ds_read_b64_tr_b16 v[160:161], v22 offset:16384
ds_read_b64_tr_b16 v[162:163], v22 offset:16640
ds_read_b64_tr_b16 v[164:165], v22 offset:18432
ds_read_b64_tr_b16 v[166:167], v22 offset:18688
ds_read_b64_tr_b16 v[168:169], v22 offset:20480
ds_read_b64_tr_b16 v[170:171], v22 offset:20736
s_waitcnt lgkmcnt(4)
ds_read_b64_tr_b16 v[172:173], v22 offset:22528
ds_read_b64_tr_b16 v[174:175], v22 offset:22784
ds_read_b64_tr_b16 v[176:177], v22 offset:24576
ds_read_b64_tr_b16 v[178:179], v22 offset:24832
ds_read_b64_tr_b16 v[180:181], v22 offset:26624
ds_read_b64_tr_b16 v[182:183], v22 offset:26880
ds_read_b64_tr_b16 v[184:185], v22 offset:28672
ds_read_b64_tr_b16 v[186:187], v22 offset:28928
ds_read_b64_tr_b16 v[188:189], v22 offset:30720
ds_read_b64_tr_b16 v[190:191], v22 offset:30976
L_gu_182:
s_cmp_lt_u32 s3, 4
s_cbranch_scc0 L_dma_183
s_mov_b32 s48, s20
s_mov_b32 s49, s21
s_mov_b32 s50, 0x158000
s_mov_b32 s51, 0x20000
v_lshrrev_b32 v18, 4, v0
v_and_b32 v16, 15, v0
v_xor_b32 v16, v16, v18
v_xor_b32 v17, 4, v16
v_lshlrev_b32 v19, 10, v18
v_lshl_add_u32 v22, v16, 4, v19
v_lshl_add_u32 v23, v17, 4, v19
s_lshl_b32 s76, s74, 15
s_lshl_b32 s66, s34, 8
s_add_u32 s76, s76, s66
s_lshl_b32 s77, s34, 13
s_add_u32 s77, s77, 77824
v_bfe_u32 v19, v0, 2, 2
v_and_b32 v16, 2, v0
v_lshlrev_b32 v16, 2, v16
v_xor_b32 v16, v16, v19
v_and_b32 v17, 1, v18
v_lshlrev_b32 v17, 2, v17
v_xor_b32 v16, v16, v17
v_lshlrev_b32 v16, 4, v16
v_lshl_add_u32 v16, v18, 10, v16
v_lshl_add_u32 v16, v19, 8, v16
v_and_b32 v17, 1, v0
v_lshl_add_u32 v16, v17, 3, v16
v_add_u32 v68, s77, v16
v_xor_b32 v69, 16, v68
v_xor_b32 v70, 32, v68
v_xor_b32 v71, 48, v68
v_xor_b32 v72, 64, v68
v_xor_b32 v73, 80, v68
v_xor_b32 v74, 96, v68
v_xor_b32 v75, 112, v68
s_add_u32 m0, s77, 0
s_xor_b32 s66, s76, 0
buffer_load_dwordx4 v22, s[48:51], s66 offen  lds
s_add_u32 m0, s77, 1024
s_xor_b32 s66, s76, 8192
buffer_load_dwordx4 v23, s[48:51], s66 offen  lds
s_add_u32 m0, s77, 2048
s_xor_b32 s66, s76, 16384
buffer_load_dwordx4 v22, s[48:51], s66 offen  lds
s_add_u32 m0, s77, 3072
s_xor_b32 s66, s76, 24576
buffer_load_dwordx4 v23, s[48:51], s66 offen  lds
s_add_u32 m0, s77, 4096
s_xor_b32 s66, s76, 4096
buffer_load_dwordx4 v22, s[48:51], s66 offen  lds
s_add_u32 m0, s77, 5120
s_xor_b32 s66, s76, 12288
buffer_load_dwordx4 v23, s[48:51], s66 offen  lds
s_add_u32 m0, s77, 6144
s_xor_b32 s66, s76, 20480
buffer_load_dwordx4 v22, s[48:51], s66 offen  lds
s_waitcnt vmcnt(7)
s_branch L_dma_184
L_dma_183:
s_waitcnt vmcnt(0)
L_dma_184:
s_mov_b32 s73, 0x3f803f80
v_mov_b32 v20, 0
v_mov_b32 v21, 0
v_max3_u32 v12, v56, v57, v58
v_max_u32 v12, v12, v59
v_cmp_eq_u32 vcc, -1, v12
s_cbranch_vccz L_x_181
buffer_load_dwordx4 v[56:59], v1, s[36:39], s64 offen sc1
s_sleep 1
s_mov_b32 s75, 0
L_poll_185:
buffer_load_dwordx4 v[56:59], v1, s[36:39], s64 offen sc1
s_waitcnt vmcnt(1)
v_max3_u32 v12, v56, v57, v58
v_max_u32 v12, v12, v59
v_cmp_eq_u32 vcc, -1, v12
s_cbranch_vccz L_pollx_186
s_add_u32 s75, s75, 1
s_cmp_lt_u32 s75, 0x100000
s_cbranch_scc1 L_poll_185
L_pollx_186:
L_x_181:
v_dot2c_f32_bf16 v20, s73, v56
v_dot2c_f32_bf16 v21, v56, v56
v_dot2c_f32_bf16 v20, s73, v57
v_dot2c_f32_bf16 v21, v57, v57
v_dot2c_f32_bf16 v20, s73, v58
v_dot2c_f32_bf16 v21, v58, v58
v_dot2c_f32_bf16 v20, s73, v59
v_dot2c_f32_bf16 v21, v59, v59
v_lshlrev_b32 v40, 16, v56
v_and_b32 v41, s68, v56
v_lshlrev_b32 v42, 16, v57
v_permlane32_swap_b32 v20, v21
v_add_f32 v12, v20, v21
v_and_b32 v43, s68, v57
v_lshlrev_b32 v44, 16, v58
v_add_f32_dpp v12, v12, v12 quad_perm:[1,0,3,2] row_mask:0xf bank_mask:0xf
v_and_b32 v45, s68, v58
v_lshlrev_b32 v46, 16, v59
v_add_f32_dpp v12, v12, v12 quad_perm:[2,3,0,1] row_mask:0xf bank_mask:0xf
v_and_b32 v47, s68, v59
v_pk_mul_f32 v[48:49], v[40:41], v[32:33]
v_add_f32_dpp v12, v12, v12 row_ror:4 row_mask:0xf bank_mask:0xf
v_pk_mul_f32 v[50:51], v[42:43], v[34:35]
v_pk_mul_f32 v[52:53], v[44:45], v[36:37]
v_add_f32_dpp v12, v12, v12 row_ror:8 row_mask:0xf bank_mask:0xf
v_pk_mul_f32 v[54:55], v[46:47], v[38:39]
s_nop 0
v_add_f32_dpp v12, v12, v12 row_bcast:15 row_mask:0xa bank_mask:0xf
s_nop 0
v_readlane_b32 s70, v12, 16
v_readlane_b32 s71, v12, 48
s_nop 0
v_mul_f32 v12, s70, v14
v_mul_f32 v13, s71, v15
v_fma_f32 v13, -v12, v12, v13
v_max_f32 v13, 0, v13
v_add_f32 v13, 0x3727c5ac, v13
v_rsq_f32 v2, v13
v_pk_fma_f32 v[48:49], v[12:13], v[32:33], v[48:49] op_sel_hi:[0,1,1]
v_pk_fma_f32 v[50:51], v[12:13], v[34:35], v[50:51] op_sel_hi:[0,1,1]
v_pk_fma_f32 v[52:53], v[12:13], v[36:37], v[52:53] op_sel_hi:[0,1,1]
v_pk_fma_f32 v[54:55], v[12:13], v[38:39], v[54:55] op_sel_hi:[0,1,1]
v_pk_fma_f32 v[24:25], v[2:3], v[48:49], v[24:25] op_sel_hi:[0,1,1]
v_pk_fma_f32 v[28:29], v[2:3], v[52:53], v[28:29] op_sel_hi:[0,1,1]
v_pk_fma_f32 v[26:27], v[2:3], v[50:51], v[26:27] op_sel_hi:[0,1,1]
v_pk_fma_f32 v[30:31], v[2:3], v[54:55], v[30:31] op_sel_hi:[0,1,1]
v_cvt_pk_bf16_f32 v40, v24, v25
v_cvt_pk_bf16_f32 v41, v28, v29
ds_write_b64 v5, v[40:41]
v_cvt_pk_bf16_f32 v42, v26, v27
v_cvt_pk_bf16_f32 v43, v30, v31
ds_write_b64 v6, v[42:43]
s_cmp_lt_u32 s3, 4
s_cbranch_scc0 L_dma_187
s_mov_b32 s48, s20
s_mov_b32 s49, s21
s_mov_b32 s50, 0x158000
s_mov_b32 s51, 0x20000
s_add_u32 m0, s77, 7168
s_xor_b32 s66, s76, 28672
buffer_load_dwordx4 v23, s[48:51], s66 offen  lds
L_dma_187:
s_cmp_lt_u32 s3, 4
s_waitcnt lgkmcnt(0)
s_barrier
s_cbranch_scc1 L_bar_fin
ds_read_b128 v[192:195], v7 offset:0
ds_read_b128 v[196:199], v8 offset:1024
ds_read_b128 v[200:203], v7 offset:2048
ds_read_b128 v[204:207], v8 offset:3072
ds_read_b128 v[208:211], v7 offset:4096
ds_read_b128 v[212:215], v8 offset:5120
ds_read_b128 v[216:219], v7 offset:6144
ds_read_b128 v[220:223], v8 offset:7168
s_waitcnt lgkmcnt(7)
v_smfmac_f32_16x16x64_bf16 v[64:67], v[192:195], v[128:135], v16
s_waitcnt lgkmcnt(6)
v_smfmac_f32_16x16x64_bf16 v[64:67], v[196:199], v[136:143], v16
s_waitcnt lgkmcnt(5)
v_smfmac_f32_16x16x64_bf16 v[64:67], v[200:203], v[144:151], v16
s_waitcnt lgkmcnt(4)
v_smfmac_f32_16x16x64_bf16 v[64:67], v[204:207], v[152:159], v16
s_waitcnt lgkmcnt(3)
v_smfmac_f32_16x16x64_bf16 v[64:67], v[208:211], v[160:167], v16
s_waitcnt lgkmcnt(2)
v_smfmac_f32_16x16x64_bf16 v[64:67], v[212:215], v[168:175], v16
s_waitcnt lgkmcnt(1)
v_smfmac_f32_16x16x64_bf16 v[64:67], v[216:219], v[176:183], v16
s_waitcnt lgkmcnt(0)
v_smfmac_f32_16x16x64_bf16 v[64:67], v[220:223], v[184:191], v16
s_nop 7
v_add_f32 v66, v66, v67
v_add_f32 v64, v64, v65
v_mul_f32 v18, v64, v17
v_mul_f32_dpp v18, v66, v17 row_ror:8 row_mask:0xf bank_mask:0xc
v_exp_f32 v18, v18
v_mov_b32_dpp v66, v64 row_ror:8 row_mask:0xf bank_mask:0x3
v_add_f32 v18, 1.0, v18
v_rcp_f32 v18, v18
s_nop 0
v_mul_f32 v18, v18, v66
v_cvt_pk_bf16_f32 v18, v18, v18
ds_write_b16 v9, v18 offset:3584
s_waitcnt lgkmcnt(0)
s_barrier
s_endpgm
L_bar_fin:
s_waitcnt vmcnt(0)
ds_read_b64_tr_b16 v[96:97], v68 offset:0
ds_read_b64_tr_b16 v[98:99], v68 offset:4096
ds_read_b64_tr_b16 v[100:101], v69 offset:0
ds_read_b64_tr_b16 v[102:103], v69 offset:4096
ds_read_b64_tr_b16 v[104:105], v70 offset:0
ds_read_b64_tr_b16 v[106:107], v70 offset:4096
ds_read_b64_tr_b16 v[108:109], v71 offset:0
ds_read_b64_tr_b16 v[110:111], v71 offset:4096
ds_read_b64_tr_b16 v[112:113], v72 offset:0
ds_read_b64_tr_b16 v[114:115], v72 offset:4096
ds_read_b64_tr_b16 v[116:117], v73 offset:0
s_waitcnt lgkmcnt(4)
ds_read_b64_tr_b16 v[118:119], v73 offset:4096
ds_read_b64_tr_b16 v[120:121], v74 offset:0
ds_read_b64_tr_b16 v[122:123], v74 offset:4096
ds_read_b64_tr_b16 v[124:125], v75 offset:0
ds_read_b64_tr_b16 v[126:127], v75 offset:4096
s_waitcnt lgkmcnt(0)
s_barrier
ds_read_b128 v[48:51], v10 offset:3584
s_waitcnt lgkmcnt(0)
v_mfma_f32_16x16x32_bf16 v[192:195], v[48:51], v[96:99], 0
v_mfma_f32_16x16x32_bf16 v[196:199], v[48:51], v[100:103], 0
v_mfma_f32_16x16x32_bf16 v[200:203], v[48:51], v[104:107], 0
s_nop 1
v_mfma_f32_16x16x32_bf16 v[204:207], v[48:51], v[108:111], 0
s_nop 1
v_mfma_f32_16x16x32_bf16 v[208:211], v[48:51], v[112:115], 0
s_nop 0
v_cvt_pk_bf16_f32 v16, v192, v196
v_mfma_f32_16x16x32_bf16 v[212:215], v[48:51], v[116:119], 0
v_cvt_pk_bf16_f32 v20, v193, v197
v_mfma_f32_16x16x32_bf16 v[216:219], v[48:51], v[120:123], 0
v_cvt_pk_bf16_f32 v17, v200, v204
v_cvt_pk_bf16_f32 v21, v201, v205
v_mfma_f32_16x16x32_bf16 v[220:223], v[48:51], v[124:127], 0
s_nop 2
v_cvt_pk_bf16_f32 v18, v208, v212
v_cvt_pk_bf16_f32 v22, v209, v213
s_nop 2
v_cvt_pk_bf16_f32 v19, v216, v220
buffer_store_dwordx4 v[16:19], v11, s[36:39], s69 offen sc1
v_cvt_pk_bf16_f32 v23, v217, v221
buffer_store_dwordx4 v[20:23], v11, s[36:39], s72 offen sc1
s_endpgm
s_endpgm
L_srest:
s_lshr_b32 s32, s2, 5
s_and_b32 s33, s2, 31
s_and_b32 s67, s2, 7
s_lshr_b32 s68, s2, 3
s_sub_u32 s68, s68, 26
s_min_u32 s74, s67, 3
s_mul_i32 s66, s67, 5
s_add_u32 s74, s74, s66
s_add_u32 s74, s74, s68
s_cmp_lt_u32 s67, 3
s_cselect_b32 s66, 6, 5
s_cmp_lt_u32 s68, s66
s_cselect_b32 s74, s74, -1
s_cmp_lt_u32 s2, 48
s_cselect_b32 s66, 2, 3
s_cselect_b32 s72, 14+26, 42+26
s_cmp_lt_u32 s2, 16
s_cselect_b32 s66, 1, s66
s_cselect_b32 s72, 26, s72
s_lshl_b32 s66, s67, s66
s_add_u32 s72, s72, s66
s_add_u32 s72, s72, s68
s_mov_b32 s36, s30
s_mov_b32 s37, s31
s_mov_b32 s38, 0x1d0000
s_mov_b32 s39, 0x20000
s_mov_b32 s52, s28
s_mov_b32 s53, s29
s_mov_b32 s54, 0x100
s_mov_b32 s55, 0x20000
s_mov_b32 s46, 0x40000
s_mov_b32 s47, 0x20000
s_cmp_eq_u32 s74, -1
s_mov_b32 s69, 30
s_cselect_b32 s69, 20, s69
s_cmp_lt_u32 s2, 144
s_cselect_b32 s69, 0, s69
s_cmp_lt_u32 s2, 112
s_cselect_b32 s69, 50, s69
s_cmp_lt_u32 s2, 48
s_cselect_b32 s69, 30, s69
s_cmp_lt_u32 s2, 16
s_cselect_b32 s69, 40, s69
s_and_b32 s66, s72, 7
s_cmp_eq_u32 s66, 3
s_cselect_b32 s66, 40, 0
s_cmp_lt_u32 s2, 112
s_cselect_b32 s66, s66, 0
s_add_u32 s69, s69, s66
s_xor_b32 s64, s65, 1024
s_cmpk_gt_u32 s69, 4
s_cbranch_scc1 L_d_1
s_waitcnt vmcnt(3)
L_d_1:
buffer_load_dwordx4 v[24:27], v1, s[40:43], s64 offen nt
s_xor_b32 s64, s65, 66560
s_cmpk_gt_u32 s69, 5
s_cbranch_scc1 L_d_2
s_waitcnt vmcnt(3)
L_d_2:
buffer_load_dwordx4 v[28:31], v1, s[40:43], s64 offen nt
s_xor_b32 s64, s65, 3072
s_cmpk_gt_u32 s69, 6
s_cbranch_scc1 L_d_3
s_waitcnt vmcnt(3)
L_d_3:
buffer_load_dwordx4 v[32:35], v1, s[40:43], s64 offen nt
s_xor_b32 s64, s65, 68608
s_cmpk_gt_u32 s69, 7
s_waitcnt vmcnt(6)
s_cbranch_scc1 L_d_4
s_waitcnt vmcnt(3)
L_d_4:
buffer_load_dwordx4 v[36:39], v1, s[40:43], s64 offen nt
s_xor_b32 s64, s65, 32768
s_cmpk_gt_u32 s69, 8
s_waitcnt vmcnt(6)
s_cbranch_scc1 L_d_5
s_waitcnt vmcnt(3)
L_d_5:
buffer_load_dwordx4 v[40:43], v1, s[40:43], s64 offen nt
s_xor_b32 s64, s65, 98304
s_cmpk_gt_u32 s69, 9
s_waitcnt vmcnt(6)
s_cbranch_scc1 L_d_6
s_waitcnt vmcnt(3)
L_d_6:
buffer_load_dwordx4 v[44:47], v1, s[40:43], s64 offen nt
s_xor_b32 s64, s65, 34816
s_cmpk_gt_u32 s69, 10
s_waitcnt vmcnt(6)
s_cbranch_scc1 L_d_7
s_waitcnt vmcnt(3)
L_d_7:
buffer_load_dwordx4 v[48:51], v1, s[40:43], s64 offen nt
s_xor_b32 s64, s65, 100352
s_cmpk_gt_u32 s69, 11
s_waitcnt vmcnt(6)
s_cbranch_scc1 L_d_8
s_waitcnt vmcnt(3)
L_d_8:
buffer_load_dwordx4 v[52:55], v1, s[40:43], s64 offen nt
s_xor_b32 s64, s65, 33792
s_cmpk_gt_u32 s69, 12
s_waitcnt vmcnt(6)
s_cbranch_scc1 L_d_9
s_waitcnt vmcnt(3)
L_d_9:
buffer_load_dwordx4 v[56:59], v1, s[40:43], s64 offen nt
s_xor_b32 s64, s65, 99328
s_cmpk_gt_u32 s69, 13
s_waitcnt vmcnt(6)
s_cbranch_scc1 L_d_10
s_waitcnt vmcnt(3)
L_d_10:
buffer_load_dwordx4 v[60:63], v1, s[40:43], s64 offen nt
s_xor_b32 s64, s65, 35840
s_cmpk_gt_u32 s69, 14
s_waitcnt vmcnt(6)
s_cbranch_scc1 L_d_11
s_waitcnt vmcnt(3)
L_d_11:
buffer_load_dwordx4 v[64:67], v1, s[40:43], s64 offen nt
s_xor_b32 s64, s65, 101376
s_cmpk_gt_u32 s69, 15
s_waitcnt vmcnt(6)
s_cbranch_scc1 L_d_12
s_waitcnt vmcnt(3)
L_d_12:
buffer_load_dwordx4 v[68:71], v1, s[40:43], s64 offen nt
s_xor_b32 s64, s65, 131072
s_cmpk_gt_u32 s69, 16
s_waitcnt vmcnt(6)
s_cbranch_scc1 L_d_13
s_waitcnt vmcnt(3)
L_d_13:
buffer_load_dwordx4 v[72:75], v1, s[40:43], s64 offen nt
s_xor_b32 s64, s65, 196608
s_cmpk_gt_u32 s69, 17
s_waitcnt vmcnt(6)
s_cbranch_scc1 L_d_14
s_waitcnt vmcnt(3)
L_d_14:
buffer_load_dwordx4 v[76:79], v1, s[40:43], s64 offen nt
s_xor_b32 s64, s65, 133120
s_cmpk_gt_u32 s69, 18
s_waitcnt vmcnt(6)
s_cbranch_scc1 L_d_15
s_waitcnt vmcnt(3)
L_d_15:
buffer_load_dwordx4 v[80:83], v1, s[40:43], s64 offen nt
s_xor_b32 s64, s65, 198656
s_cmpk_gt_u32 s69, 19
s_waitcnt vmcnt(6)
s_cbranch_scc1 L_d_16
s_waitcnt vmcnt(3)
L_d_16:
buffer_load_dwordx4 v[84:87], v1, s[40:43], s64 offen nt
s_xor_b32 s64, s65, 132096
s_cmpk_gt_u32 s69, 20
s_waitcnt vmcnt(6)
s_cbranch_scc1 L_d_17
s_waitcnt vmcnt(4)
L_d_17:
buffer_load_dwordx4 v[88:91], v1, s[40:43], s64 offen nt
s_xor_b32 s64, s65, 197632
s_cmpk_gt_u32 s69, 21
s_waitcnt vmcnt(6)
s_cbranch_scc1 L_d_18
s_waitcnt vmcnt(4)
L_d_18:
buffer_load_dwordx4 v[92:95], v1, s[40:43], s64 offen nt
s_xor_b32 s64, s65, 134144
s_cmpk_gt_u32 s69, 22
s_waitcnt vmcnt(6)
s_cbranch_scc1 L_d_19
s_waitcnt vmcnt(4)
L_d_19:
buffer_load_dwordx4 v[96:99], v1, s[40:43], s64 offen nt
s_xor_b32 s64, s65, 199680
s_cmpk_gt_u32 s69, 23
s_waitcnt vmcnt(6)
s_cbranch_scc1 L_d_20
s_waitcnt vmcnt(4)
L_d_20:
buffer_load_dwordx4 v[100:103], v1, s[40:43], s64 offen nt
s_xor_b32 s64, s65, 163840
s_cmpk_gt_u32 s69, 24
s_waitcnt vmcnt(6)
s_cbranch_scc1 L_d_21
s_waitcnt vmcnt(4)
L_d_21:
buffer_load_dwordx4 v[104:107], v1, s[40:43], s64 offen nt
s_xor_b32 s64, s65, 229376
s_cmpk_gt_u32 s69, 25
s_waitcnt vmcnt(6)
s_cbranch_scc1 L_d_22
s_waitcnt vmcnt(4)
L_d_22:
buffer_load_dwordx4 v[108:111], v1, s[40:43], s64 offen nt
s_xor_b32 s64, s65, 165888
s_cmpk_gt_u32 s69, 26
s_waitcnt vmcnt(6)
s_cbranch_scc1 L_d_23
s_waitcnt vmcnt(4)
L_d_23:
buffer_load_dwordx4 v[112:115], v1, s[40:43], s64 offen nt
s_xor_b32 s64, s65, 231424
s_cmpk_gt_u32 s69, 27
s_waitcnt vmcnt(6)
s_cbranch_scc1 L_d_24
s_waitcnt vmcnt(4)
L_d_24:
buffer_load_dwordx4 v[116:119], v1, s[40:43], s64 offen nt
s_xor_b32 s64, s65, 164864
s_cmpk_gt_u32 s69, 28
s_waitcnt vmcnt(6)
s_cbranch_scc1 L_d_25
s_waitcnt vmcnt(4)
L_d_25:
buffer_load_dwordx4 v[120:123], v1, s[40:43], s64 offen nt
s_xor_b32 s64, s65, 230400
s_cmpk_gt_u32 s69, 29
s_waitcnt vmcnt(6)
s_cbranch_scc1 L_d_26
s_waitcnt vmcnt(4)
L_d_26:
buffer_load_dwordx4 v[124:127], v1, s[40:43], s64 offen nt
s_xor_b32 s64, s65, 166912
s_cmpk_gt_u32 s69, 30
s_waitcnt vmcnt(6)
s_cbranch_scc1 L_d_27
s_waitcnt vmcnt(4)
L_d_27:
buffer_load_dwordx4 v[128:131], v1, s[40:43], s64 offen nt
s_xor_b32 s64, s65, 232448
s_cmpk_gt_u32 s69, 31
s_waitcnt vmcnt(6)
s_cbranch_scc1 L_d_28
s_waitcnt vmcnt(4)
L_d_28:
buffer_load_dwordx4 v[132:135], v1, s[40:43], s64 offen nt
s_xor_b32 s64, s65, 4096
s_cmpk_gt_u32 s69, 32
s_waitcnt vmcnt(6)
s_cbranch_scc1 L_d_29
s_waitcnt vmcnt(4)
L_d_29:
buffer_load_dwordx4 v[136:139], v1, s[40:43], s64 offen nt
s_xor_b32 s64, s65, 69632
s_cmpk_gt_u32 s69, 33
s_waitcnt vmcnt(6)
s_cbranch_scc1 L_d_30
s_waitcnt vmcnt(4)
L_d_30:
buffer_load_dwordx4 v[140:143], v1, s[40:43], s64 offen nt
s_xor_b32 s64, s65, 6144
s_cmpk_gt_u32 s69, 34
s_waitcnt vmcnt(6)
s_cbranch_scc1 L_d_31
s_waitcnt vmcnt(4)
L_d_31:
buffer_load_dwordx4 v[144:147], v1, s[40:43], s64 offen nt
s_xor_b32 s64, s65, 71680
s_cmpk_gt_u32 s69, 35
s_waitcnt vmcnt(6)
s_cbranch_scc1 L_d_32
s_waitcnt vmcnt(4)
L_d_32:
buffer_load_dwordx4 v[148:151], v1, s[40:43], s64 offen nt
s_xor_b32 s64, s65, 5120
s_cmpk_gt_u32 s69, 36
s_waitcnt vmcnt(6)
s_cbranch_scc1 L_d_33
s_waitcnt vmcnt(4)
L_d_33:
buffer_load_dwordx4 v[152:155], v1, s[40:43], s64 offen nt
s_xor_b32 s64, s65, 70656
s_cmpk_gt_u32 s69, 37
s_waitcnt vmcnt(6)
s_cbranch_scc1 L_d_34
s_waitcnt vmcnt(4)
L_d_34:
buffer_load_dwordx4 v[156:159], v1, s[40:43], s64 offen nt
s_xor_b32 s64, s65, 7168
s_cmpk_gt_u32 s69, 38
s_waitcnt vmcnt(6)
s_cbranch_scc1 L_d_35
s_waitcnt vmcnt(4)
L_d_35:
buffer_load_dwordx4 v[160:163], v1, s[40:43], s64 offen nt
s_xor_b32 s64, s65, 72704
s_cmpk_gt_u32 s69, 39
s_waitcnt vmcnt(6)
s_cbranch_scc1 L_d_36
s_waitcnt vmcnt(4)
L_d_36:
buffer_load_dwordx4 v[164:167], v1, s[40:43], s64 offen nt
s_xor_b32 s64, s65, 36864
s_cmpk_gt_u32 s69, 40
s_waitcnt vmcnt(6)
s_cbranch_scc1 L_d_37
s_waitcnt vmcnt(4)
L_d_37:
buffer_load_dwordx4 v[168:171], v1, s[40:43], s64 offen nt
s_xor_b32 s64, s65, 102400
s_cmpk_gt_u32 s69, 41
s_waitcnt vmcnt(6)
s_cbranch_scc1 L_d_38
s_waitcnt vmcnt(4)
L_d_38:
buffer_load_dwordx4 v[172:175], v1, s[40:43], s64 offen nt
s_xor_b32 s64, s65, 38912
s_cmpk_gt_u32 s69, 42
s_waitcnt vmcnt(6)
s_cbranch_scc1 L_d_39
s_waitcnt vmcnt(4)
L_d_39:
buffer_load_dwordx4 v[176:179], v1, s[40:43], s64 offen nt
s_xor_b32 s64, s65, 104448
s_cmpk_gt_u32 s69, 43
s_waitcnt vmcnt(6)
s_cbranch_scc1 L_d_40
s_waitcnt vmcnt(4)
L_d_40:
buffer_load_dwordx4 v[180:183], v1, s[40:43], s64 offen nt
s_xor_b32 s64, s65, 37888
s_cmpk_gt_u32 s69, 44
s_waitcnt vmcnt(6)
s_cbranch_scc1 L_d_41
s_waitcnt vmcnt(4)
L_d_41:
buffer_load_dwordx4 v[184:187], v1, s[40:43], s64 offen nt
s_xor_b32 s64, s65, 103424
s_cmpk_gt_u32 s69, 45
s_waitcnt vmcnt(6)
s_cbranch_scc1 L_d_42
s_waitcnt vmcnt(4)
L_d_42:
buffer_load_dwordx4 v[188:191], v1, s[40:43], s64 offen nt
s_xor_b32 s64, s65, 39936
s_cmpk_gt_u32 s69, 46
s_waitcnt vmcnt(6)
s_cbranch_scc1 L_d_43
s_waitcnt vmcnt(4)
L_d_43:
buffer_load_dwordx4 v[192:195], v1, s[40:43], s64 offen nt
s_xor_b32 s64, s65, 105472
s_cmpk_gt_u32 s69, 47
s_waitcnt vmcnt(6)
s_cbranch_scc1 L_d_44
s_waitcnt vmcnt(4)
L_d_44:
buffer_load_dwordx4 v[196:199], v1, s[40:43], s64 offen nt
s_xor_b32 s64, s65, 135168
s_cmpk_gt_u32 s69, 48
s_waitcnt vmcnt(6)
s_cbranch_scc1 L_d_45
s_waitcnt vmcnt(4)
L_d_45:
buffer_load_dwordx4 v[200:203], v1, s[40:43], s64 offen nt
s_xor_b32 s64, s65, 200704
s_cmpk_gt_u32 s69, 49
s_waitcnt vmcnt(6)
s_cbranch_scc1 L_d_46
s_waitcnt vmcnt(4)
L_d_46:
buffer_load_dwordx4 v[204:207], v1, s[40:43], s64 offen nt
s_xor_b32 s64, s65, 137216
s_cmpk_gt_u32 s69, 50
s_waitcnt vmcnt(6)
s_cbranch_scc1 L_d_47
s_waitcnt vmcnt(4)
L_d_47:
buffer_load_dwordx4 v[208:211], v1, s[40:43], s64 offen nt
s_xor_b32 s64, s65, 202752
s_cmpk_gt_u32 s69, 51
s_waitcnt vmcnt(6)
s_cbranch_scc1 L_d_48
s_waitcnt vmcnt(4)
L_d_48:
buffer_load_dwordx4 v[212:215], v1, s[40:43], s64 offen nt
s_xor_b32 s64, s65, 136192
s_cmpk_gt_u32 s69, 52
s_waitcnt vmcnt(6)
s_cbranch_scc1 L_d_49
s_waitcnt vmcnt(4)
L_d_49:
buffer_load_dwordx4 v[216:219], v1, s[40:43], s64 offen nt
s_xor_b32 s64, s65, 201728
s_cmpk_gt_u32 s69, 53
s_waitcnt vmcnt(6)
s_cbranch_scc1 L_d_50
s_waitcnt vmcnt(4)
L_d_50:
buffer_load_dwordx4 v[220:223], v1, s[40:43], s64 offen nt
s_xor_b32 s64, s65, 138240
s_cmpk_gt_u32 s69, 54
s_waitcnt vmcnt(6)
s_cbranch_scc1 L_d_51
s_waitcnt vmcnt(4)
L_d_51:
buffer_load_dwordx4 v[224:227], v1, s[40:43], s64 offen nt
s_xor_b32 s64, s65, 203776
s_cmpk_gt_u32 s69, 55
s_waitcnt vmcnt(6)
s_cbranch_scc1 L_d_52
s_waitcnt vmcnt(4)
L_d_52:
buffer_load_dwordx4 v[228:231], v1, s[40:43], s64 offen nt
s_cmp_eq_u32 s74, -1
s_mov_b32 s69, 80
s_cselect_b32 s69, 0, s69
s_cmp_lt_u32 s2, 144
s_cselect_b32 s69, 80, s69
s_cmp_lt_u32 s2, 112
s_cselect_b32 s69, 112, s69
s_cmp_lt_u32 s2, 48
s_cselect_b32 s69, 0, s69
s_cmp_lt_u32 s2, 16
s_cselect_b32 s69, 112, s69
s_xor_b32 s64, s65, 167936
s_cmpk_gt_u32 s69, 56
s_waitcnt vmcnt(6)
s_cbranch_scc1 L_d_53
s_waitcnt vmcnt(4)
L_d_53:
buffer_load_dwordx4 v[232:235], v1, s[40:43], s64 offen nt
s_xor_b32 s64, s65, 233472
s_cmpk_gt_u32 s69, 57
s_waitcnt vmcnt(6)
s_cbranch_scc1 L_d_54
s_waitcnt vmcnt(4)
L_d_54:
buffer_load_dwordx4 v[236:239], v1, s[40:43], s64 offen nt
s_xor_b32 s64, s65, 169984
s_cmpk_gt_u32 s69, 58
s_waitcnt vmcnt(6)
s_cbranch_scc1 L_d_55
s_waitcnt vmcnt(4)
L_d_55:
buffer_load_dwordx4 v[240:243], v1, s[40:43], s64 offen nt
v_and_b32 v2, 31, v0
v_lshlrev_b32 v2, 2, v2
buffer_load_dword v3, v2, s[52:55], 0 offen offset:128
s_xor_b32 s64, s65, 235520
s_cmpk_gt_u32 s69, 59
s_waitcnt vmcnt(6)
s_cbranch_scc1 L_d_56
s_waitcnt vmcnt(4)
L_d_56:
buffer_load_dwordx4 v[244:247], v1, s[40:43], s64 offen nt
s_xor_b32 s64, s65, 168960
s_cmpk_gt_u32 s69, 60
s_waitcnt vmcnt(6)
s_cbranch_scc1 L_d_57
s_waitcnt vmcnt(4)
L_d_57:
buffer_load_dwordx4 v[248:251], v1, s[40:43], s64 offen nt
s_xor_b32 s64, s65, 234496
s_cmpk_gt_u32 s69, 61
s_waitcnt vmcnt(6)
s_cbranch_scc1 L_d_58
s_waitcnt vmcnt(4)
L_d_58:
buffer_load_dwordx4 v[252:255], v1, s[40:43], s64 offen nt
s_mul_i32 s70, s34, 15360
s_add_u32 s70, s70, 69632
s_add_u32 m0, s70, 0
s_xor_b32 s64, s65, 171008
s_cmpk_gt_u32 s69, 62
s_waitcnt vmcnt(6)
s_cbranch_scc1 L_d_59
s_waitcnt vmcnt(4)
L_d_59:
buffer_load_dwordx4 v1, s[40:43], s64 offen nt lds
s_add_u32 m0, s70, 1024
s_xor_b32 s64, s65, 236544
s_cmpk_gt_u32 s69, 63
s_waitcnt vmcnt(6)
s_cbranch_scc1 L_d_60
s_waitcnt vmcnt(4)
L_d_60:
buffer_load_dwordx4 v1, s[40:43], s64 offen nt lds
s_add_u32 m0, s70, 2048
s_xor_b32 s64, s65, 0
s_cmpk_gt_u32 s69, 64
s_waitcnt vmcnt(6)
s_cbranch_scc1 L_d_61
s_waitcnt vmcnt(4)
L_d_61:
buffer_load_dwordx4 v1, s[44:47], s64 offen nt lds
s_add_u32 m0, s70, 3072
s_xor_b32 s64, s65, 65536
s_cmpk_gt_u32 s69, 65
s_waitcnt vmcnt(6)
s_cbranch_scc1 L_d_62
s_waitcnt vmcnt(4)
L_d_62:
buffer_load_dwordx4 v1, s[44:47], s64 offen nt lds
s_add_u32 m0, s70, 4096
s_xor_b32 s64, s65, 2048
s_cmpk_gt_u32 s69, 66
s_waitcnt vmcnt(6)
s_cbranch_scc1 L_d_63
s_waitcnt vmcnt(4)
L_d_63:
buffer_load_dwordx4 v1, s[44:47], s64 offen nt lds
s_add_u32 m0, s70, 5120
s_xor_b32 s64, s65, 67584
s_cmpk_gt_u32 s69, 67
s_waitcnt vmcnt(6)
s_cbranch_scc1 L_d_64
s_waitcnt vmcnt(4)
L_d_64:
buffer_load_dwordx4 v1, s[44:47], s64 offen nt lds
v_cmp_eq_u32 vcc, 0, v3
s_cbranch_vccz L_jf_66
s_mov_b32 s75, 0
L_poll_67:
v_and_b32 v2, 31, v0
v_lshlrev_b32 v2, 2, v2
buffer_load_dword v3, v2, s[52:55], 0 offen offset:128 sc1
s_waitcnt vmcnt(0)
v_cmp_eq_u32 vcc, 0, v3
s_cbranch_vccz L_pollx_68
s_sleep 40
s_add_u32 s75, s75, 1
s_cmp_lt_u32 s75, 0x100000
s_cbranch_scc1 L_poll_67
L_pollx_68:
L_jf_66:
s_mul_i32 s68, s32, 12288
s_lshl_b32 s67, s33, 8
s_add_u32 s68, s68, s67
s_add_u32 s68, s68, 16384
v_and_b32 v2, 0xf0, v1
buffer_load_dwordx4 v[4:7], v2, s[36:39], s68 offen sc1
s_add_u32 m0, s70, 6144
s_xor_b32 s64, s65, 1024
s_cmpk_gt_u32 s69, 68
s_waitcnt vmcnt(6)
s_cbranch_scc1 L_d_65
s_waitcnt vmcnt(4)
L_d_65:
buffer_load_dwordx4 v1, s[44:47], s64 offen nt lds
s_add_u32 m0, s70, 7168
s_xor_b32 s64, s65, 66560
s_cmpk_gt_u32 s69, 69
s_waitcnt vmcnt(6)
s_cbranch_scc1 L_d_69
s_waitcnt vmcnt(4)
L_d_69:
buffer_load_dwordx4 v1, s[44:47], s64 offen nt lds
s_add_u32 m0, s70, 8192
s_xor_b32 s64, s65, 3072
s_cmpk_gt_u32 s69, 70
s_waitcnt vmcnt(6)
s_cbranch_scc1 L_d_70
s_waitcnt vmcnt(4)
L_d_70:
buffer_load_dwordx4 v1, s[44:47], s64 offen nt lds
s_add_u32 m0, s70, 9216
s_xor_b32 s64, s65, 68608
s_cmpk_gt_u32 s69, 71
s_waitcnt vmcnt(6)
s_cbranch_scc1 L_d_71
s_waitcnt vmcnt(4)
L_d_71:
buffer_load_dwordx4 v1, s[44:47], s64 offen nt lds
s_add_u32 m0, s70, 10240
s_xor_b32 s64, s65, 32768
s_cmpk_gt_u32 s69, 72
s_waitcnt vmcnt(6)
s_cbranch_scc1 L_d_72
s_waitcnt vmcnt(4)
L_d_72:
buffer_load_dwordx4 v1, s[44:47], s64 offen nt lds
s_add_u32 m0, s70, 11264
s_xor_b32 s64, s65, 98304
s_cmpk_gt_u32 s69, 73
s_waitcnt vmcnt(6)
s_cbranch_scc1 L_d_73
s_waitcnt vmcnt(4)
L_d_73:
buffer_load_dwordx4 v1, s[44:47], s64 offen nt lds
s_add_u32 m0, s70, 12288
s_xor_b32 s64, s65, 34816
s_cmpk_gt_u32 s69, 74
s_waitcnt vmcnt(6)
s_cbranch_scc1 L_d_74
s_waitcnt vmcnt(4)
L_d_74:
buffer_load_dwordx4 v1, s[44:47], s64 offen nt lds
s_add_u32 m0, s70, 13312
s_xor_b32 s64, s65, 100352
s_cmpk_gt_u32 s69, 75
s_waitcnt vmcnt(6)
s_cbranch_scc1 L_d_75
s_waitcnt vmcnt(4)
L_d_75:
buffer_load_dwordx4 v1, s[44:47], s64 offen nt lds
s_add_u32 m0, s70, 14336
s_xor_b32 s64, s65, 33792
s_cmpk_gt_u32 s69, 76
s_waitcnt vmcnt(6)
s_cbranch_scc1 L_d_76
s_waitcnt vmcnt(4)
L_d_76:
buffer_load_dwordx4 v1, s[44:47], s64 offen nt lds
v_max3_u32 v3, v4, v5, v6
v_max_u32 v3, v3, v7
v_cmp_eq_u32 vcc, -1, v3
s_cbranch_vccz L_q_77
s_mov_b32 s75, 0
L_poll_78:
s_mul_i32 s68, s32, 12288
s_lshl_b32 s67, s33, 8
s_add_u32 s68, s68, s67
s_add_u32 s68, s68, 16384
v_and_b32 v2, 0xf0, v1
buffer_load_dwordx4 v[4:7], v2, s[36:39], s68 offen sc1
s_waitcnt vmcnt(0)
v_max3_u32 v3, v4, v5, v6
v_max_u32 v3, v3, v7
v_cmp_eq_u32 vcc, -1, v3
s_cbranch_vccz L_pollx_79
s_add_u32 s75, s75, 1
s_cmp_lt_u32 s75, 0x100000
s_cbranch_scc1 L_poll_78
L_pollx_79:
L_q_77:
s_mov_b32 s66, 0x3db504f3
v_dot2_f32_bf16 v8, v8, v4, 0
v_dot2_f32_bf16 v12, v12, v4, 0
v_dot2_f32_bf16 v16, v16, v4, 0
v_dot2_f32_bf16 v20, v20, v4, 0
v_dot2c_f32_bf16 v8, v9, v5
v_dot2c_f32_bf16 v12, v13, v5
v_dot2c_f32_bf16 v16, v17, v5
v_dot2c_f32_bf16 v20, v21, v5
v_dot2c_f32_bf16 v8, v10, v6
v_dot2c_f32_bf16 v12, v14, v6
v_dot2c_f32_bf16 v16, v18, v6
v_dot2c_f32_bf16 v20, v22, v6
v_dot2c_f32_bf16 v8, v11, v7
v_dot2c_f32_bf16 v12, v15, v7
v_dot2c_f32_bf16 v16, v19, v7
v_dot2c_f32_bf16 v20, v23, v7
v_add_f32_dpp v9, v8, v8 row_ror:8 row_mask:0xf bank_mask:0x3
v_add_f32_dpp v13, v12, v12 row_ror:8 row_mask:0xf bank_mask:0x3
v_add_f32_dpp v9, v16, v16 row_ror:8 row_mask:0xf bank_mask:0xc
v_add_f32_dpp v13, v20, v20 row_ror:8 row_mask:0xf bank_mask:0xc
s_nop 0
v_add_f32_dpp v17, v9, v9 row_shl:4 row_mask:0xf bank_mask:0x5
v_add_f32_dpp v17, v13, v13 row_shr:4 row_mask:0xf bank_mask:0xa
s_nop 1
v_add_f32_dpp v17, v17, v17 quad_perm:[1,0,3,2] row_mask:0xf bank_mask:0xf
s_nop 1
v_add_f32_dpp v17, v17, v17 quad_perm:[2,3,0,1] row_mask:0xf bank_mask:0xf
v_cvt_pk_bf16_f32 v17, 0, v17
v_mul_f32 v17, s66, v17
v_cvt_pk_bf16_f32 v17, 0, v17
v_dot2_f32_bf16 v24, v24, v4, 0
v_dot2_f32_bf16 v28, v28, v4, 0
v_dot2_f32_bf16 v32, v32, v4, 0
v_dot2_f32_bf16 v36, v36, v4, 0
v_dot2c_f32_bf16 v24, v25, v5
v_dot2c_f32_bf16 v28, v29, v5
v_dot2c_f32_bf16 v32, v33, v5
v_dot2c_f32_bf16 v36, v37, v5
v_dot2c_f32_bf16 v24, v26, v6
v_dot2c_f32_bf16 v28, v30, v6
v_dot2c_f32_bf16 v32, v34, v6
v_dot2c_f32_bf16 v36, v38, v6
v_dot2c_f32_bf16 v24, v27, v7
v_dot2c_f32_bf16 v28, v31, v7
v_dot2c_f32_bf16 v32, v35, v7
v_dot2c_f32_bf16 v36, v39, v7
v_add_f32_dpp v25, v24, v24 row_ror:8 row_mask:0xf bank_mask:0x3
v_add_f32_dpp v29, v28, v28 row_ror:8 row_mask:0xf bank_mask:0x3
v_add_f32_dpp v25, v32, v32 row_ror:8 row_mask:0xf bank_mask:0xc
v_add_f32_dpp v29, v36, v36 row_ror:8 row_mask:0xf bank_mask:0xc
s_nop 0
v_add_f32_dpp v8, v25, v25 row_shl:4 row_mask:0xf bank_mask:0x5
v_add_f32_dpp v8, v29, v29 row_shr:4 row_mask:0xf bank_mask:0xa
s_nop 1
v_add_f32_dpp v8, v8, v8 quad_perm:[1,0,3,2] row_mask:0xf bank_mask:0xf
s_nop 1
v_add_f32_dpp v8, v8, v8 quad_perm:[2,3,0,1] row_mask:0xf bank_mask:0xf
v_cvt_pk_bf16_f32 v8, 0, v8
v_mul_f32 v8, s66, v8
v_cvt_pk_bf16_f32 v8, 0, v8
s_xor_b32 s64, s65, 99328
s_cmpk_gt_u32 s69, 77
s_waitcnt vmcnt(6)
s_cbranch_scc1 L_d_80
s_waitcnt vmcnt(4)
L_d_80:
buffer_load_dwordx4 v[24:27], v1, s[44:47], s64 offen nt
v_dot2_f32_bf16 v40, v40, v4, 0
v_dot2_f32_bf16 v44, v44, v4, 0
v_dot2_f32_bf16 v48, v48, v4, 0
v_dot2_f32_bf16 v52, v52, v4, 0
v_dot2c_f32_bf16 v40, v41, v5
v_dot2c_f32_bf16 v44, v45, v5
v_dot2c_f32_bf16 v48, v49, v5
v_dot2c_f32_bf16 v52, v53, v5
v_dot2c_f32_bf16 v40, v42, v6
v_dot2c_f32_bf16 v44, v46, v6
v_dot2c_f32_bf16 v48, v50, v6
v_dot2c_f32_bf16 v52, v54, v6
v_dot2c_f32_bf16 v40, v43, v7
v_dot2c_f32_bf16 v44, v47, v7
v_dot2c_f32_bf16 v48, v51, v7
v_dot2c_f32_bf16 v52, v55, v7
v_add_f32_dpp v41, v40, v40 row_ror:8 row_mask:0xf bank_mask:0x3
v_add_f32_dpp v45, v44, v44 row_ror:8 row_mask:0xf bank_mask:0x3
v_add_f32_dpp v41, v48, v48 row_ror:8 row_mask:0xf bank_mask:0xc
v_add_f32_dpp v45, v52, v52 row_ror:8 row_mask:0xf bank_mask:0xc
s_nop 0
v_add_f32_dpp v9, v41, v41 row_shl:4 row_mask:0xf bank_mask:0x5
v_add_f32_dpp v9, v45, v45 row_shr:4 row_mask:0xf bank_mask:0xa
s_nop 1
v_add_f32_dpp v9, v9, v9 quad_perm:[1,0,3,2] row_mask:0xf bank_mask:0xf
s_nop 1
v_add_f32_dpp v9, v9, v9 quad_perm:[2,3,0,1] row_mask:0xf bank_mask:0xf
v_cvt_pk_bf16_f32 v9, 0, v9
v_mul_f32 v9, s66, v9
v_cvt_pk_bf16_f32 v9, 0, v9
s_and_b32 s62, s2, 7
s_lshl_b32 s62, s62, 9
s_add_u32 s62, s62, 1327104
s_lshr_b32 s63, s2, 3
s_lshl_b32 s63, s63, 2
s_add_u32 s63, s63, s62
s_cmp_eq_u32 s34, 0
s_cbranch_scc0 L_w_82
v_mov_b32 v2, 14
s_mov_b64 exec, 1
buffer_store_dword v2, off, s[36:39], s63 offset:0
s_mov_b64 exec, -1
L_w_82:
s_xor_b32 s64, s65, 35840
s_cmpk_gt_u32 s69, 78
s_waitcnt vmcnt(6)
s_cbranch_scc1 L_d_81
s_waitcnt vmcnt(4)
L_d_81:
buffer_load_dwordx4 v[28:31], v1, s[44:47], s64 offen nt
v_dot2_f32_bf16 v56, v56, v4, 0
v_dot2_f32_bf16 v60, v60, v4, 0
v_dot2_f32_bf16 v64, v64, v4, 0
v_dot2_f32_bf16 v68, v68, v4, 0
v_dot2c_f32_bf16 v56, v57, v5
v_dot2c_f32_bf16 v60, v61, v5
v_dot2c_f32_bf16 v64, v65, v5
v_dot2c_f32_bf16 v68, v69, v5
v_dot2c_f32_bf16 v56, v58, v6
v_dot2c_f32_bf16 v60, v62, v6
v_dot2c_f32_bf16 v64, v66, v6
v_dot2c_f32_bf16 v68, v70, v6
v_dot2c_f32_bf16 v56, v59, v7
v_dot2c_f32_bf16 v60, v63, v7
v_dot2c_f32_bf16 v64, v67, v7
v_dot2c_f32_bf16 v68, v71, v7
v_add_f32_dpp v57, v56, v56 row_ror:8 row_mask:0xf bank_mask:0x3
v_add_f32_dpp v61, v60, v60 row_ror:8 row_mask:0xf bank_mask:0x3
v_add_f32_dpp v57, v64, v64 row_ror:8 row_mask:0xf bank_mask:0xc
v_add_f32_dpp v61, v68, v68 row_ror:8 row_mask:0xf bank_mask:0xc
s_nop 0
v_add_f32_dpp v10, v57, v57 row_shl:4 row_mask:0xf bank_mask:0x5
v_add_f32_dpp v10, v61, v61 row_shr:4 row_mask:0xf bank_mask:0xa
s_nop 1
v_add_f32_dpp v10, v10, v10 quad_perm:[1,0,3,2] row_mask:0xf bank_mask:0xf
s_nop 1
v_add_f32_dpp v10, v10, v10 quad_perm:[2,3,0,1] row_mask:0xf bank_mask:0xf
v_cvt_pk_bf16_f32 v10, 0, v10
v_mul_f32 v10, s66, v10
v_cvt_pk_bf16_f32 v10, 0, v10
s_xor_b32 s64, s65, 101376
s_cmpk_gt_u32 s69, 79
s_waitcnt vmcnt(6)
s_cbranch_scc1 L_d_83
s_waitcnt vmcnt(4)
L_d_83:
buffer_load_dwordx4 v[32:35], v1, s[44:47], s64 offen nt
v_dot2_f32_bf16 v72, v72, v4, 0
v_dot2_f32_bf16 v76, v76, v4, 0
v_dot2_f32_bf16 v80, v80, v4, 0
v_dot2_f32_bf16 v84, v84, v4, 0
v_dot2c_f32_bf16 v72, v73, v5
v_dot2c_f32_bf16 v76, v77, v5
v_dot2c_f32_bf16 v80, v81, v5
v_dot2c_f32_bf16 v84, v85, v5
v_dot2c_f32_bf16 v72, v74, v6
v_dot2c_f32_bf16 v76, v78, v6
v_dot2c_f32_bf16 v80, v82, v6
v_dot2c_f32_bf16 v84, v86, v6
v_dot2c_f32_bf16 v72, v75, v7
v_dot2c_f32_bf16 v76, v79, v7
v_dot2c_f32_bf16 v80, v83, v7
v_dot2c_f32_bf16 v84, v87, v7
v_add_f32_dpp v73, v72, v72 row_ror:8 row_mask:0xf bank_mask:0x3
v_add_f32_dpp v77, v76, v76 row_ror:8 row_mask:0xf bank_mask:0x3
v_add_f32_dpp v73, v80, v80 row_ror:8 row_mask:0xf bank_mask:0xc
v_add_f32_dpp v77, v84, v84 row_ror:8 row_mask:0xf bank_mask:0xc
s_nop 0
v_add_f32_dpp v11, v73, v73 row_shl:4 row_mask:0xf bank_mask:0x5
v_add_f32_dpp v11, v77, v77 row_shr:4 row_mask:0xf bank_mask:0xa
s_nop 1
v_add_f32_dpp v11, v11, v11 quad_perm:[1,0,3,2] row_mask:0xf bank_mask:0xf
s_nop 1
v_add_f32_dpp v11, v11, v11 quad_perm:[2,3,0,1] row_mask:0xf bank_mask:0xf
v_cvt_pk_bf16_f32 v11, 0, v11
v_mul_f32 v11, s66, v11
v_cvt_pk_bf16_f32 v11, 0, v11
s_xor_b32 s64, s65, 131072
s_cmpk_gt_u32 s69, 80
s_waitcnt vmcnt(6)
s_cbranch_scc1 L_d_84
s_waitcnt vmcnt(4)
L_d_84:
buffer_load_dwordx4 v[36:39], v1, s[44:47], s64 offen nt
v_dot2_f32_bf16 v88, v88, v4, 0
v_dot2_f32_bf16 v92, v92, v4, 0
v_dot2_f32_bf16 v96, v96, v4, 0
v_dot2_f32_bf16 v100, v100, v4, 0
v_dot2c_f32_bf16 v88, v89, v5
v_dot2c_f32_bf16 v92, v93, v5
v_dot2c_f32_bf16 v96, v97, v5
v_dot2c_f32_bf16 v100, v101, v5
v_dot2c_f32_bf16 v88, v90, v6
v_dot2c_f32_bf16 v92, v94, v6
v_dot2c_f32_bf16 v96, v98, v6
v_dot2c_f32_bf16 v100, v102, v6
v_dot2c_f32_bf16 v88, v91, v7
v_dot2c_f32_bf16 v92, v95, v7
v_dot2c_f32_bf16 v96, v99, v7
v_dot2c_f32_bf16 v100, v103, v7
v_add_f32_dpp v89, v88, v88 row_ror:8 row_mask:0xf bank_mask:0x3
v_add_f32_dpp v93, v92, v92 row_ror:8 row_mask:0xf bank_mask:0x3
v_add_f32_dpp v89, v96, v96 row_ror:8 row_mask:0xf bank_mask:0xc
v_add_f32_dpp v93, v100, v100 row_ror:8 row_mask:0xf bank_mask:0xc
s_nop 0
v_add_f32_dpp v12, v89, v89 row_shl:4 row_mask:0xf bank_mask:0x5
v_add_f32_dpp v12, v93, v93 row_shr:4 row_mask:0xf bank_mask:0xa
s_nop 1
v_add_f32_dpp v12, v12, v12 quad_perm:[1,0,3,2] row_mask:0xf bank_mask:0xf
s_nop 1
v_add_f32_dpp v12, v12, v12 quad_perm:[2,3,0,1] row_mask:0xf bank_mask:0xf
v_cvt_pk_bf16_f32 v12, 0, v12
v_mul_f32 v12, s66, v12
v_cvt_pk_bf16_f32 v12, 0, v12
s_xor_b32 s64, s65, 196608
s_cmpk_gt_u32 s69, 81
s_waitcnt vmcnt(6)
s_cbranch_scc1 L_d_85
s_waitcnt vmcnt(4)
L_d_85:
buffer_load_dwordx4 v[40:43], v1, s[44:47], s64 offen nt
v_dot2_f32_bf16 v104, v104, v4, 0
v_dot2_f32_bf16 v108, v108, v4, 0
v_dot2_f32_bf16 v112, v112, v4, 0
v_dot2_f32_bf16 v116, v116, v4, 0
v_dot2c_f32_bf16 v104, v105, v5
v_dot2c_f32_bf16 v108, v109, v5
v_dot2c_f32_bf16 v112, v113, v5
v_dot2c_f32_bf16 v116, v117, v5
v_dot2c_f32_bf16 v104, v106, v6
v_dot2c_f32_bf16 v108, v110, v6
v_dot2c_f32_bf16 v112, v114, v6
v_dot2c_f32_bf16 v116, v118, v6
v_dot2c_f32_bf16 v104, v107, v7
v_dot2c_f32_bf16 v108, v111, v7
v_dot2c_f32_bf16 v112, v115, v7
v_dot2c_f32_bf16 v116, v119, v7
v_add_f32_dpp v105, v104, v104 row_ror:8 row_mask:0xf bank_mask:0x3
v_add_f32_dpp v109, v108, v108 row_ror:8 row_mask:0xf bank_mask:0x3
v_add_f32_dpp v105, v112, v112 row_ror:8 row_mask:0xf bank_mask:0xc
v_add_f32_dpp v109, v116, v116 row_ror:8 row_mask:0xf bank_mask:0xc
s_nop 0
v_add_f32_dpp v13, v105, v105 row_shl:4 row_mask:0xf bank_mask:0x5
v_add_f32_dpp v13, v109, v109 row_shr:4 row_mask:0xf bank_mask:0xa
s_nop 1
v_add_f32_dpp v13, v13, v13 quad_perm:[1,0,3,2] row_mask:0xf bank_mask:0xf
s_nop 1
v_add_f32_dpp v13, v13, v13 quad_perm:[2,3,0,1] row_mask:0xf bank_mask:0xf
v_cvt_pk_bf16_f32 v13, 0, v13
v_mul_f32 v13, s66, v13
v_cvt_pk_bf16_f32 v13, 0, v13
s_xor_b32 s64, s65, 133120
s_cmpk_gt_u32 s69, 82
s_waitcnt vmcnt(6)
s_cbranch_scc1 L_d_86
s_waitcnt vmcnt(4)
L_d_86:
buffer_load_dwordx4 v[44:47], v1, s[44:47], s64 offen nt
v_dot2_f32_bf16 v120, v120, v4, 0
v_dot2_f32_bf16 v124, v124, v4, 0
v_dot2_f32_bf16 v128, v128, v4, 0
v_dot2_f32_bf16 v132, v132, v4, 0
v_dot2c_f32_bf16 v120, v121, v5
v_dot2c_f32_bf16 v124, v125, v5
v_dot2c_f32_bf16 v128, v129, v5
v_dot2c_f32_bf16 v132, v133, v5
v_dot2c_f32_bf16 v120, v122, v6
v_dot2c_f32_bf16 v124, v126, v6
v_dot2c_f32_bf16 v128, v130, v6
v_dot2c_f32_bf16 v132, v134, v6
v_dot2c_f32_bf16 v120, v123, v7
v_dot2c_f32_bf16 v124, v127, v7
v_dot2c_f32_bf16 v128, v131, v7
v_dot2c_f32_bf16 v132, v135, v7
v_add_f32_dpp v121, v120, v120 row_ror:8 row_mask:0xf bank_mask:0x3
v_add_f32_dpp v125, v124, v124 row_ror:8 row_mask:0xf bank_mask:0x3
v_add_f32_dpp v121, v128, v128 row_ror:8 row_mask:0xf bank_mask:0xc
v_add_f32_dpp v125, v132, v132 row_ror:8 row_mask:0xf bank_mask:0xc
s_nop 0
v_add_f32_dpp v14, v121, v121 row_shl:4 row_mask:0xf bank_mask:0x5
v_add_f32_dpp v14, v125, v125 row_shr:4 row_mask:0xf bank_mask:0xa
s_nop 1
v_add_f32_dpp v14, v14, v14 quad_perm:[1,0,3,2] row_mask:0xf bank_mask:0xf
s_nop 1
v_add_f32_dpp v14, v14, v14 quad_perm:[2,3,0,1] row_mask:0xf bank_mask:0xf
v_cvt_pk_bf16_f32 v14, 0, v14
v_mul_f32 v14, s66, v14
v_cvt_pk_bf16_f32 v14, 0, v14
s_xor_b32 s64, s65, 198656
s_cmpk_gt_u32 s69, 83
s_waitcnt vmcnt(6)
s_cbranch_scc1 L_d_87
s_waitcnt vmcnt(4)
L_d_87:
buffer_load_dwordx4 v[48:51], v1, s[44:47], s64 offen nt
v_dot2_f32_bf16 v136, v136, v4, 0
v_dot2_f32_bf16 v140, v140, v4, 0
v_dot2_f32_bf16 v144, v144, v4, 0
v_dot2_f32_bf16 v148, v148, v4, 0
v_dot2c_f32_bf16 v136, v137, v5
v_dot2c_f32_bf16 v140, v141, v5
v_dot2c_f32_bf16 v144, v145, v5
v_dot2c_f32_bf16 v148, v149, v5
v_dot2c_f32_bf16 v136, v138, v6
v_dot2c_f32_bf16 v140, v142, v6
v_dot2c_f32_bf16 v144, v146, v6
v_dot2c_f32_bf16 v148, v150, v6
v_dot2c_f32_bf16 v136, v139, v7
v_dot2c_f32_bf16 v140, v143, v7
v_dot2c_f32_bf16 v144, v147, v7
v_dot2c_f32_bf16 v148, v151, v7
v_add_f32_dpp v137, v136, v136 row_ror:8 row_mask:0xf bank_mask:0x3
v_add_f32_dpp v141, v140, v140 row_ror:8 row_mask:0xf bank_mask:0x3
v_add_f32_dpp v137, v144, v144 row_ror:8 row_mask:0xf bank_mask:0xc
v_add_f32_dpp v141, v148, v148 row_ror:8 row_mask:0xf bank_mask:0xc
s_nop 0
v_add_f32_dpp v15, v137, v137 row_shl:4 row_mask:0xf bank_mask:0x5
v_add_f32_dpp v15, v141, v141 row_shr:4 row_mask:0xf bank_mask:0xa
s_nop 1
v_add_f32_dpp v15, v15, v15 quad_perm:[1,0,3,2] row_mask:0xf bank_mask:0xf
s_nop 1
v_add_f32_dpp v15, v15, v15 quad_perm:[2,3,0,1] row_mask:0xf bank_mask:0xf
v_cvt_pk_bf16_f32 v15, 0, v15
v_mul_f32 v15, s66, v15
v_cvt_pk_bf16_f32 v15, 0, v15
s_xor_b32 s64, s65, 132096
s_cmpk_gt_u32 s69, 84
s_waitcnt vmcnt(6)
s_cbranch_scc1 L_d_88
s_waitcnt vmcnt(4)
L_d_88:
buffer_load_dwordx4 v[52:55], v1, s[44:47], s64 offen nt
v_dot2_f32_bf16 v152, v152, v4, 0
v_dot2_f32_bf16 v156, v156, v4, 0
v_dot2_f32_bf16 v160, v160, v4, 0
v_dot2_f32_bf16 v164, v164, v4, 0
v_dot2c_f32_bf16 v152, v153, v5
v_dot2c_f32_bf16 v156, v157, v5
v_dot2c_f32_bf16 v160, v161, v5
v_dot2c_f32_bf16 v164, v165, v5
v_dot2c_f32_bf16 v152, v154, v6
v_dot2c_f32_bf16 v156, v158, v6
v_dot2c_f32_bf16 v160, v162, v6
v_dot2c_f32_bf16 v164, v166, v6
v_dot2c_f32_bf16 v152, v155, v7
v_dot2c_f32_bf16 v156, v159, v7
v_dot2c_f32_bf16 v160, v163, v7
v_dot2c_f32_bf16 v164, v167, v7
v_add_f32_dpp v153, v152, v152 row_ror:8 row_mask:0xf bank_mask:0x3
v_add_f32_dpp v157, v156, v156 row_ror:8 row_mask:0xf bank_mask:0x3
v_add_f32_dpp v153, v160, v160 row_ror:8 row_mask:0xf bank_mask:0xc
v_add_f32_dpp v157, v164, v164 row_ror:8 row_mask:0xf bank_mask:0xc
s_nop 0
v_add_f32_dpp v16, v153, v153 row_shl:4 row_mask:0xf bank_mask:0x5
v_add_f32_dpp v16, v157, v157 row_shr:4 row_mask:0xf bank_mask:0xa
s_nop 1
v_add_f32_dpp v16, v16, v16 quad_perm:[1,0,3,2] row_mask:0xf bank_mask:0xf
s_nop 1
v_add_f32_dpp v16, v16, v16 quad_perm:[2,3,0,1] row_mask:0xf bank_mask:0xf
v_cvt_pk_bf16_f32 v16, 0, v16
v_mul_f32 v16, s66, v16
v_cvt_pk_bf16_f32 v16, 0, v16
s_xor_b32 s64, s65, 197632
s_cmpk_gt_u32 s69, 85
s_waitcnt vmcnt(6)
s_cbranch_scc1 L_d_89
s_waitcnt vmcnt(4)
L_d_89:
buffer_load_dwordx4 v[56:59], v1, s[44:47], s64 offen nt
v_dot2_f32_bf16 v168, v168, v4, 0
v_dot2_f32_bf16 v172, v172, v4, 0
v_dot2_f32_bf16 v176, v176, v4, 0
v_dot2_f32_bf16 v180, v180, v4, 0
v_dot2c_f32_bf16 v168, v169, v5
v_dot2c_f32_bf16 v172, v173, v5
v_dot2c_f32_bf16 v176, v177, v5
v_dot2c_f32_bf16 v180, v181, v5
v_dot2c_f32_bf16 v168, v170, v6
v_dot2c_f32_bf16 v172, v174, v6
v_dot2c_f32_bf16 v176, v178, v6
v_dot2c_f32_bf16 v180, v182, v6
v_dot2c_f32_bf16 v168, v171, v7
v_dot2c_f32_bf16 v172, v175, v7
v_dot2c_f32_bf16 v176, v179, v7
v_dot2c_f32_bf16 v180, v183, v7
v_add_f32_dpp v169, v168, v168 row_ror:8 row_mask:0xf bank_mask:0x3
v_add_f32_dpp v173, v172, v172 row_ror:8 row_mask:0xf bank_mask:0x3
v_add_f32_dpp v169, v176, v176 row_ror:8 row_mask:0xf bank_mask:0xc
v_add_f32_dpp v173, v180, v180 row_ror:8 row_mask:0xf bank_mask:0xc
s_nop 0
v_add_f32_dpp v18, v169, v169 row_shl:4 row_mask:0xf bank_mask:0x5
v_add_f32_dpp v18, v173, v173 row_shr:4 row_mask:0xf bank_mask:0xa
s_nop 1
v_add_f32_dpp v18, v18, v18 quad_perm:[1,0,3,2] row_mask:0xf bank_mask:0xf
s_nop 1
v_add_f32_dpp v18, v18, v18 quad_perm:[2,3,0,1] row_mask:0xf bank_mask:0xf
v_cvt_pk_bf16_f32 v18, 0, v18
v_mul_f32 v18, s66, v18
v_cvt_pk_bf16_f32 v18, 0, v18
s_cmp_eq_u32 s34, 1
s_cbranch_scc0 L_w_91
v_mov_b32 v60, 22
s_mov_b64 exec, 1
buffer_store_dword v60, off, s[36:39], s63 offset:0
s_mov_b64 exec, -1
L_w_91:
s_xor_b32 s64, s65, 134144
s_cmpk_gt_u32 s69, 86
s_waitcnt vmcnt(6)
s_cbranch_scc1 L_d_90
s_waitcnt vmcnt(4)
L_d_90:
buffer_load_dwordx4 v[64:67], v1, s[44:47], s64 offen nt
v_dot2_f32_bf16 v184, v184, v4, 0
v_dot2_f32_bf16 v188, v188, v4, 0
v_dot2_f32_bf16 v192, v192, v4, 0
v_dot2_f32_bf16 v196, v196, v4, 0
v_dot2c_f32_bf16 v184, v185, v5
v_dot2c_f32_bf16 v188, v189, v5
v_dot2c_f32_bf16 v192, v193, v5
v_dot2c_f32_bf16 v196, v197, v5
v_dot2c_f32_bf16 v184, v186, v6
v_dot2c_f32_bf16 v188, v190, v6
v_dot2c_f32_bf16 v192, v194, v6
v_dot2c_f32_bf16 v196, v198, v6
v_dot2c_f32_bf16 v184, v187, v7
v_dot2c_f32_bf16 v188, v191, v7
v_dot2c_f32_bf16 v192, v195, v7
v_dot2c_f32_bf16 v196, v199, v7
v_add_f32_dpp v185, v184, v184 row_ror:8 row_mask:0xf bank_mask:0x3
v_add_f32_dpp v189, v188, v188 row_ror:8 row_mask:0xf bank_mask:0x3
v_add_f32_dpp v185, v192, v192 row_ror:8 row_mask:0xf bank_mask:0xc
v_add_f32_dpp v189, v196, v196 row_ror:8 row_mask:0xf bank_mask:0xc
s_nop 0
v_add_f32_dpp v19, v185, v185 row_shl:4 row_mask:0xf bank_mask:0x5
v_add_f32_dpp v19, v189, v189 row_shr:4 row_mask:0xf bank_mask:0xa
s_nop 1
v_add_f32_dpp v19, v19, v19 quad_perm:[1,0,3,2] row_mask:0xf bank_mask:0xf
s_nop 1
v_add_f32_dpp v19, v19, v19 quad_perm:[2,3,0,1] row_mask:0xf bank_mask:0xf
v_cvt_pk_bf16_f32 v19, 0, v19
v_mul_f32 v19, s66, v19
v_cvt_pk_bf16_f32 v19, 0, v19
s_xor_b32 s64, s65, 199680
s_cmpk_gt_u32 s69, 87
s_waitcnt vmcnt(6)
s_cbranch_scc1 L_d_92
s_waitcnt vmcnt(4)
L_d_92:
buffer_load_dwordx4 v[68:71], v1, s[44:47], s64 offen nt
v_dot2_f32_bf16 v200, v200, v4, 0
v_dot2_f32_bf16 v204, v204, v4, 0
v_dot2_f32_bf16 v208, v208, v4, 0
v_dot2_f32_bf16 v212, v212, v4, 0
v_dot2c_f32_bf16 v200, v201, v5
v_dot2c_f32_bf16 v204, v205, v5
v_dot2c_f32_bf16 v208, v209, v5
v_dot2c_f32_bf16 v212, v213, v5
v_dot2c_f32_bf16 v200, v202, v6
v_dot2c_f32_bf16 v204, v206, v6
v_dot2c_f32_bf16 v208, v210, v6
v_dot2c_f32_bf16 v212, v214, v6
v_dot2c_f32_bf16 v200, v203, v7
v_dot2c_f32_bf16 v204, v207, v7
v_dot2c_f32_bf16 v208, v211, v7
v_dot2c_f32_bf16 v212, v215, v7
v_add_f32_dpp v201, v200, v200 row_ror:8 row_mask:0xf bank_mask:0x3
v_add_f32_dpp v205, v204, v204 row_ror:8 row_mask:0xf bank_mask:0x3
v_add_f32_dpp v201, v208, v208 row_ror:8 row_mask:0xf bank_mask:0xc
v_add_f32_dpp v205, v212, v212 row_ror:8 row_mask:0xf bank_mask:0xc
s_nop 0
v_add_f32_dpp v20, v201, v201 row_shl:4 row_mask:0xf bank_mask:0x5
v_add_f32_dpp v20, v205, v205 row_shr:4 row_mask:0xf bank_mask:0xa
s_nop 1
v_add_f32_dpp v20, v20, v20 quad_perm:[1,0,3,2] row_mask:0xf bank_mask:0xf
s_nop 1
v_add_f32_dpp v20, v20, v20 quad_perm:[2,3,0,1] row_mask:0xf bank_mask:0xf
v_cvt_pk_bf16_f32 v20, 0, v20
v_mul_f32 v20, s66, v20
v_cvt_pk_bf16_f32 v20, 0, v20
s_xor_b32 s64, s65, 163840
s_cmpk_gt_u32 s69, 88
s_waitcnt vmcnt(6)
s_cbranch_scc1 L_d_93
s_waitcnt vmcnt(4)
L_d_93:
buffer_load_dwordx4 v[72:75], v1, s[44:47], s64 offen nt
v_dot2_f32_bf16 v216, v216, v4, 0
v_dot2_f32_bf16 v220, v220, v4, 0
v_dot2_f32_bf16 v224, v224, v4, 0
v_dot2_f32_bf16 v228, v228, v4, 0
v_dot2c_f32_bf16 v216, v217, v5
v_dot2c_f32_bf16 v220, v221, v5
v_dot2c_f32_bf16 v224, v225, v5
v_dot2c_f32_bf16 v228, v229, v5
v_dot2c_f32_bf16 v216, v218, v6
v_dot2c_f32_bf16 v220, v222, v6
v_dot2c_f32_bf16 v224, v226, v6
v_dot2c_f32_bf16 v228, v230, v6
v_dot2c_f32_bf16 v216, v219, v7
v_dot2c_f32_bf16 v220, v223, v7
v_dot2c_f32_bf16 v224, v227, v7
v_dot2c_f32_bf16 v228, v231, v7
v_add_f32_dpp v217, v216, v216 row_ror:8 row_mask:0xf bank_mask:0x3
v_add_f32_dpp v221, v220, v220 row_ror:8 row_mask:0xf bank_mask:0x3
v_add_f32_dpp v217, v224, v224 row_ror:8 row_mask:0xf bank_mask:0xc
v_add_f32_dpp v221, v228, v228 row_ror:8 row_mask:0xf bank_mask:0xc
s_nop 0
v_add_f32_dpp v21, v217, v217 row_shl:4 row_mask:0xf bank_mask:0x5
v_add_f32_dpp v21, v221, v221 row_shr:4 row_mask:0xf bank_mask:0xa
s_nop 1
v_add_f32_dpp v21, v21, v21 quad_perm:[1,0,3,2] row_mask:0xf bank_mask:0xf
s_nop 1
v_add_f32_dpp v21, v21, v21 quad_perm:[2,3,0,1] row_mask:0xf bank_mask:0xf
v_cvt_pk_bf16_f32 v21, 0, v21
v_mul_f32 v21, s66, v21
v_cvt_pk_bf16_f32 v21, 0, v21
s_xor_b32 s64, s65, 229376
s_cmpk_gt_u32 s69, 89
s_waitcnt vmcnt(6)
s_cbranch_scc1 L_d_94
s_waitcnt vmcnt(4)
L_d_94:
buffer_load_dwordx4 v[76:79], v1, s[44:47], s64 offen nt
v_dot2_f32_bf16 v232, v232, v4, 0
v_dot2_f32_bf16 v236, v236, v4, 0
v_dot2_f32_bf16 v240, v240, v4, 0
v_dot2_f32_bf16 v244, v244, v4, 0
v_dot2c_f32_bf16 v232, v233, v5
v_dot2c_f32_bf16 v236, v237, v5
v_dot2c_f32_bf16 v240, v241, v5
v_dot2c_f32_bf16 v244, v245, v5
v_dot2c_f32_bf16 v232, v234, v6
v_dot2c_f32_bf16 v236, v238, v6
v_dot2c_f32_bf16 v240, v242, v6
v_dot2c_f32_bf16 v244, v246, v6
v_dot2c_f32_bf16 v232, v235, v7
v_dot2c_f32_bf16 v236, v239, v7
v_dot2c_f32_bf16 v240, v243, v7
v_dot2c_f32_bf16 v244, v247, v7
v_add_f32_dpp v233, v232, v232 row_ror:8 row_mask:0xf bank_mask:0x3
v_add_f32_dpp v237, v236, v236 row_ror:8 row_mask:0xf bank_mask:0x3
v_add_f32_dpp v233, v240, v240 row_ror:8 row_mask:0xf bank_mask:0xc
v_add_f32_dpp v237, v244, v244 row_ror:8 row_mask:0xf bank_mask:0xc
s_nop 0
v_add_f32_dpp v22, v233, v233 row_shl:4 row_mask:0xf bank_mask:0x5
v_add_f32_dpp v22, v237, v237 row_shr:4 row_mask:0xf bank_mask:0xa
s_nop 1
v_add_f32_dpp v22, v22, v22 quad_perm:[1,0,3,2] row_mask:0xf bank_mask:0xf
s_nop 1
v_add_f32_dpp v22, v22, v22 quad_perm:[2,3,0,1] row_mask:0xf bank_mask:0xf
v_cvt_pk_bf16_f32 v22, 0, v22
v_mul_f32 v22, s66, v22
v_cvt_pk_bf16_f32 v22, 0, v22
s_xor_b32 s64, s65, 165888
s_cmpk_gt_u32 s69, 90
s_waitcnt vmcnt(6)
s_cbranch_scc1 L_d_95
s_waitcnt vmcnt(5)
L_d_95:
buffer_load_dwordx4 v[80:83], v1, s[44:47], s64 offen nt
v_lshl_add_u32 v84, v0, 4, s70
ds_read_b128 v[88:91], v84 offset:0
ds_read_b128 v[92:95], v84 offset:1024
s_waitcnt lgkmcnt(0)
v_dot2_f32_bf16 v248, v248, v4, 0
v_dot2_f32_bf16 v252, v252, v4, 0
v_dot2_f32_bf16 v88, v88, v4, 0
v_dot2_f32_bf16 v92, v92, v4, 0
v_dot2c_f32_bf16 v248, v249, v5
v_dot2c_f32_bf16 v252, v253, v5
v_dot2c_f32_bf16 v88, v89, v5
v_dot2c_f32_bf16 v92, v93, v5
v_dot2c_f32_bf16 v248, v250, v6
v_dot2c_f32_bf16 v252, v254, v6
v_dot2c_f32_bf16 v88, v90, v6
v_dot2c_f32_bf16 v92, v94, v6
v_dot2c_f32_bf16 v248, v251, v7
v_dot2c_f32_bf16 v252, v255, v7
v_dot2c_f32_bf16 v88, v91, v7
v_dot2c_f32_bf16 v92, v95, v7
v_add_f32_dpp v249, v248, v248 row_ror:8 row_mask:0xf bank_mask:0x3
v_add_f32_dpp v253, v252, v252 row_ror:8 row_mask:0xf bank_mask:0x3
v_add_f32_dpp v249, v88, v88 row_ror:8 row_mask:0xf bank_mask:0xc
v_add_f32_dpp v253, v92, v92 row_ror:8 row_mask:0xf bank_mask:0xc
s_nop 0
v_add_f32_dpp v23, v249, v249 row_shl:4 row_mask:0xf bank_mask:0x5
v_add_f32_dpp v23, v253, v253 row_shr:4 row_mask:0xf bank_mask:0xa
s_nop 1
v_add_f32_dpp v23, v23, v23 quad_perm:[1,0,3,2] row_mask:0xf bank_mask:0xf
s_nop 1
v_add_f32_dpp v23, v23, v23 quad_perm:[2,3,0,1] row_mask:0xf bank_mask:0xf
v_cvt_pk_bf16_f32 v23, 0, v23
v_mul_f32 v23, s66, v23
v_cvt_pk_bf16_f32 v23, 0, v23
s_xor_b32 s64, s65, 231424
s_cmpk_gt_u32 s69, 91
s_waitcnt vmcnt(6)
s_cbranch_scc1 L_d_96
s_waitcnt vmcnt(5)
L_d_96:
buffer_load_dwordx4 v[96:99], v1, s[44:47], s64 offen nt
v_max3_f32 v2, v17, v8, v9
v_max3_f32 v2, v2, v10, v11
v_max3_f32 v2, v2, v12, v13
v_max3_f32 v2, v2, v14, v15
v_max3_f32 v2, v2, v16, v18
v_max3_f32 v2, v2, v19, v20
v_max3_f32 v2, v2, v21, v22
v_max_f32 v2, v2, v23
v_max_f32 v2, 0xff7fffff, v2
s_nop 1
v_max_f32_dpp v2, v2, v2 row_ror:4 row_mask:0xf bank_mask:0xf
s_nop 1
v_max_f32_dpp v2, v2, v2 row_ror:8 row_mask:0xf bank_mask:0xf
v_mov_b32 v3, v2
s_nop 1
v_permlane16_swap_b32 v2, v3
s_nop 1
v_max_f32 v2, v2, v3
v_mov_b32 v3, v2
s_nop 1
v_permlane32_swap_b32 v2, v3
s_nop 1
v_max_f32 v2, v2, v3
s_mov_b32 s67, 0x3fb8aa3b
v_sub_f32 v17, v17, v2
v_sub_f32 v8, v8, v2
v_sub_f32 v9, v9, v2
v_sub_f32 v10, v10, v2
v_sub_f32 v11, v11, v2
v_sub_f32 v12, v12, v2
v_sub_f32 v13, v13, v2
v_sub_f32 v14, v14, v2
v_sub_f32 v15, v15, v2
v_sub_f32 v16, v16, v2
v_sub_f32 v18, v18, v2
v_sub_f32 v19, v19, v2
v_sub_f32 v20, v20, v2
v_sub_f32 v21, v21, v2
v_sub_f32 v22, v22, v2
v_sub_f32 v23, v23, v2
v_mul_f32 v17, s67, v17
v_mul_f32 v8, s67, v8
v_mul_f32 v9, s67, v9
v_mul_f32 v10, s67, v10
v_mul_f32 v11, s67, v11
v_mul_f32 v12, s67, v12
v_mul_f32 v13, s67, v13
v_mul_f32 v14, s67, v14
v_mul_f32 v15, s67, v15
v_mul_f32 v16, s67, v16
v_mul_f32 v18, s67, v18
v_mul_f32 v19, s67, v19
v_mul_f32 v20, s67, v20
v_mul_f32 v21, s67, v21
v_mul_f32 v22, s67, v22
v_mul_f32 v23, s67, v23
s_xor_b32 s64, s65, 164864
s_cmpk_gt_u32 s69, 92
s_waitcnt vmcnt(6)
s_cbranch_scc1 L_d_97
s_waitcnt vmcnt(5)
L_d_97:
buffer_load_dwordx4 v[120:123], v1, s[44:47], s64 offen nt
v_exp_f32 v17, v17
v_exp_f32 v8, v8
v_exp_f32 v9, v9
v_exp_f32 v10, v10
v_exp_f32 v11, v11
v_exp_f32 v12, v12
v_exp_f32 v13, v13
v_exp_f32 v14, v14
v_exp_f32 v15, v15
v_exp_f32 v16, v16
v_exp_f32 v18, v18
v_exp_f32 v19, v19
v_exp_f32 v20, v20
v_exp_f32 v21, v21
v_exp_f32 v22, v22
v_exp_f32 v23, v23
v_add_f32 v3, v17, v8
v_add_f32 v3, v3, v9
v_add_f32 v3, v3, v10
v_add_f32 v3, v3, v11
v_add_f32 v3, v3, v12
v_add_f32 v3, v3, v13
v_add_f32 v3, v3, v14
v_add_f32 v3, v3, v15
v_add_f32 v3, v3, v16
v_add_f32 v3, v3, v18
v_add_f32 v3, v3, v19
v_add_f32 v3, v3, v20
v_add_f32 v3, v3, v21
v_add_f32 v3, v3, v22
v_add_f32 v3, v3, v23
s_nop 1
v_add_f32_dpp v3, v3, v3 row_ror:4 row_mask:0xf bank_mask:0xf
s_nop 1
v_add_f32_dpp v3, v3, v3 row_ror:8 row_mask:0xf bank_mask:0xf
v_mov_b32 v100, v3
s_nop 1
v_permlane16_swap_b32 v3, v100
s_nop 1
v_add_f32 v3, v3, v100
v_mov_b32 v100, v3
s_nop 1
v_permlane32_swap_b32 v3, v100
s_nop 1
v_add_f32 v3, v3, v100
v_min_u32 v3, -2, v3
s_lshl_b32 s68, s34, 3
v_mov_b32 v100, s68
ds_write_b64 v100, v[2:3] offset:256
v_and_b32 v101, 15, v0
v_lshrrev_b32 v102, 1, v101
v_and_b32 v101, 1, v0
v_lshlrev_b32 v101, 4, v101
v_mov_b32 v103, 0xffff
v_lshlrev_b32 v101, v101, v103
v_cmp_eq_u32 vcc, 0, v102
s_nop 1
v_cndmask_b32 v4, 0, v101, vcc
v_cmp_eq_u32 vcc, 1, v102
s_nop 1
v_cndmask_b32 v5, 0, v101, vcc
v_cmp_eq_u32 vcc, 2, v102
s_nop 1
v_cndmask_b32 v6, 0, v101, vcc
v_cmp_eq_u32 vcc, 3, v102
s_nop 1
v_cndmask_b32 v7, 0, v101, vcc
s_xor_b32 s64, s65, 230400
s_cmpk_gt_u32 s69, 93
s_waitcnt vmcnt(6)
s_cbranch_scc1 L_d_98
s_waitcnt vmcnt(5)
L_d_98:
buffer_load_dwordx4 v[124:127], v1, s[44:47], s64 offen nt
v_mov_b32 v100, 0
s_mov_b32 s75, 0
L_poll_99:
ds_read_b128 v[104:107], v100 offset:256
ds_read_b128 v[108:111], v100 offset:272
s_waitcnt lgkmcnt(0)
v_max3_u32 v101, v105, v107, v109
v_max_u32 v101, v101, v111
v_cmp_eq_u32 vcc, -1, v101
s_cbranch_vccz L_pollx_100
s_add_u32 s75, s75, 1
s_cmp_lt_u32 s75, 0x1000000
s_cbranch_scc1 L_poll_99
L_pollx_100:
v_max3_f32 v101, v104, v106, v108
v_max_f32 v101, v101, v110
v_sub_f32 v104, v104, v101
v_sub_f32 v106, v106, v101
v_sub_f32 v108, v108, v101
v_sub_f32 v110, v110, v101
v_sub_f32 v2, v2, v101
v_mul_f32 v104, s67, v104
v_mul_f32 v106, s67, v106
v_mul_f32 v108, s67, v108
v_mul_f32 v110, s67, v110
v_mul_f32 v2, s67, v2
v_exp_f32 v104, v104
v_exp_f32 v106, v106
v_exp_f32 v108, v108
v_exp_f32 v110, v110
v_exp_f32 v2, v2
v_mul_f32 v3, v104, v105
v_fmac_f32 v3, v106, v107
v_fmac_f32 v3, v108, v109
v_fmac_f32 v3, v110, v111
v_rcp_f32 v3, v3
s_nop 0
v_mul_f32 v2, v2, v3
v_mul_f32 v17, v17, v2
v_mul_f32 v8, v8, v2
v_mul_f32 v9, v9, v2
v_mul_f32 v10, v10, v2
v_mul_f32 v11, v11, v2
v_mul_f32 v12, v12, v2
v_mul_f32 v13, v13, v2
v_mul_f32 v14, v14, v2
v_mul_f32 v15, v15, v2
v_mul_f32 v16, v16, v2
v_mul_f32 v18, v18, v2
v_mul_f32 v19, v19, v2
v_mul_f32 v20, v20, v2
v_mul_f32 v21, v21, v2
v_mul_f32 v22, v22, v2
v_mul_f32 v23, v23, v2
v_cvt_pk_bf16_f32 v17, v17, v17
v_cvt_pk_bf16_f32 v8, v8, v8
v_cvt_pk_bf16_f32 v9, v9, v9
v_cvt_pk_bf16_f32 v10, v10, v10
v_cvt_pk_bf16_f32 v11, v11, v11
v_cvt_pk_bf16_f32 v12, v12, v12
v_cvt_pk_bf16_f32 v13, v13, v13
v_cvt_pk_bf16_f32 v14, v14, v14
v_cvt_pk_bf16_f32 v15, v15, v15
v_cvt_pk_bf16_f32 v16, v16, v16
v_cvt_pk_bf16_f32 v18, v18, v18
v_cvt_pk_bf16_f32 v19, v19, v19
v_cvt_pk_bf16_f32 v20, v20, v20
v_cvt_pk_bf16_f32 v21, v21, v21
v_cvt_pk_bf16_f32 v22, v22, v22
v_cvt_pk_bf16_f32 v23, v23, v23
s_nop 1
s_cmp_eq_u32 s34, 2
s_cbranch_scc0 L_w_102
v_mov_b32 v60, 30
s_mov_b64 exec, 1
buffer_store_dword v60, off, s[36:39], s63 offset:0
s_mov_b64 exec, -1
L_w_102:
s_xor_b32 s64, s65, 166912
s_cmpk_gt_u32 s69, 94
s_waitcnt vmcnt(6)
s_cbranch_scc1 L_d_101
s_waitcnt vmcnt(5)
L_d_101:
buffer_load_dwordx4 v[128:131], v1, s[44:47], s64 offen nt
ds_read_b128 v[132:135], v84 offset:2048
ds_read_b128 v[136:139], v84 offset:3072
ds_read_b128 v[140:143], v84 offset:4096
ds_read_b128 v[144:147], v84 offset:5120
ds_read_b128 v[148:151], v84 offset:6144
ds_read_b128 v[152:155], v84 offset:7168
ds_read_b128 v[156:159], v84 offset:8192
ds_read_b128 v[160:163], v84 offset:9216
s_waitcnt lgkmcnt(0)
v_and_b32_dpp v104, v17, v4 row_newbcast:0 row_mask:0xf bank_mask:0xf
v_and_b32_dpp v105, v17, v5 row_newbcast:0 row_mask:0xf bank_mask:0xf
v_and_b32_dpp v106, v17, v6 row_newbcast:0 row_mask:0xf bank_mask:0xf
v_and_b32_dpp v107, v17, v7 row_newbcast:0 row_mask:0xf bank_mask:0xf
v_and_b32_dpp v108, v17, v4 row_newbcast:4 row_mask:0xf bank_mask:0xf
v_and_b32_dpp v109, v17, v5 row_newbcast:4 row_mask:0xf bank_mask:0xf
v_and_b32_dpp v110, v17, v6 row_newbcast:4 row_mask:0xf bank_mask:0xf
v_and_b32_dpp v111, v17, v7 row_newbcast:4 row_mask:0xf bank_mask:0xf
v_mfma_f32_16x16x32_bf16 v[112:115], v[104:107], v[132:135], 0
v_and_b32_dpp v104, v17, v4 row_newbcast:8 row_mask:0xf bank_mask:0xf
v_and_b32_dpp v105, v17, v5 row_newbcast:8 row_mask:0xf bank_mask:0xf
v_and_b32_dpp v106, v17, v6 row_newbcast:8 row_mask:0xf bank_mask:0xf
v_and_b32_dpp v107, v17, v7 row_newbcast:8 row_mask:0xf bank_mask:0xf
v_mfma_f32_16x16x32_bf16 v[112:115], v[108:111], v[136:139], v[112:115]
v_and_b32_dpp v108, v17, v4 row_newbcast:12 row_mask:0xf bank_mask:0xf
v_and_b32_dpp v109, v17, v5 row_newbcast:12 row_mask:0xf bank_mask:0xf
v_and_b32_dpp v110, v17, v6 row_newbcast:12 row_mask:0xf bank_mask:0xf
v_and_b32_dpp v111, v17, v7 row_newbcast:12 row_mask:0xf bank_mask:0xf
v_mfma_f32_16x16x32_bf16 v[112:115], v[104:107], v[140:143], v[112:115]
v_and_b32_dpp v104, v8, v4 row_newbcast:0 row_mask:0xf bank_mask:0xf
v_and_b32_dpp v105, v8, v5 row_newbcast:0 row_mask:0xf bank_mask:0xf
v_and_b32_dpp v106, v8, v6 row_newbcast:0 row_mask:0xf bank_mask:0xf
v_and_b32_dpp v107, v8, v7 row_newbcast:0 row_mask:0xf bank_mask:0xf
v_mfma_f32_16x16x32_bf16 v[112:115], v[108:111], v[144:147], v[112:115]
v_and_b32_dpp v108, v8, v4 row_newbcast:4 row_mask:0xf bank_mask:0xf
v_and_b32_dpp v109, v8, v5 row_newbcast:4 row_mask:0xf bank_mask:0xf
v_and_b32_dpp v110, v8, v6 row_newbcast:4 row_mask:0xf bank_mask:0xf
v_and_b32_dpp v111, v8, v7 row_newbcast:4 row_mask:0xf bank_mask:0xf
v_mfma_f32_16x16x32_bf16 v[112:115], v[104:107], v[148:151], v[112:115]
s_xor_b32 s64, s65, 232448
s_cmpk_gt_u32 s69, 95
s_waitcnt vmcnt(6)
s_cbranch_scc1 L_d_103
s_waitcnt vmcnt(5)
L_d_103:
buffer_load_dwordx4 v[164:167], v1, s[44:47], s64 offen nt
v_and_b32_dpp v104, v8, v4 row_newbcast:8 row_mask:0xf bank_mask:0xf
v_and_b32_dpp v105, v8, v5 row_newbcast:8 row_mask:0xf bank_mask:0xf
v_and_b32_dpp v106, v8, v6 row_newbcast:8 row_mask:0xf bank_mask:0xf
v_and_b32_dpp v107, v8, v7 row_newbcast:8 row_mask:0xf bank_mask:0xf
v_mfma_f32_16x16x32_bf16 v[112:115], v[108:111], v[152:155], v[112:115]
v_and_b32_dpp v108, v8, v4 row_newbcast:12 row_mask:0xf bank_mask:0xf
v_and_b32_dpp v109, v8, v5 row_newbcast:12 row_mask:0xf bank_mask:0xf
v_and_b32_dpp v110, v8, v6 row_newbcast:12 row_mask:0xf bank_mask:0xf
v_and_b32_dpp v111, v8, v7 row_newbcast:12 row_mask:0xf bank_mask:0xf
v_mfma_f32_16x16x32_bf16 v[112:115], v[104:107], v[156:159], v[112:115]
v_and_b32_dpp v104, v9, v4 row_newbcast:0 row_mask:0xf bank_mask:0xf
v_and_b32_dpp v105, v9, v5 row_newbcast:0 row_mask:0xf bank_mask:0xf
v_and_b32_dpp v106, v9, v6 row_newbcast:0 row_mask:0xf bank_mask:0xf
v_and_b32_dpp v107, v9, v7 row_newbcast:0 row_mask:0xf bank_mask:0xf
v_mfma_f32_16x16x32_bf16 v[112:115], v[108:111], v[160:163], v[112:115]
ds_read_b128 v[168:171], v84 offset:10240
ds_read_b128 v[172:175], v84 offset:11264
ds_read_b128 v[176:179], v84 offset:12288
ds_read_b128 v[180:183], v84 offset:13312
ds_read_b128 v[184:187], v84 offset:14336
s_waitcnt lgkmcnt(0)
v_and_b32_dpp v108, v9, v4 row_newbcast:4 row_mask:0xf bank_mask:0xf
v_and_b32_dpp v109, v9, v5 row_newbcast:4 row_mask:0xf bank_mask:0xf
v_and_b32_dpp v110, v9, v6 row_newbcast:4 row_mask:0xf bank_mask:0xf
v_and_b32_dpp v111, v9, v7 row_newbcast:4 row_mask:0xf bank_mask:0xf
v_mfma_f32_16x16x32_bf16 v[112:115], v[104:107], v[168:171], v[112:115]
v_and_b32_dpp v104, v9, v4 row_newbcast:8 row_mask:0xf bank_mask:0xf
v_and_b32_dpp v105, v9, v5 row_newbcast:8 row_mask:0xf bank_mask:0xf
v_and_b32_dpp v106, v9, v6 row_newbcast:8 row_mask:0xf bank_mask:0xf
v_and_b32_dpp v107, v9, v7 row_newbcast:8 row_mask:0xf bank_mask:0xf
v_mfma_f32_16x16x32_bf16 v[112:115], v[108:111], v[172:175], v[112:115]
s_xor_b32 s64, s65, 4096
s_cmpk_gt_u32 s69, 96
s_waitcnt vmcnt(6)
s_cbranch_scc1 L_d_104
s_waitcnt vmcnt(5)
L_d_104:
buffer_load_dwordx4 v[188:191], v1, s[44:47], s64 offen nt
v_and_b32_dpp v108, v9, v4 row_newbcast:12 row_mask:0xf bank_mask:0xf
v_and_b32_dpp v109, v9, v5 row_newbcast:12 row_mask:0xf bank_mask:0xf
v_and_b32_dpp v110, v9, v6 row_newbcast:12 row_mask:0xf bank_mask:0xf
v_and_b32_dpp v111, v9, v7 row_newbcast:12 row_mask:0xf bank_mask:0xf
v_mfma_f32_16x16x32_bf16 v[112:115], v[104:107], v[176:179], v[112:115]
v_and_b32_dpp v104, v10, v4 row_newbcast:0 row_mask:0xf bank_mask:0xf
v_and_b32_dpp v105, v10, v5 row_newbcast:0 row_mask:0xf bank_mask:0xf
v_and_b32_dpp v106, v10, v6 row_newbcast:0 row_mask:0xf bank_mask:0xf
v_and_b32_dpp v107, v10, v7 row_newbcast:0 row_mask:0xf bank_mask:0xf
v_mfma_f32_16x16x32_bf16 v[112:115], v[108:111], v[180:183], v[112:115]
v_and_b32_dpp v108, v10, v4 row_newbcast:4 row_mask:0xf bank_mask:0xf
v_and_b32_dpp v109, v10, v5 row_newbcast:4 row_mask:0xf bank_mask:0xf
v_and_b32_dpp v110, v10, v6 row_newbcast:4 row_mask:0xf bank_mask:0xf
v_and_b32_dpp v111, v10, v7 row_newbcast:4 row_mask:0xf bank_mask:0xf
v_mfma_f32_16x16x32_bf16 v[112:115], v[104:107], v[184:187], v[112:115]
v_and_b32_dpp v104, v10, v4 row_newbcast:8 row_mask:0xf bank_mask:0xf
v_and_b32_dpp v105, v10, v5 row_newbcast:8 row_mask:0xf bank_mask:0xf
v_and_b32_dpp v106, v10, v6 row_newbcast:8 row_mask:0xf bank_mask:0xf
v_and_b32_dpp v107, v10, v7 row_newbcast:8 row_mask:0xf bank_mask:0xf
v_mfma_f32_16x16x32_bf16 v[112:115], v[108:111], v[24:27], v[112:115]
v_and_b32_dpp v108, v10, v4 row_newbcast:12 row_mask:0xf bank_mask:0xf
v_and_b32_dpp v109, v10, v5 row_newbcast:12 row_mask:0xf bank_mask:0xf
v_and_b32_dpp v110, v10, v6 row_newbcast:12 row_mask:0xf bank_mask:0xf
v_and_b32_dpp v111, v10, v7 row_newbcast:12 row_mask:0xf bank_mask:0xf
v_mfma_f32_16x16x32_bf16 v[112:115], v[104:107], v[28:31], v[112:115]
s_xor_b32 s64, s65, 69632
s_cmpk_gt_u32 s69, 97
s_waitcnt vmcnt(6)
s_cbranch_scc1 L_d_105
s_waitcnt vmcnt(5)
L_d_105:
buffer_load_dwordx4 v[192:195], v1, s[44:47], s64 offen nt
v_and_b32_dpp v104, v11, v4 row_newbcast:0 row_mask:0xf bank_mask:0xf
v_and_b32_dpp v105, v11, v5 row_newbcast:0 row_mask:0xf bank_mask:0xf
v_and_b32_dpp v106, v11, v6 row_newbcast:0 row_mask:0xf bank_mask:0xf
v_and_b32_dpp v107, v11, v7 row_newbcast:0 row_mask:0xf bank_mask:0xf
v_mfma_f32_16x16x32_bf16 v[112:115], v[108:111], v[32:35], v[112:115]
v_and_b32_dpp v108, v11, v4 row_newbcast:4 row_mask:0xf bank_mask:0xf
v_and_b32_dpp v109, v11, v5 row_newbcast:4 row_mask:0xf bank_mask:0xf
v_and_b32_dpp v110, v11, v6 row_newbcast:4 row_mask:0xf bank_mask:0xf
v_and_b32_dpp v111, v11, v7 row_newbcast:4 row_mask:0xf bank_mask:0xf
v_mfma_f32_16x16x32_bf16 v[112:115], v[104:107], v[36:39], v[112:115]
v_and_b32_dpp v104, v11, v4 row_newbcast:8 row_mask:0xf bank_mask:0xf
v_and_b32_dpp v105, v11, v5 row_newbcast:8 row_mask:0xf bank_mask:0xf
v_and_b32_dpp v106, v11, v6 row_newbcast:8 row_mask:0xf bank_mask:0xf
v_and_b32_dpp v107, v11, v7 row_newbcast:8 row_mask:0xf bank_mask:0xf
v_mfma_f32_16x16x32_bf16 v[112:115], v[108:111], v[40:43], v[112:115]
v_and_b32_dpp v108, v11, v4 row_newbcast:12 row_mask:0xf bank_mask:0xf
v_and_b32_dpp v109, v11, v5 row_newbcast:12 row_mask:0xf bank_mask:0xf
v_and_b32_dpp v110, v11, v6 row_newbcast:12 row_mask:0xf bank_mask:0xf
v_and_b32_dpp v111, v11, v7 row_newbcast:12 row_mask:0xf bank_mask:0xf
v_mfma_f32_16x16x32_bf16 v[112:115], v[104:107], v[44:47], v[112:115]
v_and_b32_dpp v104, v12, v4 row_newbcast:0 row_mask:0xf bank_mask:0xf
v_and_b32_dpp v105, v12, v5 row_newbcast:0 row_mask:0xf bank_mask:0xf
v_and_b32_dpp v106, v12, v6 row_newbcast:0 row_mask:0xf bank_mask:0xf
v_and_b32_dpp v107, v12, v7 row_newbcast:0 row_mask:0xf bank_mask:0xf
v_mfma_f32_16x16x32_bf16 v[112:115], v[108:111], v[48:51], v[112:115]
s_xor_b32 s64, s65, 6144
s_cmpk_gt_u32 s69, 98
s_waitcnt vmcnt(6)
s_cbranch_scc1 L_d_106
s_waitcnt vmcnt(5)
L_d_106:
buffer_load_dwordx4 v[196:199], v1, s[44:47], s64 offen nt
v_and_b32_dpp v108, v12, v4 row_newbcast:4 row_mask:0xf bank_mask:0xf
v_and_b32_dpp v109, v12, v5 row_newbcast:4 row_mask:0xf bank_mask:0xf
v_and_b32_dpp v110, v12, v6 row_newbcast:4 row_mask:0xf bank_mask:0xf
v_and_b32_dpp v111, v12, v7 row_newbcast:4 row_mask:0xf bank_mask:0xf
v_mfma_f32_16x16x32_bf16 v[112:115], v[104:107], v[52:55], v[112:115]
v_and_b32_dpp v104, v12, v4 row_newbcast:8 row_mask:0xf bank_mask:0xf
v_and_b32_dpp v105, v12, v5 row_newbcast:8 row_mask:0xf bank_mask:0xf
v_and_b32_dpp v106, v12, v6 row_newbcast:8 row_mask:0xf bank_mask:0xf
v_and_b32_dpp v107, v12, v7 row_newbcast:8 row_mask:0xf bank_mask:0xf
v_mfma_f32_16x16x32_bf16 v[112:115], v[108:111], v[56:59], v[112:115]
v_and_b32_dpp v108, v12, v4 row_newbcast:12 row_mask:0xf bank_mask:0xf
v_and_b32_dpp v109, v12, v5 row_newbcast:12 row_mask:0xf bank_mask:0xf
v_and_b32_dpp v110, v12, v6 row_newbcast:12 row_mask:0xf bank_mask:0xf
v_and_b32_dpp v111, v12, v7 row_newbcast:12 row_mask:0xf bank_mask:0xf
v_mfma_f32_16x16x32_bf16 v[112:115], v[104:107], v[64:67], v[112:115]
v_and_b32_dpp v104, v13, v4 row_newbcast:0 row_mask:0xf bank_mask:0xf
v_and_b32_dpp v105, v13, v5 row_newbcast:0 row_mask:0xf bank_mask:0xf
v_and_b32_dpp v106, v13, v6 row_newbcast:0 row_mask:0xf bank_mask:0xf
v_and_b32_dpp v107, v13, v7 row_newbcast:0 row_mask:0xf bank_mask:0xf
v_mfma_f32_16x16x32_bf16 v[112:115], v[108:111], v[68:71], v[112:115]
v_and_b32_dpp v108, v13, v4 row_newbcast:4 row_mask:0xf bank_mask:0xf
v_and_b32_dpp v109, v13, v5 row_newbcast:4 row_mask:0xf bank_mask:0xf
v_and_b32_dpp v110, v13, v6 row_newbcast:4 row_mask:0xf bank_mask:0xf
v_and_b32_dpp v111, v13, v7 row_newbcast:4 row_mask:0xf bank_mask:0xf
v_mfma_f32_16x16x32_bf16 v[112:115], v[104:107], v[72:75], v[112:115]
s_xor_b32 s64, s65, 71680
s_cmpk_gt_u32 s69, 99
s_waitcnt vmcnt(6)
s_cbranch_scc1 L_d_107
s_waitcnt vmcnt(5)
L_d_107:
buffer_load_dwordx4 v[200:203], v1, s[44:47], s64 offen nt
v_and_b32_dpp v104, v13, v4 row_newbcast:8 row_mask:0xf bank_mask:0xf
v_and_b32_dpp v105, v13, v5 row_newbcast:8 row_mask:0xf bank_mask:0xf
v_and_b32_dpp v106, v13, v6 row_newbcast:8 row_mask:0xf bank_mask:0xf
v_and_b32_dpp v107, v13, v7 row_newbcast:8 row_mask:0xf bank_mask:0xf
v_mfma_f32_16x16x32_bf16 v[112:115], v[108:111], v[76:79], v[112:115]
v_and_b32_dpp v108, v13, v4 row_newbcast:12 row_mask:0xf bank_mask:0xf
v_and_b32_dpp v109, v13, v5 row_newbcast:12 row_mask:0xf bank_mask:0xf
v_and_b32_dpp v110, v13, v6 row_newbcast:12 row_mask:0xf bank_mask:0xf
v_and_b32_dpp v111, v13, v7 row_newbcast:12 row_mask:0xf bank_mask:0xf
v_mfma_f32_16x16x32_bf16 v[112:115], v[104:107], v[80:83], v[112:115]
v_and_b32_dpp v104, v14, v4 row_newbcast:0 row_mask:0xf bank_mask:0xf
v_and_b32_dpp v105, v14, v5 row_newbcast:0 row_mask:0xf bank_mask:0xf
v_and_b32_dpp v106, v14, v6 row_newbcast:0 row_mask:0xf bank_mask:0xf
v_and_b32_dpp v107, v14, v7 row_newbcast:0 row_mask:0xf bank_mask:0xf
v_mfma_f32_16x16x32_bf16 v[112:115], v[108:111], v[96:99], v[112:115]
v_and_b32_dpp v108, v14, v4 row_newbcast:4 row_mask:0xf bank_mask:0xf
v_and_b32_dpp v109, v14, v5 row_newbcast:4 row_mask:0xf bank_mask:0xf
v_and_b32_dpp v110, v14, v6 row_newbcast:4 row_mask:0xf bank_mask:0xf
v_and_b32_dpp v111, v14, v7 row_newbcast:4 row_mask:0xf bank_mask:0xf
v_mfma_f32_16x16x32_bf16 v[112:115], v[104:107], v[120:123], v[112:115]
s_xor_b32 s64, s65, 5120
s_cmpk_gt_u32 s69, 100
s_waitcnt vmcnt(6)
s_cbranch_scc1 L_d_108
s_waitcnt vmcnt(5)
L_d_108:
buffer_load_dwordx4 v[204:207], v1, s[44:47], s64 offen nt
v_and_b32_dpp v104, v14, v4 row_newbcast:8 row_mask:0xf bank_mask:0xf
v_and_b32_dpp v105, v14, v5 row_newbcast:8 row_mask:0xf bank_mask:0xf
v_and_b32_dpp v106, v14, v6 row_newbcast:8 row_mask:0xf bank_mask:0xf
v_and_b32_dpp v107, v14, v7 row_newbcast:8 row_mask:0xf bank_mask:0xf
v_mfma_f32_16x16x32_bf16 v[112:115], v[108:111], v[124:127], v[112:115]
s_xor_b32 s64, s65, 70656
s_cmpk_gt_u32 s69, 101
s_waitcnt vmcnt(6)
s_cbranch_scc1 L_d_109
s_waitcnt vmcnt(5)
L_d_109:
buffer_load_dwordx4 v[208:211], v1, s[44:47], s64 offen nt
v_and_b32_dpp v108, v14, v4 row_newbcast:12 row_mask:0xf bank_mask:0xf
v_and_b32_dpp v109, v14, v5 row_newbcast:12 row_mask:0xf bank_mask:0xf
v_and_b32_dpp v110, v14, v6 row_newbcast:12 row_mask:0xf bank_mask:0xf
v_and_b32_dpp v111, v14, v7 row_newbcast:12 row_mask:0xf bank_mask:0xf
v_mfma_f32_16x16x32_bf16 v[112:115], v[104:107], v[128:131], v[112:115]
s_cmp_eq_u32 s34, 3
s_cbranch_scc0 L_w_111
v_mov_b32 v60, 38
s_mov_b64 exec, 1
buffer_store_dword v60, off, s[36:39], s63 offset:0
s_mov_b64 exec, -1
L_w_111:
s_xor_b32 s64, s65, 7168
s_cmpk_gt_u32 s69, 102
s_waitcnt vmcnt(6)
s_cbranch_scc1 L_d_110
s_waitcnt vmcnt(5)
L_d_110:
buffer_load_dwordx4 v[212:215], v1, s[44:47], s64 offen nt
v_and_b32_dpp v104, v15, v4 row_newbcast:0 row_mask:0xf bank_mask:0xf
v_and_b32_dpp v105, v15, v5 row_newbcast:0 row_mask:0xf bank_mask:0xf
v_and_b32_dpp v106, v15, v6 row_newbcast:0 row_mask:0xf bank_mask:0xf
v_and_b32_dpp v107, v15, v7 row_newbcast:0 row_mask:0xf bank_mask:0xf
v_mfma_f32_16x16x32_bf16 v[112:115], v[108:111], v[164:167], v[112:115]
s_xor_b32 s64, s65, 72704
s_cmpk_gt_u32 s69, 103
s_waitcnt vmcnt(6)
s_cbranch_scc1 L_d_112
s_waitcnt vmcnt(5)
L_d_112:
buffer_load_dwordx4 v[216:219], v1, s[44:47], s64 offen nt
v_and_b32_dpp v108, v15, v4 row_newbcast:4 row_mask:0xf bank_mask:0xf
v_and_b32_dpp v109, v15, v5 row_newbcast:4 row_mask:0xf bank_mask:0xf
v_and_b32_dpp v110, v15, v6 row_newbcast:4 row_mask:0xf bank_mask:0xf
v_and_b32_dpp v111, v15, v7 row_newbcast:4 row_mask:0xf bank_mask:0xf
v_mfma_f32_16x16x32_bf16 v[112:115], v[104:107], v[188:191], v[112:115]
s_xor_b32 s64, s65, 36864
s_cmpk_gt_u32 s69, 104
s_waitcnt vmcnt(6)
s_cbranch_scc1 L_d_113
s_waitcnt vmcnt(5)
L_d_113:
buffer_load_dwordx4 v[220:223], v1, s[44:47], s64 offen nt
v_and_b32_dpp v104, v15, v4 row_newbcast:8 row_mask:0xf bank_mask:0xf
v_and_b32_dpp v105, v15, v5 row_newbcast:8 row_mask:0xf bank_mask:0xf
v_and_b32_dpp v106, v15, v6 row_newbcast:8 row_mask:0xf bank_mask:0xf
v_and_b32_dpp v107, v15, v7 row_newbcast:8 row_mask:0xf bank_mask:0xf
v_mfma_f32_16x16x32_bf16 v[112:115], v[108:111], v[192:195], v[112:115]
s_xor_b32 s64, s65, 102400
s_cmpk_gt_u32 s69, 105
s_waitcnt vmcnt(6)
s_cbranch_scc1 L_d_114
s_waitcnt vmcnt(5)
L_d_114:
buffer_load_dwordx4 v[224:227], v1, s[44:47], s64 offen nt
v_and_b32_dpp v108, v15, v4 row_newbcast:12 row_mask:0xf bank_mask:0xf
v_and_b32_dpp v109, v15, v5 row_newbcast:12 row_mask:0xf bank_mask:0xf
v_and_b32_dpp v110, v15, v6 row_newbcast:12 row_mask:0xf bank_mask:0xf
v_and_b32_dpp v111, v15, v7 row_newbcast:12 row_mask:0xf bank_mask:0xf
v_mfma_f32_16x16x32_bf16 v[112:115], v[104:107], v[196:199], v[112:115]
s_xor_b32 s64, s65, 38912
s_cmpk_gt_u32 s69, 106
s_waitcnt vmcnt(6)
s_cbranch_scc1 L_d_115
s_waitcnt vmcnt(5)
L_d_115:
buffer_load_dwordx4 v[228:231], v1, s[44:47], s64 offen nt
v_and_b32_dpp v104, v16, v4 row_newbcast:0 row_mask:0xf bank_mask:0xf
v_and_b32_dpp v105, v16, v5 row_newbcast:0 row_mask:0xf bank_mask:0xf
v_and_b32_dpp v106, v16, v6 row_newbcast:0 row_mask:0xf bank_mask:0xf
v_and_b32_dpp v107, v16, v7 row_newbcast:0 row_mask:0xf bank_mask:0xf
v_mfma_f32_16x16x32_bf16 v[112:115], v[108:111], v[200:203], v[112:115]
s_xor_b32 s64, s65, 104448
s_cmpk_gt_u32 s69, 107
s_waitcnt vmcnt(6)
s_cbranch_scc1 L_d_116
s_waitcnt vmcnt(5)
L_d_116:
buffer_load_dwordx4 v[232:235], v1, s[44:47], s64 offen nt
v_and_b32_dpp v108, v16, v4 row_newbcast:4 row_mask:0xf bank_mask:0xf
v_and_b32_dpp v109, v16, v5 row_newbcast:4 row_mask:0xf bank_mask:0xf
v_and_b32_dpp v110, v16, v6 row_newbcast:4 row_mask:0xf bank_mask:0xf
v_and_b32_dpp v111, v16, v7 row_newbcast:4 row_mask:0xf bank_mask:0xf
v_mfma_f32_16x16x32_bf16 v[112:115], v[104:107], v[204:207], v[112:115]
s_xor_b32 s64, s65, 37888
s_cmpk_gt_u32 s69, 108
s_waitcnt vmcnt(6)
s_cbranch_scc1 L_d_117
s_waitcnt vmcnt(5)
L_d_117:
buffer_load_dwordx4 v[236:239], v1, s[44:47], s64 offen nt
v_and_b32_dpp v104, v16, v4 row_newbcast:8 row_mask:0xf bank_mask:0xf
v_and_b32_dpp v105, v16, v5 row_newbcast:8 row_mask:0xf bank_mask:0xf
v_and_b32_dpp v106, v16, v6 row_newbcast:8 row_mask:0xf bank_mask:0xf
v_and_b32_dpp v107, v16, v7 row_newbcast:8 row_mask:0xf bank_mask:0xf
v_mfma_f32_16x16x32_bf16 v[112:115], v[108:111], v[208:211], v[112:115]
s_xor_b32 s64, s65, 103424
s_cmpk_gt_u32 s69, 109
s_waitcnt vmcnt(6)
s_cbranch_scc1 L_d_118
s_waitcnt vmcnt(5)
L_d_118:
buffer_load_dwordx4 v[240:243], v1, s[44:47], s64 offen nt
v_and_b32_dpp v108, v16, v4 row_newbcast:12 row_mask:0xf bank_mask:0xf
v_and_b32_dpp v109, v16, v5 row_newbcast:12 row_mask:0xf bank_mask:0xf
v_and_b32_dpp v110, v16, v6 row_newbcast:12 row_mask:0xf bank_mask:0xf
v_and_b32_dpp v111, v16, v7 row_newbcast:12 row_mask:0xf bank_mask:0xf
v_mfma_f32_16x16x32_bf16 v[112:115], v[104:107], v[212:215], v[112:115]
s_cmp_eq_u32 s34, 0
s_cbranch_scc0 L_w_120
v_mov_b32 v60, 46
s_mov_b64 exec, 1
buffer_store_dword v60, off, s[36:39], s63 offset:0
s_mov_b64 exec, -1
L_w_120:
s_xor_b32 s64, s65, 39936
s_cmpk_gt_u32 s69, 110
s_waitcnt vmcnt(6)
s_cbranch_scc1 L_d_119
s_waitcnt vmcnt(5)
L_d_119:
buffer_load_dwordx4 v[244:247], v1, s[44:47], s64 offen nt
v_and_b32_dpp v104, v18, v4 row_newbcast:0 row_mask:0xf bank_mask:0xf
v_and_b32_dpp v105, v18, v5 row_newbcast:0 row_mask:0xf bank_mask:0xf
v_and_b32_dpp v106, v18, v6 row_newbcast:0 row_mask:0xf bank_mask:0xf
v_and_b32_dpp v107, v18, v7 row_newbcast:0 row_mask:0xf bank_mask:0xf
v_mfma_f32_16x16x32_bf16 v[112:115], v[108:111], v[216:219], v[112:115]
s_xor_b32 s64, s65, 105472
s_cmpk_gt_u32 s69, 111
s_waitcnt vmcnt(6)
s_cbranch_scc1 L_d_121
s_waitcnt vmcnt(5)
L_d_121:
buffer_load_dwordx4 v[248:251], v1, s[44:47], s64 offen nt
v_and_b32_dpp v108, v18, v4 row_newbcast:4 row_mask:0xf bank_mask:0xf
v_and_b32_dpp v109, v18, v5 row_newbcast:4 row_mask:0xf bank_mask:0xf
v_and_b32_dpp v110, v18, v6 row_newbcast:4 row_mask:0xf bank_mask:0xf
v_and_b32_dpp v111, v18, v7 row_newbcast:4 row_mask:0xf bank_mask:0xf
v_mfma_f32_16x16x32_bf16 v[112:115], v[104:107], v[220:223], v[112:115]
s_xor_b32 s64, s65, 135168
s_waitcnt vmcnt(5)
buffer_load_dwordx4 v[252:255], v1, s[44:47], s64 offen nt
v_and_b32_dpp v104, v18, v4 row_newbcast:8 row_mask:0xf bank_mask:0xf
v_and_b32_dpp v105, v18, v5 row_newbcast:8 row_mask:0xf bank_mask:0xf
v_and_b32_dpp v106, v18, v6 row_newbcast:8 row_mask:0xf bank_mask:0xf
v_and_b32_dpp v107, v18, v7 row_newbcast:8 row_mask:0xf bank_mask:0xf
v_mfma_f32_16x16x32_bf16 v[112:115], v[108:111], v[224:227], v[112:115]
v_and_b32_dpp v108, v18, v4 row_newbcast:12 row_mask:0xf bank_mask:0xf
v_and_b32_dpp v109, v18, v5 row_newbcast:12 row_mask:0xf bank_mask:0xf
v_and_b32_dpp v110, v18, v6 row_newbcast:12 row_mask:0xf bank_mask:0xf
v_and_b32_dpp v111, v18, v7 row_newbcast:12 row_mask:0xf bank_mask:0xf
v_mfma_f32_16x16x32_bf16 v[112:115], v[104:107], v[228:231], v[112:115]
s_xor_b32 s64, s65, 200704
s_waitcnt vmcnt(5)
buffer_load_dwordx4 v[88:91], v1, s[44:47], s64 offen nt
v_and_b32_dpp v104, v19, v4 row_newbcast:0 row_mask:0xf bank_mask:0xf
v_and_b32_dpp v105, v19, v5 row_newbcast:0 row_mask:0xf bank_mask:0xf
v_and_b32_dpp v106, v19, v6 row_newbcast:0 row_mask:0xf bank_mask:0xf
v_and_b32_dpp v107, v19, v7 row_newbcast:0 row_mask:0xf bank_mask:0xf
v_mfma_f32_16x16x32_bf16 v[112:115], v[108:111], v[232:235], v[112:115]
s_xor_b32 s64, s65, 137216
s_waitcnt vmcnt(5)
buffer_load_dwordx4 v[92:95], v1, s[44:47], s64 offen nt
v_and_b32_dpp v108, v19, v4 row_newbcast:4 row_mask:0xf bank_mask:0xf
v_and_b32_dpp v109, v19, v5 row_newbcast:4 row_mask:0xf bank_mask:0xf
v_and_b32_dpp v110, v19, v6 row_newbcast:4 row_mask:0xf bank_mask:0xf
v_and_b32_dpp v111, v19, v7 row_newbcast:4 row_mask:0xf bank_mask:0xf
v_mfma_f32_16x16x32_bf16 v[112:115], v[104:107], v[236:239], v[112:115]
s_xor_b32 s64, s65, 202752
s_waitcnt vmcnt(5)
buffer_load_dwordx4 v[132:135], v1, s[44:47], s64 offen nt
v_and_b32_dpp v104, v19, v4 row_newbcast:8 row_mask:0xf bank_mask:0xf
v_and_b32_dpp v105, v19, v5 row_newbcast:8 row_mask:0xf bank_mask:0xf
v_and_b32_dpp v106, v19, v6 row_newbcast:8 row_mask:0xf bank_mask:0xf
v_and_b32_dpp v107, v19, v7 row_newbcast:8 row_mask:0xf bank_mask:0xf
v_mfma_f32_16x16x32_bf16 v[112:115], v[108:111], v[240:243], v[112:115]
s_xor_b32 s64, s65, 136192
s_waitcnt vmcnt(5)
buffer_load_dwordx4 v[136:139], v1, s[44:47], s64 offen nt
v_and_b32_dpp v108, v19, v4 row_newbcast:12 row_mask:0xf bank_mask:0xf
v_and_b32_dpp v109, v19, v5 row_newbcast:12 row_mask:0xf bank_mask:0xf
v_and_b32_dpp v110, v19, v6 row_newbcast:12 row_mask:0xf bank_mask:0xf
v_and_b32_dpp v111, v19, v7 row_newbcast:12 row_mask:0xf bank_mask:0xf
v_mfma_f32_16x16x32_bf16 v[112:115], v[104:107], v[244:247], v[112:115]
s_xor_b32 s64, s65, 201728
s_waitcnt vmcnt(5)
buffer_load_dwordx4 v[140:143], v1, s[44:47], s64 offen nt
v_and_b32_dpp v104, v20, v4 row_newbcast:0 row_mask:0xf bank_mask:0xf
v_and_b32_dpp v105, v20, v5 row_newbcast:0 row_mask:0xf bank_mask:0xf
v_and_b32_dpp v106, v20, v6 row_newbcast:0 row_mask:0xf bank_mask:0xf
v_and_b32_dpp v107, v20, v7 row_newbcast:0 row_mask:0xf bank_mask:0xf
v_mfma_f32_16x16x32_bf16 v[112:115], v[108:111], v[248:251], v[112:115]
s_cmp_eq_u32 s34, 1
s_cbranch_scc0 L_w_122
v_mov_b32 v60, 54
s_mov_b64 exec, 1
buffer_store_dword v60, off, s[36:39], s63 offset:0
s_mov_b64 exec, -1
L_w_122:
s_xor_b32 s64, s65, 138240
s_waitcnt vmcnt(5)
buffer_load_dwordx4 v[144:147], v1, s[44:47], s64 offen nt
v_and_b32_dpp v108, v20, v4 row_newbcast:4 row_mask:0xf bank_mask:0xf
v_and_b32_dpp v109, v20, v5 row_newbcast:4 row_mask:0xf bank_mask:0xf
v_and_b32_dpp v110, v20, v6 row_newbcast:4 row_mask:0xf bank_mask:0xf
v_and_b32_dpp v111, v20, v7 row_newbcast:4 row_mask:0xf bank_mask:0xf
v_mfma_f32_16x16x32_bf16 v[112:115], v[104:107], v[252:255], v[112:115]
s_xor_b32 s64, s65, 203776
s_waitcnt vmcnt(5)
buffer_load_dwordx4 v[148:151], v1, s[44:47], s64 offen nt
v_and_b32_dpp v104, v20, v4 row_newbcast:8 row_mask:0xf bank_mask:0xf
v_and_b32_dpp v105, v20, v5 row_newbcast:8 row_mask:0xf bank_mask:0xf
v_and_b32_dpp v106, v20, v6 row_newbcast:8 row_mask:0xf bank_mask:0xf
v_and_b32_dpp v107, v20, v7 row_newbcast:8 row_mask:0xf bank_mask:0xf
v_mfma_f32_16x16x32_bf16 v[112:115], v[108:111], v[88:91], v[112:115]
s_xor_b32 s64, s65, 167936
s_waitcnt vmcnt(7)
buffer_load_dwordx4 v[152:155], v1, s[44:47], s64 offen nt
s_xor_b32 s64, s65, 233472
s_waitcnt vmcnt(7)
buffer_load_dwordx4 v[156:159], v1, s[44:47], s64 offen nt
s_cmp_lt_u32 s2, 208
s_cbranch_scc0 L_hp_123
v_lshlrev_b32 v160, 2, v0
buffer_load_dword v161, v160, s[36:39], s62 offen offset:0 sc1
L_hp_123:
s_xor_b32 s64, s65, 169984
s_waitcnt vmcnt(7)
buffer_load_dwordx4 v[176:179], v1, s[44:47], s64 offen nt
v_and_b32_dpp v108, v20, v4 row_newbcast:12 row_mask:0xf bank_mask:0xf
v_and_b32_dpp v109, v20, v5 row_newbcast:12 row_mask:0xf bank_mask:0xf
v_and_b32_dpp v110, v20, v6 row_newbcast:12 row_mask:0xf bank_mask:0xf
v_and_b32_dpp v111, v20, v7 row_newbcast:12 row_mask:0xf bank_mask:0xf
v_mfma_f32_16x16x32_bf16 v[112:115], v[104:107], v[92:95], v[112:115]
s_xor_b32 s64, s65, 235520
s_waitcnt vmcnt(7)
buffer_load_dwordx4 v[180:183], v1, s[44:47], s64 offen nt
v_and_b32_dpp v104, v21, v4 row_newbcast:0 row_mask:0xf bank_mask:0xf
v_and_b32_dpp v105, v21, v5 row_newbcast:0 row_mask:0xf bank_mask:0xf
v_and_b32_dpp v106, v21, v6 row_newbcast:0 row_mask:0xf bank_mask:0xf
v_and_b32_dpp v107, v21, v7 row_newbcast:0 row_mask:0xf bank_mask:0xf
v_mfma_f32_16x16x32_bf16 v[112:115], v[108:111], v[132:135], v[112:115]
s_xor_b32 s64, s65, 168960
s_waitcnt vmcnt(7)
buffer_load_dwordx4 v[184:187], v1, s[44:47], s64 offen nt
v_and_b32_dpp v108, v21, v4 row_newbcast:4 row_mask:0xf bank_mask:0xf
v_and_b32_dpp v109, v21, v5 row_newbcast:4 row_mask:0xf bank_mask:0xf
v_and_b32_dpp v110, v21, v6 row_newbcast:4 row_mask:0xf bank_mask:0xf
v_and_b32_dpp v111, v21, v7 row_newbcast:4 row_mask:0xf bank_mask:0xf
v_mfma_f32_16x16x32_bf16 v[112:115], v[104:107], v[136:139], v[112:115]
s_xor_b32 s64, s65, 234496
s_waitcnt vmcnt(7)
buffer_load_dwordx4 v[24:27], v1, s[44:47], s64 offen nt
v_and_b32_dpp v104, v21, v4 row_newbcast:8 row_mask:0xf bank_mask:0xf
v_and_b32_dpp v105, v21, v5 row_newbcast:8 row_mask:0xf bank_mask:0xf
v_and_b32_dpp v106, v21, v6 row_newbcast:8 row_mask:0xf bank_mask:0xf
v_and_b32_dpp v107, v21, v7 row_newbcast:8 row_mask:0xf bank_mask:0xf
v_mfma_f32_16x16x32_bf16 v[112:115], v[108:111], v[140:143], v[112:115]
s_cmp_eq_u32 s34, 2
s_cbranch_scc0 L_w_124
v_mov_b32 v60, 62
s_mov_b64 exec, 1
buffer_store_dword v60, off, s[36:39], s63 offset:0
s_mov_b64 exec, -1
L_w_124:
s_xor_b32 s64, s65, 171008
s_waitcnt vmcnt(7)
buffer_load_dwordx4 v[28:31], v1, s[44:47], s64 offen nt
v_and_b32_dpp v108, v21, v4 row_newbcast:12 row_mask:0xf bank_mask:0xf
v_and_b32_dpp v109, v21, v5 row_newbcast:12 row_mask:0xf bank_mask:0xf
v_and_b32_dpp v110, v21, v6 row_newbcast:12 row_mask:0xf bank_mask:0xf
v_and_b32_dpp v111, v21, v7 row_newbcast:12 row_mask:0xf bank_mask:0xf
v_mfma_f32_16x16x32_bf16 v[112:115], v[104:107], v[144:147], v[112:115]
s_xor_b32 s64, s65, 236544
s_waitcnt vmcnt(7)
buffer_load_dwordx4 v[32:35], v1, s[44:47], s64 offen nt
v_and_b32_dpp v104, v22, v4 row_newbcast:0 row_mask:0xf bank_mask:0xf
v_and_b32_dpp v105, v22, v5 row_newbcast:0 row_mask:0xf bank_mask:0xf
v_and_b32_dpp v106, v22, v6 row_newbcast:0 row_mask:0xf bank_mask:0xf
v_and_b32_dpp v107, v22, v7 row_newbcast:0 row_mask:0xf bank_mask:0xf
v_mfma_f32_16x16x32_bf16 v[112:115], v[108:111], v[148:151], v[112:115]
s_cmp_lt_u32 s2, 208
s_cbranch_scc0 L_nohelp
v_lshrrev_b32 v172, 3, v0
v_sub_u32 v172, 63, v172
v_and_b32 v168, 7, v0
v_lshlrev_b32 v168, 7, v168
v_bfe_u32 v162, v172, 0, 1
v_lshl_or_b32 v168, v162, 16, v168
v_bfe_u32 v162, v172, 1, 1
v_lshl_or_b32 v168, v162, 11, v168
v_bfe_u32 v162, v172, 2, 1
v_lshl_or_b32 v168, v162, 10, v168
v_bfe_u32 v162, v172, 3, 1
v_lshl_or_b32 v168, v162, 15, v168
v_bfe_u32 v162, v172, 4, 1
v_lshl_or_b32 v168, v162, 17, v168
v_bfe_u32 v162, v172, 5, 1
v_lshl_or_b32 v168, v162, 12, v168
v_lshrrev_b32 v173, 3, v0
v_sub_u32 v173, 55, v173
v_and_b32 v169, 7, v0
v_lshlrev_b32 v169, 7, v169
v_bfe_u32 v162, v173, 0, 1
v_lshl_or_b32 v169, v162, 16, v169
v_bfe_u32 v162, v173, 1, 1
v_lshl_or_b32 v169, v162, 11, v169
v_bfe_u32 v162, v173, 2, 1
v_lshl_or_b32 v169, v162, 10, v169
v_bfe_u32 v162, v173, 3, 1
v_lshl_or_b32 v169, v162, 15, v169
v_bfe_u32 v162, v173, 4, 1
v_lshl_or_b32 v169, v162, 17, v169
v_bfe_u32 v162, v173, 5, 1
v_lshl_or_b32 v169, v162, 12, v169
v_lshrrev_b32 v174, 3, v0
v_sub_u32 v174, 47, v174
v_and_b32 v170, 7, v0
v_lshlrev_b32 v170, 7, v170
v_bfe_u32 v162, v174, 0, 1
v_lshl_or_b32 v170, v162, 16, v170
v_bfe_u32 v162, v174, 1, 1
v_lshl_or_b32 v170, v162, 11, v170
v_bfe_u32 v162, v174, 2, 1
v_lshl_or_b32 v170, v162, 10, v170
v_bfe_u32 v162, v174, 3, 1
v_lshl_or_b32 v170, v162, 15, v170
v_bfe_u32 v162, v174, 4, 1
v_lshl_or_b32 v170, v162, 17, v170
v_bfe_u32 v162, v174, 5, 1
v_lshl_or_b32 v170, v162, 12, v170
v_lshrrev_b32 v175, 3, v0
v_sub_u32 v175, 39, v175
v_and_b32 v171, 7, v0
v_lshlrev_b32 v171, 7, v171
v_bfe_u32 v162, v175, 0, 1
v_lshl_or_b32 v171, v162, 16, v171
v_bfe_u32 v162, v175, 1, 1
v_lshl_or_b32 v171, v162, 11, v171
v_bfe_u32 v162, v175, 2, 1
v_lshl_or_b32 v171, v162, 10, v171
v_bfe_u32 v162, v175, 3, 1
v_lshl_or_b32 v171, v162, 15, v171
v_bfe_u32 v162, v175, 4, 1
v_lshl_or_b32 v171, v162, 17, v171
v_bfe_u32 v162, v175, 5, 1
v_lshl_or_b32 v171, v162, 12, v171
s_lshr_b32 s71, s2, 3
v_subrev_u32 v163, s71, v0
v_and_b32 v163, 31, v163
s_waitcnt vmcnt(6)
v_mov_b32 v162, v161
s_nop 1
v_permlane32_swap_b32 v161, v162
v_add_u32 v161, 1, v161
v_max_u32 v161, 7, v161
v_cmp_eq_u32 vcc, -1, v162
v_mov_b32 v160, 0xff
s_nop 0
v_cndmask_b32 v161, v160, v161, vcc
v_lshl_or_b32 v161, v161, 5, v163
s_nop 1
v_min_u32_dpp v161, v161, v161 quad_perm:[1,0,3,2] row_mask:0xf bank_mask:0xf
s_nop 1
v_min_u32_dpp v161, v161, v161 quad_perm:[2,3,0,1] row_mask:0xf bank_mask:0xf
s_nop 1
v_min_u32_dpp v161, v161, v161 row_ror:4 row_mask:0xf bank_mask:0xf
s_nop 1
v_min_u32_dpp v161, v161, v161 row_ror:8 row_mask:0xf bank_mask:0xf
s_nop 1
v_readlane_b32 s76, v161, 0
v_readlane_b32 s66, v161, 16
s_min_u32 s76, s76, s66
s_lshr_b32 s66, s76, 5
s_cmp_lt_u32 s66, 50
s_cbranch_scc0 L_drain
s_mov_b32 s48, s8
s_mov_b32 s49, s9
s_mov_b32 s50, 0x10000000
s_mov_b32 s51, 0x20000
s_lshr_b32 s64, s2, 3
s_add_u32 s76, s76, s64
s_and_b32 s76, s76, 31
s_lshl_b32 s67, s76, 2
s_add_u32 s67, s67, s62
s_lshl_b32 s76, s76, 3
s_and_b32 s64, s2, 7
s_or_b32 s76, s76, s64
s_and_b32 s64, s34, 1
s_lshl_b32 s64, s64, 14
s_lshr_b32 s71, s34, 1
s_lshl_b32 s71, s71, 13
s_or_b32 s64, s64, s71
s_lshl_b32 s71, s76, 10
s_xor_b32 s64, s64, s71
s_or_b32 s64, s64, 0xC0000
s_lshl_b32 s76, s76, 20
s_xor_b32 s76, s76, s64
s_add_u32 s66, s66, 11
v_xor_b32 v171, s76, v171
v_cmp_lt_u32 vcc, s66, v175
s_or_b64 exec, vcc, 1
buffer_load_dword v160, v171, s[48:51], 0 offen
s_mov_b64 exec, -1
v_xor_b32 v170, s76, v170
v_cmp_lt_u32 vcc, s66, v174
s_or_b64 exec, vcc, 1
buffer_load_dword v160, v170, s[48:51], 0 offen
s_mov_b64 exec, -1
v_xor_b32 v169, s76, v169
v_cmp_lt_u32 vcc, s66, v173
s_or_b64 exec, vcc, 1
buffer_load_dword v160, v169, s[48:51], 0 offen
s_mov_b64 exec, -1
v_xor_b32 v168, s76, v168
v_cmp_lt_u32 vcc, s66, v172
s_or_b64 exec, vcc, 1
buffer_load_dword v160, v168, s[48:51], 0 offen
s_mov_b64 exec, -1
s_mov_b64 exec, 1
buffer_store_dword v1, off, s[36:39], s67 offset:128
s_mov_b64 exec, -1
s_waitcnt vmcnt(12)
v_and_b32_dpp v108, v22, v4 row_newbcast:4 row_mask:0xf bank_mask:0xf
v_and_b32_dpp v109, v22, v5 row_newbcast:4 row_mask:0xf bank_mask:0xf
v_and_b32_dpp v110, v22, v6 row_newbcast:4 row_mask:0xf bank_mask:0xf
v_and_b32_dpp v111, v22, v7 row_newbcast:4 row_mask:0xf bank_mask:0xf
v_mfma_f32_16x16x32_bf16 v[112:115], v[104:107], v[152:155], v[112:115]
s_waitcnt vmcnt(11)
v_and_b32_dpp v104, v22, v4 row_newbcast:8 row_mask:0xf bank_mask:0xf
v_and_b32_dpp v105, v22, v5 row_newbcast:8 row_mask:0xf bank_mask:0xf
v_and_b32_dpp v106, v22, v6 row_newbcast:8 row_mask:0xf bank_mask:0xf
v_and_b32_dpp v107, v22, v7 row_newbcast:8 row_mask:0xf bank_mask:0xf
v_mfma_f32_16x16x32_bf16 v[112:115], v[108:111], v[156:159], v[112:115]
s_waitcnt vmcnt(10)
v_and_b32_dpp v108, v22, v4 row_newbcast:12 row_mask:0xf bank_mask:0xf
v_and_b32_dpp v109, v22, v5 row_newbcast:12 row_mask:0xf bank_mask:0xf
v_and_b32_dpp v110, v22, v6 row_newbcast:12 row_mask:0xf bank_mask:0xf
v_and_b32_dpp v111, v22, v7 row_newbcast:12 row_mask:0xf bank_mask:0xf
v_mfma_f32_16x16x32_bf16 v[112:115], v[104:107], v[176:179], v[112:115]
s_waitcnt vmcnt(9)
v_and_b32_dpp v104, v23, v4 row_newbcast:0 row_mask:0xf bank_mask:0xf
v_and_b32_dpp v105, v23, v5 row_newbcast:0 row_mask:0xf bank_mask:0xf
v_and_b32_dpp v106, v23, v6 row_newbcast:0 row_mask:0xf bank_mask:0xf
v_and_b32_dpp v107, v23, v7 row_newbcast:0 row_mask:0xf bank_mask:0xf
v_mfma_f32_16x16x32_bf16 v[112:115], v[108:111], v[180:183], v[112:115]
s_waitcnt vmcnt(8)
v_and_b32_dpp v108, v23, v4 row_newbcast:4 row_mask:0xf bank_mask:0xf
v_and_b32_dpp v109, v23, v5 row_newbcast:4 row_mask:0xf bank_mask:0xf
v_and_b32_dpp v110, v23, v6 row_newbcast:4 row_mask:0xf bank_mask:0xf
v_and_b32_dpp v111, v23, v7 row_newbcast:4 row_mask:0xf bank_mask:0xf
v_mfma_f32_16x16x32_bf16 v[112:115], v[104:107], v[184:187], v[112:115]
s_waitcnt vmcnt(7)
v_and_b32_dpp v104, v23, v4 row_newbcast:8 row_mask:0xf bank_mask:0xf
v_and_b32_dpp v105, v23, v5 row_newbcast:8 row_mask:0xf bank_mask:0xf
v_and_b32_dpp v106, v23, v6 row_newbcast:8 row_mask:0xf bank_mask:0xf
v_and_b32_dpp v107, v23, v7 row_newbcast:8 row_mask:0xf bank_mask:0xf
v_mfma_f32_16x16x32_bf16 v[112:115], v[108:111], v[24:27], v[112:115]
s_waitcnt vmcnt(6)
v_and_b32_dpp v108, v23, v4 row_newbcast:12 row_mask:0xf bank_mask:0xf
v_and_b32_dpp v109, v23, v5 row_newbcast:12 row_mask:0xf bank_mask:0xf
v_and_b32_dpp v110, v23, v6 row_newbcast:12 row_mask:0xf bank_mask:0xf
v_and_b32_dpp v111, v23, v7 row_newbcast:12 row_mask:0xf bank_mask:0xf
v_mfma_f32_16x16x32_bf16 v[112:115], v[104:107], v[28:31], v[112:115]
s_waitcnt vmcnt(5)
v_mfma_f32_16x16x32_bf16 v[112:115], v[108:111], v[32:35], v[112:115]
s_branch L_drained
L_nohelp:
L_drain:
s_waitcnt vmcnt(7)
v_and_b32_dpp v108, v22, v4 row_newbcast:4 row_mask:0xf bank_mask:0xf
v_and_b32_dpp v109, v22, v5 row_newbcast:4 row_mask:0xf bank_mask:0xf
v_and_b32_dpp v110, v22, v6 row_newbcast:4 row_mask:0xf bank_mask:0xf
v_and_b32_dpp v111, v22, v7 row_newbcast:4 row_mask:0xf bank_mask:0xf
v_mfma_f32_16x16x32_bf16 v[112:115], v[104:107], v[152:155], v[112:115]
s_waitcnt vmcnt(6)
v_and_b32_dpp v104, v22, v4 row_newbcast:8 row_mask:0xf bank_mask:0xf
v_and_b32_dpp v105, v22, v5 row_newbcast:8 row_mask:0xf bank_mask:0xf
v_and_b32_dpp v106, v22, v6 row_newbcast:8 row_mask:0xf bank_mask:0xf
v_and_b32_dpp v107, v22, v7 row_newbcast:8 row_mask:0xf bank_mask:0xf
v_mfma_f32_16x16x32_bf16 v[112:115], v[108:111], v[156:159], v[112:115]
s_waitcnt vmcnt(5)
v_and_b32_dpp v108, v22, v4 row_newbcast:12 row_mask:0xf bank_mask:0xf
v_and_b32_dpp v109, v22, v5 row_newbcast:12 row_mask:0xf bank_mask:0xf
v_and_b32_dpp v110, v22, v6 row_newbcast:12 row_mask:0xf bank_mask:0xf
v_and_b32_dpp v111, v22, v7 row_newbcast:12 row_mask:0xf bank_mask:0xf
v_mfma_f32_16x16x32_bf16 v[112:115], v[104:107], v[176:179], v[112:115]
s_waitcnt vmcnt(4)
v_and_b32_dpp v104, v23, v4 row_newbcast:0 row_mask:0xf bank_mask:0xf
v_and_b32_dpp v105, v23, v5 row_newbcast:0 row_mask:0xf bank_mask:0xf
v_and_b32_dpp v106, v23, v6 row_newbcast:0 row_mask:0xf bank_mask:0xf
v_and_b32_dpp v107, v23, v7 row_newbcast:0 row_mask:0xf bank_mask:0xf
v_mfma_f32_16x16x32_bf16 v[112:115], v[108:111], v[180:183], v[112:115]
s_waitcnt vmcnt(3)
v_and_b32_dpp v108, v23, v4 row_newbcast:4 row_mask:0xf bank_mask:0xf
v_and_b32_dpp v109, v23, v5 row_newbcast:4 row_mask:0xf bank_mask:0xf
v_and_b32_dpp v110, v23, v6 row_newbcast:4 row_mask:0xf bank_mask:0xf
v_and_b32_dpp v111, v23, v7 row_newbcast:4 row_mask:0xf bank_mask:0xf
v_mfma_f32_16x16x32_bf16 v[112:115], v[104:107], v[184:187], v[112:115]
s_waitcnt vmcnt(2)
v_and_b32_dpp v104, v23, v4 row_newbcast:8 row_mask:0xf bank_mask:0xf
v_and_b32_dpp v105, v23, v5 row_newbcast:8 row_mask:0xf bank_mask:0xf
v_and_b32_dpp v106, v23, v6 row_newbcast:8 row_mask:0xf bank_mask:0xf
v_and_b32_dpp v107, v23, v7 row_newbcast:8 row_mask:0xf bank_mask:0xf
v_mfma_f32_16x16x32_bf16 v[112:115], v[108:111], v[24:27], v[112:115]
s_waitcnt vmcnt(1)
v_and_b32_dpp v108, v23, v4 row_newbcast:12 row_mask:0xf bank_mask:0xf
v_and_b32_dpp v109, v23, v5 row_newbcast:12 row_mask:0xf bank_mask:0xf
v_and_b32_dpp v110, v23, v6 row_newbcast:12 row_mask:0xf bank_mask:0xf
v_and_b32_dpp v111, v23, v7 row_newbcast:12 row_mask:0xf bank_mask:0xf
v_mfma_f32_16x16x32_bf16 v[112:115], v[104:107], v[28:31], v[112:115]
s_waitcnt vmcnt(0)
v_mfma_f32_16x16x32_bf16 v[112:115], v[108:111], v[32:35], v[112:115]
L_drained:
v_and_b32 v2, 15, v0
v_lshlrev_b32 v2, 5, v2
v_and_b32 v3, 16, v0
v_add_u32 v2, v2, v3
s_lshl_b32 s68, s34, 9
v_add_u32 v2, s68, v2
s_mov_b32 exec_hi, 0
s_nop 1
ds_write_b128 v2, v[112:115] offset:512
s_mov_b32 exec_hi, -1
v_lshlrev_b32 v1, 4, v0
s_waitcnt lgkmcnt(0)
s_barrier
v_mov_b32 v2, 0
ds_read_b32 v3, v2 offset:328
s_waitcnt lgkmcnt(0)
v_readfirstlane_b32 s35, v3
s_branch L_tail_s
L_fin:
L_end:
s_endpgm
L_code_end:
.section .rodata,"a"
.p2align 6
.amdhsa_kernel adaLN_cond__sliding_block_cached__glu_gated_glu__decode_kernel
  .amdhsa_next_free_vgpr 256
  .amdhsa_next_free_sgpr 102
  .amdhsa_accum_offset 256
  .amdhsa_group_segment_fixed_size 0
  .amdhsa_kernarg_size 112
  .amdhsa_user_sgpr_count 2
  .amdhsa_user_sgpr_kernarg_segment_ptr 1
  .amdhsa_system_sgpr_workgroup_id_x 1
  .amdhsa_float_denorm_mode_32 3
.end_amdhsa_kernel
```

```asm
; @launch grid=(256,1,1) block=(512,1,1) lds=131072
.amdgcn_target "amdgcn-amd-amdhsa--gfx950"
.text
.globl adaLN_cond__sliding_block_cached__glu_gated_glu__decode_kernel
.p2align 8
.type adaLN_cond__sliding_block_cached__glu_gated_glu__decode_kernel,@function
adaLN_cond__sliding_block_cached__glu_gated_glu__decode_kernel:
L_code_begin:
s_load_dwordx16 s[4:19], s[0:1], 0
s_load_dwordx8 s[20:27], s[0:1], 64
s_load_dwordx4 s[28:31], s[0:1], 96
s_cmpk_ge_u32 s2, 256
s_cbranch_scc1 L_end
v_lshrrev_b32 v1, 6, v0
v_and_b32 v0, 63, v0
v_readfirstlane_b32 s3, v1
v_lshlrev_b32 v1, 4, v0
s_lshl_b32 s64, s2, 20
s_add_u32 s64, s64, 0xC0000
s_mov_b32 s42, 0x40000
s_mov_b32 s43, 0x20000
s_and_b32 s34, s3, 3
s_cmp_ge_u32 s3, 4
s_cbranch_scc1 L_helper
s_and_b32 s65, s34, 1
s_lshl_b32 s65, s65, 14
s_lshr_b32 s66, s34, 1
s_lshl_b32 s66, s66, 13
s_or_b32 s65, s65, s66
s_lshl_b32 s66, s2, 10
s_xor_b32 s65, s65, s66
s_waitcnt lgkmcnt(0)
s_add_u32 s40, s6, s64
s_addc_u32 s41, s7, 0
s_add_u32 s44, s8, s64
s_addc_u32 s45, s9, 0
buffer_load_dwordx4 v[8:11], v1, s[40:43], s65 offen nt
s_xor_b32 s64, s65, 65536
buffer_load_dwordx4 v[12:15], v1, s[40:43], s64 offen nt
s_xor_b32 s64, s65, 2048
buffer_load_dwordx4 v[16:19], v1, s[40:43], s64 offen nt
s_xor_b32 s64, s65, 67584
buffer_load_dwordx4 v[20:23], v1, s[40:43], s64 offen nt
s_barrier
s_branch L_srest
L_helper:
s_setprio 2
v_lshlrev_b32 v2, 2, v0
s_cmp_eq_u32 s3, 7
s_cbranch_scc0 L_nopf
s_getpc_b64 s[60:61]
L_pc:
s_lshr_b32 s66, s2, 3
s_lshl_b32 s66, s66, 10
v_add_u32 v10, s66, v1
v_min_u32 v10, L_code_end-L_pc-16, v10
global_load_dwordx4 v[12:15], v10, s[60:61]
v_subrev_u32 v3, 16, v0
v_ashrrev_i32 v3, 31, v3
ds_write_b32 v2, v3 offset:256
L_nopf:
s_and_b32 s67, s2, 7
s_lshr_b32 s68, s2, 3
v_and_b32 v38, 7, v0
v_lshrrev_b32 v37, 3, v0
s_cmp_eq_u32 s34, 0
s_cbranch_scc0 L_p0a
s_mov_b32 s70, 6
s_lshl_b32 s67, s67, 1
s_add_u32 s66, s67, 14
v_min_u32 v38, 5, v38
v_cmp_lt_u32 vcc, 1, v38
v_add_u32 v36, s66, v38
s_nop 0
v_cndmask_b32 v38, v38, v36, vcc
s_branch L_p0b
L_p0a:
s_lshl_b32 s67, s67, 3
s_lshl_b32 s65, s2, 3
s_and_b32 s65, s65, 0xff
s_lshr_b32 s66, s2, 5
s_or_b32 s65, s65, s66
s_cmp_eq_u32 s34, 2
s_cselect_b32 s70, 1, 8
s_cselect_b32 s68, s65, s68
s_cselect_b32 s67, 0, s67
L_p0b:
v_lshl_add_u32 v37, s68, 4, v37
v_mul_u32_u24 v37, s70, v37
v_lshl_add_u32 v38, v37, 3, v38
v_add_lshl_u32 v38, v38, s67, 7
s_lshl_b32 s70, s70, 13
v_add_u32 v39, s70, v38
s_sub_u32 s64, s2, 112
s_cmp_lt_u32 s64, 32
s_waitcnt lgkmcnt(0)
s_barrier
s_cbranch_scc1 L_jan
s_cmp_eq_u32 s34, 3
s_cbranch_scc1 L_p0_125
s_cmp_eq_u32 s34, 0
s_cselect_b32 s62, s24, s10
s_cselect_b32 s63, s25, s11
s_cmp_eq_u32 s34, 2
s_cselect_b32 s62, s12, s62
s_cselect_b32 s63, s13, s63
global_load_dword v12, v38, s[62:63]
global_load_dword v13, v39, s[62:63]
L_p0_125:
L_nop0:
s_cmp_eq_u32 s34, 3
s_cselect_b32 s64, 16, 0
s_cmp_lt_u32 s2, s64
s_cbranch_scc0 L_nopc
v_mov_b32 v4, -1
v_mov_b32 v5, -1
v_mov_b32 v6, -1
v_mov_b32 v7, -1
s_and_b32 s66, s2, 7
s_lshl_b32 s66, s66, 11
s_and_b32 s65, s2, 8
s_lshl_b32 s65, s65, 7
s_add_u32 s66, s66, s65
v_add_u32 v8, s66, v1
global_store_dwordx4 v8, v[4:7], s[30:31] sc1
s_lshl_b32 s66, s2, 2
v_mov_b32 v3, s66
s_waitcnt vmcnt(0)
s_mov_b64 exec, 1
global_store_dword v3, v4, s[28:29] sc1
s_mov_b64 exec, -1
L_nopc:
s_cmp_eq_u32 s34, 3
s_cbranch_scc0 L_w_126
s_and_b32 s67, s2, 7
s_lshr_b32 s68, s2, 3
s_min_u32 s64, s67, 3
s_mul_i32 s65, s67, 5
s_add_u32 s64, s64, s65
s_cmp_lt_u32 s67, 3
s_cselect_b32 s65, 6, 5
L_w_126:
s_lshr_b32 s32, s2, 5
s_and_b32 s33, s2, 31
s_and_b32 s67, s2, 7
s_lshr_b32 s68, s2, 3
s_sub_u32 s68, s68, 26
s_min_u32 s74, s67, 3
s_mul_i32 s66, s67, 5
s_add_u32 s74, s74, s66
s_add_u32 s74, s74, s68
s_cmp_lt_u32 s67, 3
s_cselect_b32 s66, 6, 5
s_cmp_lt_u32 s68, s66
s_cselect_b32 s74, s74, -1
s_cmp_lt_u32 s2, 48
s_cselect_b32 s66, 2, 3
s_cselect_b32 s72, 14+26, 42+26
s_cmp_lt_u32 s2, 16
s_cselect_b32 s66, 1, s66
s_cselect_b32 s72, 26, s72
s_lshl_b32 s66, s67, s66
s_add_u32 s72, s72, s66
s_add_u32 s72, s72, s68
s_mov_b32 s36, s30
s_mov_b32 s37, s31
s_mov_b32 s38, 0x1d0000
s_mov_b32 s39, 0x20000
s_mov_b32 s52, s28
s_mov_b32 s53, s29
s_mov_b32 s54, 0x100
s_mov_b32 s55, 0x20000
v_mov_b32 v9, 1
s_cmp_lt_u32 s2, 112
s_cbranch_scc0 L_norole
L_gemm:
v_and_b32 v16, 7, v0
v_lshlrev_b32 v16, 10, v16
v_and_b32 v17, 8, v0
v_lshl_add_u32 v16, v17, 3, v16
v_and_b32 v17, 48, v0
v_add_u32 v16, v16, v17
s_lshl_b32 s67, s34, 8
v_lshrrev_b32 v19, 3, v0
v_and_b32 v17, 2, v19
v_and_b32 v18, 7, v0
v_xor_b32 v17, v17, v18
v_xor_b32 v18, 4, v17
v_lshlrev_b32 v17, 4, v17
v_lshlrev_b32 v18, 4, v18
s_cmp_lt_u32 s2, 48
s_cbranch_scc0 L_gq0
s_mov_b32 s40, s24
s_mov_b32 s41, s25
s_mov_b32 s42, 0x300000
s_mov_b32 s43, 0x20000
s_mov_b32 s48, s22
s_mov_b32 s49, s23
s_mov_b32 s50, 0x2000
s_mov_b32 s51, 0x20000
s_mov_b32 s70, 6144
s_lshl_b32 s64, s72, 7
s_branch L_g1
L_gq0:
s_mov_b32 s40, s10
s_mov_b32 s41, s11
s_mov_b32 s42, 0x400000
s_mov_b32 s43, 0x20000
s_mov_b32 s48, s4
s_mov_b32 s49, s5
s_mov_b32 s50, 0x2000
s_mov_b32 s51, 0x20000
s_mov_b32 s70, 8192
s_sub_u32 s64, s72, 48
s_lshl_b32 s64, s64, 7
L_g1:
buffer_load_dwordx4 v[192:195], v16, s[48:51], s67 offen offset:0
buffer_load_dwordx4 v[196:199], v16, s[48:51], s67 offen offset:128
v_mul_lo_u32 v19, s70, v19
v_add_u32 v17, v17, v19
v_add_u32 v18, v18, v19
s_lshl_b32 s66, s70, 7
s_mul_i32 s66, s66, s34
s_add_u32 s64, s64, s66
s_lshl_b32 s70, s70, 3
s_lshl_b32 s65, s34, 13
s_add_u32 s65, s65, 4096
s_cmp_lt_u32 s2, 16
s_cselect_b32 s71, 0, 2
s_cmp_ge_u32 s2, 48
s_cselect_b32 s71, 1, s71
s_add_u32 m0, s65, 0
s_nop 0
buffer_load_dwordx4 v17, s[40:43], s64 offen  lds
s_add_u32 s64, s64, s70
s_add_u32 m0, s65, 1024
s_nop 0
buffer_load_dwordx4 v18, s[40:43], s64 offen  lds
s_add_u32 s64, s64, s70
s_cmp_eq_u32 s71, 2
s_cbranch_scc0 L_pace_127
s_waitcnt vmcnt(1)
L_pace_127:
s_add_u32 m0, s65, 2048
s_nop 0
buffer_load_dwordx4 v17, s[40:43], s64 offen  lds
s_add_u32 s64, s64, s70
s_cmp_eq_u32 s71, 0
s_cbranch_scc1 L_pace_128
s_waitcnt vmcnt(2)
s_cmp_eq_u32 s71, 2
s_cbranch_scc0 L_pace_128
s_waitcnt vmcnt(1)
L_pace_128:
s_add_u32 m0, s65, 3072
s_nop 0
buffer_load_dwordx4 v18, s[40:43], s64 offen  lds
s_add_u32 s64, s64, s70
s_cmp_eq_u32 s71, 0
s_cbranch_scc1 L_pace_129
s_waitcnt vmcnt(2)
s_cmp_eq_u32 s71, 2
s_cbranch_scc0 L_pace_129
s_waitcnt vmcnt(1)
L_pace_129:
s_add_u32 m0, s65, 4096
s_nop 0
buffer_load_dwordx4 v17, s[40:43], s64 offen  lds
s_add_u32 s64, s64, s70
s_cmp_eq_u32 s71, 0
s_cbranch_scc1 L_pace_130
s_waitcnt vmcnt(2)
s_cmp_eq_u32 s71, 2
s_cbranch_scc0 L_pace_130
s_waitcnt vmcnt(1)
L_pace_130:
s_add_u32 m0, s65, 5120
s_nop 0
buffer_load_dwordx4 v18, s[40:43], s64 offen  lds
s_add_u32 s64, s64, s70
s_cmp_eq_u32 s71, 0
s_cbranch_scc1 L_pace_131
s_waitcnt vmcnt(2)
s_cmp_eq_u32 s71, 2
s_cbranch_scc0 L_pace_131
s_waitcnt vmcnt(1)
L_pace_131:
s_add_u32 m0, s65, 6144
s_nop 0
buffer_load_dwordx4 v17, s[40:43], s64 offen  lds
s_add_u32 s64, s64, s70
s_cmp_eq_u32 s71, 0
s_cbranch_scc1 L_pace_132
s_waitcnt vmcnt(2)
s_cmp_eq_u32 s71, 2
s_cbranch_scc0 L_pace_132
s_waitcnt vmcnt(1)
L_pace_132:
s_add_u32 m0, s65, 7168
s_nop 0
buffer_load_dwordx4 v18, s[40:43], s64 offen  lds
s_add_u32 s64, s64, s70
s_cmp_eq_u32 s71, 0
s_cbranch_scc1 L_pace_133
s_waitcnt vmcnt(2)
s_cmp_eq_u32 s71, 2
s_cbranch_scc0 L_pace_133
s_waitcnt vmcnt(1)
L_pace_133:
s_add_u32 m0, s65, 32768
s_nop 0
buffer_load_dwordx4 v17, s[40:43], s64 offen  lds
s_add_u32 s64, s64, s70
s_cmp_eq_u32 s71, 0
s_cbranch_scc1 L_pace_134
s_waitcnt vmcnt(2)
s_cmp_eq_u32 s71, 2
s_cbranch_scc0 L_pace_134
s_waitcnt vmcnt(1)
L_pace_134:
s_add_u32 m0, s65, 33792
s_nop 0
buffer_load_dwordx4 v18, s[40:43], s64 offen  lds
s_add_u32 s64, s64, s70
s_cmp_eq_u32 s71, 0
s_cbranch_scc1 L_pace_135
s_waitcnt vmcnt(2)
s_cmp_eq_u32 s71, 2
s_cbranch_scc0 L_pace_135
s_waitcnt vmcnt(1)
L_pace_135:
s_add_u32 m0, s65, 34816
s_nop 0
buffer_load_dwordx4 v17, s[40:43], s64 offen  lds
s_add_u32 s64, s64, s70
s_cmp_eq_u32 s71, 0
s_cbranch_scc1 L_pace_136
s_waitcnt vmcnt(2)
s_cmp_eq_u32 s71, 2
s_cbranch_scc0 L_pace_136
s_waitcnt vmcnt(1)
L_pace_136:
s_add_u32 m0, s65, 35840
s_nop 0
buffer_load_dwordx4 v18, s[40:43], s64 offen  lds
s_add_u32 s64, s64, s70
s_cmp_eq_u32 s71, 0
s_cbranch_scc1 L_pace_137
s_waitcnt vmcnt(2)
s_cmp_eq_u32 s71, 2
s_cbranch_scc0 L_pace_137
s_waitcnt vmcnt(1)
L_pace_137:
s_add_u32 m0, s65, 36864
s_nop 0
buffer_load_dwordx4 v17, s[40:43], s64 offen  lds
s_add_u32 s64, s64, s70
s_cmp_eq_u32 s71, 0
s_cbranch_scc1 L_pace_138
s_waitcnt vmcnt(2)
s_cmp_eq_u32 s71, 2
s_cbranch_scc0 L_pace_138
s_waitcnt vmcnt(1)
L_pace_138:
s_add_u32 m0, s65, 37888
s_nop 0
buffer_load_dwordx4 v18, s[40:43], s64 offen  lds
s_add_u32 s64, s64, s70
s_cmp_eq_u32 s71, 0
s_cbranch_scc1 L_pace_139
s_waitcnt vmcnt(2)
s_cmp_eq_u32 s71, 2
s_cbranch_scc0 L_pace_139
s_waitcnt vmcnt(1)
L_pace_139:
s_add_u32 m0, s65, 38912
s_nop 0
buffer_load_dwordx4 v17, s[40:43], s64 offen  lds
s_add_u32 s64, s64, s70
s_cmp_eq_u32 s71, 0
s_cbranch_scc1 L_pace_140
s_waitcnt vmcnt(2)
s_cmp_eq_u32 s71, 2
s_cbranch_scc0 L_pace_140
s_waitcnt vmcnt(1)
L_pace_140:
s_add_u32 m0, s65, 39936
s_nop 0
buffer_load_dwordx4 v18, s[40:43], s64 offen  lds
s_add_u32 s64, s64, s70
s_waitcnt vmcnt(16)
s_cmp_eq_u32 s34, 0
s_cselect_b32 s73, 48, 0x1000
v_and_b32 v30, 15, v0
v_lshlrev_b32 v30, 2, v30
s_cmp_ge_u32 s2, s73
s_cbranch_scc0 L_fl_141
buffer_load_dword v31, v30, s[52:55], 0 offen sc1
L_fl_141:
s_mov_b32 s68, 0xffff0000
s_cmp_lt_u32 s2, 48
s_cbranch_scc0 L_gq1
s_mov_b32 s66, 0xbfb8aa3b
v_lshlrev_b32 v20, 16, v192
v_and_b32 v21, s68, v192
v_mul_f32 v22, s66, v20
v_mul_f32 v23, s66, v21
v_exp_f32 v22, v22
v_exp_f32 v23, v23
s_nop 0
v_add_f32 v22, 1.0, v22
v_add_f32 v23, 1.0, v23
v_rcp_f32 v22, v22
v_rcp_f32 v23, v23
s_nop 0
v_mul_f32 v20, v20, v22
v_mul_f32 v21, v21, v23
v_cvt_pk_bf16_f32 v48, v20, v21
v_lshlrev_b32 v20, 16, v193
v_and_b32 v21, s68, v193
v_mul_f32 v22, s66, v20
v_mul_f32 v23, s66, v21
v_exp_f32 v22, v22
v_exp_f32 v23, v23
s_nop 0
v_add_f32 v22, 1.0, v22
v_add_f32 v23, 1.0, v23
v_rcp_f32 v22, v22
v_rcp_f32 v23, v23
s_nop 0
v_mul_f32 v20, v20, v22
v_mul_f32 v21, v21, v23
v_cvt_pk_bf16_f32 v49, v20, v21
v_lshlrev_b32 v20, 16, v194
v_and_b32 v21, s68, v194
v_mul_f32 v22, s66, v20
v_mul_f32 v23, s66, v21
v_exp_f32 v22, v22
v_exp_f32 v23, v23
s_nop 0
v_add_f32 v22, 1.0, v22
v_add_f32 v23, 1.0, v23
v_rcp_f32 v22, v22
v_rcp_f32 v23, v23
s_nop 0
v_mul_f32 v20, v20, v22
v_mul_f32 v21, v21, v23
v_cvt_pk_bf16_f32 v50, v20, v21
v_lshlrev_b32 v20, 16, v195
v_and_b32 v21, s68, v195
v_mul_f32 v22, s66, v20
v_mul_f32 v23, s66, v21
v_exp_f32 v22, v22
v_exp_f32 v23, v23
s_nop 0
v_add_f32 v22, 1.0, v22
v_add_f32 v23, 1.0, v23
v_rcp_f32 v22, v22
v_rcp_f32 v23, v23
s_nop 0
v_mul_f32 v20, v20, v22
v_mul_f32 v21, v21, v23
v_cvt_pk_bf16_f32 v51, v20, v21
v_lshlrev_b32 v20, 16, v196
v_and_b32 v21, s68, v196
v_mul_f32 v22, s66, v20
v_mul_f32 v23, s66, v21
v_exp_f32 v22, v22
v_exp_f32 v23, v23
s_nop 0
v_add_f32 v22, 1.0, v22
v_add_f32 v23, 1.0, v23
v_rcp_f32 v22, v22
v_rcp_f32 v23, v23
s_nop 0
v_mul_f32 v20, v20, v22
v_mul_f32 v21, v21, v23
v_cvt_pk_bf16_f32 v52, v20, v21
v_lshlrev_b32 v20, 16, v197
v_and_b32 v21, s68, v197
v_mul_f32 v22, s66, v20
v_mul_f32 v23, s66, v21
v_exp_f32 v22, v22
v_exp_f32 v23, v23
s_nop 0
v_add_f32 v22, 1.0, v22
v_add_f32 v23, 1.0, v23
v_rcp_f32 v22, v22
v_rcp_f32 v23, v23
s_nop 0
v_mul_f32 v20, v20, v22
v_mul_f32 v21, v21, v23
v_cvt_pk_bf16_f32 v53, v20, v21
v_lshlrev_b32 v20, 16, v198
v_and_b32 v21, s68, v198
v_mul_f32 v22, s66, v20
v_mul_f32 v23, s66, v21
v_exp_f32 v22, v22
v_exp_f32 v23, v23
s_nop 0
v_add_f32 v22, 1.0, v22
v_add_f32 v23, 1.0, v23
v_rcp_f32 v22, v22
v_rcp_f32 v23, v23
s_nop 0
v_mul_f32 v20, v20, v22
v_mul_f32 v21, v21, v23
v_cvt_pk_bf16_f32 v54, v20, v21
v_lshlrev_b32 v20, 16, v199
v_and_b32 v21, s68, v199
v_mul_f32 v22, s66, v20
v_mul_f32 v23, s66, v21
v_exp_f32 v22, v22
v_exp_f32 v23, v23
s_nop 0
v_add_f32 v22, 1.0, v22
v_add_f32 v23, 1.0, v23
v_rcp_f32 v22, v22
v_rcp_f32 v23, v23
s_nop 0
v_mul_f32 v20, v20, v22
v_mul_f32 v21, v21, v23
v_cvt_pk_bf16_f32 v55, v20, v21
s_branch L_g2
L_gq1:
v_and_b32 v32, 7, v0
v_lshlrev_b32 v32, 2, v32
v_lshlrev_b32 v96, 16, v192
v_and_b32 v97, s68, v192
v_lshlrev_b32 v98, 16, v193
v_and_b32 v99, s68, v193
v_lshlrev_b32 v100, 16, v194
v_and_b32 v101, s68, v194
v_lshlrev_b32 v102, 16, v195
v_and_b32 v103, s68, v195
v_lshlrev_b32 v104, 16, v196
v_and_b32 v105, s68, v196
v_lshlrev_b32 v106, 16, v197
v_and_b32 v107, s68, v197
v_lshlrev_b32 v108, 16, v198
v_and_b32 v109, s68, v198
v_lshlrev_b32 v110, 16, v199
v_and_b32 v111, s68, v199
v_add_f32 v20, v96, v97
v_add_f32 v20, v20, v98
v_add_f32 v20, v20, v99
v_add_f32 v20, v20, v100
v_add_f32 v20, v20, v101
v_add_f32 v20, v20, v102
v_add_f32 v20, v20, v103
v_add_f32 v20, v20, v104
v_add_f32 v20, v20, v105
v_add_f32 v20, v20, v106
v_add_f32 v20, v20, v107
v_add_f32 v20, v20, v108
v_add_f32 v20, v20, v109
v_add_f32 v20, v20, v110
v_add_f32 v20, v20, v111
s_nop 1
v_add_f32_dpp v20, v20, v20 row_ror:8 row_mask:0xf bank_mask:0xf
v_mov_b32 v22, v20
s_nop 1
v_permlane16_swap_b32 v20, v22
s_nop 1
v_add_f32 v20, v20, v22
v_mov_b32 v22, v20
s_nop 1
v_permlane32_swap_b32 v20, v22
s_nop 1
v_add_f32 v20, v20, v22
v_mul_f32 v20, 0x3c000000, v20
v_mov_b32 v21, 0
v_sub_f32 v22, v96, v20
v_fmac_f32 v21, v22, v22
v_sub_f32 v22, v97, v20
v_fmac_f32 v21, v22, v22
v_sub_f32 v22, v98, v20
v_fmac_f32 v21, v22, v22
v_sub_f32 v22, v99, v20
v_fmac_f32 v21, v22, v22
v_sub_f32 v22, v100, v20
v_fmac_f32 v21, v22, v22
v_sub_f32 v22, v101, v20
v_fmac_f32 v21, v22, v22
v_sub_f32 v22, v102, v20
v_fmac_f32 v21, v22, v22
v_sub_f32 v22, v103, v20
v_fmac_f32 v21, v22, v22
v_sub_f32 v22, v104, v20
v_fmac_f32 v21, v22, v22
v_sub_f32 v22, v105, v20
v_fmac_f32 v21, v22, v22
v_sub_f32 v22, v106, v20
v_fmac_f32 v21, v22, v22
v_sub_f32 v22, v107, v20
v_fmac_f32 v21, v22, v22
v_sub_f32 v22, v108, v20
v_fmac_f32 v21, v22, v22
v_sub_f32 v22, v109, v20
v_fmac_f32 v21, v22, v22
v_sub_f32 v22, v110, v20
v_fmac_f32 v21, v22, v22
v_sub_f32 v22, v111, v20
v_fmac_f32 v21, v22, v22
s_nop 1
v_add_f32_dpp v21, v21, v21 row_ror:8 row_mask:0xf bank_mask:0xf
v_mov_b32 v22, v21
s_nop 1
v_permlane16_swap_b32 v21, v22
s_nop 1
v_add_f32 v21, v21, v22
v_mov_b32 v22, v21
s_nop 1
v_permlane32_swap_b32 v21, v22
s_nop 1
v_add_f32 v21, v21, v22
v_lshlrev_b32 v22, 1, v32
s_lshl_b32 s66, s34, 6
v_add_u32 v23, s66, v22
ds_write_b64 v23, v[20:21] offset:0
v_mov_b32 v23, 0
s_waitcnt lgkmcnt(0)
s_mov_b64 exec, 1
ds_add_u32 v23, v9 offset:332
s_mov_b64 exec, -1
s_mov_b32 s75, 0
L_poll_142:
ds_read_b32 v24, v23 offset:332
s_waitcnt lgkmcnt(0)
v_cmp_gt_u32 vcc, 4, v24
s_cbranch_vccz L_pollx_143
s_add_u32 s75, s75, 1
s_cmp_lt_u32 s75, 0x1000000
s_cbranch_scc1 L_poll_142
L_pollx_143:
ds_read_b64 v[112:113], v22 offset:0
ds_read_b64 v[114:115], v22 offset:64
ds_read_b64 v[116:117], v22 offset:128
ds_read_b64 v[118:119], v22 offset:192
s_waitcnt lgkmcnt(0)
v_add_f32 v20, v112, v114
v_add_f32 v21, v116, v118
v_add_f32 v20, v20, v21
v_mul_f32 v20, 0x3e800000, v20
v_add_f32 v24, v113, v115
v_add_f32 v21, v117, v119
v_add_f32 v24, v24, v21
v_mov_b32 v21, 0
v_sub_f32 v22, v112, v20
v_fmac_f32 v21, v22, v22
v_sub_f32 v22, v114, v20
v_fmac_f32 v21, v22, v22
v_sub_f32 v22, v116, v20
v_fmac_f32 v21, v22, v22
v_sub_f32 v22, v118, v20
v_fmac_f32 v21, v22, v22
v_fmac_f32 v24, 0x43000000, v21
v_mul_f32 v24, 0x3b000000, v24
v_cvt_pk_bf16_f32 v24, 0, v24
v_cvt_pk_bf16_f32 v20, 0, v20
v_add_f32 v24, 0x3727c5ac, v24
v_cvt_pk_bf16_f32 v24, 0, v24
v_sqrt_f32 v24, v24
s_nop 0
v_cvt_pk_bf16_f32 v24, 0, v24
v_rcp_f32 v24, v24
s_nop 0
v_sub_f32 v96, v96, v20
v_cvt_pk_bf16_f32 v96, 0, v96
v_mul_f32 v96, v96, v24
v_cvt_pk_bf16_f32 v96, 0, v96
v_sub_f32 v97, v97, v20
v_cvt_pk_bf16_f32 v97, 0, v97
v_mul_f32 v97, v97, v24
v_cvt_pk_bf16_f32 v97, 0, v97
v_sub_f32 v98, v98, v20
v_cvt_pk_bf16_f32 v98, 0, v98
v_mul_f32 v98, v98, v24
v_cvt_pk_bf16_f32 v98, 0, v98
v_sub_f32 v99, v99, v20
v_cvt_pk_bf16_f32 v99, 0, v99
v_mul_f32 v99, v99, v24
v_cvt_pk_bf16_f32 v99, 0, v99
v_sub_f32 v100, v100, v20
v_cvt_pk_bf16_f32 v100, 0, v100
v_mul_f32 v100, v100, v24
v_cvt_pk_bf16_f32 v100, 0, v100
v_sub_f32 v101, v101, v20
v_cvt_pk_bf16_f32 v101, 0, v101
v_mul_f32 v101, v101, v24
v_cvt_pk_bf16_f32 v101, 0, v101
v_sub_f32 v102, v102, v20
v_cvt_pk_bf16_f32 v102, 0, v102
v_mul_f32 v102, v102, v24
v_cvt_pk_bf16_f32 v102, 0, v102
v_sub_f32 v103, v103, v20
v_cvt_pk_bf16_f32 v103, 0, v103
v_mul_f32 v103, v103, v24
v_cvt_pk_bf16_f32 v103, 0, v103
v_sub_f32 v104, v104, v20
v_cvt_pk_bf16_f32 v104, 0, v104
v_mul_f32 v104, v104, v24
v_cvt_pk_bf16_f32 v104, 0, v104
v_sub_f32 v105, v105, v20
v_cvt_pk_bf16_f32 v105, 0, v105
v_mul_f32 v105, v105, v24
v_cvt_pk_bf16_f32 v105, 0, v105
v_sub_f32 v106, v106, v20
v_cvt_pk_bf16_f32 v106, 0, v106
v_mul_f32 v106, v106, v24
v_cvt_pk_bf16_f32 v106, 0, v106
v_sub_f32 v107, v107, v20
v_cvt_pk_bf16_f32 v107, 0, v107
v_mul_f32 v107, v107, v24
v_cvt_pk_bf16_f32 v107, 0, v107
v_sub_f32 v108, v108, v20
v_cvt_pk_bf16_f32 v108, 0, v108
v_mul_f32 v108, v108, v24
v_cvt_pk_bf16_f32 v108, 0, v108
v_sub_f32 v109, v109, v20
v_cvt_pk_bf16_f32 v109, 0, v109
v_mul_f32 v109, v109, v24
v_cvt_pk_bf16_f32 v109, 0, v109
v_sub_f32 v110, v110, v20
v_cvt_pk_bf16_f32 v110, 0, v110
v_mul_f32 v110, v110, v24
v_cvt_pk_bf16_f32 v110, 0, v110
v_sub_f32 v111, v111, v20
v_cvt_pk_bf16_f32 v111, 0, v111
v_mul_f32 v111, v111, v24
v_cvt_pk_bf16_f32 v111, 0, v111
L_g2:
s_cmp_ge_u32 s2, s73
s_cbranch_scc0 L_fl_144
s_waitcnt vmcnt(0)
v_cmp_eq_u32 vcc, 0, v31
s_cbranch_vccz L_fl_144
s_mov_b32 s75, 0
L_poll_145:
buffer_load_dword v31, v30, s[52:55], 0 offen sc1
s_waitcnt vmcnt(0)
v_cmp_eq_u32 vcc, 0, v31
s_cbranch_vccz L_pollx_146
s_sleep 40
s_add_u32 s75, s75, 1
s_cmp_lt_u32 s75, 0x100000
s_cbranch_scc1 L_poll_145
L_pollx_146:
L_fl_144:
v_mov_b32 v20, 0
s_cmp_eq_u32 s34, 0
s_cbranch_scc0 L_w_147
ds_write_b32 v20, v9 offset:324
L_w_147:
v_lshrrev_b32 v18, 4, v0
v_bfe_u32 v19, v0, 2, 2
v_lshrrev_b32 v20, 1, v19
v_and_b32 v21, 1, v18
v_lshl_add_u32 v20, v21, 1, v20
v_lshlrev_b32 v20, 5, v20
v_lshl_add_u32 v20, v18, 10, v20
v_lshl_add_u32 v20, v19, 7, v20
v_and_b32 v21, 3, v0
v_lshl_add_u32 v20, v21, 3, v20
v_add_u32 v40, s65, v20
v_xor_b32 v41, 32, v40
v_xor_b32 v42, 64, v40
v_xor_b32 v43, 96, v40
s_waitcnt vmcnt(12) lgkmcnt(0)
ds_read_b64_tr_b16 v[128:129], v40 offset:0
ds_read_b64_tr_b16 v[130:131], v40 offset:512
ds_read_b64_tr_b16 v[132:133], v41 offset:0
ds_read_b64_tr_b16 v[134:135], v41 offset:512
ds_read_b64_tr_b16 v[136:137], v42 offset:0
ds_read_b64_tr_b16 v[138:139], v42 offset:512
ds_read_b64_tr_b16 v[140:141], v43 offset:0
ds_read_b64_tr_b16 v[142:143], v43 offset:512
s_waitcnt vmcnt(8) lgkmcnt(0)
ds_read_b64_tr_b16 v[144:145], v40 offset:4096
ds_read_b64_tr_b16 v[146:147], v40 offset:4608
ds_read_b64_tr_b16 v[148:149], v41 offset:4096
ds_read_b64_tr_b16 v[150:151], v41 offset:4608
ds_read_b64_tr_b16 v[152:153], v42 offset:4096
ds_read_b64_tr_b16 v[154:155], v42 offset:4608
ds_read_b64_tr_b16 v[156:157], v43 offset:4096
ds_read_b64_tr_b16 v[158:159], v43 offset:4608
s_waitcnt vmcnt(4) lgkmcnt(0)
ds_read_b64_tr_b16 v[160:161], v40 offset:32768
ds_read_b64_tr_b16 v[162:163], v40 offset:33280
ds_read_b64_tr_b16 v[164:165], v41 offset:32768
ds_read_b64_tr_b16 v[166:167], v41 offset:33280
ds_read_b64_tr_b16 v[168:169], v42 offset:32768
ds_read_b64_tr_b16 v[170:171], v42 offset:33280
ds_read_b64_tr_b16 v[172:173], v43 offset:32768
ds_read_b64_tr_b16 v[174:175], v43 offset:33280
s_waitcnt vmcnt(0) lgkmcnt(0)
ds_read_b64_tr_b16 v[176:177], v40 offset:36864
ds_read_b64_tr_b16 v[178:179], v40 offset:37376
ds_read_b64_tr_b16 v[180:181], v41 offset:36864
ds_read_b64_tr_b16 v[182:183], v41 offset:37376
ds_read_b64_tr_b16 v[184:185], v42 offset:36864
ds_read_b64_tr_b16 v[186:187], v42 offset:37376
ds_read_b64_tr_b16 v[188:189], v43 offset:36864
ds_read_b64_tr_b16 v[190:191], v43 offset:37376
s_waitcnt lgkmcnt(0)
s_cmp_eq_u32 s34, 2
s_cselect_b32 s73, 16, 0x1000
v_and_b32 v30, 31, v0
v_lshlrev_b32 v30, 2, v30
s_cmp_ge_u32 s2, s73
s_cbranch_scc0 L_fl_148
buffer_load_dword v31, v30, s[52:55], 0 offen offset:128 sc1
L_fl_148:
s_cmp_lt_u32 s2, 48
s_cbranch_scc1 L_g3
v_mov_b32 v20, 0
s_mov_b32 s75, 0
L_poll_149:
ds_read_b32 v22, v20 offset:324
s_waitcnt lgkmcnt(0)
v_cmp_eq_u32 vcc, 0, v22
s_cbranch_vccz L_pollx_150
s_sleep 1
s_add_u32 s75, s75, 1
s_cmp_lt_u32 s75, 0x1000000
s_cbranch_scc1 L_poll_149
L_pollx_150:
s_lshl_b32 s64, s34, 11
s_add_u32 s64, s64, 0
s_add_u32 s66, s64, 8192
s_mov_b32 s75, 0
L_poll_151:
buffer_load_dwordx4 v[192:195], v1, s[36:39], s64 offen offset:0 sc1
buffer_load_dwordx4 v[200:203], v1, s[36:39], s66 offen offset:0 sc1
buffer_load_dwordx4 v[196:199], v1, s[36:39], s64 offen offset:1024 sc1
buffer_load_dwordx4 v[204:207], v1, s[36:39], s66 offen offset:1024 sc1
s_waitcnt vmcnt(0)
v_max3_u32 v22, v192, v193, v194
v_max3_u32 v22, v22, v195, v196
v_max3_u32 v22, v22, v197, v198
v_max3_u32 v22, v22, v199, v200
v_max3_u32 v22, v22, v201, v202
v_max3_u32 v22, v22, v203, v204
v_max3_u32 v22, v22, v205, v206
v_max_u32 v22, v22, v207
v_cmp_eq_u32 vcc, -1, v22
s_cbranch_vccz L_pollx_152
s_sleep 16
s_add_u32 s75, s75, 1
s_cmp_lt_u32 s75, 0x100000
s_cbranch_scc1 L_poll_151
L_pollx_152:
v_lshlrev_b32 v20, 16, v200
v_and_b32 v21, s68, v200
v_add_f32 v20, 1.0, v20
v_add_f32 v21, 1.0, v21
v_cvt_pk_bf16_f32 v20, 0, v20
v_cvt_pk_bf16_f32 v21, 0, v21
v_mul_f32 v20, v20, v96
v_mul_f32 v21, v21, v97
v_cvt_pk_bf16_f32 v20, 0, v20
v_cvt_pk_bf16_f32 v21, 0, v21
v_lshlrev_b32 v22, 16, v192
v_and_b32 v23, s68, v192
v_add_f32 v20, v20, v22
v_add_f32 v21, v21, v23
v_cvt_pk_bf16_f32 v48, v20, v21
v_lshlrev_b32 v20, 16, v201
v_and_b32 v21, s68, v201
v_add_f32 v20, 1.0, v20
v_add_f32 v21, 1.0, v21
v_cvt_pk_bf16_f32 v20, 0, v20
v_cvt_pk_bf16_f32 v21, 0, v21
v_mul_f32 v20, v20, v98
v_mul_f32 v21, v21, v99
v_cvt_pk_bf16_f32 v20, 0, v20
v_cvt_pk_bf16_f32 v21, 0, v21
v_lshlrev_b32 v22, 16, v193
v_and_b32 v23, s68, v193
v_add_f32 v20, v20, v22
v_add_f32 v21, v21, v23
v_cvt_pk_bf16_f32 v49, v20, v21
v_lshlrev_b32 v20, 16, v202
v_and_b32 v21, s68, v202
v_add_f32 v20, 1.0, v20
v_add_f32 v21, 1.0, v21
v_cvt_pk_bf16_f32 v20, 0, v20
v_cvt_pk_bf16_f32 v21, 0, v21
v_mul_f32 v20, v20, v100
v_mul_f32 v21, v21, v101
v_cvt_pk_bf16_f32 v20, 0, v20
v_cvt_pk_bf16_f32 v21, 0, v21
v_lshlrev_b32 v22, 16, v194
v_and_b32 v23, s68, v194
v_add_f32 v20, v20, v22
v_add_f32 v21, v21, v23
v_cvt_pk_bf16_f32 v50, v20, v21
v_lshlrev_b32 v20, 16, v203
v_and_b32 v21, s68, v203
v_add_f32 v20, 1.0, v20
v_add_f32 v21, 1.0, v21
v_cvt_pk_bf16_f32 v20, 0, v20
v_cvt_pk_bf16_f32 v21, 0, v21
v_mul_f32 v20, v20, v102
v_mul_f32 v21, v21, v103
v_cvt_pk_bf16_f32 v20, 0, v20
v_cvt_pk_bf16_f32 v21, 0, v21
v_lshlrev_b32 v22, 16, v195
v_and_b32 v23, s68, v195
v_add_f32 v20, v20, v22
v_add_f32 v21, v21, v23
v_cvt_pk_bf16_f32 v51, v20, v21
v_lshlrev_b32 v20, 16, v204
v_and_b32 v21, s68, v204
v_add_f32 v20, 1.0, v20
v_add_f32 v21, 1.0, v21
v_cvt_pk_bf16_f32 v20, 0, v20
v_cvt_pk_bf16_f32 v21, 0, v21
v_mul_f32 v20, v20, v104
v_mul_f32 v21, v21, v105
v_cvt_pk_bf16_f32 v20, 0, v20
v_cvt_pk_bf16_f32 v21, 0, v21
v_lshlrev_b32 v22, 16, v196
v_and_b32 v23, s68, v196
v_add_f32 v20, v20, v22
v_add_f32 v21, v21, v23
v_cvt_pk_bf16_f32 v52, v20, v21
v_lshlrev_b32 v20, 16, v205
v_and_b32 v21, s68, v205
v_add_f32 v20, 1.0, v20
v_add_f32 v21, 1.0, v21
v_cvt_pk_bf16_f32 v20, 0, v20
v_cvt_pk_bf16_f32 v21, 0, v21
v_mul_f32 v20, v20, v106
v_mul_f32 v21, v21, v107
v_cvt_pk_bf16_f32 v20, 0, v20
v_cvt_pk_bf16_f32 v21, 0, v21
v_lshlrev_b32 v22, 16, v197
v_and_b32 v23, s68, v197
v_add_f32 v20, v20, v22
v_add_f32 v21, v21, v23
v_cvt_pk_bf16_f32 v53, v20, v21
v_lshlrev_b32 v20, 16, v206
v_and_b32 v21, s68, v206
v_add_f32 v20, 1.0, v20
v_add_f32 v21, 1.0, v21
v_cvt_pk_bf16_f32 v20, 0, v20
v_cvt_pk_bf16_f32 v21, 0, v21
v_mul_f32 v20, v20, v108
v_mul_f32 v21, v21, v109
v_cvt_pk_bf16_f32 v20, 0, v20
v_cvt_pk_bf16_f32 v21, 0, v21
v_lshlrev_b32 v22, 16, v198
v_and_b32 v23, s68, v198
v_add_f32 v20, v20, v22
v_add_f32 v21, v21, v23
v_cvt_pk_bf16_f32 v54, v20, v21
v_lshlrev_b32 v20, 16, v207
v_and_b32 v21, s68, v207
v_add_f32 v20, 1.0, v20
v_add_f32 v21, 1.0, v21
v_cvt_pk_bf16_f32 v20, 0, v20
v_cvt_pk_bf16_f32 v21, 0, v21
v_mul_f32 v20, v20, v110
v_mul_f32 v21, v21, v111
v_cvt_pk_bf16_f32 v20, 0, v20
v_cvt_pk_bf16_f32 v21, 0, v21
v_lshlrev_b32 v22, 16, v199
v_and_b32 v23, s68, v199
v_add_f32 v20, v20, v22
v_add_f32 v21, v21, v23
v_cvt_pk_bf16_f32 v55, v20, v21
L_g3:
s_cmp_ge_u32 s2, s73
s_cbranch_scc0 L_fl_153
s_waitcnt vmcnt(0)
v_cmp_eq_u32 vcc, 0, v31
s_cbranch_vccz L_fl_153
s_mov_b32 s75, 0
L_poll_154:
buffer_load_dword v31, v30, s[52:55], 0 offen offset:128 sc1
s_waitcnt vmcnt(0)
v_cmp_eq_u32 vcc, 0, v31
s_cbranch_vccz L_pollx_155
s_sleep 40
s_add_u32 s75, s75, 1
s_cmp_lt_u32 s75, 0x100000
s_cbranch_scc1 L_poll_154
L_pollx_155:
L_fl_153:
s_nop 1
v_mfma_f32_16x16x32_bf16 v[64:67], v[128:131], v[48:51], 0
v_mfma_f32_16x16x32_bf16 v[68:71], v[132:135], v[48:51], 0
v_mfma_f32_16x16x32_bf16 v[72:75], v[136:139], v[48:51], 0
v_mfma_f32_16x16x32_bf16 v[76:79], v[140:143], v[48:51], 0
v_mfma_f32_16x16x32_bf16 v[80:83], v[144:147], v[48:51], 0
v_mfma_f32_16x16x32_bf16 v[84:87], v[148:151], v[48:51], 0
v_mfma_f32_16x16x32_bf16 v[88:91], v[152:155], v[48:51], 0
v_mfma_f32_16x16x32_bf16 v[92:95], v[156:159], v[48:51], 0
v_mfma_f32_16x16x32_bf16 v[64:67], v[160:163], v[52:55], v[64:67]
v_mfma_f32_16x16x32_bf16 v[68:71], v[164:167], v[52:55], v[68:71]
v_mfma_f32_16x16x32_bf16 v[72:75], v[168:171], v[52:55], v[72:75]
v_mfma_f32_16x16x32_bf16 v[76:79], v[172:175], v[52:55], v[76:79]
v_mfma_f32_16x16x32_bf16 v[80:83], v[176:179], v[52:55], v[80:83]
v_mfma_f32_16x16x32_bf16 v[84:87], v[180:183], v[52:55], v[84:87]
v_mfma_f32_16x16x32_bf16 v[88:91], v[184:187], v[52:55], v[88:91]
v_mfma_f32_16x16x32_bf16 v[92:95], v[188:191], v[52:55], v[92:95]
v_and_b32 v20, 7, v0
v_mul_u32_u24 v20, 272, v20
v_and_b32 v21, 8, v0
v_lshl_add_u32 v20, v21, 3, v20
v_and_b32 v21, 48, v0
v_add_u32 v20, v20, v21
s_mul_i32 s64, s34, 8192
s_add_u32 s64, s64, 4096
v_add_u32 v20, s64, v20
s_nop 7
v_add_f32_dpp v24, v80, v64 row_ror:8 row_mask:0xf bank_mask:0x3
v_add_f32_dpp v24, v68, v84 row_ror:8 row_mask:0xf bank_mask:0xc
v_add_f32_dpp v25, v81, v65 row_ror:8 row_mask:0xf bank_mask:0x3
v_add_f32_dpp v25, v69, v85 row_ror:8 row_mask:0xf bank_mask:0xc
v_add_f32_dpp v26, v82, v66 row_ror:8 row_mask:0xf bank_mask:0x3
v_add_f32_dpp v26, v70, v86 row_ror:8 row_mask:0xf bank_mask:0xc
v_add_f32_dpp v27, v83, v67 row_ror:8 row_mask:0xf bank_mask:0x3
v_add_f32_dpp v27, v71, v87 row_ror:8 row_mask:0xf bank_mask:0xc
ds_write_b128 v20, v[24:27] offset:0
v_add_f32_dpp v28, v88, v72 row_ror:8 row_mask:0xf bank_mask:0x3
v_add_f32_dpp v28, v76, v92 row_ror:8 row_mask:0xf bank_mask:0xc
v_add_f32_dpp v29, v89, v73 row_ror:8 row_mask:0xf bank_mask:0x3
v_add_f32_dpp v29, v77, v93 row_ror:8 row_mask:0xf bank_mask:0xc
v_add_f32_dpp v30, v90, v74 row_ror:8 row_mask:0xf bank_mask:0x3
v_add_f32_dpp v30, v78, v94 row_ror:8 row_mask:0xf bank_mask:0xc
v_add_f32_dpp v31, v91, v75 row_ror:8 row_mask:0xf bank_mask:0x3
v_add_f32_dpp v31, v79, v95 row_ror:8 row_mask:0xf bank_mask:0xc
ds_write_b128 v20, v[28:31] offset:128
v_mov_b32 v20, 0
s_waitcnt lgkmcnt(0)
s_mov_b64 exec, 1
ds_add_u32 v20, v9 offset:320
s_mov_b64 exec, -1
s_cmp_eq_u32 s34, 0
s_cbranch_scc0 L_waitq
s_cmp_lt_u32 s2, 16
s_cbranch_scc0 L_gq2
v_and_b32 v21, 7, v0
v_lshrrev_b32 v22, 4, v0
v_and_b32 v23, 8, v0
v_lshrrev_b32 v23, 1, v23
v_add_u32 v22, v22, v23
v_mov_b32 v23, v1
s_lshl_b32 s64, s72, 10
s_add_u32 s64, s64, 0
s_branch L_g4
L_gq2:
v_lshrrev_b32 v21, 3, v0
v_and_b32 v22, 7, v0
s_mov_b32 s64, 10240
s_cmp_lt_u32 s2, 48
s_cselect_b32 s64, 22528, s64
s_mov_b32 s65, 12288
v_mul_lo_u32 v23, s65, v21
v_lshl_add_u32 v23, v22, 4, v23
s_lshl_b32 s66, s72, 7
s_add_u32 s64, s64, s66
L_g4:
v_mul_u32_u24 v21, 272, v21
v_lshl_add_u32 v21, v22, 5, v21
v_add_u32 v21, 4096, v21
s_mov_b32 s75, 0
L_poll_156:
ds_read_b32 v22, v20 offset:320
s_waitcnt lgkmcnt(0)
v_cmp_gt_u32 vcc, 4, v22
s_cbranch_vccz L_pollx_157
s_add_u32 s75, s75, 1
s_cmp_lt_u32 s75, 0x1000000
s_cbranch_scc1 L_poll_156
L_pollx_157:
ds_read_b128 v[64:67], v21 offset:0
ds_read_b128 v[68:71], v21 offset:16
ds_read_b128 v[72:75], v21 offset:8192
ds_read_b128 v[76:79], v21 offset:8208
ds_read_b128 v[80:83], v21 offset:16384
ds_read_b128 v[84:87], v21 offset:16400
ds_read_b128 v[88:91], v21 offset:24576
ds_read_b128 v[92:95], v21 offset:24592
s_waitcnt lgkmcnt(0)
v_add_f32 v64, v64, v72
v_add_f32 v65, v65, v73
v_add_f32 v66, v66, v74
v_add_f32 v67, v67, v75
v_add_f32 v68, v68, v76
v_add_f32 v69, v69, v77
v_add_f32 v70, v70, v78
v_add_f32 v71, v71, v79
v_add_f32 v64, v64, v80
v_add_f32 v65, v65, v81
v_add_f32 v66, v66, v82
v_add_f32 v67, v67, v83
v_add_f32 v68, v68, v84
v_add_f32 v69, v69, v85
v_add_f32 v70, v70, v86
v_add_f32 v71, v71, v87
v_add_f32 v64, v64, v88
v_add_f32 v65, v65, v89
v_add_f32 v66, v66, v90
v_add_f32 v67, v67, v91
v_add_f32 v68, v68, v92
v_add_f32 v69, v69, v93
v_add_f32 v70, v70, v94
v_add_f32 v71, v71, v95
v_cvt_pk_bf16_f32 v24, v64, v65
v_cvt_pk_bf16_f32 v25, v66, v67
v_cvt_pk_bf16_f32 v26, v68, v69
v_cvt_pk_bf16_f32 v27, v70, v71
v_min_u32 v24, -2, v24
v_min_u32 v25, -2, v25
v_min_u32 v26, -2, v26
v_min_u32 v27, -2, v27
buffer_store_dwordx4 v[24:27], v23, s[36:39], s64 offen sc1
s_branch L_waitq
L_jan:
v_mov_b32 v4, -1
v_mov_b32 v5, -1
v_mov_b32 v6, -1
v_mov_b32 v7, -1
s_lshl_b32 s67, s64, 2
s_add_u32 s67, s67, s34
s_cmp_lt_u32 s67, 32
s_cselect_b32 s66, 0, 933888
s_mul_i32 s65, s67, 3072
s_add_u32 s65, s65, s66
s_add_u32 s65, s65, 16384
v_add_u32 v8, s65, v1
global_store_dwordx4 v8, v[4:7], s[30:31] offset:0 sc1
global_store_dwordx4 v8, v[4:7], s[30:31] offset:1024 sc1
global_store_dwordx4 v8, v[4:7], s[30:31] offset:2048 sc1
s_and_b32 s66, s67, 64
s_add_u32 s67, s67, s66
s_lshl_b32 s67, s67, 7
s_add_u32 s67, s67, 1343488
v_and_b32 v8, 8, v0
v_lshlrev_b32 v8, 10, v8
v_and_b32 v10, 0x70, v1
v_add3_u32 v8, v8, v10, s67
s_mov_b64 exec, 0xffff
global_store_dwordx4 v8, v[4:7], s[30:31] sc1
s_mov_b64 exec, 1
s_load_dword s68, s[30:31], 0x48000
s_and_b32 s65, s34, 1
s_lshl_b32 s66, s65, 13
s_xor_b32 s67, s67, s66
s_xor_b32 s66, s67, 0x2000
s_waitcnt vmcnt(0) lgkmcnt(0)
s_mov_b64 exec, -1
s_cmp_eq_u32 s34, 3
s_cbranch_scc1 L_p0_158
s_cmp_eq_u32 s34, 0
s_cselect_b32 s62, s24, s10
s_cselect_b32 s63, s25, s11
s_cmp_eq_u32 s34, 2
s_cselect_b32 s62, s12, s62
s_cselect_b32 s63, s13, s63
global_load_dword v12, v38, s[62:63]
global_load_dword v13, v39, s[62:63]
L_p0_158:
s_mov_b64 exec, 1
s_mov_b32 s70, 0
s_load_dword s68, s[30:31], s67
L_race_159:
s_getreg_b32 s69, hwreg(HW_REG_IB_STS, 8, 4)
s_add_u32 s70, s70, 1
s_cmp_eq_u32 s69, 0
s_cbranch_scc0 L_race_159
s_waitcnt lgkmcnt(0)
s_mov_b32 s71, 0
s_load_dword s68, s[30:31], s66
L_race_160:
s_getreg_b32 s69, hwreg(HW_REG_IB_STS, 8, 4)
s_add_u32 s71, s71, 1
s_cmp_eq_u32 s69, 0
s_cbranch_scc0 L_race_160
s_waitcnt lgkmcnt(0)
s_cmp_lt_u32 s71, s70
s_cselect_b32 s70, 1, 0
s_xor_b32 s70, s70, s65
s_getreg_b32 s69, hwreg(HW_REG_XCC_ID, 2, 1)
s_xor_b32 s70, s70, s69
s_lshl_b32 s69, s69, 14
s_lshl_b32 s70, s70, 8
s_add_u32 s70, s70, s69
s_add_u32 s70, s70, 1
v_mov_b32 v9, s70
s_lshl_b32 s65, s64, 2
v_mov_b32 v8, s65
ds_add_rtn_u32 v11, v2, v9 offset:320
s_waitcnt lgkmcnt(0)
v_add_u32 v11, v11, v9
v_and_b32 v10, 0xff, v11
v_cmp_eq_u32 vcc, 4, v10
s_cbranch_vccz L_j_161
global_store_dword v8, v11, s[28:29] offset:128 sc1
L_j_161:
s_mov_b64 exec, -1
s_branch L_nop0
L_norole:
s_cmp_eq_u32 s74, -1
s_cbranch_scc1 L_waitq
L_waitq:
s_cmp_eq_u32 s74, -1
s_cselect_b64 vcc, 0, -1
s_cmp_lt_u32 s2, 112
s_cselect_b64 vcc, -1, vcc
s_mov_b32 s44, s12
s_mov_b32 s45, s13
s_mov_b32 s46, 0x400000
s_mov_b32 s47, 0x20000
v_lshrrev_b32 v18, 4, v0
v_and_b32 v16, 15, v0
v_xor_b32 v16, v16, v18
v_xor_b32 v17, 4, v16
v_lshlrev_b32 v19, 10, v18
v_lshl_add_u32 v22, v16, 4, v19
v_lshl_add_u32 v23, v17, 4, v19
v_and_b32 v19, 1, v18
v_lshlrev_b32 v19, 10, v19
v_lshrrev_b32 v18, 1, v18
v_lshl_add_u32 v18, v18, 11, v19
v_lshl_add_u32 v16, v16, 4, v18
v_lshl_add_u32 v17, v17, 4, v18
v_lshrrev_b32 v18, 4, v0
v_bfe_u32 v19, v0, 2, 2
v_and_b32 v20, 2, v0
v_lshlrev_b32 v20, 2, v20
v_xor_b32 v20, v20, v19
v_and_b32 v21, 1, v18
v_lshlrev_b32 v21, 2, v21
v_xor_b32 v20, v20, v21
v_lshlrev_b32 v20, 4, v20
v_lshl_add_u32 v20, v18, 10, v20
v_lshl_add_u32 v20, v19, 8, v20
v_and_b32 v21, 1, v0
v_lshl_add_u32 v20, v21, 3, v20
s_lshl_b32 s65, s34, 13
s_add_u32 s65, s65, 8192
v_add_u32 v40, s65, v20
v_xor_b32 v41, 16, v40
v_xor_b32 v42, 32, v40
v_xor_b32 v43, 48, v40
v_xor_b32 v44, 64, v40
v_xor_b32 v45, 80, v40
v_xor_b32 v46, 96, v40
v_xor_b32 v47, 112, v40
s_lshl_b32 s64, s33, 17
s_lshl_b32 s66, s34, 8
s_add_u32 s64, s64, s66
s_mov_b32 s68, 0
s_lshl_b32 s66, s68, 10
s_add_u32 s64, s64, s66
s_add_u32 m0, s65, 0
s_xor_b32 s66, s64, 0
buffer_load_dwordx4 v16, s[44:47], s66 offen  lds
s_add_u32 m0, s65, 1024
s_xor_b32 s66, s64, 8192
buffer_load_dwordx4 v17, s[44:47], s66 offen  lds
s_add_u32 m0, s65, 2048
s_xor_b32 s66, s64, 16384
buffer_load_dwordx4 v16, s[44:47], s66 offen  lds
s_waitcnt vmcnt(2)
s_add_u32 m0, s65, 3072
s_xor_b32 s66, s64, 24576
buffer_load_dwordx4 v17, s[44:47], s66 offen  lds
s_waitcnt vmcnt(2)
s_add_u32 m0, s65, 32768
s_xor_b32 s66, s64, 4096
buffer_load_dwordx4 v16, s[44:47], s66 offen  lds
s_waitcnt vmcnt(2)
s_add_u32 m0, s65, 33792
s_xor_b32 s66, s64, 12288
buffer_load_dwordx4 v17, s[44:47], s66 offen  lds
s_waitcnt vmcnt(2)
ds_read_b64_tr_b16 v[128:129], v40 offset:0
ds_read_b64_tr_b16 v[136:137], v41 offset:0
ds_read_b64_tr_b16 v[144:145], v42 offset:0
ds_read_b64_tr_b16 v[152:153], v43 offset:0
ds_read_b64_tr_b16 v[160:161], v44 offset:0
ds_read_b64_tr_b16 v[168:169], v45 offset:0
ds_read_b64_tr_b16 v[176:177], v46 offset:0
ds_read_b64_tr_b16 v[184:185], v47 offset:0
s_add_u32 m0, s65, 34816
s_xor_b32 s66, s64, 20480
buffer_load_dwordx4 v16, s[44:47], s66 offen  lds
s_waitcnt vmcnt(2)
s_add_u32 m0, s65, 35840
s_xor_b32 s66, s64, 28672
buffer_load_dwordx4 v17, s[44:47], s66 offen  lds
s_waitcnt vmcnt(2)
s_waitcnt lgkmcnt(0)
s_add_u32 m0, s65, 0
s_xor_b32 s66, s64, 32768
buffer_load_dwordx4 v16, s[44:47], s66 offen  lds
s_waitcnt vmcnt(2)
s_add_u32 m0, s65, 1024
s_xor_b32 s66, s64, 40960
buffer_load_dwordx4 v17, s[44:47], s66 offen  lds
s_waitcnt vmcnt(2)
ds_read_b64_tr_b16 v[130:131], v40 offset:32768
ds_read_b64_tr_b16 v[138:139], v41 offset:32768
ds_read_b64_tr_b16 v[146:147], v42 offset:32768
ds_read_b64_tr_b16 v[154:155], v43 offset:32768
ds_read_b64_tr_b16 v[162:163], v44 offset:32768
ds_read_b64_tr_b16 v[170:171], v45 offset:32768
ds_read_b64_tr_b16 v[178:179], v46 offset:32768
ds_read_b64_tr_b16 v[186:187], v47 offset:32768
s_add_u32 m0, s65, 2048
s_xor_b32 s66, s64, 49152
buffer_load_dwordx4 v16, s[44:47], s66 offen  lds
s_waitcnt vmcnt(2)
s_add_u32 m0, s65, 3072
s_xor_b32 s66, s64, 57344
buffer_load_dwordx4 v17, s[44:47], s66 offen  lds
s_waitcnt vmcnt(2)
s_waitcnt lgkmcnt(0)
s_add_u32 m0, s65, 32768
s_xor_b32 s66, s64, 36864
buffer_load_dwordx4 v16, s[44:47], s66 offen  lds
s_waitcnt vmcnt(2)
s_add_u32 m0, s65, 33792
s_xor_b32 s66, s64, 45056
buffer_load_dwordx4 v17, s[44:47], s66 offen  lds
s_waitcnt vmcnt(2)
ds_read_b64_tr_b16 v[132:133], v40 offset:0
ds_read_b64_tr_b16 v[140:141], v41 offset:0
ds_read_b64_tr_b16 v[148:149], v42 offset:0
ds_read_b64_tr_b16 v[156:157], v43 offset:0
ds_read_b64_tr_b16 v[164:165], v44 offset:0
ds_read_b64_tr_b16 v[172:173], v45 offset:0
ds_read_b64_tr_b16 v[180:181], v46 offset:0
ds_read_b64_tr_b16 v[188:189], v47 offset:0
s_add_u32 m0, s65, 34816
s_xor_b32 s66, s64, 53248
buffer_load_dwordx4 v16, s[44:47], s66 offen  lds
s_waitcnt vmcnt(2)
s_add_u32 m0, s65, 35840
s_xor_b32 s66, s64, 61440
buffer_load_dwordx4 v17, s[44:47], s66 offen  lds
s_waitcnt vmcnt(2)
s_waitcnt lgkmcnt(0)
s_add_u32 m0, s65, 0
s_xor_b32 s66, s64, 65536
buffer_load_dwordx4 v16, s[44:47], s66 offen  lds
s_waitcnt vmcnt(2)
s_add_u32 m0, s65, 1024
s_xor_b32 s66, s64, 73728
buffer_load_dwordx4 v17, s[44:47], s66 offen  lds
s_waitcnt vmcnt(2)
ds_read_b64_tr_b16 v[134:135], v40 offset:32768
ds_read_b64_tr_b16 v[142:143], v41 offset:32768
ds_read_b64_tr_b16 v[150:151], v42 offset:32768
ds_read_b64_tr_b16 v[158:159], v43 offset:32768
ds_read_b64_tr_b16 v[166:167], v44 offset:32768
ds_read_b64_tr_b16 v[174:175], v45 offset:32768
ds_read_b64_tr_b16 v[182:183], v46 offset:32768
ds_read_b64_tr_b16 v[190:191], v47 offset:32768
s_add_u32 m0, s65, 2048
s_xor_b32 s66, s64, 81920
buffer_load_dwordx4 v16, s[44:47], s66 offen  lds
s_waitcnt vmcnt(2)
s_add_u32 m0, s65, 3072
s_xor_b32 s66, s64, 90112
buffer_load_dwordx4 v17, s[44:47], s66 offen  lds
s_waitcnt vmcnt(2)
s_waitcnt lgkmcnt(0)
s_add_u32 m0, s65, 32768
s_xor_b32 s66, s64, 69632
buffer_load_dwordx4 v16, s[44:47], s66 offen  lds
s_waitcnt vmcnt(2)
s_add_u32 m0, s65, 33792
s_xor_b32 s66, s64, 77824
buffer_load_dwordx4 v17, s[44:47], s66 offen  lds
s_waitcnt vmcnt(2)
ds_read_b64_tr_b16 v[192:193], v40 offset:0
ds_read_b64_tr_b16 v[200:201], v41 offset:0
ds_read_b64_tr_b16 v[208:209], v42 offset:0
ds_read_b64_tr_b16 v[216:217], v43 offset:0
ds_read_b64_tr_b16 v[224:225], v44 offset:0
ds_read_b64_tr_b16 v[232:233], v45 offset:0
ds_read_b64_tr_b16 v[240:241], v46 offset:0
ds_read_b64_tr_b16 v[248:249], v47 offset:0
s_add_u32 m0, s65, 34816
s_xor_b32 s66, s64, 86016
buffer_load_dwordx4 v16, s[44:47], s66 offen  lds
s_waitcnt vmcnt(2)
s_add_u32 m0, s65, 35840
s_xor_b32 s66, s64, 94208
buffer_load_dwordx4 v17, s[44:47], s66 offen  lds
s_waitcnt vmcnt(2)
s_waitcnt lgkmcnt(0)
s_add_u32 m0, s65, 0
s_xor_b32 s66, s64, 98304
buffer_load_dwordx4 v16, s[44:47], s66 offen  lds
s_waitcnt vmcnt(2)
s_add_u32 m0, s65, 1024
s_xor_b32 s66, s64, 106496
buffer_load_dwordx4 v17, s[44:47], s66 offen  lds
s_waitcnt vmcnt(2)
ds_read_b64_tr_b16 v[194:195], v40 offset:32768
ds_read_b64_tr_b16 v[202:203], v41 offset:32768
ds_read_b64_tr_b16 v[210:211], v42 offset:32768
ds_read_b64_tr_b16 v[218:219], v43 offset:32768
ds_read_b64_tr_b16 v[226:227], v44 offset:32768
ds_read_b64_tr_b16 v[234:235], v45 offset:32768
ds_read_b64_tr_b16 v[242:243], v46 offset:32768
ds_read_b64_tr_b16 v[250:251], v47 offset:32768
v_and_b32 v24, 127, v2
buffer_load_dword v25, v24, s[52:55], 0 offen offset:128
s_add_u32 m0, s65, 2048
s_xor_b32 s66, s64, 114688
buffer_load_dwordx4 v16, s[44:47], s66 offen  lds
s_waitcnt vmcnt(2)
s_add_u32 m0, s65, 3072
s_xor_b32 s66, s64, 122880
buffer_load_dwordx4 v17, s[44:47], s66 offen  lds
s_waitcnt vmcnt(2)
s_waitcnt lgkmcnt(0)
s_add_u32 m0, s65, 32768
s_xor_b32 s66, s64, 102400
buffer_load_dwordx4 v16, s[44:47], s66 offen  lds
s_waitcnt vmcnt(2)
s_add_u32 m0, s65, 33792
s_xor_b32 s66, s64, 110592
buffer_load_dwordx4 v17, s[44:47], s66 offen  lds
s_waitcnt vmcnt(2)
ds_read_b64_tr_b16 v[196:197], v40 offset:0
ds_read_b64_tr_b16 v[204:205], v41 offset:0
ds_read_b64_tr_b16 v[212:213], v42 offset:0
ds_read_b64_tr_b16 v[220:221], v43 offset:0
ds_read_b64_tr_b16 v[228:229], v44 offset:0
ds_read_b64_tr_b16 v[236:237], v45 offset:0
ds_read_b64_tr_b16 v[244:245], v46 offset:0
ds_read_b64_tr_b16 v[252:253], v47 offset:0
s_add_u32 m0, s65, 34816
s_xor_b32 s66, s64, 118784
buffer_load_dwordx4 v16, s[44:47], s66 offen  lds
s_waitcnt vmcnt(2)
s_add_u32 m0, s65, 35840
s_xor_b32 s66, s64, 126976
buffer_load_dwordx4 v17, s[44:47], s66 offen  lds
s_waitcnt vmcnt(0)
ds_read_b64_tr_b16 v[198:199], v40 offset:32768
ds_read_b64_tr_b16 v[206:207], v41 offset:32768
ds_read_b64_tr_b16 v[214:215], v42 offset:32768
ds_read_b64_tr_b16 v[222:223], v43 offset:32768
ds_read_b64_tr_b16 v[230:231], v44 offset:32768
ds_read_b64_tr_b16 v[238:239], v45 offset:32768
ds_read_b64_tr_b16 v[246:247], v46 offset:32768
ds_read_b64_tr_b16 v[254:255], v47 offset:32768
s_waitcnt lgkmcnt(0)
v_cmp_eq_u32 vcc, 0, v25
s_cbranch_vccz L_tab_162
s_mov_b32 s75, 0
L_poll_163:
buffer_load_dword v25, v24, s[52:55], 0 offen offset:128 sc1
s_waitcnt vmcnt(0)
v_cmp_eq_u32 vcc, 0, v25
s_cbranch_vccz L_pollx_164
s_sleep 40
s_add_u32 s75, s75, 1
s_cmp_lt_u32 s75, 0x100000
s_cbranch_scc1 L_poll_163
L_pollx_164:
L_tab_162:
v_bfe_u32 v26, v25, 8, 3
v_lshrrev_b32 v25, 16, v25
s_nop 0
v_add_u32_dpp v26, v26, v26 quad_perm:[1,0,3,2] row_mask:0xf bank_mask:0xf
s_nop 1
v_add_u32_dpp v26, v26, v26 quad_perm:[2,3,0,1] row_mask:0xf bank_mask:0xf
s_nop 1
v_add_u32_dpp v26, v26, v26 row_ror:4 row_mask:0xf bank_mask:0xf
s_nop 1
v_add_u32_dpp v26, v26, v26 row_ror:8 row_mask:0xf bank_mask:0xf
s_nop 1
v_readlane_b32 s66, v26, 0
v_readlane_b32 s71, v26, 16
s_add_u32 s66, s66, s71
s_cmp_gt_u32 s66, 64
s_cselect_b32 s66, 1, 0
v_cmp_ne_u32 vcc, s66, v25
s_and_b32 s71, vcc_lo, 0xff
s_bcnt0_i32_b32 s66, s71
s_sub_u32 s66, s66, 24
v_mbcnt_lo_u32_b32 v24, s71, 0
v_sub_u32 v25, v0, v24
v_add_u32 v24, s66, v24
v_cndmask_b32 v24, v25, v24, vcc
v_bfe_u32 v25, v24, 1, 2
v_and_b32 v26, 1, v24
v_lshl_or_b32 v25, v26, 2, v25
v_lshlrev_b32 v25, v2, v25
s_nop 1
v_or_b32_dpp v25, v25, v25 quad_perm:[1,0,3,2] row_mask:0xf bank_mask:0xf
s_nop 1
v_or_b32_dpp v25, v25, v25 quad_perm:[2,3,0,1] row_mask:0xf bank_mask:0xf
s_nop 1
v_or_b32_dpp v25, v25, v25 row_shl:4 row_mask:0xf bank_mask:0xf
s_nop 1
v_readfirstlane_b32 s35, v25
s_mov_b64 exec, 1
ds_write_b32 v2, v25 offset:328
s_mov_b64 exec, -1
s_sub_u32 s64, s2, 144
s_cmp_lt_u32 s64, 64
s_cbranch_scc0 L_rp_165
s_cmp_eq_u32 s34, 0
s_cbranch_scc0 L_rp_165
s_mov_b32 s48, s4
s_mov_b32 s49, s5
s_mov_b32 s50, 0x2000
s_mov_b32 s51, 0x20000
v_and_b32 v5, 15, v0
v_and_b32 v6, 16, v0
v_lshl_add_u32 v5, v6, 1, v5
v_and_b32 v6, 32, v0
v_lshrrev_b32 v6, 1, v6
v_add_u32 v5, v5, v6
v_lshlrev_b32 v5, 1, v5
v_and_b32 v6, 0x7c, v5
s_lshl_b32 s65, s64, 7
s_and_b32 s66, s65, 0x380
s_lshr_b32 s64, s64, 3
s_mul_i32 s64, s64, 12288
s_add_u32 s64, s64, s66
s_add_u32 s64, s64, 24576
buffer_load_ushort v18, v5, s[48:51], s65 offen
s_mov_b32 s75, 0
L_poll_166:
buffer_load_dword v19, v6, s[36:39], s64 offen offset:0 sc1
buffer_load_dword v20, v6, s[36:39], s64 offen offset:3072 sc1
s_waitcnt vmcnt(0)
v_max_u32 v16, v19, v20
v_cmp_eq_u32 vcc, -1, v16
s_cbranch_vccz L_pollx_167
s_sleep 40
s_add_u32 s75, s75, 1
s_cmp_lt_u32 s75, 0x100000
s_cbranch_scc1 L_poll_166
L_pollx_167:
v_and_b32 v16, 1, v0
v_lshlrev_b32 v16, 4, v16
v_xor_b32 v16, 16, v16
v_lshlrev_b32 v18, 16, v18
v_lshlrev_b32 v19, v16, v19
v_and_b32 v19, 0xffff0000, v19
v_lshlrev_b32 v20, v16, v20
v_and_b32 v20, 0xffff0000, v20
ds_write_b32 v2, v18 offset:4096
ds_write_b32 v2, v19 offset:4352
ds_write_b32 v2, v20 offset:4608
L_rp_165:
v_lshlrev_b32 v10, 3, v0
s_lshl_b32 s64, s34, 8
s_add_u32 s64, s64, 2560
s_lshr_b32 s66, s68, 1
v_xor_b32 v12, s66, v0
v_mov_b32 v14, 0
v_bfe_u32 v11, v12, 0, 1
v_lshl_or_b32 v14, v11, 0, v14
v_bfe_u32 v11, v12, 1, 1
v_lshl_or_b32 v14, v11, 1, v14
v_bfe_u32 v11, v12, 2, 1
v_lshl_or_b32 v14, v11, 2, v14
v_bfe_u32 v11, v12, 3, 1
v_lshl_or_b32 v14, v11, 3, v14
v_bfe_u32 v11, v12, 4, 1
v_lshl_or_b32 v14, v11, 4, v14
v_bfe_u32 v11, v12, 5, 1
v_lshl_or_b32 v14, v11, 5, v14
v_and_b32 v11, 0x38, v14
v_and_b32 v12, 1, v14
v_lshl_add_u32 v11, v12, 2, v11
v_bfe_u32 v12, v14, 1, 2
v_add_u32 v11, v11, v12
v_lshl_add_u32 v11, v11, 2, s64
v_and_b32 v14, 1, v0
v_and_b32 v12, 48, v0
v_lshlrev_b32 v12, 1, v12
v_lshl_add_u32 v12, v14, 4, v12
v_add_u32 v12, s64, v12
v_mul_u32_u24 v15, 0xaaaa, v14
v_add_u32 v15, 0x4444, v15
v_mov_b32 v64, 0
v_mov_b32 v65, 0
v_mov_b32 v66, 0
v_mov_b32 v67, 0
v_mov_b32 v68, 0
v_mov_b32 v69, 0
v_mov_b32 v70, 0
v_mov_b32 v71, 0
v_mov_b32 v72, 0
v_mov_b32 v73, 0
v_mov_b32 v74, 0
v_mov_b32 v75, 0
v_mov_b32 v76, 0
v_mov_b32 v77, 0
v_mov_b32 v78, 0
v_mov_b32 v79, 0
v_mov_b32 v80, 0
v_mov_b32 v81, 0
v_mov_b32 v82, 0
v_mov_b32 v83, 0
v_mov_b32 v84, 0
v_mov_b32 v85, 0
v_mov_b32 v86, 0
v_mov_b32 v87, 0
v_mov_b32 v88, 0
v_mov_b32 v89, 0
v_mov_b32 v90, 0
v_mov_b32 v91, 0
v_mov_b32 v92, 0
v_mov_b32 v93, 0
v_mov_b32 v94, 0
v_mov_b32 v95, 0
s_lshl_b32 s64, s34, 3
s_lshr_b32 s64, s35, s64
v_bfe_u32 v13, v0, 3, 1
v_lshlrev_b32 v13, 2, v13
v_bfe_u32 v13, s64, v13, 3
v_and_b32 v14, 0x70, v1
v_lshl_add_u32 v13, v13, 12, v14
s_lshl_b32 s64, s34, 2
s_add_u32 s64, s64, s33
v_bfe_u32 v14, v0, 3, 1
v_lshl_add_u32 v14, v14, 1, s64
v_and_b32 v14, 31, v14
v_lshl_add_u32 v13, v14, 7, v13
s_lshl_b32 s69, s32, 15
s_add_u32 s69, s69, 1048576
s_waitcnt vmcnt(0) lgkmcnt(0)
s_barrier
ds_read_b64 v[20:21], v10 offset:512
ds_read_b64 v[22:23], v10 offset:1024
ds_read_b64 v[24:25], v10 offset:1536
ds_read_b64 v[26:27], v10 offset:2048
s_waitcnt lgkmcnt(2)
v_pk_add_f32 v[20:21], v[20:21], v[22:23]
s_waitcnt lgkmcnt(1)
v_pk_add_f32 v[20:21], v[20:21], v[24:25]
s_waitcnt lgkmcnt(0)
v_pk_add_f32 v[20:21], v[20:21], v[26:27]
v_cvt_pk_bf16_f32 v20, v20, v21
ds_write_b32 v11, v20
ds_read_b128 v[48:51], v12 offset:0
ds_read_b128 v[52:55], v12 offset:128
s_waitcnt lgkmcnt(1)
v_smfmac_f32_16x16x64_bf16 v[64:67], v[48:51], v[128:135], v15
v_smfmac_f32_16x16x64_bf16 v[68:71], v[48:51], v[136:143], v15
v_smfmac_f32_16x16x64_bf16 v[72:75], v[48:51], v[144:151], v15
v_smfmac_f32_16x16x64_bf16 v[76:79], v[48:51], v[152:159], v15
s_waitcnt lgkmcnt(0)
v_smfmac_f32_16x16x64_bf16 v[64:67], v[52:55], v[192:199], v15
v_smfmac_f32_16x16x64_bf16 v[68:71], v[52:55], v[200:207], v15
v_smfmac_f32_16x16x64_bf16 v[72:75], v[52:55], v[208:215], v15
v_smfmac_f32_16x16x64_bf16 v[76:79], v[52:55], v[216:223], v15
v_smfmac_f32_16x16x64_bf16 v[80:83], v[48:51], v[160:167], v15
v_smfmac_f32_16x16x64_bf16 v[84:87], v[48:51], v[168:175], v15
v_smfmac_f32_16x16x64_bf16 v[88:91], v[48:51], v[176:183], v15
v_smfmac_f32_16x16x64_bf16 v[92:95], v[48:51], v[184:191], v15
v_smfmac_f32_16x16x64_bf16 v[80:83], v[52:55], v[224:231], v15
v_add_f32 v64, v64, v65
v_smfmac_f32_16x16x64_bf16 v[84:87], v[52:55], v[232:239], v15
v_add_f32 v68, v68, v69
v_add_f32 v72, v72, v73
v_smfmac_f32_16x16x64_bf16 v[88:91], v[52:55], v[240:247], v15
v_add_f32 v76, v76, v77
v_cvt_pk_bf16_f32 v20, v64, v68
v_smfmac_f32_16x16x64_bf16 v[92:95], v[52:55], v[248:255], v15
v_cvt_pk_bf16_f32 v21, v72, v76
v_add_f32 v80, v80, v81
s_mov_b64 exec, 0xffff
v_add_f32 v84, v84, v85
v_cvt_pk_bf16_f32 v22, v80, v84
s_nop 0
v_add_f32 v88, v88, v89
s_nop 0
v_add_f32 v92, v92, v93
v_cvt_pk_bf16_f32 v23, v88, v92
buffer_store_dwordx4 v[20:23], v13, s[36:39], s69 offen sc1
s_mov_b64 exec, -1
s_sub_u32 s67, s2, 16
s_cmp_lt_u32 s67, 128
s_cbranch_scc0 L_nogp
s_and_b32 s66, s2, 7
s_min_u32 s64, s66, 3
s_mul_i32 s71, s66, 5
s_add_u32 s64, s64, s71
s_cmp_lt_u32 s66, 3
s_cselect_b32 s66, 5, 4
v_and_b32 v8, 7, v0
v_min_u32 v8, s66, v8
v_add_u32 v8, s64, v8
s_and_b32 s64, s67, 0xf8
s_lshl_b32 s64, s64, 2
s_lshl_b32 s66, s34, 3
s_add_u32 s64, s64, s66
v_lshrrev_b32 v9, 3, v0
v_add_u32 v9, s64, v9
v_mul_u32_u24 v9, 2752, v9
v_lshl_add_u32 v8, v8, 6, v9
global_load_dword v10, v8, s[16:17]
global_load_dword v11, v8, s[18:19]
s_and_b32 s66, s2, 7
s_min_u32 s70, s66, 3
s_mul_i32 s71, s66, 5
s_add_u32 s70, s70, s71
s_cmp_lt_u32 s66, 3
s_cselect_b32 s66, 6, 5
s_lshl_b32 s66, s66, 8
s_sub_u32 s66, s66, 1
s_lshr_b32 s71, s67, 3
s_lshl_b32 s71, s71, 2
s_add_u32 s71, s71, s34
s_mul_i32 s71, s71, 24
v_min_u32 v12, 23, v0
v_add_u32 v12, s71, v12
v_min_u32 v12, s66, v12
s_lshl_b32 s70, s70, 15
v_lshl_add_u32 v12, v12, 7, s70
global_load_dword v13, v12, s[20:21]
s_endpgm
L_nogp:
L_tail_s:
s_cmp_eq_u32 s74, -1
s_cbranch_scc0 L_ffn
s_cmp_eq_u32 s3, 0
s_cbranch_scc0 L_fin
s_sub_u32 s70, s2, 144
s_cmp_lt_u32 s70, 64
s_cbranch_scc0 L_fin
s_lshl_b32 s64, s70, 2
s_lshr_b32 s67, s35, s64
s_and_b32 s71, s67, 7
s_andn2_b32 s66, s70, 7
s_add_u32 s66, s66, s71
s_lshl_b32 s66, s66, 12
s_add_u32 s66, s66, 1048576
buffer_load_dwordx4 v[16:19], v1, s[36:39], s66 offen offset:0 sc1
buffer_load_dwordx4 v[20:23], v1, s[36:39], s66 offen offset:1024 sc1
buffer_load_dwordx4 v[24:27], v1, s[36:39], s66 offen offset:2048 sc1
buffer_load_dwordx4 v[28:31], v1, s[36:39], s66 offen offset:3072 sc1
v_mov_b32 v32, -1
v_mov_b32 v33, -1
v_mov_b32 v34, -1
v_mov_b32 v35, -1
s_and_b32 s64, s71, 6
s_lshl_b32 s64, s64, 12
s_and_b32 s65, s71, 1
s_lshl_b32 s65, s65, 15
s_or_b32 s64, s64, s65
s_lshr_b32 s65, s70, 3
s_lshl_b32 s65, s65, 16
s_add_u32 s64, s64, s65
s_lshr_b32 s65, s70, 4
s_lshl_b32 s65, s65, 2
s_and_b32 s67, s70, 7
s_add_u32 s65, s65, s67
s_lshl_b32 s65, s65, 7
s_add_u32 s64, s64, s65
s_add_u32 s64, s64, 1376256
s_add_u32 s65, s64, 4096
buffer_store_dwordx4 v[32:35], v1, s[36:39], s64 offen offset:0 sc1
buffer_store_dwordx4 v[32:35], v1, s[36:39], s64 offen offset:1024 sc1
buffer_store_dwordx4 v[32:35], v1, s[36:39], s64 offen offset:2048 sc1
buffer_store_dwordx4 v[32:35], v1, s[36:39], s64 offen offset:3072 sc1
buffer_store_dwordx4 v[32:35], v1, s[36:39], s65 offen offset:0 sc1
s_mov_b64 exec, 0xffffff
buffer_store_dwordx4 v[32:35], v1, s[36:39], s65 offen offset:1024 sc1
s_mov_b64 exec, -1
v_lshlrev_b32 v2, 2, v0
ds_read_b32 v8, v2 offset:4096
ds_read_b32 v9, v2 offset:4352
ds_read_b32 v10, v2 offset:4608
s_mov_b32 s56, s26
s_mov_b32 s57, s27
s_mov_b32 s58, 0x2000
s_mov_b32 s59, 0x20000
v_and_b32 v5, 15, v0
v_and_b32 v6, 16, v0
v_lshl_add_u32 v5, v6, 1, v5
v_and_b32 v6, 32, v0
v_lshrrev_b32 v6, 1, v6
v_add_u32 v5, v5, v6
v_lshlrev_b32 v5, 1, v5
v_and_b32 v6, 0x7c, v5
s_lshl_b32 s73, s70, 7
v_and_b32 v11, 1, v0
v_lshlrev_b32 v3, 4, v11
v_mov_b32 v7, 0x3f80
v_lshlrev_b32 v7, v3, v7
v_and_b32 v2, 4, v0
v_cmp_eq_u32 vcc, 0, v2
v_bfe_u32 v2, v0, 1, 1
v_mul_u32_u24 v43, 0xaaaa, v2
v_add_u32 v43, 0x4444, v43
v_cndmask_b32 v44, 0, v7, vcc
v_sub_u32 v45, v7, v44
v_mov_b32 v46, v44
v_mov_b32 v47, v45
v_mov_b32 v48, 0
v_mov_b32 v49, 0
v_mov_b32 v50, 0
v_mov_b32 v51, 0
v_mov_b32 v52, 0
v_mov_b32 v53, 0
v_mov_b32 v54, 0
v_mov_b32 v55, 0
s_add_u32 s68, s73, 1310720
s_mov_b32 s76, 0xaaaaaaaa
s_mov_b32 s77, 0xaaaaaaaa
v_cmp_gt_u32 vcc, 24, v0
v_mov_b32 v41, 0x40000000
v_lshl_add_u32 v12, v11, 13, v6
v_cndmask_b32 v41, v41, v1, vcc
s_mov_b32 s75, 0
s_waitcnt vmcnt(0) lgkmcnt(0)
buffer_load_dwordx4 v[16:19], v1, s[36:39], s66 offen offset:0 sc1
buffer_load_dwordx4 v[20:23], v1, s[36:39], s66 offen offset:1024 sc1
buffer_load_dwordx4 v[24:27], v1, s[36:39], s66 offen offset:2048 sc1
buffer_load_dwordx4 v[28:31], v1, s[36:39], s66 offen offset:3072 sc1
s_sleep 1
buffer_load_dwordx4 v[16:19], v1, s[36:39], s66 offen offset:0 sc1
buffer_load_dwordx4 v[20:23], v1, s[36:39], s66 offen offset:1024 sc1
buffer_load_dwordx4 v[24:27], v1, s[36:39], s66 offen offset:2048 sc1
buffer_load_dwordx4 v[28:31], v1, s[36:39], s66 offen offset:3072 sc1
s_sleep 1
buffer_load_dwordx4 v[16:19], v1, s[36:39], s66 offen offset:0 sc1
buffer_load_dwordx4 v[20:23], v1, s[36:39], s66 offen offset:1024 sc1
buffer_load_dwordx4 v[24:27], v1, s[36:39], s66 offen offset:2048 sc1
buffer_load_dwordx4 v[28:31], v1, s[36:39], s66 offen offset:3072 sc1
s_sleep 1
L_rn_170:
v_smfmac_f32_16x16x64_bf16 v[48:51], v[44:47], v[16:23], v43
v_smfmac_f32_16x16x64_bf16 v[48:51], v[44:47], v[24:31], v43
buffer_load_dwordx4 v[16:19], v1, s[36:39], s66 offen offset:0 sc1
buffer_load_dwordx4 v[20:23], v1, s[36:39], s66 offen offset:1024 sc1
buffer_load_dwordx4 v[24:27], v1, s[36:39], s66 offen offset:2048 sc1
buffer_load_dwordx4 v[28:31], v1, s[36:39], s66 offen offset:3072 sc1
s_add_u32 s75, s75, 1
s_and_b32 s78, s75, 15
s_nop 1
v_add_f32_dpp v13, v48, v48 row_ror:8 row_mask:0x3 bank_mask:0x3
v_add_f32_dpp v13, v49, v49 row_ror:8 row_mask:0x3 bank_mask:0xc
v_add_f32_dpp v13, v50, v50 row_ror:8 row_mask:0xc bank_mask:0x3
v_add_f32_dpp v13, v51, v51 row_ror:8 row_mask:0xc bank_mask:0xc
v_cmp_u_f32 vcc, v13, v13
s_cbranch_vccz L_rz_171
v_mov_b32 v48, 0
v_mov_b32 v49, 0
v_mov_b32 v50, 0
v_mov_b32 v51, 0
s_waitcnt vmcnt(12)
s_cbranch_scc1 L_rn_170
v_max3_u32 v2, v16, v17, v18
v_max3_u32 v2, v2, v19, v20
v_max3_u32 v2, v2, v21, v22
v_max3_u32 v2, v2, v23, v24
v_max3_u32 v2, v2, v25, v26
v_max3_u32 v2, v2, v27, v28
v_max3_u32 v2, v2, v29, v30
v_max_u32 v2, v2, v31
v_cmp_eq_u32 vcc, -1, v2
s_cbranch_vccz L_rx_169
s_cmp_lt_u32 s75, 0x100000
s_cbranch_scc1 L_rn_170
L_rx_169:
v_smfmac_f32_16x16x64_bf16 v[48:51], v[44:47], v[16:23], v43
v_smfmac_f32_16x16x64_bf16 v[48:51], v[44:47], v[24:31], v43
s_nop 7
v_add_f32_dpp v13, v48, v48 row_ror:8 row_mask:0x3 bank_mask:0x3
v_add_f32_dpp v13, v49, v49 row_ror:8 row_mask:0x3 bank_mask:0xc
v_add_f32_dpp v13, v50, v50 row_ror:8 row_mask:0xc bank_mask:0x3
v_add_f32_dpp v13, v51, v51 row_ror:8 row_mask:0xc bank_mask:0xc
L_rz_171:
v_fmac_f32 v8, v13, v9
s_nop 1
v_mov_b32_dpp v14, v8 quad_perm:[1,1,3,3] row_mask:0xf bank_mask:0xf
v_mov_b32_dpp v13, v8 quad_perm:[0,0,2,2] row_mask:0xf bank_mask:0xf
v_cvt_pk_bf16_f32 v13, v13, v14
buffer_store_dword v13, v12, s[36:39], s68 offen sc1
v_cvt_pk_bf16_f32 v8, 0, v8
buffer_load_dwordx4 v[64:67], v1, s[36:39], s64 offen offset:0 sc1
buffer_load_dwordx4 v[68:71], v1, s[36:39], s64 offen offset:1024 sc1
buffer_load_dwordx4 v[72:75], v1, s[36:39], s64 offen offset:2048 sc1
buffer_load_dwordx4 v[76:79], v1, s[36:39], s64 offen offset:3072 sc1
buffer_load_dwordx4 v[80:83], v1, s[36:39], s65 offen offset:0 sc1
buffer_load_dwordx4 v[84:87], v41, s[36:39], s65 offen offset:1024 sc1
s_mov_b32 s75, 0
s_waitcnt vmcnt(0)
buffer_load_dwordx4 v[64:67], v1, s[36:39], s64 offen offset:0 sc1
buffer_load_dwordx4 v[68:71], v1, s[36:39], s64 offen offset:1024 sc1
buffer_load_dwordx4 v[72:75], v1, s[36:39], s64 offen offset:2048 sc1
buffer_load_dwordx4 v[76:79], v1, s[36:39], s64 offen offset:3072 sc1
buffer_load_dwordx4 v[80:83], v1, s[36:39], s65 offen offset:0 sc1
buffer_load_dwordx4 v[84:87], v41, s[36:39], s65 offen offset:1024 sc1
s_sleep 1
buffer_load_dwordx4 v[64:67], v1, s[36:39], s64 offen offset:0 sc1
buffer_load_dwordx4 v[68:71], v1, s[36:39], s64 offen offset:1024 sc1
buffer_load_dwordx4 v[72:75], v1, s[36:39], s64 offen offset:2048 sc1
buffer_load_dwordx4 v[76:79], v1, s[36:39], s64 offen offset:3072 sc1
buffer_load_dwordx4 v[80:83], v1, s[36:39], s65 offen offset:0 sc1
buffer_load_dwordx4 v[84:87], v41, s[36:39], s65 offen offset:1024 sc1
s_sleep 1
L_rn_174:
v_smfmac_f32_16x16x64_bf16 v[52:55], v[44:47], v[64:71], v43
v_smfmac_f32_16x16x64_bf16 v[52:55], v[44:47], v[72:79], v43
v_smfmac_f32_16x16x64_bf16 v[52:55], v[44:47], v[80:87], v43
buffer_load_dwordx4 v[64:67], v1, s[36:39], s64 offen offset:0 sc1
buffer_load_dwordx4 v[68:71], v1, s[36:39], s64 offen offset:1024 sc1
buffer_load_dwordx4 v[72:75], v1, s[36:39], s64 offen offset:2048 sc1
buffer_load_dwordx4 v[76:79], v1, s[36:39], s64 offen offset:3072 sc1
buffer_load_dwordx4 v[80:83], v1, s[36:39], s65 offen offset:0 sc1
buffer_load_dwordx4 v[84:87], v41, s[36:39], s65 offen offset:1024 sc1
s_add_u32 s75, s75, 1
s_and_b32 s78, s75, 15
v_add_f32_dpp v13, v52, v52 row_ror:8 row_mask:0x3 bank_mask:0x3
v_add_f32_dpp v13, v53, v53 row_ror:8 row_mask:0x3 bank_mask:0xc
v_add_f32_dpp v13, v54, v54 row_ror:8 row_mask:0xc bank_mask:0x3
v_add_f32_dpp v13, v55, v55 row_ror:8 row_mask:0xc bank_mask:0xc
v_cmp_u_f32 vcc, v13, v13
s_cbranch_vccz L_rz_175
v_mov_b32 v52, 0
v_mov_b32 v53, 0
v_mov_b32 v54, 0
v_mov_b32 v55, 0
s_waitcnt vmcnt(12)
s_cbranch_scc1 L_rn_174
v_max3_u32 v2, v64, v65, v66
v_max3_u32 v2, v2, v67, v68
v_max3_u32 v2, v2, v69, v70
v_max3_u32 v2, v2, v71, v72
v_max3_u32 v2, v2, v73, v74
v_max3_u32 v2, v2, v75, v76
v_max3_u32 v2, v2, v77, v78
v_max3_u32 v2, v2, v79, v80
v_max3_u32 v2, v2, v81, v82
v_max3_u32 v2, v2, v83, v84
v_max3_u32 v2, v2, v85, v86
v_max_u32 v2, v2, v87
v_cmp_eq_u32 vcc, -1, v2
s_cbranch_vccz L_rx_173
s_cmp_lt_u32 s75, 0x100000
s_cbranch_scc1 L_rn_174
L_rx_173:
v_smfmac_f32_16x16x64_bf16 v[52:55], v[44:47], v[64:71], v43
v_smfmac_f32_16x16x64_bf16 v[52:55], v[44:47], v[72:79], v43
v_smfmac_f32_16x16x64_bf16 v[52:55], v[44:47], v[80:87], v43
s_nop 7
v_add_f32_dpp v13, v52, v52 row_ror:8 row_mask:0x3 bank_mask:0x3
v_add_f32_dpp v13, v53, v53 row_ror:8 row_mask:0x3 bank_mask:0xc
v_add_f32_dpp v13, v54, v54 row_ror:8 row_mask:0xc bank_mask:0x3
v_add_f32_dpp v13, v55, v55 row_ror:8 row_mask:0xc bank_mask:0xc
L_rz_175:
v_fmac_f32 v8, v13, v10
s_nop 1
v_mov_b32_dpp v14, v8 quad_perm:[1,1,3,3] row_mask:0xf bank_mask:0xf
s_not_b64 exec, s[76:77]
v_cvt_pk_bf16_f32 v13, v8, v14
buffer_store_dword v13, v6, s[56:59], s73 offen sc1
s_mov_b64 exec, -1
s_cmp_lt_u32 s70, 8
s_cbranch_scc0 L_fin2
s_mov_b64 exec, 0xffff
buffer_store_dwordx4 v[44:47], v1, s[36:39], s62 offen sc1
s_mov_b64 exec, -1
L_fin2:
s_endpgm
L_ffn:
s_mul_i32 s67, s3, 12288
s_add_u32 s67, s67, 25600
v_lshlrev_b32 v7, 3, v0
buffer_load_dwordx4 v[8:11], v1, s[36:39], s67 offen offset:0 sc1
buffer_load_dwordx4 v[12:15], v1, s[36:39], s67 offen offset:1024 sc1
s_cmp_lt_u32 s3, 4
s_cbranch_scc1 L_post_176
s_mov_b32 s40, s16
s_mov_b32 s41, s17
s_mov_b32 s42, 0x158000
s_mov_b32 s43, 0x20000
s_mov_b32 s56, s18
s_mov_b32 s57, s19
s_mov_b32 s58, 0x158000
s_mov_b32 s59, 0x20000
v_lshrrev_b32 v16, 2, v0
v_mul_u32_u24 v16, 2752, v16
v_and_b32 v17, 3, v0
v_lshrrev_b32 v18, 5, v0
v_xor_b32 v17, v17, v18
v_xor_b32 v18, 2, v17
v_lshl_add_u32 v17, v17, 4, v16
v_lshl_add_u32 v18, v18, 4, v16
s_mul_i32 s64, s34, 352256
s_lshl_b32 s65, s74, 6
s_add_u32 s64, s64, s65
s_lshl_b32 s65, s34, 13
s_add_u32 m0, s65, 4096
s_add_u32 s66, s64, 0
buffer_load_dwordx4 v17, s[40:43], s66 offen  lds
s_add_u32 m0, s65, 36864
s_add_u32 s66, s64, 0
buffer_load_dwordx4 v18, s[56:59], s66 offen  lds
s_add_u32 m0, s65, 5120
s_add_u32 s66, s64, 44032
buffer_load_dwordx4 v17, s[40:43], s66 offen  lds
s_add_u32 m0, s65, 37888
s_add_u32 s66, s64, 44032
buffer_load_dwordx4 v18, s[56:59], s66 offen  lds
s_add_u32 m0, s65, 6144
s_add_u32 s66, s64, 88064
buffer_load_dwordx4 v17, s[40:43], s66 offen  lds
s_add_u32 m0, s65, 38912
s_add_u32 s66, s64, 88064
buffer_load_dwordx4 v18, s[56:59], s66 offen  lds
s_add_u32 m0, s65, 7168
s_add_u32 s66, s64, 132096
buffer_load_dwordx4 v17, s[40:43], s66 offen  lds
s_add_u32 m0, s65, 39936
s_add_u32 s66, s64, 132096
buffer_load_dwordx4 v18, s[56:59], s66 offen  lds
s_add_u32 m0, s65, 8192
s_add_u32 s66, s64, 176128
buffer_load_dwordx4 v17, s[40:43], s66 offen  lds
s_add_u32 m0, s65, 40960
s_add_u32 s66, s64, 176128
buffer_load_dwordx4 v18, s[56:59], s66 offen  lds
s_add_u32 m0, s65, 9216
s_add_u32 s66, s64, 220160
buffer_load_dwordx4 v17, s[40:43], s66 offen  lds
s_add_u32 m0, s65, 41984
s_add_u32 s66, s64, 220160
buffer_load_dwordx4 v18, s[56:59], s66 offen  lds
s_add_u32 m0, s65, 10240
s_add_u32 s66, s64, 264192
buffer_load_dwordx4 v17, s[40:43], s66 offen  lds
s_add_u32 m0, s65, 43008
s_add_u32 s66, s64, 264192
buffer_load_dwordx4 v18, s[56:59], s66 offen  lds
s_add_u32 m0, s65, 11264
s_add_u32 s66, s64, 308224
buffer_load_dwordx4 v17, s[40:43], s66 offen  lds
s_add_u32 m0, s65, 44032
s_add_u32 s66, s64, 308224
buffer_load_dwordx4 v18, s[56:59], s66 offen  lds
s_waitcnt vmcnt(16)
s_branch L_post_177
L_post_176:
s_waitcnt vmcnt(0)
L_post_177:
v_max3_u32 v16, v8, v9, v10
v_max3_u32 v16, v16, v11, v12
v_max3_u32 v16, v16, v13, v14
v_max_u32 v16, v16, v15
v_cmp_eq_u32 vcc, -1, v16
s_cbranch_vccz L_cb_178
s_mov_b32 s75, 0
L_poll_179:
buffer_load_dwordx4 v[8:11], v1, s[36:39], s67 offen offset:0 sc1
buffer_load_dwordx4 v[12:15], v1, s[36:39], s67 offen offset:1024 sc1
s_waitcnt vmcnt(0)
v_max3_u32 v16, v8, v9, v10
v_max3_u32 v16, v16, v11, v12
v_max3_u32 v16, v16, v13, v14
v_max_u32 v16, v16, v15
v_cmp_eq_u32 vcc, -1, v16
s_cbranch_vccz L_pollx_180
s_add_u32 s75, s75, 1
s_cmp_lt_u32 s75, 0x100000
s_cbranch_scc1 L_poll_179
L_pollx_180:
L_cb_178:
s_mov_b32 s68, 0xffff0000
v_lshlrev_b32 v24, 16, v8
v_and_b32 v25, s68, v8
v_lshlrev_b32 v32, 16, v12
v_and_b32 v33, s68, v12
v_lshlrev_b32 v26, 16, v9
v_and_b32 v27, s68, v9
v_lshlrev_b32 v34, 16, v13
v_and_b32 v35, s68, v13
v_lshlrev_b32 v28, 16, v10
v_and_b32 v29, s68, v10
v_lshlrev_b32 v36, 16, v14
v_and_b32 v37, s68, v14
v_lshlrev_b32 v30, 16, v11
v_and_b32 v31, s68, v11
v_lshlrev_b32 v38, 16, v15
v_and_b32 v39, s68, v15
v_add_f32 v32, 1.0, v32
v_add_f32 v33, 1.0, v33
v_add_f32 v34, 1.0, v34
v_add_f32 v35, 1.0, v35
v_add_f32 v36, 1.0, v36
v_add_f32 v37, 1.0, v37
v_add_f32 v38, 1.0, v38
v_add_f32 v39, 1.0, v39
v_lshrrev_b32 v2, 3, v0
v_bfe_u32 v3, v0, 1, 3
v_and_b32 v4, 3, v3
s_lshl_b32 s64, s3, 1
v_xor_b32 v3, s64, v3
v_lshlrev_b32 v5, 10, v2
v_lshl_add_u32 v5, v4, 8, v5
v_lshl_add_u32 v5, v3, 4, v5
v_and_b32 v4, 1, v0
v_lshl_add_u32 v5, v4, 3, v5
v_add_u32 v5, 69632, v5
v_xor_b32 v6, 16, v5
v_mul_u32_u24 v16, 0xaaaa, v4
v_add_u32 v16, 0x4444, v16
v_lshrrev_b32 v2, 4, v0
v_bfe_u32 v3, v0, 3, 1
v_xor_b32 v7, v2, v0
v_lshlrev_b32 v7, 4, v7
v_add_u32 v7, 69632, v7
v_xor_b32 v8, 64, v7
v_and_b32 v4, 7, v0
v_and_b32 v9, 0x38, v0
v_lshlrev_b32 v9, 3, v9
v_lshl_add_u32 v9, v4, 1, v9
s_lshl_b32 s64, s34, 4
v_add_u32 v9, s64, v9
v_and_b32 v10, 12, v0
v_lshlrev_b32 v10, 5, v10
v_and_b32 v4, 1, v0
v_lshl_add_u32 v10, v4, 6, v10
v_lshl_add_u32 v10, v2, 4, v10
v_mov_b32 v17, 0xbfb8aa3b
v_mov_b32 v64, 0
v_mov_b32 v65, 0
v_mov_b32 v66, 0
v_mov_b32 v67, 0
s_lshl_b32 s64, s34, 3
s_lshr_b32 s64, s35, s64
v_lshlrev_b32 v3, 2, v3
v_bfe_u32 v3, s64, v3, 3
v_and_b32 v11, 6, v3
v_lshlrev_b32 v11, 12, v11
v_and_b32 v3, 1, v3
v_lshl_add_u32 v11, v3, 15, v11
v_lshl_add_u32 v11, v2, 17, v11
v_and_b32 v4, 240, v1
v_add_u32 v11, v11, v4
v_lshl_add_u32 v11, v2, 9, v11
s_lshl_b32 s64, s34, 8
v_add_u32 v11, s64, v11
s_lshl_b32 s69, s74, 7
s_add_u32 s69, s69, 1376256
s_add_u32 s72, s69, 65536
s_lshl_b32 s64, s3, 10
s_lshl_b32 s65, s2, 2
s_lshr_b32 s65, s35, s65
s_and_b32 s65, s65, 2
s_lshl_b32 s65, s65, 12
s_add_u32 s64, s64, s65
s_add_u32 s64, s64, 1310720
v_mov_b32 v14, 0xbb000000
v_mov_b32 v15, 0x3b000000
v_lshrrev_b32 v18, 4, v0
v_bfe_u32 v19, v0, 2, 2
v_bfe_u32 v20, v0, 1, 1
v_and_b32 v22, 1, v18
v_lshl_add_u32 v22, v20, 1, v22
v_xor_b32 v22, s34, v22
v_lshlrev_b32 v22, 4, v22
v_lshl_add_u32 v22, v20, 15, v22
v_lshl_add_u32 v22, v18, 9, v22
v_lshl_add_u32 v22, v19, 6, v22
v_and_b32 v20, 1, v0
v_lshl_add_u32 v22, v20, 3, v22
v_add_u32 v22, 4096, v22
s_lshr_b32 s73, s3, 2
s_waitcnt vmcnt(0)
s_barrier
buffer_load_dwordx4 v[56:59], v1, s[36:39], s64 offen sc1
s_cmp_eq_u32 s73, 0
s_cbranch_scc1 L_gu_182
ds_read_b64_tr_b16 v[128:129], v22 offset:0
ds_read_b64_tr_b16 v[130:131], v22 offset:256
ds_read_b64_tr_b16 v[132:133], v22 offset:2048
ds_read_b64_tr_b16 v[134:135], v22 offset:2304
ds_read_b64_tr_b16 v[136:137], v22 offset:4096
ds_read_b64_tr_b16 v[138:139], v22 offset:4352
ds_read_b64_tr_b16 v[140:141], v22 offset:6144
ds_read_b64_tr_b16 v[142:143], v22 offset:6400
ds_read_b64_tr_b16 v[144:145], v22 offset:8192
ds_read_b64_tr_b16 v[146:147], v22 offset:8448
ds_read_b64_tr_b16 v[148:149], v22 offset:10240
s_waitcnt lgkmcnt(4)
ds_read_b64_tr_b16 v[150:151], v22 offset:10496
ds_read_b64_tr_b16 v[152:153], v22 offset:12288
ds_read_b64_tr_b16 v[154:155], v22 offset:12544
ds_read_b64_tr_b16 v[156:157], v22 offset:14336
ds_read_b64_tr_b16 v[158:159], v22 offset:14592
ds_read_b64_tr_b16 v[160:161], v22 offset:16384
ds_read_b64_tr_b16 v[162:163], v22 offset:16640
ds_read_b64_tr_b16 v[164:165], v22 offset:18432
ds_read_b64_tr_b16 v[166:167], v22 offset:18688
ds_read_b64_tr_b16 v[168:169], v22 offset:20480
ds_read_b64_tr_b16 v[170:171], v22 offset:20736
s_waitcnt lgkmcnt(4)
ds_read_b64_tr_b16 v[172:173], v22 offset:22528
ds_read_b64_tr_b16 v[174:175], v22 offset:22784
ds_read_b64_tr_b16 v[176:177], v22 offset:24576
ds_read_b64_tr_b16 v[178:179], v22 offset:24832
ds_read_b64_tr_b16 v[180:181], v22 offset:26624
ds_read_b64_tr_b16 v[182:183], v22 offset:26880
ds_read_b64_tr_b16 v[184:185], v22 offset:28672
ds_read_b64_tr_b16 v[186:187], v22 offset:28928
ds_read_b64_tr_b16 v[188:189], v22 offset:30720
ds_read_b64_tr_b16 v[190:191], v22 offset:30976
L_gu_182:
s_cmp_lt_u32 s3, 4
s_cbranch_scc0 L_dma_183
s_mov_b32 s48, s20
s_mov_b32 s49, s21
s_mov_b32 s50, 0x158000
s_mov_b32 s51, 0x20000
v_lshrrev_b32 v18, 4, v0
v_and_b32 v16, 15, v0
v_xor_b32 v16, v16, v18
v_xor_b32 v17, 4, v16
v_lshlrev_b32 v19, 10, v18
v_lshl_add_u32 v22, v16, 4, v19
v_lshl_add_u32 v23, v17, 4, v19
s_lshl_b32 s76, s74, 15
s_lshl_b32 s66, s34, 8
s_add_u32 s76, s76, s66
s_lshl_b32 s77, s34, 13
s_add_u32 s77, s77, 77824
v_bfe_u32 v19, v0, 2, 2
v_and_b32 v16, 2, v0
v_lshlrev_b32 v16, 2, v16
v_xor_b32 v16, v16, v19
v_and_b32 v17, 1, v18
v_lshlrev_b32 v17, 2, v17
v_xor_b32 v16, v16, v17
v_lshlrev_b32 v16, 4, v16
v_lshl_add_u32 v16, v18, 10, v16
v_lshl_add_u32 v16, v19, 8, v16
v_and_b32 v17, 1, v0
v_lshl_add_u32 v16, v17, 3, v16
v_add_u32 v68, s77, v16
v_xor_b32 v69, 16, v68
v_xor_b32 v70, 32, v68
v_xor_b32 v71, 48, v68
v_xor_b32 v72, 64, v68
v_xor_b32 v73, 80, v68
v_xor_b32 v74, 96, v68
v_xor_b32 v75, 112, v68
s_add_u32 m0, s77, 0
s_xor_b32 s66, s76, 0
buffer_load_dwordx4 v22, s[48:51], s66 offen  lds
s_add_u32 m0, s77, 1024
s_xor_b32 s66, s76, 8192
buffer_load_dwordx4 v23, s[48:51], s66 offen  lds
s_add_u32 m0, s77, 2048
s_xor_b32 s66, s76, 16384
buffer_load_dwordx4 v22, s[48:51], s66 offen  lds
s_add_u32 m0, s77, 3072
s_xor_b32 s66, s76, 24576
buffer_load_dwordx4 v23, s[48:51], s66 offen  lds
s_add_u32 m0, s77, 4096
s_xor_b32 s66, s76, 4096
buffer_load_dwordx4 v22, s[48:51], s66 offen  lds
s_add_u32 m0, s77, 5120
s_xor_b32 s66, s76, 12288
buffer_load_dwordx4 v23, s[48:51], s66 offen  lds
s_add_u32 m0, s77, 6144
s_xor_b32 s66, s76, 20480
buffer_load_dwordx4 v22, s[48:51], s66 offen  lds
s_waitcnt vmcnt(7)
s_branch L_dma_184
L_dma_183:
s_waitcnt vmcnt(0)
L_dma_184:
s_mov_b32 s73, 0x3f803f80
v_mov_b32 v20, 0
v_mov_b32 v21, 0
v_max3_u32 v12, v56, v57, v58
v_max_u32 v12, v12, v59
v_cmp_eq_u32 vcc, -1, v12
s_cbranch_vccz L_x_181
buffer_load_dwordx4 v[56:59], v1, s[36:39], s64 offen sc1
s_sleep 1
s_mov_b32 s75, 0
L_poll_185:
buffer_load_dwordx4 v[56:59], v1, s[36:39], s64 offen sc1
s_waitcnt vmcnt(1)
v_max3_u32 v12, v56, v57, v58
v_max_u32 v12, v12, v59
v_cmp_eq_u32 vcc, -1, v12
s_cbranch_vccz L_pollx_186
s_add_u32 s75, s75, 1
s_cmp_lt_u32 s75, 0x100000
s_cbranch_scc1 L_poll_185
L_pollx_186:
L_x_181:
v_dot2c_f32_bf16 v20, s73, v56
v_dot2c_f32_bf16 v21, v56, v56
v_dot2c_f32_bf16 v20, s73, v57
v_dot2c_f32_bf16 v21, v57, v57
v_dot2c_f32_bf16 v20, s73, v58
v_dot2c_f32_bf16 v21, v58, v58
v_dot2c_f32_bf16 v20, s73, v59
v_dot2c_f32_bf16 v21, v59, v59
v_lshlrev_b32 v40, 16, v56
v_and_b32 v41, s68, v56
v_lshlrev_b32 v42, 16, v57
v_permlane32_swap_b32 v20, v21
v_add_f32 v12, v20, v21
v_and_b32 v43, s68, v57
v_lshlrev_b32 v44, 16, v58
v_add_f32_dpp v12, v12, v12 quad_perm:[1,0,3,2] row_mask:0xf bank_mask:0xf
v_and_b32 v45, s68, v58
v_lshlrev_b32 v46, 16, v59
v_add_f32_dpp v12, v12, v12 quad_perm:[2,3,0,1] row_mask:0xf bank_mask:0xf
v_and_b32 v47, s68, v59
v_pk_mul_f32 v[48:49], v[40:41], v[32:33]
v_add_f32_dpp v12, v12, v12 row_ror:4 row_mask:0xf bank_mask:0xf
v_pk_mul_f32 v[50:51], v[42:43], v[34:35]
v_pk_mul_f32 v[52:53], v[44:45], v[36:37]
v_add_f32_dpp v12, v12, v12 row_ror:8 row_mask:0xf bank_mask:0xf
v_pk_mul_f32 v[54:55], v[46:47], v[38:39]
s_nop 0
v_add_f32_dpp v12, v12, v12 row_bcast:15 row_mask:0xa bank_mask:0xf
s_nop 0
v_readlane_b32 s70, v12, 16
v_readlane_b32 s71, v12, 48
s_nop 0
v_mul_f32 v12, s70, v14
v_mul_f32 v13, s71, v15
v_fma_f32 v13, -v12, v12, v13
v_max_f32 v13, 0, v13
v_add_f32 v13, 0x3727c5ac, v13
v_rsq_f32 v2, v13
v_pk_fma_f32 v[48:49], v[12:13], v[32:33], v[48:49] op_sel_hi:[0,1,1]
v_pk_fma_f32 v[50:51], v[12:13], v[34:35], v[50:51] op_sel_hi:[0,1,1]
v_pk_fma_f32 v[52:53], v[12:13], v[36:37], v[52:53] op_sel_hi:[0,1,1]
v_pk_fma_f32 v[54:55], v[12:13], v[38:39], v[54:55] op_sel_hi:[0,1,1]
v_pk_fma_f32 v[24:25], v[2:3], v[48:49], v[24:25] op_sel_hi:[0,1,1]
v_pk_fma_f32 v[28:29], v[2:3], v[52:53], v[28:29] op_sel_hi:[0,1,1]
v_pk_fma_f32 v[26:27], v[2:3], v[50:51], v[26:27] op_sel_hi:[0,1,1]
v_pk_fma_f32 v[30:31], v[2:3], v[54:55], v[30:31] op_sel_hi:[0,1,1]
v_cvt_pk_bf16_f32 v40, v24, v25
v_cvt_pk_bf16_f32 v41, v28, v29
ds_write_b64 v5, v[40:41]
v_cvt_pk_bf16_f32 v42, v26, v27
v_cvt_pk_bf16_f32 v43, v30, v31
ds_write_b64 v6, v[42:43]
s_cmp_lt_u32 s3, 4
s_cbranch_scc0 L_dma_187
s_mov_b32 s48, s20
s_mov_b32 s49, s21
s_mov_b32 s50, 0x158000
s_mov_b32 s51, 0x20000
s_add_u32 m0, s77, 7168
s_xor_b32 s66, s76, 28672
buffer_load_dwordx4 v23, s[48:51], s66 offen  lds
L_dma_187:
s_cmp_lt_u32 s3, 4
s_waitcnt lgkmcnt(0)
s_barrier
s_cbranch_scc1 L_bar_fin
ds_read_b128 v[192:195], v7 offset:0
ds_read_b128 v[196:199], v8 offset:1024
ds_read_b128 v[200:203], v7 offset:2048
ds_read_b128 v[204:207], v8 offset:3072
ds_read_b128 v[208:211], v7 offset:4096
ds_read_b128 v[212:215], v8 offset:5120
ds_read_b128 v[216:219], v7 offset:6144
ds_read_b128 v[220:223], v8 offset:7168
s_waitcnt lgkmcnt(7)
v_smfmac_f32_16x16x64_bf16 v[64:67], v[192:195], v[128:135], v16
s_waitcnt lgkmcnt(6)
v_smfmac_f32_16x16x64_bf16 v[64:67], v[196:199], v[136:143], v16
s_waitcnt lgkmcnt(5)
v_smfmac_f32_16x16x64_bf16 v[64:67], v[200:203], v[144:151], v16
s_waitcnt lgkmcnt(4)
v_smfmac_f32_16x16x64_bf16 v[64:67], v[204:207], v[152:159], v16
s_waitcnt lgkmcnt(3)
v_smfmac_f32_16x16x64_bf16 v[64:67], v[208:211], v[160:167], v16
s_waitcnt lgkmcnt(2)
v_smfmac_f32_16x16x64_bf16 v[64:67], v[212:215], v[168:175], v16
s_waitcnt lgkmcnt(1)
v_smfmac_f32_16x16x64_bf16 v[64:67], v[216:219], v[176:183], v16
s_waitcnt lgkmcnt(0)
v_smfmac_f32_16x16x64_bf16 v[64:67], v[220:223], v[184:191], v16
s_nop 7
v_add_f32 v66, v66, v67
v_add_f32 v64, v64, v65
v_mul_f32 v18, v64, v17
v_mul_f32_dpp v18, v66, v17 row_ror:8 row_mask:0xf bank_mask:0xc
v_exp_f32 v18, v18
v_mov_b32_dpp v66, v64 row_ror:8 row_mask:0xf bank_mask:0x3
v_add_f32 v18, 1.0, v18
v_rcp_f32 v18, v18
s_nop 0
v_mul_f32 v18, v18, v66
v_cvt_pk_bf16_f32 v18, v18, v18
ds_write_b16 v9, v18 offset:3584
s_waitcnt lgkmcnt(0)
s_barrier
s_endpgm
L_bar_fin:
s_waitcnt vmcnt(0)
ds_read_b64_tr_b16 v[96:97], v68 offset:0
ds_read_b64_tr_b16 v[98:99], v68 offset:4096
ds_read_b64_tr_b16 v[100:101], v69 offset:0
ds_read_b64_tr_b16 v[102:103], v69 offset:4096
ds_read_b64_tr_b16 v[104:105], v70 offset:0
ds_read_b64_tr_b16 v[106:107], v70 offset:4096
ds_read_b64_tr_b16 v[108:109], v71 offset:0
ds_read_b64_tr_b16 v[110:111], v71 offset:4096
ds_read_b64_tr_b16 v[112:113], v72 offset:0
ds_read_b64_tr_b16 v[114:115], v72 offset:4096
ds_read_b64_tr_b16 v[116:117], v73 offset:0
s_waitcnt lgkmcnt(4)
ds_read_b64_tr_b16 v[118:119], v73 offset:4096
ds_read_b64_tr_b16 v[120:121], v74 offset:0
ds_read_b64_tr_b16 v[122:123], v74 offset:4096
ds_read_b64_tr_b16 v[124:125], v75 offset:0
ds_read_b64_tr_b16 v[126:127], v75 offset:4096
s_waitcnt lgkmcnt(0)
s_barrier
ds_read_b128 v[48:51], v10 offset:3584
s_waitcnt lgkmcnt(0)
v_mfma_f32_16x16x32_bf16 v[192:195], v[48:51], v[96:99], 0
v_mfma_f32_16x16x32_bf16 v[196:199], v[48:51], v[100:103], 0
v_mfma_f32_16x16x32_bf16 v[200:203], v[48:51], v[104:107], 0
s_nop 1
v_mfma_f32_16x16x32_bf16 v[204:207], v[48:51], v[108:111], 0
s_nop 1
v_mfma_f32_16x16x32_bf16 v[208:211], v[48:51], v[112:115], 0
s_nop 0
v_cvt_pk_bf16_f32 v16, v192, v196
v_mfma_f32_16x16x32_bf16 v[212:215], v[48:51], v[116:119], 0
v_cvt_pk_bf16_f32 v20, v193, v197
v_mfma_f32_16x16x32_bf16 v[216:219], v[48:51], v[120:123], 0
v_cvt_pk_bf16_f32 v17, v200, v204
v_cvt_pk_bf16_f32 v21, v201, v205
v_mfma_f32_16x16x32_bf16 v[220:223], v[48:51], v[124:127], 0
s_nop 2
v_cvt_pk_bf16_f32 v18, v208, v212
v_cvt_pk_bf16_f32 v22, v209, v213
s_nop 2
v_cvt_pk_bf16_f32 v19, v216, v220
buffer_store_dwordx4 v[16:19], v11, s[36:39], s69 offen sc1
v_cvt_pk_bf16_f32 v23, v217, v221
buffer_store_dwordx4 v[20:23], v11, s[36:39], s72 offen sc1
s_endpgm
s_endpgm
L_srest:
s_lshr_b32 s32, s2, 5
s_and_b32 s33, s2, 31
s_and_b32 s67, s2, 7
s_lshr_b32 s68, s2, 3
s_sub_u32 s68, s68, 26
s_min_u32 s74, s67, 3
s_mul_i32 s66, s67, 5
s_add_u32 s74, s74, s66
s_add_u32 s74, s74, s68
s_cmp_lt_u32 s67, 3
s_cselect_b32 s66, 6, 5
s_cmp_lt_u32 s68, s66
s_cselect_b32 s74, s74, -1
s_cmp_lt_u32 s2, 48
s_cselect_b32 s66, 2, 3
s_cselect_b32 s72, 14+26, 42+26
s_cmp_lt_u32 s2, 16
s_cselect_b32 s66, 1, s66
s_cselect_b32 s72, 26, s72
s_lshl_b32 s66, s67, s66
s_add_u32 s72, s72, s66
s_add_u32 s72, s72, s68
s_mov_b32 s36, s30
s_mov_b32 s37, s31
s_mov_b32 s38, 0x1d0000
s_mov_b32 s39, 0x20000
s_mov_b32 s52, s28
s_mov_b32 s53, s29
s_mov_b32 s54, 0x100
s_mov_b32 s55, 0x20000
s_mov_b32 s46, 0x40000
s_mov_b32 s47, 0x20000
s_cmp_eq_u32 s74, -1
s_mov_b32 s69, 30
s_cselect_b32 s69, 20, s69
s_cmp_lt_u32 s2, 144
s_cselect_b32 s69, 0, s69
s_cmp_lt_u32 s2, 112
s_cselect_b32 s69, 50, s69
s_cmp_lt_u32 s2, 48
s_cselect_b32 s69, 30, s69
s_cmp_lt_u32 s2, 16
s_cselect_b32 s69, 40, s69
s_and_b32 s66, s72, 7
s_cmp_eq_u32 s66, 3
s_cselect_b32 s66, 40, 0
s_cmp_lt_u32 s2, 112
s_cselect_b32 s66, s66, 0
s_add_u32 s69, s69, s66
s_xor_b32 s64, s65, 1024
s_cmpk_gt_u32 s69, 4
s_cbranch_scc1 L_d_1
s_waitcnt vmcnt(3)
L_d_1:
buffer_load_dwordx4 v[24:27], v1, s[40:43], s64 offen nt
s_xor_b32 s64, s65, 66560
s_cmpk_gt_u32 s69, 5
s_cbranch_scc1 L_d_2
s_waitcnt vmcnt(3)
L_d_2:
buffer_load_dwordx4 v[28:31], v1, s[40:43], s64 offen nt
s_xor_b32 s64, s65, 3072
s_cmpk_gt_u32 s69, 6
s_cbranch_scc1 L_d_3
s_waitcnt vmcnt(3)
L_d_3:
buffer_load_dwordx4 v[32:35], v1, s[40:43], s64 offen nt
s_xor_b32 s64, s65, 68608
s_cmpk_gt_u32 s69, 7
s_waitcnt vmcnt(6)
s_cbranch_scc1 L_d_4
s_waitcnt vmcnt(3)
L_d_4:
buffer_load_dwordx4 v[36:39], v1, s[40:43], s64 offen nt
s_xor_b32 s64, s65, 32768
s_cmpk_gt_u32 s69, 8
s_waitcnt vmcnt(6)
s_cbranch_scc1 L_d_5
s_waitcnt vmcnt(3)
L_d_5:
buffer_load_dwordx4 v[40:43], v1, s[40:43], s64 offen nt
s_xor_b32 s64, s65, 98304
s_cmpk_gt_u32 s69, 9
s_waitcnt vmcnt(6)
s_cbranch_scc1 L_d_6
s_waitcnt vmcnt(3)
L_d_6:
buffer_load_dwordx4 v[44:47], v1, s[40:43], s64 offen nt
s_xor_b32 s64, s65, 34816
s_cmpk_gt_u32 s69, 10
s_waitcnt vmcnt(6)
s_cbranch_scc1 L_d_7
s_waitcnt vmcnt(3)
L_d_7:
buffer_load_dwordx4 v[48:51], v1, s[40:43], s64 offen nt
s_xor_b32 s64, s65, 100352
s_cmpk_gt_u32 s69, 11
s_waitcnt vmcnt(6)
s_cbranch_scc1 L_d_8
s_waitcnt vmcnt(3)
L_d_8:
buffer_load_dwordx4 v[52:55], v1, s[40:43], s64 offen nt
s_xor_b32 s64, s65, 33792
s_cmpk_gt_u32 s69, 12
s_waitcnt vmcnt(6)
s_cbranch_scc1 L_d_9
s_waitcnt vmcnt(3)
L_d_9:
buffer_load_dwordx4 v[56:59], v1, s[40:43], s64 offen nt
s_xor_b32 s64, s65, 99328
s_cmpk_gt_u32 s69, 13
s_waitcnt vmcnt(6)
s_cbranch_scc1 L_d_10
s_waitcnt vmcnt(3)
L_d_10:
buffer_load_dwordx4 v[60:63], v1, s[40:43], s64 offen nt
s_xor_b32 s64, s65, 35840
s_cmpk_gt_u32 s69, 14
s_waitcnt vmcnt(6)
s_cbranch_scc1 L_d_11
s_waitcnt vmcnt(3)
L_d_11:
buffer_load_dwordx4 v[64:67], v1, s[40:43], s64 offen nt
s_xor_b32 s64, s65, 101376
s_cmpk_gt_u32 s69, 15
s_waitcnt vmcnt(6)
s_cbranch_scc1 L_d_12
s_waitcnt vmcnt(3)
L_d_12:
buffer_load_dwordx4 v[68:71], v1, s[40:43], s64 offen nt
s_xor_b32 s64, s65, 131072
s_cmpk_gt_u32 s69, 16
s_waitcnt vmcnt(6)
s_cbranch_scc1 L_d_13
s_waitcnt vmcnt(3)
L_d_13:
buffer_load_dwordx4 v[72:75], v1, s[40:43], s64 offen nt
s_xor_b32 s64, s65, 196608
s_cmpk_gt_u32 s69, 17
s_waitcnt vmcnt(6)
s_cbranch_scc1 L_d_14
s_waitcnt vmcnt(3)
L_d_14:
buffer_load_dwordx4 v[76:79], v1, s[40:43], s64 offen nt
s_xor_b32 s64, s65, 133120
s_cmpk_gt_u32 s69, 18
s_waitcnt vmcnt(6)
s_cbranch_scc1 L_d_15
s_waitcnt vmcnt(3)
L_d_15:
buffer_load_dwordx4 v[80:83], v1, s[40:43], s64 offen nt
s_xor_b32 s64, s65, 198656
s_cmpk_gt_u32 s69, 19
s_waitcnt vmcnt(6)
s_cbranch_scc1 L_d_16
s_waitcnt vmcnt(3)
L_d_16:
buffer_load_dwordx4 v[84:87], v1, s[40:43], s64 offen nt
s_xor_b32 s64, s65, 132096
s_cmpk_gt_u32 s69, 20
s_waitcnt vmcnt(6)
s_cbranch_scc1 L_d_17
s_waitcnt vmcnt(4)
L_d_17:
buffer_load_dwordx4 v[88:91], v1, s[40:43], s64 offen nt
s_xor_b32 s64, s65, 197632
s_cmpk_gt_u32 s69, 21
s_waitcnt vmcnt(6)
s_cbranch_scc1 L_d_18
s_waitcnt vmcnt(4)
L_d_18:
buffer_load_dwordx4 v[92:95], v1, s[40:43], s64 offen nt
s_xor_b32 s64, s65, 134144
s_cmpk_gt_u32 s69, 22
s_waitcnt vmcnt(6)
s_cbranch_scc1 L_d_19
s_waitcnt vmcnt(4)
L_d_19:
buffer_load_dwordx4 v[96:99], v1, s[40:43], s64 offen nt
s_xor_b32 s64, s65, 199680
s_cmpk_gt_u32 s69, 23
s_waitcnt vmcnt(6)
s_cbranch_scc1 L_d_20
s_waitcnt vmcnt(4)
L_d_20:
buffer_load_dwordx4 v[100:103], v1, s[40:43], s64 offen nt
s_xor_b32 s64, s65, 163840
s_cmpk_gt_u32 s69, 24
s_waitcnt vmcnt(6)
s_cbranch_scc1 L_d_21
s_waitcnt vmcnt(4)
L_d_21:
buffer_load_dwordx4 v[104:107], v1, s[40:43], s64 offen nt
s_xor_b32 s64, s65, 229376
s_cmpk_gt_u32 s69, 25
s_waitcnt vmcnt(6)
s_cbranch_scc1 L_d_22
s_waitcnt vmcnt(4)
L_d_22:
buffer_load_dwordx4 v[108:111], v1, s[40:43], s64 offen nt
s_xor_b32 s64, s65, 165888
s_cmpk_gt_u32 s69, 26
s_waitcnt vmcnt(6)
s_cbranch_scc1 L_d_23
s_waitcnt vmcnt(4)
L_d_23:
buffer_load_dwordx4 v[112:115], v1, s[40:43], s64 offen nt
s_xor_b32 s64, s65, 231424
s_cmpk_gt_u32 s69, 27
s_waitcnt vmcnt(6)
s_cbranch_scc1 L_d_24
s_waitcnt vmcnt(4)
L_d_24:
buffer_load_dwordx4 v[116:119], v1, s[40:43], s64 offen nt
s_xor_b32 s64, s65, 164864
s_cmpk_gt_u32 s69, 28
s_waitcnt vmcnt(6)
s_cbranch_scc1 L_d_25
s_waitcnt vmcnt(4)
L_d_25:
buffer_load_dwordx4 v[120:123], v1, s[40:43], s64 offen nt
s_xor_b32 s64, s65, 230400
s_cmpk_gt_u32 s69, 29
s_waitcnt vmcnt(6)
s_cbranch_scc1 L_d_26
s_waitcnt vmcnt(4)
L_d_26:
buffer_load_dwordx4 v[124:127], v1, s[40:43], s64 offen nt
s_xor_b32 s64, s65, 166912
s_cmpk_gt_u32 s69, 30
s_waitcnt vmcnt(6)
s_cbranch_scc1 L_d_27
s_waitcnt vmcnt(4)
L_d_27:
buffer_load_dwordx4 v[128:131], v1, s[40:43], s64 offen nt
s_xor_b32 s64, s65, 232448
s_cmpk_gt_u32 s69, 31
s_waitcnt vmcnt(6)
s_cbranch_scc1 L_d_28
s_waitcnt vmcnt(4)
L_d_28:
buffer_load_dwordx4 v[132:135], v1, s[40:43], s64 offen nt
s_xor_b32 s64, s65, 4096
s_cmpk_gt_u32 s69, 32
s_waitcnt vmcnt(6)
s_cbranch_scc1 L_d_29
s_waitcnt vmcnt(4)
L_d_29:
buffer_load_dwordx4 v[136:139], v1, s[40:43], s64 offen nt
s_xor_b32 s64, s65, 69632
s_cmpk_gt_u32 s69, 33
s_waitcnt vmcnt(6)
s_cbranch_scc1 L_d_30
s_waitcnt vmcnt(4)
L_d_30:
buffer_load_dwordx4 v[140:143], v1, s[40:43], s64 offen nt
s_xor_b32 s64, s65, 6144
s_cmpk_gt_u32 s69, 34
s_waitcnt vmcnt(6)
s_cbranch_scc1 L_d_31
s_waitcnt vmcnt(4)
L_d_31:
buffer_load_dwordx4 v[144:147], v1, s[40:43], s64 offen nt
s_xor_b32 s64, s65, 71680
s_cmpk_gt_u32 s69, 35
s_waitcnt vmcnt(6)
s_cbranch_scc1 L_d_32
s_waitcnt vmcnt(4)
L_d_32:
buffer_load_dwordx4 v[148:151], v1, s[40:43], s64 offen nt
s_xor_b32 s64, s65, 5120
s_cmpk_gt_u32 s69, 36
s_waitcnt vmcnt(6)
s_cbranch_scc1 L_d_33
s_waitcnt vmcnt(4)
L_d_33:
buffer_load_dwordx4 v[152:155], v1, s[40:43], s64 offen nt
s_xor_b32 s64, s65, 70656
s_cmpk_gt_u32 s69, 37
s_waitcnt vmcnt(6)
s_cbranch_scc1 L_d_34
s_waitcnt vmcnt(4)
L_d_34:
buffer_load_dwordx4 v[156:159], v1, s[40:43], s64 offen nt
s_xor_b32 s64, s65, 7168
s_cmpk_gt_u32 s69, 38
s_waitcnt vmcnt(6)
s_cbranch_scc1 L_d_35
s_waitcnt vmcnt(4)
L_d_35:
buffer_load_dwordx4 v[160:163], v1, s[40:43], s64 offen nt
s_xor_b32 s64, s65, 72704
s_cmpk_gt_u32 s69, 39
s_waitcnt vmcnt(6)
s_cbranch_scc1 L_d_36
s_waitcnt vmcnt(4)
L_d_36:
buffer_load_dwordx4 v[164:167], v1, s[40:43], s64 offen nt
s_xor_b32 s64, s65, 36864
s_cmpk_gt_u32 s69, 40
s_waitcnt vmcnt(6)
s_cbranch_scc1 L_d_37
s_waitcnt vmcnt(4)
L_d_37:
buffer_load_dwordx4 v[168:171], v1, s[40:43], s64 offen nt
s_xor_b32 s64, s65, 102400
s_cmpk_gt_u32 s69, 41
s_waitcnt vmcnt(6)
s_cbranch_scc1 L_d_38
s_waitcnt vmcnt(4)
L_d_38:
buffer_load_dwordx4 v[172:175], v1, s[40:43], s64 offen nt
s_xor_b32 s64, s65, 38912
s_cmpk_gt_u32 s69, 42
s_waitcnt vmcnt(6)
s_cbranch_scc1 L_d_39
s_waitcnt vmcnt(4)
L_d_39:
buffer_load_dwordx4 v[176:179], v1, s[40:43], s64 offen nt
s_xor_b32 s64, s65, 104448
s_cmpk_gt_u32 s69, 43
s_waitcnt vmcnt(6)
s_cbranch_scc1 L_d_40
s_waitcnt vmcnt(4)
L_d_40:
buffer_load_dwordx4 v[180:183], v1, s[40:43], s64 offen nt
s_xor_b32 s64, s65, 37888
s_cmpk_gt_u32 s69, 44
s_waitcnt vmcnt(6)
s_cbranch_scc1 L_d_41
s_waitcnt vmcnt(4)
L_d_41:
buffer_load_dwordx4 v[184:187], v1, s[40:43], s64 offen nt
s_xor_b32 s64, s65, 103424
s_cmpk_gt_u32 s69, 45
s_waitcnt vmcnt(6)
s_cbranch_scc1 L_d_42
s_waitcnt vmcnt(4)
L_d_42:
buffer_load_dwordx4 v[188:191], v1, s[40:43], s64 offen nt
s_xor_b32 s64, s65, 39936
s_cmpk_gt_u32 s69, 46
s_waitcnt vmcnt(6)
s_cbranch_scc1 L_d_43
s_waitcnt vmcnt(4)
L_d_43:
buffer_load_dwordx4 v[192:195], v1, s[40:43], s64 offen nt
s_xor_b32 s64, s65, 105472
s_cmpk_gt_u32 s69, 47
s_waitcnt vmcnt(6)
s_cbranch_scc1 L_d_44
s_waitcnt vmcnt(4)
L_d_44:
buffer_load_dwordx4 v[196:199], v1, s[40:43], s64 offen nt
s_xor_b32 s64, s65, 135168
s_cmpk_gt_u32 s69, 48
s_waitcnt vmcnt(6)
s_cbranch_scc1 L_d_45
s_waitcnt vmcnt(4)
L_d_45:
buffer_load_dwordx4 v[200:203], v1, s[40:43], s64 offen nt
s_xor_b32 s64, s65, 200704
s_cmpk_gt_u32 s69, 49
s_waitcnt vmcnt(6)
s_cbranch_scc1 L_d_46
s_waitcnt vmcnt(4)
L_d_46:
buffer_load_dwordx4 v[204:207], v1, s[40:43], s64 offen nt
s_xor_b32 s64, s65, 137216
s_cmpk_gt_u32 s69, 50
s_waitcnt vmcnt(6)
s_cbranch_scc1 L_d_47
s_waitcnt vmcnt(4)
L_d_47:
buffer_load_dwordx4 v[208:211], v1, s[40:43], s64 offen nt
s_xor_b32 s64, s65, 202752
s_cmpk_gt_u32 s69, 51
s_waitcnt vmcnt(6)
s_cbranch_scc1 L_d_48
s_waitcnt vmcnt(4)
L_d_48:
buffer_load_dwordx4 v[212:215], v1, s[40:43], s64 offen nt
s_xor_b32 s64, s65, 136192
s_cmpk_gt_u32 s69, 52
s_waitcnt vmcnt(6)
s_cbranch_scc1 L_d_49
s_waitcnt vmcnt(4)
L_d_49:
buffer_load_dwordx4 v[216:219], v1, s[40:43], s64 offen nt
s_xor_b32 s64, s65, 201728
s_cmpk_gt_u32 s69, 53
s_waitcnt vmcnt(6)
s_cbranch_scc1 L_d_50
s_waitcnt vmcnt(4)
L_d_50:
buffer_load_dwordx4 v[220:223], v1, s[40:43], s64 offen nt
s_xor_b32 s64, s65, 138240
s_cmpk_gt_u32 s69, 54
s_waitcnt vmcnt(6)
s_cbranch_scc1 L_d_51
s_waitcnt vmcnt(4)
L_d_51:
buffer_load_dwordx4 v[224:227], v1, s[40:43], s64 offen nt
s_xor_b32 s64, s65, 203776
s_cmpk_gt_u32 s69, 55
s_waitcnt vmcnt(6)
s_cbranch_scc1 L_d_52
s_waitcnt vmcnt(4)
L_d_52:
buffer_load_dwordx4 v[228:231], v1, s[40:43], s64 offen nt
s_cmp_eq_u32 s74, -1
s_mov_b32 s69, 64
s_cselect_b32 s69, 64, s69
s_cmp_lt_u32 s2, 144
s_cselect_b32 s69, 80, s69
s_cmp_lt_u32 s2, 112
s_cselect_b32 s69, 96, s69
s_cmp_lt_u32 s2, 48
s_cselect_b32 s69, 72, s69
s_cmp_lt_u32 s2, 16
s_cselect_b32 s69, 112, s69
s_xor_b32 s64, s65, 167936
s_cmpk_gt_u32 s69, 56
s_waitcnt vmcnt(6)
s_cbranch_scc1 L_d_53
s_waitcnt vmcnt(4)
L_d_53:
buffer_load_dwordx4 v[232:235], v1, s[40:43], s64 offen nt
s_xor_b32 s64, s65, 233472
s_cmpk_gt_u32 s69, 57
s_waitcnt vmcnt(6)
s_cbranch_scc1 L_d_54
s_waitcnt vmcnt(4)
L_d_54:
buffer_load_dwordx4 v[236:239], v1, s[40:43], s64 offen nt
s_xor_b32 s64, s65, 169984
s_cmpk_gt_u32 s69, 58
s_waitcnt vmcnt(6)
s_cbranch_scc1 L_d_55
s_waitcnt vmcnt(4)
L_d_55:
buffer_load_dwordx4 v[240:243], v1, s[40:43], s64 offen nt
v_and_b32 v2, 31, v0
v_lshlrev_b32 v2, 2, v2
buffer_load_dword v3, v2, s[52:55], 0 offen offset:128
s_xor_b32 s64, s65, 235520
s_cmpk_gt_u32 s69, 59
s_waitcnt vmcnt(6)
s_cbranch_scc1 L_d_56
s_waitcnt vmcnt(4)
L_d_56:
buffer_load_dwordx4 v[244:247], v1, s[40:43], s64 offen nt
s_xor_b32 s64, s65, 168960
s_cmpk_gt_u32 s69, 60
s_waitcnt vmcnt(6)
s_cbranch_scc1 L_d_57
s_waitcnt vmcnt(4)
L_d_57:
buffer_load_dwordx4 v[248:251], v1, s[40:43], s64 offen nt
s_xor_b32 s64, s65, 234496
s_cmpk_gt_u32 s69, 61
s_waitcnt vmcnt(6)
s_cbranch_scc1 L_d_58
s_waitcnt vmcnt(4)
L_d_58:
buffer_load_dwordx4 v[252:255], v1, s[40:43], s64 offen nt
s_mul_i32 s70, s34, 15360
s_add_u32 s70, s70, 69632
s_add_u32 m0, s70, 0
s_xor_b32 s64, s65, 171008
s_cmpk_gt_u32 s69, 62
s_waitcnt vmcnt(6)
s_cbranch_scc1 L_d_59
s_waitcnt vmcnt(4)
L_d_59:
buffer_load_dwordx4 v1, s[40:43], s64 offen nt lds
s_add_u32 m0, s70, 1024
s_xor_b32 s64, s65, 236544
s_cmpk_gt_u32 s69, 63
s_waitcnt vmcnt(6)
s_cbranch_scc1 L_d_60
s_waitcnt vmcnt(4)
L_d_60:
buffer_load_dwordx4 v1, s[40:43], s64 offen nt lds
s_add_u32 m0, s70, 2048
s_xor_b32 s64, s65, 0
s_cmpk_gt_u32 s69, 64
s_waitcnt vmcnt(6)
s_cbranch_scc1 L_d_61
s_waitcnt vmcnt(4)
L_d_61:
buffer_load_dwordx4 v1, s[44:47], s64 offen nt lds
s_add_u32 m0, s70, 3072
s_xor_b32 s64, s65, 65536
s_cmpk_gt_u32 s69, 65
s_waitcnt vmcnt(6)
s_cbranch_scc1 L_d_62
s_waitcnt vmcnt(4)
L_d_62:
buffer_load_dwordx4 v1, s[44:47], s64 offen nt lds
s_add_u32 m0, s70, 4096
s_xor_b32 s64, s65, 2048
s_cmpk_gt_u32 s69, 66
s_waitcnt vmcnt(6)
s_cbranch_scc1 L_d_63
s_waitcnt vmcnt(4)
L_d_63:
buffer_load_dwordx4 v1, s[44:47], s64 offen nt lds
s_add_u32 m0, s70, 5120
s_xor_b32 s64, s65, 67584
s_cmpk_gt_u32 s69, 67
s_waitcnt vmcnt(6)
s_cbranch_scc1 L_d_64
s_waitcnt vmcnt(4)
L_d_64:
buffer_load_dwordx4 v1, s[44:47], s64 offen nt lds
v_cmp_eq_u32 vcc, 0, v3
s_cbranch_vccz L_jf_66
s_mov_b32 s75, 0
L_poll_67:
v_and_b32 v2, 31, v0
v_lshlrev_b32 v2, 2, v2
buffer_load_dword v3, v2, s[52:55], 0 offen offset:128 sc1
s_waitcnt vmcnt(0)
v_cmp_eq_u32 vcc, 0, v3
s_cbranch_vccz L_pollx_68
s_sleep 40
s_add_u32 s75, s75, 1
s_cmp_lt_u32 s75, 0x100000
s_cbranch_scc1 L_poll_67
L_pollx_68:
L_jf_66:
s_mul_i32 s68, s32, 12288
s_lshl_b32 s67, s33, 8
s_add_u32 s68, s68, s67
s_add_u32 s68, s68, 16384
v_and_b32 v2, 0xf0, v1
buffer_load_dwordx4 v[4:7], v2, s[36:39], s68 offen sc1
s_add_u32 m0, s70, 6144
s_xor_b32 s64, s65, 1024
s_cmpk_gt_u32 s69, 68
s_waitcnt vmcnt(6)
s_cbranch_scc1 L_d_65
s_waitcnt vmcnt(4)
L_d_65:
buffer_load_dwordx4 v1, s[44:47], s64 offen nt lds
s_add_u32 m0, s70, 7168
s_xor_b32 s64, s65, 66560
s_cmpk_gt_u32 s69, 69
s_waitcnt vmcnt(6)
s_cbranch_scc1 L_d_69
s_waitcnt vmcnt(4)
L_d_69:
buffer_load_dwordx4 v1, s[44:47], s64 offen nt lds
s_add_u32 m0, s70, 8192
s_xor_b32 s64, s65, 3072
s_cmpk_gt_u32 s69, 70
s_waitcnt vmcnt(6)
s_cbranch_scc1 L_d_70
s_waitcnt vmcnt(4)
L_d_70:
buffer_load_dwordx4 v1, s[44:47], s64 offen nt lds
s_add_u32 m0, s70, 9216
s_xor_b32 s64, s65, 68608
s_cmpk_gt_u32 s69, 71
s_waitcnt vmcnt(6)
s_cbranch_scc1 L_d_71
s_waitcnt vmcnt(4)
L_d_71:
buffer_load_dwordx4 v1, s[44:47], s64 offen nt lds
s_add_u32 m0, s70, 10240
s_xor_b32 s64, s65, 32768
s_cmpk_gt_u32 s69, 72
s_waitcnt vmcnt(6)
s_cbranch_scc1 L_d_72
s_waitcnt vmcnt(4)
L_d_72:
buffer_load_dwordx4 v1, s[44:47], s64 offen nt lds
s_add_u32 m0, s70, 11264
s_xor_b32 s64, s65, 98304
s_cmpk_gt_u32 s69, 73
s_waitcnt vmcnt(6)
s_cbranch_scc1 L_d_73
s_waitcnt vmcnt(4)
L_d_73:
buffer_load_dwordx4 v1, s[44:47], s64 offen nt lds
s_add_u32 m0, s70, 12288
s_xor_b32 s64, s65, 34816
s_cmpk_gt_u32 s69, 74
s_waitcnt vmcnt(6)
s_cbranch_scc1 L_d_74
s_waitcnt vmcnt(4)
L_d_74:
buffer_load_dwordx4 v1, s[44:47], s64 offen nt lds
s_add_u32 m0, s70, 13312
s_xor_b32 s64, s65, 100352
s_cmpk_gt_u32 s69, 75
s_waitcnt vmcnt(6)
s_cbranch_scc1 L_d_75
s_waitcnt vmcnt(4)
L_d_75:
buffer_load_dwordx4 v1, s[44:47], s64 offen nt lds
s_add_u32 m0, s70, 14336
s_xor_b32 s64, s65, 33792
s_cmpk_gt_u32 s69, 76
s_waitcnt vmcnt(6)
s_cbranch_scc1 L_d_76
s_waitcnt vmcnt(4)
L_d_76:
buffer_load_dwordx4 v1, s[44:47], s64 offen nt lds
v_max3_u32 v3, v4, v5, v6
v_max_u32 v3, v3, v7
v_cmp_eq_u32 vcc, -1, v3
s_cbranch_vccz L_q_77
s_mov_b32 s75, 0
L_poll_78:
s_mul_i32 s68, s32, 12288
s_lshl_b32 s67, s33, 8
s_add_u32 s68, s68, s67
s_add_u32 s68, s68, 16384
v_and_b32 v2, 0xf0, v1
buffer_load_dwordx4 v[4:7], v2, s[36:39], s68 offen sc1
s_waitcnt vmcnt(0)
v_max3_u32 v3, v4, v5, v6
v_max_u32 v3, v3, v7
v_cmp_eq_u32 vcc, -1, v3
s_cbranch_vccz L_pollx_79
s_add_u32 s75, s75, 1
s_cmp_lt_u32 s75, 0x100000
s_cbranch_scc1 L_poll_78
L_pollx_79:
L_q_77:
s_mov_b32 s66, 0x3db504f3
v_dot2_f32_bf16 v8, v8, v4, 0
v_dot2_f32_bf16 v12, v12, v4, 0
v_dot2_f32_bf16 v16, v16, v4, 0
v_dot2_f32_bf16 v20, v20, v4, 0
v_dot2c_f32_bf16 v8, v9, v5
v_dot2c_f32_bf16 v12, v13, v5
v_dot2c_f32_bf16 v16, v17, v5
v_dot2c_f32_bf16 v20, v21, v5
v_dot2c_f32_bf16 v8, v10, v6
v_dot2c_f32_bf16 v12, v14, v6
v_dot2c_f32_bf16 v16, v18, v6
v_dot2c_f32_bf16 v20, v22, v6
v_dot2c_f32_bf16 v8, v11, v7
v_dot2c_f32_bf16 v12, v15, v7
v_dot2c_f32_bf16 v16, v19, v7
v_dot2c_f32_bf16 v20, v23, v7
v_add_f32_dpp v9, v8, v8 row_ror:8 row_mask:0xf bank_mask:0x3
v_add_f32_dpp v13, v12, v12 row_ror:8 row_mask:0xf bank_mask:0x3
v_add_f32_dpp v9, v16, v16 row_ror:8 row_mask:0xf bank_mask:0xc
v_add_f32_dpp v13, v20, v20 row_ror:8 row_mask:0xf bank_mask:0xc
s_nop 0
v_add_f32_dpp v17, v9, v9 row_shl:4 row_mask:0xf bank_mask:0x5
v_add_f32_dpp v17, v13, v13 row_shr:4 row_mask:0xf bank_mask:0xa
s_nop 1
v_add_f32_dpp v17, v17, v17 quad_perm:[1,0,3,2] row_mask:0xf bank_mask:0xf
s_nop 1
v_add_f32_dpp v17, v17, v17 quad_perm:[2,3,0,1] row_mask:0xf bank_mask:0xf
v_cvt_pk_bf16_f32 v17, 0, v17
v_mul_f32 v17, s66, v17
v_cvt_pk_bf16_f32 v17, 0, v17
v_dot2_f32_bf16 v24, v24, v4, 0
v_dot2_f32_bf16 v28, v28, v4, 0
v_dot2_f32_bf16 v32, v32, v4, 0
v_dot2_f32_bf16 v36, v36, v4, 0
v_dot2c_f32_bf16 v24, v25, v5
v_dot2c_f32_bf16 v28, v29, v5
v_dot2c_f32_bf16 v32, v33, v5
v_dot2c_f32_bf16 v36, v37, v5
v_dot2c_f32_bf16 v24, v26, v6
v_dot2c_f32_bf16 v28, v30, v6
v_dot2c_f32_bf16 v32, v34, v6
v_dot2c_f32_bf16 v36, v38, v6
v_dot2c_f32_bf16 v24, v27, v7
v_dot2c_f32_bf16 v28, v31, v7
v_dot2c_f32_bf16 v32, v35, v7
v_dot2c_f32_bf16 v36, v39, v7
v_add_f32_dpp v25, v24, v24 row_ror:8 row_mask:0xf bank_mask:0x3
v_add_f32_dpp v29, v28, v28 row_ror:8 row_mask:0xf bank_mask:0x3
v_add_f32_dpp v25, v32, v32 row_ror:8 row_mask:0xf bank_mask:0xc
v_add_f32_dpp v29, v36, v36 row_ror:8 row_mask:0xf bank_mask:0xc
s_nop 0
v_add_f32_dpp v8, v25, v25 row_shl:4 row_mask:0xf bank_mask:0x5
v_add_f32_dpp v8, v29, v29 row_shr:4 row_mask:0xf bank_mask:0xa
s_nop 1
v_add_f32_dpp v8, v8, v8 quad_perm:[1,0,3,2] row_mask:0xf bank_mask:0xf
s_nop 1
v_add_f32_dpp v8, v8, v8 quad_perm:[2,3,0,1] row_mask:0xf bank_mask:0xf
v_cvt_pk_bf16_f32 v8, 0, v8
v_mul_f32 v8, s66, v8
v_cvt_pk_bf16_f32 v8, 0, v8
s_xor_b32 s64, s65, 99328
s_cmpk_gt_u32 s69, 77
s_waitcnt vmcnt(6)
s_cbranch_scc1 L_d_80
s_waitcnt vmcnt(4)
L_d_80:
buffer_load_dwordx4 v[24:27], v1, s[44:47], s64 offen nt
v_dot2_f32_bf16 v40, v40, v4, 0
v_dot2_f32_bf16 v44, v44, v4, 0
v_dot2_f32_bf16 v48, v48, v4, 0
v_dot2_f32_bf16 v52, v52, v4, 0
v_dot2c_f32_bf16 v40, v41, v5
v_dot2c_f32_bf16 v44, v45, v5
v_dot2c_f32_bf16 v48, v49, v5
v_dot2c_f32_bf16 v52, v53, v5
v_dot2c_f32_bf16 v40, v42, v6
v_dot2c_f32_bf16 v44, v46, v6
v_dot2c_f32_bf16 v48, v50, v6
v_dot2c_f32_bf16 v52, v54, v6
v_dot2c_f32_bf16 v40, v43, v7
v_dot2c_f32_bf16 v44, v47, v7
v_dot2c_f32_bf16 v48, v51, v7
v_dot2c_f32_bf16 v52, v55, v7
v_add_f32_dpp v41, v40, v40 row_ror:8 row_mask:0xf bank_mask:0x3
v_add_f32_dpp v45, v44, v44 row_ror:8 row_mask:0xf bank_mask:0x3
v_add_f32_dpp v41, v48, v48 row_ror:8 row_mask:0xf bank_mask:0xc
v_add_f32_dpp v45, v52, v52 row_ror:8 row_mask:0xf bank_mask:0xc
s_nop 0
v_add_f32_dpp v9, v41, v41 row_shl:4 row_mask:0xf bank_mask:0x5
v_add_f32_dpp v9, v45, v45 row_shr:4 row_mask:0xf bank_mask:0xa
s_nop 1
v_add_f32_dpp v9, v9, v9 quad_perm:[1,0,3,2] row_mask:0xf bank_mask:0xf
s_nop 1
v_add_f32_dpp v9, v9, v9 quad_perm:[2,3,0,1] row_mask:0xf bank_mask:0xf
v_cvt_pk_bf16_f32 v9, 0, v9
v_mul_f32 v9, s66, v9
v_cvt_pk_bf16_f32 v9, 0, v9
s_and_b32 s62, s2, 7
s_lshl_b32 s62, s62, 9
s_add_u32 s62, s62, 1327104
s_lshr_b32 s63, s2, 3
s_lshl_b32 s63, s63, 2
s_add_u32 s63, s63, s62
s_cmp_eq_u32 s34, 0
s_cbranch_scc0 L_w_82
v_mov_b32 v2, 14
s_mov_b64 exec, 1
buffer_store_dword v2, off, s[36:39], s63 offset:0
s_mov_b64 exec, -1
L_w_82:
s_xor_b32 s64, s65, 35840
s_cmpk_gt_u32 s69, 78
s_waitcnt vmcnt(6)
s_cbranch_scc1 L_d_81
s_waitcnt vmcnt(4)
L_d_81:
buffer_load_dwordx4 v[28:31], v1, s[44:47], s64 offen nt
v_dot2_f32_bf16 v56, v56, v4, 0
v_dot2_f32_bf16 v60, v60, v4, 0
v_dot2_f32_bf16 v64, v64, v4, 0
v_dot2_f32_bf16 v68, v68, v4, 0
v_dot2c_f32_bf16 v56, v57, v5
v_dot2c_f32_bf16 v60, v61, v5
v_dot2c_f32_bf16 v64, v65, v5
v_dot2c_f32_bf16 v68, v69, v5
v_dot2c_f32_bf16 v56, v58, v6
v_dot2c_f32_bf16 v60, v62, v6
v_dot2c_f32_bf16 v64, v66, v6
v_dot2c_f32_bf16 v68, v70, v6
v_dot2c_f32_bf16 v56, v59, v7
v_dot2c_f32_bf16 v60, v63, v7
v_dot2c_f32_bf16 v64, v67, v7
v_dot2c_f32_bf16 v68, v71, v7
v_add_f32_dpp v57, v56, v56 row_ror:8 row_mask:0xf bank_mask:0x3
v_add_f32_dpp v61, v60, v60 row_ror:8 row_mask:0xf bank_mask:0x3
v_add_f32_dpp v57, v64, v64 row_ror:8 row_mask:0xf bank_mask:0xc
v_add_f32_dpp v61, v68, v68 row_ror:8 row_mask:0xf bank_mask:0xc
s_nop 0
v_add_f32_dpp v10, v57, v57 row_shl:4 row_mask:0xf bank_mask:0x5
v_add_f32_dpp v10, v61, v61 row_shr:4 row_mask:0xf bank_mask:0xa
s_nop 1
v_add_f32_dpp v10, v10, v10 quad_perm:[1,0,3,2] row_mask:0xf bank_mask:0xf
s_nop 1
v_add_f32_dpp v10, v10, v10 quad_perm:[2,3,0,1] row_mask:0xf bank_mask:0xf
v_cvt_pk_bf16_f32 v10, 0, v10
v_mul_f32 v10, s66, v10
v_cvt_pk_bf16_f32 v10, 0, v10
s_xor_b32 s64, s65, 101376
s_cmpk_gt_u32 s69, 79
s_waitcnt vmcnt(6)
s_cbranch_scc1 L_d_83
s_waitcnt vmcnt(4)
L_d_83:
buffer_load_dwordx4 v[32:35], v1, s[44:47], s64 offen nt
v_dot2_f32_bf16 v72, v72, v4, 0
v_dot2_f32_bf16 v76, v76, v4, 0
v_dot2_f32_bf16 v80, v80, v4, 0
v_dot2_f32_bf16 v84, v84, v4, 0
v_dot2c_f32_bf16 v72, v73, v5
v_dot2c_f32_bf16 v76, v77, v5
v_dot2c_f32_bf16 v80, v81, v5
v_dot2c_f32_bf16 v84, v85, v5
v_dot2c_f32_bf16 v72, v74, v6
v_dot2c_f32_bf16 v76, v78, v6
v_dot2c_f32_bf16 v80, v82, v6
v_dot2c_f32_bf16 v84, v86, v6
v_dot2c_f32_bf16 v72, v75, v7
v_dot2c_f32_bf16 v76, v79, v7
v_dot2c_f32_bf16 v80, v83, v7
v_dot2c_f32_bf16 v84, v87, v7
v_add_f32_dpp v73, v72, v72 row_ror:8 row_mask:0xf bank_mask:0x3
v_add_f32_dpp v77, v76, v76 row_ror:8 row_mask:0xf bank_mask:0x3
v_add_f32_dpp v73, v80, v80 row_ror:8 row_mask:0xf bank_mask:0xc
v_add_f32_dpp v77, v84, v84 row_ror:8 row_mask:0xf bank_mask:0xc
s_nop 0
v_add_f32_dpp v11, v73, v73 row_shl:4 row_mask:0xf bank_mask:0x5
v_add_f32_dpp v11, v77, v77 row_shr:4 row_mask:0xf bank_mask:0xa
s_nop 1
v_add_f32_dpp v11, v11, v11 quad_perm:[1,0,3,2] row_mask:0xf bank_mask:0xf
s_nop 1
v_add_f32_dpp v11, v11, v11 quad_perm:[2,3,0,1] row_mask:0xf bank_mask:0xf
v_cvt_pk_bf16_f32 v11, 0, v11
v_mul_f32 v11, s66, v11
v_cvt_pk_bf16_f32 v11, 0, v11
s_xor_b32 s64, s65, 131072
s_cmpk_gt_u32 s69, 80
s_waitcnt vmcnt(6)
s_cbranch_scc1 L_d_84
s_waitcnt vmcnt(4)
L_d_84:
buffer_load_dwordx4 v[36:39], v1, s[44:47], s64 offen nt
v_dot2_f32_bf16 v88, v88, v4, 0
v_dot2_f32_bf16 v92, v92, v4, 0
v_dot2_f32_bf16 v96, v96, v4, 0
v_dot2_f32_bf16 v100, v100, v4, 0
v_dot2c_f32_bf16 v88, v89, v5
v_dot2c_f32_bf16 v92, v93, v5
v_dot2c_f32_bf16 v96, v97, v5
v_dot2c_f32_bf16 v100, v101, v5
v_dot2c_f32_bf16 v88, v90, v6
v_dot2c_f32_bf16 v92, v94, v6
v_dot2c_f32_bf16 v96, v98, v6
v_dot2c_f32_bf16 v100, v102, v6
v_dot2c_f32_bf16 v88, v91, v7
v_dot2c_f32_bf16 v92, v95, v7
v_dot2c_f32_bf16 v96, v99, v7
v_dot2c_f32_bf16 v100, v103, v7
v_add_f32_dpp v89, v88, v88 row_ror:8 row_mask:0xf bank_mask:0x3
v_add_f32_dpp v93, v92, v92 row_ror:8 row_mask:0xf bank_mask:0x3
v_add_f32_dpp v89, v96, v96 row_ror:8 row_mask:0xf bank_mask:0xc
v_add_f32_dpp v93, v100, v100 row_ror:8 row_mask:0xf bank_mask:0xc
s_nop 0
v_add_f32_dpp v12, v89, v89 row_shl:4 row_mask:0xf bank_mask:0x5
v_add_f32_dpp v12, v93, v93 row_shr:4 row_mask:0xf bank_mask:0xa
s_nop 1
v_add_f32_dpp v12, v12, v12 quad_perm:[1,0,3,2] row_mask:0xf bank_mask:0xf
s_nop 1
v_add_f32_dpp v12, v12, v12 quad_perm:[2,3,0,1] row_mask:0xf bank_mask:0xf
v_cvt_pk_bf16_f32 v12, 0, v12
v_mul_f32 v12, s66, v12
v_cvt_pk_bf16_f32 v12, 0, v12
s_xor_b32 s64, s65, 196608
s_cmpk_gt_u32 s69, 81
s_waitcnt vmcnt(6)
s_cbranch_scc1 L_d_85
s_waitcnt vmcnt(4)
L_d_85:
buffer_load_dwordx4 v[40:43], v1, s[44:47], s64 offen nt
v_dot2_f32_bf16 v104, v104, v4, 0
v_dot2_f32_bf16 v108, v108, v4, 0
v_dot2_f32_bf16 v112, v112, v4, 0
v_dot2_f32_bf16 v116, v116, v4, 0
v_dot2c_f32_bf16 v104, v105, v5
v_dot2c_f32_bf16 v108, v109, v5
v_dot2c_f32_bf16 v112, v113, v5
v_dot2c_f32_bf16 v116, v117, v5
v_dot2c_f32_bf16 v104, v106, v6
v_dot2c_f32_bf16 v108, v110, v6
v_dot2c_f32_bf16 v112, v114, v6
v_dot2c_f32_bf16 v116, v118, v6
v_dot2c_f32_bf16 v104, v107, v7
v_dot2c_f32_bf16 v108, v111, v7
v_dot2c_f32_bf16 v112, v115, v7
v_dot2c_f32_bf16 v116, v119, v7
v_add_f32_dpp v105, v104, v104 row_ror:8 row_mask:0xf bank_mask:0x3
v_add_f32_dpp v109, v108, v108 row_ror:8 row_mask:0xf bank_mask:0x3
v_add_f32_dpp v105, v112, v112 row_ror:8 row_mask:0xf bank_mask:0xc
v_add_f32_dpp v109, v116, v116 row_ror:8 row_mask:0xf bank_mask:0xc
s_nop 0
v_add_f32_dpp v13, v105, v105 row_shl:4 row_mask:0xf bank_mask:0x5
v_add_f32_dpp v13, v109, v109 row_shr:4 row_mask:0xf bank_mask:0xa
s_nop 1
v_add_f32_dpp v13, v13, v13 quad_perm:[1,0,3,2] row_mask:0xf bank_mask:0xf
s_nop 1
v_add_f32_dpp v13, v13, v13 quad_perm:[2,3,0,1] row_mask:0xf bank_mask:0xf
v_cvt_pk_bf16_f32 v13, 0, v13
v_mul_f32 v13, s66, v13
v_cvt_pk_bf16_f32 v13, 0, v13
s_xor_b32 s64, s65, 133120
s_cmpk_gt_u32 s69, 82
s_waitcnt vmcnt(6)
s_cbranch_scc1 L_d_86
s_waitcnt vmcnt(4)
L_d_86:
buffer_load_dwordx4 v[44:47], v1, s[44:47], s64 offen nt
v_dot2_f32_bf16 v120, v120, v4, 0
v_dot2_f32_bf16 v124, v124, v4, 0
v_dot2_f32_bf16 v128, v128, v4, 0
v_dot2_f32_bf16 v132, v132, v4, 0
v_dot2c_f32_bf16 v120, v121, v5
v_dot2c_f32_bf16 v124, v125, v5
v_dot2c_f32_bf16 v128, v129, v5
v_dot2c_f32_bf16 v132, v133, v5
v_dot2c_f32_bf16 v120, v122, v6
v_dot2c_f32_bf16 v124, v126, v6
v_dot2c_f32_bf16 v128, v130, v6
v_dot2c_f32_bf16 v132, v134, v6
v_dot2c_f32_bf16 v120, v123, v7
v_dot2c_f32_bf16 v124, v127, v7
v_dot2c_f32_bf16 v128, v131, v7
v_dot2c_f32_bf16 v132, v135, v7
v_add_f32_dpp v121, v120, v120 row_ror:8 row_mask:0xf bank_mask:0x3
v_add_f32_dpp v125, v124, v124 row_ror:8 row_mask:0xf bank_mask:0x3
v_add_f32_dpp v121, v128, v128 row_ror:8 row_mask:0xf bank_mask:0xc
v_add_f32_dpp v125, v132, v132 row_ror:8 row_mask:0xf bank_mask:0xc
s_nop 0
v_add_f32_dpp v14, v121, v121 row_shl:4 row_mask:0xf bank_mask:0x5
v_add_f32_dpp v14, v125, v125 row_shr:4 row_mask:0xf bank_mask:0xa
s_nop 1
v_add_f32_dpp v14, v14, v14 quad_perm:[1,0,3,2] row_mask:0xf bank_mask:0xf
s_nop 1
v_add_f32_dpp v14, v14, v14 quad_perm:[2,3,0,1] row_mask:0xf bank_mask:0xf
v_cvt_pk_bf16_f32 v14, 0, v14
v_mul_f32 v14, s66, v14
v_cvt_pk_bf16_f32 v14, 0, v14
s_xor_b32 s64, s65, 198656
s_cmpk_gt_u32 s69, 83
s_waitcnt vmcnt(6)
s_cbranch_scc1 L_d_87
s_waitcnt vmcnt(4)
L_d_87:
buffer_load_dwordx4 v[48:51], v1, s[44:47], s64 offen nt
v_dot2_f32_bf16 v136, v136, v4, 0
v_dot2_f32_bf16 v140, v140, v4, 0
v_dot2_f32_bf16 v144, v144, v4, 0
v_dot2_f32_bf16 v148, v148, v4, 0
v_dot2c_f32_bf16 v136, v137, v5
v_dot2c_f32_bf16 v140, v141, v5
v_dot2c_f32_bf16 v144, v145, v5
v_dot2c_f32_bf16 v148, v149, v5
v_dot2c_f32_bf16 v136, v138, v6
v_dot2c_f32_bf16 v140, v142, v6
v_dot2c_f32_bf16 v144, v146, v6
v_dot2c_f32_bf16 v148, v150, v6
v_dot2c_f32_bf16 v136, v139, v7
v_dot2c_f32_bf16 v140, v143, v7
v_dot2c_f32_bf16 v144, v147, v7
v_dot2c_f32_bf16 v148, v151, v7
v_add_f32_dpp v137, v136, v136 row_ror:8 row_mask:0xf bank_mask:0x3
v_add_f32_dpp v141, v140, v140 row_ror:8 row_mask:0xf bank_mask:0x3
v_add_f32_dpp v137, v144, v144 row_ror:8 row_mask:0xf bank_mask:0xc
v_add_f32_dpp v141, v148, v148 row_ror:8 row_mask:0xf bank_mask:0xc
s_nop 0
v_add_f32_dpp v15, v137, v137 row_shl:4 row_mask:0xf bank_mask:0x5
v_add_f32_dpp v15, v141, v141 row_shr:4 row_mask:0xf bank_mask:0xa
s_nop 1
v_add_f32_dpp v15, v15, v15 quad_perm:[1,0,3,2] row_mask:0xf bank_mask:0xf
s_nop 1
v_add_f32_dpp v15, v15, v15 quad_perm:[2,3,0,1] row_mask:0xf bank_mask:0xf
v_cvt_pk_bf16_f32 v15, 0, v15
v_mul_f32 v15, s66, v15
v_cvt_pk_bf16_f32 v15, 0, v15
s_xor_b32 s64, s65, 132096
s_cmpk_gt_u32 s69, 84
s_waitcnt vmcnt(6)
s_cbranch_scc1 L_d_88
s_waitcnt vmcnt(4)
L_d_88:
buffer_load_dwordx4 v[52:55], v1, s[44:47], s64 offen nt
v_dot2_f32_bf16 v152, v152, v4, 0
v_dot2_f32_bf16 v156, v156, v4, 0
v_dot2_f32_bf16 v160, v160, v4, 0
v_dot2_f32_bf16 v164, v164, v4, 0
v_dot2c_f32_bf16 v152, v153, v5
v_dot2c_f32_bf16 v156, v157, v5
v_dot2c_f32_bf16 v160, v161, v5
v_dot2c_f32_bf16 v164, v165, v5
v_dot2c_f32_bf16 v152, v154, v6
v_dot2c_f32_bf16 v156, v158, v6
v_dot2c_f32_bf16 v160, v162, v6
v_dot2c_f32_bf16 v164, v166, v6
v_dot2c_f32_bf16 v152, v155, v7
v_dot2c_f32_bf16 v156, v159, v7
v_dot2c_f32_bf16 v160, v163, v7
v_dot2c_f32_bf16 v164, v167, v7
v_add_f32_dpp v153, v152, v152 row_ror:8 row_mask:0xf bank_mask:0x3
v_add_f32_dpp v157, v156, v156 row_ror:8 row_mask:0xf bank_mask:0x3
v_add_f32_dpp v153, v160, v160 row_ror:8 row_mask:0xf bank_mask:0xc
v_add_f32_dpp v157, v164, v164 row_ror:8 row_mask:0xf bank_mask:0xc
s_nop 0
v_add_f32_dpp v16, v153, v153 row_shl:4 row_mask:0xf bank_mask:0x5
v_add_f32_dpp v16, v157, v157 row_shr:4 row_mask:0xf bank_mask:0xa
s_nop 1
v_add_f32_dpp v16, v16, v16 quad_perm:[1,0,3,2] row_mask:0xf bank_mask:0xf
s_nop 1
v_add_f32_dpp v16, v16, v16 quad_perm:[2,3,0,1] row_mask:0xf bank_mask:0xf
v_cvt_pk_bf16_f32 v16, 0, v16
v_mul_f32 v16, s66, v16
v_cvt_pk_bf16_f32 v16, 0, v16
s_xor_b32 s64, s65, 197632
s_cmpk_gt_u32 s69, 85
s_waitcnt vmcnt(6)
s_cbranch_scc1 L_d_89
s_waitcnt vmcnt(4)
L_d_89:
buffer_load_dwordx4 v[56:59], v1, s[44:47], s64 offen nt
v_dot2_f32_bf16 v168, v168, v4, 0
v_dot2_f32_bf16 v172, v172, v4, 0
v_dot2_f32_bf16 v176, v176, v4, 0
v_dot2_f32_bf16 v180, v180, v4, 0
v_dot2c_f32_bf16 v168, v169, v5
v_dot2c_f32_bf16 v172, v173, v5
v_dot2c_f32_bf16 v176, v177, v5
v_dot2c_f32_bf16 v180, v181, v5
v_dot2c_f32_bf16 v168, v170, v6
v_dot2c_f32_bf16 v172, v174, v6
v_dot2c_f32_bf16 v176, v178, v6
v_dot2c_f32_bf16 v180, v182, v6
v_dot2c_f32_bf16 v168, v171, v7
v_dot2c_f32_bf16 v172, v175, v7
v_dot2c_f32_bf16 v176, v179, v7
v_dot2c_f32_bf16 v180, v183, v7
v_add_f32_dpp v169, v168, v168 row_ror:8 row_mask:0xf bank_mask:0x3
v_add_f32_dpp v173, v172, v172 row_ror:8 row_mask:0xf bank_mask:0x3
v_add_f32_dpp v169, v176, v176 row_ror:8 row_mask:0xf bank_mask:0xc
v_add_f32_dpp v173, v180, v180 row_ror:8 row_mask:0xf bank_mask:0xc
s_nop 0
v_add_f32_dpp v18, v169, v169 row_shl:4 row_mask:0xf bank_mask:0x5
v_add_f32_dpp v18, v173, v173 row_shr:4 row_mask:0xf bank_mask:0xa
s_nop 1
v_add_f32_dpp v18, v18, v18 quad_perm:[1,0,3,2] row_mask:0xf bank_mask:0xf
s_nop 1
v_add_f32_dpp v18, v18, v18 quad_perm:[2,3,0,1] row_mask:0xf bank_mask:0xf
v_cvt_pk_bf16_f32 v18, 0, v18
v_mul_f32 v18, s66, v18
v_cvt_pk_bf16_f32 v18, 0, v18
s_cmp_eq_u32 s34, 1
s_cbranch_scc0 L_w_91
v_mov_b32 v60, 22
s_mov_b64 exec, 1
buffer_store_dword v60, off, s[36:39], s63 offset:0
s_mov_b64 exec, -1
L_w_91:
s_xor_b32 s64, s65, 134144
s_cmpk_gt_u32 s69, 86
s_waitcnt vmcnt(6)
s_cbranch_scc1 L_d_90
s_waitcnt vmcnt(4)
L_d_90:
buffer_load_dwordx4 v[64:67], v1, s[44:47], s64 offen nt
v_dot2_f32_bf16 v184, v184, v4, 0
v_dot2_f32_bf16 v188, v188, v4, 0
v_dot2_f32_bf16 v192, v192, v4, 0
v_dot2_f32_bf16 v196, v196, v4, 0
v_dot2c_f32_bf16 v184, v185, v5
v_dot2c_f32_bf16 v188, v189, v5
v_dot2c_f32_bf16 v192, v193, v5
v_dot2c_f32_bf16 v196, v197, v5
v_dot2c_f32_bf16 v184, v186, v6
v_dot2c_f32_bf16 v188, v190, v6
v_dot2c_f32_bf16 v192, v194, v6
v_dot2c_f32_bf16 v196, v198, v6
v_dot2c_f32_bf16 v184, v187, v7
v_dot2c_f32_bf16 v188, v191, v7
v_dot2c_f32_bf16 v192, v195, v7
v_dot2c_f32_bf16 v196, v199, v7
v_add_f32_dpp v185, v184, v184 row_ror:8 row_mask:0xf bank_mask:0x3
v_add_f32_dpp v189, v188, v188 row_ror:8 row_mask:0xf bank_mask:0x3
v_add_f32_dpp v185, v192, v192 row_ror:8 row_mask:0xf bank_mask:0xc
v_add_f32_dpp v189, v196, v196 row_ror:8 row_mask:0xf bank_mask:0xc
s_nop 0
v_add_f32_dpp v19, v185, v185 row_shl:4 row_mask:0xf bank_mask:0x5
v_add_f32_dpp v19, v189, v189 row_shr:4 row_mask:0xf bank_mask:0xa
s_nop 1
v_add_f32_dpp v19, v19, v19 quad_perm:[1,0,3,2] row_mask:0xf bank_mask:0xf
s_nop 1
v_add_f32_dpp v19, v19, v19 quad_perm:[2,3,0,1] row_mask:0xf bank_mask:0xf
v_cvt_pk_bf16_f32 v19, 0, v19
v_mul_f32 v19, s66, v19
v_cvt_pk_bf16_f32 v19, 0, v19
s_xor_b32 s64, s65, 199680
s_cmpk_gt_u32 s69, 87
s_waitcnt vmcnt(6)
s_cbranch_scc1 L_d_92
s_waitcnt vmcnt(4)
L_d_92:
buffer_load_dwordx4 v[68:71], v1, s[44:47], s64 offen nt
v_dot2_f32_bf16 v200, v200, v4, 0
v_dot2_f32_bf16 v204, v204, v4, 0
v_dot2_f32_bf16 v208, v208, v4, 0
v_dot2_f32_bf16 v212, v212, v4, 0
v_dot2c_f32_bf16 v200, v201, v5
v_dot2c_f32_bf16 v204, v205, v5
v_dot2c_f32_bf16 v208, v209, v5
v_dot2c_f32_bf16 v212, v213, v5
v_dot2c_f32_bf16 v200, v202, v6
v_dot2c_f32_bf16 v204, v206, v6
v_dot2c_f32_bf16 v208, v210, v6
v_dot2c_f32_bf16 v212, v214, v6
v_dot2c_f32_bf16 v200, v203, v7
v_dot2c_f32_bf16 v204, v207, v7
v_dot2c_f32_bf16 v208, v211, v7
v_dot2c_f32_bf16 v212, v215, v7
v_add_f32_dpp v201, v200, v200 row_ror:8 row_mask:0xf bank_mask:0x3
v_add_f32_dpp v205, v204, v204 row_ror:8 row_mask:0xf bank_mask:0x3
v_add_f32_dpp v201, v208, v208 row_ror:8 row_mask:0xf bank_mask:0xc
v_add_f32_dpp v205, v212, v212 row_ror:8 row_mask:0xf bank_mask:0xc
s_nop 0
v_add_f32_dpp v20, v201, v201 row_shl:4 row_mask:0xf bank_mask:0x5
v_add_f32_dpp v20, v205, v205 row_shr:4 row_mask:0xf bank_mask:0xa
s_nop 1
v_add_f32_dpp v20, v20, v20 quad_perm:[1,0,3,2] row_mask:0xf bank_mask:0xf
s_nop 1
v_add_f32_dpp v20, v20, v20 quad_perm:[2,3,0,1] row_mask:0xf bank_mask:0xf
v_cvt_pk_bf16_f32 v20, 0, v20
v_mul_f32 v20, s66, v20
v_cvt_pk_bf16_f32 v20, 0, v20
s_xor_b32 s64, s65, 163840
s_cmpk_gt_u32 s69, 88
s_waitcnt vmcnt(6)
s_cbranch_scc1 L_d_93
s_waitcnt vmcnt(4)
L_d_93:
buffer_load_dwordx4 v[72:75], v1, s[44:47], s64 offen nt
v_dot2_f32_bf16 v216, v216, v4, 0
v_dot2_f32_bf16 v220, v220, v4, 0
v_dot2_f32_bf16 v224, v224, v4, 0
v_dot2_f32_bf16 v228, v228, v4, 0
v_dot2c_f32_bf16 v216, v217, v5
v_dot2c_f32_bf16 v220, v221, v5
v_dot2c_f32_bf16 v224, v225, v5
v_dot2c_f32_bf16 v228, v229, v5
v_dot2c_f32_bf16 v216, v218, v6
v_dot2c_f32_bf16 v220, v222, v6
v_dot2c_f32_bf16 v224, v226, v6
v_dot2c_f32_bf16 v228, v230, v6
v_dot2c_f32_bf16 v216, v219, v7
v_dot2c_f32_bf16 v220, v223, v7
v_dot2c_f32_bf16 v224, v227, v7
v_dot2c_f32_bf16 v228, v231, v7
v_add_f32_dpp v217, v216, v216 row_ror:8 row_mask:0xf bank_mask:0x3
v_add_f32_dpp v221, v220, v220 row_ror:8 row_mask:0xf bank_mask:0x3
v_add_f32_dpp v217, v224, v224 row_ror:8 row_mask:0xf bank_mask:0xc
v_add_f32_dpp v221, v228, v228 row_ror:8 row_mask:0xf bank_mask:0xc
s_nop 0
v_add_f32_dpp v21, v217, v217 row_shl:4 row_mask:0xf bank_mask:0x5
v_add_f32_dpp v21, v221, v221 row_shr:4 row_mask:0xf bank_mask:0xa
s_nop 1
v_add_f32_dpp v21, v21, v21 quad_perm:[1,0,3,2] row_mask:0xf bank_mask:0xf
s_nop 1
v_add_f32_dpp v21, v21, v21 quad_perm:[2,3,0,1] row_mask:0xf bank_mask:0xf
v_cvt_pk_bf16_f32 v21, 0, v21
v_mul_f32 v21, s66, v21
v_cvt_pk_bf16_f32 v21, 0, v21
s_xor_b32 s64, s65, 229376
s_cmpk_gt_u32 s69, 89
s_waitcnt vmcnt(6)
s_cbranch_scc1 L_d_94
s_waitcnt vmcnt(4)
L_d_94:
buffer_load_dwordx4 v[76:79], v1, s[44:47], s64 offen nt
v_dot2_f32_bf16 v232, v232, v4, 0
v_dot2_f32_bf16 v236, v236, v4, 0
v_dot2_f32_bf16 v240, v240, v4, 0
v_dot2_f32_bf16 v244, v244, v4, 0
v_dot2c_f32_bf16 v232, v233, v5
v_dot2c_f32_bf16 v236, v237, v5
v_dot2c_f32_bf16 v240, v241, v5
v_dot2c_f32_bf16 v244, v245, v5
v_dot2c_f32_bf16 v232, v234, v6
v_dot2c_f32_bf16 v236, v238, v6
v_dot2c_f32_bf16 v240, v242, v6
v_dot2c_f32_bf16 v244, v246, v6
v_dot2c_f32_bf16 v232, v235, v7
v_dot2c_f32_bf16 v236, v239, v7
v_dot2c_f32_bf16 v240, v243, v7
v_dot2c_f32_bf16 v244, v247, v7
v_add_f32_dpp v233, v232, v232 row_ror:8 row_mask:0xf bank_mask:0x3
v_add_f32_dpp v237, v236, v236 row_ror:8 row_mask:0xf bank_mask:0x3
v_add_f32_dpp v233, v240, v240 row_ror:8 row_mask:0xf bank_mask:0xc
v_add_f32_dpp v237, v244, v244 row_ror:8 row_mask:0xf bank_mask:0xc
s_nop 0
v_add_f32_dpp v22, v233, v233 row_shl:4 row_mask:0xf bank_mask:0x5
v_add_f32_dpp v22, v237, v237 row_shr:4 row_mask:0xf bank_mask:0xa
s_nop 1
v_add_f32_dpp v22, v22, v22 quad_perm:[1,0,3,2] row_mask:0xf bank_mask:0xf
s_nop 1
v_add_f32_dpp v22, v22, v22 quad_perm:[2,3,0,1] row_mask:0xf bank_mask:0xf
v_cvt_pk_bf16_f32 v22, 0, v22
v_mul_f32 v22, s66, v22
v_cvt_pk_bf16_f32 v22, 0, v22
s_xor_b32 s64, s65, 165888
s_cmpk_gt_u32 s69, 90
s_waitcnt vmcnt(6)
s_cbranch_scc1 L_d_95
s_waitcnt vmcnt(5)
L_d_95:
buffer_load_dwordx4 v[80:83], v1, s[44:47], s64 offen nt
v_lshl_add_u32 v84, v0, 4, s70
ds_read_b128 v[88:91], v84 offset:0
ds_read_b128 v[92:95], v84 offset:1024
s_waitcnt lgkmcnt(0)
v_dot2_f32_bf16 v248, v248, v4, 0
v_dot2_f32_bf16 v252, v252, v4, 0
v_dot2_f32_bf16 v88, v88, v4, 0
v_dot2_f32_bf16 v92, v92, v4, 0
v_dot2c_f32_bf16 v248, v249, v5
v_dot2c_f32_bf16 v252, v253, v5
v_dot2c_f32_bf16 v88, v89, v5
v_dot2c_f32_bf16 v92, v93, v5
v_dot2c_f32_bf16 v248, v250, v6
v_dot2c_f32_bf16 v252, v254, v6
v_dot2c_f32_bf16 v88, v90, v6
v_dot2c_f32_bf16 v92, v94, v6
v_dot2c_f32_bf16 v248, v251, v7
v_dot2c_f32_bf16 v252, v255, v7
v_dot2c_f32_bf16 v88, v91, v7
v_dot2c_f32_bf16 v92, v95, v7
v_add_f32_dpp v249, v248, v248 row_ror:8 row_mask:0xf bank_mask:0x3
v_add_f32_dpp v253, v252, v252 row_ror:8 row_mask:0xf bank_mask:0x3
v_add_f32_dpp v249, v88, v88 row_ror:8 row_mask:0xf bank_mask:0xc
v_add_f32_dpp v253, v92, v92 row_ror:8 row_mask:0xf bank_mask:0xc
s_nop 0
v_add_f32_dpp v23, v249, v249 row_shl:4 row_mask:0xf bank_mask:0x5
v_add_f32_dpp v23, v253, v253 row_shr:4 row_mask:0xf bank_mask:0xa
s_nop 1
v_add_f32_dpp v23, v23, v23 quad_perm:[1,0,3,2] row_mask:0xf bank_mask:0xf
s_nop 1
v_add_f32_dpp v23, v23, v23 quad_perm:[2,3,0,1] row_mask:0xf bank_mask:0xf
v_cvt_pk_bf16_f32 v23, 0, v23
v_mul_f32 v23, s66, v23
v_cvt_pk_bf16_f32 v23, 0, v23
s_xor_b32 s64, s65, 231424
s_cmpk_gt_u32 s69, 91
s_waitcnt vmcnt(6)
s_cbranch_scc1 L_d_96
s_waitcnt vmcnt(5)
L_d_96:
buffer_load_dwordx4 v[96:99], v1, s[44:47], s64 offen nt
v_max3_f32 v2, v17, v8, v9
v_max3_f32 v2, v2, v10, v11
v_max3_f32 v2, v2, v12, v13
v_max3_f32 v2, v2, v14, v15
v_max3_f32 v2, v2, v16, v18
v_max3_f32 v2, v2, v19, v20
v_max3_f32 v2, v2, v21, v22
v_max_f32 v2, v2, v23
v_max_f32 v2, 0xff7fffff, v2
s_nop 1
v_max_f32_dpp v2, v2, v2 row_ror:4 row_mask:0xf bank_mask:0xf
s_nop 1
v_max_f32_dpp v2, v2, v2 row_ror:8 row_mask:0xf bank_mask:0xf
v_mov_b32 v3, v2
s_nop 1
v_permlane16_swap_b32 v2, v3
s_nop 1
v_max_f32 v2, v2, v3
v_mov_b32 v3, v2
s_nop 1
v_permlane32_swap_b32 v2, v3
s_nop 1
v_max_f32 v2, v2, v3
s_mov_b32 s67, 0x3fb8aa3b
v_sub_f32 v17, v17, v2
v_sub_f32 v8, v8, v2
v_sub_f32 v9, v9, v2
v_sub_f32 v10, v10, v2
v_sub_f32 v11, v11, v2
v_sub_f32 v12, v12, v2
v_sub_f32 v13, v13, v2
v_sub_f32 v14, v14, v2
v_sub_f32 v15, v15, v2
v_sub_f32 v16, v16, v2
v_sub_f32 v18, v18, v2
v_sub_f32 v19, v19, v2
v_sub_f32 v20, v20, v2
v_sub_f32 v21, v21, v2
v_sub_f32 v22, v22, v2
v_sub_f32 v23, v23, v2
v_mul_f32 v17, s67, v17
v_mul_f32 v8, s67, v8
v_mul_f32 v9, s67, v9
v_mul_f32 v10, s67, v10
v_mul_f32 v11, s67, v11
v_mul_f32 v12, s67, v12
v_mul_f32 v13, s67, v13
v_mul_f32 v14, s67, v14
v_mul_f32 v15, s67, v15
v_mul_f32 v16, s67, v16
v_mul_f32 v18, s67, v18
v_mul_f32 v19, s67, v19
v_mul_f32 v20, s67, v20
v_mul_f32 v21, s67, v21
v_mul_f32 v22, s67, v22
v_mul_f32 v23, s67, v23
s_xor_b32 s64, s65, 164864
s_cmpk_gt_u32 s69, 92
s_waitcnt vmcnt(6)
s_cbranch_scc1 L_d_97
s_waitcnt vmcnt(5)
L_d_97:
buffer_load_dwordx4 v[120:123], v1, s[44:47], s64 offen nt
v_exp_f32 v17, v17
v_exp_f32 v8, v8
v_exp_f32 v9, v9
v_exp_f32 v10, v10
v_exp_f32 v11, v11
v_exp_f32 v12, v12
v_exp_f32 v13, v13
v_exp_f32 v14, v14
v_exp_f32 v15, v15
v_exp_f32 v16, v16
v_exp_f32 v18, v18
v_exp_f32 v19, v19
v_exp_f32 v20, v20
v_exp_f32 v21, v21
v_exp_f32 v22, v22
v_exp_f32 v23, v23
v_add_f32 v3, v17, v8
v_add_f32 v3, v3, v9
v_add_f32 v3, v3, v10
v_add_f32 v3, v3, v11
v_add_f32 v3, v3, v12
v_add_f32 v3, v3, v13
v_add_f32 v3, v3, v14
v_add_f32 v3, v3, v15
v_add_f32 v3, v3, v16
v_add_f32 v3, v3, v18
v_add_f32 v3, v3, v19
v_add_f32 v3, v3, v20
v_add_f32 v3, v3, v21
v_add_f32 v3, v3, v22
v_add_f32 v3, v3, v23
s_nop 1
v_add_f32_dpp v3, v3, v3 row_ror:4 row_mask:0xf bank_mask:0xf
s_nop 1
v_add_f32_dpp v3, v3, v3 row_ror:8 row_mask:0xf bank_mask:0xf
v_mov_b32 v100, v3
s_nop 1
v_permlane16_swap_b32 v3, v100
s_nop 1
v_add_f32 v3, v3, v100
v_mov_b32 v100, v3
s_nop 1
v_permlane32_swap_b32 v3, v100
s_nop 1
v_add_f32 v3, v3, v100
v_min_u32 v3, -2, v3
s_lshl_b32 s68, s34, 3
v_mov_b32 v100, s68
ds_write_b64 v100, v[2:3] offset:256
v_and_b32 v101, 15, v0
v_lshrrev_b32 v102, 1, v101
v_and_b32 v101, 1, v0
v_lshlrev_b32 v101, 4, v101
v_mov_b32 v103, 0xffff
v_lshlrev_b32 v101, v101, v103
v_cmp_eq_u32 vcc, 0, v102
s_nop 1
v_cndmask_b32 v4, 0, v101, vcc
v_cmp_eq_u32 vcc, 1, v102
s_nop 1
v_cndmask_b32 v5, 0, v101, vcc
v_cmp_eq_u32 vcc, 2, v102
s_nop 1
v_cndmask_b32 v6, 0, v101, vcc
v_cmp_eq_u32 vcc, 3, v102
s_nop 1
v_cndmask_b32 v7, 0, v101, vcc
s_xor_b32 s64, s65, 230400
s_cmpk_gt_u32 s69, 93
s_waitcnt vmcnt(6)
s_cbranch_scc1 L_d_98
s_waitcnt vmcnt(5)
L_d_98:
buffer_load_dwordx4 v[124:127], v1, s[44:47], s64 offen nt
v_mov_b32 v100, 0
s_mov_b32 s75, 0
L_poll_99:
ds_read_b128 v[104:107], v100 offset:256
ds_read_b128 v[108:111], v100 offset:272
s_waitcnt lgkmcnt(0)
v_max3_u32 v101, v105, v107, v109
v_max_u32 v101, v101, v111
v_cmp_eq_u32 vcc, -1, v101
s_cbranch_vccz L_pollx_100
s_add_u32 s75, s75, 1
s_cmp_lt_u32 s75, 0x1000000
s_cbranch_scc1 L_poll_99
L_pollx_100:
v_max3_f32 v101, v104, v106, v108
v_max_f32 v101, v101, v110
v_sub_f32 v104, v104, v101
v_sub_f32 v106, v106, v101
v_sub_f32 v108, v108, v101
v_sub_f32 v110, v110, v101
v_sub_f32 v2, v2, v101
v_mul_f32 v104, s67, v104
v_mul_f32 v106, s67, v106
v_mul_f32 v108, s67, v108
v_mul_f32 v110, s67, v110
v_mul_f32 v2, s67, v2
v_exp_f32 v104, v104
v_exp_f32 v106, v106
v_exp_f32 v108, v108
v_exp_f32 v110, v110
v_exp_f32 v2, v2
v_mul_f32 v3, v104, v105
v_fmac_f32 v3, v106, v107
v_fmac_f32 v3, v108, v109
v_fmac_f32 v3, v110, v111
v_rcp_f32 v3, v3
s_nop 0
v_mul_f32 v2, v2, v3
v_mul_f32 v17, v17, v2
v_mul_f32 v8, v8, v2
v_mul_f32 v9, v9, v2
v_mul_f32 v10, v10, v2
v_mul_f32 v11, v11, v2
v_mul_f32 v12, v12, v2
v_mul_f32 v13, v13, v2
v_mul_f32 v14, v14, v2
v_mul_f32 v15, v15, v2
v_mul_f32 v16, v16, v2
v_mul_f32 v18, v18, v2
v_mul_f32 v19, v19, v2
v_mul_f32 v20, v20, v2
v_mul_f32 v21, v21, v2
v_mul_f32 v22, v22, v2
v_mul_f32 v23, v23, v2
v_cvt_pk_bf16_f32 v17, v17, v17
v_cvt_pk_bf16_f32 v8, v8, v8
v_cvt_pk_bf16_f32 v9, v9, v9
v_cvt_pk_bf16_f32 v10, v10, v10
v_cvt_pk_bf16_f32 v11, v11, v11
v_cvt_pk_bf16_f32 v12, v12, v12
v_cvt_pk_bf16_f32 v13, v13, v13
v_cvt_pk_bf16_f32 v14, v14, v14
v_cvt_pk_bf16_f32 v15, v15, v15
v_cvt_pk_bf16_f32 v16, v16, v16
v_cvt_pk_bf16_f32 v18, v18, v18
v_cvt_pk_bf16_f32 v19, v19, v19
v_cvt_pk_bf16_f32 v20, v20, v20
v_cvt_pk_bf16_f32 v21, v21, v21
v_cvt_pk_bf16_f32 v22, v22, v22
v_cvt_pk_bf16_f32 v23, v23, v23
s_nop 1
s_cmp_eq_u32 s34, 2
s_cbranch_scc0 L_w_102
v_mov_b32 v60, 30
s_mov_b64 exec, 1
buffer_store_dword v60, off, s[36:39], s63 offset:0
s_mov_b64 exec, -1
L_w_102:
s_xor_b32 s64, s65, 166912
s_cmpk_gt_u32 s69, 94
s_waitcnt vmcnt(6)
s_cbranch_scc1 L_d_101
s_waitcnt vmcnt(5)
L_d_101:
buffer_load_dwordx4 v[128:131], v1, s[44:47], s64 offen nt
ds_read_b128 v[132:135], v84 offset:2048
ds_read_b128 v[136:139], v84 offset:3072
ds_read_b128 v[140:143], v84 offset:4096
ds_read_b128 v[144:147], v84 offset:5120
ds_read_b128 v[148:151], v84 offset:6144
ds_read_b128 v[152:155], v84 offset:7168
ds_read_b128 v[156:159], v84 offset:8192
ds_read_b128 v[160:163], v84 offset:9216
s_waitcnt lgkmcnt(0)
v_and_b32_dpp v104, v17, v4 row_newbcast:0 row_mask:0xf bank_mask:0xf
v_and_b32_dpp v105, v17, v5 row_newbcast:0 row_mask:0xf bank_mask:0xf
v_and_b32_dpp v106, v17, v6 row_newbcast:0 row_mask:0xf bank_mask:0xf
v_and_b32_dpp v107, v17, v7 row_newbcast:0 row_mask:0xf bank_mask:0xf
v_and_b32_dpp v108, v17, v4 row_newbcast:4 row_mask:0xf bank_mask:0xf
v_and_b32_dpp v109, v17, v5 row_newbcast:4 row_mask:0xf bank_mask:0xf
v_and_b32_dpp v110, v17, v6 row_newbcast:4 row_mask:0xf bank_mask:0xf
v_and_b32_dpp v111, v17, v7 row_newbcast:4 row_mask:0xf bank_mask:0xf
v_mfma_f32_16x16x32_bf16 v[112:115], v[104:107], v[132:135], 0
v_and_b32_dpp v104, v17, v4 row_newbcast:8 row_mask:0xf bank_mask:0xf
v_and_b32_dpp v105, v17, v5 row_newbcast:8 row_mask:0xf bank_mask:0xf
v_and_b32_dpp v106, v17, v6 row_newbcast:8 row_mask:0xf bank_mask:0xf
v_and_b32_dpp v107, v17, v7 row_newbcast:8 row_mask:0xf bank_mask:0xf
v_mfma_f32_16x16x32_bf16 v[112:115], v[108:111], v[136:139], v[112:115]
v_and_b32_dpp v108, v17, v4 row_newbcast:12 row_mask:0xf bank_mask:0xf
v_and_b32_dpp v109, v17, v5 row_newbcast:12 row_mask:0xf bank_mask:0xf
v_and_b32_dpp v110, v17, v6 row_newbcast:12 row_mask:0xf bank_mask:0xf
v_and_b32_dpp v111, v17, v7 row_newbcast:12 row_mask:0xf bank_mask:0xf
v_mfma_f32_16x16x32_bf16 v[112:115], v[104:107], v[140:143], v[112:115]
v_and_b32_dpp v104, v8, v4 row_newbcast:0 row_mask:0xf bank_mask:0xf
v_and_b32_dpp v105, v8, v5 row_newbcast:0 row_mask:0xf bank_mask:0xf
v_and_b32_dpp v106, v8, v6 row_newbcast:0 row_mask:0xf bank_mask:0xf
v_and_b32_dpp v107, v8, v7 row_newbcast:0 row_mask:0xf bank_mask:0xf
v_mfma_f32_16x16x32_bf16 v[112:115], v[108:111], v[144:147], v[112:115]
v_and_b32_dpp v108, v8, v4 row_newbcast:4 row_mask:0xf bank_mask:0xf
v_and_b32_dpp v109, v8, v5 row_newbcast:4 row_mask:0xf bank_mask:0xf
v_and_b32_dpp v110, v8, v6 row_newbcast:4 row_mask:0xf bank_mask:0xf
v_and_b32_dpp v111, v8, v7 row_newbcast:4 row_mask:0xf bank_mask:0xf
v_mfma_f32_16x16x32_bf16 v[112:115], v[104:107], v[148:151], v[112:115]
s_xor_b32 s64, s65, 232448
s_cmpk_gt_u32 s69, 95
s_waitcnt vmcnt(6)
s_cbranch_scc1 L_d_103
s_waitcnt vmcnt(5)
L_d_103:
buffer_load_dwordx4 v[164:167], v1, s[44:47], s64 offen nt
v_and_b32_dpp v104, v8, v4 row_newbcast:8 row_mask:0xf bank_mask:0xf
v_and_b32_dpp v105, v8, v5 row_newbcast:8 row_mask:0xf bank_mask:0xf
v_and_b32_dpp v106, v8, v6 row_newbcast:8 row_mask:0xf bank_mask:0xf
v_and_b32_dpp v107, v8, v7 row_newbcast:8 row_mask:0xf bank_mask:0xf
v_mfma_f32_16x16x32_bf16 v[112:115], v[108:111], v[152:155], v[112:115]
v_and_b32_dpp v108, v8, v4 row_newbcast:12 row_mask:0xf bank_mask:0xf
v_and_b32_dpp v109, v8, v5 row_newbcast:12 row_mask:0xf bank_mask:0xf
v_and_b32_dpp v110, v8, v6 row_newbcast:12 row_mask:0xf bank_mask:0xf
v_and_b32_dpp v111, v8, v7 row_newbcast:12 row_mask:0xf bank_mask:0xf
v_mfma_f32_16x16x32_bf16 v[112:115], v[104:107], v[156:159], v[112:115]
v_and_b32_dpp v104, v9, v4 row_newbcast:0 row_mask:0xf bank_mask:0xf
v_and_b32_dpp v105, v9, v5 row_newbcast:0 row_mask:0xf bank_mask:0xf
v_and_b32_dpp v106, v9, v6 row_newbcast:0 row_mask:0xf bank_mask:0xf
v_and_b32_dpp v107, v9, v7 row_newbcast:0 row_mask:0xf bank_mask:0xf
v_mfma_f32_16x16x32_bf16 v[112:115], v[108:111], v[160:163], v[112:115]
ds_read_b128 v[168:171], v84 offset:10240
ds_read_b128 v[172:175], v84 offset:11264
ds_read_b128 v[176:179], v84 offset:12288
ds_read_b128 v[180:183], v84 offset:13312
ds_read_b128 v[184:187], v84 offset:14336
s_waitcnt lgkmcnt(0)
v_and_b32_dpp v108, v9, v4 row_newbcast:4 row_mask:0xf bank_mask:0xf
v_and_b32_dpp v109, v9, v5 row_newbcast:4 row_mask:0xf bank_mask:0xf
v_and_b32_dpp v110, v9, v6 row_newbcast:4 row_mask:0xf bank_mask:0xf
v_and_b32_dpp v111, v9, v7 row_newbcast:4 row_mask:0xf bank_mask:0xf
v_mfma_f32_16x16x32_bf16 v[112:115], v[104:107], v[168:171], v[112:115]
v_and_b32_dpp v104, v9, v4 row_newbcast:8 row_mask:0xf bank_mask:0xf
v_and_b32_dpp v105, v9, v5 row_newbcast:8 row_mask:0xf bank_mask:0xf
v_and_b32_dpp v106, v9, v6 row_newbcast:8 row_mask:0xf bank_mask:0xf
v_and_b32_dpp v107, v9, v7 row_newbcast:8 row_mask:0xf bank_mask:0xf
v_mfma_f32_16x16x32_bf16 v[112:115], v[108:111], v[172:175], v[112:115]
s_xor_b32 s64, s65, 4096
s_cmpk_gt_u32 s69, 96
s_waitcnt vmcnt(6)
s_cbranch_scc1 L_d_104
s_waitcnt vmcnt(5)
L_d_104:
buffer_load_dwordx4 v[188:191], v1, s[44:47], s64 offen nt
v_and_b32_dpp v108, v9, v4 row_newbcast:12 row_mask:0xf bank_mask:0xf
v_and_b32_dpp v109, v9, v5 row_newbcast:12 row_mask:0xf bank_mask:0xf
v_and_b32_dpp v110, v9, v6 row_newbcast:12 row_mask:0xf bank_mask:0xf
v_and_b32_dpp v111, v9, v7 row_newbcast:12 row_mask:0xf bank_mask:0xf
v_mfma_f32_16x16x32_bf16 v[112:115], v[104:107], v[176:179], v[112:115]
v_and_b32_dpp v104, v10, v4 row_newbcast:0 row_mask:0xf bank_mask:0xf
v_and_b32_dpp v105, v10, v5 row_newbcast:0 row_mask:0xf bank_mask:0xf
v_and_b32_dpp v106, v10, v6 row_newbcast:0 row_mask:0xf bank_mask:0xf
v_and_b32_dpp v107, v10, v7 row_newbcast:0 row_mask:0xf bank_mask:0xf
v_mfma_f32_16x16x32_bf16 v[112:115], v[108:111], v[180:183], v[112:115]
v_and_b32_dpp v108, v10, v4 row_newbcast:4 row_mask:0xf bank_mask:0xf
v_and_b32_dpp v109, v10, v5 row_newbcast:4 row_mask:0xf bank_mask:0xf
v_and_b32_dpp v110, v10, v6 row_newbcast:4 row_mask:0xf bank_mask:0xf
v_and_b32_dpp v111, v10, v7 row_newbcast:4 row_mask:0xf bank_mask:0xf
v_mfma_f32_16x16x32_bf16 v[112:115], v[104:107], v[184:187], v[112:115]
v_and_b32_dpp v104, v10, v4 row_newbcast:8 row_mask:0xf bank_mask:0xf
v_and_b32_dpp v105, v10, v5 row_newbcast:8 row_mask:0xf bank_mask:0xf
v_and_b32_dpp v106, v10, v6 row_newbcast:8 row_mask:0xf bank_mask:0xf
v_and_b32_dpp v107, v10, v7 row_newbcast:8 row_mask:0xf bank_mask:0xf
v_mfma_f32_16x16x32_bf16 v[112:115], v[108:111], v[24:27], v[112:115]
v_and_b32_dpp v108, v10, v4 row_newbcast:12 row_mask:0xf bank_mask:0xf
v_and_b32_dpp v109, v10, v5 row_newbcast:12 row_mask:0xf bank_mask:0xf
v_and_b32_dpp v110, v10, v6 row_newbcast:12 row_mask:0xf bank_mask:0xf
v_and_b32_dpp v111, v10, v7 row_newbcast:12 row_mask:0xf bank_mask:0xf
v_mfma_f32_16x16x32_bf16 v[112:115], v[104:107], v[28:31], v[112:115]
s_xor_b32 s64, s65, 69632
s_cmpk_gt_u32 s69, 97
s_waitcnt vmcnt(6)
s_cbranch_scc1 L_d_105
s_waitcnt vmcnt(5)
L_d_105:
buffer_load_dwordx4 v[192:195], v1, s[44:47], s64 offen nt
v_and_b32_dpp v104, v11, v4 row_newbcast:0 row_mask:0xf bank_mask:0xf
v_and_b32_dpp v105, v11, v5 row_newbcast:0 row_mask:0xf bank_mask:0xf
v_and_b32_dpp v106, v11, v6 row_newbcast:0 row_mask:0xf bank_mask:0xf
v_and_b32_dpp v107, v11, v7 row_newbcast:0 row_mask:0xf bank_mask:0xf
v_mfma_f32_16x16x32_bf16 v[112:115], v[108:111], v[32:35], v[112:115]
v_and_b32_dpp v108, v11, v4 row_newbcast:4 row_mask:0xf bank_mask:0xf
v_and_b32_dpp v109, v11, v5 row_newbcast:4 row_mask:0xf bank_mask:0xf
v_and_b32_dpp v110, v11, v6 row_newbcast:4 row_mask:0xf bank_mask:0xf
v_and_b32_dpp v111, v11, v7 row_newbcast:4 row_mask:0xf bank_mask:0xf
v_mfma_f32_16x16x32_bf16 v[112:115], v[104:107], v[36:39], v[112:115]
v_and_b32_dpp v104, v11, v4 row_newbcast:8 row_mask:0xf bank_mask:0xf
v_and_b32_dpp v105, v11, v5 row_newbcast:8 row_mask:0xf bank_mask:0xf
v_and_b32_dpp v106, v11, v6 row_newbcast:8 row_mask:0xf bank_mask:0xf
v_and_b32_dpp v107, v11, v7 row_newbcast:8 row_mask:0xf bank_mask:0xf
v_mfma_f32_16x16x32_bf16 v[112:115], v[108:111], v[40:43], v[112:115]
v_and_b32_dpp v108, v11, v4 row_newbcast:12 row_mask:0xf bank_mask:0xf
v_and_b32_dpp v109, v11, v5 row_newbcast:12 row_mask:0xf bank_mask:0xf
v_and_b32_dpp v110, v11, v6 row_newbcast:12 row_mask:0xf bank_mask:0xf
v_and_b32_dpp v111, v11, v7 row_newbcast:12 row_mask:0xf bank_mask:0xf
v_mfma_f32_16x16x32_bf16 v[112:115], v[104:107], v[44:47], v[112:115]
v_and_b32_dpp v104, v12, v4 row_newbcast:0 row_mask:0xf bank_mask:0xf
v_and_b32_dpp v105, v12, v5 row_newbcast:0 row_mask:0xf bank_mask:0xf
v_and_b32_dpp v106, v12, v6 row_newbcast:0 row_mask:0xf bank_mask:0xf
v_and_b32_dpp v107, v12, v7 row_newbcast:0 row_mask:0xf bank_mask:0xf
v_mfma_f32_16x16x32_bf16 v[112:115], v[108:111], v[48:51], v[112:115]
s_xor_b32 s64, s65, 6144
s_cmpk_gt_u32 s69, 98
s_waitcnt vmcnt(6)
s_cbranch_scc1 L_d_106
s_waitcnt vmcnt(5)
L_d_106:
buffer_load_dwordx4 v[196:199], v1, s[44:47], s64 offen nt
v_and_b32_dpp v108, v12, v4 row_newbcast:4 row_mask:0xf bank_mask:0xf
v_and_b32_dpp v109, v12, v5 row_newbcast:4 row_mask:0xf bank_mask:0xf
v_and_b32_dpp v110, v12, v6 row_newbcast:4 row_mask:0xf bank_mask:0xf
v_and_b32_dpp v111, v12, v7 row_newbcast:4 row_mask:0xf bank_mask:0xf
v_mfma_f32_16x16x32_bf16 v[112:115], v[104:107], v[52:55], v[112:115]
v_and_b32_dpp v104, v12, v4 row_newbcast:8 row_mask:0xf bank_mask:0xf
v_and_b32_dpp v105, v12, v5 row_newbcast:8 row_mask:0xf bank_mask:0xf
v_and_b32_dpp v106, v12, v6 row_newbcast:8 row_mask:0xf bank_mask:0xf
v_and_b32_dpp v107, v12, v7 row_newbcast:8 row_mask:0xf bank_mask:0xf
v_mfma_f32_16x16x32_bf16 v[112:115], v[108:111], v[56:59], v[112:115]
v_and_b32_dpp v108, v12, v4 row_newbcast:12 row_mask:0xf bank_mask:0xf
v_and_b32_dpp v109, v12, v5 row_newbcast:12 row_mask:0xf bank_mask:0xf
v_and_b32_dpp v110, v12, v6 row_newbcast:12 row_mask:0xf bank_mask:0xf
v_and_b32_dpp v111, v12, v7 row_newbcast:12 row_mask:0xf bank_mask:0xf
v_mfma_f32_16x16x32_bf16 v[112:115], v[104:107], v[64:67], v[112:115]
v_and_b32_dpp v104, v13, v4 row_newbcast:0 row_mask:0xf bank_mask:0xf
v_and_b32_dpp v105, v13, v5 row_newbcast:0 row_mask:0xf bank_mask:0xf
v_and_b32_dpp v106, v13, v6 row_newbcast:0 row_mask:0xf bank_mask:0xf
v_and_b32_dpp v107, v13, v7 row_newbcast:0 row_mask:0xf bank_mask:0xf
v_mfma_f32_16x16x32_bf16 v[112:115], v[108:111], v[68:71], v[112:115]
v_and_b32_dpp v108, v13, v4 row_newbcast:4 row_mask:0xf bank_mask:0xf
v_and_b32_dpp v109, v13, v5 row_newbcast:4 row_mask:0xf bank_mask:0xf
v_and_b32_dpp v110, v13, v6 row_newbcast:4 row_mask:0xf bank_mask:0xf
v_and_b32_dpp v111, v13, v7 row_newbcast:4 row_mask:0xf bank_mask:0xf
v_mfma_f32_16x16x32_bf16 v[112:115], v[104:107], v[72:75], v[112:115]
s_xor_b32 s64, s65, 71680
s_cmpk_gt_u32 s69, 99
s_waitcnt vmcnt(6)
s_cbranch_scc1 L_d_107
s_waitcnt vmcnt(5)
L_d_107:
buffer_load_dwordx4 v[200:203], v1, s[44:47], s64 offen nt
v_and_b32_dpp v104, v13, v4 row_newbcast:8 row_mask:0xf bank_mask:0xf
v_and_b32_dpp v105, v13, v5 row_newbcast:8 row_mask:0xf bank_mask:0xf
v_and_b32_dpp v106, v13, v6 row_newbcast:8 row_mask:0xf bank_mask:0xf
v_and_b32_dpp v107, v13, v7 row_newbcast:8 row_mask:0xf bank_mask:0xf
v_mfma_f32_16x16x32_bf16 v[112:115], v[108:111], v[76:79], v[112:115]
v_and_b32_dpp v108, v13, v4 row_newbcast:12 row_mask:0xf bank_mask:0xf
v_and_b32_dpp v109, v13, v5 row_newbcast:12 row_mask:0xf bank_mask:0xf
v_and_b32_dpp v110, v13, v6 row_newbcast:12 row_mask:0xf bank_mask:0xf
v_and_b32_dpp v111, v13, v7 row_newbcast:12 row_mask:0xf bank_mask:0xf
v_mfma_f32_16x16x32_bf16 v[112:115], v[104:107], v[80:83], v[112:115]
v_and_b32_dpp v104, v14, v4 row_newbcast:0 row_mask:0xf bank_mask:0xf
v_and_b32_dpp v105, v14, v5 row_newbcast:0 row_mask:0xf bank_mask:0xf
v_and_b32_dpp v106, v14, v6 row_newbcast:0 row_mask:0xf bank_mask:0xf
v_and_b32_dpp v107, v14, v7 row_newbcast:0 row_mask:0xf bank_mask:0xf
v_mfma_f32_16x16x32_bf16 v[112:115], v[108:111], v[96:99], v[112:115]
v_and_b32_dpp v108, v14, v4 row_newbcast:4 row_mask:0xf bank_mask:0xf
v_and_b32_dpp v109, v14, v5 row_newbcast:4 row_mask:0xf bank_mask:0xf
v_and_b32_dpp v110, v14, v6 row_newbcast:4 row_mask:0xf bank_mask:0xf
v_and_b32_dpp v111, v14, v7 row_newbcast:4 row_mask:0xf bank_mask:0xf
v_mfma_f32_16x16x32_bf16 v[112:115], v[104:107], v[120:123], v[112:115]
s_xor_b32 s64, s65, 5120
s_cmpk_gt_u32 s69, 100
s_waitcnt vmcnt(6)
s_cbranch_scc1 L_d_108
s_waitcnt vmcnt(5)
L_d_108:
buffer_load_dwordx4 v[204:207], v1, s[44:47], s64 offen nt
v_and_b32_dpp v104, v14, v4 row_newbcast:8 row_mask:0xf bank_mask:0xf
v_and_b32_dpp v105, v14, v5 row_newbcast:8 row_mask:0xf bank_mask:0xf
v_and_b32_dpp v106, v14, v6 row_newbcast:8 row_mask:0xf bank_mask:0xf
v_and_b32_dpp v107, v14, v7 row_newbcast:8 row_mask:0xf bank_mask:0xf
v_mfma_f32_16x16x32_bf16 v[112:115], v[108:111], v[124:127], v[112:115]
s_xor_b32 s64, s65, 70656
s_cmpk_gt_u32 s69, 101
s_waitcnt vmcnt(6)
s_cbranch_scc1 L_d_109
s_waitcnt vmcnt(5)
L_d_109:
buffer_load_dwordx4 v[208:211], v1, s[44:47], s64 offen nt
v_and_b32_dpp v108, v14, v4 row_newbcast:12 row_mask:0xf bank_mask:0xf
v_and_b32_dpp v109, v14, v5 row_newbcast:12 row_mask:0xf bank_mask:0xf
v_and_b32_dpp v110, v14, v6 row_newbcast:12 row_mask:0xf bank_mask:0xf
v_and_b32_dpp v111, v14, v7 row_newbcast:12 row_mask:0xf bank_mask:0xf
v_mfma_f32_16x16x32_bf16 v[112:115], v[104:107], v[128:131], v[112:115]
s_cmp_eq_u32 s34, 3
s_cbranch_scc0 L_w_111
v_mov_b32 v60, 38
s_mov_b64 exec, 1
buffer_store_dword v60, off, s[36:39], s63 offset:0
s_mov_b64 exec, -1
L_w_111:
s_xor_b32 s64, s65, 7168
s_cmpk_gt_u32 s69, 102
s_waitcnt vmcnt(6)
s_cbranch_scc1 L_d_110
s_waitcnt vmcnt(5)
L_d_110:
buffer_load_dwordx4 v[212:215], v1, s[44:47], s64 offen nt
v_and_b32_dpp v104, v15, v4 row_newbcast:0 row_mask:0xf bank_mask:0xf
v_and_b32_dpp v105, v15, v5 row_newbcast:0 row_mask:0xf bank_mask:0xf
v_and_b32_dpp v106, v15, v6 row_newbcast:0 row_mask:0xf bank_mask:0xf
v_and_b32_dpp v107, v15, v7 row_newbcast:0 row_mask:0xf bank_mask:0xf
v_mfma_f32_16x16x32_bf16 v[112:115], v[108:111], v[164:167], v[112:115]
s_xor_b32 s64, s65, 72704
s_cmpk_gt_u32 s69, 103
s_waitcnt vmcnt(6)
s_cbranch_scc1 L_d_112
s_waitcnt vmcnt(5)
L_d_112:
buffer_load_dwordx4 v[216:219], v1, s[44:47], s64 offen nt
v_and_b32_dpp v108, v15, v4 row_newbcast:4 row_mask:0xf bank_mask:0xf
v_and_b32_dpp v109, v15, v5 row_newbcast:4 row_mask:0xf bank_mask:0xf
v_and_b32_dpp v110, v15, v6 row_newbcast:4 row_mask:0xf bank_mask:0xf
v_and_b32_dpp v111, v15, v7 row_newbcast:4 row_mask:0xf bank_mask:0xf
v_mfma_f32_16x16x32_bf16 v[112:115], v[104:107], v[188:191], v[112:115]
s_xor_b32 s64, s65, 36864
s_cmpk_gt_u32 s69, 104
s_waitcnt vmcnt(6)
s_cbranch_scc1 L_d_113
s_waitcnt vmcnt(5)
L_d_113:
buffer_load_dwordx4 v[220:223], v1, s[44:47], s64 offen nt
v_and_b32_dpp v104, v15, v4 row_newbcast:8 row_mask:0xf bank_mask:0xf
v_and_b32_dpp v105, v15, v5 row_newbcast:8 row_mask:0xf bank_mask:0xf
v_and_b32_dpp v106, v15, v6 row_newbcast:8 row_mask:0xf bank_mask:0xf
v_and_b32_dpp v107, v15, v7 row_newbcast:8 row_mask:0xf bank_mask:0xf
v_mfma_f32_16x16x32_bf16 v[112:115], v[108:111], v[192:195], v[112:115]
s_xor_b32 s64, s65, 102400
s_cmpk_gt_u32 s69, 105
s_waitcnt vmcnt(6)
s_cbranch_scc1 L_d_114
s_waitcnt vmcnt(5)
L_d_114:
buffer_load_dwordx4 v[224:227], v1, s[44:47], s64 offen nt
v_and_b32_dpp v108, v15, v4 row_newbcast:12 row_mask:0xf bank_mask:0xf
v_and_b32_dpp v109, v15, v5 row_newbcast:12 row_mask:0xf bank_mask:0xf
v_and_b32_dpp v110, v15, v6 row_newbcast:12 row_mask:0xf bank_mask:0xf
v_and_b32_dpp v111, v15, v7 row_newbcast:12 row_mask:0xf bank_mask:0xf
v_mfma_f32_16x16x32_bf16 v[112:115], v[104:107], v[196:199], v[112:115]
s_xor_b32 s64, s65, 38912
s_cmpk_gt_u32 s69, 106
s_waitcnt vmcnt(6)
s_cbranch_scc1 L_d_115
s_waitcnt vmcnt(5)
L_d_115:
buffer_load_dwordx4 v[228:231], v1, s[44:47], s64 offen nt
v_and_b32_dpp v104, v16, v4 row_newbcast:0 row_mask:0xf bank_mask:0xf
v_and_b32_dpp v105, v16, v5 row_newbcast:0 row_mask:0xf bank_mask:0xf
v_and_b32_dpp v106, v16, v6 row_newbcast:0 row_mask:0xf bank_mask:0xf
v_and_b32_dpp v107, v16, v7 row_newbcast:0 row_mask:0xf bank_mask:0xf
v_mfma_f32_16x16x32_bf16 v[112:115], v[108:111], v[200:203], v[112:115]
s_xor_b32 s64, s65, 104448
s_cmpk_gt_u32 s69, 107
s_waitcnt vmcnt(6)
s_cbranch_scc1 L_d_116
s_waitcnt vmcnt(5)
L_d_116:
buffer_load_dwordx4 v[232:235], v1, s[44:47], s64 offen nt
v_and_b32_dpp v108, v16, v4 row_newbcast:4 row_mask:0xf bank_mask:0xf
v_and_b32_dpp v109, v16, v5 row_newbcast:4 row_mask:0xf bank_mask:0xf
v_and_b32_dpp v110, v16, v6 row_newbcast:4 row_mask:0xf bank_mask:0xf
v_and_b32_dpp v111, v16, v7 row_newbcast:4 row_mask:0xf bank_mask:0xf
v_mfma_f32_16x16x32_bf16 v[112:115], v[104:107], v[204:207], v[112:115]
s_xor_b32 s64, s65, 37888
s_cmpk_gt_u32 s69, 108
s_waitcnt vmcnt(6)
s_cbranch_scc1 L_d_117
s_waitcnt vmcnt(5)
L_d_117:
buffer_load_dwordx4 v[236:239], v1, s[44:47], s64 offen nt
v_and_b32_dpp v104, v16, v4 row_newbcast:8 row_mask:0xf bank_mask:0xf
v_and_b32_dpp v105, v16, v5 row_newbcast:8 row_mask:0xf bank_mask:0xf
v_and_b32_dpp v106, v16, v6 row_newbcast:8 row_mask:0xf bank_mask:0xf
v_and_b32_dpp v107, v16, v7 row_newbcast:8 row_mask:0xf bank_mask:0xf
v_mfma_f32_16x16x32_bf16 v[112:115], v[108:111], v[208:211], v[112:115]
s_xor_b32 s64, s65, 103424
s_cmpk_gt_u32 s69, 109
s_waitcnt vmcnt(6)
s_cbranch_scc1 L_d_118
s_waitcnt vmcnt(5)
L_d_118:
buffer_load_dwordx4 v[240:243], v1, s[44:47], s64 offen nt
v_and_b32_dpp v108, v16, v4 row_newbcast:12 row_mask:0xf bank_mask:0xf
v_and_b32_dpp v109, v16, v5 row_newbcast:12 row_mask:0xf bank_mask:0xf
v_and_b32_dpp v110, v16, v6 row_newbcast:12 row_mask:0xf bank_mask:0xf
v_and_b32_dpp v111, v16, v7 row_newbcast:12 row_mask:0xf bank_mask:0xf
v_mfma_f32_16x16x32_bf16 v[112:115], v[104:107], v[212:215], v[112:115]
s_cmp_eq_u32 s34, 0
s_cbranch_scc0 L_w_120
v_mov_b32 v60, 46
s_mov_b64 exec, 1
buffer_store_dword v60, off, s[36:39], s63 offset:0
s_mov_b64 exec, -1
L_w_120:
s_xor_b32 s64, s65, 39936
s_cmpk_gt_u32 s69, 110
s_waitcnt vmcnt(6)
s_cbranch_scc1 L_d_119
s_waitcnt vmcnt(5)
L_d_119:
buffer_load_dwordx4 v[244:247], v1, s[44:47], s64 offen nt
v_and_b32_dpp v104, v18, v4 row_newbcast:0 row_mask:0xf bank_mask:0xf
v_and_b32_dpp v105, v18, v5 row_newbcast:0 row_mask:0xf bank_mask:0xf
v_and_b32_dpp v106, v18, v6 row_newbcast:0 row_mask:0xf bank_mask:0xf
v_and_b32_dpp v107, v18, v7 row_newbcast:0 row_mask:0xf bank_mask:0xf
v_mfma_f32_16x16x32_bf16 v[112:115], v[108:111], v[216:219], v[112:115]
s_xor_b32 s64, s65, 105472
s_cmpk_gt_u32 s69, 111
s_waitcnt vmcnt(6)
s_cbranch_scc1 L_d_121
s_waitcnt vmcnt(5)
L_d_121:
buffer_load_dwordx4 v[248:251], v1, s[44:47], s64 offen nt
v_and_b32_dpp v108, v18, v4 row_newbcast:4 row_mask:0xf bank_mask:0xf
v_and_b32_dpp v109, v18, v5 row_newbcast:4 row_mask:0xf bank_mask:0xf
v_and_b32_dpp v110, v18, v6 row_newbcast:4 row_mask:0xf bank_mask:0xf
v_and_b32_dpp v111, v18, v7 row_newbcast:4 row_mask:0xf bank_mask:0xf
v_mfma_f32_16x16x32_bf16 v[112:115], v[104:107], v[220:223], v[112:115]
s_xor_b32 s64, s65, 135168
s_waitcnt vmcnt(5)
buffer_load_dwordx4 v[252:255], v1, s[44:47], s64 offen nt
v_and_b32_dpp v104, v18, v4 row_newbcast:8 row_mask:0xf bank_mask:0xf
v_and_b32_dpp v105, v18, v5 row_newbcast:8 row_mask:0xf bank_mask:0xf
v_and_b32_dpp v106, v18, v6 row_newbcast:8 row_mask:0xf bank_mask:0xf
v_and_b32_dpp v107, v18, v7 row_newbcast:8 row_mask:0xf bank_mask:0xf
v_mfma_f32_16x16x32_bf16 v[112:115], v[108:111], v[224:227], v[112:115]
v_and_b32_dpp v108, v18, v4 row_newbcast:12 row_mask:0xf bank_mask:0xf
v_and_b32_dpp v109, v18, v5 row_newbcast:12 row_mask:0xf bank_mask:0xf
v_and_b32_dpp v110, v18, v6 row_newbcast:12 row_mask:0xf bank_mask:0xf
v_and_b32_dpp v111, v18, v7 row_newbcast:12 row_mask:0xf bank_mask:0xf
v_mfma_f32_16x16x32_bf16 v[112:115], v[104:107], v[228:231], v[112:115]
s_xor_b32 s64, s65, 200704
s_waitcnt vmcnt(5)
buffer_load_dwordx4 v[88:91], v1, s[44:47], s64 offen nt
v_and_b32_dpp v104, v19, v4 row_newbcast:0 row_mask:0xf bank_mask:0xf
v_and_b32_dpp v105, v19, v5 row_newbcast:0 row_mask:0xf bank_mask:0xf
v_and_b32_dpp v106, v19, v6 row_newbcast:0 row_mask:0xf bank_mask:0xf
v_and_b32_dpp v107, v19, v7 row_newbcast:0 row_mask:0xf bank_mask:0xf
v_mfma_f32_16x16x32_bf16 v[112:115], v[108:111], v[232:235], v[112:115]
s_xor_b32 s64, s65, 137216
s_waitcnt vmcnt(5)
buffer_load_dwordx4 v[92:95], v1, s[44:47], s64 offen nt
v_and_b32_dpp v108, v19, v4 row_newbcast:4 row_mask:0xf bank_mask:0xf
v_and_b32_dpp v109, v19, v5 row_newbcast:4 row_mask:0xf bank_mask:0xf
v_and_b32_dpp v110, v19, v6 row_newbcast:4 row_mask:0xf bank_mask:0xf
v_and_b32_dpp v111, v19, v7 row_newbcast:4 row_mask:0xf bank_mask:0xf
v_mfma_f32_16x16x32_bf16 v[112:115], v[104:107], v[236:239], v[112:115]
s_xor_b32 s64, s65, 202752
s_waitcnt vmcnt(5)
buffer_load_dwordx4 v[132:135], v1, s[44:47], s64 offen nt
v_and_b32_dpp v104, v19, v4 row_newbcast:8 row_mask:0xf bank_mask:0xf
v_and_b32_dpp v105, v19, v5 row_newbcast:8 row_mask:0xf bank_mask:0xf
v_and_b32_dpp v106, v19, v6 row_newbcast:8 row_mask:0xf bank_mask:0xf
v_and_b32_dpp v107, v19, v7 row_newbcast:8 row_mask:0xf bank_mask:0xf
v_mfma_f32_16x16x32_bf16 v[112:115], v[108:111], v[240:243], v[112:115]
s_xor_b32 s64, s65, 136192
s_waitcnt vmcnt(5)
buffer_load_dwordx4 v[136:139], v1, s[44:47], s64 offen nt
v_and_b32_dpp v108, v19, v4 row_newbcast:12 row_mask:0xf bank_mask:0xf
v_and_b32_dpp v109, v19, v5 row_newbcast:12 row_mask:0xf bank_mask:0xf
v_and_b32_dpp v110, v19, v6 row_newbcast:12 row_mask:0xf bank_mask:0xf
v_and_b32_dpp v111, v19, v7 row_newbcast:12 row_mask:0xf bank_mask:0xf
v_mfma_f32_16x16x32_bf16 v[112:115], v[104:107], v[244:247], v[112:115]
s_xor_b32 s64, s65, 201728
s_waitcnt vmcnt(5)
buffer_load_dwordx4 v[140:143], v1, s[44:47], s64 offen nt
v_and_b32_dpp v104, v20, v4 row_newbcast:0 row_mask:0xf bank_mask:0xf
v_and_b32_dpp v105, v20, v5 row_newbcast:0 row_mask:0xf bank_mask:0xf
v_and_b32_dpp v106, v20, v6 row_newbcast:0 row_mask:0xf bank_mask:0xf
v_and_b32_dpp v107, v20, v7 row_newbcast:0 row_mask:0xf bank_mask:0xf
v_mfma_f32_16x16x32_bf16 v[112:115], v[108:111], v[248:251], v[112:115]
s_cmp_eq_u32 s34, 1
s_cbranch_scc0 L_w_122
v_mov_b32 v60, 54
s_mov_b64 exec, 1
buffer_store_dword v60, off, s[36:39], s63 offset:0
s_mov_b64 exec, -1
L_w_122:
s_xor_b32 s64, s65, 138240
s_waitcnt vmcnt(5)
buffer_load_dwordx4 v[144:147], v1, s[44:47], s64 offen nt
v_and_b32_dpp v108, v20, v4 row_newbcast:4 row_mask:0xf bank_mask:0xf
v_and_b32_dpp v109, v20, v5 row_newbcast:4 row_mask:0xf bank_mask:0xf
v_and_b32_dpp v110, v20, v6 row_newbcast:4 row_mask:0xf bank_mask:0xf
v_and_b32_dpp v111, v20, v7 row_newbcast:4 row_mask:0xf bank_mask:0xf
v_mfma_f32_16x16x32_bf16 v[112:115], v[104:107], v[252:255], v[112:115]
s_xor_b32 s64, s65, 203776
s_waitcnt vmcnt(5)
buffer_load_dwordx4 v[148:151], v1, s[44:47], s64 offen nt
v_and_b32_dpp v104, v20, v4 row_newbcast:8 row_mask:0xf bank_mask:0xf
v_and_b32_dpp v105, v20, v5 row_newbcast:8 row_mask:0xf bank_mask:0xf
v_and_b32_dpp v106, v20, v6 row_newbcast:8 row_mask:0xf bank_mask:0xf
v_and_b32_dpp v107, v20, v7 row_newbcast:8 row_mask:0xf bank_mask:0xf
v_mfma_f32_16x16x32_bf16 v[112:115], v[108:111], v[88:91], v[112:115]
s_xor_b32 s64, s65, 167936
s_waitcnt vmcnt(7)
buffer_load_dwordx4 v[152:155], v1, s[44:47], s64 offen nt
s_xor_b32 s64, s65, 233472
s_waitcnt vmcnt(7)
buffer_load_dwordx4 v[156:159], v1, s[44:47], s64 offen nt
s_cmp_lt_u32 s2, 208
s_cbranch_scc0 L_hp_123
v_lshlrev_b32 v160, 2, v0
buffer_load_dword v161, v160, s[36:39], s62 offen offset:0 sc1
L_hp_123:
s_xor_b32 s64, s65, 169984
s_waitcnt vmcnt(7)
buffer_load_dwordx4 v[176:179], v1, s[44:47], s64 offen nt
v_and_b32_dpp v108, v20, v4 row_newbcast:12 row_mask:0xf bank_mask:0xf
v_and_b32_dpp v109, v20, v5 row_newbcast:12 row_mask:0xf bank_mask:0xf
v_and_b32_dpp v110, v20, v6 row_newbcast:12 row_mask:0xf bank_mask:0xf
v_and_b32_dpp v111, v20, v7 row_newbcast:12 row_mask:0xf bank_mask:0xf
v_mfma_f32_16x16x32_bf16 v[112:115], v[104:107], v[92:95], v[112:115]
s_xor_b32 s64, s65, 235520
s_waitcnt vmcnt(7)
buffer_load_dwordx4 v[180:183], v1, s[44:47], s64 offen nt
v_and_b32_dpp v104, v21, v4 row_newbcast:0 row_mask:0xf bank_mask:0xf
v_and_b32_dpp v105, v21, v5 row_newbcast:0 row_mask:0xf bank_mask:0xf
v_and_b32_dpp v106, v21, v6 row_newbcast:0 row_mask:0xf bank_mask:0xf
v_and_b32_dpp v107, v21, v7 row_newbcast:0 row_mask:0xf bank_mask:0xf
v_mfma_f32_16x16x32_bf16 v[112:115], v[108:111], v[132:135], v[112:115]
s_xor_b32 s64, s65, 168960
s_waitcnt vmcnt(7)
buffer_load_dwordx4 v[184:187], v1, s[44:47], s64 offen nt
v_and_b32_dpp v108, v21, v4 row_newbcast:4 row_mask:0xf bank_mask:0xf
v_and_b32_dpp v109, v21, v5 row_newbcast:4 row_mask:0xf bank_mask:0xf
v_and_b32_dpp v110, v21, v6 row_newbcast:4 row_mask:0xf bank_mask:0xf
v_and_b32_dpp v111, v21, v7 row_newbcast:4 row_mask:0xf bank_mask:0xf
v_mfma_f32_16x16x32_bf16 v[112:115], v[104:107], v[136:139], v[112:115]
s_xor_b32 s64, s65, 234496
s_waitcnt vmcnt(7)
buffer_load_dwordx4 v[24:27], v1, s[44:47], s64 offen nt
v_and_b32_dpp v104, v21, v4 row_newbcast:8 row_mask:0xf bank_mask:0xf
v_and_b32_dpp v105, v21, v5 row_newbcast:8 row_mask:0xf bank_mask:0xf
v_and_b32_dpp v106, v21, v6 row_newbcast:8 row_mask:0xf bank_mask:0xf
v_and_b32_dpp v107, v21, v7 row_newbcast:8 row_mask:0xf bank_mask:0xf
v_mfma_f32_16x16x32_bf16 v[112:115], v[108:111], v[140:143], v[112:115]
s_cmp_eq_u32 s34, 2
s_cbranch_scc0 L_w_124
v_mov_b32 v60, 62
s_mov_b64 exec, 1
buffer_store_dword v60, off, s[36:39], s63 offset:0
s_mov_b64 exec, -1
L_w_124:
s_xor_b32 s64, s65, 171008
s_waitcnt vmcnt(7)
buffer_load_dwordx4 v[28:31], v1, s[44:47], s64 offen nt
v_and_b32_dpp v108, v21, v4 row_newbcast:12 row_mask:0xf bank_mask:0xf
v_and_b32_dpp v109, v21, v5 row_newbcast:12 row_mask:0xf bank_mask:0xf
v_and_b32_dpp v110, v21, v6 row_newbcast:12 row_mask:0xf bank_mask:0xf
v_and_b32_dpp v111, v21, v7 row_newbcast:12 row_mask:0xf bank_mask:0xf
v_mfma_f32_16x16x32_bf16 v[112:115], v[104:107], v[144:147], v[112:115]
s_xor_b32 s64, s65, 236544
s_waitcnt vmcnt(7)
buffer_load_dwordx4 v[32:35], v1, s[44:47], s64 offen nt
v_and_b32_dpp v104, v22, v4 row_newbcast:0 row_mask:0xf bank_mask:0xf
v_and_b32_dpp v105, v22, v5 row_newbcast:0 row_mask:0xf bank_mask:0xf
v_and_b32_dpp v106, v22, v6 row_newbcast:0 row_mask:0xf bank_mask:0xf
v_and_b32_dpp v107, v22, v7 row_newbcast:0 row_mask:0xf bank_mask:0xf
v_mfma_f32_16x16x32_bf16 v[112:115], v[108:111], v[148:151], v[112:115]
s_cmp_lt_u32 s2, 208
s_cbranch_scc0 L_nohelp
v_lshrrev_b32 v172, 3, v0
v_sub_u32 v172, 63, v172
v_and_b32 v168, 7, v0
v_lshlrev_b32 v168, 7, v168
v_bfe_u32 v162, v172, 0, 1
v_lshl_or_b32 v168, v162, 16, v168
v_bfe_u32 v162, v172, 1, 1
v_lshl_or_b32 v168, v162, 11, v168
v_bfe_u32 v162, v172, 2, 1
v_lshl_or_b32 v168, v162, 10, v168
v_bfe_u32 v162, v172, 3, 1
v_lshl_or_b32 v168, v162, 15, v168
v_bfe_u32 v162, v172, 4, 1
v_lshl_or_b32 v168, v162, 17, v168
v_bfe_u32 v162, v172, 5, 1
v_lshl_or_b32 v168, v162, 12, v168
v_lshrrev_b32 v173, 3, v0
v_sub_u32 v173, 55, v173
v_and_b32 v169, 7, v0
v_lshlrev_b32 v169, 7, v169
v_bfe_u32 v162, v173, 0, 1
v_lshl_or_b32 v169, v162, 16, v169
v_bfe_u32 v162, v173, 1, 1
v_lshl_or_b32 v169, v162, 11, v169
v_bfe_u32 v162, v173, 2, 1
v_lshl_or_b32 v169, v162, 10, v169
v_bfe_u32 v162, v173, 3, 1
v_lshl_or_b32 v169, v162, 15, v169
v_bfe_u32 v162, v173, 4, 1
v_lshl_or_b32 v169, v162, 17, v169
v_bfe_u32 v162, v173, 5, 1
v_lshl_or_b32 v169, v162, 12, v169
v_lshrrev_b32 v174, 3, v0
v_sub_u32 v174, 47, v174
v_and_b32 v170, 7, v0
v_lshlrev_b32 v170, 7, v170
v_bfe_u32 v162, v174, 0, 1
v_lshl_or_b32 v170, v162, 16, v170
v_bfe_u32 v162, v174, 1, 1
v_lshl_or_b32 v170, v162, 11, v170
v_bfe_u32 v162, v174, 2, 1
v_lshl_or_b32 v170, v162, 10, v170
v_bfe_u32 v162, v174, 3, 1
v_lshl_or_b32 v170, v162, 15, v170
v_bfe_u32 v162, v174, 4, 1
v_lshl_or_b32 v170, v162, 17, v170
v_bfe_u32 v162, v174, 5, 1
v_lshl_or_b32 v170, v162, 12, v170
v_lshrrev_b32 v175, 3, v0
v_sub_u32 v175, 39, v175
v_and_b32 v171, 7, v0
v_lshlrev_b32 v171, 7, v171
v_bfe_u32 v162, v175, 0, 1
v_lshl_or_b32 v171, v162, 16, v171
v_bfe_u32 v162, v175, 1, 1
v_lshl_or_b32 v171, v162, 11, v171
v_bfe_u32 v162, v175, 2, 1
v_lshl_or_b32 v171, v162, 10, v171
v_bfe_u32 v162, v175, 3, 1
v_lshl_or_b32 v171, v162, 15, v171
v_bfe_u32 v162, v175, 4, 1
v_lshl_or_b32 v171, v162, 17, v171
v_bfe_u32 v162, v175, 5, 1
v_lshl_or_b32 v171, v162, 12, v171
s_lshr_b32 s71, s2, 3
v_subrev_u32 v163, s71, v0
v_and_b32 v163, 31, v163
s_waitcnt vmcnt(6)
v_mov_b32 v162, v161
s_nop 1
v_permlane32_swap_b32 v161, v162
v_add_u32 v161, 1, v161
v_max_u32 v161, 7, v161
v_cmp_eq_u32 vcc, -1, v162
v_mov_b32 v160, 0xff
s_nop 0
v_cndmask_b32 v161, v160, v161, vcc
v_lshl_or_b32 v161, v161, 5, v163
s_nop 1
v_min_u32_dpp v161, v161, v161 quad_perm:[1,0,3,2] row_mask:0xf bank_mask:0xf
s_nop 1
v_min_u32_dpp v161, v161, v161 quad_perm:[2,3,0,1] row_mask:0xf bank_mask:0xf
s_nop 1
v_min_u32_dpp v161, v161, v161 row_ror:4 row_mask:0xf bank_mask:0xf
s_nop 1
v_min_u32_dpp v161, v161, v161 row_ror:8 row_mask:0xf bank_mask:0xf
s_nop 1
v_readlane_b32 s76, v161, 0
v_readlane_b32 s66, v161, 16
s_min_u32 s76, s76, s66
s_lshr_b32 s66, s76, 5
s_cmp_lt_u32 s66, 50
s_cbranch_scc0 L_drain
s_mov_b32 s48, s8
s_mov_b32 s49, s9
s_mov_b32 s50, 0x10000000
s_mov_b32 s51, 0x20000
s_lshr_b32 s64, s2, 3
s_add_u32 s76, s76, s64
s_and_b32 s76, s76, 31
s_lshl_b32 s67, s76, 2
s_add_u32 s67, s67, s62
s_lshl_b32 s76, s76, 3
s_and_b32 s64, s2, 7
s_or_b32 s76, s76, s64
s_and_b32 s64, s34, 1
s_lshl_b32 s64, s64, 14
s_lshr_b32 s71, s34, 1
s_lshl_b32 s71, s71, 13
s_or_b32 s64, s64, s71
s_lshl_b32 s71, s76, 10
s_xor_b32 s64, s64, s71
s_or_b32 s64, s64, 0xC0000
s_lshl_b32 s76, s76, 20
s_xor_b32 s76, s76, s64
s_add_u32 s66, s66, 11
v_xor_b32 v171, s76, v171
v_cmp_lt_u32 vcc, s66, v175
s_or_b64 exec, vcc, 1
buffer_load_dword v160, v171, s[48:51], 0 offen
s_mov_b64 exec, -1
v_xor_b32 v170, s76, v170
v_cmp_lt_u32 vcc, s66, v174
s_or_b64 exec, vcc, 1
buffer_load_dword v160, v170, s[48:51], 0 offen
s_mov_b64 exec, -1
v_xor_b32 v169, s76, v169
v_cmp_lt_u32 vcc, s66, v173
s_or_b64 exec, vcc, 1
buffer_load_dword v160, v169, s[48:51], 0 offen
s_mov_b64 exec, -1
v_xor_b32 v168, s76, v168
v_cmp_lt_u32 vcc, s66, v172
s_or_b64 exec, vcc, 1
buffer_load_dword v160, v168, s[48:51], 0 offen
s_mov_b64 exec, -1
s_mov_b64 exec, 1
buffer_store_dword v1, off, s[36:39], s67 offset:128
s_mov_b64 exec, -1
s_waitcnt vmcnt(12)
v_and_b32_dpp v108, v22, v4 row_newbcast:4 row_mask:0xf bank_mask:0xf
v_and_b32_dpp v109, v22, v5 row_newbcast:4 row_mask:0xf bank_mask:0xf
v_and_b32_dpp v110, v22, v6 row_newbcast:4 row_mask:0xf bank_mask:0xf
v_and_b32_dpp v111, v22, v7 row_newbcast:4 row_mask:0xf bank_mask:0xf
v_mfma_f32_16x16x32_bf16 v[112:115], v[104:107], v[152:155], v[112:115]
s_waitcnt vmcnt(11)
v_and_b32_dpp v104, v22, v4 row_newbcast:8 row_mask:0xf bank_mask:0xf
v_and_b32_dpp v105, v22, v5 row_newbcast:8 row_mask:0xf bank_mask:0xf
v_and_b32_dpp v106, v22, v6 row_newbcast:8 row_mask:0xf bank_mask:0xf
v_and_b32_dpp v107, v22, v7 row_newbcast:8 row_mask:0xf bank_mask:0xf
v_mfma_f32_16x16x32_bf16 v[112:115], v[108:111], v[156:159], v[112:115]
s_waitcnt vmcnt(10)
v_and_b32_dpp v108, v22, v4 row_newbcast:12 row_mask:0xf bank_mask:0xf
v_and_b32_dpp v109, v22, v5 row_newbcast:12 row_mask:0xf bank_mask:0xf
v_and_b32_dpp v110, v22, v6 row_newbcast:12 row_mask:0xf bank_mask:0xf
v_and_b32_dpp v111, v22, v7 row_newbcast:12 row_mask:0xf bank_mask:0xf
v_mfma_f32_16x16x32_bf16 v[112:115], v[104:107], v[176:179], v[112:115]
s_waitcnt vmcnt(9)
v_and_b32_dpp v104, v23, v4 row_newbcast:0 row_mask:0xf bank_mask:0xf
v_and_b32_dpp v105, v23, v5 row_newbcast:0 row_mask:0xf bank_mask:0xf
v_and_b32_dpp v106, v23, v6 row_newbcast:0 row_mask:0xf bank_mask:0xf
v_and_b32_dpp v107, v23, v7 row_newbcast:0 row_mask:0xf bank_mask:0xf
v_mfma_f32_16x16x32_bf16 v[112:115], v[108:111], v[180:183], v[112:115]
s_waitcnt vmcnt(8)
v_and_b32_dpp v108, v23, v4 row_newbcast:4 row_mask:0xf bank_mask:0xf
v_and_b32_dpp v109, v23, v5 row_newbcast:4 row_mask:0xf bank_mask:0xf
v_and_b32_dpp v110, v23, v6 row_newbcast:4 row_mask:0xf bank_mask:0xf
v_and_b32_dpp v111, v23, v7 row_newbcast:4 row_mask:0xf bank_mask:0xf
v_mfma_f32_16x16x32_bf16 v[112:115], v[104:107], v[184:187], v[112:115]
s_waitcnt vmcnt(7)
v_and_b32_dpp v104, v23, v4 row_newbcast:8 row_mask:0xf bank_mask:0xf
v_and_b32_dpp v105, v23, v5 row_newbcast:8 row_mask:0xf bank_mask:0xf
v_and_b32_dpp v106, v23, v6 row_newbcast:8 row_mask:0xf bank_mask:0xf
v_and_b32_dpp v107, v23, v7 row_newbcast:8 row_mask:0xf bank_mask:0xf
v_mfma_f32_16x16x32_bf16 v[112:115], v[108:111], v[24:27], v[112:115]
s_waitcnt vmcnt(6)
v_and_b32_dpp v108, v23, v4 row_newbcast:12 row_mask:0xf bank_mask:0xf
v_and_b32_dpp v109, v23, v5 row_newbcast:12 row_mask:0xf bank_mask:0xf
v_and_b32_dpp v110, v23, v6 row_newbcast:12 row_mask:0xf bank_mask:0xf
v_and_b32_dpp v111, v23, v7 row_newbcast:12 row_mask:0xf bank_mask:0xf
v_mfma_f32_16x16x32_bf16 v[112:115], v[104:107], v[28:31], v[112:115]
s_waitcnt vmcnt(5)
v_mfma_f32_16x16x32_bf16 v[112:115], v[108:111], v[32:35], v[112:115]
s_branch L_drained
L_nohelp:
L_drain:
s_waitcnt vmcnt(7)
v_and_b32_dpp v108, v22, v4 row_newbcast:4 row_mask:0xf bank_mask:0xf
v_and_b32_dpp v109, v22, v5 row_newbcast:4 row_mask:0xf bank_mask:0xf
v_and_b32_dpp v110, v22, v6 row_newbcast:4 row_mask:0xf bank_mask:0xf
v_and_b32_dpp v111, v22, v7 row_newbcast:4 row_mask:0xf bank_mask:0xf
v_mfma_f32_16x16x32_bf16 v[112:115], v[104:107], v[152:155], v[112:115]
s_waitcnt vmcnt(6)
v_and_b32_dpp v104, v22, v4 row_newbcast:8 row_mask:0xf bank_mask:0xf
v_and_b32_dpp v105, v22, v5 row_newbcast:8 row_mask:0xf bank_mask:0xf
v_and_b32_dpp v106, v22, v6 row_newbcast:8 row_mask:0xf bank_mask:0xf
v_and_b32_dpp v107, v22, v7 row_newbcast:8 row_mask:0xf bank_mask:0xf
v_mfma_f32_16x16x32_bf16 v[112:115], v[108:111], v[156:159], v[112:115]
s_waitcnt vmcnt(5)
v_and_b32_dpp v108, v22, v4 row_newbcast:12 row_mask:0xf bank_mask:0xf
v_and_b32_dpp v109, v22, v5 row_newbcast:12 row_mask:0xf bank_mask:0xf
v_and_b32_dpp v110, v22, v6 row_newbcast:12 row_mask:0xf bank_mask:0xf
v_and_b32_dpp v111, v22, v7 row_newbcast:12 row_mask:0xf bank_mask:0xf
v_mfma_f32_16x16x32_bf16 v[112:115], v[104:107], v[176:179], v[112:115]
s_waitcnt vmcnt(4)
v_and_b32_dpp v104, v23, v4 row_newbcast:0 row_mask:0xf bank_mask:0xf
v_and_b32_dpp v105, v23, v5 row_newbcast:0 row_mask:0xf bank_mask:0xf
v_and_b32_dpp v106, v23, v6 row_newbcast:0 row_mask:0xf bank_mask:0xf
v_and_b32_dpp v107, v23, v7 row_newbcast:0 row_mask:0xf bank_mask:0xf
v_mfma_f32_16x16x32_bf16 v[112:115], v[108:111], v[180:183], v[112:115]
s_waitcnt vmcnt(3)
v_and_b32_dpp v108, v23, v4 row_newbcast:4 row_mask:0xf bank_mask:0xf
v_and_b32_dpp v109, v23, v5 row_newbcast:4 row_mask:0xf bank_mask:0xf
v_and_b32_dpp v110, v23, v6 row_newbcast:4 row_mask:0xf bank_mask:0xf
v_and_b32_dpp v111, v23, v7 row_newbcast:4 row_mask:0xf bank_mask:0xf
v_mfma_f32_16x16x32_bf16 v[112:115], v[104:107], v[184:187], v[112:115]
s_waitcnt vmcnt(2)
v_and_b32_dpp v104, v23, v4 row_newbcast:8 row_mask:0xf bank_mask:0xf
v_and_b32_dpp v105, v23, v5 row_newbcast:8 row_mask:0xf bank_mask:0xf
v_and_b32_dpp v106, v23, v6 row_newbcast:8 row_mask:0xf bank_mask:0xf
v_and_b32_dpp v107, v23, v7 row_newbcast:8 row_mask:0xf bank_mask:0xf
v_mfma_f32_16x16x32_bf16 v[112:115], v[108:111], v[24:27], v[112:115]
s_waitcnt vmcnt(1)
v_and_b32_dpp v108, v23, v4 row_newbcast:12 row_mask:0xf bank_mask:0xf
v_and_b32_dpp v109, v23, v5 row_newbcast:12 row_mask:0xf bank_mask:0xf
v_and_b32_dpp v110, v23, v6 row_newbcast:12 row_mask:0xf bank_mask:0xf
v_and_b32_dpp v111, v23, v7 row_newbcast:12 row_mask:0xf bank_mask:0xf
v_mfma_f32_16x16x32_bf16 v[112:115], v[104:107], v[28:31], v[112:115]
s_waitcnt vmcnt(0)
v_mfma_f32_16x16x32_bf16 v[112:115], v[108:111], v[32:35], v[112:115]
L_drained:
v_and_b32 v2, 15, v0
v_lshlrev_b32 v2, 5, v2
v_and_b32 v3, 16, v0
v_add_u32 v2, v2, v3
s_lshl_b32 s68, s34, 9
v_add_u32 v2, s68, v2
s_mov_b32 exec_hi, 0
s_nop 1
ds_write_b128 v2, v[112:115] offset:512
s_mov_b32 exec_hi, -1
v_lshlrev_b32 v1, 4, v0
s_waitcnt lgkmcnt(0)
s_barrier
v_mov_b32 v2, 0
ds_read_b32 v3, v2 offset:328
s_waitcnt lgkmcnt(0)
v_readfirstlane_b32 s35, v3
s_branch L_tail_s
L_fin:
L_end:
s_endpgm
L_code_end:
.section .rodata,"a"
.p2align 6
.amdhsa_kernel adaLN_cond__sliding_block_cached__glu_gated_glu__decode_kernel
  .amdhsa_next_free_vgpr 256
  .amdhsa_next_free_sgpr 102
  .amdhsa_accum_offset 256
  .amdhsa_group_segment_fixed_size 0
  .amdhsa_kernarg_size 112
  .amdhsa_user_sgpr_count 2
  .amdhsa_user_sgpr_kernarg_segment_ptr 1
  .amdhsa_system_sgpr_workgroup_id_x 1
  .amdhsa_float_denorm_mode_32 3
.end_amdhsa_kernel
```

```asm
; @launch grid=(256,1,1) block=(512,1,1) lds=131072
.amdgcn_target "amdgcn-amd-amdhsa--gfx950"
.text
.globl adaLN_cond__sliding_block_cached__glu_gated_glu__decode_kernel
.p2align 8
.type adaLN_cond__sliding_block_cached__glu_gated_glu__decode_kernel,@function
adaLN_cond__sliding_block_cached__glu_gated_glu__decode_kernel:
L_code_begin:
s_load_dwordx16 s[4:19], s[0:1], 0
s_load_dwordx8 s[20:27], s[0:1], 64
s_load_dwordx4 s[28:31], s[0:1], 96
s_cmpk_ge_u32 s2, 256
s_cbranch_scc1 L_end
v_lshrrev_b32 v1, 6, v0
v_and_b32 v0, 63, v0
v_readfirstlane_b32 s3, v1
v_lshlrev_b32 v1, 4, v0
s_lshl_b32 s64, s2, 20
s_add_u32 s64, s64, 0xC0000
s_mov_b32 s42, 0x40000
s_mov_b32 s43, 0x20000
s_and_b32 s34, s3, 3
s_cmp_ge_u32 s3, 4
s_cbranch_scc1 L_helper
s_and_b32 s65, s34, 1
s_lshl_b32 s65, s65, 14
s_lshr_b32 s66, s34, 1
s_lshl_b32 s66, s66, 13
s_or_b32 s65, s65, s66
s_lshl_b32 s66, s2, 10
s_xor_b32 s65, s65, s66
s_waitcnt lgkmcnt(0)
s_add_u32 s40, s6, s64
s_addc_u32 s41, s7, 0
s_add_u32 s44, s8, s64
s_addc_u32 s45, s9, 0
buffer_load_dwordx4 v[8:11], v1, s[40:43], s65 offen nt
s_xor_b32 s64, s65, 65536
buffer_load_dwordx4 v[12:15], v1, s[40:43], s64 offen nt
s_xor_b32 s64, s65, 2048
buffer_load_dwordx4 v[16:19], v1, s[40:43], s64 offen nt
s_xor_b32 s64, s65, 67584
buffer_load_dwordx4 v[20:23], v1, s[40:43], s64 offen nt
s_barrier
s_branch L_srest
L_helper:
s_setprio 2
v_lshlrev_b32 v2, 2, v0
s_cmp_eq_u32 s3, 7
s_cbranch_scc0 L_nopf
s_getpc_b64 s[60:61]
L_pc:
s_lshr_b32 s66, s2, 3
s_lshl_b32 s66, s66, 10
v_add_u32 v10, s66, v1
v_min_u32 v10, L_code_end-L_pc-16, v10
global_load_dwordx4 v[12:15], v10, s[60:61]
v_subrev_u32 v3, 16, v0
v_ashrrev_i32 v3, 31, v3
ds_write_b32 v2, v3 offset:256
L_nopf:
s_and_b32 s67, s2, 7
s_lshr_b32 s68, s2, 3
v_and_b32 v38, 7, v0
v_lshrrev_b32 v37, 3, v0
s_cmp_eq_u32 s34, 0
s_cbranch_scc0 L_p0a
s_mov_b32 s70, 6
s_lshl_b32 s67, s67, 1
s_add_u32 s66, s67, 14
v_min_u32 v38, 5, v38
v_cmp_lt_u32 vcc, 1, v38
v_add_u32 v36, s66, v38
s_nop 0
v_cndmask_b32 v38, v38, v36, vcc
s_branch L_p0b
L_p0a:
s_lshl_b32 s67, s67, 3
s_lshl_b32 s65, s2, 3
s_and_b32 s65, s65, 0xff
s_lshr_b32 s66, s2, 5
s_or_b32 s65, s65, s66
s_cmp_eq_u32 s34, 2
s_cselect_b32 s70, 1, 8
s_cselect_b32 s68, s65, s68
s_cselect_b32 s67, 0, s67
L_p0b:
v_lshl_add_u32 v37, s68, 4, v37
v_mul_u32_u24 v37, s70, v37
v_lshl_add_u32 v38, v37, 3, v38
v_add_lshl_u32 v38, v38, s67, 7
s_lshl_b32 s70, s70, 13
v_add_u32 v39, s70, v38
s_sub_u32 s64, s2, 112
s_cmp_lt_u32 s64, 32
s_waitcnt lgkmcnt(0)
s_barrier
s_cbranch_scc1 L_jan
s_cmp_eq_u32 s34, 3
s_cbranch_scc1 L_p0_125
s_cmp_eq_u32 s34, 0
s_cselect_b32 s62, s24, s10
s_cselect_b32 s63, s25, s11
s_cmp_eq_u32 s34, 2
s_cselect_b32 s62, s12, s62
s_cselect_b32 s63, s13, s63
global_load_dword v12, v38, s[62:63]
global_load_dword v13, v39, s[62:63]
L_p0_125:
L_nop0:
s_cmp_eq_u32 s34, 3
s_cselect_b32 s64, 16, 0
s_cmp_lt_u32 s2, s64
s_cbranch_scc0 L_nopc
v_mov_b32 v4, -1
v_mov_b32 v5, -1
v_mov_b32 v6, -1
v_mov_b32 v7, -1
s_and_b32 s66, s2, 7
s_lshl_b32 s66, s66, 11
s_and_b32 s65, s2, 8
s_lshl_b32 s65, s65, 7
s_add_u32 s66, s66, s65
v_add_u32 v8, s66, v1
global_store_dwordx4 v8, v[4:7], s[30:31] sc1
s_lshl_b32 s66, s2, 2
v_mov_b32 v3, s66
s_waitcnt vmcnt(0)
s_mov_b64 exec, 1
global_store_dword v3, v4, s[28:29] sc1
s_mov_b64 exec, -1
L_nopc:
s_cmp_eq_u32 s34, 3
s_cbranch_scc0 L_w_126
s_and_b32 s67, s2, 7
s_lshr_b32 s68, s2, 3
s_min_u32 s64, s67, 3
s_mul_i32 s65, s67, 5
s_add_u32 s64, s64, s65
s_cmp_lt_u32 s67, 3
s_cselect_b32 s65, 6, 5
L_w_126:
s_lshr_b32 s32, s2, 5
s_and_b32 s33, s2, 31
s_and_b32 s67, s2, 7
s_lshr_b32 s68, s2, 3
s_sub_u32 s68, s68, 26
s_min_u32 s74, s67, 3
s_mul_i32 s66, s67, 5
s_add_u32 s74, s74, s66
s_add_u32 s74, s74, s68
s_cmp_lt_u32 s67, 3
s_cselect_b32 s66, 6, 5
s_cmp_lt_u32 s68, s66
s_cselect_b32 s74, s74, -1
s_cmp_lt_u32 s2, 48
s_cselect_b32 s66, 2, 3
s_cselect_b32 s72, 14+26, 42+26
s_cmp_lt_u32 s2, 16
s_cselect_b32 s66, 1, s66
s_cselect_b32 s72, 26, s72
s_lshl_b32 s66, s67, s66
s_add_u32 s72, s72, s66
s_add_u32 s72, s72, s68
s_mov_b32 s36, s30
s_mov_b32 s37, s31
s_mov_b32 s38, 0x1d0000
s_mov_b32 s39, 0x20000
s_mov_b32 s52, s28
s_mov_b32 s53, s29
s_mov_b32 s54, 0x100
s_mov_b32 s55, 0x20000
v_mov_b32 v9, 1
s_cmp_lt_u32 s2, 112
s_cbranch_scc0 L_norole
L_gemm:
v_and_b32 v16, 7, v0
v_lshlrev_b32 v16, 10, v16
v_and_b32 v17, 8, v0
v_lshl_add_u32 v16, v17, 3, v16
v_and_b32 v17, 48, v0
v_add_u32 v16, v16, v17
s_lshl_b32 s67, s34, 8
v_lshrrev_b32 v19, 3, v0
v_and_b32 v17, 2, v19
v_and_b32 v18, 7, v0
v_xor_b32 v17, v17, v18
v_xor_b32 v18, 4, v17
v_lshlrev_b32 v17, 4, v17
v_lshlrev_b32 v18, 4, v18
s_cmp_lt_u32 s2, 48
s_cbranch_scc0 L_gq0
s_mov_b32 s40, s24
s_mov_b32 s41, s25
s_mov_b32 s42, 0x300000
s_mov_b32 s43, 0x20000
s_mov_b32 s48, s22
s_mov_b32 s49, s23
s_mov_b32 s50, 0x2000
s_mov_b32 s51, 0x20000
s_mov_b32 s70, 6144
s_lshl_b32 s64, s72, 7
s_branch L_g1
L_gq0:
s_mov_b32 s40, s10
s_mov_b32 s41, s11
s_mov_b32 s42, 0x400000
s_mov_b32 s43, 0x20000
s_mov_b32 s48, s4
s_mov_b32 s49, s5
s_mov_b32 s50, 0x2000
s_mov_b32 s51, 0x20000
s_mov_b32 s70, 8192
s_sub_u32 s64, s72, 48
s_lshl_b32 s64, s64, 7
L_g1:
buffer_load_dwordx4 v[192:195], v16, s[48:51], s67 offen offset:0
buffer_load_dwordx4 v[196:199], v16, s[48:51], s67 offen offset:128
v_mul_lo_u32 v19, s70, v19
v_add_u32 v17, v17, v19
v_add_u32 v18, v18, v19
s_lshl_b32 s66, s70, 7
s_mul_i32 s66, s66, s34
s_add_u32 s64, s64, s66
s_lshl_b32 s70, s70, 3
s_lshl_b32 s65, s34, 13
s_add_u32 s65, s65, 4096
s_cmp_lt_u32 s2, 16
s_cselect_b32 s71, 0, 2
s_cmp_ge_u32 s2, 48
s_cselect_b32 s71, 1, s71
s_add_u32 m0, s65, 0
s_nop 0
buffer_load_dwordx4 v17, s[40:43], s64 offen  lds
s_add_u32 s64, s64, s70
s_add_u32 m0, s65, 1024
s_nop 0
buffer_load_dwordx4 v18, s[40:43], s64 offen  lds
s_add_u32 s64, s64, s70
s_cmp_eq_u32 s71, 2
s_cbranch_scc0 L_pace_127
s_waitcnt vmcnt(1)
L_pace_127:
s_add_u32 m0, s65, 2048
s_nop 0
buffer_load_dwordx4 v17, s[40:43], s64 offen  lds
s_add_u32 s64, s64, s70
s_cmp_eq_u32 s71, 0
s_cbranch_scc1 L_pace_128
s_waitcnt vmcnt(2)
s_cmp_eq_u32 s71, 2
s_cbranch_scc0 L_pace_128
s_waitcnt vmcnt(1)
L_pace_128:
s_add_u32 m0, s65, 3072
s_nop 0
buffer_load_dwordx4 v18, s[40:43], s64 offen  lds
s_add_u32 s64, s64, s70
s_cmp_eq_u32 s71, 0
s_cbranch_scc1 L_pace_129
s_waitcnt vmcnt(2)
s_cmp_eq_u32 s71, 2
s_cbranch_scc0 L_pace_129
s_waitcnt vmcnt(1)
L_pace_129:
s_add_u32 m0, s65, 4096
s_nop 0
buffer_load_dwordx4 v17, s[40:43], s64 offen  lds
s_add_u32 s64, s64, s70
s_cmp_eq_u32 s71, 0
s_cbranch_scc1 L_pace_130
s_waitcnt vmcnt(2)
s_cmp_eq_u32 s71, 2
s_cbranch_scc0 L_pace_130
s_waitcnt vmcnt(1)
L_pace_130:
s_add_u32 m0, s65, 5120
s_nop 0
buffer_load_dwordx4 v18, s[40:43], s64 offen  lds
s_add_u32 s64, s64, s70
s_cmp_eq_u32 s71, 0
s_cbranch_scc1 L_pace_131
s_waitcnt vmcnt(2)
s_cmp_eq_u32 s71, 2
s_cbranch_scc0 L_pace_131
s_waitcnt vmcnt(1)
L_pace_131:
s_add_u32 m0, s65, 6144
s_nop 0
buffer_load_dwordx4 v17, s[40:43], s64 offen  lds
s_add_u32 s64, s64, s70
s_cmp_eq_u32 s71, 0
s_cbranch_scc1 L_pace_132
s_waitcnt vmcnt(2)
s_cmp_eq_u32 s71, 2
s_cbranch_scc0 L_pace_132
s_waitcnt vmcnt(1)
L_pace_132:
s_add_u32 m0, s65, 7168
s_nop 0
buffer_load_dwordx4 v18, s[40:43], s64 offen  lds
s_add_u32 s64, s64, s70
s_cmp_eq_u32 s71, 0
s_cbranch_scc1 L_pace_133
s_waitcnt vmcnt(2)
s_cmp_eq_u32 s71, 2
s_cbranch_scc0 L_pace_133
s_waitcnt vmcnt(1)
L_pace_133:
s_add_u32 m0, s65, 32768
s_nop 0
buffer_load_dwordx4 v17, s[40:43], s64 offen  lds
s_add_u32 s64, s64, s70
s_cmp_eq_u32 s71, 0
s_cbranch_scc1 L_pace_134
s_waitcnt vmcnt(2)
s_cmp_eq_u32 s71, 2
s_cbranch_scc0 L_pace_134
s_waitcnt vmcnt(1)
L_pace_134:
s_add_u32 m0, s65, 33792
s_nop 0
buffer_load_dwordx4 v18, s[40:43], s64 offen  lds
s_add_u32 s64, s64, s70
s_cmp_eq_u32 s71, 0
s_cbranch_scc1 L_pace_135
s_waitcnt vmcnt(2)
s_cmp_eq_u32 s71, 2
s_cbranch_scc0 L_pace_135
s_waitcnt vmcnt(1)
L_pace_135:
s_add_u32 m0, s65, 34816
s_nop 0
buffer_load_dwordx4 v17, s[40:43], s64 offen  lds
s_add_u32 s64, s64, s70
s_cmp_eq_u32 s71, 0
s_cbranch_scc1 L_pace_136
s_waitcnt vmcnt(2)
s_cmp_eq_u32 s71, 2
s_cbranch_scc0 L_pace_136
s_waitcnt vmcnt(1)
L_pace_136:
s_add_u32 m0, s65, 35840
s_nop 0
buffer_load_dwordx4 v18, s[40:43], s64 offen  lds
s_add_u32 s64, s64, s70
s_cmp_eq_u32 s71, 0
s_cbranch_scc1 L_pace_137
s_waitcnt vmcnt(2)
s_cmp_eq_u32 s71, 2
s_cbranch_scc0 L_pace_137
s_waitcnt vmcnt(1)
L_pace_137:
s_add_u32 m0, s65, 36864
s_nop 0
buffer_load_dwordx4 v17, s[40:43], s64 offen  lds
s_add_u32 s64, s64, s70
s_cmp_eq_u32 s71, 0
s_cbranch_scc1 L_pace_138
s_waitcnt vmcnt(2)
s_cmp_eq_u32 s71, 2
s_cbranch_scc0 L_pace_138
s_waitcnt vmcnt(1)
L_pace_138:
s_add_u32 m0, s65, 37888
s_nop 0
buffer_load_dwordx4 v18, s[40:43], s64 offen  lds
s_add_u32 s64, s64, s70
s_cmp_eq_u32 s71, 0
s_cbranch_scc1 L_pace_139
s_waitcnt vmcnt(2)
s_cmp_eq_u32 s71, 2
s_cbranch_scc0 L_pace_139
s_waitcnt vmcnt(1)
L_pace_139:
s_add_u32 m0, s65, 38912
s_nop 0
buffer_load_dwordx4 v17, s[40:43], s64 offen  lds
s_add_u32 s64, s64, s70
s_cmp_eq_u32 s71, 0
s_cbranch_scc1 L_pace_140
s_waitcnt vmcnt(2)
s_cmp_eq_u32 s71, 2
s_cbranch_scc0 L_pace_140
s_waitcnt vmcnt(1)
L_pace_140:
s_add_u32 m0, s65, 39936
s_nop 0
buffer_load_dwordx4 v18, s[40:43], s64 offen  lds
s_add_u32 s64, s64, s70
s_waitcnt vmcnt(16)
s_cmp_eq_u32 s34, 0
s_cselect_b32 s73, 48, 0x1000
v_and_b32 v30, 15, v0
v_lshlrev_b32 v30, 2, v30
s_cmp_ge_u32 s2, s73
s_cbranch_scc0 L_fl_141
buffer_load_dword v31, v30, s[52:55], 0 offen sc1
L_fl_141:
s_mov_b32 s68, 0xffff0000
s_cmp_lt_u32 s2, 48
s_cbranch_scc0 L_gq1
s_mov_b32 s66, 0xbfb8aa3b
v_lshlrev_b32 v20, 16, v192
v_and_b32 v21, s68, v192
v_mul_f32 v22, s66, v20
v_mul_f32 v23, s66, v21
v_exp_f32 v22, v22
v_exp_f32 v23, v23
s_nop 0
v_add_f32 v22, 1.0, v22
v_add_f32 v23, 1.0, v23
v_rcp_f32 v22, v22
v_rcp_f32 v23, v23
s_nop 0
v_mul_f32 v20, v20, v22
v_mul_f32 v21, v21, v23
v_cvt_pk_bf16_f32 v48, v20, v21
v_lshlrev_b32 v20, 16, v193
v_and_b32 v21, s68, v193
v_mul_f32 v22, s66, v20
v_mul_f32 v23, s66, v21
v_exp_f32 v22, v22
v_exp_f32 v23, v23
s_nop 0
v_add_f32 v22, 1.0, v22
v_add_f32 v23, 1.0, v23
v_rcp_f32 v22, v22
v_rcp_f32 v23, v23
s_nop 0
v_mul_f32 v20, v20, v22
v_mul_f32 v21, v21, v23
v_cvt_pk_bf16_f32 v49, v20, v21
v_lshlrev_b32 v20, 16, v194
v_and_b32 v21, s68, v194
v_mul_f32 v22, s66, v20
v_mul_f32 v23, s66, v21
v_exp_f32 v22, v22
v_exp_f32 v23, v23
s_nop 0
v_add_f32 v22, 1.0, v22
v_add_f32 v23, 1.0, v23
v_rcp_f32 v22, v22
v_rcp_f32 v23, v23
s_nop 0
v_mul_f32 v20, v20, v22
v_mul_f32 v21, v21, v23
v_cvt_pk_bf16_f32 v50, v20, v21
v_lshlrev_b32 v20, 16, v195
v_and_b32 v21, s68, v195
v_mul_f32 v22, s66, v20
v_mul_f32 v23, s66, v21
v_exp_f32 v22, v22
v_exp_f32 v23, v23
s_nop 0
v_add_f32 v22, 1.0, v22
v_add_f32 v23, 1.0, v23
v_rcp_f32 v22, v22
v_rcp_f32 v23, v23
s_nop 0
v_mul_f32 v20, v20, v22
v_mul_f32 v21, v21, v23
v_cvt_pk_bf16_f32 v51, v20, v21
v_lshlrev_b32 v20, 16, v196
v_and_b32 v21, s68, v196
v_mul_f32 v22, s66, v20
v_mul_f32 v23, s66, v21
v_exp_f32 v22, v22
v_exp_f32 v23, v23
s_nop 0
v_add_f32 v22, 1.0, v22
v_add_f32 v23, 1.0, v23
v_rcp_f32 v22, v22
v_rcp_f32 v23, v23
s_nop 0
v_mul_f32 v20, v20, v22
v_mul_f32 v21, v21, v23
v_cvt_pk_bf16_f32 v52, v20, v21
v_lshlrev_b32 v20, 16, v197
v_and_b32 v21, s68, v197
v_mul_f32 v22, s66, v20
v_mul_f32 v23, s66, v21
v_exp_f32 v22, v22
v_exp_f32 v23, v23
s_nop 0
v_add_f32 v22, 1.0, v22
v_add_f32 v23, 1.0, v23
v_rcp_f32 v22, v22
v_rcp_f32 v23, v23
s_nop 0
v_mul_f32 v20, v20, v22
v_mul_f32 v21, v21, v23
v_cvt_pk_bf16_f32 v53, v20, v21
v_lshlrev_b32 v20, 16, v198
v_and_b32 v21, s68, v198
v_mul_f32 v22, s66, v20
v_mul_f32 v23, s66, v21
v_exp_f32 v22, v22
v_exp_f32 v23, v23
s_nop 0
v_add_f32 v22, 1.0, v22
v_add_f32 v23, 1.0, v23
v_rcp_f32 v22, v22
v_rcp_f32 v23, v23
s_nop 0
v_mul_f32 v20, v20, v22
v_mul_f32 v21, v21, v23
v_cvt_pk_bf16_f32 v54, v20, v21
v_lshlrev_b32 v20, 16, v199
v_and_b32 v21, s68, v199
v_mul_f32 v22, s66, v20
v_mul_f32 v23, s66, v21
v_exp_f32 v22, v22
v_exp_f32 v23, v23
s_nop 0
v_add_f32 v22, 1.0, v22
v_add_f32 v23, 1.0, v23
v_rcp_f32 v22, v22
v_rcp_f32 v23, v23
s_nop 0
v_mul_f32 v20, v20, v22
v_mul_f32 v21, v21, v23
v_cvt_pk_bf16_f32 v55, v20, v21
s_branch L_g2
L_gq1:
v_and_b32 v32, 7, v0
v_lshlrev_b32 v32, 2, v32
v_lshlrev_b32 v96, 16, v192
v_and_b32 v97, s68, v192
v_lshlrev_b32 v98, 16, v193
v_and_b32 v99, s68, v193
v_lshlrev_b32 v100, 16, v194
v_and_b32 v101, s68, v194
v_lshlrev_b32 v102, 16, v195
v_and_b32 v103, s68, v195
v_lshlrev_b32 v104, 16, v196
v_and_b32 v105, s68, v196
v_lshlrev_b32 v106, 16, v197
v_and_b32 v107, s68, v197
v_lshlrev_b32 v108, 16, v198
v_and_b32 v109, s68, v198
v_lshlrev_b32 v110, 16, v199
v_and_b32 v111, s68, v199
v_add_f32 v20, v96, v97
v_add_f32 v20, v20, v98
v_add_f32 v20, v20, v99
v_add_f32 v20, v20, v100
v_add_f32 v20, v20, v101
v_add_f32 v20, v20, v102
v_add_f32 v20, v20, v103
v_add_f32 v20, v20, v104
v_add_f32 v20, v20, v105
v_add_f32 v20, v20, v106
v_add_f32 v20, v20, v107
v_add_f32 v20, v20, v108
v_add_f32 v20, v20, v109
v_add_f32 v20, v20, v110
v_add_f32 v20, v20, v111
s_nop 1
v_add_f32_dpp v20, v20, v20 row_ror:8 row_mask:0xf bank_mask:0xf
v_mov_b32 v22, v20
s_nop 1
v_permlane16_swap_b32 v20, v22
s_nop 1
v_add_f32 v20, v20, v22
v_mov_b32 v22, v20
s_nop 1
v_permlane32_swap_b32 v20, v22
s_nop 1
v_add_f32 v20, v20, v22
v_mul_f32 v20, 0x3c000000, v20
v_mov_b32 v21, 0
v_sub_f32 v22, v96, v20
v_fmac_f32 v21, v22, v22
v_sub_f32 v22, v97, v20
v_fmac_f32 v21, v22, v22
v_sub_f32 v22, v98, v20
v_fmac_f32 v21, v22, v22
v_sub_f32 v22, v99, v20
v_fmac_f32 v21, v22, v22
v_sub_f32 v22, v100, v20
v_fmac_f32 v21, v22, v22
v_sub_f32 v22, v101, v20
v_fmac_f32 v21, v22, v22
v_sub_f32 v22, v102, v20
v_fmac_f32 v21, v22, v22
v_sub_f32 v22, v103, v20
v_fmac_f32 v21, v22, v22
v_sub_f32 v22, v104, v20
v_fmac_f32 v21, v22, v22
v_sub_f32 v22, v105, v20
v_fmac_f32 v21, v22, v22
v_sub_f32 v22, v106, v20
v_fmac_f32 v21, v22, v22
v_sub_f32 v22, v107, v20
v_fmac_f32 v21, v22, v22
v_sub_f32 v22, v108, v20
v_fmac_f32 v21, v22, v22
v_sub_f32 v22, v109, v20
v_fmac_f32 v21, v22, v22
v_sub_f32 v22, v110, v20
v_fmac_f32 v21, v22, v22
v_sub_f32 v22, v111, v20
v_fmac_f32 v21, v22, v22
s_nop 1
v_add_f32_dpp v21, v21, v21 row_ror:8 row_mask:0xf bank_mask:0xf
v_mov_b32 v22, v21
s_nop 1
v_permlane16_swap_b32 v21, v22
s_nop 1
v_add_f32 v21, v21, v22
v_mov_b32 v22, v21
s_nop 1
v_permlane32_swap_b32 v21, v22
s_nop 1
v_add_f32 v21, v21, v22
v_lshlrev_b32 v22, 1, v32
s_lshl_b32 s66, s34, 6
v_add_u32 v23, s66, v22
ds_write_b64 v23, v[20:21] offset:0
v_mov_b32 v23, 0
s_waitcnt lgkmcnt(0)
s_mov_b64 exec, 1
ds_add_u32 v23, v9 offset:332
s_mov_b64 exec, -1
s_mov_b32 s75, 0
L_poll_142:
ds_read_b32 v24, v23 offset:332
s_waitcnt lgkmcnt(0)
v_cmp_gt_u32 vcc, 4, v24
s_cbranch_vccz L_pollx_143
s_add_u32 s75, s75, 1
s_cmp_lt_u32 s75, 0x1000000
s_cbranch_scc1 L_poll_142
L_pollx_143:
ds_read_b64 v[112:113], v22 offset:0
ds_read_b64 v[114:115], v22 offset:64
ds_read_b64 v[116:117], v22 offset:128
ds_read_b64 v[118:119], v22 offset:192
s_waitcnt lgkmcnt(0)
v_add_f32 v20, v112, v114
v_add_f32 v21, v116, v118
v_add_f32 v20, v20, v21
v_mul_f32 v20, 0x3e800000, v20
v_add_f32 v24, v113, v115
v_add_f32 v21, v117, v119
v_add_f32 v24, v24, v21
v_mov_b32 v21, 0
v_sub_f32 v22, v112, v20
v_fmac_f32 v21, v22, v22
v_sub_f32 v22, v114, v20
v_fmac_f32 v21, v22, v22
v_sub_f32 v22, v116, v20
v_fmac_f32 v21, v22, v22
v_sub_f32 v22, v118, v20
v_fmac_f32 v21, v22, v22
v_fmac_f32 v24, 0x43000000, v21
v_mul_f32 v24, 0x3b000000, v24
v_cvt_pk_bf16_f32 v24, 0, v24
v_cvt_pk_bf16_f32 v20, 0, v20
v_add_f32 v24, 0x3727c5ac, v24
v_cvt_pk_bf16_f32 v24, 0, v24
v_sqrt_f32 v24, v24
s_nop 0
v_cvt_pk_bf16_f32 v24, 0, v24
v_rcp_f32 v24, v24
s_nop 0
v_sub_f32 v96, v96, v20
v_cvt_pk_bf16_f32 v96, 0, v96
v_mul_f32 v96, v96, v24
v_cvt_pk_bf16_f32 v96, 0, v96
v_sub_f32 v97, v97, v20
v_cvt_pk_bf16_f32 v97, 0, v97
v_mul_f32 v97, v97, v24
v_cvt_pk_bf16_f32 v97, 0, v97
v_sub_f32 v98, v98, v20
v_cvt_pk_bf16_f32 v98, 0, v98
v_mul_f32 v98, v98, v24
v_cvt_pk_bf16_f32 v98, 0, v98
v_sub_f32 v99, v99, v20
v_cvt_pk_bf16_f32 v99, 0, v99
v_mul_f32 v99, v99, v24
v_cvt_pk_bf16_f32 v99, 0, v99
v_sub_f32 v100, v100, v20
v_cvt_pk_bf16_f32 v100, 0, v100
v_mul_f32 v100, v100, v24
v_cvt_pk_bf16_f32 v100, 0, v100
v_sub_f32 v101, v101, v20
v_cvt_pk_bf16_f32 v101, 0, v101
v_mul_f32 v101, v101, v24
v_cvt_pk_bf16_f32 v101, 0, v101
v_sub_f32 v102, v102, v20
v_cvt_pk_bf16_f32 v102, 0, v102
v_mul_f32 v102, v102, v24
v_cvt_pk_bf16_f32 v102, 0, v102
v_sub_f32 v103, v103, v20
v_cvt_pk_bf16_f32 v103, 0, v103
v_mul_f32 v103, v103, v24
v_cvt_pk_bf16_f32 v103, 0, v103
v_sub_f32 v104, v104, v20
v_cvt_pk_bf16_f32 v104, 0, v104
v_mul_f32 v104, v104, v24
v_cvt_pk_bf16_f32 v104, 0, v104
v_sub_f32 v105, v105, v20
v_cvt_pk_bf16_f32 v105, 0, v105
v_mul_f32 v105, v105, v24
v_cvt_pk_bf16_f32 v105, 0, v105
v_sub_f32 v106, v106, v20
v_cvt_pk_bf16_f32 v106, 0, v106
v_mul_f32 v106, v106, v24
v_cvt_pk_bf16_f32 v106, 0, v106
v_sub_f32 v107, v107, v20
v_cvt_pk_bf16_f32 v107, 0, v107
v_mul_f32 v107, v107, v24
v_cvt_pk_bf16_f32 v107, 0, v107
v_sub_f32 v108, v108, v20
v_cvt_pk_bf16_f32 v108, 0, v108
v_mul_f32 v108, v108, v24
v_cvt_pk_bf16_f32 v108, 0, v108
v_sub_f32 v109, v109, v20
v_cvt_pk_bf16_f32 v109, 0, v109
v_mul_f32 v109, v109, v24
v_cvt_pk_bf16_f32 v109, 0, v109
v_sub_f32 v110, v110, v20
v_cvt_pk_bf16_f32 v110, 0, v110
v_mul_f32 v110, v110, v24
v_cvt_pk_bf16_f32 v110, 0, v110
v_sub_f32 v111, v111, v20
v_cvt_pk_bf16_f32 v111, 0, v111
v_mul_f32 v111, v111, v24
v_cvt_pk_bf16_f32 v111, 0, v111
L_g2:
s_cmp_ge_u32 s2, s73
s_cbranch_scc0 L_fl_144
s_waitcnt vmcnt(0)
v_cmp_eq_u32 vcc, 0, v31
s_cbranch_vccz L_fl_144
s_mov_b32 s75, 0
L_poll_145:
buffer_load_dword v31, v30, s[52:55], 0 offen sc1
s_waitcnt vmcnt(0)
v_cmp_eq_u32 vcc, 0, v31
s_cbranch_vccz L_pollx_146
s_sleep 40
s_add_u32 s75, s75, 1
s_cmp_lt_u32 s75, 0x100000
s_cbranch_scc1 L_poll_145
L_pollx_146:
L_fl_144:
v_mov_b32 v20, 0
s_cmp_eq_u32 s34, 0
s_cbranch_scc0 L_w_147
ds_write_b32 v20, v9 offset:324
L_w_147:
v_lshrrev_b32 v18, 4, v0
v_bfe_u32 v19, v0, 2, 2
v_lshrrev_b32 v20, 1, v19
v_and_b32 v21, 1, v18
v_lshl_add_u32 v20, v21, 1, v20
v_lshlrev_b32 v20, 5, v20
v_lshl_add_u32 v20, v18, 10, v20
v_lshl_add_u32 v20, v19, 7, v20
v_and_b32 v21, 3, v0
v_lshl_add_u32 v20, v21, 3, v20
v_add_u32 v40, s65, v20
v_xor_b32 v41, 32, v40
v_xor_b32 v42, 64, v40
v_xor_b32 v43, 96, v40
s_waitcnt vmcnt(12) lgkmcnt(0)
ds_read_b64_tr_b16 v[128:129], v40 offset:0
ds_read_b64_tr_b16 v[130:131], v40 offset:512
ds_read_b64_tr_b16 v[132:133], v41 offset:0
ds_read_b64_tr_b16 v[134:135], v41 offset:512
ds_read_b64_tr_b16 v[136:137], v42 offset:0
ds_read_b64_tr_b16 v[138:139], v42 offset:512
ds_read_b64_tr_b16 v[140:141], v43 offset:0
ds_read_b64_tr_b16 v[142:143], v43 offset:512
s_waitcnt vmcnt(8) lgkmcnt(0)
ds_read_b64_tr_b16 v[144:145], v40 offset:4096
ds_read_b64_tr_b16 v[146:147], v40 offset:4608
ds_read_b64_tr_b16 v[148:149], v41 offset:4096
ds_read_b64_tr_b16 v[150:151], v41 offset:4608
ds_read_b64_tr_b16 v[152:153], v42 offset:4096
ds_read_b64_tr_b16 v[154:155], v42 offset:4608
ds_read_b64_tr_b16 v[156:157], v43 offset:4096
ds_read_b64_tr_b16 v[158:159], v43 offset:4608
s_waitcnt vmcnt(4) lgkmcnt(0)
ds_read_b64_tr_b16 v[160:161], v40 offset:32768
ds_read_b64_tr_b16 v[162:163], v40 offset:33280
ds_read_b64_tr_b16 v[164:165], v41 offset:32768
ds_read_b64_tr_b16 v[166:167], v41 offset:33280
ds_read_b64_tr_b16 v[168:169], v42 offset:32768
ds_read_b64_tr_b16 v[170:171], v42 offset:33280
ds_read_b64_tr_b16 v[172:173], v43 offset:32768
ds_read_b64_tr_b16 v[174:175], v43 offset:33280
s_waitcnt vmcnt(0) lgkmcnt(0)
ds_read_b64_tr_b16 v[176:177], v40 offset:36864
ds_read_b64_tr_b16 v[178:179], v40 offset:37376
ds_read_b64_tr_b16 v[180:181], v41 offset:36864
ds_read_b64_tr_b16 v[182:183], v41 offset:37376
ds_read_b64_tr_b16 v[184:185], v42 offset:36864
ds_read_b64_tr_b16 v[186:187], v42 offset:37376
ds_read_b64_tr_b16 v[188:189], v43 offset:36864
ds_read_b64_tr_b16 v[190:191], v43 offset:37376
s_waitcnt lgkmcnt(0)
s_cmp_eq_u32 s34, 2
s_cselect_b32 s73, 16, 0x1000
v_and_b32 v30, 31, v0
v_lshlrev_b32 v30, 2, v30
s_cmp_ge_u32 s2, s73
s_cbranch_scc0 L_fl_148
buffer_load_dword v31, v30, s[52:55], 0 offen offset:128 sc1
L_fl_148:
s_cmp_lt_u32 s2, 48
s_cbranch_scc1 L_g3
v_mov_b32 v20, 0
s_mov_b32 s75, 0
L_poll_149:
ds_read_b32 v22, v20 offset:324
s_waitcnt lgkmcnt(0)
v_cmp_eq_u32 vcc, 0, v22
s_cbranch_vccz L_pollx_150
s_sleep 1
s_add_u32 s75, s75, 1
s_cmp_lt_u32 s75, 0x1000000
s_cbranch_scc1 L_poll_149
L_pollx_150:
s_lshl_b32 s64, s34, 11
s_add_u32 s64, s64, 0
s_add_u32 s66, s64, 8192
s_mov_b32 s75, 0
L_poll_151:
buffer_load_dwordx4 v[192:195], v1, s[36:39], s64 offen offset:0 sc1
buffer_load_dwordx4 v[200:203], v1, s[36:39], s66 offen offset:0 sc1
buffer_load_dwordx4 v[196:199], v1, s[36:39], s64 offen offset:1024 sc1
buffer_load_dwordx4 v[204:207], v1, s[36:39], s66 offen offset:1024 sc1
s_waitcnt vmcnt(0)
v_max3_u32 v22, v192, v193, v194
v_max3_u32 v22, v22, v195, v196
v_max3_u32 v22, v22, v197, v198
v_max3_u32 v22, v22, v199, v200
v_max3_u32 v22, v22, v201, v202
v_max3_u32 v22, v22, v203, v204
v_max3_u32 v22, v22, v205, v206
v_max_u32 v22, v22, v207
v_cmp_eq_u32 vcc, -1, v22
s_cbranch_vccz L_pollx_152
s_sleep 16
s_add_u32 s75, s75, 1
s_cmp_lt_u32 s75, 0x100000
s_cbranch_scc1 L_poll_151
L_pollx_152:
v_lshlrev_b32 v20, 16, v200
v_and_b32 v21, s68, v200
v_add_f32 v20, 1.0, v20
v_add_f32 v21, 1.0, v21
v_cvt_pk_bf16_f32 v20, 0, v20
v_cvt_pk_bf16_f32 v21, 0, v21
v_mul_f32 v20, v20, v96
v_mul_f32 v21, v21, v97
v_cvt_pk_bf16_f32 v20, 0, v20
v_cvt_pk_bf16_f32 v21, 0, v21
v_lshlrev_b32 v22, 16, v192
v_and_b32 v23, s68, v192
v_add_f32 v20, v20, v22
v_add_f32 v21, v21, v23
v_cvt_pk_bf16_f32 v48, v20, v21
v_lshlrev_b32 v20, 16, v201
v_and_b32 v21, s68, v201
v_add_f32 v20, 1.0, v20
v_add_f32 v21, 1.0, v21
v_cvt_pk_bf16_f32 v20, 0, v20
v_cvt_pk_bf16_f32 v21, 0, v21
v_mul_f32 v20, v20, v98
v_mul_f32 v21, v21, v99
v_cvt_pk_bf16_f32 v20, 0, v20
v_cvt_pk_bf16_f32 v21, 0, v21
v_lshlrev_b32 v22, 16, v193
v_and_b32 v23, s68, v193
v_add_f32 v20, v20, v22
v_add_f32 v21, v21, v23
v_cvt_pk_bf16_f32 v49, v20, v21
v_lshlrev_b32 v20, 16, v202
v_and_b32 v21, s68, v202
v_add_f32 v20, 1.0, v20
v_add_f32 v21, 1.0, v21
v_cvt_pk_bf16_f32 v20, 0, v20
v_cvt_pk_bf16_f32 v21, 0, v21
v_mul_f32 v20, v20, v100
v_mul_f32 v21, v21, v101
v_cvt_pk_bf16_f32 v20, 0, v20
v_cvt_pk_bf16_f32 v21, 0, v21
v_lshlrev_b32 v22, 16, v194
v_and_b32 v23, s68, v194
v_add_f32 v20, v20, v22
v_add_f32 v21, v21, v23
v_cvt_pk_bf16_f32 v50, v20, v21
v_lshlrev_b32 v20, 16, v203
v_and_b32 v21, s68, v203
v_add_f32 v20, 1.0, v20
v_add_f32 v21, 1.0, v21
v_cvt_pk_bf16_f32 v20, 0, v20
v_cvt_pk_bf16_f32 v21, 0, v21
v_mul_f32 v20, v20, v102
v_mul_f32 v21, v21, v103
v_cvt_pk_bf16_f32 v20, 0, v20
v_cvt_pk_bf16_f32 v21, 0, v21
v_lshlrev_b32 v22, 16, v195
v_and_b32 v23, s68, v195
v_add_f32 v20, v20, v22
v_add_f32 v21, v21, v23
v_cvt_pk_bf16_f32 v51, v20, v21
v_lshlrev_b32 v20, 16, v204
v_and_b32 v21, s68, v204
v_add_f32 v20, 1.0, v20
v_add_f32 v21, 1.0, v21
v_cvt_pk_bf16_f32 v20, 0, v20
v_cvt_pk_bf16_f32 v21, 0, v21
v_mul_f32 v20, v20, v104
v_mul_f32 v21, v21, v105
v_cvt_pk_bf16_f32 v20, 0, v20
v_cvt_pk_bf16_f32 v21, 0, v21
v_lshlrev_b32 v22, 16, v196
v_and_b32 v23, s68, v196
v_add_f32 v20, v20, v22
v_add_f32 v21, v21, v23
v_cvt_pk_bf16_f32 v52, v20, v21
v_lshlrev_b32 v20, 16, v205
v_and_b32 v21, s68, v205
v_add_f32 v20, 1.0, v20
v_add_f32 v21, 1.0, v21
v_cvt_pk_bf16_f32 v20, 0, v20
v_cvt_pk_bf16_f32 v21, 0, v21
v_mul_f32 v20, v20, v106
v_mul_f32 v21, v21, v107
v_cvt_pk_bf16_f32 v20, 0, v20
v_cvt_pk_bf16_f32 v21, 0, v21
v_lshlrev_b32 v22, 16, v197
v_and_b32 v23, s68, v197
v_add_f32 v20, v20, v22
v_add_f32 v21, v21, v23
v_cvt_pk_bf16_f32 v53, v20, v21
v_lshlrev_b32 v20, 16, v206
v_and_b32 v21, s68, v206
v_add_f32 v20, 1.0, v20
v_add_f32 v21, 1.0, v21
v_cvt_pk_bf16_f32 v20, 0, v20
v_cvt_pk_bf16_f32 v21, 0, v21
v_mul_f32 v20, v20, v108
v_mul_f32 v21, v21, v109
v_cvt_pk_bf16_f32 v20, 0, v20
v_cvt_pk_bf16_f32 v21, 0, v21
v_lshlrev_b32 v22, 16, v198
v_and_b32 v23, s68, v198
v_add_f32 v20, v20, v22
v_add_f32 v21, v21, v23
v_cvt_pk_bf16_f32 v54, v20, v21
v_lshlrev_b32 v20, 16, v207
v_and_b32 v21, s68, v207
v_add_f32 v20, 1.0, v20
v_add_f32 v21, 1.0, v21
v_cvt_pk_bf16_f32 v20, 0, v20
v_cvt_pk_bf16_f32 v21, 0, v21
v_mul_f32 v20, v20, v110
v_mul_f32 v21, v21, v111
v_cvt_pk_bf16_f32 v20, 0, v20
v_cvt_pk_bf16_f32 v21, 0, v21
v_lshlrev_b32 v22, 16, v199
v_and_b32 v23, s68, v199
v_add_f32 v20, v20, v22
v_add_f32 v21, v21, v23
v_cvt_pk_bf16_f32 v55, v20, v21
L_g3:
s_cmp_ge_u32 s2, s73
s_cbranch_scc0 L_fl_153
s_waitcnt vmcnt(0)
v_cmp_eq_u32 vcc, 0, v31
s_cbranch_vccz L_fl_153
s_mov_b32 s75, 0
L_poll_154:
buffer_load_dword v31, v30, s[52:55], 0 offen offset:128 sc1
s_waitcnt vmcnt(0)
v_cmp_eq_u32 vcc, 0, v31
s_cbranch_vccz L_pollx_155
s_sleep 40
s_add_u32 s75, s75, 1
s_cmp_lt_u32 s75, 0x100000
s_cbranch_scc1 L_poll_154
L_pollx_155:
L_fl_153:
s_nop 1
v_mfma_f32_16x16x32_bf16 v[64:67], v[128:131], v[48:51], 0
v_mfma_f32_16x16x32_bf16 v[68:71], v[132:135], v[48:51], 0
v_mfma_f32_16x16x32_bf16 v[72:75], v[136:139], v[48:51], 0
v_mfma_f32_16x16x32_bf16 v[76:79], v[140:143], v[48:51], 0
v_mfma_f32_16x16x32_bf16 v[80:83], v[144:147], v[48:51], 0
v_mfma_f32_16x16x32_bf16 v[84:87], v[148:151], v[48:51], 0
v_mfma_f32_16x16x32_bf16 v[88:91], v[152:155], v[48:51], 0
v_mfma_f32_16x16x32_bf16 v[92:95], v[156:159], v[48:51], 0
v_mfma_f32_16x16x32_bf16 v[64:67], v[160:163], v[52:55], v[64:67]
v_mfma_f32_16x16x32_bf16 v[68:71], v[164:167], v[52:55], v[68:71]
v_mfma_f32_16x16x32_bf16 v[72:75], v[168:171], v[52:55], v[72:75]
v_mfma_f32_16x16x32_bf16 v[76:79], v[172:175], v[52:55], v[76:79]
v_mfma_f32_16x16x32_bf16 v[80:83], v[176:179], v[52:55], v[80:83]
v_mfma_f32_16x16x32_bf16 v[84:87], v[180:183], v[52:55], v[84:87]
v_mfma_f32_16x16x32_bf16 v[88:91], v[184:187], v[52:55], v[88:91]
v_mfma_f32_16x16x32_bf16 v[92:95], v[188:191], v[52:55], v[92:95]
v_and_b32 v20, 7, v0
v_mul_u32_u24 v20, 272, v20
v_and_b32 v21, 8, v0
v_lshl_add_u32 v20, v21, 3, v20
v_and_b32 v21, 48, v0
v_add_u32 v20, v20, v21
s_mul_i32 s64, s34, 8192
s_add_u32 s64, s64, 4096
v_add_u32 v20, s64, v20
s_nop 7
v_add_f32_dpp v24, v80, v64 row_ror:8 row_mask:0xf bank_mask:0x3
v_add_f32_dpp v24, v68, v84 row_ror:8 row_mask:0xf bank_mask:0xc
v_add_f32_dpp v25, v81, v65 row_ror:8 row_mask:0xf bank_mask:0x3
v_add_f32_dpp v25, v69, v85 row_ror:8 row_mask:0xf bank_mask:0xc
v_add_f32_dpp v26, v82, v66 row_ror:8 row_mask:0xf bank_mask:0x3
v_add_f32_dpp v26, v70, v86 row_ror:8 row_mask:0xf bank_mask:0xc
v_add_f32_dpp v27, v83, v67 row_ror:8 row_mask:0xf bank_mask:0x3
v_add_f32_dpp v27, v71, v87 row_ror:8 row_mask:0xf bank_mask:0xc
ds_write_b128 v20, v[24:27] offset:0
v_add_f32_dpp v28, v88, v72 row_ror:8 row_mask:0xf bank_mask:0x3
v_add_f32_dpp v28, v76, v92 row_ror:8 row_mask:0xf bank_mask:0xc
v_add_f32_dpp v29, v89, v73 row_ror:8 row_mask:0xf bank_mask:0x3
v_add_f32_dpp v29, v77, v93 row_ror:8 row_mask:0xf bank_mask:0xc
v_add_f32_dpp v30, v90, v74 row_ror:8 row_mask:0xf bank_mask:0x3
v_add_f32_dpp v30, v78, v94 row_ror:8 row_mask:0xf bank_mask:0xc
v_add_f32_dpp v31, v91, v75 row_ror:8 row_mask:0xf bank_mask:0x3
v_add_f32_dpp v31, v79, v95 row_ror:8 row_mask:0xf bank_mask:0xc
ds_write_b128 v20, v[28:31] offset:128
v_mov_b32 v20, 0
s_waitcnt lgkmcnt(0)
s_mov_b64 exec, 1
ds_add_u32 v20, v9 offset:320
s_mov_b64 exec, -1
s_cmp_eq_u32 s34, 0
s_cbranch_scc0 L_waitq
s_cmp_lt_u32 s2, 16
s_cbranch_scc0 L_gq2
v_and_b32 v21, 7, v0
v_lshrrev_b32 v22, 4, v0
v_and_b32 v23, 8, v0
v_lshrrev_b32 v23, 1, v23
v_add_u32 v22, v22, v23
v_mov_b32 v23, v1
s_lshl_b32 s64, s72, 10
s_add_u32 s64, s64, 0
s_branch L_g4
L_gq2:
v_lshrrev_b32 v21, 3, v0
v_and_b32 v22, 7, v0
s_mov_b32 s64, 10240
s_cmp_lt_u32 s2, 48
s_cselect_b32 s64, 22528, s64
s_mov_b32 s65, 12288
v_mul_lo_u32 v23, s65, v21
v_lshl_add_u32 v23, v22, 4, v23
s_lshl_b32 s66, s72, 7
s_add_u32 s64, s64, s66
L_g4:
v_mul_u32_u24 v21, 272, v21
v_lshl_add_u32 v21, v22, 5, v21
v_add_u32 v21, 4096, v21
s_mov_b32 s75, 0
L_poll_156:
ds_read_b32 v22, v20 offset:320
s_waitcnt lgkmcnt(0)
v_cmp_gt_u32 vcc, 4, v22
s_cbranch_vccz L_pollx_157
s_add_u32 s75, s75, 1
s_cmp_lt_u32 s75, 0x1000000
s_cbranch_scc1 L_poll_156
L_pollx_157:
ds_read_b128 v[64:67], v21 offset:0
ds_read_b128 v[68:71], v21 offset:16
ds_read_b128 v[72:75], v21 offset:8192
ds_read_b128 v[76:79], v21 offset:8208
ds_read_b128 v[80:83], v21 offset:16384
ds_read_b128 v[84:87], v21 offset:16400
ds_read_b128 v[88:91], v21 offset:24576
ds_read_b128 v[92:95], v21 offset:24592
s_waitcnt lgkmcnt(0)
v_add_f32 v64, v64, v72
v_add_f32 v65, v65, v73
v_add_f32 v66, v66, v74
v_add_f32 v67, v67, v75
v_add_f32 v68, v68, v76
v_add_f32 v69, v69, v77
v_add_f32 v70, v70, v78
v_add_f32 v71, v71, v79
v_add_f32 v64, v64, v80
v_add_f32 v65, v65, v81
v_add_f32 v66, v66, v82
v_add_f32 v67, v67, v83
v_add_f32 v68, v68, v84
v_add_f32 v69, v69, v85
v_add_f32 v70, v70, v86
v_add_f32 v71, v71, v87
v_add_f32 v64, v64, v88
v_add_f32 v65, v65, v89
v_add_f32 v66, v66, v90
v_add_f32 v67, v67, v91
v_add_f32 v68, v68, v92
v_add_f32 v69, v69, v93
v_add_f32 v70, v70, v94
v_add_f32 v71, v71, v95
v_cvt_pk_bf16_f32 v24, v64, v65
v_cvt_pk_bf16_f32 v25, v66, v67
v_cvt_pk_bf16_f32 v26, v68, v69
v_cvt_pk_bf16_f32 v27, v70, v71
v_min_u32 v24, -2, v24
v_min_u32 v25, -2, v25
v_min_u32 v26, -2, v26
v_min_u32 v27, -2, v27
buffer_store_dwordx4 v[24:27], v23, s[36:39], s64 offen sc1
s_branch L_waitq
L_jan:
v_mov_b32 v4, -1
v_mov_b32 v5, -1
v_mov_b32 v6, -1
v_mov_b32 v7, -1
s_lshl_b32 s67, s64, 2
s_add_u32 s67, s67, s34
s_cmp_lt_u32 s67, 32
s_cselect_b32 s66, 0, 933888
s_mul_i32 s65, s67, 3072
s_add_u32 s65, s65, s66
s_add_u32 s65, s65, 16384
v_add_u32 v8, s65, v1
global_store_dwordx4 v8, v[4:7], s[30:31] offset:0 sc1
global_store_dwordx4 v8, v[4:7], s[30:31] offset:1024 sc1
global_store_dwordx4 v8, v[4:7], s[30:31] offset:2048 sc1
s_and_b32 s66, s67, 64
s_add_u32 s67, s67, s66
s_lshl_b32 s67, s67, 7
s_add_u32 s67, s67, 1343488
v_and_b32 v8, 8, v0
v_lshlrev_b32 v8, 10, v8
v_and_b32 v10, 0x70, v1
v_add3_u32 v8, v8, v10, s67
s_mov_b64 exec, 0xffff
global_store_dwordx4 v8, v[4:7], s[30:31] sc1
s_mov_b64 exec, 1
s_load_dword s68, s[30:31], 0x48000
s_and_b32 s65, s34, 1
s_lshl_b32 s66, s65, 13
s_xor_b32 s67, s67, s66
s_xor_b32 s66, s67, 0x2000
s_waitcnt vmcnt(0) lgkmcnt(0)
s_mov_b64 exec, -1
s_cmp_eq_u32 s34, 3
s_cbranch_scc1 L_p0_158
s_cmp_eq_u32 s34, 0
s_cselect_b32 s62, s24, s10
s_cselect_b32 s63, s25, s11
s_cmp_eq_u32 s34, 2
s_cselect_b32 s62, s12, s62
s_cselect_b32 s63, s13, s63
global_load_dword v12, v38, s[62:63]
global_load_dword v13, v39, s[62:63]
L_p0_158:
s_mov_b64 exec, 1
s_mov_b32 s70, 0
s_load_dword s68, s[30:31], s67
L_race_159:
s_getreg_b32 s69, hwreg(HW_REG_IB_STS, 8, 4)
s_add_u32 s70, s70, 1
s_cmp_eq_u32 s69, 0
s_cbranch_scc0 L_race_159
s_waitcnt lgkmcnt(0)
s_mov_b32 s71, 0
s_load_dword s68, s[30:31], s66
L_race_160:
s_getreg_b32 s69, hwreg(HW_REG_IB_STS, 8, 4)
s_add_u32 s71, s71, 1
s_cmp_eq_u32 s69, 0
s_cbranch_scc0 L_race_160
s_waitcnt lgkmcnt(0)
s_cmp_lt_u32 s71, s70
s_cselect_b32 s70, 1, 0
s_xor_b32 s70, s70, s65
s_getreg_b32 s69, hwreg(HW_REG_XCC_ID, 2, 1)
s_xor_b32 s70, s70, s69
s_lshl_b32 s69, s69, 14
s_lshl_b32 s70, s70, 8
s_add_u32 s70, s70, s69
s_add_u32 s70, s70, 1
v_mov_b32 v9, s70
s_lshl_b32 s65, s64, 2
v_mov_b32 v8, s65
ds_add_rtn_u32 v11, v2, v9 offset:320
s_waitcnt lgkmcnt(0)
v_add_u32 v11, v11, v9
v_and_b32 v10, 0xff, v11
v_cmp_eq_u32 vcc, 4, v10
s_cbranch_vccz L_j_161
global_store_dword v8, v11, s[28:29] offset:128 sc1
L_j_161:
s_mov_b64 exec, -1
s_branch L_nop0
L_norole:
s_cmp_eq_u32 s74, -1
s_cbranch_scc1 L_waitq
L_waitq:
s_cmp_eq_u32 s74, -1
s_cselect_b64 vcc, 0, -1
s_cmp_lt_u32 s2, 112
s_cselect_b64 vcc, -1, vcc
s_mov_b32 s44, s12
s_mov_b32 s45, s13
s_mov_b32 s46, 0x400000
s_mov_b32 s47, 0x20000
v_lshrrev_b32 v18, 4, v0
v_and_b32 v16, 15, v0
v_xor_b32 v16, v16, v18
v_xor_b32 v17, 4, v16
v_lshlrev_b32 v19, 10, v18
v_lshl_add_u32 v22, v16, 4, v19
v_lshl_add_u32 v23, v17, 4, v19
v_and_b32 v19, 1, v18
v_lshlrev_b32 v19, 10, v19
v_lshrrev_b32 v18, 1, v18
v_lshl_add_u32 v18, v18, 11, v19
v_lshl_add_u32 v16, v16, 4, v18
v_lshl_add_u32 v17, v17, 4, v18
v_lshrrev_b32 v18, 4, v0
v_bfe_u32 v19, v0, 2, 2
v_and_b32 v20, 2, v0
v_lshlrev_b32 v20, 2, v20
v_xor_b32 v20, v20, v19
v_and_b32 v21, 1, v18
v_lshlrev_b32 v21, 2, v21
v_xor_b32 v20, v20, v21
v_lshlrev_b32 v20, 4, v20
v_lshl_add_u32 v20, v18, 10, v20
v_lshl_add_u32 v20, v19, 8, v20
v_and_b32 v21, 1, v0
v_lshl_add_u32 v20, v21, 3, v20
s_lshl_b32 s65, s34, 13
s_add_u32 s65, s65, 8192
v_add_u32 v40, s65, v20
v_xor_b32 v41, 16, v40
v_xor_b32 v42, 32, v40
v_xor_b32 v43, 48, v40
v_xor_b32 v44, 64, v40
v_xor_b32 v45, 80, v40
v_xor_b32 v46, 96, v40
v_xor_b32 v47, 112, v40
s_lshl_b32 s64, s33, 17
s_lshl_b32 s66, s34, 8
s_add_u32 s64, s64, s66
s_mov_b32 s68, 0
s_lshl_b32 s66, s68, 10
s_add_u32 s64, s64, s66
s_add_u32 m0, s65, 0
s_xor_b32 s66, s64, 0
buffer_load_dwordx4 v16, s[44:47], s66 offen  lds
s_add_u32 m0, s65, 1024
s_xor_b32 s66, s64, 8192
buffer_load_dwordx4 v17, s[44:47], s66 offen  lds
s_add_u32 m0, s65, 2048
s_xor_b32 s66, s64, 16384
buffer_load_dwordx4 v16, s[44:47], s66 offen  lds
s_waitcnt vmcnt(2)
s_add_u32 m0, s65, 3072
s_xor_b32 s66, s64, 24576
buffer_load_dwordx4 v17, s[44:47], s66 offen  lds
s_waitcnt vmcnt(2)
s_add_u32 m0, s65, 32768
s_xor_b32 s66, s64, 4096
buffer_load_dwordx4 v16, s[44:47], s66 offen  lds
s_waitcnt vmcnt(2)
s_add_u32 m0, s65, 33792
s_xor_b32 s66, s64, 12288
buffer_load_dwordx4 v17, s[44:47], s66 offen  lds
s_waitcnt vmcnt(2)
ds_read_b64_tr_b16 v[128:129], v40 offset:0
ds_read_b64_tr_b16 v[136:137], v41 offset:0
ds_read_b64_tr_b16 v[144:145], v42 offset:0
ds_read_b64_tr_b16 v[152:153], v43 offset:0
ds_read_b64_tr_b16 v[160:161], v44 offset:0
ds_read_b64_tr_b16 v[168:169], v45 offset:0
ds_read_b64_tr_b16 v[176:177], v46 offset:0
ds_read_b64_tr_b16 v[184:185], v47 offset:0
s_add_u32 m0, s65, 34816
s_xor_b32 s66, s64, 20480
buffer_load_dwordx4 v16, s[44:47], s66 offen  lds
s_waitcnt vmcnt(2)
s_add_u32 m0, s65, 35840
s_xor_b32 s66, s64, 28672
buffer_load_dwordx4 v17, s[44:47], s66 offen  lds
s_waitcnt vmcnt(2)
s_waitcnt lgkmcnt(0)
s_add_u32 m0, s65, 0
s_xor_b32 s66, s64, 32768
buffer_load_dwordx4 v16, s[44:47], s66 offen  lds
s_waitcnt vmcnt(2)
s_add_u32 m0, s65, 1024
s_xor_b32 s66, s64, 40960
buffer_load_dwordx4 v17, s[44:47], s66 offen  lds
s_waitcnt vmcnt(2)
ds_read_b64_tr_b16 v[130:131], v40 offset:32768
ds_read_b64_tr_b16 v[138:139], v41 offset:32768
ds_read_b64_tr_b16 v[146:147], v42 offset:32768
ds_read_b64_tr_b16 v[154:155], v43 offset:32768
ds_read_b64_tr_b16 v[162:163], v44 offset:32768
ds_read_b64_tr_b16 v[170:171], v45 offset:32768
ds_read_b64_tr_b16 v[178:179], v46 offset:32768
ds_read_b64_tr_b16 v[186:187], v47 offset:32768
s_add_u32 m0, s65, 2048
s_xor_b32 s66, s64, 49152
buffer_load_dwordx4 v16, s[44:47], s66 offen  lds
s_waitcnt vmcnt(2)
s_add_u32 m0, s65, 3072
s_xor_b32 s66, s64, 57344
buffer_load_dwordx4 v17, s[44:47], s66 offen  lds
s_waitcnt vmcnt(2)
s_waitcnt lgkmcnt(0)
s_add_u32 m0, s65, 32768
s_xor_b32 s66, s64, 36864
buffer_load_dwordx4 v16, s[44:47], s66 offen  lds
s_waitcnt vmcnt(2)
s_add_u32 m0, s65, 33792
s_xor_b32 s66, s64, 45056
buffer_load_dwordx4 v17, s[44:47], s66 offen  lds
s_waitcnt vmcnt(2)
ds_read_b64_tr_b16 v[132:133], v40 offset:0
ds_read_b64_tr_b16 v[140:141], v41 offset:0
ds_read_b64_tr_b16 v[148:149], v42 offset:0
ds_read_b64_tr_b16 v[156:157], v43 offset:0
ds_read_b64_tr_b16 v[164:165], v44 offset:0
ds_read_b64_tr_b16 v[172:173], v45 offset:0
ds_read_b64_tr_b16 v[180:181], v46 offset:0
ds_read_b64_tr_b16 v[188:189], v47 offset:0
s_add_u32 m0, s65, 34816
s_xor_b32 s66, s64, 53248
buffer_load_dwordx4 v16, s[44:47], s66 offen  lds
s_waitcnt vmcnt(2)
s_add_u32 m0, s65, 35840
s_xor_b32 s66, s64, 61440
buffer_load_dwordx4 v17, s[44:47], s66 offen  lds
s_waitcnt vmcnt(2)
s_waitcnt lgkmcnt(0)
s_add_u32 m0, s65, 0
s_xor_b32 s66, s64, 65536
buffer_load_dwordx4 v16, s[44:47], s66 offen  lds
s_waitcnt vmcnt(2)
s_add_u32 m0, s65, 1024
s_xor_b32 s66, s64, 73728
buffer_load_dwordx4 v17, s[44:47], s66 offen  lds
s_waitcnt vmcnt(2)
ds_read_b64_tr_b16 v[134:135], v40 offset:32768
ds_read_b64_tr_b16 v[142:143], v41 offset:32768
ds_read_b64_tr_b16 v[150:151], v42 offset:32768
ds_read_b64_tr_b16 v[158:159], v43 offset:32768
ds_read_b64_tr_b16 v[166:167], v44 offset:32768
ds_read_b64_tr_b16 v[174:175], v45 offset:32768
ds_read_b64_tr_b16 v[182:183], v46 offset:32768
ds_read_b64_tr_b16 v[190:191], v47 offset:32768
s_add_u32 m0, s65, 2048
s_xor_b32 s66, s64, 81920
buffer_load_dwordx4 v16, s[44:47], s66 offen  lds
s_waitcnt vmcnt(2)
s_add_u32 m0, s65, 3072
s_xor_b32 s66, s64, 90112
buffer_load_dwordx4 v17, s[44:47], s66 offen  lds
s_waitcnt vmcnt(2)
s_waitcnt lgkmcnt(0)
s_add_u32 m0, s65, 32768
s_xor_b32 s66, s64, 69632
buffer_load_dwordx4 v16, s[44:47], s66 offen  lds
s_waitcnt vmcnt(2)
s_add_u32 m0, s65, 33792
s_xor_b32 s66, s64, 77824
buffer_load_dwordx4 v17, s[44:47], s66 offen  lds
s_waitcnt vmcnt(2)
ds_read_b64_tr_b16 v[192:193], v40 offset:0
ds_read_b64_tr_b16 v[200:201], v41 offset:0
ds_read_b64_tr_b16 v[208:209], v42 offset:0
ds_read_b64_tr_b16 v[216:217], v43 offset:0
ds_read_b64_tr_b16 v[224:225], v44 offset:0
ds_read_b64_tr_b16 v[232:233], v45 offset:0
ds_read_b64_tr_b16 v[240:241], v46 offset:0
ds_read_b64_tr_b16 v[248:249], v47 offset:0
s_add_u32 m0, s65, 34816
s_xor_b32 s66, s64, 86016
buffer_load_dwordx4 v16, s[44:47], s66 offen  lds
s_waitcnt vmcnt(2)
s_add_u32 m0, s65, 35840
s_xor_b32 s66, s64, 94208
buffer_load_dwordx4 v17, s[44:47], s66 offen  lds
s_waitcnt vmcnt(2)
s_waitcnt lgkmcnt(0)
s_add_u32 m0, s65, 0
s_xor_b32 s66, s64, 98304
buffer_load_dwordx4 v16, s[44:47], s66 offen  lds
s_waitcnt vmcnt(2)
s_add_u32 m0, s65, 1024
s_xor_b32 s66, s64, 106496
buffer_load_dwordx4 v17, s[44:47], s66 offen  lds
s_waitcnt vmcnt(2)
ds_read_b64_tr_b16 v[194:195], v40 offset:32768
ds_read_b64_tr_b16 v[202:203], v41 offset:32768
ds_read_b64_tr_b16 v[210:211], v42 offset:32768
ds_read_b64_tr_b16 v[218:219], v43 offset:32768
ds_read_b64_tr_b16 v[226:227], v44 offset:32768
ds_read_b64_tr_b16 v[234:235], v45 offset:32768
ds_read_b64_tr_b16 v[242:243], v46 offset:32768
ds_read_b64_tr_b16 v[250:251], v47 offset:32768
v_and_b32 v24, 127, v2
buffer_load_dword v25, v24, s[52:55], 0 offen offset:128
s_add_u32 m0, s65, 2048
s_xor_b32 s66, s64, 114688
buffer_load_dwordx4 v16, s[44:47], s66 offen  lds
s_waitcnt vmcnt(2)
s_add_u32 m0, s65, 3072
s_xor_b32 s66, s64, 122880
buffer_load_dwordx4 v17, s[44:47], s66 offen  lds
s_waitcnt vmcnt(2)
s_waitcnt lgkmcnt(0)
s_add_u32 m0, s65, 32768
s_xor_b32 s66, s64, 102400
buffer_load_dwordx4 v16, s[44:47], s66 offen  lds
s_waitcnt vmcnt(2)
s_add_u32 m0, s65, 33792
s_xor_b32 s66, s64, 110592
buffer_load_dwordx4 v17, s[44:47], s66 offen  lds
s_waitcnt vmcnt(2)
ds_read_b64_tr_b16 v[196:197], v40 offset:0
ds_read_b64_tr_b16 v[204:205], v41 offset:0
ds_read_b64_tr_b16 v[212:213], v42 offset:0
ds_read_b64_tr_b16 v[220:221], v43 offset:0
ds_read_b64_tr_b16 v[228:229], v44 offset:0
ds_read_b64_tr_b16 v[236:237], v45 offset:0
ds_read_b64_tr_b16 v[244:245], v46 offset:0
ds_read_b64_tr_b16 v[252:253], v47 offset:0
s_add_u32 m0, s65, 34816
s_xor_b32 s66, s64, 118784
buffer_load_dwordx4 v16, s[44:47], s66 offen  lds
s_waitcnt vmcnt(2)
s_add_u32 m0, s65, 35840
s_xor_b32 s66, s64, 126976
buffer_load_dwordx4 v17, s[44:47], s66 offen  lds
s_waitcnt vmcnt(0)
ds_read_b64_tr_b16 v[198:199], v40 offset:32768
ds_read_b64_tr_b16 v[206:207], v41 offset:32768
ds_read_b64_tr_b16 v[214:215], v42 offset:32768
ds_read_b64_tr_b16 v[222:223], v43 offset:32768
ds_read_b64_tr_b16 v[230:231], v44 offset:32768
ds_read_b64_tr_b16 v[238:239], v45 offset:32768
ds_read_b64_tr_b16 v[246:247], v46 offset:32768
ds_read_b64_tr_b16 v[254:255], v47 offset:32768
s_waitcnt lgkmcnt(0)
v_cmp_eq_u32 vcc, 0, v25
s_cbranch_vccz L_tab_162
s_mov_b32 s75, 0
L_poll_163:
buffer_load_dword v25, v24, s[52:55], 0 offen offset:128 sc1
s_waitcnt vmcnt(0)
v_cmp_eq_u32 vcc, 0, v25
s_cbranch_vccz L_pollx_164
s_sleep 40
s_add_u32 s75, s75, 1
s_cmp_lt_u32 s75, 0x100000
s_cbranch_scc1 L_poll_163
L_pollx_164:
L_tab_162:
v_bfe_u32 v26, v25, 8, 3
v_lshrrev_b32 v25, 16, v25
s_nop 0
v_add_u32_dpp v26, v26, v26 quad_perm:[1,0,3,2] row_mask:0xf bank_mask:0xf
s_nop 1
v_add_u32_dpp v26, v26, v26 quad_perm:[2,3,0,1] row_mask:0xf bank_mask:0xf
s_nop 1
v_add_u32_dpp v26, v26, v26 row_ror:4 row_mask:0xf bank_mask:0xf
s_nop 1
v_add_u32_dpp v26, v26, v26 row_ror:8 row_mask:0xf bank_mask:0xf
s_nop 1
v_readlane_b32 s66, v26, 0
v_readlane_b32 s71, v26, 16
s_add_u32 s66, s66, s71
s_cmp_gt_u32 s66, 64
s_cselect_b32 s66, 1, 0
v_cmp_ne_u32 vcc, s66, v25
s_and_b32 s71, vcc_lo, 0xff
s_bcnt0_i32_b32 s66, s71
s_sub_u32 s66, s66, 24
v_mbcnt_lo_u32_b32 v24, s71, 0
v_sub_u32 v25, v0, v24
v_add_u32 v24, s66, v24
v_cndmask_b32 v24, v25, v24, vcc
v_bfe_u32 v25, v24, 1, 2
v_and_b32 v26, 1, v24
v_lshl_or_b32 v25, v26, 2, v25
v_lshlrev_b32 v25, v2, v25
s_nop 1
v_or_b32_dpp v25, v25, v25 quad_perm:[1,0,3,2] row_mask:0xf bank_mask:0xf
s_nop 1
v_or_b32_dpp v25, v25, v25 quad_perm:[2,3,0,1] row_mask:0xf bank_mask:0xf
s_nop 1
v_or_b32_dpp v25, v25, v25 row_shl:4 row_mask:0xf bank_mask:0xf
s_nop 1
v_readfirstlane_b32 s35, v25
s_mov_b64 exec, 1
ds_write_b32 v2, v25 offset:328
s_mov_b64 exec, -1
s_sub_u32 s64, s2, 144
s_cmp_lt_u32 s64, 64
s_cbranch_scc0 L_rp_165
s_cmp_eq_u32 s34, 0
s_cbranch_scc0 L_rp_165
s_mov_b32 s48, s4
s_mov_b32 s49, s5
s_mov_b32 s50, 0x2000
s_mov_b32 s51, 0x20000
v_and_b32 v5, 15, v0
v_and_b32 v6, 16, v0
v_lshl_add_u32 v5, v6, 1, v5
v_and_b32 v6, 32, v0
v_lshrrev_b32 v6, 1, v6
v_add_u32 v5, v5, v6
v_lshlrev_b32 v5, 1, v5
v_and_b32 v6, 0x7c, v5
s_lshl_b32 s65, s64, 7
s_and_b32 s66, s65, 0x380
s_lshr_b32 s64, s64, 3
s_mul_i32 s64, s64, 12288
s_add_u32 s64, s64, s66
s_add_u32 s64, s64, 24576
buffer_load_ushort v18, v5, s[48:51], s65 offen
s_mov_b32 s75, 0
L_poll_166:
buffer_load_dword v19, v6, s[36:39], s64 offen offset:0 sc1
buffer_load_dword v20, v6, s[36:39], s64 offen offset:3072 sc1
s_waitcnt vmcnt(0)
v_max_u32 v16, v19, v20
v_cmp_eq_u32 vcc, -1, v16
s_cbranch_vccz L_pollx_167
s_sleep 40
s_add_u32 s75, s75, 1
s_cmp_lt_u32 s75, 0x100000
s_cbranch_scc1 L_poll_166
L_pollx_167:
v_and_b32 v16, 1, v0
v_lshlrev_b32 v16, 4, v16
v_xor_b32 v16, 16, v16
v_lshlrev_b32 v18, 16, v18
v_lshlrev_b32 v19, v16, v19
v_and_b32 v19, 0xffff0000, v19
v_lshlrev_b32 v20, v16, v20
v_and_b32 v20, 0xffff0000, v20
ds_write_b32 v2, v18 offset:4096
ds_write_b32 v2, v19 offset:4352
ds_write_b32 v2, v20 offset:4608
L_rp_165:
v_lshlrev_b32 v10, 3, v0
s_lshl_b32 s64, s34, 8
s_add_u32 s64, s64, 2560
s_lshr_b32 s66, s68, 1
v_xor_b32 v12, s66, v0
v_mov_b32 v14, 0
v_bfe_u32 v11, v12, 0, 1
v_lshl_or_b32 v14, v11, 0, v14
v_bfe_u32 v11, v12, 1, 1
v_lshl_or_b32 v14, v11, 1, v14
v_bfe_u32 v11, v12, 2, 1
v_lshl_or_b32 v14, v11, 2, v14
v_bfe_u32 v11, v12, 3, 1
v_lshl_or_b32 v14, v11, 3, v14
v_bfe_u32 v11, v12, 4, 1
v_lshl_or_b32 v14, v11, 4, v14
v_bfe_u32 v11, v12, 5, 1
v_lshl_or_b32 v14, v11, 5, v14
v_and_b32 v11, 0x38, v14
v_and_b32 v12, 1, v14
v_lshl_add_u32 v11, v12, 2, v11
v_bfe_u32 v12, v14, 1, 2
v_add_u32 v11, v11, v12
v_lshl_add_u32 v11, v11, 2, s64
v_and_b32 v14, 1, v0
v_and_b32 v12, 48, v0
v_lshlrev_b32 v12, 1, v12
v_lshl_add_u32 v12, v14, 4, v12
v_add_u32 v12, s64, v12
v_mul_u32_u24 v15, 0xaaaa, v14
v_add_u32 v15, 0x4444, v15
v_mov_b32 v64, 0
v_mov_b32 v65, 0
v_mov_b32 v66, 0
v_mov_b32 v67, 0
v_mov_b32 v68, 0
v_mov_b32 v69, 0
v_mov_b32 v70, 0
v_mov_b32 v71, 0
v_mov_b32 v72, 0
v_mov_b32 v73, 0
v_mov_b32 v74, 0
v_mov_b32 v75, 0
v_mov_b32 v76, 0
v_mov_b32 v77, 0
v_mov_b32 v78, 0
v_mov_b32 v79, 0
v_mov_b32 v80, 0
v_mov_b32 v81, 0
v_mov_b32 v82, 0
v_mov_b32 v83, 0
v_mov_b32 v84, 0
v_mov_b32 v85, 0
v_mov_b32 v86, 0
v_mov_b32 v87, 0
v_mov_b32 v88, 0
v_mov_b32 v89, 0
v_mov_b32 v90, 0
v_mov_b32 v91, 0
v_mov_b32 v92, 0
v_mov_b32 v93, 0
v_mov_b32 v94, 0
v_mov_b32 v95, 0
s_lshl_b32 s64, s34, 3
s_lshr_b32 s64, s35, s64
v_bfe_u32 v13, v0, 3, 1
v_lshlrev_b32 v13, 2, v13
v_bfe_u32 v13, s64, v13, 3
v_and_b32 v14, 0x70, v1
v_lshl_add_u32 v13, v13, 12, v14
s_lshl_b32 s64, s34, 2
s_add_u32 s64, s64, s33
v_bfe_u32 v14, v0, 3, 1
v_lshl_add_u32 v14, v14, 1, s64
v_and_b32 v14, 31, v14
v_lshl_add_u32 v13, v14, 7, v13
s_lshl_b32 s69, s32, 15
s_add_u32 s69, s69, 1048576
s_waitcnt vmcnt(0) lgkmcnt(0)
s_barrier
ds_read_b64 v[20:21], v10 offset:512
ds_read_b64 v[22:23], v10 offset:1024
ds_read_b64 v[24:25], v10 offset:1536
ds_read_b64 v[26:27], v10 offset:2048
s_waitcnt lgkmcnt(2)
v_pk_add_f32 v[20:21], v[20:21], v[22:23]
s_waitcnt lgkmcnt(1)
v_pk_add_f32 v[20:21], v[20:21], v[24:25]
s_waitcnt lgkmcnt(0)
v_pk_add_f32 v[20:21], v[20:21], v[26:27]
v_cvt_pk_bf16_f32 v20, v20, v21
ds_write_b32 v11, v20
ds_read_b128 v[48:51], v12 offset:0
ds_read_b128 v[52:55], v12 offset:128
s_waitcnt lgkmcnt(1)
v_smfmac_f32_16x16x64_bf16 v[64:67], v[48:51], v[128:135], v15
v_smfmac_f32_16x16x64_bf16 v[68:71], v[48:51], v[136:143], v15
v_smfmac_f32_16x16x64_bf16 v[72:75], v[48:51], v[144:151], v15
v_smfmac_f32_16x16x64_bf16 v[76:79], v[48:51], v[152:159], v15
s_waitcnt lgkmcnt(0)
v_smfmac_f32_16x16x64_bf16 v[64:67], v[52:55], v[192:199], v15
v_smfmac_f32_16x16x64_bf16 v[68:71], v[52:55], v[200:207], v15
v_smfmac_f32_16x16x64_bf16 v[72:75], v[52:55], v[208:215], v15
v_smfmac_f32_16x16x64_bf16 v[76:79], v[52:55], v[216:223], v15
v_smfmac_f32_16x16x64_bf16 v[80:83], v[48:51], v[160:167], v15
v_smfmac_f32_16x16x64_bf16 v[84:87], v[48:51], v[168:175], v15
v_smfmac_f32_16x16x64_bf16 v[88:91], v[48:51], v[176:183], v15
v_smfmac_f32_16x16x64_bf16 v[92:95], v[48:51], v[184:191], v15
v_smfmac_f32_16x16x64_bf16 v[80:83], v[52:55], v[224:231], v15
v_add_f32 v64, v64, v65
v_smfmac_f32_16x16x64_bf16 v[84:87], v[52:55], v[232:239], v15
v_add_f32 v68, v68, v69
v_add_f32 v72, v72, v73
v_smfmac_f32_16x16x64_bf16 v[88:91], v[52:55], v[240:247], v15
v_add_f32 v76, v76, v77
v_cvt_pk_bf16_f32 v20, v64, v68
v_smfmac_f32_16x16x64_bf16 v[92:95], v[52:55], v[248:255], v15
v_cvt_pk_bf16_f32 v21, v72, v76
v_add_f32 v80, v80, v81
s_mov_b64 exec, 0xffff
v_add_f32 v84, v84, v85
v_cvt_pk_bf16_f32 v22, v80, v84
s_nop 0
v_add_f32 v88, v88, v89
s_nop 0
v_add_f32 v92, v92, v93
v_cvt_pk_bf16_f32 v23, v88, v92
buffer_store_dwordx4 v[20:23], v13, s[36:39], s69 offen sc1
s_mov_b64 exec, -1
s_sub_u32 s67, s2, 16
s_cmp_lt_u32 s67, 128
s_cbranch_scc0 L_nogp
s_and_b32 s66, s2, 7
s_min_u32 s64, s66, 3
s_mul_i32 s71, s66, 5
s_add_u32 s64, s64, s71
s_cmp_lt_u32 s66, 3
s_cselect_b32 s66, 5, 4
v_and_b32 v8, 7, v0
v_min_u32 v8, s66, v8
v_add_u32 v8, s64, v8
s_and_b32 s64, s67, 0xf8
s_lshl_b32 s64, s64, 2
s_lshl_b32 s66, s34, 3
s_add_u32 s64, s64, s66
v_lshrrev_b32 v9, 3, v0
v_add_u32 v9, s64, v9
v_mul_u32_u24 v9, 2752, v9
v_lshl_add_u32 v8, v8, 6, v9
global_load_dword v10, v8, s[16:17]
global_load_dword v11, v8, s[18:19]
s_and_b32 s66, s2, 7
s_min_u32 s70, s66, 3
s_mul_i32 s71, s66, 5
s_add_u32 s70, s70, s71
s_cmp_lt_u32 s66, 3
s_cselect_b32 s66, 6, 5
s_lshl_b32 s66, s66, 8
s_sub_u32 s66, s66, 1
s_lshr_b32 s71, s67, 3
s_lshl_b32 s71, s71, 2
s_add_u32 s71, s71, s34
s_mul_i32 s71, s71, 24
v_min_u32 v12, 23, v0
v_add_u32 v12, s71, v12
v_min_u32 v12, s66, v12
s_lshl_b32 s70, s70, 15
v_lshl_add_u32 v12, v12, 7, s70
global_load_dword v13, v12, s[20:21]
s_endpgm
L_nogp:
L_tail_s:
s_cmp_eq_u32 s74, -1
s_cbranch_scc0 L_ffn
s_cmp_eq_u32 s3, 0
s_cbranch_scc0 L_fin
s_sub_u32 s70, s2, 144
s_cmp_lt_u32 s70, 64
s_cbranch_scc0 L_fin
s_lshl_b32 s64, s70, 2
s_lshr_b32 s67, s35, s64
s_and_b32 s71, s67, 7
s_andn2_b32 s66, s70, 7
s_add_u32 s66, s66, s71
s_lshl_b32 s66, s66, 12
s_add_u32 s66, s66, 1048576
buffer_load_dwordx4 v[16:19], v1, s[36:39], s66 offen offset:0 sc1
buffer_load_dwordx4 v[20:23], v1, s[36:39], s66 offen offset:1024 sc1
buffer_load_dwordx4 v[24:27], v1, s[36:39], s66 offen offset:2048 sc1
buffer_load_dwordx4 v[28:31], v1, s[36:39], s66 offen offset:3072 sc1
v_mov_b32 v32, -1
v_mov_b32 v33, -1
v_mov_b32 v34, -1
v_mov_b32 v35, -1
s_and_b32 s64, s71, 6
s_lshl_b32 s64, s64, 12
s_and_b32 s65, s71, 1
s_lshl_b32 s65, s65, 15
s_or_b32 s64, s64, s65
s_lshr_b32 s65, s70, 3
s_lshl_b32 s65, s65, 16
s_add_u32 s64, s64, s65
s_lshr_b32 s65, s70, 4
s_lshl_b32 s65, s65, 2
s_and_b32 s67, s70, 7
s_add_u32 s65, s65, s67
s_lshl_b32 s65, s65, 7
s_add_u32 s64, s64, s65
s_add_u32 s64, s64, 1376256
s_add_u32 s65, s64, 4096
buffer_store_dwordx4 v[32:35], v1, s[36:39], s64 offen offset:0 sc1
buffer_store_dwordx4 v[32:35], v1, s[36:39], s64 offen offset:1024 sc1
buffer_store_dwordx4 v[32:35], v1, s[36:39], s64 offen offset:2048 sc1
buffer_store_dwordx4 v[32:35], v1, s[36:39], s64 offen offset:3072 sc1
buffer_store_dwordx4 v[32:35], v1, s[36:39], s65 offen offset:0 sc1
s_mov_b64 exec, 0xffffff
buffer_store_dwordx4 v[32:35], v1, s[36:39], s65 offen offset:1024 sc1
s_mov_b64 exec, -1
v_lshlrev_b32 v2, 2, v0
ds_read_b32 v8, v2 offset:4096
ds_read_b32 v9, v2 offset:4352
ds_read_b32 v10, v2 offset:4608
s_mov_b32 s56, s26
s_mov_b32 s57, s27
s_mov_b32 s58, 0x2000
s_mov_b32 s59, 0x20000
v_and_b32 v5, 15, v0
v_and_b32 v6, 16, v0
v_lshl_add_u32 v5, v6, 1, v5
v_and_b32 v6, 32, v0
v_lshrrev_b32 v6, 1, v6
v_add_u32 v5, v5, v6
v_lshlrev_b32 v5, 1, v5
v_and_b32 v6, 0x7c, v5
s_lshl_b32 s73, s70, 7
v_and_b32 v11, 1, v0
v_lshlrev_b32 v3, 4, v11
v_mov_b32 v7, 0x3f80
v_lshlrev_b32 v7, v3, v7
v_and_b32 v2, 4, v0
v_cmp_eq_u32 vcc, 0, v2
v_bfe_u32 v2, v0, 1, 1
v_mul_u32_u24 v43, 0xaaaa, v2
v_add_u32 v43, 0x4444, v43
v_cndmask_b32 v44, 0, v7, vcc
v_sub_u32 v45, v7, v44
v_mov_b32 v46, v44
v_mov_b32 v47, v45
v_mov_b32 v48, 0
v_mov_b32 v49, 0
v_mov_b32 v50, 0
v_mov_b32 v51, 0
v_mov_b32 v52, 0
v_mov_b32 v53, 0
v_mov_b32 v54, 0
v_mov_b32 v55, 0
s_add_u32 s68, s73, 1310720
s_mov_b32 s76, 0xaaaaaaaa
s_mov_b32 s77, 0xaaaaaaaa
v_cmp_gt_u32 vcc, 24, v0
v_mov_b32 v41, 0x40000000
v_lshl_add_u32 v12, v11, 13, v6
v_cndmask_b32 v41, v41, v1, vcc
s_mov_b32 s75, 0
s_waitcnt vmcnt(0) lgkmcnt(0)
buffer_load_dwordx4 v[16:19], v1, s[36:39], s66 offen offset:0 sc1
buffer_load_dwordx4 v[20:23], v1, s[36:39], s66 offen offset:1024 sc1
buffer_load_dwordx4 v[24:27], v1, s[36:39], s66 offen offset:2048 sc1
buffer_load_dwordx4 v[28:31], v1, s[36:39], s66 offen offset:3072 sc1
s_sleep 1
buffer_load_dwordx4 v[16:19], v1, s[36:39], s66 offen offset:0 sc1
buffer_load_dwordx4 v[20:23], v1, s[36:39], s66 offen offset:1024 sc1
buffer_load_dwordx4 v[24:27], v1, s[36:39], s66 offen offset:2048 sc1
buffer_load_dwordx4 v[28:31], v1, s[36:39], s66 offen offset:3072 sc1
s_sleep 1
buffer_load_dwordx4 v[16:19], v1, s[36:39], s66 offen offset:0 sc1
buffer_load_dwordx4 v[20:23], v1, s[36:39], s66 offen offset:1024 sc1
buffer_load_dwordx4 v[24:27], v1, s[36:39], s66 offen offset:2048 sc1
buffer_load_dwordx4 v[28:31], v1, s[36:39], s66 offen offset:3072 sc1
s_sleep 1
L_rn_170:
v_smfmac_f32_16x16x64_bf16 v[48:51], v[44:47], v[16:23], v43
v_smfmac_f32_16x16x64_bf16 v[48:51], v[44:47], v[24:31], v43
buffer_load_dwordx4 v[16:19], v1, s[36:39], s66 offen offset:0 sc1
buffer_load_dwordx4 v[20:23], v1, s[36:39], s66 offen offset:1024 sc1
buffer_load_dwordx4 v[24:27], v1, s[36:39], s66 offen offset:2048 sc1
buffer_load_dwordx4 v[28:31], v1, s[36:39], s66 offen offset:3072 sc1
s_add_u32 s75, s75, 1
s_and_b32 s78, s75, 15
s_nop 1
v_add_f32_dpp v13, v48, v48 row_ror:8 row_mask:0x3 bank_mask:0x3
v_add_f32_dpp v13, v49, v49 row_ror:8 row_mask:0x3 bank_mask:0xc
v_add_f32_dpp v13, v50, v50 row_ror:8 row_mask:0xc bank_mask:0x3
v_add_f32_dpp v13, v51, v51 row_ror:8 row_mask:0xc bank_mask:0xc
v_cmp_u_f32 vcc, v13, v13
s_cbranch_vccz L_rz_171
v_mov_b32 v48, 0
v_mov_b32 v49, 0
v_mov_b32 v50, 0
v_mov_b32 v51, 0
s_waitcnt vmcnt(12)
s_cbranch_scc1 L_rn_170
v_max3_u32 v2, v16, v17, v18
v_max3_u32 v2, v2, v19, v20
v_max3_u32 v2, v2, v21, v22
v_max3_u32 v2, v2, v23, v24
v_max3_u32 v2, v2, v25, v26
v_max3_u32 v2, v2, v27, v28
v_max3_u32 v2, v2, v29, v30
v_max_u32 v2, v2, v31
v_cmp_eq_u32 vcc, -1, v2
s_cbranch_vccz L_rx_169
s_cmp_lt_u32 s75, 0x100000
s_cbranch_scc1 L_rn_170
L_rx_169:
v_smfmac_f32_16x16x64_bf16 v[48:51], v[44:47], v[16:23], v43
v_smfmac_f32_16x16x64_bf16 v[48:51], v[44:47], v[24:31], v43
s_nop 7
v_add_f32_dpp v13, v48, v48 row_ror:8 row_mask:0x3 bank_mask:0x3
v_add_f32_dpp v13, v49, v49 row_ror:8 row_mask:0x3 bank_mask:0xc
v_add_f32_dpp v13, v50, v50 row_ror:8 row_mask:0xc bank_mask:0x3
v_add_f32_dpp v13, v51, v51 row_ror:8 row_mask:0xc bank_mask:0xc
L_rz_171:
v_fmac_f32 v8, v13, v9
s_nop 1
v_mov_b32_dpp v14, v8 quad_perm:[1,1,3,3] row_mask:0xf bank_mask:0xf
v_mov_b32_dpp v13, v8 quad_perm:[0,0,2,2] row_mask:0xf bank_mask:0xf
v_cvt_pk_bf16_f32 v13, v13, v14
buffer_store_dword v13, v12, s[36:39], s68 offen sc1
v_cvt_pk_bf16_f32 v8, 0, v8
buffer_load_dwordx4 v[64:67], v1, s[36:39], s64 offen offset:0 sc1
buffer_load_dwordx4 v[68:71], v1, s[36:39], s64 offen offset:1024 sc1
buffer_load_dwordx4 v[72:75], v1, s[36:39], s64 offen offset:2048 sc1
buffer_load_dwordx4 v[76:79], v1, s[36:39], s64 offen offset:3072 sc1
buffer_load_dwordx4 v[80:83], v1, s[36:39], s65 offen offset:0 sc1
buffer_load_dwordx4 v[84:87], v41, s[36:39], s65 offen offset:1024 sc1
s_mov_b32 s75, 0
s_waitcnt vmcnt(0)
buffer_load_dwordx4 v[64:67], v1, s[36:39], s64 offen offset:0 sc1
buffer_load_dwordx4 v[68:71], v1, s[36:39], s64 offen offset:1024 sc1
buffer_load_dwordx4 v[72:75], v1, s[36:39], s64 offen offset:2048 sc1
buffer_load_dwordx4 v[76:79], v1, s[36:39], s64 offen offset:3072 sc1
buffer_load_dwordx4 v[80:83], v1, s[36:39], s65 offen offset:0 sc1
buffer_load_dwordx4 v[84:87], v41, s[36:39], s65 offen offset:1024 sc1
s_sleep 1
buffer_load_dwordx4 v[64:67], v1, s[36:39], s64 offen offset:0 sc1
buffer_load_dwordx4 v[68:71], v1, s[36:39], s64 offen offset:1024 sc1
buffer_load_dwordx4 v[72:75], v1, s[36:39], s64 offen offset:2048 sc1
buffer_load_dwordx4 v[76:79], v1, s[36:39], s64 offen offset:3072 sc1
buffer_load_dwordx4 v[80:83], v1, s[36:39], s65 offen offset:0 sc1
buffer_load_dwordx4 v[84:87], v41, s[36:39], s65 offen offset:1024 sc1
s_sleep 1
L_rn_174:
v_smfmac_f32_16x16x64_bf16 v[52:55], v[44:47], v[64:71], v43
v_smfmac_f32_16x16x64_bf16 v[52:55], v[44:47], v[72:79], v43
v_smfmac_f32_16x16x64_bf16 v[52:55], v[44:47], v[80:87], v43
buffer_load_dwordx4 v[64:67], v1, s[36:39], s64 offen offset:0 sc1
buffer_load_dwordx4 v[68:71], v1, s[36:39], s64 offen offset:1024 sc1
buffer_load_dwordx4 v[72:75], v1, s[36:39], s64 offen offset:2048 sc1
buffer_load_dwordx4 v[76:79], v1, s[36:39], s64 offen offset:3072 sc1
buffer_load_dwordx4 v[80:83], v1, s[36:39], s65 offen offset:0 sc1
buffer_load_dwordx4 v[84:87], v41, s[36:39], s65 offen offset:1024 sc1
s_add_u32 s75, s75, 1
s_and_b32 s78, s75, 15
v_add_f32_dpp v13, v52, v52 row_ror:8 row_mask:0x3 bank_mask:0x3
v_add_f32_dpp v13, v53, v53 row_ror:8 row_mask:0x3 bank_mask:0xc
v_add_f32_dpp v13, v54, v54 row_ror:8 row_mask:0xc bank_mask:0x3
v_add_f32_dpp v13, v55, v55 row_ror:8 row_mask:0xc bank_mask:0xc
v_cmp_u_f32 vcc, v13, v13
s_cbranch_vccz L_rz_175
v_mov_b32 v52, 0
v_mov_b32 v53, 0
v_mov_b32 v54, 0
v_mov_b32 v55, 0
s_waitcnt vmcnt(12)
s_cbranch_scc1 L_rn_174
v_max3_u32 v2, v64, v65, v66
v_max3_u32 v2, v2, v67, v68
v_max3_u32 v2, v2, v69, v70
v_max3_u32 v2, v2, v71, v72
v_max3_u32 v2, v2, v73, v74
v_max3_u32 v2, v2, v75, v76
v_max3_u32 v2, v2, v77, v78
v_max3_u32 v2, v2, v79, v80
v_max3_u32 v2, v2, v81, v82
v_max3_u32 v2, v2, v83, v84
v_max3_u32 v2, v2, v85, v86
v_max_u32 v2, v2, v87
v_cmp_eq_u32 vcc, -1, v2
s_cbranch_vccz L_rx_173
s_cmp_lt_u32 s75, 0x100000
s_cbranch_scc1 L_rn_174
L_rx_173:
v_smfmac_f32_16x16x64_bf16 v[52:55], v[44:47], v[64:71], v43
v_smfmac_f32_16x16x64_bf16 v[52:55], v[44:47], v[72:79], v43
v_smfmac_f32_16x16x64_bf16 v[52:55], v[44:47], v[80:87], v43
s_nop 7
v_add_f32_dpp v13, v52, v52 row_ror:8 row_mask:0x3 bank_mask:0x3
v_add_f32_dpp v13, v53, v53 row_ror:8 row_mask:0x3 bank_mask:0xc
v_add_f32_dpp v13, v54, v54 row_ror:8 row_mask:0xc bank_mask:0x3
v_add_f32_dpp v13, v55, v55 row_ror:8 row_mask:0xc bank_mask:0xc
L_rz_175:
v_fmac_f32 v8, v13, v10
s_nop 1
v_mov_b32_dpp v14, v8 quad_perm:[1,1,3,3] row_mask:0xf bank_mask:0xf
s_not_b64 exec, s[76:77]
v_cvt_pk_bf16_f32 v13, v8, v14
buffer_store_dword v13, v6, s[56:59], s73 offen sc1
s_mov_b64 exec, -1
s_cmp_lt_u32 s70, 8
s_cbranch_scc0 L_fin2
s_mov_b64 exec, 0xffff
buffer_store_dwordx4 v[44:47], v1, s[36:39], s62 offen sc1
s_mov_b64 exec, -1
L_fin2:
s_endpgm
L_ffn:
s_mul_i32 s67, s3, 12288
s_add_u32 s67, s67, 25600
v_lshlrev_b32 v7, 3, v0
buffer_load_dwordx4 v[8:11], v1, s[36:39], s67 offen offset:0 sc1
buffer_load_dwordx4 v[12:15], v1, s[36:39], s67 offen offset:1024 sc1
s_cmp_lt_u32 s3, 4
s_cbranch_scc1 L_post_176
s_mov_b32 s40, s16
s_mov_b32 s41, s17
s_mov_b32 s42, 0x158000
s_mov_b32 s43, 0x20000
s_mov_b32 s56, s18
s_mov_b32 s57, s19
s_mov_b32 s58, 0x158000
s_mov_b32 s59, 0x20000
v_lshrrev_b32 v16, 2, v0
v_mul_u32_u24 v16, 2752, v16
v_and_b32 v17, 3, v0
v_lshrrev_b32 v18, 5, v0
v_xor_b32 v17, v17, v18
v_xor_b32 v18, 2, v17
v_lshl_add_u32 v17, v17, 4, v16
v_lshl_add_u32 v18, v18, 4, v16
s_mul_i32 s64, s34, 352256
s_lshl_b32 s65, s74, 6
s_add_u32 s64, s64, s65
s_lshl_b32 s65, s34, 13
s_add_u32 m0, s65, 4096
s_add_u32 s66, s64, 0
buffer_load_dwordx4 v17, s[40:43], s66 offen  lds
s_add_u32 m0, s65, 36864
s_add_u32 s66, s64, 0
buffer_load_dwordx4 v18, s[56:59], s66 offen  lds
s_add_u32 m0, s65, 5120
s_add_u32 s66, s64, 44032
buffer_load_dwordx4 v17, s[40:43], s66 offen  lds
s_add_u32 m0, s65, 37888
s_add_u32 s66, s64, 44032
buffer_load_dwordx4 v18, s[56:59], s66 offen  lds
s_add_u32 m0, s65, 6144
s_add_u32 s66, s64, 88064
buffer_load_dwordx4 v17, s[40:43], s66 offen  lds
s_add_u32 m0, s65, 38912
s_add_u32 s66, s64, 88064
buffer_load_dwordx4 v18, s[56:59], s66 offen  lds
s_add_u32 m0, s65, 7168
s_add_u32 s66, s64, 132096
buffer_load_dwordx4 v17, s[40:43], s66 offen  lds
s_add_u32 m0, s65, 39936
s_add_u32 s66, s64, 132096
buffer_load_dwordx4 v18, s[56:59], s66 offen  lds
s_add_u32 m0, s65, 8192
s_add_u32 s66, s64, 176128
buffer_load_dwordx4 v17, s[40:43], s66 offen  lds
s_add_u32 m0, s65, 40960
s_add_u32 s66, s64, 176128
buffer_load_dwordx4 v18, s[56:59], s66 offen  lds
s_add_u32 m0, s65, 9216
s_add_u32 s66, s64, 220160
buffer_load_dwordx4 v17, s[40:43], s66 offen  lds
s_add_u32 m0, s65, 41984
s_add_u32 s66, s64, 220160
buffer_load_dwordx4 v18, s[56:59], s66 offen  lds
s_add_u32 m0, s65, 10240
s_add_u32 s66, s64, 264192
buffer_load_dwordx4 v17, s[40:43], s66 offen  lds
s_add_u32 m0, s65, 43008
s_add_u32 s66, s64, 264192
buffer_load_dwordx4 v18, s[56:59], s66 offen  lds
s_add_u32 m0, s65, 11264
s_add_u32 s66, s64, 308224
buffer_load_dwordx4 v17, s[40:43], s66 offen  lds
s_add_u32 m0, s65, 44032
s_add_u32 s66, s64, 308224
buffer_load_dwordx4 v18, s[56:59], s66 offen  lds
s_waitcnt vmcnt(16)
s_branch L_post_177
L_post_176:
s_waitcnt vmcnt(0)
L_post_177:
v_max3_u32 v16, v8, v9, v10
v_max3_u32 v16, v16, v11, v12
v_max3_u32 v16, v16, v13, v14
v_max_u32 v16, v16, v15
v_cmp_eq_u32 vcc, -1, v16
s_cbranch_vccz L_cb_178
s_mov_b32 s75, 0
L_poll_179:
buffer_load_dwordx4 v[8:11], v1, s[36:39], s67 offen offset:0 sc1
buffer_load_dwordx4 v[12:15], v1, s[36:39], s67 offen offset:1024 sc1
s_waitcnt vmcnt(0)
v_max3_u32 v16, v8, v9, v10
v_max3_u32 v16, v16, v11, v12
v_max3_u32 v16, v16, v13, v14
v_max_u32 v16, v16, v15
v_cmp_eq_u32 vcc, -1, v16
s_cbranch_vccz L_pollx_180
s_add_u32 s75, s75, 1
s_cmp_lt_u32 s75, 0x100000
s_cbranch_scc1 L_poll_179
L_pollx_180:
L_cb_178:
s_mov_b32 s68, 0xffff0000
v_lshlrev_b32 v24, 16, v8
v_and_b32 v25, s68, v8
v_lshlrev_b32 v32, 16, v12
v_and_b32 v33, s68, v12
v_lshlrev_b32 v26, 16, v9
v_and_b32 v27, s68, v9
v_lshlrev_b32 v34, 16, v13
v_and_b32 v35, s68, v13
v_lshlrev_b32 v28, 16, v10
v_and_b32 v29, s68, v10
v_lshlrev_b32 v36, 16, v14
v_and_b32 v37, s68, v14
v_lshlrev_b32 v30, 16, v11
v_and_b32 v31, s68, v11
v_lshlrev_b32 v38, 16, v15
v_and_b32 v39, s68, v15
v_add_f32 v32, 1.0, v32
v_add_f32 v33, 1.0, v33
v_add_f32 v34, 1.0, v34
v_add_f32 v35, 1.0, v35
v_add_f32 v36, 1.0, v36
v_add_f32 v37, 1.0, v37
v_add_f32 v38, 1.0, v38
v_add_f32 v39, 1.0, v39
v_lshrrev_b32 v2, 3, v0
v_bfe_u32 v3, v0, 1, 3
v_and_b32 v4, 3, v3
s_lshl_b32 s64, s3, 1
v_xor_b32 v3, s64, v3
v_lshlrev_b32 v5, 10, v2
v_lshl_add_u32 v5, v4, 8, v5
v_lshl_add_u32 v5, v3, 4, v5
v_and_b32 v4, 1, v0
v_lshl_add_u32 v5, v4, 3, v5
v_add_u32 v5, 69632, v5
v_xor_b32 v6, 16, v5
v_mul_u32_u24 v16, 0xaaaa, v4
v_add_u32 v16, 0x4444, v16
v_lshrrev_b32 v2, 4, v0
v_bfe_u32 v3, v0, 3, 1
v_xor_b32 v7, v2, v0
v_lshlrev_b32 v7, 4, v7
v_add_u32 v7, 69632, v7
v_xor_b32 v8, 64, v7
v_and_b32 v4, 7, v0
v_and_b32 v9, 0x38, v0
v_lshlrev_b32 v9, 3, v9
v_lshl_add_u32 v9, v4, 1, v9
s_lshl_b32 s64, s34, 4
v_add_u32 v9, s64, v9
v_and_b32 v10, 12, v0
v_lshlrev_b32 v10, 5, v10
v_and_b32 v4, 1, v0
v_lshl_add_u32 v10, v4, 6, v10
v_lshl_add_u32 v10, v2, 4, v10
v_mov_b32 v17, 0xbfb8aa3b
v_mov_b32 v64, 0
v_mov_b32 v65, 0
v_mov_b32 v66, 0
v_mov_b32 v67, 0
s_lshl_b32 s64, s34, 3
s_lshr_b32 s64, s35, s64
v_lshlrev_b32 v3, 2, v3
v_bfe_u32 v3, s64, v3, 3
v_and_b32 v11, 6, v3
v_lshlrev_b32 v11, 12, v11
v_and_b32 v3, 1, v3
v_lshl_add_u32 v11, v3, 15, v11
v_lshl_add_u32 v11, v2, 17, v11
v_and_b32 v4, 240, v1
v_add_u32 v11, v11, v4
v_lshl_add_u32 v11, v2, 9, v11
s_lshl_b32 s64, s34, 8
v_add_u32 v11, s64, v11
s_lshl_b32 s69, s74, 7
s_add_u32 s69, s69, 1376256
s_add_u32 s72, s69, 65536
s_lshl_b32 s64, s3, 10
s_lshl_b32 s65, s2, 2
s_lshr_b32 s65, s35, s65
s_and_b32 s65, s65, 2
s_lshl_b32 s65, s65, 12
s_add_u32 s64, s64, s65
s_add_u32 s64, s64, 1310720
v_mov_b32 v14, 0xbb000000
v_mov_b32 v15, 0x3b000000
v_lshrrev_b32 v18, 4, v0
v_bfe_u32 v19, v0, 2, 2
v_bfe_u32 v20, v0, 1, 1
v_and_b32 v22, 1, v18
v_lshl_add_u32 v22, v20, 1, v22
v_xor_b32 v22, s34, v22
v_lshlrev_b32 v22, 4, v22
v_lshl_add_u32 v22, v20, 15, v22
v_lshl_add_u32 v22, v18, 9, v22
v_lshl_add_u32 v22, v19, 6, v22
v_and_b32 v20, 1, v0
v_lshl_add_u32 v22, v20, 3, v22
v_add_u32 v22, 4096, v22
s_lshr_b32 s73, s3, 2
s_waitcnt vmcnt(0)
s_barrier
buffer_load_dwordx4 v[56:59], v1, s[36:39], s64 offen sc1
s_cmp_eq_u32 s73, 0
s_cbranch_scc1 L_gu_182
ds_read_b64_tr_b16 v[128:129], v22 offset:0
ds_read_b64_tr_b16 v[130:131], v22 offset:256
ds_read_b64_tr_b16 v[132:133], v22 offset:2048
ds_read_b64_tr_b16 v[134:135], v22 offset:2304
ds_read_b64_tr_b16 v[136:137], v22 offset:4096
ds_read_b64_tr_b16 v[138:139], v22 offset:4352
ds_read_b64_tr_b16 v[140:141], v22 offset:6144
ds_read_b64_tr_b16 v[142:143], v22 offset:6400
ds_read_b64_tr_b16 v[144:145], v22 offset:8192
ds_read_b64_tr_b16 v[146:147], v22 offset:8448
ds_read_b64_tr_b16 v[148:149], v22 offset:10240
s_waitcnt lgkmcnt(4)
ds_read_b64_tr_b16 v[150:151], v22 offset:10496
ds_read_b64_tr_b16 v[152:153], v22 offset:12288
ds_read_b64_tr_b16 v[154:155], v22 offset:12544
ds_read_b64_tr_b16 v[156:157], v22 offset:14336
ds_read_b64_tr_b16 v[158:159], v22 offset:14592
ds_read_b64_tr_b16 v[160:161], v22 offset:16384
ds_read_b64_tr_b16 v[162:163], v22 offset:16640
ds_read_b64_tr_b16 v[164:165], v22 offset:18432
ds_read_b64_tr_b16 v[166:167], v22 offset:18688
ds_read_b64_tr_b16 v[168:169], v22 offset:20480
ds_read_b64_tr_b16 v[170:171], v22 offset:20736
s_waitcnt lgkmcnt(4)
ds_read_b64_tr_b16 v[172:173], v22 offset:22528
ds_read_b64_tr_b16 v[174:175], v22 offset:22784
ds_read_b64_tr_b16 v[176:177], v22 offset:24576
ds_read_b64_tr_b16 v[178:179], v22 offset:24832
ds_read_b64_tr_b16 v[180:181], v22 offset:26624
ds_read_b64_tr_b16 v[182:183], v22 offset:26880
ds_read_b64_tr_b16 v[184:185], v22 offset:28672
ds_read_b64_tr_b16 v[186:187], v22 offset:28928
ds_read_b64_tr_b16 v[188:189], v22 offset:30720
ds_read_b64_tr_b16 v[190:191], v22 offset:30976
L_gu_182:
s_cmp_lt_u32 s3, 4
s_cbranch_scc0 L_dma_183
s_mov_b32 s48, s20
s_mov_b32 s49, s21
s_mov_b32 s50, 0x158000
s_mov_b32 s51, 0x20000
v_lshrrev_b32 v18, 4, v0
v_and_b32 v16, 15, v0
v_xor_b32 v16, v16, v18
v_xor_b32 v17, 4, v16
v_lshlrev_b32 v19, 10, v18
v_lshl_add_u32 v22, v16, 4, v19
v_lshl_add_u32 v23, v17, 4, v19
s_lshl_b32 s76, s74, 15
s_lshl_b32 s66, s34, 8
s_add_u32 s76, s76, s66
s_lshl_b32 s77, s34, 13
s_add_u32 s77, s77, 77824
v_bfe_u32 v19, v0, 2, 2
v_and_b32 v16, 2, v0
v_lshlrev_b32 v16, 2, v16
v_xor_b32 v16, v16, v19
v_and_b32 v17, 1, v18
v_lshlrev_b32 v17, 2, v17
v_xor_b32 v16, v16, v17
v_lshlrev_b32 v16, 4, v16
v_lshl_add_u32 v16, v18, 10, v16
v_lshl_add_u32 v16, v19, 8, v16
v_and_b32 v17, 1, v0
v_lshl_add_u32 v16, v17, 3, v16
v_add_u32 v68, s77, v16
v_xor_b32 v69, 16, v68
v_xor_b32 v70, 32, v68
v_xor_b32 v71, 48, v68
v_xor_b32 v72, 64, v68
v_xor_b32 v73, 80, v68
v_xor_b32 v74, 96, v68
v_xor_b32 v75, 112, v68
s_add_u32 m0, s77, 0
s_xor_b32 s66, s76, 0
buffer_load_dwordx4 v22, s[48:51], s66 offen  lds
s_add_u32 m0, s77, 1024
s_xor_b32 s66, s76, 8192
buffer_load_dwordx4 v23, s[48:51], s66 offen  lds
s_add_u32 m0, s77, 2048
s_xor_b32 s66, s76, 16384
buffer_load_dwordx4 v22, s[48:51], s66 offen  lds
s_add_u32 m0, s77, 3072
s_xor_b32 s66, s76, 24576
buffer_load_dwordx4 v23, s[48:51], s66 offen  lds
s_add_u32 m0, s77, 4096
s_xor_b32 s66, s76, 4096
buffer_load_dwordx4 v22, s[48:51], s66 offen  lds
s_add_u32 m0, s77, 5120
s_xor_b32 s66, s76, 12288
buffer_load_dwordx4 v23, s[48:51], s66 offen  lds
s_add_u32 m0, s77, 6144
s_xor_b32 s66, s76, 20480
buffer_load_dwordx4 v22, s[48:51], s66 offen  lds
s_waitcnt vmcnt(7)
s_branch L_dma_184
L_dma_183:
s_waitcnt vmcnt(0)
L_dma_184:
s_mov_b32 s73, 0x3f803f80
v_mov_b32 v20, 0
v_mov_b32 v21, 0
v_max3_u32 v12, v56, v57, v58
v_max_u32 v12, v12, v59
v_cmp_eq_u32 vcc, -1, v12
s_cbranch_vccz L_x_181
buffer_load_dwordx4 v[56:59], v1, s[36:39], s64 offen sc1
s_sleep 1
s_mov_b32 s75, 0
L_poll_185:
buffer_load_dwordx4 v[56:59], v1, s[36:39], s64 offen sc1
s_waitcnt vmcnt(1)
v_max3_u32 v12, v56, v57, v58
v_max_u32 v12, v12, v59
v_cmp_eq_u32 vcc, -1, v12
s_cbranch_vccz L_pollx_186
s_add_u32 s75, s75, 1
s_cmp_lt_u32 s75, 0x100000
s_cbranch_scc1 L_poll_185
L_pollx_186:
L_x_181:
v_dot2c_f32_bf16 v20, s73, v56
v_dot2c_f32_bf16 v21, v56, v56
v_dot2c_f32_bf16 v20, s73, v57
v_dot2c_f32_bf16 v21, v57, v57
v_dot2c_f32_bf16 v20, s73, v58
v_dot2c_f32_bf16 v21, v58, v58
v_dot2c_f32_bf16 v20, s73, v59
v_dot2c_f32_bf16 v21, v59, v59
v_lshlrev_b32 v40, 16, v56
v_and_b32 v41, s68, v56
v_lshlrev_b32 v42, 16, v57
v_permlane32_swap_b32 v20, v21
v_add_f32 v12, v20, v21
v_and_b32 v43, s68, v57
v_lshlrev_b32 v44, 16, v58
v_add_f32_dpp v12, v12, v12 quad_perm:[1,0,3,2] row_mask:0xf bank_mask:0xf
v_and_b32 v45, s68, v58
v_lshlrev_b32 v46, 16, v59
v_add_f32_dpp v12, v12, v12 quad_perm:[2,3,0,1] row_mask:0xf bank_mask:0xf
v_and_b32 v47, s68, v59
v_pk_mul_f32 v[48:49], v[40:41], v[32:33]
v_add_f32_dpp v12, v12, v12 row_ror:4 row_mask:0xf bank_mask:0xf
v_pk_mul_f32 v[50:51], v[42:43], v[34:35]
v_pk_mul_f32 v[52:53], v[44:45], v[36:37]
v_add_f32_dpp v12, v12, v12 row_ror:8 row_mask:0xf bank_mask:0xf
v_pk_mul_f32 v[54:55], v[46:47], v[38:39]
s_nop 0
v_add_f32_dpp v12, v12, v12 row_bcast:15 row_mask:0xa bank_mask:0xf
s_nop 0
v_readlane_b32 s70, v12, 16
v_readlane_b32 s71, v12, 48
s_nop 0
v_mul_f32 v12, s70, v14
v_mul_f32 v13, s71, v15
v_fma_f32 v13, -v12, v12, v13
v_max_f32 v13, 0, v13
v_add_f32 v13, 0x3727c5ac, v13
v_rsq_f32 v2, v13
v_pk_fma_f32 v[48:49], v[12:13], v[32:33], v[48:49] op_sel_hi:[0,1,1]
v_pk_fma_f32 v[50:51], v[12:13], v[34:35], v[50:51] op_sel_hi:[0,1,1]
v_pk_fma_f32 v[52:53], v[12:13], v[36:37], v[52:53] op_sel_hi:[0,1,1]
v_pk_fma_f32 v[54:55], v[12:13], v[38:39], v[54:55] op_sel_hi:[0,1,1]
v_pk_fma_f32 v[24:25], v[2:3], v[48:49], v[24:25] op_sel_hi:[0,1,1]
v_pk_fma_f32 v[28:29], v[2:3], v[52:53], v[28:29] op_sel_hi:[0,1,1]
v_pk_fma_f32 v[26:27], v[2:3], v[50:51], v[26:27] op_sel_hi:[0,1,1]
v_pk_fma_f32 v[30:31], v[2:3], v[54:55], v[30:31] op_sel_hi:[0,1,1]
v_cvt_pk_bf16_f32 v40, v24, v25
v_cvt_pk_bf16_f32 v41, v28, v29
ds_write_b64 v5, v[40:41]
v_cvt_pk_bf16_f32 v42, v26, v27
v_cvt_pk_bf16_f32 v43, v30, v31
ds_write_b64 v6, v[42:43]
s_cmp_lt_u32 s3, 4
s_cbranch_scc0 L_dma_187
s_mov_b32 s48, s20
s_mov_b32 s49, s21
s_mov_b32 s50, 0x158000
s_mov_b32 s51, 0x20000
s_add_u32 m0, s77, 7168
s_xor_b32 s66, s76, 28672
buffer_load_dwordx4 v23, s[48:51], s66 offen  lds
L_dma_187:
s_cmp_lt_u32 s3, 4
s_waitcnt lgkmcnt(0)
s_barrier
s_cbranch_scc1 L_bar_fin
ds_read_b128 v[192:195], v7 offset:0
ds_read_b128 v[196:199], v8 offset:1024
ds_read_b128 v[200:203], v7 offset:2048
ds_read_b128 v[204:207], v8 offset:3072
ds_read_b128 v[208:211], v7 offset:4096
ds_read_b128 v[212:215], v8 offset:5120
ds_read_b128 v[216:219], v7 offset:6144
ds_read_b128 v[220:223], v8 offset:7168
s_waitcnt lgkmcnt(7)
v_smfmac_f32_16x16x64_bf16 v[64:67], v[192:195], v[128:135], v16
s_waitcnt lgkmcnt(6)
v_smfmac_f32_16x16x64_bf16 v[64:67], v[196:199], v[136:143], v16
s_waitcnt lgkmcnt(5)
v_smfmac_f32_16x16x64_bf16 v[64:67], v[200:203], v[144:151], v16
s_waitcnt lgkmcnt(4)
v_smfmac_f32_16x16x64_bf16 v[64:67], v[204:207], v[152:159], v16
s_waitcnt lgkmcnt(3)
v_smfmac_f32_16x16x64_bf16 v[64:67], v[208:211], v[160:167], v16
s_waitcnt lgkmcnt(2)
v_smfmac_f32_16x16x64_bf16 v[64:67], v[212:215], v[168:175], v16
s_waitcnt lgkmcnt(1)
v_smfmac_f32_16x16x64_bf16 v[64:67], v[216:219], v[176:183], v16
s_waitcnt lgkmcnt(0)
v_smfmac_f32_16x16x64_bf16 v[64:67], v[220:223], v[184:191], v16
s_nop 7
v_add_f32 v66, v66, v67
v_add_f32 v64, v64, v65
v_mul_f32 v18, v64, v17
v_mul_f32_dpp v18, v66, v17 row_ror:8 row_mask:0xf bank_mask:0xc
v_exp_f32 v18, v18
v_mov_b32_dpp v66, v64 row_ror:8 row_mask:0xf bank_mask:0x3
v_add_f32 v18, 1.0, v18
v_rcp_f32 v18, v18
s_nop 0
v_mul_f32 v18, v18, v66
v_cvt_pk_bf16_f32 v18, v18, v18
ds_write_b16 v9, v18 offset:3584
s_waitcnt lgkmcnt(0)
s_barrier
s_endpgm
L_bar_fin:
s_waitcnt vmcnt(0)
ds_read_b64_tr_b16 v[96:97], v68 offset:0
ds_read_b64_tr_b16 v[98:99], v68 offset:4096
ds_read_b64_tr_b16 v[100:101], v69 offset:0
ds_read_b64_tr_b16 v[102:103], v69 offset:4096
ds_read_b64_tr_b16 v[104:105], v70 offset:0
ds_read_b64_tr_b16 v[106:107], v70 offset:4096
ds_read_b64_tr_b16 v[108:109], v71 offset:0
ds_read_b64_tr_b16 v[110:111], v71 offset:4096
ds_read_b64_tr_b16 v[112:113], v72 offset:0
ds_read_b64_tr_b16 v[114:115], v72 offset:4096
ds_read_b64_tr_b16 v[116:117], v73 offset:0
s_waitcnt lgkmcnt(4)
ds_read_b64_tr_b16 v[118:119], v73 offset:4096
ds_read_b64_tr_b16 v[120:121], v74 offset:0
ds_read_b64_tr_b16 v[122:123], v74 offset:4096
ds_read_b64_tr_b16 v[124:125], v75 offset:0
ds_read_b64_tr_b16 v[126:127], v75 offset:4096
s_waitcnt lgkmcnt(0)
s_barrier
ds_read_b128 v[48:51], v10 offset:3584
s_waitcnt lgkmcnt(0)
v_mfma_f32_16x16x32_bf16 v[192:195], v[48:51], v[96:99], 0
v_mfma_f32_16x16x32_bf16 v[196:199], v[48:51], v[100:103], 0
v_mfma_f32_16x16x32_bf16 v[200:203], v[48:51], v[104:107], 0
s_nop 1
v_mfma_f32_16x16x32_bf16 v[204:207], v[48:51], v[108:111], 0
s_nop 1
v_mfma_f32_16x16x32_bf16 v[208:211], v[48:51], v[112:115], 0
s_nop 0
v_cvt_pk_bf16_f32 v16, v192, v196
v_mfma_f32_16x16x32_bf16 v[212:215], v[48:51], v[116:119], 0
v_cvt_pk_bf16_f32 v20, v193, v197
v_mfma_f32_16x16x32_bf16 v[216:219], v[48:51], v[120:123], 0
v_cvt_pk_bf16_f32 v17, v200, v204
v_cvt_pk_bf16_f32 v21, v201, v205
v_mfma_f32_16x16x32_bf16 v[220:223], v[48:51], v[124:127], 0
s_nop 2
v_cvt_pk_bf16_f32 v18, v208, v212
v_cvt_pk_bf16_f32 v22, v209, v213
s_nop 2
v_cvt_pk_bf16_f32 v19, v216, v220
buffer_store_dwordx4 v[16:19], v11, s[36:39], s69 offen sc1
v_cvt_pk_bf16_f32 v23, v217, v221
buffer_store_dwordx4 v[20:23], v11, s[36:39], s72 offen sc1
s_endpgm
s_endpgm
L_srest:
s_lshr_b32 s32, s2, 5
s_and_b32 s33, s2, 31
s_and_b32 s67, s2, 7
s_lshr_b32 s68, s2, 3
s_sub_u32 s68, s68, 26
s_min_u32 s74, s67, 3
s_mul_i32 s66, s67, 5
s_add_u32 s74, s74, s66
s_add_u32 s74, s74, s68
s_cmp_lt_u32 s67, 3
s_cselect_b32 s66, 6, 5
s_cmp_lt_u32 s68, s66
s_cselect_b32 s74, s74, -1
s_cmp_lt_u32 s2, 48
s_cselect_b32 s66, 2, 3
s_cselect_b32 s72, 14+26, 42+26
s_cmp_lt_u32 s2, 16
s_cselect_b32 s66, 1, s66
s_cselect_b32 s72, 26, s72
s_lshl_b32 s66, s67, s66
s_add_u32 s72, s72, s66
s_add_u32 s72, s72, s68
s_mov_b32 s36, s30
s_mov_b32 s37, s31
s_mov_b32 s38, 0x1d0000
s_mov_b32 s39, 0x20000
s_mov_b32 s52, s28
s_mov_b32 s53, s29
s_mov_b32 s54, 0x100
s_mov_b32 s55, 0x20000
s_mov_b32 s46, 0x40000
s_mov_b32 s47, 0x20000
s_cmp_eq_u32 s74, -1
s_mov_b32 s69, 30
s_cselect_b32 s69, 20, s69
s_cmp_lt_u32 s2, 144
s_cselect_b32 s69, 0, s69
s_cmp_lt_u32 s2, 112
s_cselect_b32 s69, 50, s69
s_cmp_lt_u32 s2, 48
s_cselect_b32 s69, 30, s69
s_cmp_lt_u32 s2, 16
s_cselect_b32 s69, 40, s69
s_and_b32 s66, s72, 7
s_cmp_eq_u32 s66, 3
s_cselect_b32 s66, 40, 0
s_cmp_lt_u32 s2, 112
s_cselect_b32 s66, s66, 0
s_add_u32 s69, s69, s66
s_xor_b32 s64, s65, 1024
s_cmpk_gt_u32 s69, 4
s_cbranch_scc1 L_d_1
s_waitcnt vmcnt(3)
L_d_1:
buffer_load_dwordx4 v[24:27], v1, s[40:43], s64 offen nt
s_xor_b32 s64, s65, 66560
s_cmpk_gt_u32 s69, 5
s_cbranch_scc1 L_d_2
s_waitcnt vmcnt(3)
L_d_2:
buffer_load_dwordx4 v[28:31], v1, s[40:43], s64 offen nt
s_xor_b32 s64, s65, 3072
s_cmpk_gt_u32 s69, 6
s_cbranch_scc1 L_d_3
s_waitcnt vmcnt(3)
L_d_3:
buffer_load_dwordx4 v[32:35], v1, s[40:43], s64 offen nt
s_xor_b32 s64, s65, 68608
s_cmpk_gt_u32 s69, 7
s_waitcnt vmcnt(6)
s_cbranch_scc1 L_d_4
s_waitcnt vmcnt(3)
L_d_4:
buffer_load_dwordx4 v[36:39], v1, s[40:43], s64 offen nt
s_xor_b32 s64, s65, 32768
s_cmpk_gt_u32 s69, 8
s_waitcnt vmcnt(6)
s_cbranch_scc1 L_d_5
s_waitcnt vmcnt(3)
L_d_5:
buffer_load_dwordx4 v[40:43], v1, s[40:43], s64 offen nt
s_xor_b32 s64, s65, 98304
s_cmpk_gt_u32 s69, 9
s_waitcnt vmcnt(6)
s_cbranch_scc1 L_d_6
s_waitcnt vmcnt(3)
L_d_6:
buffer_load_dwordx4 v[44:47], v1, s[40:43], s64 offen nt
s_xor_b32 s64, s65, 34816
s_cmpk_gt_u32 s69, 10
s_waitcnt vmcnt(6)
s_cbranch_scc1 L_d_7
s_waitcnt vmcnt(3)
L_d_7:
buffer_load_dwordx4 v[48:51], v1, s[40:43], s64 offen nt
s_xor_b32 s64, s65, 100352
s_cmpk_gt_u32 s69, 11
s_waitcnt vmcnt(6)
s_cbranch_scc1 L_d_8
s_waitcnt vmcnt(3)
L_d_8:
buffer_load_dwordx4 v[52:55], v1, s[40:43], s64 offen nt
s_xor_b32 s64, s65, 33792
s_cmpk_gt_u32 s69, 12
s_waitcnt vmcnt(6)
s_cbranch_scc1 L_d_9
s_waitcnt vmcnt(3)
L_d_9:
buffer_load_dwordx4 v[56:59], v1, s[40:43], s64 offen nt
s_xor_b32 s64, s65, 99328
s_cmpk_gt_u32 s69, 13
s_waitcnt vmcnt(6)
s_cbranch_scc1 L_d_10
s_waitcnt vmcnt(3)
L_d_10:
buffer_load_dwordx4 v[60:63], v1, s[40:43], s64 offen nt
s_xor_b32 s64, s65, 35840
s_cmpk_gt_u32 s69, 14
s_waitcnt vmcnt(6)
s_cbranch_scc1 L_d_11
s_waitcnt vmcnt(3)
L_d_11:
buffer_load_dwordx4 v[64:67], v1, s[40:43], s64 offen nt
s_xor_b32 s64, s65, 101376
s_cmpk_gt_u32 s69, 15
s_waitcnt vmcnt(6)
s_cbranch_scc1 L_d_12
s_waitcnt vmcnt(3)
L_d_12:
buffer_load_dwordx4 v[68:71], v1, s[40:43], s64 offen nt
s_xor_b32 s64, s65, 131072
s_cmpk_gt_u32 s69, 16
s_waitcnt vmcnt(6)
s_cbranch_scc1 L_d_13
s_waitcnt vmcnt(3)
L_d_13:
buffer_load_dwordx4 v[72:75], v1, s[40:43], s64 offen nt
s_xor_b32 s64, s65, 196608
s_cmpk_gt_u32 s69, 17
s_waitcnt vmcnt(6)
s_cbranch_scc1 L_d_14
s_waitcnt vmcnt(3)
L_d_14:
buffer_load_dwordx4 v[76:79], v1, s[40:43], s64 offen nt
s_xor_b32 s64, s65, 133120
s_cmpk_gt_u32 s69, 18
s_waitcnt vmcnt(6)
s_cbranch_scc1 L_d_15
s_waitcnt vmcnt(3)
L_d_15:
buffer_load_dwordx4 v[80:83], v1, s[40:43], s64 offen nt
s_xor_b32 s64, s65, 198656
s_cmpk_gt_u32 s69, 19
s_waitcnt vmcnt(6)
s_cbranch_scc1 L_d_16
s_waitcnt vmcnt(3)
L_d_16:
buffer_load_dwordx4 v[84:87], v1, s[40:43], s64 offen nt
s_xor_b32 s64, s65, 132096
s_cmpk_gt_u32 s69, 20
s_waitcnt vmcnt(6)
s_cbranch_scc1 L_d_17
s_waitcnt vmcnt(3)
L_d_17:
buffer_load_dwordx4 v[88:91], v1, s[40:43], s64 offen nt
s_xor_b32 s64, s65, 197632
s_cmpk_gt_u32 s69, 21
s_waitcnt vmcnt(6)
s_cbranch_scc1 L_d_18
s_waitcnt vmcnt(3)
L_d_18:
buffer_load_dwordx4 v[92:95], v1, s[40:43], s64 offen nt
s_xor_b32 s64, s65, 134144
s_cmpk_gt_u32 s69, 22
s_waitcnt vmcnt(6)
s_cbranch_scc1 L_d_19
s_waitcnt vmcnt(3)
L_d_19:
buffer_load_dwordx4 v[96:99], v1, s[40:43], s64 offen nt
s_xor_b32 s64, s65, 199680
s_cmpk_gt_u32 s69, 23
s_waitcnt vmcnt(6)
s_cbranch_scc1 L_d_20
s_waitcnt vmcnt(3)
L_d_20:
buffer_load_dwordx4 v[100:103], v1, s[40:43], s64 offen nt
s_xor_b32 s64, s65, 163840
s_cmpk_gt_u32 s69, 24
s_waitcnt vmcnt(6)
s_cbranch_scc1 L_d_21
s_waitcnt vmcnt(3)
L_d_21:
buffer_load_dwordx4 v[104:107], v1, s[40:43], s64 offen nt
s_xor_b32 s64, s65, 229376
s_cmpk_gt_u32 s69, 25
s_waitcnt vmcnt(6)
s_cbranch_scc1 L_d_22
s_waitcnt vmcnt(3)
L_d_22:
buffer_load_dwordx4 v[108:111], v1, s[40:43], s64 offen nt
s_xor_b32 s64, s65, 165888
s_cmpk_gt_u32 s69, 26
s_waitcnt vmcnt(6)
s_cbranch_scc1 L_d_23
s_waitcnt vmcnt(3)
L_d_23:
buffer_load_dwordx4 v[112:115], v1, s[40:43], s64 offen nt
s_xor_b32 s64, s65, 231424
s_cmpk_gt_u32 s69, 27
s_waitcnt vmcnt(6)
s_cbranch_scc1 L_d_24
s_waitcnt vmcnt(3)
L_d_24:
buffer_load_dwordx4 v[116:119], v1, s[40:43], s64 offen nt
s_xor_b32 s64, s65, 164864
s_cmpk_gt_u32 s69, 28
s_waitcnt vmcnt(6)
s_cbranch_scc1 L_d_25
s_waitcnt vmcnt(3)
L_d_25:
buffer_load_dwordx4 v[120:123], v1, s[40:43], s64 offen nt
s_xor_b32 s64, s65, 230400
s_cmpk_gt_u32 s69, 29
s_waitcnt vmcnt(6)
s_cbranch_scc1 L_d_26
s_waitcnt vmcnt(3)
L_d_26:
buffer_load_dwordx4 v[124:127], v1, s[40:43], s64 offen nt
s_xor_b32 s64, s65, 166912
s_cmpk_gt_u32 s69, 30
s_waitcnt vmcnt(6)
s_cbranch_scc1 L_d_27
s_waitcnt vmcnt(3)
L_d_27:
buffer_load_dwordx4 v[128:131], v1, s[40:43], s64 offen nt
s_xor_b32 s64, s65, 232448
s_cmpk_gt_u32 s69, 31
s_waitcnt vmcnt(6)
s_cbranch_scc1 L_d_28
s_waitcnt vmcnt(3)
L_d_28:
buffer_load_dwordx4 v[132:135], v1, s[40:43], s64 offen nt
s_xor_b32 s64, s65, 4096
s_cmpk_gt_u32 s69, 32
s_waitcnt vmcnt(6)
s_cbranch_scc1 L_d_29
s_waitcnt vmcnt(4)
L_d_29:
buffer_load_dwordx4 v[136:139], v1, s[40:43], s64 offen nt
s_xor_b32 s64, s65, 69632
s_cmpk_gt_u32 s69, 33
s_waitcnt vmcnt(6)
s_cbranch_scc1 L_d_30
s_waitcnt vmcnt(4)
L_d_30:
buffer_load_dwordx4 v[140:143], v1, s[40:43], s64 offen nt
s_xor_b32 s64, s65, 6144
s_cmpk_gt_u32 s69, 34
s_waitcnt vmcnt(6)
s_cbranch_scc1 L_d_31
s_waitcnt vmcnt(4)
L_d_31:
buffer_load_dwordx4 v[144:147], v1, s[40:43], s64 offen nt
s_xor_b32 s64, s65, 71680
s_cmpk_gt_u32 s69, 35
s_waitcnt vmcnt(6)
s_cbranch_scc1 L_d_32
s_waitcnt vmcnt(4)
L_d_32:
buffer_load_dwordx4 v[148:151], v1, s[40:43], s64 offen nt
s_xor_b32 s64, s65, 5120
s_cmpk_gt_u32 s69, 36
s_waitcnt vmcnt(6)
s_cbranch_scc1 L_d_33
s_waitcnt vmcnt(4)
L_d_33:
buffer_load_dwordx4 v[152:155], v1, s[40:43], s64 offen nt
s_xor_b32 s64, s65, 70656
s_cmpk_gt_u32 s69, 37
s_waitcnt vmcnt(6)
s_cbranch_scc1 L_d_34
s_waitcnt vmcnt(4)
L_d_34:
buffer_load_dwordx4 v[156:159], v1, s[40:43], s64 offen nt
s_xor_b32 s64, s65, 7168
s_cmpk_gt_u32 s69, 38
s_waitcnt vmcnt(6)
s_cbranch_scc1 L_d_35
s_waitcnt vmcnt(4)
L_d_35:
buffer_load_dwordx4 v[160:163], v1, s[40:43], s64 offen nt
s_xor_b32 s64, s65, 72704
s_cmpk_gt_u32 s69, 39
s_waitcnt vmcnt(6)
s_cbranch_scc1 L_d_36
s_waitcnt vmcnt(4)
L_d_36:
buffer_load_dwordx4 v[164:167], v1, s[40:43], s64 offen nt
s_xor_b32 s64, s65, 36864
s_cmpk_gt_u32 s69, 40
s_waitcnt vmcnt(6)
s_cbranch_scc1 L_d_37
s_waitcnt vmcnt(4)
L_d_37:
buffer_load_dwordx4 v[168:171], v1, s[40:43], s64 offen nt
s_xor_b32 s64, s65, 102400
s_cmpk_gt_u32 s69, 41
s_waitcnt vmcnt(6)
s_cbranch_scc1 L_d_38
s_waitcnt vmcnt(4)
L_d_38:
buffer_load_dwordx4 v[172:175], v1, s[40:43], s64 offen nt
s_xor_b32 s64, s65, 38912
s_cmpk_gt_u32 s69, 42
s_waitcnt vmcnt(6)
s_cbranch_scc1 L_d_39
s_waitcnt vmcnt(4)
L_d_39:
buffer_load_dwordx4 v[176:179], v1, s[40:43], s64 offen nt
s_xor_b32 s64, s65, 104448
s_cmpk_gt_u32 s69, 43
s_waitcnt vmcnt(6)
s_cbranch_scc1 L_d_40
s_waitcnt vmcnt(4)
L_d_40:
buffer_load_dwordx4 v[180:183], v1, s[40:43], s64 offen nt
s_xor_b32 s64, s65, 37888
s_cmpk_gt_u32 s69, 44
s_waitcnt vmcnt(6)
s_cbranch_scc1 L_d_41
s_waitcnt vmcnt(4)
L_d_41:
buffer_load_dwordx4 v[184:187], v1, s[40:43], s64 offen nt
s_xor_b32 s64, s65, 103424
s_cmpk_gt_u32 s69, 45
s_waitcnt vmcnt(6)
s_cbranch_scc1 L_d_42
s_waitcnt vmcnt(4)
L_d_42:
buffer_load_dwordx4 v[188:191], v1, s[40:43], s64 offen nt
s_xor_b32 s64, s65, 39936
s_cmpk_gt_u32 s69, 46
s_waitcnt vmcnt(6)
s_cbranch_scc1 L_d_43
s_waitcnt vmcnt(4)
L_d_43:
buffer_load_dwordx4 v[192:195], v1, s[40:43], s64 offen nt
s_xor_b32 s64, s65, 105472
s_cmpk_gt_u32 s69, 47
s_waitcnt vmcnt(6)
s_cbranch_scc1 L_d_44
s_waitcnt vmcnt(4)
L_d_44:
buffer_load_dwordx4 v[196:199], v1, s[40:43], s64 offen nt
s_xor_b32 s64, s65, 135168
s_cmpk_gt_u32 s69, 48
s_waitcnt vmcnt(6)
s_cbranch_scc1 L_d_45
s_waitcnt vmcnt(4)
L_d_45:
buffer_load_dwordx4 v[200:203], v1, s[40:43], s64 offen nt
s_xor_b32 s64, s65, 200704
s_cmpk_gt_u32 s69, 49
s_waitcnt vmcnt(6)
s_cbranch_scc1 L_d_46
s_waitcnt vmcnt(4)
L_d_46:
buffer_load_dwordx4 v[204:207], v1, s[40:43], s64 offen nt
s_xor_b32 s64, s65, 137216
s_cmpk_gt_u32 s69, 50
s_waitcnt vmcnt(6)
s_cbranch_scc1 L_d_47
s_waitcnt vmcnt(4)
L_d_47:
buffer_load_dwordx4 v[208:211], v1, s[40:43], s64 offen nt
s_xor_b32 s64, s65, 202752
s_cmpk_gt_u32 s69, 51
s_waitcnt vmcnt(6)
s_cbranch_scc1 L_d_48
s_waitcnt vmcnt(4)
L_d_48:
buffer_load_dwordx4 v[212:215], v1, s[40:43], s64 offen nt
s_xor_b32 s64, s65, 136192
s_cmpk_gt_u32 s69, 52
s_waitcnt vmcnt(6)
s_cbranch_scc1 L_d_49
s_waitcnt vmcnt(4)
L_d_49:
buffer_load_dwordx4 v[216:219], v1, s[40:43], s64 offen nt
s_xor_b32 s64, s65, 201728
s_cmpk_gt_u32 s69, 53
s_waitcnt vmcnt(6)
s_cbranch_scc1 L_d_50
s_waitcnt vmcnt(4)
L_d_50:
buffer_load_dwordx4 v[220:223], v1, s[40:43], s64 offen nt
s_xor_b32 s64, s65, 138240
s_cmpk_gt_u32 s69, 54
s_waitcnt vmcnt(6)
s_cbranch_scc1 L_d_51
s_waitcnt vmcnt(4)
L_d_51:
buffer_load_dwordx4 v[224:227], v1, s[40:43], s64 offen nt
s_xor_b32 s64, s65, 203776
s_cmpk_gt_u32 s69, 55
s_waitcnt vmcnt(6)
s_cbranch_scc1 L_d_52
s_waitcnt vmcnt(4)
L_d_52:
buffer_load_dwordx4 v[228:231], v1, s[40:43], s64 offen nt
s_cmp_eq_u32 s74, -1
s_mov_b32 s69, 64
s_cselect_b32 s69, 64, s69
s_cmp_lt_u32 s2, 144
s_cselect_b32 s69, 112, s69
s_cmp_lt_u32 s2, 112
s_cselect_b32 s69, 0, s69
s_cmp_lt_u32 s2, 48
s_cselect_b32 s69, 72, s69
s_cmp_lt_u32 s2, 16
s_cselect_b32 s69, 112, s69
s_xor_b32 s64, s65, 167936
s_cmpk_gt_u32 s69, 56
s_waitcnt vmcnt(6)
s_cbranch_scc1 L_d_53
s_waitcnt vmcnt(4)
L_d_53:
buffer_load_dwordx4 v[232:235], v1, s[40:43], s64 offen nt
s_xor_b32 s64, s65, 233472
s_cmpk_gt_u32 s69, 57
s_waitcnt vmcnt(6)
s_cbranch_scc1 L_d_54
s_waitcnt vmcnt(4)
L_d_54:
buffer_load_dwordx4 v[236:239], v1, s[40:43], s64 offen nt
s_xor_b32 s64, s65, 169984
s_cmpk_gt_u32 s69, 58
s_waitcnt vmcnt(6)
s_cbranch_scc1 L_d_55
s_waitcnt vmcnt(4)
L_d_55:
buffer_load_dwordx4 v[240:243], v1, s[40:43], s64 offen nt
v_and_b32 v2, 31, v0
v_lshlrev_b32 v2, 2, v2
buffer_load_dword v3, v2, s[52:55], 0 offen offset:128
s_xor_b32 s64, s65, 235520
s_cmpk_gt_u32 s69, 59
s_waitcnt vmcnt(6)
s_cbranch_scc1 L_d_56
s_waitcnt vmcnt(4)
L_d_56:
buffer_load_dwordx4 v[244:247], v1, s[40:43], s64 offen nt
s_xor_b32 s64, s65, 168960
s_cmpk_gt_u32 s69, 60
s_waitcnt vmcnt(6)
s_cbranch_scc1 L_d_57
s_waitcnt vmcnt(4)
L_d_57:
buffer_load_dwordx4 v[248:251], v1, s[40:43], s64 offen nt
s_xor_b32 s64, s65, 234496
s_cmpk_gt_u32 s69, 61
s_waitcnt vmcnt(6)
s_cbranch_scc1 L_d_58
s_waitcnt vmcnt(4)
L_d_58:
buffer_load_dwordx4 v[252:255], v1, s[40:43], s64 offen nt
s_mul_i32 s70, s34, 15360
s_add_u32 s70, s70, 69632
s_add_u32 m0, s70, 0
s_xor_b32 s64, s65, 171008
s_cmpk_gt_u32 s69, 62
s_waitcnt vmcnt(6)
s_cbranch_scc1 L_d_59
s_waitcnt vmcnt(4)
L_d_59:
buffer_load_dwordx4 v1, s[40:43], s64 offen nt lds
s_add_u32 m0, s70, 1024
s_xor_b32 s64, s65, 236544
s_cmpk_gt_u32 s69, 63
s_waitcnt vmcnt(6)
s_cbranch_scc1 L_d_60
s_waitcnt vmcnt(4)
L_d_60:
buffer_load_dwordx4 v1, s[40:43], s64 offen nt lds
s_add_u32 m0, s70, 2048
s_xor_b32 s64, s65, 0
s_cmpk_gt_u32 s69, 64
s_waitcnt vmcnt(6)
s_cbranch_scc1 L_d_61
s_waitcnt vmcnt(4)
L_d_61:
buffer_load_dwordx4 v1, s[44:47], s64 offen nt lds
s_add_u32 m0, s70, 3072
s_xor_b32 s64, s65, 65536
s_cmpk_gt_u32 s69, 65
s_waitcnt vmcnt(6)
s_cbranch_scc1 L_d_62
s_waitcnt vmcnt(4)
L_d_62:
buffer_load_dwordx4 v1, s[44:47], s64 offen nt lds
s_add_u32 m0, s70, 4096
s_xor_b32 s64, s65, 2048
s_cmpk_gt_u32 s69, 66
s_waitcnt vmcnt(6)
s_cbranch_scc1 L_d_63
s_waitcnt vmcnt(4)
L_d_63:
buffer_load_dwordx4 v1, s[44:47], s64 offen nt lds
s_add_u32 m0, s70, 5120
s_xor_b32 s64, s65, 67584
s_cmpk_gt_u32 s69, 67
s_waitcnt vmcnt(6)
s_cbranch_scc1 L_d_64
s_waitcnt vmcnt(4)
L_d_64:
buffer_load_dwordx4 v1, s[44:47], s64 offen nt lds
v_cmp_eq_u32 vcc, 0, v3
s_cbranch_vccz L_jf_66
s_mov_b32 s75, 0
L_poll_67:
v_and_b32 v2, 31, v0
v_lshlrev_b32 v2, 2, v2
buffer_load_dword v3, v2, s[52:55], 0 offen offset:128 sc1
s_waitcnt vmcnt(0)
v_cmp_eq_u32 vcc, 0, v3
s_cbranch_vccz L_pollx_68
s_sleep 40
s_add_u32 s75, s75, 1
s_cmp_lt_u32 s75, 0x100000
s_cbranch_scc1 L_poll_67
L_pollx_68:
L_jf_66:
s_mul_i32 s68, s32, 12288
s_lshl_b32 s67, s33, 8
s_add_u32 s68, s68, s67
s_add_u32 s68, s68, 16384
v_and_b32 v2, 0xf0, v1
buffer_load_dwordx4 v[4:7], v2, s[36:39], s68 offen sc1
s_add_u32 m0, s70, 6144
s_xor_b32 s64, s65, 1024
s_cmpk_gt_u32 s69, 68
s_waitcnt vmcnt(6)
s_cbranch_scc1 L_d_65
s_waitcnt vmcnt(4)
L_d_65:
buffer_load_dwordx4 v1, s[44:47], s64 offen nt lds
s_add_u32 m0, s70, 7168
s_xor_b32 s64, s65, 66560
s_cmpk_gt_u32 s69, 69
s_waitcnt vmcnt(6)
s_cbranch_scc1 L_d_69
s_waitcnt vmcnt(4)
L_d_69:
buffer_load_dwordx4 v1, s[44:47], s64 offen nt lds
s_add_u32 m0, s70, 8192
s_xor_b32 s64, s65, 3072
s_cmpk_gt_u32 s69, 70
s_waitcnt vmcnt(6)
s_cbranch_scc1 L_d_70
s_waitcnt vmcnt(4)
L_d_70:
buffer_load_dwordx4 v1, s[44:47], s64 offen nt lds
s_add_u32 m0, s70, 9216
s_xor_b32 s64, s65, 68608
s_cmpk_gt_u32 s69, 71
s_waitcnt vmcnt(6)
s_cbranch_scc1 L_d_71
s_waitcnt vmcnt(4)
L_d_71:
buffer_load_dwordx4 v1, s[44:47], s64 offen nt lds
s_add_u32 m0, s70, 10240
s_xor_b32 s64, s65, 32768
s_cmpk_gt_u32 s69, 72
s_waitcnt vmcnt(6)
s_cbranch_scc1 L_d_72
s_waitcnt vmcnt(4)
L_d_72:
buffer_load_dwordx4 v1, s[44:47], s64 offen nt lds
s_add_u32 m0, s70, 11264
s_xor_b32 s64, s65, 98304
s_cmpk_gt_u32 s69, 73
s_waitcnt vmcnt(6)
s_cbranch_scc1 L_d_73
s_waitcnt vmcnt(4)
L_d_73:
buffer_load_dwordx4 v1, s[44:47], s64 offen nt lds
s_add_u32 m0, s70, 12288
s_xor_b32 s64, s65, 34816
s_cmpk_gt_u32 s69, 74
s_waitcnt vmcnt(6)
s_cbranch_scc1 L_d_74
s_waitcnt vmcnt(4)
L_d_74:
buffer_load_dwordx4 v1, s[44:47], s64 offen nt lds
s_add_u32 m0, s70, 13312
s_xor_b32 s64, s65, 100352
s_cmpk_gt_u32 s69, 75
s_waitcnt vmcnt(6)
s_cbranch_scc1 L_d_75
s_waitcnt vmcnt(4)
L_d_75:
buffer_load_dwordx4 v1, s[44:47], s64 offen nt lds
s_add_u32 m0, s70, 14336
s_xor_b32 s64, s65, 33792
s_cmpk_gt_u32 s69, 76
s_waitcnt vmcnt(6)
s_cbranch_scc1 L_d_76
s_waitcnt vmcnt(4)
L_d_76:
buffer_load_dwordx4 v1, s[44:47], s64 offen nt lds
v_max3_u32 v3, v4, v5, v6
v_max_u32 v3, v3, v7
v_cmp_eq_u32 vcc, -1, v3
s_cbranch_vccz L_q_77
s_mov_b32 s75, 0
L_poll_78:
s_mul_i32 s68, s32, 12288
s_lshl_b32 s67, s33, 8
s_add_u32 s68, s68, s67
s_add_u32 s68, s68, 16384
v_and_b32 v2, 0xf0, v1
buffer_load_dwordx4 v[4:7], v2, s[36:39], s68 offen sc1
s_waitcnt vmcnt(0)
v_max3_u32 v3, v4, v5, v6
v_max_u32 v3, v3, v7
v_cmp_eq_u32 vcc, -1, v3
s_cbranch_vccz L_pollx_79
s_add_u32 s75, s75, 1
s_cmp_lt_u32 s75, 0x100000
s_cbranch_scc1 L_poll_78
L_pollx_79:
L_q_77:
s_mov_b32 s66, 0x3db504f3
v_dot2_f32_bf16 v8, v8, v4, 0
v_dot2_f32_bf16 v12, v12, v4, 0
v_dot2_f32_bf16 v16, v16, v4, 0
v_dot2_f32_bf16 v20, v20, v4, 0
v_dot2c_f32_bf16 v8, v9, v5
v_dot2c_f32_bf16 v12, v13, v5
v_dot2c_f32_bf16 v16, v17, v5
v_dot2c_f32_bf16 v20, v21, v5
v_dot2c_f32_bf16 v8, v10, v6
v_dot2c_f32_bf16 v12, v14, v6
v_dot2c_f32_bf16 v16, v18, v6
v_dot2c_f32_bf16 v20, v22, v6
v_dot2c_f32_bf16 v8, v11, v7
v_dot2c_f32_bf16 v12, v15, v7
v_dot2c_f32_bf16 v16, v19, v7
v_dot2c_f32_bf16 v20, v23, v7
v_add_f32_dpp v9, v8, v8 row_ror:8 row_mask:0xf bank_mask:0x3
v_add_f32_dpp v13, v12, v12 row_ror:8 row_mask:0xf bank_mask:0x3
v_add_f32_dpp v9, v16, v16 row_ror:8 row_mask:0xf bank_mask:0xc
v_add_f32_dpp v13, v20, v20 row_ror:8 row_mask:0xf bank_mask:0xc
s_nop 0
v_add_f32_dpp v17, v9, v9 row_shl:4 row_mask:0xf bank_mask:0x5
v_add_f32_dpp v17, v13, v13 row_shr:4 row_mask:0xf bank_mask:0xa
s_nop 1
v_add_f32_dpp v17, v17, v17 quad_perm:[1,0,3,2] row_mask:0xf bank_mask:0xf
s_nop 1
v_add_f32_dpp v17, v17, v17 quad_perm:[2,3,0,1] row_mask:0xf bank_mask:0xf
v_cvt_pk_bf16_f32 v17, 0, v17
v_mul_f32 v17, s66, v17
v_cvt_pk_bf16_f32 v17, 0, v17
v_dot2_f32_bf16 v24, v24, v4, 0
v_dot2_f32_bf16 v28, v28, v4, 0
v_dot2_f32_bf16 v32, v32, v4, 0
v_dot2_f32_bf16 v36, v36, v4, 0
v_dot2c_f32_bf16 v24, v25, v5
v_dot2c_f32_bf16 v28, v29, v5
v_dot2c_f32_bf16 v32, v33, v5
v_dot2c_f32_bf16 v36, v37, v5
v_dot2c_f32_bf16 v24, v26, v6
v_dot2c_f32_bf16 v28, v30, v6
v_dot2c_f32_bf16 v32, v34, v6
v_dot2c_f32_bf16 v36, v38, v6
v_dot2c_f32_bf16 v24, v27, v7
v_dot2c_f32_bf16 v28, v31, v7
v_dot2c_f32_bf16 v32, v35, v7
v_dot2c_f32_bf16 v36, v39, v7
v_add_f32_dpp v25, v24, v24 row_ror:8 row_mask:0xf bank_mask:0x3
v_add_f32_dpp v29, v28, v28 row_ror:8 row_mask:0xf bank_mask:0x3
v_add_f32_dpp v25, v32, v32 row_ror:8 row_mask:0xf bank_mask:0xc
v_add_f32_dpp v29, v36, v36 row_ror:8 row_mask:0xf bank_mask:0xc
s_nop 0
v_add_f32_dpp v8, v25, v25 row_shl:4 row_mask:0xf bank_mask:0x5
v_add_f32_dpp v8, v29, v29 row_shr:4 row_mask:0xf bank_mask:0xa
s_nop 1
v_add_f32_dpp v8, v8, v8 quad_perm:[1,0,3,2] row_mask:0xf bank_mask:0xf
s_nop 1
v_add_f32_dpp v8, v8, v8 quad_perm:[2,3,0,1] row_mask:0xf bank_mask:0xf
v_cvt_pk_bf16_f32 v8, 0, v8
v_mul_f32 v8, s66, v8
v_cvt_pk_bf16_f32 v8, 0, v8
s_xor_b32 s64, s65, 99328
s_cmpk_gt_u32 s69, 77
s_waitcnt vmcnt(6)
s_cbranch_scc1 L_d_80
s_waitcnt vmcnt(4)
L_d_80:
buffer_load_dwordx4 v[24:27], v1, s[44:47], s64 offen nt
v_dot2_f32_bf16 v40, v40, v4, 0
v_dot2_f32_bf16 v44, v44, v4, 0
v_dot2_f32_bf16 v48, v48, v4, 0
v_dot2_f32_bf16 v52, v52, v4, 0
v_dot2c_f32_bf16 v40, v41, v5
v_dot2c_f32_bf16 v44, v45, v5
v_dot2c_f32_bf16 v48, v49, v5
v_dot2c_f32_bf16 v52, v53, v5
v_dot2c_f32_bf16 v40, v42, v6
v_dot2c_f32_bf16 v44, v46, v6
v_dot2c_f32_bf16 v48, v50, v6
v_dot2c_f32_bf16 v52, v54, v6
v_dot2c_f32_bf16 v40, v43, v7
v_dot2c_f32_bf16 v44, v47, v7
v_dot2c_f32_bf16 v48, v51, v7
v_dot2c_f32_bf16 v52, v55, v7
v_add_f32_dpp v41, v40, v40 row_ror:8 row_mask:0xf bank_mask:0x3
v_add_f32_dpp v45, v44, v44 row_ror:8 row_mask:0xf bank_mask:0x3
v_add_f32_dpp v41, v48, v48 row_ror:8 row_mask:0xf bank_mask:0xc
v_add_f32_dpp v45, v52, v52 row_ror:8 row_mask:0xf bank_mask:0xc
s_nop 0
v_add_f32_dpp v9, v41, v41 row_shl:4 row_mask:0xf bank_mask:0x5
v_add_f32_dpp v9, v45, v45 row_shr:4 row_mask:0xf bank_mask:0xa
s_nop 1
v_add_f32_dpp v9, v9, v9 quad_perm:[1,0,3,2] row_mask:0xf bank_mask:0xf
s_nop 1
v_add_f32_dpp v9, v9, v9 quad_perm:[2,3,0,1] row_mask:0xf bank_mask:0xf
v_cvt_pk_bf16_f32 v9, 0, v9
v_mul_f32 v9, s66, v9
v_cvt_pk_bf16_f32 v9, 0, v9
s_and_b32 s62, s2, 7
s_lshl_b32 s62, s62, 9
s_add_u32 s62, s62, 1327104
s_lshr_b32 s63, s2, 3
s_lshl_b32 s63, s63, 2
s_add_u32 s63, s63, s62
s_cmp_eq_u32 s34, 0
s_cbranch_scc0 L_w_82
v_mov_b32 v2, 14
s_mov_b64 exec, 1
buffer_store_dword v2, off, s[36:39], s63 offset:0
s_mov_b64 exec, -1
L_w_82:
s_xor_b32 s64, s65, 35840
s_cmpk_gt_u32 s69, 78
s_waitcnt vmcnt(6)
s_cbranch_scc1 L_d_81
s_waitcnt vmcnt(4)
L_d_81:
buffer_load_dwordx4 v[28:31], v1, s[44:47], s64 offen nt
v_dot2_f32_bf16 v56, v56, v4, 0
v_dot2_f32_bf16 v60, v60, v4, 0
v_dot2_f32_bf16 v64, v64, v4, 0
v_dot2_f32_bf16 v68, v68, v4, 0
v_dot2c_f32_bf16 v56, v57, v5
v_dot2c_f32_bf16 v60, v61, v5
v_dot2c_f32_bf16 v64, v65, v5
v_dot2c_f32_bf16 v68, v69, v5
v_dot2c_f32_bf16 v56, v58, v6
v_dot2c_f32_bf16 v60, v62, v6
v_dot2c_f32_bf16 v64, v66, v6
v_dot2c_f32_bf16 v68, v70, v6
v_dot2c_f32_bf16 v56, v59, v7
v_dot2c_f32_bf16 v60, v63, v7
v_dot2c_f32_bf16 v64, v67, v7
v_dot2c_f32_bf16 v68, v71, v7
v_add_f32_dpp v57, v56, v56 row_ror:8 row_mask:0xf bank_mask:0x3
v_add_f32_dpp v61, v60, v60 row_ror:8 row_mask:0xf bank_mask:0x3
v_add_f32_dpp v57, v64, v64 row_ror:8 row_mask:0xf bank_mask:0xc
v_add_f32_dpp v61, v68, v68 row_ror:8 row_mask:0xf bank_mask:0xc
s_nop 0
v_add_f32_dpp v10, v57, v57 row_shl:4 row_mask:0xf bank_mask:0x5
v_add_f32_dpp v10, v61, v61 row_shr:4 row_mask:0xf bank_mask:0xa
s_nop 1
v_add_f32_dpp v10, v10, v10 quad_perm:[1,0,3,2] row_mask:0xf bank_mask:0xf
s_nop 1
v_add_f32_dpp v10, v10, v10 quad_perm:[2,3,0,1] row_mask:0xf bank_mask:0xf
v_cvt_pk_bf16_f32 v10, 0, v10
v_mul_f32 v10, s66, v10
v_cvt_pk_bf16_f32 v10, 0, v10
s_xor_b32 s64, s65, 101376
s_cmpk_gt_u32 s69, 79
s_waitcnt vmcnt(6)
s_cbranch_scc1 L_d_83
s_waitcnt vmcnt(4)
L_d_83:
buffer_load_dwordx4 v[32:35], v1, s[44:47], s64 offen nt
v_dot2_f32_bf16 v72, v72, v4, 0
v_dot2_f32_bf16 v76, v76, v4, 0
v_dot2_f32_bf16 v80, v80, v4, 0
v_dot2_f32_bf16 v84, v84, v4, 0
v_dot2c_f32_bf16 v72, v73, v5
v_dot2c_f32_bf16 v76, v77, v5
v_dot2c_f32_bf16 v80, v81, v5
v_dot2c_f32_bf16 v84, v85, v5
v_dot2c_f32_bf16 v72, v74, v6
v_dot2c_f32_bf16 v76, v78, v6
v_dot2c_f32_bf16 v80, v82, v6
v_dot2c_f32_bf16 v84, v86, v6
v_dot2c_f32_bf16 v72, v75, v7
v_dot2c_f32_bf16 v76, v79, v7
v_dot2c_f32_bf16 v80, v83, v7
v_dot2c_f32_bf16 v84, v87, v7
v_add_f32_dpp v73, v72, v72 row_ror:8 row_mask:0xf bank_mask:0x3
v_add_f32_dpp v77, v76, v76 row_ror:8 row_mask:0xf bank_mask:0x3
v_add_f32_dpp v73, v80, v80 row_ror:8 row_mask:0xf bank_mask:0xc
v_add_f32_dpp v77, v84, v84 row_ror:8 row_mask:0xf bank_mask:0xc
s_nop 0
v_add_f32_dpp v11, v73, v73 row_shl:4 row_mask:0xf bank_mask:0x5
v_add_f32_dpp v11, v77, v77 row_shr:4 row_mask:0xf bank_mask:0xa
s_nop 1
v_add_f32_dpp v11, v11, v11 quad_perm:[1,0,3,2] row_mask:0xf bank_mask:0xf
s_nop 1
v_add_f32_dpp v11, v11, v11 quad_perm:[2,3,0,1] row_mask:0xf bank_mask:0xf
v_cvt_pk_bf16_f32 v11, 0, v11
v_mul_f32 v11, s66, v11
v_cvt_pk_bf16_f32 v11, 0, v11
s_xor_b32 s64, s65, 131072
s_cmpk_gt_u32 s69, 80
s_waitcnt vmcnt(6)
s_cbranch_scc1 L_d_84
s_waitcnt vmcnt(4)
L_d_84:
buffer_load_dwordx4 v[36:39], v1, s[44:47], s64 offen nt
v_dot2_f32_bf16 v88, v88, v4, 0
v_dot2_f32_bf16 v92, v92, v4, 0
v_dot2_f32_bf16 v96, v96, v4, 0
v_dot2_f32_bf16 v100, v100, v4, 0
v_dot2c_f32_bf16 v88, v89, v5
v_dot2c_f32_bf16 v92, v93, v5
v_dot2c_f32_bf16 v96, v97, v5
v_dot2c_f32_bf16 v100, v101, v5
v_dot2c_f32_bf16 v88, v90, v6
v_dot2c_f32_bf16 v92, v94, v6
v_dot2c_f32_bf16 v96, v98, v6
v_dot2c_f32_bf16 v100, v102, v6
v_dot2c_f32_bf16 v88, v91, v7
v_dot2c_f32_bf16 v92, v95, v7
v_dot2c_f32_bf16 v96, v99, v7
v_dot2c_f32_bf16 v100, v103, v7
v_add_f32_dpp v89, v88, v88 row_ror:8 row_mask:0xf bank_mask:0x3
v_add_f32_dpp v93, v92, v92 row_ror:8 row_mask:0xf bank_mask:0x3
v_add_f32_dpp v89, v96, v96 row_ror:8 row_mask:0xf bank_mask:0xc
v_add_f32_dpp v93, v100, v100 row_ror:8 row_mask:0xf bank_mask:0xc
s_nop 0
v_add_f32_dpp v12, v89, v89 row_shl:4 row_mask:0xf bank_mask:0x5
v_add_f32_dpp v12, v93, v93 row_shr:4 row_mask:0xf bank_mask:0xa
s_nop 1
v_add_f32_dpp v12, v12, v12 quad_perm:[1,0,3,2] row_mask:0xf bank_mask:0xf
s_nop 1
v_add_f32_dpp v12, v12, v12 quad_perm:[2,3,0,1] row_mask:0xf bank_mask:0xf
v_cvt_pk_bf16_f32 v12, 0, v12
v_mul_f32 v12, s66, v12
v_cvt_pk_bf16_f32 v12, 0, v12
s_xor_b32 s64, s65, 196608
s_cmpk_gt_u32 s69, 81
s_waitcnt vmcnt(6)
s_cbranch_scc1 L_d_85
s_waitcnt vmcnt(4)
L_d_85:
buffer_load_dwordx4 v[40:43], v1, s[44:47], s64 offen nt
v_dot2_f32_bf16 v104, v104, v4, 0
v_dot2_f32_bf16 v108, v108, v4, 0
v_dot2_f32_bf16 v112, v112, v4, 0
v_dot2_f32_bf16 v116, v116, v4, 0
v_dot2c_f32_bf16 v104, v105, v5
v_dot2c_f32_bf16 v108, v109, v5
v_dot2c_f32_bf16 v112, v113, v5
v_dot2c_f32_bf16 v116, v117, v5
v_dot2c_f32_bf16 v104, v106, v6
v_dot2c_f32_bf16 v108, v110, v6
v_dot2c_f32_bf16 v112, v114, v6
v_dot2c_f32_bf16 v116, v118, v6
v_dot2c_f32_bf16 v104, v107, v7
v_dot2c_f32_bf16 v108, v111, v7
v_dot2c_f32_bf16 v112, v115, v7
v_dot2c_f32_bf16 v116, v119, v7
v_add_f32_dpp v105, v104, v104 row_ror:8 row_mask:0xf bank_mask:0x3
v_add_f32_dpp v109, v108, v108 row_ror:8 row_mask:0xf bank_mask:0x3
v_add_f32_dpp v105, v112, v112 row_ror:8 row_mask:0xf bank_mask:0xc
v_add_f32_dpp v109, v116, v116 row_ror:8 row_mask:0xf bank_mask:0xc
s_nop 0
v_add_f32_dpp v13, v105, v105 row_shl:4 row_mask:0xf bank_mask:0x5
v_add_f32_dpp v13, v109, v109 row_shr:4 row_mask:0xf bank_mask:0xa
s_nop 1
v_add_f32_dpp v13, v13, v13 quad_perm:[1,0,3,2] row_mask:0xf bank_mask:0xf
s_nop 1
v_add_f32_dpp v13, v13, v13 quad_perm:[2,3,0,1] row_mask:0xf bank_mask:0xf
v_cvt_pk_bf16_f32 v13, 0, v13
v_mul_f32 v13, s66, v13
v_cvt_pk_bf16_f32 v13, 0, v13
s_xor_b32 s64, s65, 133120
s_cmpk_gt_u32 s69, 82
s_waitcnt vmcnt(6)
s_cbranch_scc1 L_d_86
s_waitcnt vmcnt(4)
L_d_86:
buffer_load_dwordx4 v[44:47], v1, s[44:47], s64 offen nt
v_dot2_f32_bf16 v120, v120, v4, 0
v_dot2_f32_bf16 v124, v124, v4, 0
v_dot2_f32_bf16 v128, v128, v4, 0
v_dot2_f32_bf16 v132, v132, v4, 0
v_dot2c_f32_bf16 v120, v121, v5
v_dot2c_f32_bf16 v124, v125, v5
v_dot2c_f32_bf16 v128, v129, v5
v_dot2c_f32_bf16 v132, v133, v5
v_dot2c_f32_bf16 v120, v122, v6
v_dot2c_f32_bf16 v124, v126, v6
v_dot2c_f32_bf16 v128, v130, v6
v_dot2c_f32_bf16 v132, v134, v6
v_dot2c_f32_bf16 v120, v123, v7
v_dot2c_f32_bf16 v124, v127, v7
v_dot2c_f32_bf16 v128, v131, v7
v_dot2c_f32_bf16 v132, v135, v7
v_add_f32_dpp v121, v120, v120 row_ror:8 row_mask:0xf bank_mask:0x3
v_add_f32_dpp v125, v124, v124 row_ror:8 row_mask:0xf bank_mask:0x3
v_add_f32_dpp v121, v128, v128 row_ror:8 row_mask:0xf bank_mask:0xc
v_add_f32_dpp v125, v132, v132 row_ror:8 row_mask:0xf bank_mask:0xc
s_nop 0
v_add_f32_dpp v14, v121, v121 row_shl:4 row_mask:0xf bank_mask:0x5
v_add_f32_dpp v14, v125, v125 row_shr:4 row_mask:0xf bank_mask:0xa
s_nop 1
v_add_f32_dpp v14, v14, v14 quad_perm:[1,0,3,2] row_mask:0xf bank_mask:0xf
s_nop 1
v_add_f32_dpp v14, v14, v14 quad_perm:[2,3,0,1] row_mask:0xf bank_mask:0xf
v_cvt_pk_bf16_f32 v14, 0, v14
v_mul_f32 v14, s66, v14
v_cvt_pk_bf16_f32 v14, 0, v14
s_xor_b32 s64, s65, 198656
s_cmpk_gt_u32 s69, 83
s_waitcnt vmcnt(6)
s_cbranch_scc1 L_d_87
s_waitcnt vmcnt(4)
L_d_87:
buffer_load_dwordx4 v[48:51], v1, s[44:47], s64 offen nt
v_dot2_f32_bf16 v136, v136, v4, 0
v_dot2_f32_bf16 v140, v140, v4, 0
v_dot2_f32_bf16 v144, v144, v4, 0
v_dot2_f32_bf16 v148, v148, v4, 0
v_dot2c_f32_bf16 v136, v137, v5
v_dot2c_f32_bf16 v140, v141, v5
v_dot2c_f32_bf16 v144, v145, v5
v_dot2c_f32_bf16 v148, v149, v5
v_dot2c_f32_bf16 v136, v138, v6
v_dot2c_f32_bf16 v140, v142, v6
v_dot2c_f32_bf16 v144, v146, v6
v_dot2c_f32_bf16 v148, v150, v6
v_dot2c_f32_bf16 v136, v139, v7
v_dot2c_f32_bf16 v140, v143, v7
v_dot2c_f32_bf16 v144, v147, v7
v_dot2c_f32_bf16 v148, v151, v7
v_add_f32_dpp v137, v136, v136 row_ror:8 row_mask:0xf bank_mask:0x3
v_add_f32_dpp v141, v140, v140 row_ror:8 row_mask:0xf bank_mask:0x3
v_add_f32_dpp v137, v144, v144 row_ror:8 row_mask:0xf bank_mask:0xc
v_add_f32_dpp v141, v148, v148 row_ror:8 row_mask:0xf bank_mask:0xc
s_nop 0
v_add_f32_dpp v15, v137, v137 row_shl:4 row_mask:0xf bank_mask:0x5
v_add_f32_dpp v15, v141, v141 row_shr:4 row_mask:0xf bank_mask:0xa
s_nop 1
v_add_f32_dpp v15, v15, v15 quad_perm:[1,0,3,2] row_mask:0xf bank_mask:0xf
s_nop 1
v_add_f32_dpp v15, v15, v15 quad_perm:[2,3,0,1] row_mask:0xf bank_mask:0xf
v_cvt_pk_bf16_f32 v15, 0, v15
v_mul_f32 v15, s66, v15
v_cvt_pk_bf16_f32 v15, 0, v15
s_xor_b32 s64, s65, 132096
s_cmpk_gt_u32 s69, 84
s_waitcnt vmcnt(6)
s_cbranch_scc1 L_d_88
s_waitcnt vmcnt(4)
L_d_88:
buffer_load_dwordx4 v[52:55], v1, s[44:47], s64 offen nt
v_dot2_f32_bf16 v152, v152, v4, 0
v_dot2_f32_bf16 v156, v156, v4, 0
v_dot2_f32_bf16 v160, v160, v4, 0
v_dot2_f32_bf16 v164, v164, v4, 0
v_dot2c_f32_bf16 v152, v153, v5
v_dot2c_f32_bf16 v156, v157, v5
v_dot2c_f32_bf16 v160, v161, v5
v_dot2c_f32_bf16 v164, v165, v5
v_dot2c_f32_bf16 v152, v154, v6
v_dot2c_f32_bf16 v156, v158, v6
v_dot2c_f32_bf16 v160, v162, v6
v_dot2c_f32_bf16 v164, v166, v6
v_dot2c_f32_bf16 v152, v155, v7
v_dot2c_f32_bf16 v156, v159, v7
v_dot2c_f32_bf16 v160, v163, v7
v_dot2c_f32_bf16 v164, v167, v7
v_add_f32_dpp v153, v152, v152 row_ror:8 row_mask:0xf bank_mask:0x3
v_add_f32_dpp v157, v156, v156 row_ror:8 row_mask:0xf bank_mask:0x3
v_add_f32_dpp v153, v160, v160 row_ror:8 row_mask:0xf bank_mask:0xc
v_add_f32_dpp v157, v164, v164 row_ror:8 row_mask:0xf bank_mask:0xc
s_nop 0
v_add_f32_dpp v16, v153, v153 row_shl:4 row_mask:0xf bank_mask:0x5
v_add_f32_dpp v16, v157, v157 row_shr:4 row_mask:0xf bank_mask:0xa
s_nop 1
v_add_f32_dpp v16, v16, v16 quad_perm:[1,0,3,2] row_mask:0xf bank_mask:0xf
s_nop 1
v_add_f32_dpp v16, v16, v16 quad_perm:[2,3,0,1] row_mask:0xf bank_mask:0xf
v_cvt_pk_bf16_f32 v16, 0, v16
v_mul_f32 v16, s66, v16
v_cvt_pk_bf16_f32 v16, 0, v16
s_xor_b32 s64, s65, 197632
s_cmpk_gt_u32 s69, 85
s_waitcnt vmcnt(6)
s_cbranch_scc1 L_d_89
s_waitcnt vmcnt(4)
L_d_89:
buffer_load_dwordx4 v[56:59], v1, s[44:47], s64 offen nt
v_dot2_f32_bf16 v168, v168, v4, 0
v_dot2_f32_bf16 v172, v172, v4, 0
v_dot2_f32_bf16 v176, v176, v4, 0
v_dot2_f32_bf16 v180, v180, v4, 0
v_dot2c_f32_bf16 v168, v169, v5
v_dot2c_f32_bf16 v172, v173, v5
v_dot2c_f32_bf16 v176, v177, v5
v_dot2c_f32_bf16 v180, v181, v5
v_dot2c_f32_bf16 v168, v170, v6
v_dot2c_f32_bf16 v172, v174, v6
v_dot2c_f32_bf16 v176, v178, v6
v_dot2c_f32_bf16 v180, v182, v6
v_dot2c_f32_bf16 v168, v171, v7
v_dot2c_f32_bf16 v172, v175, v7
v_dot2c_f32_bf16 v176, v179, v7
v_dot2c_f32_bf16 v180, v183, v7
v_add_f32_dpp v169, v168, v168 row_ror:8 row_mask:0xf bank_mask:0x3
v_add_f32_dpp v173, v172, v172 row_ror:8 row_mask:0xf bank_mask:0x3
v_add_f32_dpp v169, v176, v176 row_ror:8 row_mask:0xf bank_mask:0xc
v_add_f32_dpp v173, v180, v180 row_ror:8 row_mask:0xf bank_mask:0xc
s_nop 0
v_add_f32_dpp v18, v169, v169 row_shl:4 row_mask:0xf bank_mask:0x5
v_add_f32_dpp v18, v173, v173 row_shr:4 row_mask:0xf bank_mask:0xa
s_nop 1
v_add_f32_dpp v18, v18, v18 quad_perm:[1,0,3,2] row_mask:0xf bank_mask:0xf
s_nop 1
v_add_f32_dpp v18, v18, v18 quad_perm:[2,3,0,1] row_mask:0xf bank_mask:0xf
v_cvt_pk_bf16_f32 v18, 0, v18
v_mul_f32 v18, s66, v18
v_cvt_pk_bf16_f32 v18, 0, v18
s_cmp_eq_u32 s34, 1
s_cbranch_scc0 L_w_91
v_mov_b32 v60, 22
s_mov_b64 exec, 1
buffer_store_dword v60, off, s[36:39], s63 offset:0
s_mov_b64 exec, -1
L_w_91:
s_xor_b32 s64, s65, 134144
s_cmpk_gt_u32 s69, 86
s_waitcnt vmcnt(6)
s_cbranch_scc1 L_d_90
s_waitcnt vmcnt(4)
L_d_90:
buffer_load_dwordx4 v[64:67], v1, s[44:47], s64 offen nt
v_dot2_f32_bf16 v184, v184, v4, 0
v_dot2_f32_bf16 v188, v188, v4, 0
v_dot2_f32_bf16 v192, v192, v4, 0
v_dot2_f32_bf16 v196, v196, v4, 0
v_dot2c_f32_bf16 v184, v185, v5
v_dot2c_f32_bf16 v188, v189, v5
v_dot2c_f32_bf16 v192, v193, v5
v_dot2c_f32_bf16 v196, v197, v5
v_dot2c_f32_bf16 v184, v186, v6
v_dot2c_f32_bf16 v188, v190, v6
v_dot2c_f32_bf16 v192, v194, v6
v_dot2c_f32_bf16 v196, v198, v6
v_dot2c_f32_bf16 v184, v187, v7
v_dot2c_f32_bf16 v188, v191, v7
v_dot2c_f32_bf16 v192, v195, v7
v_dot2c_f32_bf16 v196, v199, v7
v_add_f32_dpp v185, v184, v184 row_ror:8 row_mask:0xf bank_mask:0x3
v_add_f32_dpp v189, v188, v188 row_ror:8 row_mask:0xf bank_mask:0x3
v_add_f32_dpp v185, v192, v192 row_ror:8 row_mask:0xf bank_mask:0xc
v_add_f32_dpp v189, v196, v196 row_ror:8 row_mask:0xf bank_mask:0xc
s_nop 0
v_add_f32_dpp v19, v185, v185 row_shl:4 row_mask:0xf bank_mask:0x5
v_add_f32_dpp v19, v189, v189 row_shr:4 row_mask:0xf bank_mask:0xa
s_nop 1
v_add_f32_dpp v19, v19, v19 quad_perm:[1,0,3,2] row_mask:0xf bank_mask:0xf
s_nop 1
v_add_f32_dpp v19, v19, v19 quad_perm:[2,3,0,1] row_mask:0xf bank_mask:0xf
v_cvt_pk_bf16_f32 v19, 0, v19
v_mul_f32 v19, s66, v19
v_cvt_pk_bf16_f32 v19, 0, v19
s_xor_b32 s64, s65, 199680
s_cmpk_gt_u32 s69, 87
s_waitcnt vmcnt(6)
s_cbranch_scc1 L_d_92
s_waitcnt vmcnt(4)
L_d_92:
buffer_load_dwordx4 v[68:71], v1, s[44:47], s64 offen nt
v_dot2_f32_bf16 v200, v200, v4, 0
v_dot2_f32_bf16 v204, v204, v4, 0
v_dot2_f32_bf16 v208, v208, v4, 0
v_dot2_f32_bf16 v212, v212, v4, 0
v_dot2c_f32_bf16 v200, v201, v5
v_dot2c_f32_bf16 v204, v205, v5
v_dot2c_f32_bf16 v208, v209, v5
v_dot2c_f32_bf16 v212, v213, v5
v_dot2c_f32_bf16 v200, v202, v6
v_dot2c_f32_bf16 v204, v206, v6
v_dot2c_f32_bf16 v208, v210, v6
v_dot2c_f32_bf16 v212, v214, v6
v_dot2c_f32_bf16 v200, v203, v7
v_dot2c_f32_bf16 v204, v207, v7
v_dot2c_f32_bf16 v208, v211, v7
v_dot2c_f32_bf16 v212, v215, v7
v_add_f32_dpp v201, v200, v200 row_ror:8 row_mask:0xf bank_mask:0x3
v_add_f32_dpp v205, v204, v204 row_ror:8 row_mask:0xf bank_mask:0x3
v_add_f32_dpp v201, v208, v208 row_ror:8 row_mask:0xf bank_mask:0xc
v_add_f32_dpp v205, v212, v212 row_ror:8 row_mask:0xf bank_mask:0xc
s_nop 0
v_add_f32_dpp v20, v201, v201 row_shl:4 row_mask:0xf bank_mask:0x5
v_add_f32_dpp v20, v205, v205 row_shr:4 row_mask:0xf bank_mask:0xa
s_nop 1
v_add_f32_dpp v20, v20, v20 quad_perm:[1,0,3,2] row_mask:0xf bank_mask:0xf
s_nop 1
v_add_f32_dpp v20, v20, v20 quad_perm:[2,3,0,1] row_mask:0xf bank_mask:0xf
v_cvt_pk_bf16_f32 v20, 0, v20
v_mul_f32 v20, s66, v20
v_cvt_pk_bf16_f32 v20, 0, v20
s_xor_b32 s64, s65, 163840
s_cmpk_gt_u32 s69, 88
s_waitcnt vmcnt(6)
s_cbranch_scc1 L_d_93
s_waitcnt vmcnt(4)
L_d_93:
buffer_load_dwordx4 v[72:75], v1, s[44:47], s64 offen nt
v_dot2_f32_bf16 v216, v216, v4, 0
v_dot2_f32_bf16 v220, v220, v4, 0
v_dot2_f32_bf16 v224, v224, v4, 0
v_dot2_f32_bf16 v228, v228, v4, 0
v_dot2c_f32_bf16 v216, v217, v5
v_dot2c_f32_bf16 v220, v221, v5
v_dot2c_f32_bf16 v224, v225, v5
v_dot2c_f32_bf16 v228, v229, v5
v_dot2c_f32_bf16 v216, v218, v6
v_dot2c_f32_bf16 v220, v222, v6
v_dot2c_f32_bf16 v224, v226, v6
v_dot2c_f32_bf16 v228, v230, v6
v_dot2c_f32_bf16 v216, v219, v7
v_dot2c_f32_bf16 v220, v223, v7
v_dot2c_f32_bf16 v224, v227, v7
v_dot2c_f32_bf16 v228, v231, v7
v_add_f32_dpp v217, v216, v216 row_ror:8 row_mask:0xf bank_mask:0x3
v_add_f32_dpp v221, v220, v220 row_ror:8 row_mask:0xf bank_mask:0x3
v_add_f32_dpp v217, v224, v224 row_ror:8 row_mask:0xf bank_mask:0xc
v_add_f32_dpp v221, v228, v228 row_ror:8 row_mask:0xf bank_mask:0xc
s_nop 0
v_add_f32_dpp v21, v217, v217 row_shl:4 row_mask:0xf bank_mask:0x5
v_add_f32_dpp v21, v221, v221 row_shr:4 row_mask:0xf bank_mask:0xa
s_nop 1
v_add_f32_dpp v21, v21, v21 quad_perm:[1,0,3,2] row_mask:0xf bank_mask:0xf
s_nop 1
v_add_f32_dpp v21, v21, v21 quad_perm:[2,3,0,1] row_mask:0xf bank_mask:0xf
v_cvt_pk_bf16_f32 v21, 0, v21
v_mul_f32 v21, s66, v21
v_cvt_pk_bf16_f32 v21, 0, v21
s_xor_b32 s64, s65, 229376
s_cmpk_gt_u32 s69, 89
s_waitcnt vmcnt(6)
s_cbranch_scc1 L_d_94
s_waitcnt vmcnt(4)
L_d_94:
buffer_load_dwordx4 v[76:79], v1, s[44:47], s64 offen nt
v_dot2_f32_bf16 v232, v232, v4, 0
v_dot2_f32_bf16 v236, v236, v4, 0
v_dot2_f32_bf16 v240, v240, v4, 0
v_dot2_f32_bf16 v244, v244, v4, 0
v_dot2c_f32_bf16 v232, v233, v5
v_dot2c_f32_bf16 v236, v237, v5
v_dot2c_f32_bf16 v240, v241, v5
v_dot2c_f32_bf16 v244, v245, v5
v_dot2c_f32_bf16 v232, v234, v6
v_dot2c_f32_bf16 v236, v238, v6
v_dot2c_f32_bf16 v240, v242, v6
v_dot2c_f32_bf16 v244, v246, v6
v_dot2c_f32_bf16 v232, v235, v7
v_dot2c_f32_bf16 v236, v239, v7
v_dot2c_f32_bf16 v240, v243, v7
v_dot2c_f32_bf16 v244, v247, v7
v_add_f32_dpp v233, v232, v232 row_ror:8 row_mask:0xf bank_mask:0x3
v_add_f32_dpp v237, v236, v236 row_ror:8 row_mask:0xf bank_mask:0x3
v_add_f32_dpp v233, v240, v240 row_ror:8 row_mask:0xf bank_mask:0xc
v_add_f32_dpp v237, v244, v244 row_ror:8 row_mask:0xf bank_mask:0xc
s_nop 0
v_add_f32_dpp v22, v233, v233 row_shl:4 row_mask:0xf bank_mask:0x5
v_add_f32_dpp v22, v237, v237 row_shr:4 row_mask:0xf bank_mask:0xa
s_nop 1
v_add_f32_dpp v22, v22, v22 quad_perm:[1,0,3,2] row_mask:0xf bank_mask:0xf
s_nop 1
v_add_f32_dpp v22, v22, v22 quad_perm:[2,3,0,1] row_mask:0xf bank_mask:0xf
v_cvt_pk_bf16_f32 v22, 0, v22
v_mul_f32 v22, s66, v22
v_cvt_pk_bf16_f32 v22, 0, v22
s_xor_b32 s64, s65, 165888
s_cmpk_gt_u32 s69, 90
s_waitcnt vmcnt(6)
s_cbranch_scc1 L_d_95
s_waitcnt vmcnt(5)
L_d_95:
buffer_load_dwordx4 v[80:83], v1, s[44:47], s64 offen nt
v_lshl_add_u32 v84, v0, 4, s70
ds_read_b128 v[88:91], v84 offset:0
ds_read_b128 v[92:95], v84 offset:1024
s_waitcnt lgkmcnt(0)
v_dot2_f32_bf16 v248, v248, v4, 0
v_dot2_f32_bf16 v252, v252, v4, 0
v_dot2_f32_bf16 v88, v88, v4, 0
v_dot2_f32_bf16 v92, v92, v4, 0
v_dot2c_f32_bf16 v248, v249, v5
v_dot2c_f32_bf16 v252, v253, v5
v_dot2c_f32_bf16 v88, v89, v5
v_dot2c_f32_bf16 v92, v93, v5
v_dot2c_f32_bf16 v248, v250, v6
v_dot2c_f32_bf16 v252, v254, v6
v_dot2c_f32_bf16 v88, v90, v6
v_dot2c_f32_bf16 v92, v94, v6
v_dot2c_f32_bf16 v248, v251, v7
v_dot2c_f32_bf16 v252, v255, v7
v_dot2c_f32_bf16 v88, v91, v7
v_dot2c_f32_bf16 v92, v95, v7
v_add_f32_dpp v249, v248, v248 row_ror:8 row_mask:0xf bank_mask:0x3
v_add_f32_dpp v253, v252, v252 row_ror:8 row_mask:0xf bank_mask:0x3
v_add_f32_dpp v249, v88, v88 row_ror:8 row_mask:0xf bank_mask:0xc
v_add_f32_dpp v253, v92, v92 row_ror:8 row_mask:0xf bank_mask:0xc
s_nop 0
v_add_f32_dpp v23, v249, v249 row_shl:4 row_mask:0xf bank_mask:0x5
v_add_f32_dpp v23, v253, v253 row_shr:4 row_mask:0xf bank_mask:0xa
s_nop 1
v_add_f32_dpp v23, v23, v23 quad_perm:[1,0,3,2] row_mask:0xf bank_mask:0xf
s_nop 1
v_add_f32_dpp v23, v23, v23 quad_perm:[2,3,0,1] row_mask:0xf bank_mask:0xf
v_cvt_pk_bf16_f32 v23, 0, v23
v_mul_f32 v23, s66, v23
v_cvt_pk_bf16_f32 v23, 0, v23
s_xor_b32 s64, s65, 231424
s_cmpk_gt_u32 s69, 91
s_waitcnt vmcnt(6)
s_cbranch_scc1 L_d_96
s_waitcnt vmcnt(5)
L_d_96:
buffer_load_dwordx4 v[96:99], v1, s[44:47], s64 offen nt
v_max3_f32 v2, v17, v8, v9
v_max3_f32 v2, v2, v10, v11
v_max3_f32 v2, v2, v12, v13
v_max3_f32 v2, v2, v14, v15
v_max3_f32 v2, v2, v16, v18
v_max3_f32 v2, v2, v19, v20
v_max3_f32 v2, v2, v21, v22
v_max_f32 v2, v2, v23
v_max_f32 v2, 0xff7fffff, v2
s_nop 1
v_max_f32_dpp v2, v2, v2 row_ror:4 row_mask:0xf bank_mask:0xf
s_nop 1
v_max_f32_dpp v2, v2, v2 row_ror:8 row_mask:0xf bank_mask:0xf
v_mov_b32 v3, v2
s_nop 1
v_permlane16_swap_b32 v2, v3
s_nop 1
v_max_f32 v2, v2, v3
v_mov_b32 v3, v2
s_nop 1
v_permlane32_swap_b32 v2, v3
s_nop 1
v_max_f32 v2, v2, v3
s_mov_b32 s67, 0x3fb8aa3b
v_sub_f32 v17, v17, v2
v_sub_f32 v8, v8, v2
v_sub_f32 v9, v9, v2
v_sub_f32 v10, v10, v2
v_sub_f32 v11, v11, v2
v_sub_f32 v12, v12, v2
v_sub_f32 v13, v13, v2
v_sub_f32 v14, v14, v2
v_sub_f32 v15, v15, v2
v_sub_f32 v16, v16, v2
v_sub_f32 v18, v18, v2
v_sub_f32 v19, v19, v2
v_sub_f32 v20, v20, v2
v_sub_f32 v21, v21, v2
v_sub_f32 v22, v22, v2
v_sub_f32 v23, v23, v2
v_mul_f32 v17, s67, v17
v_mul_f32 v8, s67, v8
v_mul_f32 v9, s67, v9
v_mul_f32 v10, s67, v10
v_mul_f32 v11, s67, v11
v_mul_f32 v12, s67, v12
v_mul_f32 v13, s67, v13
v_mul_f32 v14, s67, v14
v_mul_f32 v15, s67, v15
v_mul_f32 v16, s67, v16
v_mul_f32 v18, s67, v18
v_mul_f32 v19, s67, v19
v_mul_f32 v20, s67, v20
v_mul_f32 v21, s67, v21
v_mul_f32 v22, s67, v22
v_mul_f32 v23, s67, v23
s_xor_b32 s64, s65, 164864
s_cmpk_gt_u32 s69, 92
s_waitcnt vmcnt(6)
s_cbranch_scc1 L_d_97
s_waitcnt vmcnt(5)
L_d_97:
buffer_load_dwordx4 v[120:123], v1, s[44:47], s64 offen nt
v_exp_f32 v17, v17
v_exp_f32 v8, v8
v_exp_f32 v9, v9
v_exp_f32 v10, v10
v_exp_f32 v11, v11
v_exp_f32 v12, v12
v_exp_f32 v13, v13
v_exp_f32 v14, v14
v_exp_f32 v15, v15
v_exp_f32 v16, v16
v_exp_f32 v18, v18
v_exp_f32 v19, v19
v_exp_f32 v20, v20
v_exp_f32 v21, v21
v_exp_f32 v22, v22
v_exp_f32 v23, v23
v_add_f32 v3, v17, v8
v_add_f32 v3, v3, v9
v_add_f32 v3, v3, v10
v_add_f32 v3, v3, v11
v_add_f32 v3, v3, v12
v_add_f32 v3, v3, v13
v_add_f32 v3, v3, v14
v_add_f32 v3, v3, v15
v_add_f32 v3, v3, v16
v_add_f32 v3, v3, v18
v_add_f32 v3, v3, v19
v_add_f32 v3, v3, v20
v_add_f32 v3, v3, v21
v_add_f32 v3, v3, v22
v_add_f32 v3, v3, v23
s_nop 1
v_add_f32_dpp v3, v3, v3 row_ror:4 row_mask:0xf bank_mask:0xf
s_nop 1
v_add_f32_dpp v3, v3, v3 row_ror:8 row_mask:0xf bank_mask:0xf
v_mov_b32 v100, v3
s_nop 1
v_permlane16_swap_b32 v3, v100
s_nop 1
v_add_f32 v3, v3, v100
v_mov_b32 v100, v3
s_nop 1
v_permlane32_swap_b32 v3, v100
s_nop 1
v_add_f32 v3, v3, v100
v_min_u32 v3, -2, v3
s_lshl_b32 s68, s34, 3
v_mov_b32 v100, s68
ds_write_b64 v100, v[2:3] offset:256
v_and_b32 v101, 15, v0
v_lshrrev_b32 v102, 1, v101
v_and_b32 v101, 1, v0
v_lshlrev_b32 v101, 4, v101
v_mov_b32 v103, 0xffff
v_lshlrev_b32 v101, v101, v103
v_cmp_eq_u32 vcc, 0, v102
s_nop 1
v_cndmask_b32 v4, 0, v101, vcc
v_cmp_eq_u32 vcc, 1, v102
s_nop 1
v_cndmask_b32 v5, 0, v101, vcc
v_cmp_eq_u32 vcc, 2, v102
s_nop 1
v_cndmask_b32 v6, 0, v101, vcc
v_cmp_eq_u32 vcc, 3, v102
s_nop 1
v_cndmask_b32 v7, 0, v101, vcc
s_xor_b32 s64, s65, 230400
s_cmpk_gt_u32 s69, 93
s_waitcnt vmcnt(6)
s_cbranch_scc1 L_d_98
s_waitcnt vmcnt(5)
L_d_98:
buffer_load_dwordx4 v[124:127], v1, s[44:47], s64 offen nt
v_mov_b32 v100, 0
s_mov_b32 s75, 0
L_poll_99:
ds_read_b128 v[104:107], v100 offset:256
ds_read_b128 v[108:111], v100 offset:272
s_waitcnt lgkmcnt(0)
v_max3_u32 v101, v105, v107, v109
v_max_u32 v101, v101, v111
v_cmp_eq_u32 vcc, -1, v101
s_cbranch_vccz L_pollx_100
s_add_u32 s75, s75, 1
s_cmp_lt_u32 s75, 0x1000000
s_cbranch_scc1 L_poll_99
L_pollx_100:
v_max3_f32 v101, v104, v106, v108
v_max_f32 v101, v101, v110
v_sub_f32 v104, v104, v101
v_sub_f32 v106, v106, v101
v_sub_f32 v108, v108, v101
v_sub_f32 v110, v110, v101
v_sub_f32 v2, v2, v101
v_mul_f32 v104, s67, v104
v_mul_f32 v106, s67, v106
v_mul_f32 v108, s67, v108
v_mul_f32 v110, s67, v110
v_mul_f32 v2, s67, v2
v_exp_f32 v104, v104
v_exp_f32 v106, v106
v_exp_f32 v108, v108
v_exp_f32 v110, v110
v_exp_f32 v2, v2
v_mul_f32 v3, v104, v105
v_fmac_f32 v3, v106, v107
v_fmac_f32 v3, v108, v109
v_fmac_f32 v3, v110, v111
v_rcp_f32 v3, v3
s_nop 0
v_mul_f32 v2, v2, v3
v_mul_f32 v17, v17, v2
v_mul_f32 v8, v8, v2
v_mul_f32 v9, v9, v2
v_mul_f32 v10, v10, v2
v_mul_f32 v11, v11, v2
v_mul_f32 v12, v12, v2
v_mul_f32 v13, v13, v2
v_mul_f32 v14, v14, v2
v_mul_f32 v15, v15, v2
v_mul_f32 v16, v16, v2
v_mul_f32 v18, v18, v2
v_mul_f32 v19, v19, v2
v_mul_f32 v20, v20, v2
v_mul_f32 v21, v21, v2
v_mul_f32 v22, v22, v2
v_mul_f32 v23, v23, v2
v_cvt_pk_bf16_f32 v17, v17, v17
v_cvt_pk_bf16_f32 v8, v8, v8
v_cvt_pk_bf16_f32 v9, v9, v9
v_cvt_pk_bf16_f32 v10, v10, v10
v_cvt_pk_bf16_f32 v11, v11, v11
v_cvt_pk_bf16_f32 v12, v12, v12
v_cvt_pk_bf16_f32 v13, v13, v13
v_cvt_pk_bf16_f32 v14, v14, v14
v_cvt_pk_bf16_f32 v15, v15, v15
v_cvt_pk_bf16_f32 v16, v16, v16
v_cvt_pk_bf16_f32 v18, v18, v18
v_cvt_pk_bf16_f32 v19, v19, v19
v_cvt_pk_bf16_f32 v20, v20, v20
v_cvt_pk_bf16_f32 v21, v21, v21
v_cvt_pk_bf16_f32 v22, v22, v22
v_cvt_pk_bf16_f32 v23, v23, v23
s_nop 1
s_cmp_eq_u32 s34, 2
s_cbranch_scc0 L_w_102
v_mov_b32 v60, 30
s_mov_b64 exec, 1
buffer_store_dword v60, off, s[36:39], s63 offset:0
s_mov_b64 exec, -1
L_w_102:
s_xor_b32 s64, s65, 166912
s_cmpk_gt_u32 s69, 94
s_waitcnt vmcnt(6)
s_cbranch_scc1 L_d_101
s_waitcnt vmcnt(5)
L_d_101:
buffer_load_dwordx4 v[128:131], v1, s[44:47], s64 offen nt
ds_read_b128 v[132:135], v84 offset:2048
ds_read_b128 v[136:139], v84 offset:3072
ds_read_b128 v[140:143], v84 offset:4096
ds_read_b128 v[144:147], v84 offset:5120
ds_read_b128 v[148:151], v84 offset:6144
ds_read_b128 v[152:155], v84 offset:7168
ds_read_b128 v[156:159], v84 offset:8192
ds_read_b128 v[160:163], v84 offset:9216
s_waitcnt lgkmcnt(0)
v_and_b32_dpp v104, v17, v4 row_newbcast:0 row_mask:0xf bank_mask:0xf
v_and_b32_dpp v105, v17, v5 row_newbcast:0 row_mask:0xf bank_mask:0xf
v_and_b32_dpp v106, v17, v6 row_newbcast:0 row_mask:0xf bank_mask:0xf
v_and_b32_dpp v107, v17, v7 row_newbcast:0 row_mask:0xf bank_mask:0xf
v_and_b32_dpp v108, v17, v4 row_newbcast:4 row_mask:0xf bank_mask:0xf
v_and_b32_dpp v109, v17, v5 row_newbcast:4 row_mask:0xf bank_mask:0xf
v_and_b32_dpp v110, v17, v6 row_newbcast:4 row_mask:0xf bank_mask:0xf
v_and_b32_dpp v111, v17, v7 row_newbcast:4 row_mask:0xf bank_mask:0xf
v_mfma_f32_16x16x32_bf16 v[112:115], v[104:107], v[132:135], 0
v_and_b32_dpp v104, v17, v4 row_newbcast:8 row_mask:0xf bank_mask:0xf
v_and_b32_dpp v105, v17, v5 row_newbcast:8 row_mask:0xf bank_mask:0xf
v_and_b32_dpp v106, v17, v6 row_newbcast:8 row_mask:0xf bank_mask:0xf
v_and_b32_dpp v107, v17, v7 row_newbcast:8 row_mask:0xf bank_mask:0xf
v_mfma_f32_16x16x32_bf16 v[112:115], v[108:111], v[136:139], v[112:115]
v_and_b32_dpp v108, v17, v4 row_newbcast:12 row_mask:0xf bank_mask:0xf
v_and_b32_dpp v109, v17, v5 row_newbcast:12 row_mask:0xf bank_mask:0xf
v_and_b32_dpp v110, v17, v6 row_newbcast:12 row_mask:0xf bank_mask:0xf
v_and_b32_dpp v111, v17, v7 row_newbcast:12 row_mask:0xf bank_mask:0xf
v_mfma_f32_16x16x32_bf16 v[112:115], v[104:107], v[140:143], v[112:115]
s_xor_b32 s64, s65, 232448
s_cmpk_gt_u32 s69, 95
s_waitcnt vmcnt(6)
s_cbranch_scc1 L_d_103
s_waitcnt vmcnt(5)
L_d_103:
buffer_load_dwordx4 v[164:167], v1, s[44:47], s64 offen nt
v_and_b32_dpp v104, v8, v4 row_newbcast:0 row_mask:0xf bank_mask:0xf
v_and_b32_dpp v105, v8, v5 row_newbcast:0 row_mask:0xf bank_mask:0xf
v_and_b32_dpp v106, v8, v6 row_newbcast:0 row_mask:0xf bank_mask:0xf
v_and_b32_dpp v107, v8, v7 row_newbcast:0 row_mask:0xf bank_mask:0xf
v_mfma_f32_16x16x32_bf16 v[112:115], v[108:111], v[144:147], v[112:115]
v_and_b32_dpp v108, v8, v4 row_newbcast:4 row_mask:0xf bank_mask:0xf
v_and_b32_dpp v109, v8, v5 row_newbcast:4 row_mask:0xf bank_mask:0xf
v_and_b32_dpp v110, v8, v6 row_newbcast:4 row_mask:0xf bank_mask:0xf
v_and_b32_dpp v111, v8, v7 row_newbcast:4 row_mask:0xf bank_mask:0xf
v_mfma_f32_16x16x32_bf16 v[112:115], v[104:107], v[148:151], v[112:115]
v_and_b32_dpp v104, v8, v4 row_newbcast:8 row_mask:0xf bank_mask:0xf
v_and_b32_dpp v105, v8, v5 row_newbcast:8 row_mask:0xf bank_mask:0xf
v_and_b32_dpp v106, v8, v6 row_newbcast:8 row_mask:0xf bank_mask:0xf
v_and_b32_dpp v107, v8, v7 row_newbcast:8 row_mask:0xf bank_mask:0xf
v_mfma_f32_16x16x32_bf16 v[112:115], v[108:111], v[152:155], v[112:115]
s_xor_b32 s64, s65, 4096
s_cmpk_gt_u32 s69, 96
s_waitcnt vmcnt(6)
s_cbranch_scc1 L_d_104
s_waitcnt vmcnt(5)
L_d_104:
buffer_load_dwordx4 v[168:171], v1, s[44:47], s64 offen nt
v_and_b32_dpp v108, v8, v4 row_newbcast:12 row_mask:0xf bank_mask:0xf
v_and_b32_dpp v109, v8, v5 row_newbcast:12 row_mask:0xf bank_mask:0xf
v_and_b32_dpp v110, v8, v6 row_newbcast:12 row_mask:0xf bank_mask:0xf
v_and_b32_dpp v111, v8, v7 row_newbcast:12 row_mask:0xf bank_mask:0xf
v_mfma_f32_16x16x32_bf16 v[112:115], v[104:107], v[156:159], v[112:115]
v_and_b32_dpp v104, v9, v4 row_newbcast:0 row_mask:0xf bank_mask:0xf
v_and_b32_dpp v105, v9, v5 row_newbcast:0 row_mask:0xf bank_mask:0xf
v_and_b32_dpp v106, v9, v6 row_newbcast:0 row_mask:0xf bank_mask:0xf
v_and_b32_dpp v107, v9, v7 row_newbcast:0 row_mask:0xf bank_mask:0xf
v_mfma_f32_16x16x32_bf16 v[112:115], v[108:111], v[160:163], v[112:115]
ds_read_b128 v[172:175], v84 offset:10240
ds_read_b128 v[176:179], v84 offset:11264
ds_read_b128 v[180:183], v84 offset:12288
ds_read_b128 v[184:187], v84 offset:13312
ds_read_b128 v[188:191], v84 offset:14336
s_waitcnt lgkmcnt(0)
v_and_b32_dpp v108, v9, v4 row_newbcast:4 row_mask:0xf bank_mask:0xf
v_and_b32_dpp v109, v9, v5 row_newbcast:4 row_mask:0xf bank_mask:0xf
v_and_b32_dpp v110, v9, v6 row_newbcast:4 row_mask:0xf bank_mask:0xf
v_and_b32_dpp v111, v9, v7 row_newbcast:4 row_mask:0xf bank_mask:0xf
v_mfma_f32_16x16x32_bf16 v[112:115], v[104:107], v[172:175], v[112:115]
s_xor_b32 s64, s65, 69632
s_cmpk_gt_u32 s69, 97
s_waitcnt vmcnt(6)
s_cbranch_scc1 L_d_105
s_waitcnt vmcnt(5)
L_d_105:
buffer_load_dwordx4 v[192:195], v1, s[44:47], s64 offen nt
v_and_b32_dpp v104, v9, v4 row_newbcast:8 row_mask:0xf bank_mask:0xf
v_and_b32_dpp v105, v9, v5 row_newbcast:8 row_mask:0xf bank_mask:0xf
v_and_b32_dpp v106, v9, v6 row_newbcast:8 row_mask:0xf bank_mask:0xf
v_and_b32_dpp v107, v9, v7 row_newbcast:8 row_mask:0xf bank_mask:0xf
v_mfma_f32_16x16x32_bf16 v[112:115], v[108:111], v[176:179], v[112:115]
v_and_b32_dpp v108, v9, v4 row_newbcast:12 row_mask:0xf bank_mask:0xf
v_and_b32_dpp v109, v9, v5 row_newbcast:12 row_mask:0xf bank_mask:0xf
v_and_b32_dpp v110, v9, v6 row_newbcast:12 row_mask:0xf bank_mask:0xf
v_and_b32_dpp v111, v9, v7 row_newbcast:12 row_mask:0xf bank_mask:0xf
v_mfma_f32_16x16x32_bf16 v[112:115], v[104:107], v[180:183], v[112:115]
v_and_b32_dpp v104, v10, v4 row_newbcast:0 row_mask:0xf bank_mask:0xf
v_and_b32_dpp v105, v10, v5 row_newbcast:0 row_mask:0xf bank_mask:0xf
v_and_b32_dpp v106, v10, v6 row_newbcast:0 row_mask:0xf bank_mask:0xf
v_and_b32_dpp v107, v10, v7 row_newbcast:0 row_mask:0xf bank_mask:0xf
v_mfma_f32_16x16x32_bf16 v[112:115], v[108:111], v[184:187], v[112:115]
s_xor_b32 s64, s65, 6144
s_cmpk_gt_u32 s69, 98
s_waitcnt vmcnt(6)
s_cbranch_scc1 L_d_106
s_waitcnt vmcnt(5)
L_d_106:
buffer_load_dwordx4 v[196:199], v1, s[44:47], s64 offen nt
v_and_b32_dpp v108, v10, v4 row_newbcast:4 row_mask:0xf bank_mask:0xf
v_and_b32_dpp v109, v10, v5 row_newbcast:4 row_mask:0xf bank_mask:0xf
v_and_b32_dpp v110, v10, v6 row_newbcast:4 row_mask:0xf bank_mask:0xf
v_and_b32_dpp v111, v10, v7 row_newbcast:4 row_mask:0xf bank_mask:0xf
v_mfma_f32_16x16x32_bf16 v[112:115], v[104:107], v[188:191], v[112:115]
v_and_b32_dpp v104, v10, v4 row_newbcast:8 row_mask:0xf bank_mask:0xf
v_and_b32_dpp v105, v10, v5 row_newbcast:8 row_mask:0xf bank_mask:0xf
v_and_b32_dpp v106, v10, v6 row_newbcast:8 row_mask:0xf bank_mask:0xf
v_and_b32_dpp v107, v10, v7 row_newbcast:8 row_mask:0xf bank_mask:0xf
v_mfma_f32_16x16x32_bf16 v[112:115], v[108:111], v[24:27], v[112:115]
v_and_b32_dpp v108, v10, v4 row_newbcast:12 row_mask:0xf bank_mask:0xf
v_and_b32_dpp v109, v10, v5 row_newbcast:12 row_mask:0xf bank_mask:0xf
v_and_b32_dpp v110, v10, v6 row_newbcast:12 row_mask:0xf bank_mask:0xf
v_and_b32_dpp v111, v10, v7 row_newbcast:12 row_mask:0xf bank_mask:0xf
v_mfma_f32_16x16x32_bf16 v[112:115], v[104:107], v[28:31], v[112:115]
s_xor_b32 s64, s65, 71680
s_cmpk_gt_u32 s69, 99
s_waitcnt vmcnt(6)
s_cbranch_scc1 L_d_107
s_waitcnt vmcnt(5)
L_d_107:
buffer_load_dwordx4 v[200:203], v1, s[44:47], s64 offen nt
v_and_b32_dpp v104, v11, v4 row_newbcast:0 row_mask:0xf bank_mask:0xf
v_and_b32_dpp v105, v11, v5 row_newbcast:0 row_mask:0xf bank_mask:0xf
v_and_b32_dpp v106, v11, v6 row_newbcast:0 row_mask:0xf bank_mask:0xf
v_and_b32_dpp v107, v11, v7 row_newbcast:0 row_mask:0xf bank_mask:0xf
v_mfma_f32_16x16x32_bf16 v[112:115], v[108:111], v[32:35], v[112:115]
v_and_b32_dpp v108, v11, v4 row_newbcast:4 row_mask:0xf bank_mask:0xf
v_and_b32_dpp v109, v11, v5 row_newbcast:4 row_mask:0xf bank_mask:0xf
v_and_b32_dpp v110, v11, v6 row_newbcast:4 row_mask:0xf bank_mask:0xf
v_and_b32_dpp v111, v11, v7 row_newbcast:4 row_mask:0xf bank_mask:0xf
v_mfma_f32_16x16x32_bf16 v[112:115], v[104:107], v[36:39], v[112:115]
v_and_b32_dpp v104, v11, v4 row_newbcast:8 row_mask:0xf bank_mask:0xf
v_and_b32_dpp v105, v11, v5 row_newbcast:8 row_mask:0xf bank_mask:0xf
v_and_b32_dpp v106, v11, v6 row_newbcast:8 row_mask:0xf bank_mask:0xf
v_and_b32_dpp v107, v11, v7 row_newbcast:8 row_mask:0xf bank_mask:0xf
v_mfma_f32_16x16x32_bf16 v[112:115], v[108:111], v[40:43], v[112:115]
s_xor_b32 s64, s65, 5120
s_cmpk_gt_u32 s69, 100
s_waitcnt vmcnt(6)
s_cbranch_scc1 L_d_108
s_waitcnt vmcnt(5)
L_d_108:
buffer_load_dwordx4 v[204:207], v1, s[44:47], s64 offen nt
v_and_b32_dpp v108, v11, v4 row_newbcast:12 row_mask:0xf bank_mask:0xf
v_and_b32_dpp v109, v11, v5 row_newbcast:12 row_mask:0xf bank_mask:0xf
v_and_b32_dpp v110, v11, v6 row_newbcast:12 row_mask:0xf bank_mask:0xf
v_and_b32_dpp v111, v11, v7 row_newbcast:12 row_mask:0xf bank_mask:0xf
v_mfma_f32_16x16x32_bf16 v[112:115], v[104:107], v[44:47], v[112:115]
v_and_b32_dpp v104, v12, v4 row_newbcast:0 row_mask:0xf bank_mask:0xf
v_and_b32_dpp v105, v12, v5 row_newbcast:0 row_mask:0xf bank_mask:0xf
v_and_b32_dpp v106, v12, v6 row_newbcast:0 row_mask:0xf bank_mask:0xf
v_and_b32_dpp v107, v12, v7 row_newbcast:0 row_mask:0xf bank_mask:0xf
v_mfma_f32_16x16x32_bf16 v[112:115], v[108:111], v[48:51], v[112:115]
v_and_b32_dpp v108, v12, v4 row_newbcast:4 row_mask:0xf bank_mask:0xf
v_and_b32_dpp v109, v12, v5 row_newbcast:4 row_mask:0xf bank_mask:0xf
v_and_b32_dpp v110, v12, v6 row_newbcast:4 row_mask:0xf bank_mask:0xf
v_and_b32_dpp v111, v12, v7 row_newbcast:4 row_mask:0xf bank_mask:0xf
v_mfma_f32_16x16x32_bf16 v[112:115], v[104:107], v[52:55], v[112:115]
s_xor_b32 s64, s65, 70656
s_cmpk_gt_u32 s69, 101
s_waitcnt vmcnt(6)
s_cbranch_scc1 L_d_109
s_waitcnt vmcnt(5)
L_d_109:
buffer_load_dwordx4 v[208:211], v1, s[44:47], s64 offen nt
v_and_b32_dpp v104, v12, v4 row_newbcast:8 row_mask:0xf bank_mask:0xf
v_and_b32_dpp v105, v12, v5 row_newbcast:8 row_mask:0xf bank_mask:0xf
v_and_b32_dpp v106, v12, v6 row_newbcast:8 row_mask:0xf bank_mask:0xf
v_and_b32_dpp v107, v12, v7 row_newbcast:8 row_mask:0xf bank_mask:0xf
v_mfma_f32_16x16x32_bf16 v[112:115], v[108:111], v[56:59], v[112:115]
v_and_b32_dpp v108, v12, v4 row_newbcast:12 row_mask:0xf bank_mask:0xf
v_and_b32_dpp v109, v12, v5 row_newbcast:12 row_mask:0xf bank_mask:0xf
v_and_b32_dpp v110, v12, v6 row_newbcast:12 row_mask:0xf bank_mask:0xf
v_and_b32_dpp v111, v12, v7 row_newbcast:12 row_mask:0xf bank_mask:0xf
v_mfma_f32_16x16x32_bf16 v[112:115], v[104:107], v[64:67], v[112:115]
v_and_b32_dpp v104, v13, v4 row_newbcast:0 row_mask:0xf bank_mask:0xf
v_and_b32_dpp v105, v13, v5 row_newbcast:0 row_mask:0xf bank_mask:0xf
v_and_b32_dpp v106, v13, v6 row_newbcast:0 row_mask:0xf bank_mask:0xf
v_and_b32_dpp v107, v13, v7 row_newbcast:0 row_mask:0xf bank_mask:0xf
v_mfma_f32_16x16x32_bf16 v[112:115], v[108:111], v[68:71], v[112:115]
s_cmp_eq_u32 s34, 3
s_cbranch_scc0 L_w_111
v_mov_b32 v60, 38
s_mov_b64 exec, 1
buffer_store_dword v60, off, s[36:39], s63 offset:0
s_mov_b64 exec, -1
L_w_111:
s_xor_b32 s64, s65, 7168
s_cmpk_gt_u32 s69, 102
s_waitcnt vmcnt(6)
s_cbranch_scc1 L_d_110
s_waitcnt vmcnt(5)
L_d_110:
buffer_load_dwordx4 v[212:215], v1, s[44:47], s64 offen nt
v_and_b32_dpp v108, v13, v4 row_newbcast:4 row_mask:0xf bank_mask:0xf
v_and_b32_dpp v109, v13, v5 row_newbcast:4 row_mask:0xf bank_mask:0xf
v_and_b32_dpp v110, v13, v6 row_newbcast:4 row_mask:0xf bank_mask:0xf
v_and_b32_dpp v111, v13, v7 row_newbcast:4 row_mask:0xf bank_mask:0xf
v_mfma_f32_16x16x32_bf16 v[112:115], v[104:107], v[72:75], v[112:115]
v_and_b32_dpp v104, v13, v4 row_newbcast:8 row_mask:0xf bank_mask:0xf
v_and_b32_dpp v105, v13, v5 row_newbcast:8 row_mask:0xf bank_mask:0xf
v_and_b32_dpp v106, v13, v6 row_newbcast:8 row_mask:0xf bank_mask:0xf
v_and_b32_dpp v107, v13, v7 row_newbcast:8 row_mask:0xf bank_mask:0xf
v_mfma_f32_16x16x32_bf16 v[112:115], v[108:111], v[76:79], v[112:115]
v_and_b32_dpp v108, v13, v4 row_newbcast:12 row_mask:0xf bank_mask:0xf
v_and_b32_dpp v109, v13, v5 row_newbcast:12 row_mask:0xf bank_mask:0xf
v_and_b32_dpp v110, v13, v6 row_newbcast:12 row_mask:0xf bank_mask:0xf
v_and_b32_dpp v111, v13, v7 row_newbcast:12 row_mask:0xf bank_mask:0xf
v_mfma_f32_16x16x32_bf16 v[112:115], v[104:107], v[80:83], v[112:115]
s_xor_b32 s64, s65, 72704
s_cmpk_gt_u32 s69, 103
s_waitcnt vmcnt(6)
s_cbranch_scc1 L_d_112
s_waitcnt vmcnt(5)
L_d_112:
buffer_load_dwordx4 v[216:219], v1, s[44:47], s64 offen nt
v_and_b32_dpp v104, v14, v4 row_newbcast:0 row_mask:0xf bank_mask:0xf
v_and_b32_dpp v105, v14, v5 row_newbcast:0 row_mask:0xf bank_mask:0xf
v_and_b32_dpp v106, v14, v6 row_newbcast:0 row_mask:0xf bank_mask:0xf
v_and_b32_dpp v107, v14, v7 row_newbcast:0 row_mask:0xf bank_mask:0xf
v_mfma_f32_16x16x32_bf16 v[112:115], v[108:111], v[96:99], v[112:115]
v_and_b32_dpp v108, v14, v4 row_newbcast:4 row_mask:0xf bank_mask:0xf
v_and_b32_dpp v109, v14, v5 row_newbcast:4 row_mask:0xf bank_mask:0xf
v_and_b32_dpp v110, v14, v6 row_newbcast:4 row_mask:0xf bank_mask:0xf
v_and_b32_dpp v111, v14, v7 row_newbcast:4 row_mask:0xf bank_mask:0xf
v_mfma_f32_16x16x32_bf16 v[112:115], v[104:107], v[120:123], v[112:115]
v_and_b32_dpp v104, v14, v4 row_newbcast:8 row_mask:0xf bank_mask:0xf
v_and_b32_dpp v105, v14, v5 row_newbcast:8 row_mask:0xf bank_mask:0xf
v_and_b32_dpp v106, v14, v6 row_newbcast:8 row_mask:0xf bank_mask:0xf
v_and_b32_dpp v107, v14, v7 row_newbcast:8 row_mask:0xf bank_mask:0xf
v_mfma_f32_16x16x32_bf16 v[112:115], v[108:111], v[124:127], v[112:115]
s_xor_b32 s64, s65, 36864
s_cmpk_gt_u32 s69, 104
s_waitcnt vmcnt(6)
s_cbranch_scc1 L_d_113
s_waitcnt vmcnt(5)
L_d_113:
buffer_load_dwordx4 v[220:223], v1, s[44:47], s64 offen nt
v_and_b32_dpp v108, v14, v4 row_newbcast:12 row_mask:0xf bank_mask:0xf
v_and_b32_dpp v109, v14, v5 row_newbcast:12 row_mask:0xf bank_mask:0xf
v_and_b32_dpp v110, v14, v6 row_newbcast:12 row_mask:0xf bank_mask:0xf
v_and_b32_dpp v111, v14, v7 row_newbcast:12 row_mask:0xf bank_mask:0xf
v_mfma_f32_16x16x32_bf16 v[112:115], v[104:107], v[128:131], v[112:115]
v_and_b32_dpp v104, v15, v4 row_newbcast:0 row_mask:0xf bank_mask:0xf
v_and_b32_dpp v105, v15, v5 row_newbcast:0 row_mask:0xf bank_mask:0xf
v_and_b32_dpp v106, v15, v6 row_newbcast:0 row_mask:0xf bank_mask:0xf
v_and_b32_dpp v107, v15, v7 row_newbcast:0 row_mask:0xf bank_mask:0xf
v_mfma_f32_16x16x32_bf16 v[112:115], v[108:111], v[164:167], v[112:115]
v_and_b32_dpp v108, v15, v4 row_newbcast:4 row_mask:0xf bank_mask:0xf
v_and_b32_dpp v109, v15, v5 row_newbcast:4 row_mask:0xf bank_mask:0xf
v_and_b32_dpp v110, v15, v6 row_newbcast:4 row_mask:0xf bank_mask:0xf
v_and_b32_dpp v111, v15, v7 row_newbcast:4 row_mask:0xf bank_mask:0xf
v_mfma_f32_16x16x32_bf16 v[112:115], v[104:107], v[168:171], v[112:115]
s_xor_b32 s64, s65, 102400
s_cmpk_gt_u32 s69, 105
s_waitcnt vmcnt(6)
s_cbranch_scc1 L_d_114
s_waitcnt vmcnt(5)
L_d_114:
buffer_load_dwordx4 v[224:227], v1, s[44:47], s64 offen nt
v_and_b32_dpp v104, v15, v4 row_newbcast:8 row_mask:0xf bank_mask:0xf
v_and_b32_dpp v105, v15, v5 row_newbcast:8 row_mask:0xf bank_mask:0xf
v_and_b32_dpp v106, v15, v6 row_newbcast:8 row_mask:0xf bank_mask:0xf
v_and_b32_dpp v107, v15, v7 row_newbcast:8 row_mask:0xf bank_mask:0xf
v_mfma_f32_16x16x32_bf16 v[112:115], v[108:111], v[192:195], v[112:115]
v_and_b32_dpp v108, v15, v4 row_newbcast:12 row_mask:0xf bank_mask:0xf
v_and_b32_dpp v109, v15, v5 row_newbcast:12 row_mask:0xf bank_mask:0xf
v_and_b32_dpp v110, v15, v6 row_newbcast:12 row_mask:0xf bank_mask:0xf
v_and_b32_dpp v111, v15, v7 row_newbcast:12 row_mask:0xf bank_mask:0xf
v_mfma_f32_16x16x32_bf16 v[112:115], v[104:107], v[196:199], v[112:115]
s_xor_b32 s64, s65, 38912
s_cmpk_gt_u32 s69, 106
s_waitcnt vmcnt(6)
s_cbranch_scc1 L_d_115
s_waitcnt vmcnt(5)
L_d_115:
buffer_load_dwordx4 v[228:231], v1, s[44:47], s64 offen nt
v_and_b32_dpp v104, v16, v4 row_newbcast:0 row_mask:0xf bank_mask:0xf
v_and_b32_dpp v105, v16, v5 row_newbcast:0 row_mask:0xf bank_mask:0xf
v_and_b32_dpp v106, v16, v6 row_newbcast:0 row_mask:0xf bank_mask:0xf
v_and_b32_dpp v107, v16, v7 row_newbcast:0 row_mask:0xf bank_mask:0xf
v_mfma_f32_16x16x32_bf16 v[112:115], v[108:111], v[200:203], v[112:115]
s_xor_b32 s64, s65, 104448
s_cmpk_gt_u32 s69, 107
s_waitcnt vmcnt(6)
s_cbranch_scc1 L_d_116
s_waitcnt vmcnt(5)
L_d_116:
buffer_load_dwordx4 v[232:235], v1, s[44:47], s64 offen nt
v_and_b32_dpp v108, v16, v4 row_newbcast:4 row_mask:0xf bank_mask:0xf
v_and_b32_dpp v109, v16, v5 row_newbcast:4 row_mask:0xf bank_mask:0xf
v_and_b32_dpp v110, v16, v6 row_newbcast:4 row_mask:0xf bank_mask:0xf
v_and_b32_dpp v111, v16, v7 row_newbcast:4 row_mask:0xf bank_mask:0xf
v_mfma_f32_16x16x32_bf16 v[112:115], v[104:107], v[204:207], v[112:115]
s_xor_b32 s64, s65, 37888
s_cmpk_gt_u32 s69, 108
s_waitcnt vmcnt(6)
s_cbranch_scc1 L_d_117
s_waitcnt vmcnt(5)
L_d_117:
buffer_load_dwordx4 v[236:239], v1, s[44:47], s64 offen nt
v_and_b32_dpp v104, v16, v4 row_newbcast:8 row_mask:0xf bank_mask:0xf
v_and_b32_dpp v105, v16, v5 row_newbcast:8 row_mask:0xf bank_mask:0xf
v_and_b32_dpp v106, v16, v6 row_newbcast:8 row_mask:0xf bank_mask:0xf
v_and_b32_dpp v107, v16, v7 row_newbcast:8 row_mask:0xf bank_mask:0xf
v_mfma_f32_16x16x32_bf16 v[112:115], v[108:111], v[208:211], v[112:115]
s_xor_b32 s64, s65, 103424
s_cmpk_gt_u32 s69, 109
s_waitcnt vmcnt(6)
s_cbranch_scc1 L_d_118
s_waitcnt vmcnt(5)
L_d_118:
buffer_load_dwordx4 v[240:243], v1, s[44:47], s64 offen nt
v_and_b32_dpp v108, v16, v4 row_newbcast:12 row_mask:0xf bank_mask:0xf
v_and_b32_dpp v109, v16, v5 row_newbcast:12 row_mask:0xf bank_mask:0xf
v_and_b32_dpp v110, v16, v6 row_newbcast:12 row_mask:0xf bank_mask:0xf
v_and_b32_dpp v111, v16, v7 row_newbcast:12 row_mask:0xf bank_mask:0xf
v_mfma_f32_16x16x32_bf16 v[112:115], v[104:107], v[212:215], v[112:115]
s_cmp_eq_u32 s34, 0
s_cbranch_scc0 L_w_120
v_mov_b32 v60, 46
s_mov_b64 exec, 1
buffer_store_dword v60, off, s[36:39], s63 offset:0
s_mov_b64 exec, -1
L_w_120:
s_xor_b32 s64, s65, 39936
s_cmpk_gt_u32 s69, 110
s_waitcnt vmcnt(6)
s_cbranch_scc1 L_d_119
s_waitcnt vmcnt(5)
L_d_119:
buffer_load_dwordx4 v[244:247], v1, s[44:47], s64 offen nt
v_and_b32_dpp v104, v18, v4 row_newbcast:0 row_mask:0xf bank_mask:0xf
v_and_b32_dpp v105, v18, v5 row_newbcast:0 row_mask:0xf bank_mask:0xf
v_and_b32_dpp v106, v18, v6 row_newbcast:0 row_mask:0xf bank_mask:0xf
v_and_b32_dpp v107, v18, v7 row_newbcast:0 row_mask:0xf bank_mask:0xf
v_mfma_f32_16x16x32_bf16 v[112:115], v[108:111], v[216:219], v[112:115]
s_xor_b32 s64, s65, 105472
s_cmpk_gt_u32 s69, 111
s_waitcnt vmcnt(6)
s_cbranch_scc1 L_d_121
s_waitcnt vmcnt(5)
L_d_121:
buffer_load_dwordx4 v[248:251], v1, s[44:47], s64 offen nt
v_and_b32_dpp v108, v18, v4 row_newbcast:4 row_mask:0xf bank_mask:0xf
v_and_b32_dpp v109, v18, v5 row_newbcast:4 row_mask:0xf bank_mask:0xf
v_and_b32_dpp v110, v18, v6 row_newbcast:4 row_mask:0xf bank_mask:0xf
v_and_b32_dpp v111, v18, v7 row_newbcast:4 row_mask:0xf bank_mask:0xf
v_mfma_f32_16x16x32_bf16 v[112:115], v[104:107], v[220:223], v[112:115]
s_xor_b32 s64, s65, 135168
s_waitcnt vmcnt(5)
buffer_load_dwordx4 v[252:255], v1, s[44:47], s64 offen nt
v_and_b32_dpp v104, v18, v4 row_newbcast:8 row_mask:0xf bank_mask:0xf
v_and_b32_dpp v105, v18, v5 row_newbcast:8 row_mask:0xf bank_mask:0xf
v_and_b32_dpp v106, v18, v6 row_newbcast:8 row_mask:0xf bank_mask:0xf
v_and_b32_dpp v107, v18, v7 row_newbcast:8 row_mask:0xf bank_mask:0xf
v_mfma_f32_16x16x32_bf16 v[112:115], v[108:111], v[224:227], v[112:115]
v_and_b32_dpp v108, v18, v4 row_newbcast:12 row_mask:0xf bank_mask:0xf
v_and_b32_dpp v109, v18, v5 row_newbcast:12 row_mask:0xf bank_mask:0xf
v_and_b32_dpp v110, v18, v6 row_newbcast:12 row_mask:0xf bank_mask:0xf
v_and_b32_dpp v111, v18, v7 row_newbcast:12 row_mask:0xf bank_mask:0xf
v_mfma_f32_16x16x32_bf16 v[112:115], v[104:107], v[228:231], v[112:115]
s_xor_b32 s64, s65, 200704
s_waitcnt vmcnt(5)
buffer_load_dwordx4 v[88:91], v1, s[44:47], s64 offen nt
v_and_b32_dpp v104, v19, v4 row_newbcast:0 row_mask:0xf bank_mask:0xf
v_and_b32_dpp v105, v19, v5 row_newbcast:0 row_mask:0xf bank_mask:0xf
v_and_b32_dpp v106, v19, v6 row_newbcast:0 row_mask:0xf bank_mask:0xf
v_and_b32_dpp v107, v19, v7 row_newbcast:0 row_mask:0xf bank_mask:0xf
v_mfma_f32_16x16x32_bf16 v[112:115], v[108:111], v[232:235], v[112:115]
s_xor_b32 s64, s65, 137216
s_waitcnt vmcnt(5)
buffer_load_dwordx4 v[92:95], v1, s[44:47], s64 offen nt
v_and_b32_dpp v108, v19, v4 row_newbcast:4 row_mask:0xf bank_mask:0xf
v_and_b32_dpp v109, v19, v5 row_newbcast:4 row_mask:0xf bank_mask:0xf
v_and_b32_dpp v110, v19, v6 row_newbcast:4 row_mask:0xf bank_mask:0xf
v_and_b32_dpp v111, v19, v7 row_newbcast:4 row_mask:0xf bank_mask:0xf
v_mfma_f32_16x16x32_bf16 v[112:115], v[104:107], v[236:239], v[112:115]
s_xor_b32 s64, s65, 202752
s_waitcnt vmcnt(5)
buffer_load_dwordx4 v[132:135], v1, s[44:47], s64 offen nt
v_and_b32_dpp v104, v19, v4 row_newbcast:8 row_mask:0xf bank_mask:0xf
v_and_b32_dpp v105, v19, v5 row_newbcast:8 row_mask:0xf bank_mask:0xf
v_and_b32_dpp v106, v19, v6 row_newbcast:8 row_mask:0xf bank_mask:0xf
v_and_b32_dpp v107, v19, v7 row_newbcast:8 row_mask:0xf bank_mask:0xf
v_mfma_f32_16x16x32_bf16 v[112:115], v[108:111], v[240:243], v[112:115]
s_xor_b32 s64, s65, 136192
s_waitcnt vmcnt(5)
buffer_load_dwordx4 v[136:139], v1, s[44:47], s64 offen nt
v_and_b32_dpp v108, v19, v4 row_newbcast:12 row_mask:0xf bank_mask:0xf
v_and_b32_dpp v109, v19, v5 row_newbcast:12 row_mask:0xf bank_mask:0xf
v_and_b32_dpp v110, v19, v6 row_newbcast:12 row_mask:0xf bank_mask:0xf
v_and_b32_dpp v111, v19, v7 row_newbcast:12 row_mask:0xf bank_mask:0xf
v_mfma_f32_16x16x32_bf16 v[112:115], v[104:107], v[244:247], v[112:115]
s_xor_b32 s64, s65, 201728
s_waitcnt vmcnt(5)
buffer_load_dwordx4 v[140:143], v1, s[44:47], s64 offen nt
v_and_b32_dpp v104, v20, v4 row_newbcast:0 row_mask:0xf bank_mask:0xf
v_and_b32_dpp v105, v20, v5 row_newbcast:0 row_mask:0xf bank_mask:0xf
v_and_b32_dpp v106, v20, v6 row_newbcast:0 row_mask:0xf bank_mask:0xf
v_and_b32_dpp v107, v20, v7 row_newbcast:0 row_mask:0xf bank_mask:0xf
v_mfma_f32_16x16x32_bf16 v[112:115], v[108:111], v[248:251], v[112:115]
s_cmp_eq_u32 s34, 1
s_cbranch_scc0 L_w_122
v_mov_b32 v60, 54
s_mov_b64 exec, 1
buffer_store_dword v60, off, s[36:39], s63 offset:0
s_mov_b64 exec, -1
L_w_122:
s_xor_b32 s64, s65, 138240
s_waitcnt vmcnt(5)
buffer_load_dwordx4 v[144:147], v1, s[44:47], s64 offen nt
v_and_b32_dpp v108, v20, v4 row_newbcast:4 row_mask:0xf bank_mask:0xf
v_and_b32_dpp v109, v20, v5 row_newbcast:4 row_mask:0xf bank_mask:0xf
v_and_b32_dpp v110, v20, v6 row_newbcast:4 row_mask:0xf bank_mask:0xf
v_and_b32_dpp v111, v20, v7 row_newbcast:4 row_mask:0xf bank_mask:0xf
v_mfma_f32_16x16x32_bf16 v[112:115], v[104:107], v[252:255], v[112:115]
s_xor_b32 s64, s65, 203776
s_waitcnt vmcnt(5)
buffer_load_dwordx4 v[148:151], v1, s[44:47], s64 offen nt
v_and_b32_dpp v104, v20, v4 row_newbcast:8 row_mask:0xf bank_mask:0xf
v_and_b32_dpp v105, v20, v5 row_newbcast:8 row_mask:0xf bank_mask:0xf
v_and_b32_dpp v106, v20, v6 row_newbcast:8 row_mask:0xf bank_mask:0xf
v_and_b32_dpp v107, v20, v7 row_newbcast:8 row_mask:0xf bank_mask:0xf
v_mfma_f32_16x16x32_bf16 v[112:115], v[108:111], v[88:91], v[112:115]
s_xor_b32 s64, s65, 167936
s_waitcnt vmcnt(5)
buffer_load_dwordx4 v[152:155], v1, s[44:47], s64 offen nt
v_and_b32_dpp v108, v20, v4 row_newbcast:12 row_mask:0xf bank_mask:0xf
v_and_b32_dpp v109, v20, v5 row_newbcast:12 row_mask:0xf bank_mask:0xf
v_and_b32_dpp v110, v20, v6 row_newbcast:12 row_mask:0xf bank_mask:0xf
v_and_b32_dpp v111, v20, v7 row_newbcast:12 row_mask:0xf bank_mask:0xf
v_mfma_f32_16x16x32_bf16 v[112:115], v[104:107], v[92:95], v[112:115]
s_xor_b32 s64, s65, 233472
s_waitcnt vmcnt(5)
buffer_load_dwordx4 v[156:159], v1, s[44:47], s64 offen nt
v_and_b32_dpp v104, v21, v4 row_newbcast:0 row_mask:0xf bank_mask:0xf
v_and_b32_dpp v105, v21, v5 row_newbcast:0 row_mask:0xf bank_mask:0xf
v_and_b32_dpp v106, v21, v6 row_newbcast:0 row_mask:0xf bank_mask:0xf
v_and_b32_dpp v107, v21, v7 row_newbcast:0 row_mask:0xf bank_mask:0xf
v_mfma_f32_16x16x32_bf16 v[112:115], v[108:111], v[132:135], v[112:115]
s_cmp_lt_u32 s2, 208
s_cbranch_scc0 L_hp_123
v_lshlrev_b32 v160, 2, v0
buffer_load_dword v161, v160, s[36:39], s62 offen offset:0 sc1
L_hp_123:
s_xor_b32 s64, s65, 169984
s_waitcnt vmcnt(5)
buffer_load_dwordx4 v[180:183], v1, s[44:47], s64 offen nt
v_and_b32_dpp v108, v21, v4 row_newbcast:4 row_mask:0xf bank_mask:0xf
v_and_b32_dpp v109, v21, v5 row_newbcast:4 row_mask:0xf bank_mask:0xf
v_and_b32_dpp v110, v21, v6 row_newbcast:4 row_mask:0xf bank_mask:0xf
v_and_b32_dpp v111, v21, v7 row_newbcast:4 row_mask:0xf bank_mask:0xf
v_mfma_f32_16x16x32_bf16 v[112:115], v[104:107], v[136:139], v[112:115]
s_xor_b32 s64, s65, 235520
s_waitcnt vmcnt(5)
buffer_load_dwordx4 v[184:187], v1, s[44:47], s64 offen nt
v_and_b32_dpp v104, v21, v4 row_newbcast:8 row_mask:0xf bank_mask:0xf
v_and_b32_dpp v105, v21, v5 row_newbcast:8 row_mask:0xf bank_mask:0xf
v_and_b32_dpp v106, v21, v6 row_newbcast:8 row_mask:0xf bank_mask:0xf
v_and_b32_dpp v107, v21, v7 row_newbcast:8 row_mask:0xf bank_mask:0xf
v_mfma_f32_16x16x32_bf16 v[112:115], v[108:111], v[140:143], v[112:115]
s_xor_b32 s64, s65, 168960
s_waitcnt vmcnt(7)
buffer_load_dwordx4 v[188:191], v1, s[44:47], s64 offen nt
s_xor_b32 s64, s65, 234496
s_waitcnt vmcnt(7)
buffer_load_dwordx4 v[24:27], v1, s[44:47], s64 offen nt
s_cmp_eq_u32 s34, 2
s_cbranch_scc0 L_w_124
v_mov_b32 v60, 62
s_mov_b64 exec, 1
buffer_store_dword v60, off, s[36:39], s63 offset:0
s_mov_b64 exec, -1
L_w_124:
s_xor_b32 s64, s65, 171008
s_waitcnt vmcnt(7)
buffer_load_dwordx4 v[28:31], v1, s[44:47], s64 offen nt
v_and_b32_dpp v108, v21, v4 row_newbcast:12 row_mask:0xf bank_mask:0xf
v_and_b32_dpp v109, v21, v5 row_newbcast:12 row_mask:0xf bank_mask:0xf
v_and_b32_dpp v110, v21, v6 row_newbcast:12 row_mask:0xf bank_mask:0xf
v_and_b32_dpp v111, v21, v7 row_newbcast:12 row_mask:0xf bank_mask:0xf
v_mfma_f32_16x16x32_bf16 v[112:115], v[104:107], v[144:147], v[112:115]
s_xor_b32 s64, s65, 236544
s_waitcnt vmcnt(7)
buffer_load_dwordx4 v[32:35], v1, s[44:47], s64 offen nt
v_and_b32_dpp v104, v22, v4 row_newbcast:0 row_mask:0xf bank_mask:0xf
v_and_b32_dpp v105, v22, v5 row_newbcast:0 row_mask:0xf bank_mask:0xf
v_and_b32_dpp v106, v22, v6 row_newbcast:0 row_mask:0xf bank_mask:0xf
v_and_b32_dpp v107, v22, v7 row_newbcast:0 row_mask:0xf bank_mask:0xf
v_mfma_f32_16x16x32_bf16 v[112:115], v[108:111], v[148:151], v[112:115]
s_cmp_lt_u32 s2, 208
s_cbranch_scc0 L_nohelp
v_lshrrev_b32 v176, 3, v0
v_sub_u32 v176, 63, v176
v_and_b32 v172, 7, v0
v_lshlrev_b32 v172, 7, v172
v_bfe_u32 v162, v176, 0, 1
v_lshl_or_b32 v172, v162, 16, v172
v_bfe_u32 v162, v176, 1, 1
v_lshl_or_b32 v172, v162, 11, v172
v_bfe_u32 v162, v176, 2, 1
v_lshl_or_b32 v172, v162, 10, v172
v_bfe_u32 v162, v176, 3, 1
v_lshl_or_b32 v172, v162, 15, v172
v_bfe_u32 v162, v176, 4, 1
v_lshl_or_b32 v172, v162, 17, v172
v_bfe_u32 v162, v176, 5, 1
v_lshl_or_b32 v172, v162, 12, v172
v_lshrrev_b32 v177, 3, v0
v_sub_u32 v177, 55, v177
v_and_b32 v173, 7, v0
v_lshlrev_b32 v173, 7, v173
v_bfe_u32 v162, v177, 0, 1
v_lshl_or_b32 v173, v162, 16, v173
v_bfe_u32 v162, v177, 1, 1
v_lshl_or_b32 v173, v162, 11, v173
v_bfe_u32 v162, v177, 2, 1
v_lshl_or_b32 v173, v162, 10, v173
v_bfe_u32 v162, v177, 3, 1
v_lshl_or_b32 v173, v162, 15, v173
v_bfe_u32 v162, v177, 4, 1
v_lshl_or_b32 v173, v162, 17, v173
v_bfe_u32 v162, v177, 5, 1
v_lshl_or_b32 v173, v162, 12, v173
v_lshrrev_b32 v178, 3, v0
v_sub_u32 v178, 47, v178
v_and_b32 v174, 7, v0
v_lshlrev_b32 v174, 7, v174
v_bfe_u32 v162, v178, 0, 1
v_lshl_or_b32 v174, v162, 16, v174
v_bfe_u32 v162, v178, 1, 1
v_lshl_or_b32 v174, v162, 11, v174
v_bfe_u32 v162, v178, 2, 1
v_lshl_or_b32 v174, v162, 10, v174
v_bfe_u32 v162, v178, 3, 1
v_lshl_or_b32 v174, v162, 15, v174
v_bfe_u32 v162, v178, 4, 1
v_lshl_or_b32 v174, v162, 17, v174
v_bfe_u32 v162, v178, 5, 1
v_lshl_or_b32 v174, v162, 12, v174
v_lshrrev_b32 v179, 3, v0
v_sub_u32 v179, 39, v179
v_and_b32 v175, 7, v0
v_lshlrev_b32 v175, 7, v175
v_bfe_u32 v162, v179, 0, 1
v_lshl_or_b32 v175, v162, 16, v175
v_bfe_u32 v162, v179, 1, 1
v_lshl_or_b32 v175, v162, 11, v175
v_bfe_u32 v162, v179, 2, 1
v_lshl_or_b32 v175, v162, 10, v175
v_bfe_u32 v162, v179, 3, 1
v_lshl_or_b32 v175, v162, 15, v175
v_bfe_u32 v162, v179, 4, 1
v_lshl_or_b32 v175, v162, 17, v175
v_bfe_u32 v162, v179, 5, 1
v_lshl_or_b32 v175, v162, 12, v175
s_lshr_b32 s71, s2, 3
v_subrev_u32 v163, s71, v0
v_and_b32 v163, 31, v163
s_waitcnt vmcnt(6)
v_mov_b32 v162, v161
s_nop 1
v_permlane32_swap_b32 v161, v162
v_add_u32 v161, 1, v161
v_max_u32 v161, 7, v161
v_cmp_eq_u32 vcc, -1, v162
v_mov_b32 v160, 0xff
s_nop 0
v_cndmask_b32 v161, v160, v161, vcc
v_lshl_or_b32 v161, v161, 5, v163
s_nop 1
v_min_u32_dpp v161, v161, v161 quad_perm:[1,0,3,2] row_mask:0xf bank_mask:0xf
s_nop 1
v_min_u32_dpp v161, v161, v161 quad_perm:[2,3,0,1] row_mask:0xf bank_mask:0xf
s_nop 1
v_min_u32_dpp v161, v161, v161 row_ror:4 row_mask:0xf bank_mask:0xf
s_nop 1
v_min_u32_dpp v161, v161, v161 row_ror:8 row_mask:0xf bank_mask:0xf
s_nop 1
v_readlane_b32 s76, v161, 0
v_readlane_b32 s66, v161, 16
s_min_u32 s76, s76, s66
s_lshr_b32 s66, s76, 5
s_cmp_lt_u32 s66, 50
s_cbranch_scc0 L_drain
s_mov_b32 s48, s8
s_mov_b32 s49, s9
s_mov_b32 s50, 0x10000000
s_mov_b32 s51, 0x20000
s_lshr_b32 s64, s2, 3
s_add_u32 s76, s76, s64
s_and_b32 s76, s76, 31
s_lshl_b32 s67, s76, 2
s_add_u32 s67, s67, s62
s_lshl_b32 s76, s76, 3
s_and_b32 s64, s2, 7
s_or_b32 s76, s76, s64
s_and_b32 s64, s34, 1
s_lshl_b32 s64, s64, 14
s_lshr_b32 s71, s34, 1
s_lshl_b32 s71, s71, 13
s_or_b32 s64, s64, s71
s_lshl_b32 s71, s76, 10
s_xor_b32 s64, s64, s71
s_or_b32 s64, s64, 0xC0000
s_lshl_b32 s76, s76, 20
s_xor_b32 s76, s76, s64
s_add_u32 s66, s66, 11
v_xor_b32 v175, s76, v175
v_cmp_lt_u32 vcc, s66, v179
s_or_b64 exec, vcc, 1
buffer_load_dword v160, v175, s[48:51], 0 offen
s_mov_b64 exec, -1
v_xor_b32 v174, s76, v174
v_cmp_lt_u32 vcc, s66, v178
s_or_b64 exec, vcc, 1
buffer_load_dword v160, v174, s[48:51], 0 offen
s_mov_b64 exec, -1
v_xor_b32 v173, s76, v173
v_cmp_lt_u32 vcc, s66, v177
s_or_b64 exec, vcc, 1
buffer_load_dword v160, v173, s[48:51], 0 offen
s_mov_b64 exec, -1
v_xor_b32 v172, s76, v172
v_cmp_lt_u32 vcc, s66, v176
s_or_b64 exec, vcc, 1
buffer_load_dword v160, v172, s[48:51], 0 offen
s_mov_b64 exec, -1
s_mov_b64 exec, 1
buffer_store_dword v1, off, s[36:39], s67 offset:128
s_mov_b64 exec, -1
s_waitcnt vmcnt(12)
v_and_b32_dpp v108, v22, v4 row_newbcast:4 row_mask:0xf bank_mask:0xf
v_and_b32_dpp v109, v22, v5 row_newbcast:4 row_mask:0xf bank_mask:0xf
v_and_b32_dpp v110, v22, v6 row_newbcast:4 row_mask:0xf bank_mask:0xf
v_and_b32_dpp v111, v22, v7 row_newbcast:4 row_mask:0xf bank_mask:0xf
v_mfma_f32_16x16x32_bf16 v[112:115], v[104:107], v[152:155], v[112:115]
s_waitcnt vmcnt(11)
v_and_b32_dpp v104, v22, v4 row_newbcast:8 row_mask:0xf bank_mask:0xf
v_and_b32_dpp v105, v22, v5 row_newbcast:8 row_mask:0xf bank_mask:0xf
v_and_b32_dpp v106, v22, v6 row_newbcast:8 row_mask:0xf bank_mask:0xf
v_and_b32_dpp v107, v22, v7 row_newbcast:8 row_mask:0xf bank_mask:0xf
v_mfma_f32_16x16x32_bf16 v[112:115], v[108:111], v[156:159], v[112:115]
s_waitcnt vmcnt(10)
v_and_b32_dpp v108, v22, v4 row_newbcast:12 row_mask:0xf bank_mask:0xf
v_and_b32_dpp v109, v22, v5 row_newbcast:12 row_mask:0xf bank_mask:0xf
v_and_b32_dpp v110, v22, v6 row_newbcast:12 row_mask:0xf bank_mask:0xf
v_and_b32_dpp v111, v22, v7 row_newbcast:12 row_mask:0xf bank_mask:0xf
v_mfma_f32_16x16x32_bf16 v[112:115], v[104:107], v[180:183], v[112:115]
s_waitcnt vmcnt(9)
v_and_b32_dpp v104, v23, v4 row_newbcast:0 row_mask:0xf bank_mask:0xf
v_and_b32_dpp v105, v23, v5 row_newbcast:0 row_mask:0xf bank_mask:0xf
v_and_b32_dpp v106, v23, v6 row_newbcast:0 row_mask:0xf bank_mask:0xf
v_and_b32_dpp v107, v23, v7 row_newbcast:0 row_mask:0xf bank_mask:0xf
v_mfma_f32_16x16x32_bf16 v[112:115], v[108:111], v[184:187], v[112:115]
s_waitcnt vmcnt(8)
v_and_b32_dpp v108, v23, v4 row_newbcast:4 row_mask:0xf bank_mask:0xf
v_and_b32_dpp v109, v23, v5 row_newbcast:4 row_mask:0xf bank_mask:0xf
v_and_b32_dpp v110, v23, v6 row_newbcast:4 row_mask:0xf bank_mask:0xf
v_and_b32_dpp v111, v23, v7 row_newbcast:4 row_mask:0xf bank_mask:0xf
v_mfma_f32_16x16x32_bf16 v[112:115], v[104:107], v[188:191], v[112:115]
s_waitcnt vmcnt(7)
v_and_b32_dpp v104, v23, v4 row_newbcast:8 row_mask:0xf bank_mask:0xf
v_and_b32_dpp v105, v23, v5 row_newbcast:8 row_mask:0xf bank_mask:0xf
v_and_b32_dpp v106, v23, v6 row_newbcast:8 row_mask:0xf bank_mask:0xf
v_and_b32_dpp v107, v23, v7 row_newbcast:8 row_mask:0xf bank_mask:0xf
v_mfma_f32_16x16x32_bf16 v[112:115], v[108:111], v[24:27], v[112:115]
s_waitcnt vmcnt(6)
v_and_b32_dpp v108, v23, v4 row_newbcast:12 row_mask:0xf bank_mask:0xf
v_and_b32_dpp v109, v23, v5 row_newbcast:12 row_mask:0xf bank_mask:0xf
v_and_b32_dpp v110, v23, v6 row_newbcast:12 row_mask:0xf bank_mask:0xf
v_and_b32_dpp v111, v23, v7 row_newbcast:12 row_mask:0xf bank_mask:0xf
v_mfma_f32_16x16x32_bf16 v[112:115], v[104:107], v[28:31], v[112:115]
s_waitcnt vmcnt(5)
v_mfma_f32_16x16x32_bf16 v[112:115], v[108:111], v[32:35], v[112:115]
s_branch L_drained
L_nohelp:
L_drain:
s_waitcnt vmcnt(7)
v_and_b32_dpp v108, v22, v4 row_newbcast:4 row_mask:0xf bank_mask:0xf
v_and_b32_dpp v109, v22, v5 row_newbcast:4 row_mask:0xf bank_mask:0xf
v_and_b32_dpp v110, v22, v6 row_newbcast:4 row_mask:0xf bank_mask:0xf
v_and_b32_dpp v111, v22, v7 row_newbcast:4 row_mask:0xf bank_mask:0xf
v_mfma_f32_16x16x32_bf16 v[112:115], v[104:107], v[152:155], v[112:115]
s_waitcnt vmcnt(6)
v_and_b32_dpp v104, v22, v4 row_newbcast:8 row_mask:0xf bank_mask:0xf
v_and_b32_dpp v105, v22, v5 row_newbcast:8 row_mask:0xf bank_mask:0xf
v_and_b32_dpp v106, v22, v6 row_newbcast:8 row_mask:0xf bank_mask:0xf
v_and_b32_dpp v107, v22, v7 row_newbcast:8 row_mask:0xf bank_mask:0xf
v_mfma_f32_16x16x32_bf16 v[112:115], v[108:111], v[156:159], v[112:115]
s_waitcnt vmcnt(5)
v_and_b32_dpp v108, v22, v4 row_newbcast:12 row_mask:0xf bank_mask:0xf
v_and_b32_dpp v109, v22, v5 row_newbcast:12 row_mask:0xf bank_mask:0xf
v_and_b32_dpp v110, v22, v6 row_newbcast:12 row_mask:0xf bank_mask:0xf
v_and_b32_dpp v111, v22, v7 row_newbcast:12 row_mask:0xf bank_mask:0xf
v_mfma_f32_16x16x32_bf16 v[112:115], v[104:107], v[180:183], v[112:115]
s_waitcnt vmcnt(4)
v_and_b32_dpp v104, v23, v4 row_newbcast:0 row_mask:0xf bank_mask:0xf
v_and_b32_dpp v105, v23, v5 row_newbcast:0 row_mask:0xf bank_mask:0xf
v_and_b32_dpp v106, v23, v6 row_newbcast:0 row_mask:0xf bank_mask:0xf
v_and_b32_dpp v107, v23, v7 row_newbcast:0 row_mask:0xf bank_mask:0xf
v_mfma_f32_16x16x32_bf16 v[112:115], v[108:111], v[184:187], v[112:115]
s_waitcnt vmcnt(3)
v_and_b32_dpp v108, v23, v4 row_newbcast:4 row_mask:0xf bank_mask:0xf
v_and_b32_dpp v109, v23, v5 row_newbcast:4 row_mask:0xf bank_mask:0xf
v_and_b32_dpp v110, v23, v6 row_newbcast:4 row_mask:0xf bank_mask:0xf
v_and_b32_dpp v111, v23, v7 row_newbcast:4 row_mask:0xf bank_mask:0xf
v_mfma_f32_16x16x32_bf16 v[112:115], v[104:107], v[188:191], v[112:115]
s_waitcnt vmcnt(2)
v_and_b32_dpp v104, v23, v4 row_newbcast:8 row_mask:0xf bank_mask:0xf
v_and_b32_dpp v105, v23, v5 row_newbcast:8 row_mask:0xf bank_mask:0xf
v_and_b32_dpp v106, v23, v6 row_newbcast:8 row_mask:0xf bank_mask:0xf
v_and_b32_dpp v107, v23, v7 row_newbcast:8 row_mask:0xf bank_mask:0xf
v_mfma_f32_16x16x32_bf16 v[112:115], v[108:111], v[24:27], v[112:115]
s_waitcnt vmcnt(1)
v_and_b32_dpp v108, v23, v4 row_newbcast:12 row_mask:0xf bank_mask:0xf
v_and_b32_dpp v109, v23, v5 row_newbcast:12 row_mask:0xf bank_mask:0xf
v_and_b32_dpp v110, v23, v6 row_newbcast:12 row_mask:0xf bank_mask:0xf
v_and_b32_dpp v111, v23, v7 row_newbcast:12 row_mask:0xf bank_mask:0xf
v_mfma_f32_16x16x32_bf16 v[112:115], v[104:107], v[28:31], v[112:115]
s_waitcnt vmcnt(0)
v_mfma_f32_16x16x32_bf16 v[112:115], v[108:111], v[32:35], v[112:115]
L_drained:
v_and_b32 v2, 15, v0
v_lshlrev_b32 v2, 5, v2
v_and_b32 v3, 16, v0
v_add_u32 v2, v2, v3
s_lshl_b32 s68, s34, 9
v_add_u32 v2, s68, v2
s_mov_b32 exec_hi, 0
s_nop 1
ds_write_b128 v2, v[112:115] offset:512
s_mov_b32 exec_hi, -1
v_lshlrev_b32 v1, 4, v0
s_waitcnt lgkmcnt(0)
s_barrier
v_mov_b32 v2, 0
ds_read_b32 v3, v2 offset:328
s_waitcnt lgkmcnt(0)
v_readfirstlane_b32 s35, v3
s_branch L_tail_s
L_fin:
L_end:
s_endpgm
L_code_end:
.section .rodata,"a"
.p2align 6
.amdhsa_kernel adaLN_cond__sliding_block_cached__glu_gated_glu__decode_kernel
  .amdhsa_next_free_vgpr 256
  .amdhsa_next_free_sgpr 102
  .amdhsa_accum_offset 256
  .amdhsa_group_segment_fixed_size 0
  .amdhsa_kernarg_size 112
  .amdhsa_user_sgpr_count 2
  .amdhsa_user_sgpr_kernarg_segment_ptr 1
  .amdhsa_system_sgpr_workgroup_id_x 1
  .amdhsa_float_denorm_mode_32 3
.end_amdhsa_kernel
```

```asm
; @launch grid=(256,1,1) block=(512,1,1) lds=131072
.amdgcn_target "amdgcn-amd-amdhsa--gfx950"
.text
.globl adaLN_cond__sliding_block_cached__glu_gated_glu__decode_kernel
.p2align 8
.type adaLN_cond__sliding_block_cached__glu_gated_glu__decode_kernel,@function
adaLN_cond__sliding_block_cached__glu_gated_glu__decode_kernel:
L_code_begin:
s_load_dwordx16 s[4:19], s[0:1], 0
s_load_dwordx8 s[20:27], s[0:1], 64
s_load_dwordx4 s[28:31], s[0:1], 96
s_cmpk_ge_u32 s2, 256
s_cbranch_scc1 L_end
v_lshrrev_b32 v1, 6, v0
v_and_b32 v0, 63, v0
v_readfirstlane_b32 s3, v1
v_lshlrev_b32 v1, 4, v0
s_lshl_b32 s64, s2, 20
s_add_u32 s64, s64, 0xC0000
s_mov_b32 s42, 0x40000
s_mov_b32 s43, 0x20000
s_and_b32 s34, s3, 3
s_cmp_ge_u32 s3, 4
s_cbranch_scc1 L_helper
s_and_b32 s65, s34, 1
s_lshl_b32 s65, s65, 14
s_lshr_b32 s66, s34, 1
s_lshl_b32 s66, s66, 11
s_or_b32 s65, s65, s66
s_lshl_b32 s66, s2, 10
s_xor_b32 s65, s65, s66
s_waitcnt lgkmcnt(0)
s_add_u32 s40, s6, s64
s_addc_u32 s41, s7, 0
s_add_u32 s44, s8, s64
s_addc_u32 s45, s9, 0
buffer_load_dwordx4 v[8:11], v1, s[40:43], s65 offen nt
s_xor_b32 s64, s65, 32768
buffer_load_dwordx4 v[12:15], v1, s[40:43], s64 offen nt
s_xor_b32 s64, s65, 8192
buffer_load_dwordx4 v[16:19], v1, s[40:43], s64 offen nt
s_xor_b32 s64, s65, 40960
buffer_load_dwordx4 v[20:23], v1, s[40:43], s64 offen nt
s_barrier
s_branch L_srest
L_helper:
s_setprio 2
v_lshlrev_b32 v2, 2, v0
s_cmp_eq_u32 s3, 7
s_cbranch_scc0 L_nopf
s_getpc_b64 s[60:61]
L_pc:
s_lshr_b32 s66, s2, 3
s_lshl_b32 s66, s66, 10
v_add_u32 v10, s66, v1
v_min_u32 v10, L_code_end-L_pc-16, v10
global_load_dwordx4 v[12:15], v10, s[60:61]
v_subrev_u32 v3, 16, v0
v_ashrrev_i32 v3, 31, v3
ds_write_b32 v2, v3 offset:256
L_nopf:
s_and_b32 s67, s2, 7
s_lshr_b32 s68, s2, 3
v_and_b32 v38, 7, v0
v_lshrrev_b32 v37, 3, v0
s_cmp_eq_u32 s34, 0
s_cbranch_scc0 L_p0a
s_mov_b32 s70, 6
s_lshl_b32 s67, s67, 1
s_add_u32 s66, s67, 14
v_min_u32 v38, 5, v38
v_cmp_lt_u32 vcc, 1, v38
v_add_u32 v36, s66, v38
s_nop 0
v_cndmask_b32 v38, v38, v36, vcc
s_branch L_p0b
L_p0a:
s_lshl_b32 s67, s67, 3
s_lshl_b32 s65, s2, 3
s_and_b32 s65, s65, 0xff
s_lshr_b32 s66, s2, 5
s_or_b32 s65, s65, s66
s_cmp_eq_u32 s34, 2
s_cselect_b32 s70, 1, 8
s_cselect_b32 s68, s65, s68
s_cselect_b32 s67, 0, s67
L_p0b:
v_lshl_add_u32 v37, s68, 4, v37
v_mul_u32_u24 v37, s70, v37
v_lshl_add_u32 v38, v37, 3, v38
v_add_lshl_u32 v38, v38, s67, 7
s_lshl_b32 s70, s70, 13
v_add_u32 v39, s70, v38
s_sub_u32 s64, s2, 112
s_cmp_lt_u32 s64, 32
s_waitcnt lgkmcnt(0)
s_barrier
s_cbranch_scc1 L_jan
s_cmp_eq_u32 s34, 3
s_cbranch_scc1 L_p0_125
s_cmp_eq_u32 s34, 0
s_cselect_b32 s62, s24, s10
s_cselect_b32 s63, s25, s11
s_cmp_eq_u32 s34, 2
s_cselect_b32 s62, s12, s62
s_cselect_b32 s63, s13, s63
global_load_dword v12, v38, s[62:63]
global_load_dword v13, v39, s[62:63]
L_p0_125:
L_nop0:
s_cmp_eq_u32 s34, 3
s_cselect_b32 s64, 16, 0
s_cmp_lt_u32 s2, s64
s_cbranch_scc0 L_nopc
v_mov_b32 v4, -1
v_mov_b32 v5, -1
v_mov_b32 v6, -1
v_mov_b32 v7, -1
s_and_b32 s66, s2, 7
s_lshl_b32 s66, s66, 11
s_and_b32 s65, s2, 8
s_lshl_b32 s65, s65, 7
s_add_u32 s66, s66, s65
v_add_u32 v8, s66, v1
global_store_dwordx4 v8, v[4:7], s[30:31] sc1
s_lshl_b32 s66, s2, 2
v_mov_b32 v3, s66
s_waitcnt vmcnt(0)
s_mov_b64 exec, 1
global_store_dword v3, v4, s[28:29] sc1
s_mov_b64 exec, -1
L_nopc:
s_cmp_eq_u32 s34, 3
s_cbranch_scc0 L_w_126
s_and_b32 s67, s2, 7
s_lshr_b32 s68, s2, 3
s_min_u32 s64, s67, 3
s_mul_i32 s65, s67, 5
s_add_u32 s64, s64, s65
s_cmp_lt_u32 s67, 3
s_cselect_b32 s65, 6, 5
L_w_126:
s_lshr_b32 s32, s2, 5
s_and_b32 s33, s2, 31
s_and_b32 s67, s2, 7
s_lshr_b32 s68, s2, 3
s_sub_u32 s68, s68, 26
s_min_u32 s74, s67, 3
s_mul_i32 s66, s67, 5
s_add_u32 s74, s74, s66
s_add_u32 s74, s74, s68
s_cmp_lt_u32 s67, 3
s_cselect_b32 s66, 6, 5
s_cmp_lt_u32 s68, s66
s_cselect_b32 s74, s74, -1
s_cmp_lt_u32 s2, 48
s_cselect_b32 s66, 2, 3
s_cselect_b32 s72, 14+26, 42+26
s_cmp_lt_u32 s2, 16
s_cselect_b32 s66, 1, s66
s_cselect_b32 s72, 26, s72
s_lshl_b32 s66, s67, s66
s_add_u32 s72, s72, s66
s_add_u32 s72, s72, s68
s_mov_b32 s36, s30
s_mov_b32 s37, s31
s_mov_b32 s38, 0x1d0000
s_mov_b32 s39, 0x20000
s_mov_b32 s52, s28
s_mov_b32 s53, s29
s_mov_b32 s54, 0x100
s_mov_b32 s55, 0x20000
v_mov_b32 v9, 1
s_cmp_lt_u32 s2, 112
s_cbranch_scc0 L_norole
L_gemm:
v_and_b32 v16, 7, v0
v_lshlrev_b32 v16, 10, v16
v_and_b32 v17, 8, v0
v_lshl_add_u32 v16, v17, 3, v16
v_and_b32 v17, 48, v0
v_add_u32 v16, v16, v17
s_lshl_b32 s67, s34, 8
v_lshrrev_b32 v19, 3, v0
v_and_b32 v17, 2, v19
v_and_b32 v18, 7, v0
v_xor_b32 v17, v17, v18
v_xor_b32 v18, 4, v17
v_lshlrev_b32 v17, 4, v17
v_lshlrev_b32 v18, 4, v18
s_cmp_lt_u32 s2, 48
s_cbranch_scc0 L_gq0
s_mov_b32 s40, s24
s_mov_b32 s41, s25
s_mov_b32 s42, 0x300000
s_mov_b32 s43, 0x20000
s_mov_b32 s48, s22
s_mov_b32 s49, s23
s_mov_b32 s50, 0x2000
s_mov_b32 s51, 0x20000
s_mov_b32 s70, 6144
s_lshl_b32 s64, s72, 7
s_branch L_g1
L_gq0:
s_mov_b32 s40, s10
s_mov_b32 s41, s11
s_mov_b32 s42, 0x400000
s_mov_b32 s43, 0x20000
s_mov_b32 s48, s4
s_mov_b32 s49, s5
s_mov_b32 s50, 0x2000
s_mov_b32 s51, 0x20000
s_mov_b32 s70, 8192
s_sub_u32 s64, s72, 48
s_lshl_b32 s64, s64, 7
L_g1:
buffer_load_dwordx4 v[192:195], v16, s[48:51], s67 offen offset:0
buffer_load_dwordx4 v[196:199], v16, s[48:51], s67 offen offset:128
v_mul_lo_u32 v19, s70, v19
v_add_u32 v17, v17, v19
v_add_u32 v18, v18, v19
s_lshl_b32 s66, s70, 7
s_mul_i32 s66, s66, s34
s_add_u32 s64, s64, s66
s_lshl_b32 s70, s70, 3
s_lshl_b32 s65, s34, 13
s_add_u32 s65, s65, 4096
s_cmp_lt_u32 s2, 16
s_cselect_b32 s71, 0, 2
s_cmp_ge_u32 s2, 48
s_cselect_b32 s71, 1, s71
s_add_u32 m0, s65, 0
s_nop 0
buffer_load_dwordx4 v17, s[40:43], s64 offen  lds
s_add_u32 s64, s64, s70
s_add_u32 m0, s65, 1024
s_nop 0
buffer_load_dwordx4 v18, s[40:43], s64 offen  lds
s_add_u32 s64, s64, s70
s_cmp_eq_u32 s71, 2
s_cbranch_scc0 L_pace_127
s_waitcnt vmcnt(1)
L_pace_127:
s_add_u32 m0, s65, 2048
s_nop 0
buffer_load_dwordx4 v17, s[40:43], s64 offen  lds
s_add_u32 s64, s64, s70
s_cmp_eq_u32 s71, 0
s_cbranch_scc1 L_pace_128
s_waitcnt vmcnt(2)
s_cmp_eq_u32 s71, 2
s_cbranch_scc0 L_pace_128
s_waitcnt vmcnt(1)
L_pace_128:
s_add_u32 m0, s65, 3072
s_nop 0
buffer_load_dwordx4 v18, s[40:43], s64 offen  lds
s_add_u32 s64, s64, s70
s_cmp_eq_u32 s71, 0
s_cbranch_scc1 L_pace_129
s_waitcnt vmcnt(2)
s_cmp_eq_u32 s71, 2
s_cbranch_scc0 L_pace_129
s_waitcnt vmcnt(1)
L_pace_129:
s_add_u32 m0, s65, 4096
s_nop 0
buffer_load_dwordx4 v17, s[40:43], s64 offen  lds
s_add_u32 s64, s64, s70
s_cmp_eq_u32 s71, 0
s_cbranch_scc1 L_pace_130
s_waitcnt vmcnt(2)
s_cmp_eq_u32 s71, 2
s_cbranch_scc0 L_pace_130
s_waitcnt vmcnt(1)
L_pace_130:
s_add_u32 m0, s65, 5120
s_nop 0
buffer_load_dwordx4 v18, s[40:43], s64 offen  lds
s_add_u32 s64, s64, s70
s_cmp_eq_u32 s71, 0
s_cbranch_scc1 L_pace_131
s_waitcnt vmcnt(2)
s_cmp_eq_u32 s71, 2
s_cbranch_scc0 L_pace_131
s_waitcnt vmcnt(1)
L_pace_131:
s_add_u32 m0, s65, 6144
s_nop 0
buffer_load_dwordx4 v17, s[40:43], s64 offen  lds
s_add_u32 s64, s64, s70
s_cmp_eq_u32 s71, 0
s_cbranch_scc1 L_pace_132
s_waitcnt vmcnt(2)
s_cmp_eq_u32 s71, 2
s_cbranch_scc0 L_pace_132
s_waitcnt vmcnt(1)
L_pace_132:
s_add_u32 m0, s65, 7168
s_nop 0
buffer_load_dwordx4 v18, s[40:43], s64 offen  lds
s_add_u32 s64, s64, s70
s_cmp_eq_u32 s71, 0
s_cbranch_scc1 L_pace_133
s_waitcnt vmcnt(2)
s_cmp_eq_u32 s71, 2
s_cbranch_scc0 L_pace_133
s_waitcnt vmcnt(1)
L_pace_133:
s_add_u32 m0, s65, 32768
s_nop 0
buffer_load_dwordx4 v17, s[40:43], s64 offen  lds
s_add_u32 s64, s64, s70
s_cmp_eq_u32 s71, 0
s_cbranch_scc1 L_pace_134
s_waitcnt vmcnt(2)
s_cmp_eq_u32 s71, 2
s_cbranch_scc0 L_pace_134
s_waitcnt vmcnt(1)
L_pace_134:
s_add_u32 m0, s65, 33792
s_nop 0
buffer_load_dwordx4 v18, s[40:43], s64 offen  lds
s_add_u32 s64, s64, s70
s_cmp_eq_u32 s71, 0
s_cbranch_scc1 L_pace_135
s_waitcnt vmcnt(2)
s_cmp_eq_u32 s71, 2
s_cbranch_scc0 L_pace_135
s_waitcnt vmcnt(1)
L_pace_135:
s_add_u32 m0, s65, 34816
s_nop 0
buffer_load_dwordx4 v17, s[40:43], s64 offen  lds
s_add_u32 s64, s64, s70
s_cmp_eq_u32 s71, 0
s_cbranch_scc1 L_pace_136
s_waitcnt vmcnt(2)
s_cmp_eq_u32 s71, 2
s_cbranch_scc0 L_pace_136
s_waitcnt vmcnt(1)
L_pace_136:
s_add_u32 m0, s65, 35840
s_nop 0
buffer_load_dwordx4 v18, s[40:43], s64 offen  lds
s_add_u32 s64, s64, s70
s_cmp_eq_u32 s71, 0
s_cbranch_scc1 L_pace_137
s_waitcnt vmcnt(2)
s_cmp_eq_u32 s71, 2
s_cbranch_scc0 L_pace_137
s_waitcnt vmcnt(1)
L_pace_137:
s_add_u32 m0, s65, 36864
s_nop 0
buffer_load_dwordx4 v17, s[40:43], s64 offen  lds
s_add_u32 s64, s64, s70
s_cmp_eq_u32 s71, 0
s_cbranch_scc1 L_pace_138
s_waitcnt vmcnt(2)
s_cmp_eq_u32 s71, 2
s_cbranch_scc0 L_pace_138
s_waitcnt vmcnt(1)
L_pace_138:
s_add_u32 m0, s65, 37888
s_nop 0
buffer_load_dwordx4 v18, s[40:43], s64 offen  lds
s_add_u32 s64, s64, s70
s_cmp_eq_u32 s71, 0
s_cbranch_scc1 L_pace_139
s_waitcnt vmcnt(2)
s_cmp_eq_u32 s71, 2
s_cbranch_scc0 L_pace_139
s_waitcnt vmcnt(1)
L_pace_139:
s_add_u32 m0, s65, 38912
s_nop 0
buffer_load_dwordx4 v17, s[40:43], s64 offen  lds
s_add_u32 s64, s64, s70
s_cmp_eq_u32 s71, 0
s_cbranch_scc1 L_pace_140
s_waitcnt vmcnt(2)
s_cmp_eq_u32 s71, 2
s_cbranch_scc0 L_pace_140
s_waitcnt vmcnt(1)
L_pace_140:
s_add_u32 m0, s65, 39936
s_nop 0
buffer_load_dwordx4 v18, s[40:43], s64 offen  lds
s_add_u32 s64, s64, s70
s_waitcnt vmcnt(16)
s_cmp_eq_u32 s34, 0
s_cselect_b32 s73, 48, 0x1000
v_and_b32 v30, 15, v0
v_lshlrev_b32 v30, 2, v30
s_cmp_ge_u32 s2, s73
s_cbranch_scc0 L_fl_141
buffer_load_dword v31, v30, s[52:55], 0 offen sc1
L_fl_141:
s_mov_b32 s68, 0xffff0000
s_cmp_lt_u32 s2, 48
s_cbranch_scc0 L_gq1
s_mov_b32 s66, 0xbfb8aa3b
v_lshlrev_b32 v20, 16, v192
v_and_b32 v21, s68, v192
v_mul_f32 v22, s66, v20
v_mul_f32 v23, s66, v21
v_exp_f32 v22, v22
v_exp_f32 v23, v23
s_nop 0
v_add_f32 v22, 1.0, v22
v_add_f32 v23, 1.0, v23
v_rcp_f32 v22, v22
v_rcp_f32 v23, v23
s_nop 0
v_mul_f32 v20, v20, v22
v_mul_f32 v21, v21, v23
v_cvt_pk_bf16_f32 v48, v20, v21
v_lshlrev_b32 v20, 16, v193
v_and_b32 v21, s68, v193
v_mul_f32 v22, s66, v20
v_mul_f32 v23, s66, v21
v_exp_f32 v22, v22
v_exp_f32 v23, v23
s_nop 0
v_add_f32 v22, 1.0, v22
v_add_f32 v23, 1.0, v23
v_rcp_f32 v22, v22
v_rcp_f32 v23, v23
s_nop 0
v_mul_f32 v20, v20, v22
v_mul_f32 v21, v21, v23
v_cvt_pk_bf16_f32 v49, v20, v21
v_lshlrev_b32 v20, 16, v194
v_and_b32 v21, s68, v194
v_mul_f32 v22, s66, v20
v_mul_f32 v23, s66, v21
v_exp_f32 v22, v22
v_exp_f32 v23, v23
s_nop 0
v_add_f32 v22, 1.0, v22
v_add_f32 v23, 1.0, v23
v_rcp_f32 v22, v22
v_rcp_f32 v23, v23
s_nop 0
v_mul_f32 v20, v20, v22
v_mul_f32 v21, v21, v23
v_cvt_pk_bf16_f32 v50, v20, v21
v_lshlrev_b32 v20, 16, v195
v_and_b32 v21, s68, v195
v_mul_f32 v22, s66, v20
v_mul_f32 v23, s66, v21
v_exp_f32 v22, v22
v_exp_f32 v23, v23
s_nop 0
v_add_f32 v22, 1.0, v22
v_add_f32 v23, 1.0, v23
v_rcp_f32 v22, v22
v_rcp_f32 v23, v23
s_nop 0
v_mul_f32 v20, v20, v22
v_mul_f32 v21, v21, v23
v_cvt_pk_bf16_f32 v51, v20, v21
v_lshlrev_b32 v20, 16, v196
v_and_b32 v21, s68, v196
v_mul_f32 v22, s66, v20
v_mul_f32 v23, s66, v21
v_exp_f32 v22, v22
v_exp_f32 v23, v23
s_nop 0
v_add_f32 v22, 1.0, v22
v_add_f32 v23, 1.0, v23
v_rcp_f32 v22, v22
v_rcp_f32 v23, v23
s_nop 0
v_mul_f32 v20, v20, v22
v_mul_f32 v21, v21, v23
v_cvt_pk_bf16_f32 v52, v20, v21
v_lshlrev_b32 v20, 16, v197
v_and_b32 v21, s68, v197
v_mul_f32 v22, s66, v20
v_mul_f32 v23, s66, v21
v_exp_f32 v22, v22
v_exp_f32 v23, v23
s_nop 0
v_add_f32 v22, 1.0, v22
v_add_f32 v23, 1.0, v23
v_rcp_f32 v22, v22
v_rcp_f32 v23, v23
s_nop 0
v_mul_f32 v20, v20, v22
v_mul_f32 v21, v21, v23
v_cvt_pk_bf16_f32 v53, v20, v21
v_lshlrev_b32 v20, 16, v198
v_and_b32 v21, s68, v198
v_mul_f32 v22, s66, v20
v_mul_f32 v23, s66, v21
v_exp_f32 v22, v22
v_exp_f32 v23, v23
s_nop 0
v_add_f32 v22, 1.0, v22
v_add_f32 v23, 1.0, v23
v_rcp_f32 v22, v22
v_rcp_f32 v23, v23
s_nop 0
v_mul_f32 v20, v20, v22
v_mul_f32 v21, v21, v23
v_cvt_pk_bf16_f32 v54, v20, v21
v_lshlrev_b32 v20, 16, v199
v_and_b32 v21, s68, v199
v_mul_f32 v22, s66, v20
v_mul_f32 v23, s66, v21
v_exp_f32 v22, v22
v_exp_f32 v23, v23
s_nop 0
v_add_f32 v22, 1.0, v22
v_add_f32 v23, 1.0, v23
v_rcp_f32 v22, v22
v_rcp_f32 v23, v23
s_nop 0
v_mul_f32 v20, v20, v22
v_mul_f32 v21, v21, v23
v_cvt_pk_bf16_f32 v55, v20, v21
s_branch L_g2
L_gq1:
v_and_b32 v32, 7, v0
v_lshlrev_b32 v32, 2, v32
v_lshlrev_b32 v96, 16, v192
v_and_b32 v97, s68, v192
v_lshlrev_b32 v98, 16, v193
v_and_b32 v99, s68, v193
v_lshlrev_b32 v100, 16, v194
v_and_b32 v101, s68, v194
v_lshlrev_b32 v102, 16, v195
v_and_b32 v103, s68, v195
v_lshlrev_b32 v104, 16, v196
v_and_b32 v105, s68, v196
v_lshlrev_b32 v106, 16, v197
v_and_b32 v107, s68, v197
v_lshlrev_b32 v108, 16, v198
v_and_b32 v109, s68, v198
v_lshlrev_b32 v110, 16, v199
v_and_b32 v111, s68, v199
v_add_f32 v20, v96, v97
v_add_f32 v20, v20, v98
v_add_f32 v20, v20, v99
v_add_f32 v20, v20, v100
v_add_f32 v20, v20, v101
v_add_f32 v20, v20, v102
v_add_f32 v20, v20, v103
v_add_f32 v20, v20, v104
v_add_f32 v20, v20, v105
v_add_f32 v20, v20, v106
v_add_f32 v20, v20, v107
v_add_f32 v20, v20, v108
v_add_f32 v20, v20, v109
v_add_f32 v20, v20, v110
v_add_f32 v20, v20, v111
s_nop 1
v_add_f32_dpp v20, v20, v20 row_ror:8 row_mask:0xf bank_mask:0xf
v_mov_b32 v22, v20
s_nop 1
v_permlane16_swap_b32 v20, v22
s_nop 1
v_add_f32 v20, v20, v22
v_mov_b32 v22, v20
s_nop 1
v_permlane32_swap_b32 v20, v22
s_nop 1
v_add_f32 v20, v20, v22
v_mul_f32 v20, 0x3c000000, v20
v_mov_b32 v21, 0
v_sub_f32 v22, v96, v20
v_fmac_f32 v21, v22, v22
v_sub_f32 v22, v97, v20
v_fmac_f32 v21, v22, v22
v_sub_f32 v22, v98, v20
v_fmac_f32 v21, v22, v22
v_sub_f32 v22, v99, v20
v_fmac_f32 v21, v22, v22
v_sub_f32 v22, v100, v20
v_fmac_f32 v21, v22, v22
v_sub_f32 v22, v101, v20
v_fmac_f32 v21, v22, v22
v_sub_f32 v22, v102, v20
v_fmac_f32 v21, v22, v22
v_sub_f32 v22, v103, v20
v_fmac_f32 v21, v22, v22
v_sub_f32 v22, v104, v20
v_fmac_f32 v21, v22, v22
v_sub_f32 v22, v105, v20
v_fmac_f32 v21, v22, v22
v_sub_f32 v22, v106, v20
v_fmac_f32 v21, v22, v22
v_sub_f32 v22, v107, v20
v_fmac_f32 v21, v22, v22
v_sub_f32 v22, v108, v20
v_fmac_f32 v21, v22, v22
v_sub_f32 v22, v109, v20
v_fmac_f32 v21, v22, v22
v_sub_f32 v22, v110, v20
v_fmac_f32 v21, v22, v22
v_sub_f32 v22, v111, v20
v_fmac_f32 v21, v22, v22
s_nop 1
v_add_f32_dpp v21, v21, v21 row_ror:8 row_mask:0xf bank_mask:0xf
v_mov_b32 v22, v21
s_nop 1
v_permlane16_swap_b32 v21, v22
s_nop 1
v_add_f32 v21, v21, v22
v_mov_b32 v22, v21
s_nop 1
v_permlane32_swap_b32 v21, v22
s_nop 1
v_add_f32 v21, v21, v22
v_lshlrev_b32 v22, 1, v32
s_lshl_b32 s66, s34, 6
v_add_u32 v23, s66, v22
ds_write_b64 v23, v[20:21] offset:0
v_mov_b32 v23, 0
s_waitcnt lgkmcnt(0)
s_mov_b64 exec, 1
ds_add_u32 v23, v9 offset:332
s_mov_b64 exec, -1
s_mov_b32 s75, 0
L_poll_142:
ds_read_b32 v24, v23 offset:332
s_waitcnt lgkmcnt(0)
v_cmp_gt_u32 vcc, 4, v24
s_cbranch_vccz L_pollx_143
s_add_u32 s75, s75, 1
s_cmp_lt_u32 s75, 0x1000000
s_cbranch_scc1 L_poll_142
L_pollx_143:
ds_read_b64 v[112:113], v22 offset:0
ds_read_b64 v[114:115], v22 offset:64
ds_read_b64 v[116:117], v22 offset:128
ds_read_b64 v[118:119], v22 offset:192
s_waitcnt lgkmcnt(0)
v_add_f32 v20, v112, v114
v_add_f32 v21, v116, v118
v_add_f32 v20, v20, v21
v_mul_f32 v20, 0x3e800000, v20
v_add_f32 v24, v113, v115
v_add_f32 v21, v117, v119
v_add_f32 v24, v24, v21
v_mov_b32 v21, 0
v_sub_f32 v22, v112, v20
v_fmac_f32 v21, v22, v22
v_sub_f32 v22, v114, v20
v_fmac_f32 v21, v22, v22
v_sub_f32 v22, v116, v20
v_fmac_f32 v21, v22, v22
v_sub_f32 v22, v118, v20
v_fmac_f32 v21, v22, v22
v_fmac_f32 v24, 0x43000000, v21
v_mul_f32 v24, 0x3b000000, v24
v_cvt_pk_bf16_f32 v24, 0, v24
v_cvt_pk_bf16_f32 v20, 0, v20
v_add_f32 v24, 0x3727c5ac, v24
v_cvt_pk_bf16_f32 v24, 0, v24
v_sqrt_f32 v24, v24
s_nop 0
v_cvt_pk_bf16_f32 v24, 0, v24
v_rcp_f32 v24, v24
s_nop 0
v_sub_f32 v96, v96, v20
v_cvt_pk_bf16_f32 v96, 0, v96
v_mul_f32 v96, v96, v24
v_cvt_pk_bf16_f32 v96, 0, v96
v_sub_f32 v97, v97, v20
v_cvt_pk_bf16_f32 v97, 0, v97
v_mul_f32 v97, v97, v24
v_cvt_pk_bf16_f32 v97, 0, v97
v_sub_f32 v98, v98, v20
v_cvt_pk_bf16_f32 v98, 0, v98
v_mul_f32 v98, v98, v24
v_cvt_pk_bf16_f32 v98, 0, v98
v_sub_f32 v99, v99, v20
v_cvt_pk_bf16_f32 v99, 0, v99
v_mul_f32 v99, v99, v24
v_cvt_pk_bf16_f32 v99, 0, v99
v_sub_f32 v100, v100, v20
v_cvt_pk_bf16_f32 v100, 0, v100
v_mul_f32 v100, v100, v24
v_cvt_pk_bf16_f32 v100, 0, v100
v_sub_f32 v101, v101, v20
v_cvt_pk_bf16_f32 v101, 0, v101
v_mul_f32 v101, v101, v24
v_cvt_pk_bf16_f32 v101, 0, v101
v_sub_f32 v102, v102, v20
v_cvt_pk_bf16_f32 v102, 0, v102
v_mul_f32 v102, v102, v24
v_cvt_pk_bf16_f32 v102, 0, v102
v_sub_f32 v103, v103, v20
v_cvt_pk_bf16_f32 v103, 0, v103
v_mul_f32 v103, v103, v24
v_cvt_pk_bf16_f32 v103, 0, v103
v_sub_f32 v104, v104, v20
v_cvt_pk_bf16_f32 v104, 0, v104
v_mul_f32 v104, v104, v24
v_cvt_pk_bf16_f32 v104, 0, v104
v_sub_f32 v105, v105, v20
v_cvt_pk_bf16_f32 v105, 0, v105
v_mul_f32 v105, v105, v24
v_cvt_pk_bf16_f32 v105, 0, v105
v_sub_f32 v106, v106, v20
v_cvt_pk_bf16_f32 v106, 0, v106
v_mul_f32 v106, v106, v24
v_cvt_pk_bf16_f32 v106, 0, v106
v_sub_f32 v107, v107, v20
v_cvt_pk_bf16_f32 v107, 0, v107
v_mul_f32 v107, v107, v24
v_cvt_pk_bf16_f32 v107, 0, v107
v_sub_f32 v108, v108, v20
v_cvt_pk_bf16_f32 v108, 0, v108
v_mul_f32 v108, v108, v24
v_cvt_pk_bf16_f32 v108, 0, v108
v_sub_f32 v109, v109, v20
v_cvt_pk_bf16_f32 v109, 0, v109
v_mul_f32 v109, v109, v24
v_cvt_pk_bf16_f32 v109, 0, v109
v_sub_f32 v110, v110, v20
v_cvt_pk_bf16_f32 v110, 0, v110
v_mul_f32 v110, v110, v24
v_cvt_pk_bf16_f32 v110, 0, v110
v_sub_f32 v111, v111, v20
v_cvt_pk_bf16_f32 v111, 0, v111
v_mul_f32 v111, v111, v24
v_cvt_pk_bf16_f32 v111, 0, v111
L_g2:
s_cmp_ge_u32 s2, s73
s_cbranch_scc0 L_fl_144
s_waitcnt vmcnt(0)
v_cmp_eq_u32 vcc, 0, v31
s_cbranch_vccz L_fl_144
s_mov_b32 s75, 0
L_poll_145:
buffer_load_dword v31, v30, s[52:55], 0 offen sc1
s_waitcnt vmcnt(0)
v_cmp_eq_u32 vcc, 0, v31
s_cbranch_vccz L_pollx_146
s_sleep 40
s_add_u32 s75, s75, 1
s_cmp_lt_u32 s75, 0x100000
s_cbranch_scc1 L_poll_145
L_pollx_146:
L_fl_144:
v_mov_b32 v20, 0
s_cmp_eq_u32 s34, 0
s_cbranch_scc0 L_w_147
ds_write_b32 v20, v9 offset:324
L_w_147:
v_lshrrev_b32 v18, 4, v0
v_bfe_u32 v19, v0, 2, 2
v_lshrrev_b32 v20, 1, v19
v_and_b32 v21, 1, v18
v_lshl_add_u32 v20, v21, 1, v20
v_lshlrev_b32 v20, 5, v20
v_lshl_add_u32 v20, v18, 10, v20
v_lshl_add_u32 v20, v19, 7, v20
v_and_b32 v21, 3, v0
v_lshl_add_u32 v20, v21, 3, v20
v_add_u32 v40, s65, v20
v_xor_b32 v41, 32, v40
v_xor_b32 v42, 64, v40
v_xor_b32 v43, 96, v40
s_waitcnt vmcnt(12) lgkmcnt(0)
ds_read_b64_tr_b16 v[128:129], v40 offset:0
ds_read_b64_tr_b16 v[130:131], v40 offset:512
ds_read_b64_tr_b16 v[132:133], v41 offset:0
ds_read_b64_tr_b16 v[134:135], v41 offset:512
ds_read_b64_tr_b16 v[136:137], v42 offset:0
ds_read_b64_tr_b16 v[138:139], v42 offset:512
ds_read_b64_tr_b16 v[140:141], v43 offset:0
ds_read_b64_tr_b16 v[142:143], v43 offset:512
s_waitcnt vmcnt(8) lgkmcnt(0)
ds_read_b64_tr_b16 v[144:145], v40 offset:4096
ds_read_b64_tr_b16 v[146:147], v40 offset:4608
ds_read_b64_tr_b16 v[148:149], v41 offset:4096
ds_read_b64_tr_b16 v[150:151], v41 offset:4608
ds_read_b64_tr_b16 v[152:153], v42 offset:4096
ds_read_b64_tr_b16 v[154:155], v42 offset:4608
ds_read_b64_tr_b16 v[156:157], v43 offset:4096
ds_read_b64_tr_b16 v[158:159], v43 offset:4608
s_waitcnt vmcnt(4) lgkmcnt(0)
ds_read_b64_tr_b16 v[160:161], v40 offset:32768
ds_read_b64_tr_b16 v[162:163], v40 offset:33280
ds_read_b64_tr_b16 v[164:165], v41 offset:32768
ds_read_b64_tr_b16 v[166:167], v41 offset:33280
ds_read_b64_tr_b16 v[168:169], v42 offset:32768
ds_read_b64_tr_b16 v[170:171], v42 offset:33280
ds_read_b64_tr_b16 v[172:173], v43 offset:32768
ds_read_b64_tr_b16 v[174:175], v43 offset:33280
s_waitcnt vmcnt(0) lgkmcnt(0)
ds_read_b64_tr_b16 v[176:177], v40 offset:36864
ds_read_b64_tr_b16 v[178:179], v40 offset:37376
ds_read_b64_tr_b16 v[180:181], v41 offset:36864
ds_read_b64_tr_b16 v[182:183], v41 offset:37376
ds_read_b64_tr_b16 v[184:185], v42 offset:36864
ds_read_b64_tr_b16 v[186:187], v42 offset:37376
ds_read_b64_tr_b16 v[188:189], v43 offset:36864
ds_read_b64_tr_b16 v[190:191], v43 offset:37376
s_waitcnt lgkmcnt(0)
s_cmp_eq_u32 s34, 2
s_cselect_b32 s73, 16, 0x1000
v_and_b32 v30, 31, v0
v_lshlrev_b32 v30, 2, v30
s_cmp_ge_u32 s2, s73
s_cbranch_scc0 L_fl_148
buffer_load_dword v31, v30, s[52:55], 0 offen offset:128 sc1
L_fl_148:
s_cmp_lt_u32 s2, 48
s_cbranch_scc1 L_g3
v_mov_b32 v20, 0
s_mov_b32 s75, 0
L_poll_149:
ds_read_b32 v22, v20 offset:324
s_waitcnt lgkmcnt(0)
v_cmp_eq_u32 vcc, 0, v22
s_cbranch_vccz L_pollx_150
s_sleep 1
s_add_u32 s75, s75, 1
s_cmp_lt_u32 s75, 0x1000000
s_cbranch_scc1 L_poll_149
L_pollx_150:
s_lshl_b32 s64, s34, 11
s_add_u32 s64, s64, 0
s_add_u32 s66, s64, 8192
s_mov_b32 s75, 0
L_poll_151:
buffer_load_dwordx4 v[192:195], v1, s[36:39], s64 offen offset:0 sc1
buffer_load_dwordx4 v[200:203], v1, s[36:39], s66 offen offset:0 sc1
buffer_load_dwordx4 v[196:199], v1, s[36:39], s64 offen offset:1024 sc1
buffer_load_dwordx4 v[204:207], v1, s[36:39], s66 offen offset:1024 sc1
s_waitcnt vmcnt(0)
v_max3_u32 v22, v192, v193, v194
v_max3_u32 v22, v22, v195, v196
v_max3_u32 v22, v22, v197, v198
v_max3_u32 v22, v22, v199, v200
v_max3_u32 v22, v22, v201, v202
v_max3_u32 v22, v22, v203, v204
v_max3_u32 v22, v22, v205, v206
v_max_u32 v22, v22, v207
v_cmp_eq_u32 vcc, -1, v22
s_cbranch_vccz L_pollx_152
s_sleep 16
s_add_u32 s75, s75, 1
s_cmp_lt_u32 s75, 0x100000
s_cbranch_scc1 L_poll_151
L_pollx_152:
v_lshlrev_b32 v20, 16, v200
v_and_b32 v21, s68, v200
v_add_f32 v20, 1.0, v20
v_add_f32 v21, 1.0, v21
v_cvt_pk_bf16_f32 v20, 0, v20
v_cvt_pk_bf16_f32 v21, 0, v21
v_mul_f32 v20, v20, v96
v_mul_f32 v21, v21, v97
v_cvt_pk_bf16_f32 v20, 0, v20
v_cvt_pk_bf16_f32 v21, 0, v21
v_lshlrev_b32 v22, 16, v192
v_and_b32 v23, s68, v192
v_add_f32 v20, v20, v22
v_add_f32 v21, v21, v23
v_cvt_pk_bf16_f32 v48, v20, v21
v_lshlrev_b32 v20, 16, v201
v_and_b32 v21, s68, v201
v_add_f32 v20, 1.0, v20
v_add_f32 v21, 1.0, v21
v_cvt_pk_bf16_f32 v20, 0, v20
v_cvt_pk_bf16_f32 v21, 0, v21
v_mul_f32 v20, v20, v98
v_mul_f32 v21, v21, v99
v_cvt_pk_bf16_f32 v20, 0, v20
v_cvt_pk_bf16_f32 v21, 0, v21
v_lshlrev_b32 v22, 16, v193
v_and_b32 v23, s68, v193
v_add_f32 v20, v20, v22
v_add_f32 v21, v21, v23
v_cvt_pk_bf16_f32 v49, v20, v21
v_lshlrev_b32 v20, 16, v202
v_and_b32 v21, s68, v202
v_add_f32 v20, 1.0, v20
v_add_f32 v21, 1.0, v21
v_cvt_pk_bf16_f32 v20, 0, v20
v_cvt_pk_bf16_f32 v21, 0, v21
v_mul_f32 v20, v20, v100
v_mul_f32 v21, v21, v101
v_cvt_pk_bf16_f32 v20, 0, v20
v_cvt_pk_bf16_f32 v21, 0, v21
v_lshlrev_b32 v22, 16, v194
v_and_b32 v23, s68, v194
v_add_f32 v20, v20, v22
v_add_f32 v21, v21, v23
v_cvt_pk_bf16_f32 v50, v20, v21
v_lshlrev_b32 v20, 16, v203
v_and_b32 v21, s68, v203
v_add_f32 v20, 1.0, v20
v_add_f32 v21, 1.0, v21
v_cvt_pk_bf16_f32 v20, 0, v20
v_cvt_pk_bf16_f32 v21, 0, v21
v_mul_f32 v20, v20, v102
v_mul_f32 v21, v21, v103
v_cvt_pk_bf16_f32 v20, 0, v20
v_cvt_pk_bf16_f32 v21, 0, v21
v_lshlrev_b32 v22, 16, v195
v_and_b32 v23, s68, v195
v_add_f32 v20, v20, v22
v_add_f32 v21, v21, v23
v_cvt_pk_bf16_f32 v51, v20, v21
v_lshlrev_b32 v20, 16, v204
v_and_b32 v21, s68, v204
v_add_f32 v20, 1.0, v20
v_add_f32 v21, 1.0, v21
v_cvt_pk_bf16_f32 v20, 0, v20
v_cvt_pk_bf16_f32 v21, 0, v21
v_mul_f32 v20, v20, v104
v_mul_f32 v21, v21, v105
v_cvt_pk_bf16_f32 v20, 0, v20
v_cvt_pk_bf16_f32 v21, 0, v21
v_lshlrev_b32 v22, 16, v196
v_and_b32 v23, s68, v196
v_add_f32 v20, v20, v22
v_add_f32 v21, v21, v23
v_cvt_pk_bf16_f32 v52, v20, v21
v_lshlrev_b32 v20, 16, v205
v_and_b32 v21, s68, v205
v_add_f32 v20, 1.0, v20
v_add_f32 v21, 1.0, v21
v_cvt_pk_bf16_f32 v20, 0, v20
v_cvt_pk_bf16_f32 v21, 0, v21
v_mul_f32 v20, v20, v106
v_mul_f32 v21, v21, v107
v_cvt_pk_bf16_f32 v20, 0, v20
v_cvt_pk_bf16_f32 v21, 0, v21
v_lshlrev_b32 v22, 16, v197
v_and_b32 v23, s68, v197
v_add_f32 v20, v20, v22
v_add_f32 v21, v21, v23
v_cvt_pk_bf16_f32 v53, v20, v21
v_lshlrev_b32 v20, 16, v206
v_and_b32 v21, s68, v206
v_add_f32 v20, 1.0, v20
v_add_f32 v21, 1.0, v21
v_cvt_pk_bf16_f32 v20, 0, v20
v_cvt_pk_bf16_f32 v21, 0, v21
v_mul_f32 v20, v20, v108
v_mul_f32 v21, v21, v109
v_cvt_pk_bf16_f32 v20, 0, v20
v_cvt_pk_bf16_f32 v21, 0, v21
v_lshlrev_b32 v22, 16, v198
v_and_b32 v23, s68, v198
v_add_f32 v20, v20, v22
v_add_f32 v21, v21, v23
v_cvt_pk_bf16_f32 v54, v20, v21
v_lshlrev_b32 v20, 16, v207
v_and_b32 v21, s68, v207
v_add_f32 v20, 1.0, v20
v_add_f32 v21, 1.0, v21
v_cvt_pk_bf16_f32 v20, 0, v20
v_cvt_pk_bf16_f32 v21, 0, v21
v_mul_f32 v20, v20, v110
v_mul_f32 v21, v21, v111
v_cvt_pk_bf16_f32 v20, 0, v20
v_cvt_pk_bf16_f32 v21, 0, v21
v_lshlrev_b32 v22, 16, v199
v_and_b32 v23, s68, v199
v_add_f32 v20, v20, v22
v_add_f32 v21, v21, v23
v_cvt_pk_bf16_f32 v55, v20, v21
L_g3:
s_cmp_ge_u32 s2, s73
s_cbranch_scc0 L_fl_153
s_waitcnt vmcnt(0)
v_cmp_eq_u32 vcc, 0, v31
s_cbranch_vccz L_fl_153
s_mov_b32 s75, 0
L_poll_154:
buffer_load_dword v31, v30, s[52:55], 0 offen offset:128 sc1
s_waitcnt vmcnt(0)
v_cmp_eq_u32 vcc, 0, v31
s_cbranch_vccz L_pollx_155
s_sleep 40
s_add_u32 s75, s75, 1
s_cmp_lt_u32 s75, 0x100000
s_cbranch_scc1 L_poll_154
L_pollx_155:
L_fl_153:
s_nop 1
v_mfma_f32_16x16x32_bf16 v[64:67], v[128:131], v[48:51], 0
v_mfma_f32_16x16x32_bf16 v[68:71], v[132:135], v[48:51], 0
v_mfma_f32_16x16x32_bf16 v[72:75], v[136:139], v[48:51], 0
v_mfma_f32_16x16x32_bf16 v[76:79], v[140:143], v[48:51], 0
v_mfma_f32_16x16x32_bf16 v[80:83], v[144:147], v[48:51], 0
v_mfma_f32_16x16x32_bf16 v[84:87], v[148:151], v[48:51], 0
v_mfma_f32_16x16x32_bf16 v[88:91], v[152:155], v[48:51], 0
v_mfma_f32_16x16x32_bf16 v[92:95], v[156:159], v[48:51], 0
v_mfma_f32_16x16x32_bf16 v[64:67], v[160:163], v[52:55], v[64:67]
v_mfma_f32_16x16x32_bf16 v[68:71], v[164:167], v[52:55], v[68:71]
v_mfma_f32_16x16x32_bf16 v[72:75], v[168:171], v[52:55], v[72:75]
v_mfma_f32_16x16x32_bf16 v[76:79], v[172:175], v[52:55], v[76:79]
v_mfma_f32_16x16x32_bf16 v[80:83], v[176:179], v[52:55], v[80:83]
v_mfma_f32_16x16x32_bf16 v[84:87], v[180:183], v[52:55], v[84:87]
v_mfma_f32_16x16x32_bf16 v[88:91], v[184:187], v[52:55], v[88:91]
v_mfma_f32_16x16x32_bf16 v[92:95], v[188:191], v[52:55], v[92:95]
v_and_b32 v20, 7, v0
v_mul_u32_u24 v20, 272, v20
v_and_b32 v21, 8, v0
v_lshl_add_u32 v20, v21, 3, v20
v_and_b32 v21, 48, v0
v_add_u32 v20, v20, v21
s_mul_i32 s64, s34, 8192
s_add_u32 s64, s64, 4096
v_add_u32 v20, s64, v20
s_nop 7
v_add_f32_dpp v24, v80, v64 row_ror:8 row_mask:0xf bank_mask:0x3
v_add_f32_dpp v24, v68, v84 row_ror:8 row_mask:0xf bank_mask:0xc
v_add_f32_dpp v25, v81, v65 row_ror:8 row_mask:0xf bank_mask:0x3
v_add_f32_dpp v25, v69, v85 row_ror:8 row_mask:0xf bank_mask:0xc
v_add_f32_dpp v26, v82, v66 row_ror:8 row_mask:0xf bank_mask:0x3
v_add_f32_dpp v26, v70, v86 row_ror:8 row_mask:0xf bank_mask:0xc
v_add_f32_dpp v27, v83, v67 row_ror:8 row_mask:0xf bank_mask:0x3
v_add_f32_dpp v27, v71, v87 row_ror:8 row_mask:0xf bank_mask:0xc
ds_write_b128 v20, v[24:27] offset:0
v_add_f32_dpp v28, v88, v72 row_ror:8 row_mask:0xf bank_mask:0x3
v_add_f32_dpp v28, v76, v92 row_ror:8 row_mask:0xf bank_mask:0xc
v_add_f32_dpp v29, v89, v73 row_ror:8 row_mask:0xf bank_mask:0x3
v_add_f32_dpp v29, v77, v93 row_ror:8 row_mask:0xf bank_mask:0xc
v_add_f32_dpp v30, v90, v74 row_ror:8 row_mask:0xf bank_mask:0x3
v_add_f32_dpp v30, v78, v94 row_ror:8 row_mask:0xf bank_mask:0xc
v_add_f32_dpp v31, v91, v75 row_ror:8 row_mask:0xf bank_mask:0x3
v_add_f32_dpp v31, v79, v95 row_ror:8 row_mask:0xf bank_mask:0xc
ds_write_b128 v20, v[28:31] offset:128
v_mov_b32 v20, 0
s_waitcnt lgkmcnt(0)
s_mov_b64 exec, 1
ds_add_u32 v20, v9 offset:320
s_mov_b64 exec, -1
s_cmp_eq_u32 s34, 0
s_cbranch_scc0 L_waitq
s_cmp_lt_u32 s2, 16
s_cbranch_scc0 L_gq2
v_and_b32 v21, 7, v0
v_lshrrev_b32 v22, 4, v0
v_and_b32 v23, 8, v0
v_lshrrev_b32 v23, 1, v23
v_add_u32 v22, v22, v23
v_mov_b32 v23, v1
s_lshl_b32 s64, s72, 10
s_add_u32 s64, s64, 0
s_branch L_g4
L_gq2:
v_lshrrev_b32 v21, 3, v0
v_and_b32 v22, 7, v0
s_mov_b32 s64, 10240
s_cmp_lt_u32 s2, 48
s_cselect_b32 s64, 22528, s64
s_mov_b32 s65, 12288
v_mul_lo_u32 v23, s65, v21
v_lshl_add_u32 v23, v22, 4, v23
s_lshl_b32 s66, s72, 7
s_add_u32 s64, s64, s66
L_g4:
v_mul_u32_u24 v21, 272, v21
v_lshl_add_u32 v21, v22, 5, v21
v_add_u32 v21, 4096, v21
s_mov_b32 s75, 0
L_poll_156:
ds_read_b32 v22, v20 offset:320
s_waitcnt lgkmcnt(0)
v_cmp_gt_u32 vcc, 4, v22
s_cbranch_vccz L_pollx_157
s_add_u32 s75, s75, 1
s_cmp_lt_u32 s75, 0x1000000
s_cbranch_scc1 L_poll_156
L_pollx_157:
ds_read_b128 v[64:67], v21 offset:0
ds_read_b128 v[68:71], v21 offset:16
ds_read_b128 v[72:75], v21 offset:8192
ds_read_b128 v[76:79], v21 offset:8208
ds_read_b128 v[80:83], v21 offset:16384
ds_read_b128 v[84:87], v21 offset:16400
ds_read_b128 v[88:91], v21 offset:24576
ds_read_b128 v[92:95], v21 offset:24592
s_waitcnt lgkmcnt(0)
v_add_f32 v64, v64, v72
v_add_f32 v65, v65, v73
v_add_f32 v66, v66, v74
v_add_f32 v67, v67, v75
v_add_f32 v68, v68, v76
v_add_f32 v69, v69, v77
v_add_f32 v70, v70, v78
v_add_f32 v71, v71, v79
v_add_f32 v64, v64, v80
v_add_f32 v65, v65, v81
v_add_f32 v66, v66, v82
v_add_f32 v67, v67, v83
v_add_f32 v68, v68, v84
v_add_f32 v69, v69, v85
v_add_f32 v70, v70, v86
v_add_f32 v71, v71, v87
v_add_f32 v64, v64, v88
v_add_f32 v65, v65, v89
v_add_f32 v66, v66, v90
v_add_f32 v67, v67, v91
v_add_f32 v68, v68, v92
v_add_f32 v69, v69, v93
v_add_f32 v70, v70, v94
v_add_f32 v71, v71, v95
v_cvt_pk_bf16_f32 v24, v64, v65
v_cvt_pk_bf16_f32 v25, v66, v67
v_cvt_pk_bf16_f32 v26, v68, v69
v_cvt_pk_bf16_f32 v27, v70, v71
v_min_u32 v24, -2, v24
v_min_u32 v25, -2, v25
v_min_u32 v26, -2, v26
v_min_u32 v27, -2, v27
buffer_store_dwordx4 v[24:27], v23, s[36:39], s64 offen sc1
s_branch L_waitq
L_jan:
v_mov_b32 v4, -1
v_mov_b32 v5, -1
v_mov_b32 v6, -1
v_mov_b32 v7, -1
s_lshl_b32 s67, s64, 2
s_add_u32 s67, s67, s34
s_cmp_lt_u32 s67, 32
s_cselect_b32 s66, 0, 933888
s_mul_i32 s65, s67, 3072
s_add_u32 s65, s65, s66
s_add_u32 s65, s65, 16384
v_add_u32 v8, s65, v1
global_store_dwordx4 v8, v[4:7], s[30:31] offset:0 sc1
global_store_dwordx4 v8, v[4:7], s[30:31] offset:1024 sc1
global_store_dwordx4 v8, v[4:7], s[30:31] offset:2048 sc1
s_and_b32 s66, s67, 64
s_add_u32 s67, s67, s66
s_lshl_b32 s67, s67, 7
s_add_u32 s67, s67, 1343488
v_and_b32 v8, 8, v0
v_lshlrev_b32 v8, 10, v8
v_and_b32 v10, 0x70, v1
v_add3_u32 v8, v8, v10, s67
s_mov_b64 exec, 0xffff
global_store_dwordx4 v8, v[4:7], s[30:31] sc1
s_mov_b64 exec, 1
s_load_dword s68, s[30:31], 0x48000
s_and_b32 s65, s34, 1
s_lshl_b32 s66, s65, 13
s_xor_b32 s67, s67, s66
s_xor_b32 s66, s67, 0x2000
s_waitcnt vmcnt(0) lgkmcnt(0)
s_mov_b64 exec, -1
s_cmp_eq_u32 s34, 3
s_cbranch_scc1 L_p0_158
s_cmp_eq_u32 s34, 0
s_cselect_b32 s62, s24, s10
s_cselect_b32 s63, s25, s11
s_cmp_eq_u32 s34, 2
s_cselect_b32 s62, s12, s62
s_cselect_b32 s63, s13, s63
global_load_dword v12, v38, s[62:63]
global_load_dword v13, v39, s[62:63]
L_p0_158:
s_mov_b64 exec, 1
s_mov_b32 s70, 0
s_load_dword s68, s[30:31], s67
L_race_159:
s_getreg_b32 s69, hwreg(HW_REG_IB_STS, 8, 4)
s_add_u32 s70, s70, 1
s_cmp_eq_u32 s69, 0
s_cbranch_scc0 L_race_159
s_waitcnt lgkmcnt(0)
s_mov_b32 s71, 0
s_load_dword s68, s[30:31], s66
L_race_160:
s_getreg_b32 s69, hwreg(HW_REG_IB_STS, 8, 4)
s_add_u32 s71, s71, 1
s_cmp_eq_u32 s69, 0
s_cbranch_scc0 L_race_160
s_waitcnt lgkmcnt(0)
s_cmp_lt_u32 s71, s70
s_cselect_b32 s70, 1, 0
s_xor_b32 s70, s70, s65
s_getreg_b32 s69, hwreg(HW_REG_XCC_ID, 2, 1)
s_xor_b32 s70, s70, s69
s_lshl_b32 s69, s69, 14
s_lshl_b32 s70, s70, 8
s_add_u32 s70, s70, s69
s_add_u32 s70, s70, 1
v_mov_b32 v9, s70
s_lshl_b32 s65, s64, 2
v_mov_b32 v8, s65
ds_add_rtn_u32 v11, v2, v9 offset:320
s_waitcnt lgkmcnt(0)
v_add_u32 v11, v11, v9
v_and_b32 v10, 0xff, v11
v_cmp_eq_u32 vcc, 4, v10
s_cbranch_vccz L_j_161
global_store_dword v8, v11, s[28:29] offset:128 sc1
L_j_161:
s_mov_b64 exec, -1
s_branch L_nop0
L_norole:
s_cmp_eq_u32 s74, -1
s_cbranch_scc1 L_waitq
L_waitq:
s_cmp_eq_u32 s74, -1
s_cselect_b64 vcc, 0, -1
s_cmp_lt_u32 s2, 112
s_cselect_b64 vcc, -1, vcc
s_mov_b32 s44, s12
s_mov_b32 s45, s13
s_mov_b32 s46, 0x400000
s_mov_b32 s47, 0x20000
v_lshrrev_b32 v18, 4, v0
v_and_b32 v16, 15, v0
v_xor_b32 v16, v16, v18
v_xor_b32 v17, 4, v16
v_lshlrev_b32 v19, 10, v18
v_lshl_add_u32 v22, v16, 4, v19
v_lshl_add_u32 v23, v17, 4, v19
v_and_b32 v19, 1, v18
v_lshlrev_b32 v19, 10, v19
v_lshrrev_b32 v18, 1, v18
v_lshl_add_u32 v18, v18, 11, v19
v_lshl_add_u32 v16, v16, 4, v18
v_lshl_add_u32 v17, v17, 4, v18
v_lshrrev_b32 v18, 4, v0
v_bfe_u32 v19, v0, 2, 2
v_and_b32 v20, 2, v0
v_lshlrev_b32 v20, 2, v20
v_xor_b32 v20, v20, v19
v_and_b32 v21, 1, v18
v_lshlrev_b32 v21, 2, v21
v_xor_b32 v20, v20, v21
v_lshlrev_b32 v20, 4, v20
v_lshl_add_u32 v20, v18, 10, v20
v_lshl_add_u32 v20, v19, 8, v20
v_and_b32 v21, 1, v0
v_lshl_add_u32 v20, v21, 3, v20
s_lshl_b32 s65, s34, 13
s_add_u32 s65, s65, 8192
v_add_u32 v40, s65, v20
v_xor_b32 v41, 16, v40
v_xor_b32 v42, 32, v40
v_xor_b32 v43, 48, v40
v_xor_b32 v44, 64, v40
v_xor_b32 v45, 80, v40
v_xor_b32 v46, 96, v40
v_xor_b32 v47, 112, v40
s_lshl_b32 s64, s33, 17
s_lshl_b32 s66, s34, 8
s_add_u32 s64, s64, s66
s_mov_b32 s68, 0
s_lshl_b32 s66, s68, 10
s_add_u32 s64, s64, s66
s_add_u32 m0, s65, 0
s_xor_b32 s66, s64, 0
buffer_load_dwordx4 v16, s[44:47], s66 offen  lds
s_add_u32 m0, s65, 1024
s_xor_b32 s66, s64, 8192
buffer_load_dwordx4 v17, s[44:47], s66 offen  lds
s_add_u32 m0, s65, 2048
s_xor_b32 s66, s64, 16384
buffer_load_dwordx4 v16, s[44:47], s66 offen  lds
s_waitcnt vmcnt(2)
s_add_u32 m0, s65, 3072
s_xor_b32 s66, s64, 24576
buffer_load_dwordx4 v17, s[44:47], s66 offen  lds
s_waitcnt vmcnt(2)
s_add_u32 m0, s65, 32768
s_xor_b32 s66, s64, 4096
buffer_load_dwordx4 v16, s[44:47], s66 offen  lds
s_waitcnt vmcnt(2)
s_add_u32 m0, s65, 33792
s_xor_b32 s66, s64, 12288
buffer_load_dwordx4 v17, s[44:47], s66 offen  lds
s_waitcnt vmcnt(2)
ds_read_b64_tr_b16 v[128:129], v40 offset:0
ds_read_b64_tr_b16 v[136:137], v41 offset:0
ds_read_b64_tr_b16 v[144:145], v42 offset:0
ds_read_b64_tr_b16 v[152:153], v43 offset:0
ds_read_b64_tr_b16 v[160:161], v44 offset:0
ds_read_b64_tr_b16 v[168:169], v45 offset:0
ds_read_b64_tr_b16 v[176:177], v46 offset:0
ds_read_b64_tr_b16 v[184:185], v47 offset:0
s_add_u32 m0, s65, 34816
s_xor_b32 s66, s64, 20480
buffer_load_dwordx4 v16, s[44:47], s66 offen  lds
s_waitcnt vmcnt(2)
s_add_u32 m0, s65, 35840
s_xor_b32 s66, s64, 28672
buffer_load_dwordx4 v17, s[44:47], s66 offen  lds
s_waitcnt vmcnt(2)
s_waitcnt lgkmcnt(0)
s_add_u32 m0, s65, 0
s_xor_b32 s66, s64, 32768
buffer_load_dwordx4 v16, s[44:47], s66 offen  lds
s_waitcnt vmcnt(2)
s_add_u32 m0, s65, 1024
s_xor_b32 s66, s64, 40960
buffer_load_dwordx4 v17, s[44:47], s66 offen  lds
s_waitcnt vmcnt(2)
ds_read_b64_tr_b16 v[130:131], v40 offset:32768
ds_read_b64_tr_b16 v[138:139], v41 offset:32768
ds_read_b64_tr_b16 v[146:147], v42 offset:32768
ds_read_b64_tr_b16 v[154:155], v43 offset:32768
ds_read_b64_tr_b16 v[162:163], v44 offset:32768
ds_read_b64_tr_b16 v[170:171], v45 offset:32768
ds_read_b64_tr_b16 v[178:179], v46 offset:32768
ds_read_b64_tr_b16 v[186:187], v47 offset:32768
s_add_u32 m0, s65, 2048
s_xor_b32 s66, s64, 49152
buffer_load_dwordx4 v16, s[44:47], s66 offen  lds
s_waitcnt vmcnt(2)
s_add_u32 m0, s65, 3072
s_xor_b32 s66, s64, 57344
buffer_load_dwordx4 v17, s[44:47], s66 offen  lds
s_waitcnt vmcnt(2)
s_waitcnt lgkmcnt(0)
s_add_u32 m0, s65, 32768
s_xor_b32 s66, s64, 36864
buffer_load_dwordx4 v16, s[44:47], s66 offen  lds
s_waitcnt vmcnt(2)
s_add_u32 m0, s65, 33792
s_xor_b32 s66, s64, 45056
buffer_load_dwordx4 v17, s[44:47], s66 offen  lds
s_waitcnt vmcnt(2)
ds_read_b64_tr_b16 v[132:133], v40 offset:0
ds_read_b64_tr_b16 v[140:141], v41 offset:0
ds_read_b64_tr_b16 v[148:149], v42 offset:0
ds_read_b64_tr_b16 v[156:157], v43 offset:0
ds_read_b64_tr_b16 v[164:165], v44 offset:0
ds_read_b64_tr_b16 v[172:173], v45 offset:0
ds_read_b64_tr_b16 v[180:181], v46 offset:0
ds_read_b64_tr_b16 v[188:189], v47 offset:0
s_add_u32 m0, s65, 34816
s_xor_b32 s66, s64, 53248
buffer_load_dwordx4 v16, s[44:47], s66 offen  lds
s_waitcnt vmcnt(2)
s_add_u32 m0, s65, 35840
s_xor_b32 s66, s64, 61440
buffer_load_dwordx4 v17, s[44:47], s66 offen  lds
s_waitcnt vmcnt(2)
s_waitcnt lgkmcnt(0)
s_add_u32 m0, s65, 0
s_xor_b32 s66, s64, 65536
buffer_load_dwordx4 v16, s[44:47], s66 offen  lds
s_waitcnt vmcnt(2)
s_add_u32 m0, s65, 1024
s_xor_b32 s66, s64, 73728
buffer_load_dwordx4 v17, s[44:47], s66 offen  lds
s_waitcnt vmcnt(2)
ds_read_b64_tr_b16 v[134:135], v40 offset:32768
ds_read_b64_tr_b16 v[142:143], v41 offset:32768
ds_read_b64_tr_b16 v[150:151], v42 offset:32768
ds_read_b64_tr_b16 v[158:159], v43 offset:32768
ds_read_b64_tr_b16 v[166:167], v44 offset:32768
ds_read_b64_tr_b16 v[174:175], v45 offset:32768
ds_read_b64_tr_b16 v[182:183], v46 offset:32768
ds_read_b64_tr_b16 v[190:191], v47 offset:32768
s_add_u32 m0, s65, 2048
s_xor_b32 s66, s64, 81920
buffer_load_dwordx4 v16, s[44:47], s66 offen  lds
s_waitcnt vmcnt(2)
s_add_u32 m0, s65, 3072
s_xor_b32 s66, s64, 90112
buffer_load_dwordx4 v17, s[44:47], s66 offen  lds
s_waitcnt vmcnt(2)
s_waitcnt lgkmcnt(0)
s_add_u32 m0, s65, 32768
s_xor_b32 s66, s64, 69632
buffer_load_dwordx4 v16, s[44:47], s66 offen  lds
s_waitcnt vmcnt(2)
s_add_u32 m0, s65, 33792
s_xor_b32 s66, s64, 77824
buffer_load_dwordx4 v17, s[44:47], s66 offen  lds
s_waitcnt vmcnt(2)
ds_read_b64_tr_b16 v[192:193], v40 offset:0
ds_read_b64_tr_b16 v[200:201], v41 offset:0
ds_read_b64_tr_b16 v[208:209], v42 offset:0
ds_read_b64_tr_b16 v[216:217], v43 offset:0
ds_read_b64_tr_b16 v[224:225], v44 offset:0
ds_read_b64_tr_b16 v[232:233], v45 offset:0
ds_read_b64_tr_b16 v[240:241], v46 offset:0
ds_read_b64_tr_b16 v[248:249], v47 offset:0
s_add_u32 m0, s65, 34816
s_xor_b32 s66, s64, 86016
buffer_load_dwordx4 v16, s[44:47], s66 offen  lds
s_waitcnt vmcnt(2)
s_add_u32 m0, s65, 35840
s_xor_b32 s66, s64, 94208
buffer_load_dwordx4 v17, s[44:47], s66 offen  lds
s_waitcnt vmcnt(2)
s_waitcnt lgkmcnt(0)
s_add_u32 m0, s65, 0
s_xor_b32 s66, s64, 98304
buffer_load_dwordx4 v16, s[44:47], s66 offen  lds
s_waitcnt vmcnt(2)
s_add_u32 m0, s65, 1024
s_xor_b32 s66, s64, 106496
buffer_load_dwordx4 v17, s[44:47], s66 offen  lds
s_waitcnt vmcnt(2)
ds_read_b64_tr_b16 v[194:195], v40 offset:32768
ds_read_b64_tr_b16 v[202:203], v41 offset:32768
ds_read_b64_tr_b16 v[210:211], v42 offset:32768
ds_read_b64_tr_b16 v[218:219], v43 offset:32768
ds_read_b64_tr_b16 v[226:227], v44 offset:32768
ds_read_b64_tr_b16 v[234:235], v45 offset:32768
ds_read_b64_tr_b16 v[242:243], v46 offset:32768
ds_read_b64_tr_b16 v[250:251], v47 offset:32768
v_and_b32 v24, 127, v2
buffer_load_dword v25, v24, s[52:55], 0 offen offset:128
s_add_u32 m0, s65, 2048
s_xor_b32 s66, s64, 114688
buffer_load_dwordx4 v16, s[44:47], s66 offen  lds
s_waitcnt vmcnt(2)
s_add_u32 m0, s65, 3072
s_xor_b32 s66, s64, 122880
buffer_load_dwordx4 v17, s[44:47], s66 offen  lds
s_waitcnt vmcnt(2)
s_waitcnt lgkmcnt(0)
s_add_u32 m0, s65, 32768
s_xor_b32 s66, s64, 102400
buffer_load_dwordx4 v16, s[44:47], s66 offen  lds
s_waitcnt vmcnt(2)
s_add_u32 m0, s65, 33792
s_xor_b32 s66, s64, 110592
buffer_load_dwordx4 v17, s[44:47], s66 offen  lds
s_waitcnt vmcnt(2)
ds_read_b64_tr_b16 v[196:197], v40 offset:0
ds_read_b64_tr_b16 v[204:205], v41 offset:0
ds_read_b64_tr_b16 v[212:213], v42 offset:0
ds_read_b64_tr_b16 v[220:221], v43 offset:0
ds_read_b64_tr_b16 v[228:229], v44 offset:0
ds_read_b64_tr_b16 v[236:237], v45 offset:0
ds_read_b64_tr_b16 v[244:245], v46 offset:0
ds_read_b64_tr_b16 v[252:253], v47 offset:0
s_add_u32 m0, s65, 34816
s_xor_b32 s66, s64, 118784
buffer_load_dwordx4 v16, s[44:47], s66 offen  lds
s_waitcnt vmcnt(2)
s_add_u32 m0, s65, 35840
s_xor_b32 s66, s64, 126976
buffer_load_dwordx4 v17, s[44:47], s66 offen  lds
s_waitcnt vmcnt(0)
ds_read_b64_tr_b16 v[198:199], v40 offset:32768
ds_read_b64_tr_b16 v[206:207], v41 offset:32768
ds_read_b64_tr_b16 v[214:215], v42 offset:32768
ds_read_b64_tr_b16 v[222:223], v43 offset:32768
ds_read_b64_tr_b16 v[230:231], v44 offset:32768
ds_read_b64_tr_b16 v[238:239], v45 offset:32768
ds_read_b64_tr_b16 v[246:247], v46 offset:32768
ds_read_b64_tr_b16 v[254:255], v47 offset:32768
s_waitcnt lgkmcnt(0)
v_cmp_eq_u32 vcc, 0, v25
s_cbranch_vccz L_tab_162
s_mov_b32 s75, 0
L_poll_163:
buffer_load_dword v25, v24, s[52:55], 0 offen offset:128 sc1
s_waitcnt vmcnt(0)
v_cmp_eq_u32 vcc, 0, v25
s_cbranch_vccz L_pollx_164
s_sleep 40
s_add_u32 s75, s75, 1
s_cmp_lt_u32 s75, 0x100000
s_cbranch_scc1 L_poll_163
L_pollx_164:
L_tab_162:
v_bfe_u32 v26, v25, 8, 3
v_lshrrev_b32 v25, 16, v25
s_nop 0
v_add_u32_dpp v26, v26, v26 quad_perm:[1,0,3,2] row_mask:0xf bank_mask:0xf
s_nop 1
v_add_u32_dpp v26, v26, v26 quad_perm:[2,3,0,1] row_mask:0xf bank_mask:0xf
s_nop 1
v_add_u32_dpp v26, v26, v26 row_ror:4 row_mask:0xf bank_mask:0xf
s_nop 1
v_add_u32_dpp v26, v26, v26 row_ror:8 row_mask:0xf bank_mask:0xf
s_nop 1
v_readlane_b32 s66, v26, 0
v_readlane_b32 s71, v26, 16
s_add_u32 s66, s66, s71
s_cmp_gt_u32 s66, 64
s_cselect_b32 s66, 1, 0
v_cmp_ne_u32 vcc, s66, v25
s_and_b32 s71, vcc_lo, 0xff
s_bcnt0_i32_b32 s66, s71
s_sub_u32 s66, s66, 24
v_mbcnt_lo_u32_b32 v24, s71, 0
v_sub_u32 v25, v0, v24
v_add_u32 v24, s66, v24
v_cndmask_b32 v24, v25, v24, vcc
v_bfe_u32 v25, v24, 1, 2
v_and_b32 v26, 1, v24
v_lshl_or_b32 v25, v26, 2, v25
v_lshlrev_b32 v25, v2, v25
s_nop 1
v_or_b32_dpp v25, v25, v25 quad_perm:[1,0,3,2] row_mask:0xf bank_mask:0xf
s_nop 1
v_or_b32_dpp v25, v25, v25 quad_perm:[2,3,0,1] row_mask:0xf bank_mask:0xf
s_nop 1
v_or_b32_dpp v25, v25, v25 row_shl:4 row_mask:0xf bank_mask:0xf
s_nop 1
v_readfirstlane_b32 s35, v25
s_mov_b64 exec, 1
ds_write_b32 v2, v25 offset:328
s_mov_b64 exec, -1
s_sub_u32 s64, s2, 144
s_cmp_lt_u32 s64, 64
s_cbranch_scc0 L_rp_165
s_cmp_eq_u32 s34, 0
s_cbranch_scc0 L_rp_165
s_mov_b32 s48, s4
s_mov_b32 s49, s5
s_mov_b32 s50, 0x2000
s_mov_b32 s51, 0x20000
v_and_b32 v5, 15, v0
v_and_b32 v6, 16, v0
v_lshl_add_u32 v5, v6, 1, v5
v_and_b32 v6, 32, v0
v_lshrrev_b32 v6, 1, v6
v_add_u32 v5, v5, v6
v_lshlrev_b32 v5, 1, v5
v_and_b32 v6, 0x7c, v5
s_lshl_b32 s65, s64, 7
s_and_b32 s66, s65, 0x380
s_lshr_b32 s64, s64, 3
s_mul_i32 s64, s64, 12288
s_add_u32 s64, s64, s66
s_add_u32 s64, s64, 24576
buffer_load_ushort v18, v5, s[48:51], s65 offen
s_mov_b32 s75, 0
L_poll_166:
buffer_load_dword v19, v6, s[36:39], s64 offen offset:0 sc1
buffer_load_dword v20, v6, s[36:39], s64 offen offset:3072 sc1
s_waitcnt vmcnt(0)
v_max_u32 v16, v19, v20
v_cmp_eq_u32 vcc, -1, v16
s_cbranch_vccz L_pollx_167
s_sleep 40
s_add_u32 s75, s75, 1
s_cmp_lt_u32 s75, 0x100000
s_cbranch_scc1 L_poll_166
L_pollx_167:
v_and_b32 v16, 1, v0
v_lshlrev_b32 v16, 4, v16
v_xor_b32 v16, 16, v16
v_lshlrev_b32 v18, 16, v18
v_lshlrev_b32 v19, v16, v19
v_and_b32 v19, 0xffff0000, v19
v_lshlrev_b32 v20, v16, v20
v_and_b32 v20, 0xffff0000, v20
ds_write_b32 v2, v18 offset:4096
ds_write_b32 v2, v19 offset:4352
ds_write_b32 v2, v20 offset:4608
L_rp_165:
v_lshlrev_b32 v10, 3, v0
s_lshl_b32 s64, s34, 8
s_add_u32 s64, s64, 2560
s_lshr_b32 s66, s68, 1
v_xor_b32 v12, s66, v0
v_mov_b32 v14, 0
v_bfe_u32 v11, v12, 0, 1
v_lshl_or_b32 v14, v11, 0, v14
v_bfe_u32 v11, v12, 1, 1
v_lshl_or_b32 v14, v11, 1, v14
v_bfe_u32 v11, v12, 2, 1
v_lshl_or_b32 v14, v11, 2, v14
v_bfe_u32 v11, v12, 3, 1
v_lshl_or_b32 v14, v11, 3, v14
v_bfe_u32 v11, v12, 4, 1
v_lshl_or_b32 v14, v11, 4, v14
v_bfe_u32 v11, v12, 5, 1
v_lshl_or_b32 v14, v11, 5, v14
v_and_b32 v11, 0x38, v14
v_and_b32 v12, 1, v14
v_lshl_add_u32 v11, v12, 2, v11
v_bfe_u32 v12, v14, 1, 2
v_add_u32 v11, v11, v12
v_lshl_add_u32 v11, v11, 2, s64
v_and_b32 v14, 1, v0
v_and_b32 v12, 48, v0
v_lshlrev_b32 v12, 1, v12
v_lshl_add_u32 v12, v14, 4, v12
v_add_u32 v12, s64, v12
v_mul_u32_u24 v15, 0xaaaa, v14
v_add_u32 v15, 0x4444, v15
v_mov_b32 v64, 0
v_mov_b32 v65, 0
v_mov_b32 v66, 0
v_mov_b32 v67, 0
v_mov_b32 v68, 0
v_mov_b32 v69, 0
v_mov_b32 v70, 0
v_mov_b32 v71, 0
v_mov_b32 v72, 0
v_mov_b32 v73, 0
v_mov_b32 v74, 0
v_mov_b32 v75, 0
v_mov_b32 v76, 0
v_mov_b32 v77, 0
v_mov_b32 v78, 0
v_mov_b32 v79, 0
v_mov_b32 v80, 0
v_mov_b32 v81, 0
v_mov_b32 v82, 0
v_mov_b32 v83, 0
v_mov_b32 v84, 0
v_mov_b32 v85, 0
v_mov_b32 v86, 0
v_mov_b32 v87, 0
v_mov_b32 v88, 0
v_mov_b32 v89, 0
v_mov_b32 v90, 0
v_mov_b32 v91, 0
v_mov_b32 v92, 0
v_mov_b32 v93, 0
v_mov_b32 v94, 0
v_mov_b32 v95, 0
s_lshl_b32 s64, s34, 3
s_lshr_b32 s64, s35, s64
v_bfe_u32 v13, v0, 3, 1
v_lshlrev_b32 v13, 2, v13
v_bfe_u32 v13, s64, v13, 3
v_and_b32 v14, 0x70, v1
v_lshl_add_u32 v13, v13, 12, v14
s_lshl_b32 s64, s34, 2
s_add_u32 s64, s64, s33
v_bfe_u32 v14, v0, 3, 1
v_lshl_add_u32 v14, v14, 1, s64
v_and_b32 v14, 31, v14
v_lshl_add_u32 v13, v14, 7, v13
s_lshl_b32 s69, s32, 15
s_add_u32 s69, s69, 1048576
s_waitcnt vmcnt(0) lgkmcnt(0)
s_barrier
ds_read_b64 v[20:21], v10 offset:512
ds_read_b64 v[22:23], v10 offset:1024
ds_read_b64 v[24:25], v10 offset:1536
ds_read_b64 v[26:27], v10 offset:2048
s_waitcnt lgkmcnt(2)
v_pk_add_f32 v[20:21], v[20:21], v[22:23]
s_waitcnt lgkmcnt(1)
v_pk_add_f32 v[20:21], v[20:21], v[24:25]
s_waitcnt lgkmcnt(0)
v_pk_add_f32 v[20:21], v[20:21], v[26:27]
v_cvt_pk_bf16_f32 v20, v20, v21
ds_write_b32 v11, v20
ds_read_b128 v[48:51], v12 offset:0
ds_read_b128 v[52:55], v12 offset:128
s_waitcnt lgkmcnt(1)
v_smfmac_f32_16x16x64_bf16 v[64:67], v[48:51], v[128:135], v15
v_smfmac_f32_16x16x64_bf16 v[68:71], v[48:51], v[136:143], v15
v_smfmac_f32_16x16x64_bf16 v[72:75], v[48:51], v[144:151], v15
v_smfmac_f32_16x16x64_bf16 v[76:79], v[48:51], v[152:159], v15
s_waitcnt lgkmcnt(0)
v_smfmac_f32_16x16x64_bf16 v[64:67], v[52:55], v[192:199], v15
v_smfmac_f32_16x16x64_bf16 v[68:71], v[52:55], v[200:207], v15
v_smfmac_f32_16x16x64_bf16 v[72:75], v[52:55], v[208:215], v15
v_smfmac_f32_16x16x64_bf16 v[76:79], v[52:55], v[216:223], v15
v_smfmac_f32_16x16x64_bf16 v[80:83], v[48:51], v[160:167], v15
v_smfmac_f32_16x16x64_bf16 v[84:87], v[48:51], v[168:175], v15
v_smfmac_f32_16x16x64_bf16 v[88:91], v[48:51], v[176:183], v15
v_smfmac_f32_16x16x64_bf16 v[92:95], v[48:51], v[184:191], v15
v_smfmac_f32_16x16x64_bf16 v[80:83], v[52:55], v[224:231], v15
v_add_f32 v64, v64, v65
v_smfmac_f32_16x16x64_bf16 v[84:87], v[52:55], v[232:239], v15
v_add_f32 v68, v68, v69
v_add_f32 v72, v72, v73
v_smfmac_f32_16x16x64_bf16 v[88:91], v[52:55], v[240:247], v15
v_add_f32 v76, v76, v77
v_cvt_pk_bf16_f32 v20, v64, v68
v_smfmac_f32_16x16x64_bf16 v[92:95], v[52:55], v[248:255], v15
v_cvt_pk_bf16_f32 v21, v72, v76
v_add_f32 v80, v80, v81
s_mov_b64 exec, 0xffff
v_add_f32 v84, v84, v85
v_cvt_pk_bf16_f32 v22, v80, v84
s_nop 0
v_add_f32 v88, v88, v89
s_nop 0
v_add_f32 v92, v92, v93
v_cvt_pk_bf16_f32 v23, v88, v92
buffer_store_dwordx4 v[20:23], v13, s[36:39], s69 offen sc1
s_mov_b64 exec, -1
s_sub_u32 s67, s2, 16
s_cmp_lt_u32 s67, 128
s_cbranch_scc0 L_nogp
s_and_b32 s66, s2, 7
s_min_u32 s64, s66, 3
s_mul_i32 s71, s66, 5
s_add_u32 s64, s64, s71
s_cmp_lt_u32 s66, 3
s_cselect_b32 s66, 5, 4
v_and_b32 v8, 7, v0
v_min_u32 v8, s66, v8
v_add_u32 v8, s64, v8
s_and_b32 s64, s67, 0xf8
s_lshl_b32 s64, s64, 2
s_lshl_b32 s66, s34, 3
s_add_u32 s64, s64, s66
v_lshrrev_b32 v9, 3, v0
v_add_u32 v9, s64, v9
v_mul_u32_u24 v9, 2752, v9
v_lshl_add_u32 v8, v8, 6, v9
global_load_dword v10, v8, s[16:17]
global_load_dword v11, v8, s[18:19]
s_and_b32 s66, s2, 7
s_min_u32 s70, s66, 3
s_mul_i32 s71, s66, 5
s_add_u32 s70, s70, s71
s_cmp_lt_u32 s66, 3
s_cselect_b32 s66, 6, 5
s_lshl_b32 s66, s66, 8
s_sub_u32 s66, s66, 1
s_lshr_b32 s71, s67, 3
s_lshl_b32 s71, s71, 2
s_add_u32 s71, s71, s34
s_mul_i32 s71, s71, 24
v_min_u32 v12, 23, v0
v_add_u32 v12, s71, v12
v_min_u32 v12, s66, v12
s_lshl_b32 s70, s70, 15
v_lshl_add_u32 v12, v12, 7, s70
global_load_dword v13, v12, s[20:21]
s_endpgm
L_nogp:
L_tail_s:
s_cmp_eq_u32 s74, -1
s_cbranch_scc0 L_ffn
s_cmp_eq_u32 s3, 0
s_cbranch_scc0 L_fin
s_sub_u32 s70, s2, 144
s_cmp_lt_u32 s70, 64
s_cbranch_scc0 L_fin
s_lshl_b32 s64, s70, 2
s_lshr_b32 s67, s35, s64
s_and_b32 s71, s67, 7
s_andn2_b32 s66, s70, 7
s_add_u32 s66, s66, s71
s_lshl_b32 s66, s66, 12
s_add_u32 s66, s66, 1048576
buffer_load_dwordx4 v[16:19], v1, s[36:39], s66 offen offset:0 sc1
buffer_load_dwordx4 v[20:23], v1, s[36:39], s66 offen offset:1024 sc1
buffer_load_dwordx4 v[24:27], v1, s[36:39], s66 offen offset:2048 sc1
buffer_load_dwordx4 v[28:31], v1, s[36:39], s66 offen offset:3072 sc1
v_mov_b32 v32, -1
v_mov_b32 v33, -1
v_mov_b32 v34, -1
v_mov_b32 v35, -1
s_and_b32 s64, s71, 6
s_lshl_b32 s64, s64, 12
s_and_b32 s65, s71, 1
s_lshl_b32 s65, s65, 15
s_or_b32 s64, s64, s65
s_lshr_b32 s65, s70, 3
s_lshl_b32 s65, s65, 16
s_add_u32 s64, s64, s65
s_lshr_b32 s65, s70, 4
s_lshl_b32 s65, s65, 2
s_and_b32 s67, s70, 7
s_add_u32 s65, s65, s67
s_lshl_b32 s65, s65, 7
s_add_u32 s64, s64, s65
s_add_u32 s64, s64, 1376256
s_add_u32 s65, s64, 4096
buffer_store_dwordx4 v[32:35], v1, s[36:39], s64 offen offset:0 sc1
buffer_store_dwordx4 v[32:35], v1, s[36:39], s64 offen offset:1024 sc1
buffer_store_dwordx4 v[32:35], v1, s[36:39], s64 offen offset:2048 sc1
buffer_store_dwordx4 v[32:35], v1, s[36:39], s64 offen offset:3072 sc1
buffer_store_dwordx4 v[32:35], v1, s[36:39], s65 offen offset:0 sc1
s_mov_b64 exec, 0xffffff
buffer_store_dwordx4 v[32:35], v1, s[36:39], s65 offen offset:1024 sc1
s_mov_b64 exec, -1
v_lshlrev_b32 v2, 2, v0
ds_read_b32 v8, v2 offset:4096
ds_read_b32 v9, v2 offset:4352
ds_read_b32 v10, v2 offset:4608
s_mov_b32 s56, s26
s_mov_b32 s57, s27
s_mov_b32 s58, 0x2000
s_mov_b32 s59, 0x20000
v_and_b32 v5, 15, v0
v_and_b32 v6, 16, v0
v_lshl_add_u32 v5, v6, 1, v5
v_and_b32 v6, 32, v0
v_lshrrev_b32 v6, 1, v6
v_add_u32 v5, v5, v6
v_lshlrev_b32 v5, 1, v5
v_and_b32 v6, 0x7c, v5
s_lshl_b32 s73, s70, 7
v_and_b32 v11, 1, v0
v_lshlrev_b32 v3, 4, v11
v_mov_b32 v7, 0x3f80
v_lshlrev_b32 v7, v3, v7
v_and_b32 v2, 4, v0
v_cmp_eq_u32 vcc, 0, v2
v_bfe_u32 v2, v0, 1, 1
v_mul_u32_u24 v43, 0xaaaa, v2
v_add_u32 v43, 0x4444, v43
v_cndmask_b32 v44, 0, v7, vcc
v_sub_u32 v45, v7, v44
v_mov_b32 v46, v44
v_mov_b32 v47, v45
v_mov_b32 v48, 0
v_mov_b32 v49, 0
v_mov_b32 v50, 0
v_mov_b32 v51, 0
v_mov_b32 v52, 0
v_mov_b32 v53, 0
v_mov_b32 v54, 0
v_mov_b32 v55, 0
s_add_u32 s68, s73, 1310720
s_mov_b32 s76, 0xaaaaaaaa
s_mov_b32 s77, 0xaaaaaaaa
v_cmp_gt_u32 vcc, 24, v0
v_mov_b32 v41, 0x40000000
v_lshl_add_u32 v12, v11, 13, v6
v_cndmask_b32 v41, v41, v1, vcc
s_mov_b32 s75, 0
s_waitcnt vmcnt(0) lgkmcnt(0)
buffer_load_dwordx4 v[16:19], v1, s[36:39], s66 offen offset:0 sc1
buffer_load_dwordx4 v[20:23], v1, s[36:39], s66 offen offset:1024 sc1
buffer_load_dwordx4 v[24:27], v1, s[36:39], s66 offen offset:2048 sc1
buffer_load_dwordx4 v[28:31], v1, s[36:39], s66 offen offset:3072 sc1
s_sleep 1
buffer_load_dwordx4 v[16:19], v1, s[36:39], s66 offen offset:0 sc1
buffer_load_dwordx4 v[20:23], v1, s[36:39], s66 offen offset:1024 sc1
buffer_load_dwordx4 v[24:27], v1, s[36:39], s66 offen offset:2048 sc1
buffer_load_dwordx4 v[28:31], v1, s[36:39], s66 offen offset:3072 sc1
s_sleep 1
buffer_load_dwordx4 v[16:19], v1, s[36:39], s66 offen offset:0 sc1
buffer_load_dwordx4 v[20:23], v1, s[36:39], s66 offen offset:1024 sc1
buffer_load_dwordx4 v[24:27], v1, s[36:39], s66 offen offset:2048 sc1
buffer_load_dwordx4 v[28:31], v1, s[36:39], s66 offen offset:3072 sc1
s_sleep 1
L_rn_170:
v_smfmac_f32_16x16x64_bf16 v[48:51], v[44:47], v[16:23], v43
v_smfmac_f32_16x16x64_bf16 v[48:51], v[44:47], v[24:31], v43
buffer_load_dwordx4 v[16:19], v1, s[36:39], s66 offen offset:0 sc1
buffer_load_dwordx4 v[20:23], v1, s[36:39], s66 offen offset:1024 sc1
buffer_load_dwordx4 v[24:27], v1, s[36:39], s66 offen offset:2048 sc1
buffer_load_dwordx4 v[28:31], v1, s[36:39], s66 offen offset:3072 sc1
s_add_u32 s75, s75, 1
s_and_b32 s78, s75, 15
s_nop 1
v_add_f32_dpp v13, v48, v48 row_ror:8 row_mask:0x3 bank_mask:0x3
v_add_f32_dpp v13, v49, v49 row_ror:8 row_mask:0x3 bank_mask:0xc
v_add_f32_dpp v13, v50, v50 row_ror:8 row_mask:0xc bank_mask:0x3
v_add_f32_dpp v13, v51, v51 row_ror:8 row_mask:0xc bank_mask:0xc
v_cmp_u_f32 vcc, v13, v13
s_cbranch_vccz L_rz_171
v_mov_b32 v48, 0
v_mov_b32 v49, 0
v_mov_b32 v50, 0
v_mov_b32 v51, 0
s_waitcnt vmcnt(12)
s_cbranch_scc1 L_rn_170
v_max3_u32 v2, v16, v17, v18
v_max3_u32 v2, v2, v19, v20
v_max3_u32 v2, v2, v21, v22
v_max3_u32 v2, v2, v23, v24
v_max3_u32 v2, v2, v25, v26
v_max3_u32 v2, v2, v27, v28
v_max3_u32 v2, v2, v29, v30
v_max_u32 v2, v2, v31
v_cmp_eq_u32 vcc, -1, v2
s_cbranch_vccz L_rx_169
s_cmp_lt_u32 s75, 0x100000
s_cbranch_scc1 L_rn_170
L_rx_169:
v_smfmac_f32_16x16x64_bf16 v[48:51], v[44:47], v[16:23], v43
v_smfmac_f32_16x16x64_bf16 v[48:51], v[44:47], v[24:31], v43
s_nop 7
v_add_f32_dpp v13, v48, v48 row_ror:8 row_mask:0x3 bank_mask:0x3
v_add_f32_dpp v13, v49, v49 row_ror:8 row_mask:0x3 bank_mask:0xc
v_add_f32_dpp v13, v50, v50 row_ror:8 row_mask:0xc bank_mask:0x3
v_add_f32_dpp v13, v51, v51 row_ror:8 row_mask:0xc bank_mask:0xc
L_rz_171:
v_fmac_f32 v8, v13, v9
s_nop 1
v_mov_b32_dpp v14, v8 quad_perm:[1,1,3,3] row_mask:0xf bank_mask:0xf
v_mov_b32_dpp v13, v8 quad_perm:[0,0,2,2] row_mask:0xf bank_mask:0xf
v_cvt_pk_bf16_f32 v13, v13, v14
buffer_store_dword v13, v12, s[36:39], s68 offen sc1
v_cvt_pk_bf16_f32 v8, 0, v8
buffer_load_dwordx4 v[64:67], v1, s[36:39], s64 offen offset:0 sc1
buffer_load_dwordx4 v[68:71], v1, s[36:39], s64 offen offset:1024 sc1
buffer_load_dwordx4 v[72:75], v1, s[36:39], s64 offen offset:2048 sc1
buffer_load_dwordx4 v[76:79], v1, s[36:39], s64 offen offset:3072 sc1
buffer_load_dwordx4 v[80:83], v1, s[36:39], s65 offen offset:0 sc1
buffer_load_dwordx4 v[84:87], v41, s[36:39], s65 offen offset:1024 sc1
s_mov_b32 s75, 0
s_waitcnt vmcnt(0)
buffer_load_dwordx4 v[64:67], v1, s[36:39], s64 offen offset:0 sc1
buffer_load_dwordx4 v[68:71], v1, s[36:39], s64 offen offset:1024 sc1
buffer_load_dwordx4 v[72:75], v1, s[36:39], s64 offen offset:2048 sc1
buffer_load_dwordx4 v[76:79], v1, s[36:39], s64 offen offset:3072 sc1
buffer_load_dwordx4 v[80:83], v1, s[36:39], s65 offen offset:0 sc1
buffer_load_dwordx4 v[84:87], v41, s[36:39], s65 offen offset:1024 sc1
s_sleep 1
buffer_load_dwordx4 v[64:67], v1, s[36:39], s64 offen offset:0 sc1
buffer_load_dwordx4 v[68:71], v1, s[36:39], s64 offen offset:1024 sc1
buffer_load_dwordx4 v[72:75], v1, s[36:39], s64 offen offset:2048 sc1
buffer_load_dwordx4 v[76:79], v1, s[36:39], s64 offen offset:3072 sc1
buffer_load_dwordx4 v[80:83], v1, s[36:39], s65 offen offset:0 sc1
buffer_load_dwordx4 v[84:87], v41, s[36:39], s65 offen offset:1024 sc1
s_sleep 1
L_rn_174:
v_smfmac_f32_16x16x64_bf16 v[52:55], v[44:47], v[64:71], v43
v_smfmac_f32_16x16x64_bf16 v[52:55], v[44:47], v[72:79], v43
v_smfmac_f32_16x16x64_bf16 v[52:55], v[44:47], v[80:87], v43
buffer_load_dwordx4 v[64:67], v1, s[36:39], s64 offen offset:0 sc1
buffer_load_dwordx4 v[68:71], v1, s[36:39], s64 offen offset:1024 sc1
buffer_load_dwordx4 v[72:75], v1, s[36:39], s64 offen offset:2048 sc1
buffer_load_dwordx4 v[76:79], v1, s[36:39], s64 offen offset:3072 sc1
buffer_load_dwordx4 v[80:83], v1, s[36:39], s65 offen offset:0 sc1
buffer_load_dwordx4 v[84:87], v41, s[36:39], s65 offen offset:1024 sc1
s_add_u32 s75, s75, 1
s_and_b32 s78, s75, 15
v_add_f32_dpp v13, v52, v52 row_ror:8 row_mask:0x3 bank_mask:0x3
v_add_f32_dpp v13, v53, v53 row_ror:8 row_mask:0x3 bank_mask:0xc
v_add_f32_dpp v13, v54, v54 row_ror:8 row_mask:0xc bank_mask:0x3
v_add_f32_dpp v13, v55, v55 row_ror:8 row_mask:0xc bank_mask:0xc
v_cmp_u_f32 vcc, v13, v13
s_cbranch_vccz L_rz_175
v_mov_b32 v52, 0
v_mov_b32 v53, 0
v_mov_b32 v54, 0
v_mov_b32 v55, 0
s_waitcnt vmcnt(12)
s_cbranch_scc1 L_rn_174
v_max3_u32 v2, v64, v65, v66
v_max3_u32 v2, v2, v67, v68
v_max3_u32 v2, v2, v69, v70
v_max3_u32 v2, v2, v71, v72
v_max3_u32 v2, v2, v73, v74
v_max3_u32 v2, v2, v75, v76
v_max3_u32 v2, v2, v77, v78
v_max3_u32 v2, v2, v79, v80
v_max3_u32 v2, v2, v81, v82
v_max3_u32 v2, v2, v83, v84
v_max3_u32 v2, v2, v85, v86
v_max_u32 v2, v2, v87
v_cmp_eq_u32 vcc, -1, v2
s_cbranch_vccz L_rx_173
s_cmp_lt_u32 s75, 0x100000
s_cbranch_scc1 L_rn_174
L_rx_173:
v_smfmac_f32_16x16x64_bf16 v[52:55], v[44:47], v[64:71], v43
v_smfmac_f32_16x16x64_bf16 v[52:55], v[44:47], v[72:79], v43
v_smfmac_f32_16x16x64_bf16 v[52:55], v[44:47], v[80:87], v43
s_nop 7
v_add_f32_dpp v13, v52, v52 row_ror:8 row_mask:0x3 bank_mask:0x3
v_add_f32_dpp v13, v53, v53 row_ror:8 row_mask:0x3 bank_mask:0xc
v_add_f32_dpp v13, v54, v54 row_ror:8 row_mask:0xc bank_mask:0x3
v_add_f32_dpp v13, v55, v55 row_ror:8 row_mask:0xc bank_mask:0xc
L_rz_175:
v_fmac_f32 v8, v13, v10
s_nop 1
v_mov_b32_dpp v14, v8 quad_perm:[1,1,3,3] row_mask:0xf bank_mask:0xf
s_not_b64 exec, s[76:77]
v_cvt_pk_bf16_f32 v13, v8, v14
buffer_store_dword v13, v6, s[56:59], s73 offen sc1
s_mov_b64 exec, -1
s_cmp_lt_u32 s70, 8
s_cbranch_scc0 L_fin2
s_mov_b64 exec, 0xffff
buffer_store_dwordx4 v[44:47], v1, s[36:39], s62 offen sc1
s_mov_b64 exec, -1
L_fin2:
s_endpgm
L_ffn:
s_mul_i32 s67, s3, 12288
s_add_u32 s67, s67, 25600
v_lshlrev_b32 v7, 3, v0
buffer_load_dwordx4 v[8:11], v1, s[36:39], s67 offen offset:0 sc1
buffer_load_dwordx4 v[12:15], v1, s[36:39], s67 offen offset:1024 sc1
s_cmp_lt_u32 s3, 4
s_cbranch_scc1 L_post_176
s_mov_b32 s40, s16
s_mov_b32 s41, s17
s_mov_b32 s42, 0x158000
s_mov_b32 s43, 0x20000
s_mov_b32 s56, s18
s_mov_b32 s57, s19
s_mov_b32 s58, 0x158000
s_mov_b32 s59, 0x20000
v_lshrrev_b32 v16, 2, v0
v_mul_u32_u24 v16, 2752, v16
v_and_b32 v17, 3, v0
v_lshrrev_b32 v18, 5, v0
v_xor_b32 v17, v17, v18
v_xor_b32 v18, 2, v17
v_lshl_add_u32 v17, v17, 4, v16
v_lshl_add_u32 v18, v18, 4, v16
s_mul_i32 s64, s34, 352256
s_lshl_b32 s65, s74, 6
s_add_u32 s64, s64, s65
s_lshl_b32 s65, s34, 13
s_add_u32 m0, s65, 4096
s_add_u32 s66, s64, 0
buffer_load_dwordx4 v17, s[40:43], s66 offen  lds
s_add_u32 m0, s65, 36864
s_add_u32 s66, s64, 0
buffer_load_dwordx4 v18, s[56:59], s66 offen  lds
s_add_u32 m0, s65, 5120
s_add_u32 s66, s64, 44032
buffer_load_dwordx4 v17, s[40:43], s66 offen  lds
s_add_u32 m0, s65, 37888
s_add_u32 s66, s64, 44032
buffer_load_dwordx4 v18, s[56:59], s66 offen  lds
s_add_u32 m0, s65, 6144
s_add_u32 s66, s64, 88064
buffer_load_dwordx4 v17, s[40:43], s66 offen  lds
s_add_u32 m0, s65, 38912
s_add_u32 s66, s64, 88064
buffer_load_dwordx4 v18, s[56:59], s66 offen  lds
s_add_u32 m0, s65, 7168
s_add_u32 s66, s64, 132096
buffer_load_dwordx4 v17, s[40:43], s66 offen  lds
s_add_u32 m0, s65, 39936
s_add_u32 s66, s64, 132096
buffer_load_dwordx4 v18, s[56:59], s66 offen  lds
s_add_u32 m0, s65, 8192
s_add_u32 s66, s64, 176128
buffer_load_dwordx4 v17, s[40:43], s66 offen  lds
s_add_u32 m0, s65, 40960
s_add_u32 s66, s64, 176128
buffer_load_dwordx4 v18, s[56:59], s66 offen  lds
s_add_u32 m0, s65, 9216
s_add_u32 s66, s64, 220160
buffer_load_dwordx4 v17, s[40:43], s66 offen  lds
s_add_u32 m0, s65, 41984
s_add_u32 s66, s64, 220160
buffer_load_dwordx4 v18, s[56:59], s66 offen  lds
s_add_u32 m0, s65, 10240
s_add_u32 s66, s64, 264192
buffer_load_dwordx4 v17, s[40:43], s66 offen  lds
s_add_u32 m0, s65, 43008
s_add_u32 s66, s64, 264192
buffer_load_dwordx4 v18, s[56:59], s66 offen  lds
s_add_u32 m0, s65, 11264
s_add_u32 s66, s64, 308224
buffer_load_dwordx4 v17, s[40:43], s66 offen  lds
s_add_u32 m0, s65, 44032
s_add_u32 s66, s64, 308224
buffer_load_dwordx4 v18, s[56:59], s66 offen  lds
s_waitcnt vmcnt(16)
s_branch L_post_177
L_post_176:
s_waitcnt vmcnt(0)
L_post_177:
v_max3_u32 v16, v8, v9, v10
v_max3_u32 v16, v16, v11, v12
v_max3_u32 v16, v16, v13, v14
v_max_u32 v16, v16, v15
v_cmp_eq_u32 vcc, -1, v16
s_cbranch_vccz L_cb_178
s_mov_b32 s75, 0
L_poll_179:
buffer_load_dwordx4 v[8:11], v1, s[36:39], s67 offen offset:0 sc1
buffer_load_dwordx4 v[12:15], v1, s[36:39], s67 offen offset:1024 sc1
s_waitcnt vmcnt(0)
v_max3_u32 v16, v8, v9, v10
v_max3_u32 v16, v16, v11, v12
v_max3_u32 v16, v16, v13, v14
v_max_u32 v16, v16, v15
v_cmp_eq_u32 vcc, -1, v16
s_cbranch_vccz L_pollx_180
s_add_u32 s75, s75, 1
s_cmp_lt_u32 s75, 0x100000
s_cbranch_scc1 L_poll_179
L_pollx_180:
L_cb_178:
s_mov_b32 s68, 0xffff0000
v_lshlrev_b32 v24, 16, v8
v_and_b32 v25, s68, v8
v_lshlrev_b32 v32, 16, v12
v_and_b32 v33, s68, v12
v_lshlrev_b32 v26, 16, v9
v_and_b32 v27, s68, v9
v_lshlrev_b32 v34, 16, v13
v_and_b32 v35, s68, v13
v_lshlrev_b32 v28, 16, v10
v_and_b32 v29, s68, v10
v_lshlrev_b32 v36, 16, v14
v_and_b32 v37, s68, v14
v_lshlrev_b32 v30, 16, v11
v_and_b32 v31, s68, v11
v_lshlrev_b32 v38, 16, v15
v_and_b32 v39, s68, v15
v_add_f32 v32, 1.0, v32
v_add_f32 v33, 1.0, v33
v_add_f32 v34, 1.0, v34
v_add_f32 v35, 1.0, v35
v_add_f32 v36, 1.0, v36
v_add_f32 v37, 1.0, v37
v_add_f32 v38, 1.0, v38
v_add_f32 v39, 1.0, v39
v_lshrrev_b32 v2, 3, v0
v_bfe_u32 v3, v0, 1, 3
v_and_b32 v4, 3, v3
s_lshl_b32 s64, s3, 1
v_xor_b32 v3, s64, v3
v_lshlrev_b32 v5, 10, v2
v_lshl_add_u32 v5, v4, 8, v5
v_lshl_add_u32 v5, v3, 4, v5
v_and_b32 v4, 1, v0
v_lshl_add_u32 v5, v4, 3, v5
v_add_u32 v5, 69632, v5
v_xor_b32 v6, 16, v5
v_mul_u32_u24 v16, 0xaaaa, v4
v_add_u32 v16, 0x4444, v16
v_lshrrev_b32 v2, 4, v0
v_bfe_u32 v3, v0, 3, 1
v_xor_b32 v7, v2, v0
v_lshlrev_b32 v7, 4, v7
v_add_u32 v7, 69632, v7
v_xor_b32 v8, 64, v7
v_and_b32 v4, 7, v0
v_and_b32 v9, 0x38, v0
v_lshlrev_b32 v9, 3, v9
v_lshl_add_u32 v9, v4, 1, v9
s_lshl_b32 s64, s34, 4
v_add_u32 v9, s64, v9
v_and_b32 v10, 12, v0
v_lshlrev_b32 v10, 5, v10
v_and_b32 v4, 1, v0
v_lshl_add_u32 v10, v4, 6, v10
v_lshl_add_u32 v10, v2, 4, v10
v_mov_b32 v17, 0xbfb8aa3b
v_mov_b32 v64, 0
v_mov_b32 v65, 0
v_mov_b32 v66, 0
v_mov_b32 v67, 0
s_lshl_b32 s64, s34, 3
s_lshr_b32 s64, s35, s64
v_lshlrev_b32 v3, 2, v3
v_bfe_u32 v3, s64, v3, 3
v_and_b32 v11, 6, v3
v_lshlrev_b32 v11, 12, v11
v_and_b32 v3, 1, v3
v_lshl_add_u32 v11, v3, 15, v11
v_lshl_add_u32 v11, v2, 17, v11
v_and_b32 v4, 240, v1
v_add_u32 v11, v11, v4
v_lshl_add_u32 v11, v2, 9, v11
s_lshl_b32 s64, s34, 8
v_add_u32 v11, s64, v11
s_lshl_b32 s69, s74, 7
s_add_u32 s69, s69, 1376256
s_add_u32 s72, s69, 65536
s_lshl_b32 s64, s3, 10
s_lshl_b32 s65, s2, 2
s_lshr_b32 s65, s35, s65
s_and_b32 s65, s65, 2
s_lshl_b32 s65, s65, 12
s_add_u32 s64, s64, s65
s_add_u32 s64, s64, 1310720
v_mov_b32 v14, 0xbb000000
v_mov_b32 v15, 0x3b000000
v_lshrrev_b32 v18, 4, v0
v_bfe_u32 v19, v0, 2, 2
v_bfe_u32 v20, v0, 1, 1
v_and_b32 v22, 1, v18
v_lshl_add_u32 v22, v20, 1, v22
v_xor_b32 v22, s34, v22
v_lshlrev_b32 v22, 4, v22
v_lshl_add_u32 v22, v20, 15, v22
v_lshl_add_u32 v22, v18, 9, v22
v_lshl_add_u32 v22, v19, 6, v22
v_and_b32 v20, 1, v0
v_lshl_add_u32 v22, v20, 3, v22
v_add_u32 v22, 4096, v22
s_lshr_b32 s73, s3, 2
s_waitcnt vmcnt(0)
s_barrier
buffer_load_dwordx4 v[56:59], v1, s[36:39], s64 offen sc1
s_cmp_eq_u32 s73, 0
s_cbranch_scc1 L_gu_182
ds_read_b64_tr_b16 v[128:129], v22 offset:0
ds_read_b64_tr_b16 v[130:131], v22 offset:256
ds_read_b64_tr_b16 v[132:133], v22 offset:2048
ds_read_b64_tr_b16 v[134:135], v22 offset:2304
ds_read_b64_tr_b16 v[136:137], v22 offset:4096
ds_read_b64_tr_b16 v[138:139], v22 offset:4352
ds_read_b64_tr_b16 v[140:141], v22 offset:6144
ds_read_b64_tr_b16 v[142:143], v22 offset:6400
ds_read_b64_tr_b16 v[144:145], v22 offset:8192
ds_read_b64_tr_b16 v[146:147], v22 offset:8448
ds_read_b64_tr_b16 v[148:149], v22 offset:10240
s_waitcnt lgkmcnt(4)
ds_read_b64_tr_b16 v[150:151], v22 offset:10496
ds_read_b64_tr_b16 v[152:153], v22 offset:12288
ds_read_b64_tr_b16 v[154:155], v22 offset:12544
ds_read_b64_tr_b16 v[156:157], v22 offset:14336
ds_read_b64_tr_b16 v[158:159], v22 offset:14592
ds_read_b64_tr_b16 v[160:161], v22 offset:16384
ds_read_b64_tr_b16 v[162:163], v22 offset:16640
ds_read_b64_tr_b16 v[164:165], v22 offset:18432
ds_read_b64_tr_b16 v[166:167], v22 offset:18688
ds_read_b64_tr_b16 v[168:169], v22 offset:20480
ds_read_b64_tr_b16 v[170:171], v22 offset:20736
s_waitcnt lgkmcnt(4)
ds_read_b64_tr_b16 v[172:173], v22 offset:22528
ds_read_b64_tr_b16 v[174:175], v22 offset:22784
ds_read_b64_tr_b16 v[176:177], v22 offset:24576
ds_read_b64_tr_b16 v[178:179], v22 offset:24832
ds_read_b64_tr_b16 v[180:181], v22 offset:26624
ds_read_b64_tr_b16 v[182:183], v22 offset:26880
ds_read_b64_tr_b16 v[184:185], v22 offset:28672
ds_read_b64_tr_b16 v[186:187], v22 offset:28928
ds_read_b64_tr_b16 v[188:189], v22 offset:30720
ds_read_b64_tr_b16 v[190:191], v22 offset:30976
L_gu_182:
s_cmp_lt_u32 s3, 4
s_cbranch_scc0 L_dma_183
s_mov_b32 s48, s20
s_mov_b32 s49, s21
s_mov_b32 s50, 0x158000
s_mov_b32 s51, 0x20000
v_lshrrev_b32 v18, 4, v0
v_and_b32 v16, 15, v0
v_xor_b32 v16, v16, v18
v_xor_b32 v17, 4, v16
v_lshlrev_b32 v19, 10, v18
v_lshl_add_u32 v22, v16, 4, v19
v_lshl_add_u32 v23, v17, 4, v19
s_lshl_b32 s76, s74, 15
s_lshl_b32 s66, s34, 8
s_add_u32 s76, s76, s66
s_lshl_b32 s77, s34, 13
s_add_u32 s77, s77, 77824
v_bfe_u32 v19, v0, 2, 2
v_and_b32 v16, 2, v0
v_lshlrev_b32 v16, 2, v16
v_xor_b32 v16, v16, v19
v_and_b32 v17, 1, v18
v_lshlrev_b32 v17, 2, v17
v_xor_b32 v16, v16, v17
v_lshlrev_b32 v16, 4, v16
v_lshl_add_u32 v16, v18, 10, v16
v_lshl_add_u32 v16, v19, 8, v16
v_and_b32 v17, 1, v0
v_lshl_add_u32 v16, v17, 3, v16
v_add_u32 v68, s77, v16
v_xor_b32 v69, 16, v68
v_xor_b32 v70, 32, v68
v_xor_b32 v71, 48, v68
v_xor_b32 v72, 64, v68
v_xor_b32 v73, 80, v68
v_xor_b32 v74, 96, v68
v_xor_b32 v75, 112, v68
s_add_u32 m0, s77, 0
s_xor_b32 s66, s76, 0
buffer_load_dwordx4 v22, s[48:51], s66 offen  lds
s_add_u32 m0, s77, 1024
s_xor_b32 s66, s76, 8192
buffer_load_dwordx4 v23, s[48:51], s66 offen  lds
s_add_u32 m0, s77, 2048
s_xor_b32 s66, s76, 16384
buffer_load_dwordx4 v22, s[48:51], s66 offen  lds
s_add_u32 m0, s77, 3072
s_xor_b32 s66, s76, 24576
buffer_load_dwordx4 v23, s[48:51], s66 offen  lds
s_add_u32 m0, s77, 4096
s_xor_b32 s66, s76, 4096
buffer_load_dwordx4 v22, s[48:51], s66 offen  lds
s_add_u32 m0, s77, 5120
s_xor_b32 s66, s76, 12288
buffer_load_dwordx4 v23, s[48:51], s66 offen  lds
s_add_u32 m0, s77, 6144
s_xor_b32 s66, s76, 20480
buffer_load_dwordx4 v22, s[48:51], s66 offen  lds
s_waitcnt vmcnt(7)
s_branch L_dma_184
L_dma_183:
s_waitcnt vmcnt(0)
L_dma_184:
s_mov_b32 s73, 0x3f803f80
v_mov_b32 v20, 0
v_mov_b32 v21, 0
v_max3_u32 v12, v56, v57, v58
v_max_u32 v12, v12, v59
v_cmp_eq_u32 vcc, -1, v12
s_cbranch_vccz L_x_181
buffer_load_dwordx4 v[56:59], v1, s[36:39], s64 offen sc1
s_sleep 1
s_mov_b32 s75, 0
L_poll_185:
buffer_load_dwordx4 v[56:59], v1, s[36:39], s64 offen sc1
s_waitcnt vmcnt(1)
v_max3_u32 v12, v56, v57, v58
v_max_u32 v12, v12, v59
v_cmp_eq_u32 vcc, -1, v12
s_cbranch_vccz L_pollx_186
s_add_u32 s75, s75, 1
s_cmp_lt_u32 s75, 0x100000
s_cbranch_scc1 L_poll_185
L_pollx_186:
L_x_181:
v_dot2c_f32_bf16 v20, s73, v56
v_dot2c_f32_bf16 v21, v56, v56
v_dot2c_f32_bf16 v20, s73, v57
v_dot2c_f32_bf16 v21, v57, v57
v_dot2c_f32_bf16 v20, s73, v58
v_dot2c_f32_bf16 v21, v58, v58
v_dot2c_f32_bf16 v20, s73, v59
v_dot2c_f32_bf16 v21, v59, v59
v_lshlrev_b32 v40, 16, v56
v_and_b32 v41, s68, v56
v_lshlrev_b32 v42, 16, v57
v_permlane32_swap_b32 v20, v21
v_add_f32 v12, v20, v21
v_and_b32 v43, s68, v57
v_lshlrev_b32 v44, 16, v58
v_add_f32_dpp v12, v12, v12 quad_perm:[1,0,3,2] row_mask:0xf bank_mask:0xf
v_and_b32 v45, s68, v58
v_lshlrev_b32 v46, 16, v59
v_add_f32_dpp v12, v12, v12 quad_perm:[2,3,0,1] row_mask:0xf bank_mask:0xf
v_and_b32 v47, s68, v59
v_pk_mul_f32 v[48:49], v[40:41], v[32:33]
v_add_f32_dpp v12, v12, v12 row_ror:4 row_mask:0xf bank_mask:0xf
v_pk_mul_f32 v[50:51], v[42:43], v[34:35]
v_pk_mul_f32 v[52:53], v[44:45], v[36:37]
v_add_f32_dpp v12, v12, v12 row_ror:8 row_mask:0xf bank_mask:0xf
v_pk_mul_f32 v[54:55], v[46:47], v[38:39]
s_nop 0
v_add_f32_dpp v12, v12, v12 row_bcast:15 row_mask:0xa bank_mask:0xf
s_nop 0
v_readlane_b32 s70, v12, 16
v_readlane_b32 s71, v12, 48
s_nop 0
v_mul_f32 v12, s70, v14
v_mul_f32 v13, s71, v15
v_fma_f32 v13, -v12, v12, v13
v_max_f32 v13, 0, v13
v_add_f32 v13, 0x3727c5ac, v13
v_rsq_f32 v2, v13
v_pk_fma_f32 v[48:49], v[12:13], v[32:33], v[48:49] op_sel_hi:[0,1,1]
v_pk_fma_f32 v[50:51], v[12:13], v[34:35], v[50:51] op_sel_hi:[0,1,1]
v_pk_fma_f32 v[52:53], v[12:13], v[36:37], v[52:53] op_sel_hi:[0,1,1]
v_pk_fma_f32 v[54:55], v[12:13], v[38:39], v[54:55] op_sel_hi:[0,1,1]
v_pk_fma_f32 v[24:25], v[2:3], v[48:49], v[24:25] op_sel_hi:[0,1,1]
v_pk_fma_f32 v[28:29], v[2:3], v[52:53], v[28:29] op_sel_hi:[0,1,1]
v_pk_fma_f32 v[26:27], v[2:3], v[50:51], v[26:27] op_sel_hi:[0,1,1]
v_pk_fma_f32 v[30:31], v[2:3], v[54:55], v[30:31] op_sel_hi:[0,1,1]
v_cvt_pk_bf16_f32 v40, v24, v25
v_cvt_pk_bf16_f32 v41, v28, v29
ds_write_b64 v5, v[40:41]
v_cvt_pk_bf16_f32 v42, v26, v27
v_cvt_pk_bf16_f32 v43, v30, v31
ds_write_b64 v6, v[42:43]
s_cmp_lt_u32 s3, 4
s_cbranch_scc0 L_dma_187
s_mov_b32 s48, s20
s_mov_b32 s49, s21
s_mov_b32 s50, 0x158000
s_mov_b32 s51, 0x20000
s_add_u32 m0, s77, 7168
s_xor_b32 s66, s76, 28672
buffer_load_dwordx4 v23, s[48:51], s66 offen  lds
L_dma_187:
s_cmp_lt_u32 s3, 4
s_waitcnt lgkmcnt(0)
s_barrier
s_cbranch_scc1 L_bar_fin
ds_read_b128 v[192:195], v7 offset:0
ds_read_b128 v[196:199], v8 offset:1024
ds_read_b128 v[200:203], v7 offset:2048
ds_read_b128 v[204:207], v8 offset:3072
ds_read_b128 v[208:211], v7 offset:4096
ds_read_b128 v[212:215], v8 offset:5120
ds_read_b128 v[216:219], v7 offset:6144
ds_read_b128 v[220:223], v8 offset:7168
s_waitcnt lgkmcnt(7)
v_smfmac_f32_16x16x64_bf16 v[64:67], v[192:195], v[128:135], v16
s_waitcnt lgkmcnt(6)
v_smfmac_f32_16x16x64_bf16 v[64:67], v[196:199], v[136:143], v16
s_waitcnt lgkmcnt(5)
v_smfmac_f32_16x16x64_bf16 v[64:67], v[200:203], v[144:151], v16
s_waitcnt lgkmcnt(4)
v_smfmac_f32_16x16x64_bf16 v[64:67], v[204:207], v[152:159], v16
s_waitcnt lgkmcnt(3)
v_smfmac_f32_16x16x64_bf16 v[64:67], v[208:211], v[160:167], v16
s_waitcnt lgkmcnt(2)
v_smfmac_f32_16x16x64_bf16 v[64:67], v[212:215], v[168:175], v16
s_waitcnt lgkmcnt(1)
v_smfmac_f32_16x16x64_bf16 v[64:67], v[216:219], v[176:183], v16
s_waitcnt lgkmcnt(0)
v_smfmac_f32_16x16x64_bf16 v[64:67], v[220:223], v[184:191], v16
s_nop 7
v_add_f32 v66, v66, v67
v_add_f32 v64, v64, v65
v_mul_f32 v18, v64, v17
v_mul_f32_dpp v18, v66, v17 row_ror:8 row_mask:0xf bank_mask:0xc
v_exp_f32 v18, v18
v_mov_b32_dpp v66, v64 row_ror:8 row_mask:0xf bank_mask:0x3
v_add_f32 v18, 1.0, v18
v_rcp_f32 v18, v18
s_nop 0
v_mul_f32 v18, v18, v66
v_cvt_pk_bf16_f32 v18, v18, v18
ds_write_b16 v9, v18 offset:3584
s_waitcnt lgkmcnt(0)
s_barrier
s_endpgm
L_bar_fin:
s_waitcnt vmcnt(0)
ds_read_b64_tr_b16 v[96:97], v68 offset:0
ds_read_b64_tr_b16 v[98:99], v68 offset:4096
ds_read_b64_tr_b16 v[100:101], v69 offset:0
ds_read_b64_tr_b16 v[102:103], v69 offset:4096
ds_read_b64_tr_b16 v[104:105], v70 offset:0
ds_read_b64_tr_b16 v[106:107], v70 offset:4096
ds_read_b64_tr_b16 v[108:109], v71 offset:0
ds_read_b64_tr_b16 v[110:111], v71 offset:4096
ds_read_b64_tr_b16 v[112:113], v72 offset:0
ds_read_b64_tr_b16 v[114:115], v72 offset:4096
ds_read_b64_tr_b16 v[116:117], v73 offset:0
s_waitcnt lgkmcnt(4)
ds_read_b64_tr_b16 v[118:119], v73 offset:4096
ds_read_b64_tr_b16 v[120:121], v74 offset:0
ds_read_b64_tr_b16 v[122:123], v74 offset:4096
ds_read_b64_tr_b16 v[124:125], v75 offset:0
ds_read_b64_tr_b16 v[126:127], v75 offset:4096
s_waitcnt lgkmcnt(0)
s_barrier
ds_read_b128 v[48:51], v10 offset:3584
s_waitcnt lgkmcnt(0)
v_mfma_f32_16x16x32_bf16 v[192:195], v[48:51], v[96:99], 0
v_mfma_f32_16x16x32_bf16 v[196:199], v[48:51], v[100:103], 0
v_mfma_f32_16x16x32_bf16 v[200:203], v[48:51], v[104:107], 0
s_nop 1
v_mfma_f32_16x16x32_bf16 v[204:207], v[48:51], v[108:111], 0
s_nop 1
v_mfma_f32_16x16x32_bf16 v[208:211], v[48:51], v[112:115], 0
s_nop 0
v_cvt_pk_bf16_f32 v16, v192, v196
v_mfma_f32_16x16x32_bf16 v[212:215], v[48:51], v[116:119], 0
v_cvt_pk_bf16_f32 v20, v193, v197
v_mfma_f32_16x16x32_bf16 v[216:219], v[48:51], v[120:123], 0
v_cvt_pk_bf16_f32 v17, v200, v204
v_cvt_pk_bf16_f32 v21, v201, v205
v_mfma_f32_16x16x32_bf16 v[220:223], v[48:51], v[124:127], 0
s_nop 2
v_cvt_pk_bf16_f32 v18, v208, v212
v_cvt_pk_bf16_f32 v22, v209, v213
s_nop 2
v_cvt_pk_bf16_f32 v19, v216, v220
buffer_store_dwordx4 v[16:19], v11, s[36:39], s69 offen sc1
v_cvt_pk_bf16_f32 v23, v217, v221
buffer_store_dwordx4 v[20:23], v11, s[36:39], s72 offen sc1
s_endpgm
s_endpgm
L_srest:
s_lshr_b32 s32, s2, 5
s_and_b32 s33, s2, 31
s_and_b32 s67, s2, 7
s_lshr_b32 s68, s2, 3
s_sub_u32 s68, s68, 26
s_min_u32 s74, s67, 3
s_mul_i32 s66, s67, 5
s_add_u32 s74, s74, s66
s_add_u32 s74, s74, s68
s_cmp_lt_u32 s67, 3
s_cselect_b32 s66, 6, 5
s_cmp_lt_u32 s68, s66
s_cselect_b32 s74, s74, -1
s_cmp_lt_u32 s2, 48
s_cselect_b32 s66, 2, 3
s_cselect_b32 s72, 14+26, 42+26
s_cmp_lt_u32 s2, 16
s_cselect_b32 s66, 1, s66
s_cselect_b32 s72, 26, s72
s_lshl_b32 s66, s67, s66
s_add_u32 s72, s72, s66
s_add_u32 s72, s72, s68
s_mov_b32 s36, s30
s_mov_b32 s37, s31
s_mov_b32 s38, 0x1d0000
s_mov_b32 s39, 0x20000
s_mov_b32 s52, s28
s_mov_b32 s53, s29
s_mov_b32 s54, 0x100
s_mov_b32 s55, 0x20000
s_mov_b32 s46, 0x40000
s_mov_b32 s47, 0x20000
s_cmp_eq_u32 s74, -1
s_mov_b32 s69, 30
s_cselect_b32 s69, 20, s69
s_cmp_lt_u32 s2, 144
s_cselect_b32 s69, 0, s69
s_cmp_lt_u32 s2, 112
s_cselect_b32 s69, 50, s69
s_cmp_lt_u32 s2, 48
s_cselect_b32 s69, 30, s69
s_cmp_lt_u32 s2, 16
s_cselect_b32 s69, 40, s69
s_and_b32 s66, s72, 7
s_cmp_eq_u32 s66, 3
s_cselect_b32 s66, 40, 0
s_cmp_lt_u32 s2, 112
s_cselect_b32 s66, s66, 0
s_add_u32 s69, s69, s66
s_xor_b32 s64, s65, 1024
s_cmpk_gt_u32 s69, 4
s_cbranch_scc1 L_d_1
s_waitcnt vmcnt(3)
L_d_1:
buffer_load_dwordx4 v[24:27], v1, s[40:43], s64 offen nt
s_xor_b32 s64, s65, 33792
s_cmpk_gt_u32 s69, 5
s_cbranch_scc1 L_d_2
s_waitcnt vmcnt(3)
L_d_2:
buffer_load_dwordx4 v[28:31], v1, s[40:43], s64 offen nt
s_xor_b32 s64, s65, 9216
s_cmpk_gt_u32 s69, 6
s_cbranch_scc1 L_d_3
s_waitcnt vmcnt(3)
L_d_3:
buffer_load_dwordx4 v[32:35], v1, s[40:43], s64 offen nt
s_xor_b32 s64, s65, 41984
s_cmpk_gt_u32 s69, 7
s_waitcnt vmcnt(6)
s_cbranch_scc1 L_d_4
s_waitcnt vmcnt(3)
L_d_4:
buffer_load_dwordx4 v[36:39], v1, s[40:43], s64 offen nt
s_xor_b32 s64, s65, 65536
s_cmpk_gt_u32 s69, 8
s_waitcnt vmcnt(6)
s_cbranch_scc1 L_d_5
s_waitcnt vmcnt(3)
L_d_5:
buffer_load_dwordx4 v[40:43], v1, s[40:43], s64 offen nt
s_xor_b32 s64, s65, 98304
s_cmpk_gt_u32 s69, 9
s_waitcnt vmcnt(6)
s_cbranch_scc1 L_d_6
s_waitcnt vmcnt(3)
L_d_6:
buffer_load_dwordx4 v[44:47], v1, s[40:43], s64 offen nt
s_xor_b32 s64, s65, 73728
s_cmpk_gt_u32 s69, 10
s_waitcnt vmcnt(6)
s_cbranch_scc1 L_d_7
s_waitcnt vmcnt(3)
L_d_7:
buffer_load_dwordx4 v[48:51], v1, s[40:43], s64 offen nt
s_xor_b32 s64, s65, 106496
s_cmpk_gt_u32 s69, 11
s_waitcnt vmcnt(6)
s_cbranch_scc1 L_d_8
s_waitcnt vmcnt(3)
L_d_8:
buffer_load_dwordx4 v[52:55], v1, s[40:43], s64 offen nt
s_xor_b32 s64, s65, 66560
s_cmpk_gt_u32 s69, 12
s_waitcnt vmcnt(6)
s_cbranch_scc1 L_d_9
s_waitcnt vmcnt(3)
L_d_9:
buffer_load_dwordx4 v[56:59], v1, s[40:43], s64 offen nt
s_xor_b32 s64, s65, 99328
s_cmpk_gt_u32 s69, 13
s_waitcnt vmcnt(6)
s_cbranch_scc1 L_d_10
s_waitcnt vmcnt(3)
L_d_10:
buffer_load_dwordx4 v[60:63], v1, s[40:43], s64 offen nt
s_xor_b32 s64, s65, 74752
s_cmpk_gt_u32 s69, 14
s_waitcnt vmcnt(6)
s_cbranch_scc1 L_d_11
s_waitcnt vmcnt(3)
L_d_11:
buffer_load_dwordx4 v[64:67], v1, s[40:43], s64 offen nt
s_xor_b32 s64, s65, 107520
s_cmpk_gt_u32 s69, 15
s_waitcnt vmcnt(6)
s_cbranch_scc1 L_d_12
s_waitcnt vmcnt(3)
L_d_12:
buffer_load_dwordx4 v[68:71], v1, s[40:43], s64 offen nt
s_xor_b32 s64, s65, 131072
s_cmpk_gt_u32 s69, 16
s_waitcnt vmcnt(6)
s_cbranch_scc1 L_d_13
s_waitcnt vmcnt(3)
L_d_13:
buffer_load_dwordx4 v[72:75], v1, s[40:43], s64 offen nt
s_xor_b32 s64, s65, 163840
s_cmpk_gt_u32 s69, 17
s_waitcnt vmcnt(6)
s_cbranch_scc1 L_d_14
s_waitcnt vmcnt(3)
L_d_14:
buffer_load_dwordx4 v[76:79], v1, s[40:43], s64 offen nt
s_xor_b32 s64, s65, 139264
s_cmpk_gt_u32 s69, 18
s_waitcnt vmcnt(6)
s_cbranch_scc1 L_d_15
s_waitcnt vmcnt(3)
L_d_15:
buffer_load_dwordx4 v[80:83], v1, s[40:43], s64 offen nt
s_xor_b32 s64, s65, 172032
s_cmpk_gt_u32 s69, 19
s_waitcnt vmcnt(6)
s_cbranch_scc1 L_d_16
s_waitcnt vmcnt(3)
L_d_16:
buffer_load_dwordx4 v[84:87], v1, s[40:43], s64 offen nt
s_xor_b32 s64, s65, 132096
s_cmpk_gt_u32 s69, 20
s_waitcnt vmcnt(6)
s_cbranch_scc1 L_d_17
s_waitcnt vmcnt(3)
L_d_17:
buffer_load_dwordx4 v[88:91], v1, s[40:43], s64 offen nt
s_xor_b32 s64, s65, 164864
s_cmpk_gt_u32 s69, 21
s_waitcnt vmcnt(6)
s_cbranch_scc1 L_d_18
s_waitcnt vmcnt(3)
L_d_18:
buffer_load_dwordx4 v[92:95], v1, s[40:43], s64 offen nt
s_xor_b32 s64, s65, 140288
s_cmpk_gt_u32 s69, 22
s_waitcnt vmcnt(6)
s_cbranch_scc1 L_d_19
s_waitcnt vmcnt(3)
L_d_19:
buffer_load_dwordx4 v[96:99], v1, s[40:43], s64 offen nt
s_xor_b32 s64, s65, 173056
s_cmpk_gt_u32 s69, 23
s_waitcnt vmcnt(6)
s_cbranch_scc1 L_d_20
s_waitcnt vmcnt(3)
L_d_20:
buffer_load_dwordx4 v[100:103], v1, s[40:43], s64 offen nt
s_xor_b32 s64, s65, 196608
s_cmpk_gt_u32 s69, 24
s_waitcnt vmcnt(6)
s_cbranch_scc1 L_d_21
s_waitcnt vmcnt(3)
L_d_21:
buffer_load_dwordx4 v[104:107], v1, s[40:43], s64 offen nt
s_xor_b32 s64, s65, 229376
s_cmpk_gt_u32 s69, 25
s_waitcnt vmcnt(6)
s_cbranch_scc1 L_d_22
s_waitcnt vmcnt(3)
L_d_22:
buffer_load_dwordx4 v[108:111], v1, s[40:43], s64 offen nt
s_xor_b32 s64, s65, 204800
s_cmpk_gt_u32 s69, 26
s_waitcnt vmcnt(6)
s_cbranch_scc1 L_d_23
s_waitcnt vmcnt(3)
L_d_23:
buffer_load_dwordx4 v[112:115], v1, s[40:43], s64 offen nt
s_xor_b32 s64, s65, 237568
s_cmpk_gt_u32 s69, 27
s_waitcnt vmcnt(6)
s_cbranch_scc1 L_d_24
s_waitcnt vmcnt(3)
L_d_24:
buffer_load_dwordx4 v[116:119], v1, s[40:43], s64 offen nt
s_xor_b32 s64, s65, 197632
s_cmpk_gt_u32 s69, 28
s_waitcnt vmcnt(6)
s_cbranch_scc1 L_d_25
s_waitcnt vmcnt(3)
L_d_25:
buffer_load_dwordx4 v[120:123], v1, s[40:43], s64 offen nt
s_xor_b32 s64, s65, 230400
s_cmpk_gt_u32 s69, 29
s_waitcnt vmcnt(6)
s_cbranch_scc1 L_d_26
s_waitcnt vmcnt(3)
L_d_26:
buffer_load_dwordx4 v[124:127], v1, s[40:43], s64 offen nt
s_xor_b32 s64, s65, 205824
s_cmpk_gt_u32 s69, 30
s_waitcnt vmcnt(6)
s_cbranch_scc1 L_d_27
s_waitcnt vmcnt(3)
L_d_27:
buffer_load_dwordx4 v[128:131], v1, s[40:43], s64 offen nt
s_xor_b32 s64, s65, 238592
s_cmpk_gt_u32 s69, 31
s_waitcnt vmcnt(6)
s_cbranch_scc1 L_d_28
s_waitcnt vmcnt(3)
L_d_28:
buffer_load_dwordx4 v[132:135], v1, s[40:43], s64 offen nt
s_xor_b32 s64, s65, 4096
s_cmpk_gt_u32 s69, 32
s_waitcnt vmcnt(6)
s_cbranch_scc1 L_d_29
s_waitcnt vmcnt(4)
L_d_29:
buffer_load_dwordx4 v[136:139], v1, s[40:43], s64 offen nt
s_xor_b32 s64, s65, 36864
s_cmpk_gt_u32 s69, 33
s_waitcnt vmcnt(6)
s_cbranch_scc1 L_d_30
s_waitcnt vmcnt(4)
L_d_30:
buffer_load_dwordx4 v[140:143], v1, s[40:43], s64 offen nt
s_xor_b32 s64, s65, 12288
s_cmpk_gt_u32 s69, 34
s_waitcnt vmcnt(6)
s_cbranch_scc1 L_d_31
s_waitcnt vmcnt(4)
L_d_31:
buffer_load_dwordx4 v[144:147], v1, s[40:43], s64 offen nt
s_xor_b32 s64, s65, 45056
s_cmpk_gt_u32 s69, 35
s_waitcnt vmcnt(6)
s_cbranch_scc1 L_d_32
s_waitcnt vmcnt(4)
L_d_32:
buffer_load_dwordx4 v[148:151], v1, s[40:43], s64 offen nt
s_xor_b32 s64, s65, 5120
s_cmpk_gt_u32 s69, 36
s_waitcnt vmcnt(6)
s_cbranch_scc1 L_d_33
s_waitcnt vmcnt(4)
L_d_33:
buffer_load_dwordx4 v[152:155], v1, s[40:43], s64 offen nt
s_xor_b32 s64, s65, 37888
s_cmpk_gt_u32 s69, 37
s_waitcnt vmcnt(6)
s_cbranch_scc1 L_d_34
s_waitcnt vmcnt(4)
L_d_34:
buffer_load_dwordx4 v[156:159], v1, s[40:43], s64 offen nt
s_xor_b32 s64, s65, 13312
s_cmpk_gt_u32 s69, 38
s_waitcnt vmcnt(6)
s_cbranch_scc1 L_d_35
s_waitcnt vmcnt(4)
L_d_35:
buffer_load_dwordx4 v[160:163], v1, s[40:43], s64 offen nt
s_xor_b32 s64, s65, 46080
s_cmpk_gt_u32 s69, 39
s_waitcnt vmcnt(6)
s_cbranch_scc1 L_d_36
s_waitcnt vmcnt(4)
L_d_36:
buffer_load_dwordx4 v[164:167], v1, s[40:43], s64 offen nt
s_xor_b32 s64, s65, 69632
s_cmpk_gt_u32 s69, 40
s_waitcnt vmcnt(6)
s_cbranch_scc1 L_d_37
s_waitcnt vmcnt(4)
L_d_37:
buffer_load_dwordx4 v[168:171], v1, s[40:43], s64 offen nt
s_xor_b32 s64, s65, 102400
s_cmpk_gt_u32 s69, 41
s_waitcnt vmcnt(6)
s_cbranch_scc1 L_d_38
s_waitcnt vmcnt(4)
L_d_38:
buffer_load_dwordx4 v[172:175], v1, s[40:43], s64 offen nt
s_xor_b32 s64, s65, 77824
s_cmpk_gt_u32 s69, 42
s_waitcnt vmcnt(6)
s_cbranch_scc1 L_d_39
s_waitcnt vmcnt(4)
L_d_39:
buffer_load_dwordx4 v[176:179], v1, s[40:43], s64 offen nt
s_xor_b32 s64, s65, 110592
s_cmpk_gt_u32 s69, 43
s_waitcnt vmcnt(6)
s_cbranch_scc1 L_d_40
s_waitcnt vmcnt(4)
L_d_40:
buffer_load_dwordx4 v[180:183], v1, s[40:43], s64 offen nt
s_xor_b32 s64, s65, 70656
s_cmpk_gt_u32 s69, 44
s_waitcnt vmcnt(6)
s_cbranch_scc1 L_d_41
s_waitcnt vmcnt(4)
L_d_41:
buffer_load_dwordx4 v[184:187], v1, s[40:43], s64 offen nt
s_xor_b32 s64, s65, 103424
s_cmpk_gt_u32 s69, 45
s_waitcnt vmcnt(6)
s_cbranch_scc1 L_d_42
s_waitcnt vmcnt(4)
L_d_42:
buffer_load_dwordx4 v[188:191], v1, s[40:43], s64 offen nt
s_xor_b32 s64, s65, 78848
s_cmpk_gt_u32 s69, 46
s_waitcnt vmcnt(6)
s_cbranch_scc1 L_d_43
s_waitcnt vmcnt(4)
L_d_43:
buffer_load_dwordx4 v[192:195], v1, s[40:43], s64 offen nt
s_xor_b32 s64, s65, 111616
s_cmpk_gt_u32 s69, 47
s_waitcnt vmcnt(6)
s_cbranch_scc1 L_d_44
s_waitcnt vmcnt(4)
L_d_44:
buffer_load_dwordx4 v[196:199], v1, s[40:43], s64 offen nt
s_xor_b32 s64, s65, 135168
s_cmpk_gt_u32 s69, 48
s_waitcnt vmcnt(6)
s_cbranch_scc1 L_d_45
s_waitcnt vmcnt(4)
L_d_45:
buffer_load_dwordx4 v[200:203], v1, s[40:43], s64 offen nt
s_xor_b32 s64, s65, 167936
s_cmpk_gt_u32 s69, 49
s_waitcnt vmcnt(6)
s_cbranch_scc1 L_d_46
s_waitcnt vmcnt(4)
L_d_46:
buffer_load_dwordx4 v[204:207], v1, s[40:43], s64 offen nt
s_xor_b32 s64, s65, 143360
s_cmpk_gt_u32 s69, 50
s_waitcnt vmcnt(6)
s_cbranch_scc1 L_d_47
s_waitcnt vmcnt(4)
L_d_47:
buffer_load_dwordx4 v[208:211], v1, s[40:43], s64 offen nt
s_xor_b32 s64, s65, 176128
s_cmpk_gt_u32 s69, 51
s_waitcnt vmcnt(6)
s_cbranch_scc1 L_d_48
s_waitcnt vmcnt(4)
L_d_48:
buffer_load_dwordx4 v[212:215], v1, s[40:43], s64 offen nt
s_xor_b32 s64, s65, 136192
s_cmpk_gt_u32 s69, 52
s_waitcnt vmcnt(6)
s_cbranch_scc1 L_d_49
s_waitcnt vmcnt(4)
L_d_49:
buffer_load_dwordx4 v[216:219], v1, s[40:43], s64 offen nt
s_xor_b32 s64, s65, 168960
s_cmpk_gt_u32 s69, 53
s_waitcnt vmcnt(6)
s_cbranch_scc1 L_d_50
s_waitcnt vmcnt(4)
L_d_50:
buffer_load_dwordx4 v[220:223], v1, s[40:43], s64 offen nt
s_xor_b32 s64, s65, 144384
s_cmpk_gt_u32 s69, 54
s_waitcnt vmcnt(6)
s_cbranch_scc1 L_d_51
s_waitcnt vmcnt(4)
L_d_51:
buffer_load_dwordx4 v[224:227], v1, s[40:43], s64 offen nt
s_xor_b32 s64, s65, 177152
s_cmpk_gt_u32 s69, 55
s_waitcnt vmcnt(6)
s_cbranch_scc1 L_d_52
s_waitcnt vmcnt(4)
L_d_52:
buffer_load_dwordx4 v[228:231], v1, s[40:43], s64 offen nt
s_cmp_eq_u32 s74, -1
s_mov_b32 s69, 64
s_cselect_b32 s69, 64, s69
s_cmp_lt_u32 s2, 144
s_cselect_b32 s69, 112, s69
s_cmp_lt_u32 s2, 112
s_cselect_b32 s69, 0, s69
s_cmp_lt_u32 s2, 48
s_cselect_b32 s69, 72, s69
s_cmp_lt_u32 s2, 16
s_cselect_b32 s69, 112, s69
s_xor_b32 s64, s65, 200704
s_cmpk_gt_u32 s69, 56
s_waitcnt vmcnt(6)
s_cbranch_scc1 L_d_53
s_waitcnt vmcnt(4)
L_d_53:
buffer_load_dwordx4 v[232:235], v1, s[40:43], s64 offen nt
s_xor_b32 s64, s65, 233472
s_cmpk_gt_u32 s69, 57
s_waitcnt vmcnt(6)
s_cbranch_scc1 L_d_54
s_waitcnt vmcnt(4)
L_d_54:
buffer_load_dwordx4 v[236:239], v1, s[40:43], s64 offen nt
s_xor_b32 s64, s65, 208896
s_cmpk_gt_u32 s69, 58
s_waitcnt vmcnt(6)
s_cbranch_scc1 L_d_55
s_waitcnt vmcnt(4)
L_d_55:
buffer_load_dwordx4 v[240:243], v1, s[40:43], s64 offen nt
v_and_b32 v2, 31, v0
v_lshlrev_b32 v2, 2, v2
buffer_load_dword v3, v2, s[52:55], 0 offen offset:128
s_xor_b32 s64, s65, 241664
s_cmpk_gt_u32 s69, 59
s_waitcnt vmcnt(6)
s_cbranch_scc1 L_d_56
s_waitcnt vmcnt(4)
L_d_56:
buffer_load_dwordx4 v[244:247], v1, s[40:43], s64 offen nt
s_xor_b32 s64, s65, 201728
s_cmpk_gt_u32 s69, 60
s_waitcnt vmcnt(6)
s_cbranch_scc1 L_d_57
s_waitcnt vmcnt(4)
L_d_57:
buffer_load_dwordx4 v[248:251], v1, s[40:43], s64 offen nt
s_xor_b32 s64, s65, 234496
s_cmpk_gt_u32 s69, 61
s_waitcnt vmcnt(6)
s_cbranch_scc1 L_d_58
s_waitcnt vmcnt(4)
L_d_58:
buffer_load_dwordx4 v[252:255], v1, s[40:43], s64 offen nt
s_mul_i32 s70, s34, 15360
s_add_u32 s70, s70, 69632
s_add_u32 m0, s70, 0
s_xor_b32 s64, s65, 209920
s_cmpk_gt_u32 s69, 62
s_waitcnt vmcnt(6)
s_cbranch_scc1 L_d_59
s_waitcnt vmcnt(4)
L_d_59:
buffer_load_dwordx4 v1, s[40:43], s64 offen nt lds
s_add_u32 m0, s70, 1024
s_xor_b32 s64, s65, 242688
s_cmpk_gt_u32 s69, 63
s_waitcnt vmcnt(6)
s_cbranch_scc1 L_d_60
s_waitcnt vmcnt(4)
L_d_60:
buffer_load_dwordx4 v1, s[40:43], s64 offen nt lds
s_add_u32 m0, s70, 2048
s_xor_b32 s64, s65, 0
s_cmpk_gt_u32 s69, 64
s_waitcnt vmcnt(6)
s_cbranch_scc1 L_d_61
s_waitcnt vmcnt(4)
L_d_61:
buffer_load_dwordx4 v1, s[44:47], s64 offen nt lds
s_add_u32 m0, s70, 3072
s_xor_b32 s64, s65, 32768
s_cmpk_gt_u32 s69, 65
s_waitcnt vmcnt(6)
s_cbranch_scc1 L_d_62
s_waitcnt vmcnt(4)
L_d_62:
buffer_load_dwordx4 v1, s[44:47], s64 offen nt lds
s_add_u32 m0, s70, 4096
s_xor_b32 s64, s65, 4096
s_cmpk_gt_u32 s69, 66
s_waitcnt vmcnt(6)
s_cbranch_scc1 L_d_63
s_waitcnt vmcnt(4)
L_d_63:
buffer_load_dwordx4 v1, s[44:47], s64 offen nt lds
s_add_u32 m0, s70, 5120
s_xor_b32 s64, s65, 36864
s_cmpk_gt_u32 s69, 67
s_waitcnt vmcnt(6)
s_cbranch_scc1 L_d_64
s_waitcnt vmcnt(4)
L_d_64:
buffer_load_dwordx4 v1, s[44:47], s64 offen nt lds
v_cmp_eq_u32 vcc, 0, v3
s_cbranch_vccz L_jf_66
s_mov_b32 s75, 0
L_poll_67:
v_and_b32 v2, 31, v0
v_lshlrev_b32 v2, 2, v2
buffer_load_dword v3, v2, s[52:55], 0 offen offset:128 sc1
s_waitcnt vmcnt(0)
v_cmp_eq_u32 vcc, 0, v3
s_cbranch_vccz L_pollx_68
s_sleep 40
s_add_u32 s75, s75, 1
s_cmp_lt_u32 s75, 0x100000
s_cbranch_scc1 L_poll_67
L_pollx_68:
L_jf_66:
s_mul_i32 s68, s32, 12288
s_lshl_b32 s67, s33, 8
s_add_u32 s68, s68, s67
s_add_u32 s68, s68, 16384
v_and_b32 v2, 0xf0, v1
buffer_load_dwordx4 v[4:7], v2, s[36:39], s68 offen sc1
s_add_u32 m0, s70, 6144
s_xor_b32 s64, s65, 8192
s_cmpk_gt_u32 s69, 68
s_waitcnt vmcnt(6)
s_cbranch_scc1 L_d_65
s_waitcnt vmcnt(4)
L_d_65:
buffer_load_dwordx4 v1, s[44:47], s64 offen nt lds
s_add_u32 m0, s70, 7168
s_xor_b32 s64, s65, 40960
s_cmpk_gt_u32 s69, 69
s_waitcnt vmcnt(6)
s_cbranch_scc1 L_d_69
s_waitcnt vmcnt(4)
L_d_69:
buffer_load_dwordx4 v1, s[44:47], s64 offen nt lds
s_add_u32 m0, s70, 8192
s_xor_b32 s64, s65, 12288
s_cmpk_gt_u32 s69, 70
s_waitcnt vmcnt(6)
s_cbranch_scc1 L_d_70
s_waitcnt vmcnt(4)
L_d_70:
buffer_load_dwordx4 v1, s[44:47], s64 offen nt lds
s_add_u32 m0, s70, 9216
s_xor_b32 s64, s65, 45056
s_cmpk_gt_u32 s69, 71
s_waitcnt vmcnt(6)
s_cbranch_scc1 L_d_71
s_waitcnt vmcnt(4)
L_d_71:
buffer_load_dwordx4 v1, s[44:47], s64 offen nt lds
s_add_u32 m0, s70, 10240
s_xor_b32 s64, s65, 65536
s_cmpk_gt_u32 s69, 72
s_waitcnt vmcnt(6)
s_cbranch_scc1 L_d_72
s_waitcnt vmcnt(4)
L_d_72:
buffer_load_dwordx4 v1, s[44:47], s64 offen nt lds
s_add_u32 m0, s70, 11264
s_xor_b32 s64, s65, 98304
s_cmpk_gt_u32 s69, 73
s_waitcnt vmcnt(6)
s_cbranch_scc1 L_d_73
s_waitcnt vmcnt(4)
L_d_73:
buffer_load_dwordx4 v1, s[44:47], s64 offen nt lds
s_add_u32 m0, s70, 12288
s_xor_b32 s64, s65, 69632
s_cmpk_gt_u32 s69, 74
s_waitcnt vmcnt(6)
s_cbranch_scc1 L_d_74
s_waitcnt vmcnt(4)
L_d_74:
buffer_load_dwordx4 v1, s[44:47], s64 offen nt lds
s_add_u32 m0, s70, 13312
s_xor_b32 s64, s65, 102400
s_cmpk_gt_u32 s69, 75
s_waitcnt vmcnt(6)
s_cbranch_scc1 L_d_75
s_waitcnt vmcnt(4)
L_d_75:
buffer_load_dwordx4 v1, s[44:47], s64 offen nt lds
s_add_u32 m0, s70, 14336
s_xor_b32 s64, s65, 73728
s_cmpk_gt_u32 s69, 76
s_waitcnt vmcnt(6)
s_cbranch_scc1 L_d_76
s_waitcnt vmcnt(4)
L_d_76:
buffer_load_dwordx4 v1, s[44:47], s64 offen nt lds
v_max3_u32 v3, v4, v5, v6
v_max_u32 v3, v3, v7
v_cmp_eq_u32 vcc, -1, v3
s_cbranch_vccz L_q_77
s_mov_b32 s75, 0
L_poll_78:
s_mul_i32 s68, s32, 12288
s_lshl_b32 s67, s33, 8
s_add_u32 s68, s68, s67
s_add_u32 s68, s68, 16384
v_and_b32 v2, 0xf0, v1
buffer_load_dwordx4 v[4:7], v2, s[36:39], s68 offen sc1
s_waitcnt vmcnt(0)
v_max3_u32 v3, v4, v5, v6
v_max_u32 v3, v3, v7
v_cmp_eq_u32 vcc, -1, v3
s_cbranch_vccz L_pollx_79
s_add_u32 s75, s75, 1
s_cmp_lt_u32 s75, 0x100000
s_cbranch_scc1 L_poll_78
L_pollx_79:
L_q_77:
s_mov_b32 s66, 0x3db504f3
v_dot2_f32_bf16 v8, v8, v4, 0
v_dot2_f32_bf16 v12, v12, v4, 0
v_dot2_f32_bf16 v16, v16, v4, 0
v_dot2_f32_bf16 v20, v20, v4, 0
v_dot2c_f32_bf16 v8, v9, v5
v_dot2c_f32_bf16 v12, v13, v5
v_dot2c_f32_bf16 v16, v17, v5
v_dot2c_f32_bf16 v20, v21, v5
v_dot2c_f32_bf16 v8, v10, v6
v_dot2c_f32_bf16 v12, v14, v6
v_dot2c_f32_bf16 v16, v18, v6
v_dot2c_f32_bf16 v20, v22, v6
v_dot2c_f32_bf16 v8, v11, v7
v_dot2c_f32_bf16 v12, v15, v7
v_dot2c_f32_bf16 v16, v19, v7
v_dot2c_f32_bf16 v20, v23, v7
v_add_f32_dpp v9, v8, v8 row_ror:8 row_mask:0xf bank_mask:0x3
v_add_f32_dpp v13, v12, v12 row_ror:8 row_mask:0xf bank_mask:0x3
v_add_f32_dpp v9, v16, v16 row_ror:8 row_mask:0xf bank_mask:0xc
v_add_f32_dpp v13, v20, v20 row_ror:8 row_mask:0xf bank_mask:0xc
s_nop 0
v_add_f32_dpp v17, v9, v9 row_shl:4 row_mask:0xf bank_mask:0x5
v_add_f32_dpp v17, v13, v13 row_shr:4 row_mask:0xf bank_mask:0xa
s_nop 1
v_add_f32_dpp v17, v17, v17 quad_perm:[1,0,3,2] row_mask:0xf bank_mask:0xf
s_nop 1
v_add_f32_dpp v17, v17, v17 quad_perm:[2,3,0,1] row_mask:0xf bank_mask:0xf
v_cvt_pk_bf16_f32 v17, 0, v17
v_mul_f32 v17, s66, v17
v_cvt_pk_bf16_f32 v17, 0, v17
v_dot2_f32_bf16 v24, v24, v4, 0
v_dot2_f32_bf16 v28, v28, v4, 0
v_dot2_f32_bf16 v32, v32, v4, 0
v_dot2_f32_bf16 v36, v36, v4, 0
v_dot2c_f32_bf16 v24, v25, v5
v_dot2c_f32_bf16 v28, v29, v5
v_dot2c_f32_bf16 v32, v33, v5
v_dot2c_f32_bf16 v36, v37, v5
v_dot2c_f32_bf16 v24, v26, v6
v_dot2c_f32_bf16 v28, v30, v6
v_dot2c_f32_bf16 v32, v34, v6
v_dot2c_f32_bf16 v36, v38, v6
v_dot2c_f32_bf16 v24, v27, v7
v_dot2c_f32_bf16 v28, v31, v7
v_dot2c_f32_bf16 v32, v35, v7
v_dot2c_f32_bf16 v36, v39, v7
v_add_f32_dpp v25, v24, v24 row_ror:8 row_mask:0xf bank_mask:0x3
v_add_f32_dpp v29, v28, v28 row_ror:8 row_mask:0xf bank_mask:0x3
v_add_f32_dpp v25, v32, v32 row_ror:8 row_mask:0xf bank_mask:0xc
v_add_f32_dpp v29, v36, v36 row_ror:8 row_mask:0xf bank_mask:0xc
s_nop 0
v_add_f32_dpp v8, v25, v25 row_shl:4 row_mask:0xf bank_mask:0x5
v_add_f32_dpp v8, v29, v29 row_shr:4 row_mask:0xf bank_mask:0xa
s_nop 1
v_add_f32_dpp v8, v8, v8 quad_perm:[1,0,3,2] row_mask:0xf bank_mask:0xf
s_nop 1
v_add_f32_dpp v8, v8, v8 quad_perm:[2,3,0,1] row_mask:0xf bank_mask:0xf
v_cvt_pk_bf16_f32 v8, 0, v8
v_mul_f32 v8, s66, v8
v_cvt_pk_bf16_f32 v8, 0, v8
s_xor_b32 s64, s65, 106496
s_cmpk_gt_u32 s69, 77
s_waitcnt vmcnt(6)
s_cbranch_scc1 L_d_80
s_waitcnt vmcnt(4)
L_d_80:
buffer_load_dwordx4 v[24:27], v1, s[44:47], s64 offen nt
v_dot2_f32_bf16 v40, v40, v4, 0
v_dot2_f32_bf16 v44, v44, v4, 0
v_dot2_f32_bf16 v48, v48, v4, 0
v_dot2_f32_bf16 v52, v52, v4, 0
v_dot2c_f32_bf16 v40, v41, v5
v_dot2c_f32_bf16 v44, v45, v5
v_dot2c_f32_bf16 v48, v49, v5
v_dot2c_f32_bf16 v52, v53, v5
v_dot2c_f32_bf16 v40, v42, v6
v_dot2c_f32_bf16 v44, v46, v6
v_dot2c_f32_bf16 v48, v50, v6
v_dot2c_f32_bf16 v52, v54, v6
v_dot2c_f32_bf16 v40, v43, v7
v_dot2c_f32_bf16 v44, v47, v7
v_dot2c_f32_bf16 v48, v51, v7
v_dot2c_f32_bf16 v52, v55, v7
v_add_f32_dpp v41, v40, v40 row_ror:8 row_mask:0xf bank_mask:0x3
v_add_f32_dpp v45, v44, v44 row_ror:8 row_mask:0xf bank_mask:0x3
v_add_f32_dpp v41, v48, v48 row_ror:8 row_mask:0xf bank_mask:0xc
v_add_f32_dpp v45, v52, v52 row_ror:8 row_mask:0xf bank_mask:0xc
s_nop 0
v_add_f32_dpp v9, v41, v41 row_shl:4 row_mask:0xf bank_mask:0x5
v_add_f32_dpp v9, v45, v45 row_shr:4 row_mask:0xf bank_mask:0xa
s_nop 1
v_add_f32_dpp v9, v9, v9 quad_perm:[1,0,3,2] row_mask:0xf bank_mask:0xf
s_nop 1
v_add_f32_dpp v9, v9, v9 quad_perm:[2,3,0,1] row_mask:0xf bank_mask:0xf
v_cvt_pk_bf16_f32 v9, 0, v9
v_mul_f32 v9, s66, v9
v_cvt_pk_bf16_f32 v9, 0, v9
s_and_b32 s62, s2, 7
s_lshl_b32 s62, s62, 9
s_add_u32 s62, s62, 1327104
s_lshr_b32 s63, s2, 3
s_lshl_b32 s63, s63, 2
s_add_u32 s63, s63, s62
s_cmp_eq_u32 s34, 0
s_cbranch_scc0 L_w_82
v_mov_b32 v2, 14
s_mov_b64 exec, 1
buffer_store_dword v2, off, s[36:39], s63 offset:0
s_mov_b64 exec, -1
L_w_82:
s_xor_b32 s64, s65, 77824
s_cmpk_gt_u32 s69, 78
s_waitcnt vmcnt(6)
s_cbranch_scc1 L_d_81
s_waitcnt vmcnt(4)
L_d_81:
buffer_load_dwordx4 v[28:31], v1, s[44:47], s64 offen nt
v_dot2_f32_bf16 v56, v56, v4, 0
v_dot2_f32_bf16 v60, v60, v4, 0
v_dot2_f32_bf16 v64, v64, v4, 0
v_dot2_f32_bf16 v68, v68, v4, 0
v_dot2c_f32_bf16 v56, v57, v5
v_dot2c_f32_bf16 v60, v61, v5
v_dot2c_f32_bf16 v64, v65, v5
v_dot2c_f32_bf16 v68, v69, v5
v_dot2c_f32_bf16 v56, v58, v6
v_dot2c_f32_bf16 v60, v62, v6
v_dot2c_f32_bf16 v64, v66, v6
v_dot2c_f32_bf16 v68, v70, v6
v_dot2c_f32_bf16 v56, v59, v7
v_dot2c_f32_bf16 v60, v63, v7
v_dot2c_f32_bf16 v64, v67, v7
v_dot2c_f32_bf16 v68, v71, v7
v_add_f32_dpp v57, v56, v56 row_ror:8 row_mask:0xf bank_mask:0x3
v_add_f32_dpp v61, v60, v60 row_ror:8 row_mask:0xf bank_mask:0x3
v_add_f32_dpp v57, v64, v64 row_ror:8 row_mask:0xf bank_mask:0xc
v_add_f32_dpp v61, v68, v68 row_ror:8 row_mask:0xf bank_mask:0xc
s_nop 0
v_add_f32_dpp v10, v57, v57 row_shl:4 row_mask:0xf bank_mask:0x5
v_add_f32_dpp v10, v61, v61 row_shr:4 row_mask:0xf bank_mask:0xa
s_nop 1
v_add_f32_dpp v10, v10, v10 quad_perm:[1,0,3,2] row_mask:0xf bank_mask:0xf
s_nop 1
v_add_f32_dpp v10, v10, v10 quad_perm:[2,3,0,1] row_mask:0xf bank_mask:0xf
v_cvt_pk_bf16_f32 v10, 0, v10
v_mul_f32 v10, s66, v10
v_cvt_pk_bf16_f32 v10, 0, v10
s_xor_b32 s64, s65, 110592
s_cmpk_gt_u32 s69, 79
s_waitcnt vmcnt(6)
s_cbranch_scc1 L_d_83
s_waitcnt vmcnt(4)
L_d_83:
buffer_load_dwordx4 v[32:35], v1, s[44:47], s64 offen nt
v_dot2_f32_bf16 v72, v72, v4, 0
v_dot2_f32_bf16 v76, v76, v4, 0
v_dot2_f32_bf16 v80, v80, v4, 0
v_dot2_f32_bf16 v84, v84, v4, 0
v_dot2c_f32_bf16 v72, v73, v5
v_dot2c_f32_bf16 v76, v77, v5
v_dot2c_f32_bf16 v80, v81, v5
v_dot2c_f32_bf16 v84, v85, v5
v_dot2c_f32_bf16 v72, v74, v6
v_dot2c_f32_bf16 v76, v78, v6
v_dot2c_f32_bf16 v80, v82, v6
v_dot2c_f32_bf16 v84, v86, v6
v_dot2c_f32_bf16 v72, v75, v7
v_dot2c_f32_bf16 v76, v79, v7
v_dot2c_f32_bf16 v80, v83, v7
v_dot2c_f32_bf16 v84, v87, v7
v_add_f32_dpp v73, v72, v72 row_ror:8 row_mask:0xf bank_mask:0x3
v_add_f32_dpp v77, v76, v76 row_ror:8 row_mask:0xf bank_mask:0x3
v_add_f32_dpp v73, v80, v80 row_ror:8 row_mask:0xf bank_mask:0xc
v_add_f32_dpp v77, v84, v84 row_ror:8 row_mask:0xf bank_mask:0xc
s_nop 0
v_add_f32_dpp v11, v73, v73 row_shl:4 row_mask:0xf bank_mask:0x5
v_add_f32_dpp v11, v77, v77 row_shr:4 row_mask:0xf bank_mask:0xa
s_nop 1
v_add_f32_dpp v11, v11, v11 quad_perm:[1,0,3,2] row_mask:0xf bank_mask:0xf
s_nop 1
v_add_f32_dpp v11, v11, v11 quad_perm:[2,3,0,1] row_mask:0xf bank_mask:0xf
v_cvt_pk_bf16_f32 v11, 0, v11
v_mul_f32 v11, s66, v11
v_cvt_pk_bf16_f32 v11, 0, v11
s_xor_b32 s64, s65, 1024
s_cmpk_gt_u32 s69, 80
s_waitcnt vmcnt(6)
s_cbranch_scc1 L_d_84
s_waitcnt vmcnt(4)
L_d_84:
buffer_load_dwordx4 v[36:39], v1, s[44:47], s64 offen nt
v_dot2_f32_bf16 v88, v88, v4, 0
v_dot2_f32_bf16 v92, v92, v4, 0
v_dot2_f32_bf16 v96, v96, v4, 0
v_dot2_f32_bf16 v100, v100, v4, 0
v_dot2c_f32_bf16 v88, v89, v5
v_dot2c_f32_bf16 v92, v93, v5
v_dot2c_f32_bf16 v96, v97, v5
v_dot2c_f32_bf16 v100, v101, v5
v_dot2c_f32_bf16 v88, v90, v6
v_dot2c_f32_bf16 v92, v94, v6
v_dot2c_f32_bf16 v96, v98, v6
v_dot2c_f32_bf16 v100, v102, v6
v_dot2c_f32_bf16 v88, v91, v7
v_dot2c_f32_bf16 v92, v95, v7
v_dot2c_f32_bf16 v96, v99, v7
v_dot2c_f32_bf16 v100, v103, v7
v_add_f32_dpp v89, v88, v88 row_ror:8 row_mask:0xf bank_mask:0x3
v_add_f32_dpp v93, v92, v92 row_ror:8 row_mask:0xf bank_mask:0x3
v_add_f32_dpp v89, v96, v96 row_ror:8 row_mask:0xf bank_mask:0xc
v_add_f32_dpp v93, v100, v100 row_ror:8 row_mask:0xf bank_mask:0xc
s_nop 0
v_add_f32_dpp v12, v89, v89 row_shl:4 row_mask:0xf bank_mask:0x5
v_add_f32_dpp v12, v93, v93 row_shr:4 row_mask:0xf bank_mask:0xa
s_nop 1
v_add_f32_dpp v12, v12, v12 quad_perm:[1,0,3,2] row_mask:0xf bank_mask:0xf
s_nop 1
v_add_f32_dpp v12, v12, v12 quad_perm:[2,3,0,1] row_mask:0xf bank_mask:0xf
v_cvt_pk_bf16_f32 v12, 0, v12
v_mul_f32 v12, s66, v12
v_cvt_pk_bf16_f32 v12, 0, v12
s_xor_b32 s64, s65, 33792
s_cmpk_gt_u32 s69, 81
s_waitcnt vmcnt(6)
s_cbranch_scc1 L_d_85
s_waitcnt vmcnt(4)
L_d_85:
buffer_load_dwordx4 v[40:43], v1, s[44:47], s64 offen nt
v_dot2_f32_bf16 v104, v104, v4, 0
v_dot2_f32_bf16 v108, v108, v4, 0
v_dot2_f32_bf16 v112, v112, v4, 0
v_dot2_f32_bf16 v116, v116, v4, 0
v_dot2c_f32_bf16 v104, v105, v5
v_dot2c_f32_bf16 v108, v109, v5
v_dot2c_f32_bf16 v112, v113, v5
v_dot2c_f32_bf16 v116, v117, v5
v_dot2c_f32_bf16 v104, v106, v6
v_dot2c_f32_bf16 v108, v110, v6
v_dot2c_f32_bf16 v112, v114, v6
v_dot2c_f32_bf16 v116, v118, v6
v_dot2c_f32_bf16 v104, v107, v7
v_dot2c_f32_bf16 v108, v111, v7
v_dot2c_f32_bf16 v112, v115, v7
v_dot2c_f32_bf16 v116, v119, v7
v_add_f32_dpp v105, v104, v104 row_ror:8 row_mask:0xf bank_mask:0x3
v_add_f32_dpp v109, v108, v108 row_ror:8 row_mask:0xf bank_mask:0x3
v_add_f32_dpp v105, v112, v112 row_ror:8 row_mask:0xf bank_mask:0xc
v_add_f32_dpp v109, v116, v116 row_ror:8 row_mask:0xf bank_mask:0xc
s_nop 0
v_add_f32_dpp v13, v105, v105 row_shl:4 row_mask:0xf bank_mask:0x5
v_add_f32_dpp v13, v109, v109 row_shr:4 row_mask:0xf bank_mask:0xa
s_nop 1
v_add_f32_dpp v13, v13, v13 quad_perm:[1,0,3,2] row_mask:0xf bank_mask:0xf
s_nop 1
v_add_f32_dpp v13, v13, v13 quad_perm:[2,3,0,1] row_mask:0xf bank_mask:0xf
v_cvt_pk_bf16_f32 v13, 0, v13
v_mul_f32 v13, s66, v13
v_cvt_pk_bf16_f32 v13, 0, v13
s_xor_b32 s64, s65, 5120
s_cmpk_gt_u32 s69, 82
s_waitcnt vmcnt(6)
s_cbranch_scc1 L_d_86
s_waitcnt vmcnt(4)
L_d_86:
buffer_load_dwordx4 v[44:47], v1, s[44:47], s64 offen nt
v_dot2_f32_bf16 v120, v120, v4, 0
v_dot2_f32_bf16 v124, v124, v4, 0
v_dot2_f32_bf16 v128, v128, v4, 0
v_dot2_f32_bf16 v132, v132, v4, 0
v_dot2c_f32_bf16 v120, v121, v5
v_dot2c_f32_bf16 v124, v125, v5
v_dot2c_f32_bf16 v128, v129, v5
v_dot2c_f32_bf16 v132, v133, v5
v_dot2c_f32_bf16 v120, v122, v6
v_dot2c_f32_bf16 v124, v126, v6
v_dot2c_f32_bf16 v128, v130, v6
v_dot2c_f32_bf16 v132, v134, v6
v_dot2c_f32_bf16 v120, v123, v7
v_dot2c_f32_bf16 v124, v127, v7
v_dot2c_f32_bf16 v128, v131, v7
v_dot2c_f32_bf16 v132, v135, v7
v_add_f32_dpp v121, v120, v120 row_ror:8 row_mask:0xf bank_mask:0x3
v_add_f32_dpp v125, v124, v124 row_ror:8 row_mask:0xf bank_mask:0x3
v_add_f32_dpp v121, v128, v128 row_ror:8 row_mask:0xf bank_mask:0xc
v_add_f32_dpp v125, v132, v132 row_ror:8 row_mask:0xf bank_mask:0xc
s_nop 0
v_add_f32_dpp v14, v121, v121 row_shl:4 row_mask:0xf bank_mask:0x5
v_add_f32_dpp v14, v125, v125 row_shr:4 row_mask:0xf bank_mask:0xa
s_nop 1
v_add_f32_dpp v14, v14, v14 quad_perm:[1,0,3,2] row_mask:0xf bank_mask:0xf
s_nop 1
v_add_f32_dpp v14, v14, v14 quad_perm:[2,3,0,1] row_mask:0xf bank_mask:0xf
v_cvt_pk_bf16_f32 v14, 0, v14
v_mul_f32 v14, s66, v14
v_cvt_pk_bf16_f32 v14, 0, v14
s_xor_b32 s64, s65, 37888
s_cmpk_gt_u32 s69, 83
s_waitcnt vmcnt(6)
s_cbranch_scc1 L_d_87
s_waitcnt vmcnt(4)
L_d_87:
buffer_load_dwordx4 v[48:51], v1, s[44:47], s64 offen nt
v_dot2_f32_bf16 v136, v136, v4, 0
v_dot2_f32_bf16 v140, v140, v4, 0
v_dot2_f32_bf16 v144, v144, v4, 0
v_dot2_f32_bf16 v148, v148, v4, 0
v_dot2c_f32_bf16 v136, v137, v5
v_dot2c_f32_bf16 v140, v141, v5
v_dot2c_f32_bf16 v144, v145, v5
v_dot2c_f32_bf16 v148, v149, v5
v_dot2c_f32_bf16 v136, v138, v6
v_dot2c_f32_bf16 v140, v142, v6
v_dot2c_f32_bf16 v144, v146, v6
v_dot2c_f32_bf16 v148, v150, v6
v_dot2c_f32_bf16 v136, v139, v7
v_dot2c_f32_bf16 v140, v143, v7
v_dot2c_f32_bf16 v144, v147, v7
v_dot2c_f32_bf16 v148, v151, v7
v_add_f32_dpp v137, v136, v136 row_ror:8 row_mask:0xf bank_mask:0x3
v_add_f32_dpp v141, v140, v140 row_ror:8 row_mask:0xf bank_mask:0x3
v_add_f32_dpp v137, v144, v144 row_ror:8 row_mask:0xf bank_mask:0xc
v_add_f32_dpp v141, v148, v148 row_ror:8 row_mask:0xf bank_mask:0xc
s_nop 0
v_add_f32_dpp v15, v137, v137 row_shl:4 row_mask:0xf bank_mask:0x5
v_add_f32_dpp v15, v141, v141 row_shr:4 row_mask:0xf bank_mask:0xa
s_nop 1
v_add_f32_dpp v15, v15, v15 quad_perm:[1,0,3,2] row_mask:0xf bank_mask:0xf
s_nop 1
v_add_f32_dpp v15, v15, v15 quad_perm:[2,3,0,1] row_mask:0xf bank_mask:0xf
v_cvt_pk_bf16_f32 v15, 0, v15
v_mul_f32 v15, s66, v15
v_cvt_pk_bf16_f32 v15, 0, v15
s_xor_b32 s64, s65, 9216
s_cmpk_gt_u32 s69, 84
s_waitcnt vmcnt(6)
s_cbranch_scc1 L_d_88
s_waitcnt vmcnt(4)
L_d_88:
buffer_load_dwordx4 v[52:55], v1, s[44:47], s64 offen nt
v_dot2_f32_bf16 v152, v152, v4, 0
v_dot2_f32_bf16 v156, v156, v4, 0
v_dot2_f32_bf16 v160, v160, v4, 0
v_dot2_f32_bf16 v164, v164, v4, 0
v_dot2c_f32_bf16 v152, v153, v5
v_dot2c_f32_bf16 v156, v157, v5
v_dot2c_f32_bf16 v160, v161, v5
v_dot2c_f32_bf16 v164, v165, v5
v_dot2c_f32_bf16 v152, v154, v6
v_dot2c_f32_bf16 v156, v158, v6
v_dot2c_f32_bf16 v160, v162, v6
v_dot2c_f32_bf16 v164, v166, v6
v_dot2c_f32_bf16 v152, v155, v7
v_dot2c_f32_bf16 v156, v159, v7
v_dot2c_f32_bf16 v160, v163, v7
v_dot2c_f32_bf16 v164, v167, v7
v_add_f32_dpp v153, v152, v152 row_ror:8 row_mask:0xf bank_mask:0x3
v_add_f32_dpp v157, v156, v156 row_ror:8 row_mask:0xf bank_mask:0x3
v_add_f32_dpp v153, v160, v160 row_ror:8 row_mask:0xf bank_mask:0xc
v_add_f32_dpp v157, v164, v164 row_ror:8 row_mask:0xf bank_mask:0xc
s_nop 0
v_add_f32_dpp v16, v153, v153 row_shl:4 row_mask:0xf bank_mask:0x5
v_add_f32_dpp v16, v157, v157 row_shr:4 row_mask:0xf bank_mask:0xa
s_nop 1
v_add_f32_dpp v16, v16, v16 quad_perm:[1,0,3,2] row_mask:0xf bank_mask:0xf
s_nop 1
v_add_f32_dpp v16, v16, v16 quad_perm:[2,3,0,1] row_mask:0xf bank_mask:0xf
v_cvt_pk_bf16_f32 v16, 0, v16
v_mul_f32 v16, s66, v16
v_cvt_pk_bf16_f32 v16, 0, v16
s_xor_b32 s64, s65, 41984
s_cmpk_gt_u32 s69, 85
s_waitcnt vmcnt(6)
s_cbranch_scc1 L_d_89
s_waitcnt vmcnt(4)
L_d_89:
buffer_load_dwordx4 v[56:59], v1, s[44:47], s64 offen nt
v_dot2_f32_bf16 v168, v168, v4, 0
v_dot2_f32_bf16 v172, v172, v4, 0
v_dot2_f32_bf16 v176, v176, v4, 0
v_dot2_f32_bf16 v180, v180, v4, 0
v_dot2c_f32_bf16 v168, v169, v5
v_dot2c_f32_bf16 v172, v173, v5
v_dot2c_f32_bf16 v176, v177, v5
v_dot2c_f32_bf16 v180, v181, v5
v_dot2c_f32_bf16 v168, v170, v6
v_dot2c_f32_bf16 v172, v174, v6
v_dot2c_f32_bf16 v176, v178, v6
v_dot2c_f32_bf16 v180, v182, v6
v_dot2c_f32_bf16 v168, v171, v7
v_dot2c_f32_bf16 v172, v175, v7
v_dot2c_f32_bf16 v176, v179, v7
v_dot2c_f32_bf16 v180, v183, v7
v_add_f32_dpp v169, v168, v168 row_ror:8 row_mask:0xf bank_mask:0x3
v_add_f32_dpp v173, v172, v172 row_ror:8 row_mask:0xf bank_mask:0x3
v_add_f32_dpp v169, v176, v176 row_ror:8 row_mask:0xf bank_mask:0xc
v_add_f32_dpp v173, v180, v180 row_ror:8 row_mask:0xf bank_mask:0xc
s_nop 0
v_add_f32_dpp v18, v169, v169 row_shl:4 row_mask:0xf bank_mask:0x5
v_add_f32_dpp v18, v173, v173 row_shr:4 row_mask:0xf bank_mask:0xa
s_nop 1
v_add_f32_dpp v18, v18, v18 quad_perm:[1,0,3,2] row_mask:0xf bank_mask:0xf
s_nop 1
v_add_f32_dpp v18, v18, v18 quad_perm:[2,3,0,1] row_mask:0xf bank_mask:0xf
v_cvt_pk_bf16_f32 v18, 0, v18
v_mul_f32 v18, s66, v18
v_cvt_pk_bf16_f32 v18, 0, v18
s_cmp_eq_u32 s34, 1
s_cbranch_scc0 L_w_91
v_mov_b32 v60, 22
s_mov_b64 exec, 1
buffer_store_dword v60, off, s[36:39], s63 offset:0
s_mov_b64 exec, -1
L_w_91:
s_xor_b32 s64, s65, 13312
s_cmpk_gt_u32 s69, 86
s_waitcnt vmcnt(6)
s_cbranch_scc1 L_d_90
s_waitcnt vmcnt(4)
L_d_90:
buffer_load_dwordx4 v[64:67], v1, s[44:47], s64 offen nt
v_dot2_f32_bf16 v184, v184, v4, 0
v_dot2_f32_bf16 v188, v188, v4, 0
v_dot2_f32_bf16 v192, v192, v4, 0
v_dot2_f32_bf16 v196, v196, v4, 0
v_dot2c_f32_bf16 v184, v185, v5
v_dot2c_f32_bf16 v188, v189, v5
v_dot2c_f32_bf16 v192, v193, v5
v_dot2c_f32_bf16 v196, v197, v5
v_dot2c_f32_bf16 v184, v186, v6
v_dot2c_f32_bf16 v188, v190, v6
v_dot2c_f32_bf16 v192, v194, v6
v_dot2c_f32_bf16 v196, v198, v6
v_dot2c_f32_bf16 v184, v187, v7
v_dot2c_f32_bf16 v188, v191, v7
v_dot2c_f32_bf16 v192, v195, v7
v_dot2c_f32_bf16 v196, v199, v7
v_add_f32_dpp v185, v184, v184 row_ror:8 row_mask:0xf bank_mask:0x3
v_add_f32_dpp v189, v188, v188 row_ror:8 row_mask:0xf bank_mask:0x3
v_add_f32_dpp v185, v192, v192 row_ror:8 row_mask:0xf bank_mask:0xc
v_add_f32_dpp v189, v196, v196 row_ror:8 row_mask:0xf bank_mask:0xc
s_nop 0
v_add_f32_dpp v19, v185, v185 row_shl:4 row_mask:0xf bank_mask:0x5
v_add_f32_dpp v19, v189, v189 row_shr:4 row_mask:0xf bank_mask:0xa
s_nop 1
v_add_f32_dpp v19, v19, v19 quad_perm:[1,0,3,2] row_mask:0xf bank_mask:0xf
s_nop 1
v_add_f32_dpp v19, v19, v19 quad_perm:[2,3,0,1] row_mask:0xf bank_mask:0xf
v_cvt_pk_bf16_f32 v19, 0, v19
v_mul_f32 v19, s66, v19
v_cvt_pk_bf16_f32 v19, 0, v19
s_xor_b32 s64, s65, 46080
s_cmpk_gt_u32 s69, 87
s_waitcnt vmcnt(6)
s_cbranch_scc1 L_d_92
s_waitcnt vmcnt(4)
L_d_92:
buffer_load_dwordx4 v[68:71], v1, s[44:47], s64 offen nt
v_dot2_f32_bf16 v200, v200, v4, 0
v_dot2_f32_bf16 v204, v204, v4, 0
v_dot2_f32_bf16 v208, v208, v4, 0
v_dot2_f32_bf16 v212, v212, v4, 0
v_dot2c_f32_bf16 v200, v201, v5
v_dot2c_f32_bf16 v204, v205, v5
v_dot2c_f32_bf16 v208, v209, v5
v_dot2c_f32_bf16 v212, v213, v5
v_dot2c_f32_bf16 v200, v202, v6
v_dot2c_f32_bf16 v204, v206, v6
v_dot2c_f32_bf16 v208, v210, v6
v_dot2c_f32_bf16 v212, v214, v6
v_dot2c_f32_bf16 v200, v203, v7
v_dot2c_f32_bf16 v204, v207, v7
v_dot2c_f32_bf16 v208, v211, v7
v_dot2c_f32_bf16 v212, v215, v7
v_add_f32_dpp v201, v200, v200 row_ror:8 row_mask:0xf bank_mask:0x3
v_add_f32_dpp v205, v204, v204 row_ror:8 row_mask:0xf bank_mask:0x3
v_add_f32_dpp v201, v208, v208 row_ror:8 row_mask:0xf bank_mask:0xc
v_add_f32_dpp v205, v212, v212 row_ror:8 row_mask:0xf bank_mask:0xc
s_nop 0
v_add_f32_dpp v20, v201, v201 row_shl:4 row_mask:0xf bank_mask:0x5
v_add_f32_dpp v20, v205, v205 row_shr:4 row_mask:0xf bank_mask:0xa
s_nop 1
v_add_f32_dpp v20, v20, v20 quad_perm:[1,0,3,2] row_mask:0xf bank_mask:0xf
s_nop 1
v_add_f32_dpp v20, v20, v20 quad_perm:[2,3,0,1] row_mask:0xf bank_mask:0xf
v_cvt_pk_bf16_f32 v20, 0, v20
v_mul_f32 v20, s66, v20
v_cvt_pk_bf16_f32 v20, 0, v20
s_xor_b32 s64, s65, 66560
s_cmpk_gt_u32 s69, 88
s_waitcnt vmcnt(6)
s_cbranch_scc1 L_d_93
s_waitcnt vmcnt(4)
L_d_93:
buffer_load_dwordx4 v[72:75], v1, s[44:47], s64 offen nt
v_dot2_f32_bf16 v216, v216, v4, 0
v_dot2_f32_bf16 v220, v220, v4, 0
v_dot2_f32_bf16 v224, v224, v4, 0
v_dot2_f32_bf16 v228, v228, v4, 0
v_dot2c_f32_bf16 v216, v217, v5
v_dot2c_f32_bf16 v220, v221, v5
v_dot2c_f32_bf16 v224, v225, v5
v_dot2c_f32_bf16 v228, v229, v5
v_dot2c_f32_bf16 v216, v218, v6
v_dot2c_f32_bf16 v220, v222, v6
v_dot2c_f32_bf16 v224, v226, v6
v_dot2c_f32_bf16 v228, v230, v6
v_dot2c_f32_bf16 v216, v219, v7
v_dot2c_f32_bf16 v220, v223, v7
v_dot2c_f32_bf16 v224, v227, v7
v_dot2c_f32_bf16 v228, v231, v7
v_add_f32_dpp v217, v216, v216 row_ror:8 row_mask:0xf bank_mask:0x3
v_add_f32_dpp v221, v220, v220 row_ror:8 row_mask:0xf bank_mask:0x3
v_add_f32_dpp v217, v224, v224 row_ror:8 row_mask:0xf bank_mask:0xc
v_add_f32_dpp v221, v228, v228 row_ror:8 row_mask:0xf bank_mask:0xc
s_nop 0
v_add_f32_dpp v21, v217, v217 row_shl:4 row_mask:0xf bank_mask:0x5
v_add_f32_dpp v21, v221, v221 row_shr:4 row_mask:0xf bank_mask:0xa
s_nop 1
v_add_f32_dpp v21, v21, v21 quad_perm:[1,0,3,2] row_mask:0xf bank_mask:0xf
s_nop 1
v_add_f32_dpp v21, v21, v21 quad_perm:[2,3,0,1] row_mask:0xf bank_mask:0xf
v_cvt_pk_bf16_f32 v21, 0, v21
v_mul_f32 v21, s66, v21
v_cvt_pk_bf16_f32 v21, 0, v21
s_xor_b32 s64, s65, 99328
s_cmpk_gt_u32 s69, 89
s_waitcnt vmcnt(6)
s_cbranch_scc1 L_d_94
s_waitcnt vmcnt(4)
L_d_94:
buffer_load_dwordx4 v[76:79], v1, s[44:47], s64 offen nt
v_dot2_f32_bf16 v232, v232, v4, 0
v_dot2_f32_bf16 v236, v236, v4, 0
v_dot2_f32_bf16 v240, v240, v4, 0
v_dot2_f32_bf16 v244, v244, v4, 0
v_dot2c_f32_bf16 v232, v233, v5
v_dot2c_f32_bf16 v236, v237, v5
v_dot2c_f32_bf16 v240, v241, v5
v_dot2c_f32_bf16 v244, v245, v5
v_dot2c_f32_bf16 v232, v234, v6
v_dot2c_f32_bf16 v236, v238, v6
v_dot2c_f32_bf16 v240, v242, v6
v_dot2c_f32_bf16 v244, v246, v6
v_dot2c_f32_bf16 v232, v235, v7
v_dot2c_f32_bf16 v236, v239, v7
v_dot2c_f32_bf16 v240, v243, v7
v_dot2c_f32_bf16 v244, v247, v7
v_add_f32_dpp v233, v232, v232 row_ror:8 row_mask:0xf bank_mask:0x3
v_add_f32_dpp v237, v236, v236 row_ror:8 row_mask:0xf bank_mask:0x3
v_add_f32_dpp v233, v240, v240 row_ror:8 row_mask:0xf bank_mask:0xc
v_add_f32_dpp v237, v244, v244 row_ror:8 row_mask:0xf bank_mask:0xc
s_nop 0
v_add_f32_dpp v22, v233, v233 row_shl:4 row_mask:0xf bank_mask:0x5
v_add_f32_dpp v22, v237, v237 row_shr:4 row_mask:0xf bank_mask:0xa
s_nop 1
v_add_f32_dpp v22, v22, v22 quad_perm:[1,0,3,2] row_mask:0xf bank_mask:0xf
s_nop 1
v_add_f32_dpp v22, v22, v22 quad_perm:[2,3,0,1] row_mask:0xf bank_mask:0xf
v_cvt_pk_bf16_f32 v22, 0, v22
v_mul_f32 v22, s66, v22
v_cvt_pk_bf16_f32 v22, 0, v22
s_xor_b32 s64, s65, 70656
s_cmpk_gt_u32 s69, 90
s_waitcnt vmcnt(6)
s_cbranch_scc1 L_d_95
s_waitcnt vmcnt(5)
L_d_95:
buffer_load_dwordx4 v[80:83], v1, s[44:47], s64 offen nt
v_lshl_add_u32 v84, v0, 4, s70
ds_read_b128 v[88:91], v84 offset:0
ds_read_b128 v[92:95], v84 offset:1024
s_waitcnt lgkmcnt(0)
v_dot2_f32_bf16 v248, v248, v4, 0
v_dot2_f32_bf16 v252, v252, v4, 0
v_dot2_f32_bf16 v88, v88, v4, 0
v_dot2_f32_bf16 v92, v92, v4, 0
v_dot2c_f32_bf16 v248, v249, v5
v_dot2c_f32_bf16 v252, v253, v5
v_dot2c_f32_bf16 v88, v89, v5
v_dot2c_f32_bf16 v92, v93, v5
v_dot2c_f32_bf16 v248, v250, v6
v_dot2c_f32_bf16 v252, v254, v6
v_dot2c_f32_bf16 v88, v90, v6
v_dot2c_f32_bf16 v92, v94, v6
v_dot2c_f32_bf16 v248, v251, v7
v_dot2c_f32_bf16 v252, v255, v7
v_dot2c_f32_bf16 v88, v91, v7
v_dot2c_f32_bf16 v92, v95, v7
v_add_f32_dpp v249, v248, v248 row_ror:8 row_mask:0xf bank_mask:0x3
v_add_f32_dpp v253, v252, v252 row_ror:8 row_mask:0xf bank_mask:0x3
v_add_f32_dpp v249, v88, v88 row_ror:8 row_mask:0xf bank_mask:0xc
v_add_f32_dpp v253, v92, v92 row_ror:8 row_mask:0xf bank_mask:0xc
s_nop 0
v_add_f32_dpp v23, v249, v249 row_shl:4 row_mask:0xf bank_mask:0x5
v_add_f32_dpp v23, v253, v253 row_shr:4 row_mask:0xf bank_mask:0xa
s_nop 1
v_add_f32_dpp v23, v23, v23 quad_perm:[1,0,3,2] row_mask:0xf bank_mask:0xf
s_nop 1
v_add_f32_dpp v23, v23, v23 quad_perm:[2,3,0,1] row_mask:0xf bank_mask:0xf
v_cvt_pk_bf16_f32 v23, 0, v23
v_mul_f32 v23, s66, v23
v_cvt_pk_bf16_f32 v23, 0, v23
s_xor_b32 s64, s65, 103424
s_cmpk_gt_u32 s69, 91
s_waitcnt vmcnt(6)
s_cbranch_scc1 L_d_96
s_waitcnt vmcnt(5)
L_d_96:
buffer_load_dwordx4 v[96:99], v1, s[44:47], s64 offen nt
v_max3_f32 v2, v17, v8, v9
v_max3_f32 v2, v2, v10, v11
v_max3_f32 v2, v2, v12, v13
v_max3_f32 v2, v2, v14, v15
v_max3_f32 v2, v2, v16, v18
v_max3_f32 v2, v2, v19, v20
v_max3_f32 v2, v2, v21, v22
v_max_f32 v2, v2, v23
v_max_f32 v2, 0xff7fffff, v2
s_nop 1
v_max_f32_dpp v2, v2, v2 row_ror:4 row_mask:0xf bank_mask:0xf
s_nop 1
v_max_f32_dpp v2, v2, v2 row_ror:8 row_mask:0xf bank_mask:0xf
v_mov_b32 v3, v2
s_nop 1
v_permlane16_swap_b32 v2, v3
s_nop 1
v_max_f32 v2, v2, v3
v_mov_b32 v3, v2
s_nop 1
v_permlane32_swap_b32 v2, v3
s_nop 1
v_max_f32 v2, v2, v3
s_mov_b32 s67, 0x3fb8aa3b
v_sub_f32 v17, v17, v2
v_sub_f32 v8, v8, v2
v_sub_f32 v9, v9, v2
v_sub_f32 v10, v10, v2
v_sub_f32 v11, v11, v2
v_sub_f32 v12, v12, v2
v_sub_f32 v13, v13, v2
v_sub_f32 v14, v14, v2
v_sub_f32 v15, v15, v2
v_sub_f32 v16, v16, v2
v_sub_f32 v18, v18, v2
v_sub_f32 v19, v19, v2
v_sub_f32 v20, v20, v2
v_sub_f32 v21, v21, v2
v_sub_f32 v22, v22, v2
v_sub_f32 v23, v23, v2
v_mul_f32 v17, s67, v17
v_mul_f32 v8, s67, v8
v_mul_f32 v9, s67, v9
v_mul_f32 v10, s67, v10
v_mul_f32 v11, s67, v11
v_mul_f32 v12, s67, v12
v_mul_f32 v13, s67, v13
v_mul_f32 v14, s67, v14
v_mul_f32 v15, s67, v15
v_mul_f32 v16, s67, v16
v_mul_f32 v18, s67, v18
v_mul_f32 v19, s67, v19
v_mul_f32 v20, s67, v20
v_mul_f32 v21, s67, v21
v_mul_f32 v22, s67, v22
v_mul_f32 v23, s67, v23
s_xor_b32 s64, s65, 74752
s_cmpk_gt_u32 s69, 92
s_waitcnt vmcnt(6)
s_cbranch_scc1 L_d_97
s_waitcnt vmcnt(5)
L_d_97:
buffer_load_dwordx4 v[120:123], v1, s[44:47], s64 offen nt
v_exp_f32 v17, v17
v_exp_f32 v8, v8
v_exp_f32 v9, v9
v_exp_f32 v10, v10
v_exp_f32 v11, v11
v_exp_f32 v12, v12
v_exp_f32 v13, v13
v_exp_f32 v14, v14
v_exp_f32 v15, v15
v_exp_f32 v16, v16
v_exp_f32 v18, v18
v_exp_f32 v19, v19
v_exp_f32 v20, v20
v_exp_f32 v21, v21
v_exp_f32 v22, v22
v_exp_f32 v23, v23
v_add_f32 v3, v17, v8
v_add_f32 v3, v3, v9
v_add_f32 v3, v3, v10
v_add_f32 v3, v3, v11
v_add_f32 v3, v3, v12
v_add_f32 v3, v3, v13
v_add_f32 v3, v3, v14
v_add_f32 v3, v3, v15
v_add_f32 v3, v3, v16
v_add_f32 v3, v3, v18
v_add_f32 v3, v3, v19
v_add_f32 v3, v3, v20
v_add_f32 v3, v3, v21
v_add_f32 v3, v3, v22
v_add_f32 v3, v3, v23
s_nop 1
v_add_f32_dpp v3, v3, v3 row_ror:4 row_mask:0xf bank_mask:0xf
s_nop 1
v_add_f32_dpp v3, v3, v3 row_ror:8 row_mask:0xf bank_mask:0xf
v_mov_b32 v100, v3
s_nop 1
v_permlane16_swap_b32 v3, v100
s_nop 1
v_add_f32 v3, v3, v100
v_mov_b32 v100, v3
s_nop 1
v_permlane32_swap_b32 v3, v100
s_nop 1
v_add_f32 v3, v3, v100
v_min_u32 v3, -2, v3
s_lshl_b32 s68, s34, 3
v_mov_b32 v100, s68
ds_write_b64 v100, v[2:3] offset:256
v_and_b32 v101, 15, v0
v_lshrrev_b32 v102, 1, v101
v_and_b32 v101, 1, v0
v_lshlrev_b32 v101, 4, v101
v_mov_b32 v103, 0xffff
v_lshlrev_b32 v101, v101, v103
v_cmp_eq_u32 vcc, 0, v102
s_nop 1
v_cndmask_b32 v4, 0, v101, vcc
v_cmp_eq_u32 vcc, 1, v102
s_nop 1
v_cndmask_b32 v5, 0, v101, vcc
v_cmp_eq_u32 vcc, 2, v102
s_nop 1
v_cndmask_b32 v6, 0, v101, vcc
v_cmp_eq_u32 vcc, 3, v102
s_nop 1
v_cndmask_b32 v7, 0, v101, vcc
s_xor_b32 s64, s65, 107520
s_cmpk_gt_u32 s69, 93
s_waitcnt vmcnt(6)
s_cbranch_scc1 L_d_98
s_waitcnt vmcnt(5)
L_d_98:
buffer_load_dwordx4 v[124:127], v1, s[44:47], s64 offen nt
v_mov_b32 v100, 0
s_mov_b32 s75, 0
L_poll_99:
ds_read_b128 v[104:107], v100 offset:256
ds_read_b128 v[108:111], v100 offset:272
s_waitcnt lgkmcnt(0)
v_max3_u32 v101, v105, v107, v109
v_max_u32 v101, v101, v111
v_cmp_eq_u32 vcc, -1, v101
s_cbranch_vccz L_pollx_100
s_add_u32 s75, s75, 1
s_cmp_lt_u32 s75, 0x1000000
s_cbranch_scc1 L_poll_99
L_pollx_100:
v_max3_f32 v101, v104, v106, v108
v_max_f32 v101, v101, v110
v_sub_f32 v104, v104, v101
v_sub_f32 v106, v106, v101
v_sub_f32 v108, v108, v101
v_sub_f32 v110, v110, v101
v_sub_f32 v2, v2, v101
v_mul_f32 v104, s67, v104
v_mul_f32 v106, s67, v106
v_mul_f32 v108, s67, v108
v_mul_f32 v110, s67, v110
v_mul_f32 v2, s67, v2
v_exp_f32 v104, v104
v_exp_f32 v106, v106
v_exp_f32 v108, v108
v_exp_f32 v110, v110
v_exp_f32 v2, v2
v_mul_f32 v3, v104, v105
v_fmac_f32 v3, v106, v107
v_fmac_f32 v3, v108, v109
v_fmac_f32 v3, v110, v111
v_rcp_f32 v3, v3
s_nop 0
v_mul_f32 v2, v2, v3
v_mul_f32 v17, v17, v2
v_mul_f32 v8, v8, v2
v_mul_f32 v9, v9, v2
v_mul_f32 v10, v10, v2
v_mul_f32 v11, v11, v2
v_mul_f32 v12, v12, v2
v_mul_f32 v13, v13, v2
v_mul_f32 v14, v14, v2
v_mul_f32 v15, v15, v2
v_mul_f32 v16, v16, v2
v_mul_f32 v18, v18, v2
v_mul_f32 v19, v19, v2
v_mul_f32 v20, v20, v2
v_mul_f32 v21, v21, v2
v_mul_f32 v22, v22, v2
v_mul_f32 v23, v23, v2
v_cvt_pk_bf16_f32 v17, v17, v17
v_cvt_pk_bf16_f32 v8, v8, v8
v_cvt_pk_bf16_f32 v9, v9, v9
v_cvt_pk_bf16_f32 v10, v10, v10
v_cvt_pk_bf16_f32 v11, v11, v11
v_cvt_pk_bf16_f32 v12, v12, v12
v_cvt_pk_bf16_f32 v13, v13, v13
v_cvt_pk_bf16_f32 v14, v14, v14
v_cvt_pk_bf16_f32 v15, v15, v15
v_cvt_pk_bf16_f32 v16, v16, v16
v_cvt_pk_bf16_f32 v18, v18, v18
v_cvt_pk_bf16_f32 v19, v19, v19
v_cvt_pk_bf16_f32 v20, v20, v20
v_cvt_pk_bf16_f32 v21, v21, v21
v_cvt_pk_bf16_f32 v22, v22, v22
v_cvt_pk_bf16_f32 v23, v23, v23
s_nop 1
s_cmp_eq_u32 s34, 2
s_cbranch_scc0 L_w_102
v_mov_b32 v60, 30
s_mov_b64 exec, 1
buffer_store_dword v60, off, s[36:39], s63 offset:0
s_mov_b64 exec, -1
L_w_102:
s_xor_b32 s64, s65, 78848
s_cmpk_gt_u32 s69, 94
s_waitcnt vmcnt(6)
s_cbranch_scc1 L_d_101
s_waitcnt vmcnt(5)
L_d_101:
buffer_load_dwordx4 v[128:131], v1, s[44:47], s64 offen nt
ds_read_b128 v[132:135], v84 offset:2048
ds_read_b128 v[136:139], v84 offset:3072
ds_read_b128 v[140:143], v84 offset:4096
ds_read_b128 v[144:147], v84 offset:5120
ds_read_b128 v[148:151], v84 offset:6144
ds_read_b128 v[152:155], v84 offset:7168
ds_read_b128 v[156:159], v84 offset:8192
ds_read_b128 v[160:163], v84 offset:9216
s_waitcnt lgkmcnt(0)
v_and_b32_dpp v104, v17, v4 row_newbcast:0 row_mask:0xf bank_mask:0xf
v_and_b32_dpp v105, v17, v5 row_newbcast:0 row_mask:0xf bank_mask:0xf
v_and_b32_dpp v106, v17, v6 row_newbcast:0 row_mask:0xf bank_mask:0xf
v_and_b32_dpp v107, v17, v7 row_newbcast:0 row_mask:0xf bank_mask:0xf
v_and_b32_dpp v108, v17, v4 row_newbcast:4 row_mask:0xf bank_mask:0xf
v_and_b32_dpp v109, v17, v5 row_newbcast:4 row_mask:0xf bank_mask:0xf
v_and_b32_dpp v110, v17, v6 row_newbcast:4 row_mask:0xf bank_mask:0xf
v_and_b32_dpp v111, v17, v7 row_newbcast:4 row_mask:0xf bank_mask:0xf
v_mfma_f32_16x16x32_bf16 v[112:115], v[104:107], v[132:135], 0
v_and_b32_dpp v104, v15, v4 row_newbcast:0 row_mask:0xf bank_mask:0xf
v_and_b32_dpp v105, v15, v5 row_newbcast:0 row_mask:0xf bank_mask:0xf
v_and_b32_dpp v106, v15, v6 row_newbcast:0 row_mask:0xf bank_mask:0xf
v_and_b32_dpp v107, v15, v7 row_newbcast:0 row_mask:0xf bank_mask:0xf
v_mfma_f32_16x16x32_bf16 v[112:115], v[108:111], v[136:139], v[112:115]
v_and_b32_dpp v108, v15, v4 row_newbcast:4 row_mask:0xf bank_mask:0xf
v_and_b32_dpp v109, v15, v5 row_newbcast:4 row_mask:0xf bank_mask:0xf
v_and_b32_dpp v110, v15, v6 row_newbcast:4 row_mask:0xf bank_mask:0xf
v_and_b32_dpp v111, v15, v7 row_newbcast:4 row_mask:0xf bank_mask:0xf
v_mfma_f32_16x16x32_bf16 v[112:115], v[104:107], v[140:143], v[112:115]
s_xor_b32 s64, s65, 111616
s_cmpk_gt_u32 s69, 95
s_waitcnt vmcnt(6)
s_cbranch_scc1 L_d_103
s_waitcnt vmcnt(5)
L_d_103:
buffer_load_dwordx4 v[164:167], v1, s[44:47], s64 offen nt
v_and_b32_dpp v104, v17, v4 row_newbcast:8 row_mask:0xf bank_mask:0xf
v_and_b32_dpp v105, v17, v5 row_newbcast:8 row_mask:0xf bank_mask:0xf
v_and_b32_dpp v106, v17, v6 row_newbcast:8 row_mask:0xf bank_mask:0xf
v_and_b32_dpp v107, v17, v7 row_newbcast:8 row_mask:0xf bank_mask:0xf
v_mfma_f32_16x16x32_bf16 v[112:115], v[108:111], v[144:147], v[112:115]
v_and_b32_dpp v108, v17, v4 row_newbcast:12 row_mask:0xf bank_mask:0xf
v_and_b32_dpp v109, v17, v5 row_newbcast:12 row_mask:0xf bank_mask:0xf
v_and_b32_dpp v110, v17, v6 row_newbcast:12 row_mask:0xf bank_mask:0xf
v_and_b32_dpp v111, v17, v7 row_newbcast:12 row_mask:0xf bank_mask:0xf
v_mfma_f32_16x16x32_bf16 v[112:115], v[104:107], v[148:151], v[112:115]
v_and_b32_dpp v104, v15, v4 row_newbcast:8 row_mask:0xf bank_mask:0xf
v_and_b32_dpp v105, v15, v5 row_newbcast:8 row_mask:0xf bank_mask:0xf
v_and_b32_dpp v106, v15, v6 row_newbcast:8 row_mask:0xf bank_mask:0xf
v_and_b32_dpp v107, v15, v7 row_newbcast:8 row_mask:0xf bank_mask:0xf
v_mfma_f32_16x16x32_bf16 v[112:115], v[108:111], v[152:155], v[112:115]
s_xor_b32 s64, s65, 131072
s_cmpk_gt_u32 s69, 96
s_waitcnt vmcnt(6)
s_cbranch_scc1 L_d_104
s_waitcnt vmcnt(5)
L_d_104:
buffer_load_dwordx4 v[168:171], v1, s[44:47], s64 offen nt
v_and_b32_dpp v108, v15, v4 row_newbcast:12 row_mask:0xf bank_mask:0xf
v_and_b32_dpp v109, v15, v5 row_newbcast:12 row_mask:0xf bank_mask:0xf
v_and_b32_dpp v110, v15, v6 row_newbcast:12 row_mask:0xf bank_mask:0xf
v_and_b32_dpp v111, v15, v7 row_newbcast:12 row_mask:0xf bank_mask:0xf
v_mfma_f32_16x16x32_bf16 v[112:115], v[104:107], v[156:159], v[112:115]
v_and_b32_dpp v104, v9, v4 row_newbcast:0 row_mask:0xf bank_mask:0xf
v_and_b32_dpp v105, v9, v5 row_newbcast:0 row_mask:0xf bank_mask:0xf
v_and_b32_dpp v106, v9, v6 row_newbcast:0 row_mask:0xf bank_mask:0xf
v_and_b32_dpp v107, v9, v7 row_newbcast:0 row_mask:0xf bank_mask:0xf
v_mfma_f32_16x16x32_bf16 v[112:115], v[108:111], v[160:163], v[112:115]
ds_read_b128 v[172:175], v84 offset:10240
ds_read_b128 v[176:179], v84 offset:11264
ds_read_b128 v[180:183], v84 offset:12288
ds_read_b128 v[184:187], v84 offset:13312
ds_read_b128 v[188:191], v84 offset:14336
s_waitcnt lgkmcnt(0)
v_and_b32_dpp v108, v9, v4 row_newbcast:4 row_mask:0xf bank_mask:0xf
v_and_b32_dpp v109, v9, v5 row_newbcast:4 row_mask:0xf bank_mask:0xf
v_and_b32_dpp v110, v9, v6 row_newbcast:4 row_mask:0xf bank_mask:0xf
v_and_b32_dpp v111, v9, v7 row_newbcast:4 row_mask:0xf bank_mask:0xf
v_mfma_f32_16x16x32_bf16 v[112:115], v[104:107], v[172:175], v[112:115]
s_xor_b32 s64, s65, 163840
s_cmpk_gt_u32 s69, 97
s_waitcnt vmcnt(6)
s_cbranch_scc1 L_d_105
s_waitcnt vmcnt(5)
L_d_105:
buffer_load_dwordx4 v[192:195], v1, s[44:47], s64 offen nt
v_and_b32_dpp v104, v18, v4 row_newbcast:0 row_mask:0xf bank_mask:0xf
v_and_b32_dpp v105, v18, v5 row_newbcast:0 row_mask:0xf bank_mask:0xf
v_and_b32_dpp v106, v18, v6 row_newbcast:0 row_mask:0xf bank_mask:0xf
v_and_b32_dpp v107, v18, v7 row_newbcast:0 row_mask:0xf bank_mask:0xf
v_mfma_f32_16x16x32_bf16 v[112:115], v[108:111], v[176:179], v[112:115]
v_and_b32_dpp v108, v18, v4 row_newbcast:4 row_mask:0xf bank_mask:0xf
v_and_b32_dpp v109, v18, v5 row_newbcast:4 row_mask:0xf bank_mask:0xf
v_and_b32_dpp v110, v18, v6 row_newbcast:4 row_mask:0xf bank_mask:0xf
v_and_b32_dpp v111, v18, v7 row_newbcast:4 row_mask:0xf bank_mask:0xf
v_mfma_f32_16x16x32_bf16 v[112:115], v[104:107], v[180:183], v[112:115]
v_and_b32_dpp v104, v9, v4 row_newbcast:8 row_mask:0xf bank_mask:0xf
v_and_b32_dpp v105, v9, v5 row_newbcast:8 row_mask:0xf bank_mask:0xf
v_and_b32_dpp v106, v9, v6 row_newbcast:8 row_mask:0xf bank_mask:0xf
v_and_b32_dpp v107, v9, v7 row_newbcast:8 row_mask:0xf bank_mask:0xf
v_mfma_f32_16x16x32_bf16 v[112:115], v[108:111], v[184:187], v[112:115]
s_xor_b32 s64, s65, 135168
s_cmpk_gt_u32 s69, 98
s_waitcnt vmcnt(6)
s_cbranch_scc1 L_d_106
s_waitcnt vmcnt(5)
L_d_106:
buffer_load_dwordx4 v[196:199], v1, s[44:47], s64 offen nt
v_and_b32_dpp v108, v9, v4 row_newbcast:12 row_mask:0xf bank_mask:0xf
v_and_b32_dpp v109, v9, v5 row_newbcast:12 row_mask:0xf bank_mask:0xf
v_and_b32_dpp v110, v9, v6 row_newbcast:12 row_mask:0xf bank_mask:0xf
v_and_b32_dpp v111, v9, v7 row_newbcast:12 row_mask:0xf bank_mask:0xf
v_mfma_f32_16x16x32_bf16 v[112:115], v[104:107], v[188:191], v[112:115]
v_and_b32_dpp v104, v18, v4 row_newbcast:8 row_mask:0xf bank_mask:0xf
v_and_b32_dpp v105, v18, v5 row_newbcast:8 row_mask:0xf bank_mask:0xf
v_and_b32_dpp v106, v18, v6 row_newbcast:8 row_mask:0xf bank_mask:0xf
v_and_b32_dpp v107, v18, v7 row_newbcast:8 row_mask:0xf bank_mask:0xf
v_mfma_f32_16x16x32_bf16 v[112:115], v[108:111], v[24:27], v[112:115]
v_and_b32_dpp v108, v18, v4 row_newbcast:12 row_mask:0xf bank_mask:0xf
v_and_b32_dpp v109, v18, v5 row_newbcast:12 row_mask:0xf bank_mask:0xf
v_and_b32_dpp v110, v18, v6 row_newbcast:12 row_mask:0xf bank_mask:0xf
v_and_b32_dpp v111, v18, v7 row_newbcast:12 row_mask:0xf bank_mask:0xf
v_mfma_f32_16x16x32_bf16 v[112:115], v[104:107], v[28:31], v[112:115]
s_xor_b32 s64, s65, 167936
s_cmpk_gt_u32 s69, 99
s_waitcnt vmcnt(6)
s_cbranch_scc1 L_d_107
s_waitcnt vmcnt(5)
L_d_107:
buffer_load_dwordx4 v[200:203], v1, s[44:47], s64 offen nt
v_and_b32_dpp v104, v8, v4 row_newbcast:0 row_mask:0xf bank_mask:0xf
v_and_b32_dpp v105, v8, v5 row_newbcast:0 row_mask:0xf bank_mask:0xf
v_and_b32_dpp v106, v8, v6 row_newbcast:0 row_mask:0xf bank_mask:0xf
v_and_b32_dpp v107, v8, v7 row_newbcast:0 row_mask:0xf bank_mask:0xf
v_mfma_f32_16x16x32_bf16 v[112:115], v[108:111], v[32:35], v[112:115]
v_and_b32_dpp v108, v8, v4 row_newbcast:4 row_mask:0xf bank_mask:0xf
v_and_b32_dpp v109, v8, v5 row_newbcast:4 row_mask:0xf bank_mask:0xf
v_and_b32_dpp v110, v8, v6 row_newbcast:4 row_mask:0xf bank_mask:0xf
v_and_b32_dpp v111, v8, v7 row_newbcast:4 row_mask:0xf bank_mask:0xf
v_mfma_f32_16x16x32_bf16 v[112:115], v[104:107], v[36:39], v[112:115]
v_and_b32_dpp v104, v16, v4 row_newbcast:0 row_mask:0xf bank_mask:0xf
v_and_b32_dpp v105, v16, v5 row_newbcast:0 row_mask:0xf bank_mask:0xf
v_and_b32_dpp v106, v16, v6 row_newbcast:0 row_mask:0xf bank_mask:0xf
v_and_b32_dpp v107, v16, v7 row_newbcast:0 row_mask:0xf bank_mask:0xf
v_mfma_f32_16x16x32_bf16 v[112:115], v[108:111], v[40:43], v[112:115]
s_xor_b32 s64, s65, 139264
s_cmpk_gt_u32 s69, 100
s_waitcnt vmcnt(6)
s_cbranch_scc1 L_d_108
s_waitcnt vmcnt(5)
L_d_108:
buffer_load_dwordx4 v[204:207], v1, s[44:47], s64 offen nt
v_and_b32_dpp v108, v16, v4 row_newbcast:4 row_mask:0xf bank_mask:0xf
v_and_b32_dpp v109, v16, v5 row_newbcast:4 row_mask:0xf bank_mask:0xf
v_and_b32_dpp v110, v16, v6 row_newbcast:4 row_mask:0xf bank_mask:0xf
v_and_b32_dpp v111, v16, v7 row_newbcast:4 row_mask:0xf bank_mask:0xf
v_mfma_f32_16x16x32_bf16 v[112:115], v[104:107], v[44:47], v[112:115]
v_and_b32_dpp v104, v8, v4 row_newbcast:8 row_mask:0xf bank_mask:0xf
v_and_b32_dpp v105, v8, v5 row_newbcast:8 row_mask:0xf bank_mask:0xf
v_and_b32_dpp v106, v8, v6 row_newbcast:8 row_mask:0xf bank_mask:0xf
v_and_b32_dpp v107, v8, v7 row_newbcast:8 row_mask:0xf bank_mask:0xf
v_mfma_f32_16x16x32_bf16 v[112:115], v[108:111], v[48:51], v[112:115]
v_and_b32_dpp v108, v8, v4 row_newbcast:12 row_mask:0xf bank_mask:0xf
v_and_b32_dpp v109, v8, v5 row_newbcast:12 row_mask:0xf bank_mask:0xf
v_and_b32_dpp v110, v8, v6 row_newbcast:12 row_mask:0xf bank_mask:0xf
v_and_b32_dpp v111, v8, v7 row_newbcast:12 row_mask:0xf bank_mask:0xf
v_mfma_f32_16x16x32_bf16 v[112:115], v[104:107], v[52:55], v[112:115]
s_xor_b32 s64, s65, 172032
s_cmpk_gt_u32 s69, 101
s_waitcnt vmcnt(6)
s_cbranch_scc1 L_d_109
s_waitcnt vmcnt(5)
L_d_109:
buffer_load_dwordx4 v[208:211], v1, s[44:47], s64 offen nt
v_and_b32_dpp v104, v16, v4 row_newbcast:8 row_mask:0xf bank_mask:0xf
v_and_b32_dpp v105, v16, v5 row_newbcast:8 row_mask:0xf bank_mask:0xf
v_and_b32_dpp v106, v16, v6 row_newbcast:8 row_mask:0xf bank_mask:0xf
v_and_b32_dpp v107, v16, v7 row_newbcast:8 row_mask:0xf bank_mask:0xf
v_mfma_f32_16x16x32_bf16 v[112:115], v[108:111], v[56:59], v[112:115]
v_and_b32_dpp v108, v16, v4 row_newbcast:12 row_mask:0xf bank_mask:0xf
v_and_b32_dpp v109, v16, v5 row_newbcast:12 row_mask:0xf bank_mask:0xf
v_and_b32_dpp v110, v16, v6 row_newbcast:12 row_mask:0xf bank_mask:0xf
v_and_b32_dpp v111, v16, v7 row_newbcast:12 row_mask:0xf bank_mask:0xf
v_mfma_f32_16x16x32_bf16 v[112:115], v[104:107], v[64:67], v[112:115]
v_and_b32_dpp v104, v10, v4 row_newbcast:0 row_mask:0xf bank_mask:0xf
v_and_b32_dpp v105, v10, v5 row_newbcast:0 row_mask:0xf bank_mask:0xf
v_and_b32_dpp v106, v10, v6 row_newbcast:0 row_mask:0xf bank_mask:0xf
v_and_b32_dpp v107, v10, v7 row_newbcast:0 row_mask:0xf bank_mask:0xf
v_mfma_f32_16x16x32_bf16 v[112:115], v[108:111], v[68:71], v[112:115]
s_cmp_eq_u32 s34, 3
s_cbranch_scc0 L_w_111
v_mov_b32 v60, 38
s_mov_b64 exec, 1
buffer_store_dword v60, off, s[36:39], s63 offset:0
s_mov_b64 exec, -1
L_w_111:
s_xor_b32 s64, s65, 143360
s_cmpk_gt_u32 s69, 102
s_waitcnt vmcnt(6)
s_cbranch_scc1 L_d_110
s_waitcnt vmcnt(5)
L_d_110:
buffer_load_dwordx4 v[212:215], v1, s[44:47], s64 offen nt
v_and_b32_dpp v108, v10, v4 row_newbcast:4 row_mask:0xf bank_mask:0xf
v_and_b32_dpp v109, v10, v5 row_newbcast:4 row_mask:0xf bank_mask:0xf
v_and_b32_dpp v110, v10, v6 row_newbcast:4 row_mask:0xf bank_mask:0xf
v_and_b32_dpp v111, v10, v7 row_newbcast:4 row_mask:0xf bank_mask:0xf
v_mfma_f32_16x16x32_bf16 v[112:115], v[104:107], v[72:75], v[112:115]
v_and_b32_dpp v104, v19, v4 row_newbcast:0 row_mask:0xf bank_mask:0xf
v_and_b32_dpp v105, v19, v5 row_newbcast:0 row_mask:0xf bank_mask:0xf
v_and_b32_dpp v106, v19, v6 row_newbcast:0 row_mask:0xf bank_mask:0xf
v_and_b32_dpp v107, v19, v7 row_newbcast:0 row_mask:0xf bank_mask:0xf
v_mfma_f32_16x16x32_bf16 v[112:115], v[108:111], v[76:79], v[112:115]
v_and_b32_dpp v108, v19, v4 row_newbcast:4 row_mask:0xf bank_mask:0xf
v_and_b32_dpp v109, v19, v5 row_newbcast:4 row_mask:0xf bank_mask:0xf
v_and_b32_dpp v110, v19, v6 row_newbcast:4 row_mask:0xf bank_mask:0xf
v_and_b32_dpp v111, v19, v7 row_newbcast:4 row_mask:0xf bank_mask:0xf
v_mfma_f32_16x16x32_bf16 v[112:115], v[104:107], v[80:83], v[112:115]
s_xor_b32 s64, s65, 176128
s_cmpk_gt_u32 s69, 103
s_waitcnt vmcnt(6)
s_cbranch_scc1 L_d_112
s_waitcnt vmcnt(5)
L_d_112:
buffer_load_dwordx4 v[216:219], v1, s[44:47], s64 offen nt
v_and_b32_dpp v104, v10, v4 row_newbcast:8 row_mask:0xf bank_mask:0xf
v_and_b32_dpp v105, v10, v5 row_newbcast:8 row_mask:0xf bank_mask:0xf
v_and_b32_dpp v106, v10, v6 row_newbcast:8 row_mask:0xf bank_mask:0xf
v_and_b32_dpp v107, v10, v7 row_newbcast:8 row_mask:0xf bank_mask:0xf
v_mfma_f32_16x16x32_bf16 v[112:115], v[108:111], v[96:99], v[112:115]
v_and_b32_dpp v108, v10, v4 row_newbcast:12 row_mask:0xf bank_mask:0xf
v_and_b32_dpp v109, v10, v5 row_newbcast:12 row_mask:0xf bank_mask:0xf
v_and_b32_dpp v110, v10, v6 row_newbcast:12 row_mask:0xf bank_mask:0xf
v_and_b32_dpp v111, v10, v7 row_newbcast:12 row_mask:0xf bank_mask:0xf
v_mfma_f32_16x16x32_bf16 v[112:115], v[104:107], v[120:123], v[112:115]
v_and_b32_dpp v104, v19, v4 row_newbcast:8 row_mask:0xf bank_mask:0xf
v_and_b32_dpp v105, v19, v5 row_newbcast:8 row_mask:0xf bank_mask:0xf
v_and_b32_dpp v106, v19, v6 row_newbcast:8 row_mask:0xf bank_mask:0xf
v_and_b32_dpp v107, v19, v7 row_newbcast:8 row_mask:0xf bank_mask:0xf
v_mfma_f32_16x16x32_bf16 v[112:115], v[108:111], v[124:127], v[112:115]
s_xor_b32 s64, s65, 196608
s_cmpk_gt_u32 s69, 104
s_waitcnt vmcnt(6)
s_cbranch_scc1 L_d_113
s_waitcnt vmcnt(5)
L_d_113:
buffer_load_dwordx4 v[220:223], v1, s[44:47], s64 offen nt
v_and_b32_dpp v108, v19, v4 row_newbcast:12 row_mask:0xf bank_mask:0xf
v_and_b32_dpp v109, v19, v5 row_newbcast:12 row_mask:0xf bank_mask:0xf
v_and_b32_dpp v110, v19, v6 row_newbcast:12 row_mask:0xf bank_mask:0xf
v_and_b32_dpp v111, v19, v7 row_newbcast:12 row_mask:0xf bank_mask:0xf
v_mfma_f32_16x16x32_bf16 v[112:115], v[104:107], v[128:131], v[112:115]
v_and_b32_dpp v104, v11, v4 row_newbcast:0 row_mask:0xf bank_mask:0xf
v_and_b32_dpp v105, v11, v5 row_newbcast:0 row_mask:0xf bank_mask:0xf
v_and_b32_dpp v106, v11, v6 row_newbcast:0 row_mask:0xf bank_mask:0xf
v_and_b32_dpp v107, v11, v7 row_newbcast:0 row_mask:0xf bank_mask:0xf
v_mfma_f32_16x16x32_bf16 v[112:115], v[108:111], v[164:167], v[112:115]
v_and_b32_dpp v108, v11, v4 row_newbcast:4 row_mask:0xf bank_mask:0xf
v_and_b32_dpp v109, v11, v5 row_newbcast:4 row_mask:0xf bank_mask:0xf
v_and_b32_dpp v110, v11, v6 row_newbcast:4 row_mask:0xf bank_mask:0xf
v_and_b32_dpp v111, v11, v7 row_newbcast:4 row_mask:0xf bank_mask:0xf
v_mfma_f32_16x16x32_bf16 v[112:115], v[104:107], v[168:171], v[112:115]
s_xor_b32 s64, s65, 229376
s_cmpk_gt_u32 s69, 105
s_waitcnt vmcnt(6)
s_cbranch_scc1 L_d_114
s_waitcnt vmcnt(5)
L_d_114:
buffer_load_dwordx4 v[224:227], v1, s[44:47], s64 offen nt
v_and_b32_dpp v104, v20, v4 row_newbcast:0 row_mask:0xf bank_mask:0xf
v_and_b32_dpp v105, v20, v5 row_newbcast:0 row_mask:0xf bank_mask:0xf
v_and_b32_dpp v106, v20, v6 row_newbcast:0 row_mask:0xf bank_mask:0xf
v_and_b32_dpp v107, v20, v7 row_newbcast:0 row_mask:0xf bank_mask:0xf
v_mfma_f32_16x16x32_bf16 v[112:115], v[108:111], v[192:195], v[112:115]
v_and_b32_dpp v108, v20, v4 row_newbcast:4 row_mask:0xf bank_mask:0xf
v_and_b32_dpp v109, v20, v5 row_newbcast:4 row_mask:0xf bank_mask:0xf
v_and_b32_dpp v110, v20, v6 row_newbcast:4 row_mask:0xf bank_mask:0xf
v_and_b32_dpp v111, v20, v7 row_newbcast:4 row_mask:0xf bank_mask:0xf
v_mfma_f32_16x16x32_bf16 v[112:115], v[104:107], v[196:199], v[112:115]
s_xor_b32 s64, s65, 200704
s_cmpk_gt_u32 s69, 106
s_waitcnt vmcnt(6)
s_cbranch_scc1 L_d_115
s_waitcnt vmcnt(5)
L_d_115:
buffer_load_dwordx4 v[228:231], v1, s[44:47], s64 offen nt
v_and_b32_dpp v104, v11, v4 row_newbcast:8 row_mask:0xf bank_mask:0xf
v_and_b32_dpp v105, v11, v5 row_newbcast:8 row_mask:0xf bank_mask:0xf
v_and_b32_dpp v106, v11, v6 row_newbcast:8 row_mask:0xf bank_mask:0xf
v_and_b32_dpp v107, v11, v7 row_newbcast:8 row_mask:0xf bank_mask:0xf
v_mfma_f32_16x16x32_bf16 v[112:115], v[108:111], v[200:203], v[112:115]
s_xor_b32 s64, s65, 233472
s_cmpk_gt_u32 s69, 107
s_waitcnt vmcnt(6)
s_cbranch_scc1 L_d_116
s_waitcnt vmcnt(5)
L_d_116:
buffer_load_dwordx4 v[232:235], v1, s[44:47], s64 offen nt
v_and_b32_dpp v108, v11, v4 row_newbcast:12 row_mask:0xf bank_mask:0xf
v_and_b32_dpp v109, v11, v5 row_newbcast:12 row_mask:0xf bank_mask:0xf
v_and_b32_dpp v110, v11, v6 row_newbcast:12 row_mask:0xf bank_mask:0xf
v_and_b32_dpp v111, v11, v7 row_newbcast:12 row_mask:0xf bank_mask:0xf
v_mfma_f32_16x16x32_bf16 v[112:115], v[104:107], v[204:207], v[112:115]
s_xor_b32 s64, s65, 204800
s_cmpk_gt_u32 s69, 108
s_waitcnt vmcnt(6)
s_cbranch_scc1 L_d_117
s_waitcnt vmcnt(5)
L_d_117:
buffer_load_dwordx4 v[236:239], v1, s[44:47], s64 offen nt
v_and_b32_dpp v104, v20, v4 row_newbcast:8 row_mask:0xf bank_mask:0xf
v_and_b32_dpp v105, v20, v5 row_newbcast:8 row_mask:0xf bank_mask:0xf
v_and_b32_dpp v106, v20, v6 row_newbcast:8 row_mask:0xf bank_mask:0xf
v_and_b32_dpp v107, v20, v7 row_newbcast:8 row_mask:0xf bank_mask:0xf
v_mfma_f32_16x16x32_bf16 v[112:115], v[108:111], v[208:211], v[112:115]
s_xor_b32 s64, s65, 237568
s_cmpk_gt_u32 s69, 109
s_waitcnt vmcnt(6)
s_cbranch_scc1 L_d_118
s_waitcnt vmcnt(5)
L_d_118:
buffer_load_dwordx4 v[240:243], v1, s[44:47], s64 offen nt
v_and_b32_dpp v108, v20, v4 row_newbcast:12 row_mask:0xf bank_mask:0xf
v_and_b32_dpp v109, v20, v5 row_newbcast:12 row_mask:0xf bank_mask:0xf
v_and_b32_dpp v110, v20, v6 row_newbcast:12 row_mask:0xf bank_mask:0xf
v_and_b32_dpp v111, v20, v7 row_newbcast:12 row_mask:0xf bank_mask:0xf
v_mfma_f32_16x16x32_bf16 v[112:115], v[104:107], v[212:215], v[112:115]
s_cmp_eq_u32 s34, 0
s_cbranch_scc0 L_w_120
v_mov_b32 v60, 46
s_mov_b64 exec, 1
buffer_store_dword v60, off, s[36:39], s63 offset:0
s_mov_b64 exec, -1
L_w_120:
s_xor_b32 s64, s65, 208896
s_cmpk_gt_u32 s69, 110
s_waitcnt vmcnt(6)
s_cbranch_scc1 L_d_119
s_waitcnt vmcnt(5)
L_d_119:
buffer_load_dwordx4 v[244:247], v1, s[44:47], s64 offen nt
v_and_b32_dpp v104, v13, v4 row_newbcast:0 row_mask:0xf bank_mask:0xf
v_and_b32_dpp v105, v13, v5 row_newbcast:0 row_mask:0xf bank_mask:0xf
v_and_b32_dpp v106, v13, v6 row_newbcast:0 row_mask:0xf bank_mask:0xf
v_and_b32_dpp v107, v13, v7 row_newbcast:0 row_mask:0xf bank_mask:0xf
v_mfma_f32_16x16x32_bf16 v[112:115], v[108:111], v[216:219], v[112:115]
s_xor_b32 s64, s65, 241664
s_cmpk_gt_u32 s69, 111
s_waitcnt vmcnt(6)
s_cbranch_scc1 L_d_121
s_waitcnt vmcnt(5)
L_d_121:
buffer_load_dwordx4 v[248:251], v1, s[44:47], s64 offen nt
v_and_b32_dpp v108, v13, v4 row_newbcast:4 row_mask:0xf bank_mask:0xf
v_and_b32_dpp v109, v13, v5 row_newbcast:4 row_mask:0xf bank_mask:0xf
v_and_b32_dpp v110, v13, v6 row_newbcast:4 row_mask:0xf bank_mask:0xf
v_and_b32_dpp v111, v13, v7 row_newbcast:4 row_mask:0xf bank_mask:0xf
v_mfma_f32_16x16x32_bf16 v[112:115], v[104:107], v[220:223], v[112:115]
s_xor_b32 s64, s65, 132096
s_waitcnt vmcnt(5)
buffer_load_dwordx4 v[252:255], v1, s[44:47], s64 offen nt
v_and_b32_dpp v104, v22, v4 row_newbcast:0 row_mask:0xf bank_mask:0xf
v_and_b32_dpp v105, v22, v5 row_newbcast:0 row_mask:0xf bank_mask:0xf
v_and_b32_dpp v106, v22, v6 row_newbcast:0 row_mask:0xf bank_mask:0xf
v_and_b32_dpp v107, v22, v7 row_newbcast:0 row_mask:0xf bank_mask:0xf
v_mfma_f32_16x16x32_bf16 v[112:115], v[108:111], v[224:227], v[112:115]
v_and_b32_dpp v108, v22, v4 row_newbcast:4 row_mask:0xf bank_mask:0xf
v_and_b32_dpp v109, v22, v5 row_newbcast:4 row_mask:0xf bank_mask:0xf
v_and_b32_dpp v110, v22, v6 row_newbcast:4 row_mask:0xf bank_mask:0xf
v_and_b32_dpp v111, v22, v7 row_newbcast:4 row_mask:0xf bank_mask:0xf
v_mfma_f32_16x16x32_bf16 v[112:115], v[104:107], v[228:231], v[112:115]
s_xor_b32 s64, s65, 164864
s_waitcnt vmcnt(5)
buffer_load_dwordx4 v[88:91], v1, s[44:47], s64 offen nt
v_and_b32_dpp v104, v13, v4 row_newbcast:8 row_mask:0xf bank_mask:0xf
v_and_b32_dpp v105, v13, v5 row_newbcast:8 row_mask:0xf bank_mask:0xf
v_and_b32_dpp v106, v13, v6 row_newbcast:8 row_mask:0xf bank_mask:0xf
v_and_b32_dpp v107, v13, v7 row_newbcast:8 row_mask:0xf bank_mask:0xf
v_mfma_f32_16x16x32_bf16 v[112:115], v[108:111], v[232:235], v[112:115]
s_xor_b32 s64, s65, 136192
s_waitcnt vmcnt(5)
buffer_load_dwordx4 v[92:95], v1, s[44:47], s64 offen nt
v_and_b32_dpp v108, v13, v4 row_newbcast:12 row_mask:0xf bank_mask:0xf
v_and_b32_dpp v109, v13, v5 row_newbcast:12 row_mask:0xf bank_mask:0xf
v_and_b32_dpp v110, v13, v6 row_newbcast:12 row_mask:0xf bank_mask:0xf
v_and_b32_dpp v111, v13, v7 row_newbcast:12 row_mask:0xf bank_mask:0xf
v_mfma_f32_16x16x32_bf16 v[112:115], v[104:107], v[236:239], v[112:115]
s_xor_b32 s64, s65, 168960
s_waitcnt vmcnt(5)
buffer_load_dwordx4 v[132:135], v1, s[44:47], s64 offen nt
v_and_b32_dpp v104, v22, v4 row_newbcast:8 row_mask:0xf bank_mask:0xf
v_and_b32_dpp v105, v22, v5 row_newbcast:8 row_mask:0xf bank_mask:0xf
v_and_b32_dpp v106, v22, v6 row_newbcast:8 row_mask:0xf bank_mask:0xf
v_and_b32_dpp v107, v22, v7 row_newbcast:8 row_mask:0xf bank_mask:0xf
v_mfma_f32_16x16x32_bf16 v[112:115], v[108:111], v[240:243], v[112:115]
s_xor_b32 s64, s65, 140288
s_waitcnt vmcnt(5)
buffer_load_dwordx4 v[136:139], v1, s[44:47], s64 offen nt
v_and_b32_dpp v108, v22, v4 row_newbcast:12 row_mask:0xf bank_mask:0xf
v_and_b32_dpp v109, v22, v5 row_newbcast:12 row_mask:0xf bank_mask:0xf
v_and_b32_dpp v110, v22, v6 row_newbcast:12 row_mask:0xf bank_mask:0xf
v_and_b32_dpp v111, v22, v7 row_newbcast:12 row_mask:0xf bank_mask:0xf
v_mfma_f32_16x16x32_bf16 v[112:115], v[104:107], v[244:247], v[112:115]
s_xor_b32 s64, s65, 173056
s_waitcnt vmcnt(5)
buffer_load_dwordx4 v[140:143], v1, s[44:47], s64 offen nt
v_and_b32_dpp v104, v12, v4 row_newbcast:0 row_mask:0xf bank_mask:0xf
v_and_b32_dpp v105, v12, v5 row_newbcast:0 row_mask:0xf bank_mask:0xf
v_and_b32_dpp v106, v12, v6 row_newbcast:0 row_mask:0xf bank_mask:0xf
v_and_b32_dpp v107, v12, v7 row_newbcast:0 row_mask:0xf bank_mask:0xf
v_mfma_f32_16x16x32_bf16 v[112:115], v[108:111], v[248:251], v[112:115]
s_cmp_eq_u32 s34, 1
s_cbranch_scc0 L_w_122
v_mov_b32 v60, 54
s_mov_b64 exec, 1
buffer_store_dword v60, off, s[36:39], s63 offset:0
s_mov_b64 exec, -1
L_w_122:
s_xor_b32 s64, s65, 144384
s_waitcnt vmcnt(5)
buffer_load_dwordx4 v[144:147], v1, s[44:47], s64 offen nt
v_and_b32_dpp v108, v12, v4 row_newbcast:4 row_mask:0xf bank_mask:0xf
v_and_b32_dpp v109, v12, v5 row_newbcast:4 row_mask:0xf bank_mask:0xf
v_and_b32_dpp v110, v12, v6 row_newbcast:4 row_mask:0xf bank_mask:0xf
v_and_b32_dpp v111, v12, v7 row_newbcast:4 row_mask:0xf bank_mask:0xf
v_mfma_f32_16x16x32_bf16 v[112:115], v[104:107], v[252:255], v[112:115]
s_xor_b32 s64, s65, 177152
s_waitcnt vmcnt(5)
buffer_load_dwordx4 v[148:151], v1, s[44:47], s64 offen nt
v_and_b32_dpp v104, v21, v4 row_newbcast:0 row_mask:0xf bank_mask:0xf
v_and_b32_dpp v105, v21, v5 row_newbcast:0 row_mask:0xf bank_mask:0xf
v_and_b32_dpp v106, v21, v6 row_newbcast:0 row_mask:0xf bank_mask:0xf
v_and_b32_dpp v107, v21, v7 row_newbcast:0 row_mask:0xf bank_mask:0xf
v_mfma_f32_16x16x32_bf16 v[112:115], v[108:111], v[88:91], v[112:115]
s_xor_b32 s64, s65, 197632
s_waitcnt vmcnt(5)
buffer_load_dwordx4 v[152:155], v1, s[44:47], s64 offen nt
v_and_b32_dpp v108, v21, v4 row_newbcast:4 row_mask:0xf bank_mask:0xf
v_and_b32_dpp v109, v21, v5 row_newbcast:4 row_mask:0xf bank_mask:0xf
v_and_b32_dpp v110, v21, v6 row_newbcast:4 row_mask:0xf bank_mask:0xf
v_and_b32_dpp v111, v21, v7 row_newbcast:4 row_mask:0xf bank_mask:0xf
v_mfma_f32_16x16x32_bf16 v[112:115], v[104:107], v[92:95], v[112:115]
s_xor_b32 s64, s65, 230400
s_waitcnt vmcnt(5)
buffer_load_dwordx4 v[156:159], v1, s[44:47], s64 offen nt
v_and_b32_dpp v104, v12, v4 row_newbcast:8 row_mask:0xf bank_mask:0xf
v_and_b32_dpp v105, v12, v5 row_newbcast:8 row_mask:0xf bank_mask:0xf
v_and_b32_dpp v106, v12, v6 row_newbcast:8 row_mask:0xf bank_mask:0xf
v_and_b32_dpp v107, v12, v7 row_newbcast:8 row_mask:0xf bank_mask:0xf
v_mfma_f32_16x16x32_bf16 v[112:115], v[108:111], v[132:135], v[112:115]
s_cmp_lt_u32 s2, 208
s_cbranch_scc0 L_hp_123
v_lshlrev_b32 v160, 2, v0
buffer_load_dword v161, v160, s[36:39], s62 offen offset:0 sc1
L_hp_123:
s_xor_b32 s64, s65, 201728
s_waitcnt vmcnt(5)
buffer_load_dwordx4 v[180:183], v1, s[44:47], s64 offen nt
v_and_b32_dpp v108, v12, v4 row_newbcast:12 row_mask:0xf bank_mask:0xf
v_and_b32_dpp v109, v12, v5 row_newbcast:12 row_mask:0xf bank_mask:0xf
v_and_b32_dpp v110, v12, v6 row_newbcast:12 row_mask:0xf bank_mask:0xf
v_and_b32_dpp v111, v12, v7 row_newbcast:12 row_mask:0xf bank_mask:0xf
v_mfma_f32_16x16x32_bf16 v[112:115], v[104:107], v[136:139], v[112:115]
s_xor_b32 s64, s65, 234496
s_waitcnt vmcnt(5)
buffer_load_dwordx4 v[184:187], v1, s[44:47], s64 offen nt
v_and_b32_dpp v104, v21, v4 row_newbcast:8 row_mask:0xf bank_mask:0xf
v_and_b32_dpp v105, v21, v5 row_newbcast:8 row_mask:0xf bank_mask:0xf
v_and_b32_dpp v106, v21, v6 row_newbcast:8 row_mask:0xf bank_mask:0xf
v_and_b32_dpp v107, v21, v7 row_newbcast:8 row_mask:0xf bank_mask:0xf
v_mfma_f32_16x16x32_bf16 v[112:115], v[108:111], v[140:143], v[112:115]
s_xor_b32 s64, s65, 205824
s_waitcnt vmcnt(7)
buffer_load_dwordx4 v[188:191], v1, s[44:47], s64 offen nt
s_xor_b32 s64, s65, 238592
s_waitcnt vmcnt(7)
buffer_load_dwordx4 v[24:27], v1, s[44:47], s64 offen nt
s_cmp_eq_u32 s34, 2
s_cbranch_scc0 L_w_124
v_mov_b32 v60, 62
s_mov_b64 exec, 1
buffer_store_dword v60, off, s[36:39], s63 offset:0
s_mov_b64 exec, -1
L_w_124:
s_xor_b32 s64, s65, 209920
s_waitcnt vmcnt(7)
buffer_load_dwordx4 v[28:31], v1, s[44:47], s64 offen nt
v_and_b32_dpp v108, v21, v4 row_newbcast:12 row_mask:0xf bank_mask:0xf
v_and_b32_dpp v109, v21, v5 row_newbcast:12 row_mask:0xf bank_mask:0xf
v_and_b32_dpp v110, v21, v6 row_newbcast:12 row_mask:0xf bank_mask:0xf
v_and_b32_dpp v111, v21, v7 row_newbcast:12 row_mask:0xf bank_mask:0xf
v_mfma_f32_16x16x32_bf16 v[112:115], v[104:107], v[144:147], v[112:115]
s_xor_b32 s64, s65, 242688
s_waitcnt vmcnt(7)
buffer_load_dwordx4 v[32:35], v1, s[44:47], s64 offen nt
v_and_b32_dpp v104, v14, v4 row_newbcast:0 row_mask:0xf bank_mask:0xf
v_and_b32_dpp v105, v14, v5 row_newbcast:0 row_mask:0xf bank_mask:0xf
v_and_b32_dpp v106, v14, v6 row_newbcast:0 row_mask:0xf bank_mask:0xf
v_and_b32_dpp v107, v14, v7 row_newbcast:0 row_mask:0xf bank_mask:0xf
v_mfma_f32_16x16x32_bf16 v[112:115], v[108:111], v[148:151], v[112:115]
s_cmp_lt_u32 s2, 208
s_cbranch_scc0 L_nohelp
v_lshrrev_b32 v176, 3, v0
v_sub_u32 v176, 63, v176
v_and_b32 v172, 7, v0
v_lshlrev_b32 v172, 7, v172
v_bfe_u32 v162, v176, 0, 1
v_lshl_or_b32 v172, v162, 15, v172
v_bfe_u32 v162, v176, 1, 1
v_lshl_or_b32 v172, v162, 12, v172
v_bfe_u32 v162, v176, 2, 1
v_lshl_or_b32 v172, v162, 13, v172
v_bfe_u32 v162, v176, 3, 1
v_lshl_or_b32 v172, v162, 16, v172
v_bfe_u32 v162, v176, 4, 1
v_lshl_or_b32 v172, v162, 10, v172
v_bfe_u32 v162, v176, 5, 1
v_lshl_or_b32 v172, v162, 17, v172
v_lshrrev_b32 v177, 3, v0
v_sub_u32 v177, 55, v177
v_and_b32 v173, 7, v0
v_lshlrev_b32 v173, 7, v173
v_bfe_u32 v162, v177, 0, 1
v_lshl_or_b32 v173, v162, 15, v173
v_bfe_u32 v162, v177, 1, 1
v_lshl_or_b32 v173, v162, 12, v173
v_bfe_u32 v162, v177, 2, 1
v_lshl_or_b32 v173, v162, 13, v173
v_bfe_u32 v162, v177, 3, 1
v_lshl_or_b32 v173, v162, 16, v173
v_bfe_u32 v162, v177, 4, 1
v_lshl_or_b32 v173, v162, 10, v173
v_bfe_u32 v162, v177, 5, 1
v_lshl_or_b32 v173, v162, 17, v173
v_lshrrev_b32 v178, 3, v0
v_sub_u32 v178, 47, v178
v_and_b32 v174, 7, v0
v_lshlrev_b32 v174, 7, v174
v_bfe_u32 v162, v178, 0, 1
v_lshl_or_b32 v174, v162, 15, v174
v_bfe_u32 v162, v178, 1, 1
v_lshl_or_b32 v174, v162, 12, v174
v_bfe_u32 v162, v178, 2, 1
v_lshl_or_b32 v174, v162, 13, v174
v_bfe_u32 v162, v178, 3, 1
v_lshl_or_b32 v174, v162, 16, v174
v_bfe_u32 v162, v178, 4, 1
v_lshl_or_b32 v174, v162, 10, v174
v_bfe_u32 v162, v178, 5, 1
v_lshl_or_b32 v174, v162, 17, v174
v_lshrrev_b32 v179, 3, v0
v_sub_u32 v179, 39, v179
v_and_b32 v175, 7, v0
v_lshlrev_b32 v175, 7, v175
v_bfe_u32 v162, v179, 0, 1
v_lshl_or_b32 v175, v162, 15, v175
v_bfe_u32 v162, v179, 1, 1
v_lshl_or_b32 v175, v162, 12, v175
v_bfe_u32 v162, v179, 2, 1
v_lshl_or_b32 v175, v162, 13, v175
v_bfe_u32 v162, v179, 3, 1
v_lshl_or_b32 v175, v162, 16, v175
v_bfe_u32 v162, v179, 4, 1
v_lshl_or_b32 v175, v162, 10, v175
v_bfe_u32 v162, v179, 5, 1
v_lshl_or_b32 v175, v162, 17, v175
s_lshr_b32 s71, s2, 3
v_subrev_u32 v163, s71, v0
v_and_b32 v163, 31, v163
s_waitcnt vmcnt(6)
v_mov_b32 v162, v161
s_nop 1
v_permlane32_swap_b32 v161, v162
v_add_u32 v161, 1, v161
v_max_u32 v161, 7, v161
v_cmp_eq_u32 vcc, -1, v162
v_mov_b32 v160, 0xff
s_nop 0
v_cndmask_b32 v161, v160, v161, vcc
v_lshl_or_b32 v161, v161, 5, v163
s_nop 1
v_min_u32_dpp v161, v161, v161 quad_perm:[1,0,3,2] row_mask:0xf bank_mask:0xf
s_nop 1
v_min_u32_dpp v161, v161, v161 quad_perm:[2,3,0,1] row_mask:0xf bank_mask:0xf
s_nop 1
v_min_u32_dpp v161, v161, v161 row_ror:4 row_mask:0xf bank_mask:0xf
s_nop 1
v_min_u32_dpp v161, v161, v161 row_ror:8 row_mask:0xf bank_mask:0xf
s_nop 1
v_readlane_b32 s76, v161, 0
v_readlane_b32 s66, v161, 16
s_min_u32 s76, s76, s66
s_lshr_b32 s66, s76, 5
s_cmp_lt_u32 s66, 50
s_cbranch_scc0 L_drain
s_mov_b32 s48, s8
s_mov_b32 s49, s9
s_mov_b32 s50, 0x10000000
s_mov_b32 s51, 0x20000
s_lshr_b32 s64, s2, 3
s_add_u32 s76, s76, s64
s_and_b32 s76, s76, 31
s_lshl_b32 s67, s76, 2
s_add_u32 s67, s67, s62
s_lshl_b32 s76, s76, 3
s_and_b32 s64, s2, 7
s_or_b32 s76, s76, s64
s_and_b32 s64, s34, 1
s_lshl_b32 s64, s64, 14
s_lshr_b32 s71, s34, 1
s_lshl_b32 s71, s71, 11
s_or_b32 s64, s64, s71
s_lshl_b32 s71, s76, 10
s_xor_b32 s64, s64, s71
s_or_b32 s64, s64, 0xC0000
s_lshl_b32 s76, s76, 20
s_xor_b32 s76, s76, s64
s_add_u32 s66, s66, 11
v_xor_b32 v175, s76, v175
v_cmp_lt_u32 vcc, s66, v179
s_or_b64 exec, vcc, 1
buffer_load_dword v160, v175, s[48:51], 0 offen
s_mov_b64 exec, -1
v_xor_b32 v174, s76, v174
v_cmp_lt_u32 vcc, s66, v178
s_or_b64 exec, vcc, 1
buffer_load_dword v160, v174, s[48:51], 0 offen
s_mov_b64 exec, -1
v_xor_b32 v173, s76, v173
v_cmp_lt_u32 vcc, s66, v177
s_or_b64 exec, vcc, 1
buffer_load_dword v160, v173, s[48:51], 0 offen
s_mov_b64 exec, -1
v_xor_b32 v172, s76, v172
v_cmp_lt_u32 vcc, s66, v176
s_or_b64 exec, vcc, 1
buffer_load_dword v160, v172, s[48:51], 0 offen
s_mov_b64 exec, -1
s_mov_b64 exec, 1
buffer_store_dword v1, off, s[36:39], s67 offset:128
s_mov_b64 exec, -1
s_waitcnt vmcnt(12)
v_and_b32_dpp v108, v14, v4 row_newbcast:4 row_mask:0xf bank_mask:0xf
v_and_b32_dpp v109, v14, v5 row_newbcast:4 row_mask:0xf bank_mask:0xf
v_and_b32_dpp v110, v14, v6 row_newbcast:4 row_mask:0xf bank_mask:0xf
v_and_b32_dpp v111, v14, v7 row_newbcast:4 row_mask:0xf bank_mask:0xf
v_mfma_f32_16x16x32_bf16 v[112:115], v[104:107], v[152:155], v[112:115]
s_waitcnt vmcnt(11)
v_and_b32_dpp v104, v23, v4 row_newbcast:0 row_mask:0xf bank_mask:0xf
v_and_b32_dpp v105, v23, v5 row_newbcast:0 row_mask:0xf bank_mask:0xf
v_and_b32_dpp v106, v23, v6 row_newbcast:0 row_mask:0xf bank_mask:0xf
v_and_b32_dpp v107, v23, v7 row_newbcast:0 row_mask:0xf bank_mask:0xf
v_mfma_f32_16x16x32_bf16 v[112:115], v[108:111], v[156:159], v[112:115]
s_waitcnt vmcnt(10)
v_and_b32_dpp v108, v23, v4 row_newbcast:4 row_mask:0xf bank_mask:0xf
v_and_b32_dpp v109, v23, v5 row_newbcast:4 row_mask:0xf bank_mask:0xf
v_and_b32_dpp v110, v23, v6 row_newbcast:4 row_mask:0xf bank_mask:0xf
v_and_b32_dpp v111, v23, v7 row_newbcast:4 row_mask:0xf bank_mask:0xf
v_mfma_f32_16x16x32_bf16 v[112:115], v[104:107], v[180:183], v[112:115]
s_waitcnt vmcnt(9)
v_and_b32_dpp v104, v14, v4 row_newbcast:8 row_mask:0xf bank_mask:0xf
v_and_b32_dpp v105, v14, v5 row_newbcast:8 row_mask:0xf bank_mask:0xf
v_and_b32_dpp v106, v14, v6 row_newbcast:8 row_mask:0xf bank_mask:0xf
v_and_b32_dpp v107, v14, v7 row_newbcast:8 row_mask:0xf bank_mask:0xf
v_mfma_f32_16x16x32_bf16 v[112:115], v[108:111], v[184:187], v[112:115]
s_waitcnt vmcnt(8)
v_and_b32_dpp v108, v14, v4 row_newbcast:12 row_mask:0xf bank_mask:0xf
v_and_b32_dpp v109, v14, v5 row_newbcast:12 row_mask:0xf bank_mask:0xf
v_and_b32_dpp v110, v14, v6 row_newbcast:12 row_mask:0xf bank_mask:0xf
v_and_b32_dpp v111, v14, v7 row_newbcast:12 row_mask:0xf bank_mask:0xf
v_mfma_f32_16x16x32_bf16 v[112:115], v[104:107], v[188:191], v[112:115]
s_waitcnt vmcnt(7)
v_and_b32_dpp v104, v23, v4 row_newbcast:8 row_mask:0xf bank_mask:0xf
v_and_b32_dpp v105, v23, v5 row_newbcast:8 row_mask:0xf bank_mask:0xf
v_and_b32_dpp v106, v23, v6 row_newbcast:8 row_mask:0xf bank_mask:0xf
v_and_b32_dpp v107, v23, v7 row_newbcast:8 row_mask:0xf bank_mask:0xf
v_mfma_f32_16x16x32_bf16 v[112:115], v[108:111], v[24:27], v[112:115]
s_waitcnt vmcnt(6)
v_and_b32_dpp v108, v23, v4 row_newbcast:12 row_mask:0xf bank_mask:0xf
v_and_b32_dpp v109, v23, v5 row_newbcast:12 row_mask:0xf bank_mask:0xf
v_and_b32_dpp v110, v23, v6 row_newbcast:12 row_mask:0xf bank_mask:0xf
v_and_b32_dpp v111, v23, v7 row_newbcast:12 row_mask:0xf bank_mask:0xf
v_mfma_f32_16x16x32_bf16 v[112:115], v[104:107], v[28:31], v[112:115]
s_waitcnt vmcnt(5)
v_mfma_f32_16x16x32_bf16 v[112:115], v[108:111], v[32:35], v[112:115]
s_branch L_drained
L_nohelp:
L_drain:
s_waitcnt vmcnt(7)
v_and_b32_dpp v108, v14, v4 row_newbcast:4 row_mask:0xf bank_mask:0xf
v_and_b32_dpp v109, v14, v5 row_newbcast:4 row_mask:0xf bank_mask:0xf
v_and_b32_dpp v110, v14, v6 row_newbcast:4 row_mask:0xf bank_mask:0xf
v_and_b32_dpp v111, v14, v7 row_newbcast:4 row_mask:0xf bank_mask:0xf
v_mfma_f32_16x16x32_bf16 v[112:115], v[104:107], v[152:155], v[112:115]
s_waitcnt vmcnt(6)
v_and_b32_dpp v104, v23, v4 row_newbcast:0 row_mask:0xf bank_mask:0xf
v_and_b32_dpp v105, v23, v5 row_newbcast:0 row_mask:0xf bank_mask:0xf
v_and_b32_dpp v106, v23, v6 row_newbcast:0 row_mask:0xf bank_mask:0xf
v_and_b32_dpp v107, v23, v7 row_newbcast:0 row_mask:0xf bank_mask:0xf
v_mfma_f32_16x16x32_bf16 v[112:115], v[108:111], v[156:159], v[112:115]
s_waitcnt vmcnt(5)
v_and_b32_dpp v108, v23, v4 row_newbcast:4 row_mask:0xf bank_mask:0xf
v_and_b32_dpp v109, v23, v5 row_newbcast:4 row_mask:0xf bank_mask:0xf
v_and_b32_dpp v110, v23, v6 row_newbcast:4 row_mask:0xf bank_mask:0xf
v_and_b32_dpp v111, v23, v7 row_newbcast:4 row_mask:0xf bank_mask:0xf
v_mfma_f32_16x16x32_bf16 v[112:115], v[104:107], v[180:183], v[112:115]
s_waitcnt vmcnt(4)
v_and_b32_dpp v104, v14, v4 row_newbcast:8 row_mask:0xf bank_mask:0xf
v_and_b32_dpp v105, v14, v5 row_newbcast:8 row_mask:0xf bank_mask:0xf
v_and_b32_dpp v106, v14, v6 row_newbcast:8 row_mask:0xf bank_mask:0xf
v_and_b32_dpp v107, v14, v7 row_newbcast:8 row_mask:0xf bank_mask:0xf
v_mfma_f32_16x16x32_bf16 v[112:115], v[108:111], v[184:187], v[112:115]
s_waitcnt vmcnt(3)
v_and_b32_dpp v108, v14, v4 row_newbcast:12 row_mask:0xf bank_mask:0xf
v_and_b32_dpp v109, v14, v5 row_newbcast:12 row_mask:0xf bank_mask:0xf
v_and_b32_dpp v110, v14, v6 row_newbcast:12 row_mask:0xf bank_mask:0xf
v_and_b32_dpp v111, v14, v7 row_newbcast:12 row_mask:0xf bank_mask:0xf
v_mfma_f32_16x16x32_bf16 v[112:115], v[104:107], v[188:191], v[112:115]
s_waitcnt vmcnt(2)
v_and_b32_dpp v104, v23, v4 row_newbcast:8 row_mask:0xf bank_mask:0xf
v_and_b32_dpp v105, v23, v5 row_newbcast:8 row_mask:0xf bank_mask:0xf
v_and_b32_dpp v106, v23, v6 row_newbcast:8 row_mask:0xf bank_mask:0xf
v_and_b32_dpp v107, v23, v7 row_newbcast:8 row_mask:0xf bank_mask:0xf
v_mfma_f32_16x16x32_bf16 v[112:115], v[108:111], v[24:27], v[112:115]
s_waitcnt vmcnt(1)
v_and_b32_dpp v108, v23, v4 row_newbcast:12 row_mask:0xf bank_mask:0xf
v_and_b32_dpp v109, v23, v5 row_newbcast:12 row_mask:0xf bank_mask:0xf
v_and_b32_dpp v110, v23, v6 row_newbcast:12 row_mask:0xf bank_mask:0xf
v_and_b32_dpp v111, v23, v7 row_newbcast:12 row_mask:0xf bank_mask:0xf
v_mfma_f32_16x16x32_bf16 v[112:115], v[104:107], v[28:31], v[112:115]
s_waitcnt vmcnt(0)
v_mfma_f32_16x16x32_bf16 v[112:115], v[108:111], v[32:35], v[112:115]
L_drained:
v_and_b32 v2, 15, v0
v_lshlrev_b32 v2, 5, v2
v_and_b32 v3, 16, v0
v_add_u32 v2, v2, v3
s_lshl_b32 s68, s34, 9
v_add_u32 v2, s68, v2
s_mov_b32 exec_hi, 0
s_nop 1
ds_write_b128 v2, v[112:115] offset:512
s_mov_b32 exec_hi, -1
v_lshlrev_b32 v1, 4, v0
s_waitcnt lgkmcnt(0)
s_barrier
v_mov_b32 v2, 0
ds_read_b32 v3, v2 offset:328
s_waitcnt lgkmcnt(0)
v_readfirstlane_b32 s35, v3
s_branch L_tail_s
L_fin:
L_end:
s_endpgm
L_code_end:
.section .rodata,"a"
.p2align 6
.amdhsa_kernel adaLN_cond__sliding_block_cached__glu_gated_glu__decode_kernel
  .amdhsa_next_free_vgpr 256
  .amdhsa_next_free_sgpr 102
  .amdhsa_accum_offset 256
  .amdhsa_group_segment_fixed_size 0
  .amdhsa_kernarg_size 112
  .amdhsa_user_sgpr_count 2
  .amdhsa_user_sgpr_kernarg_segment_ptr 1
  .amdhsa_system_sgpr_workgroup_id_x 1
  .amdhsa_float_denorm_mode_32 3
.end_amdhsa_kernel
```

```asm
; @launch grid=(256,1,1) block=(512,1,1) lds=131072
.amdgcn_target "amdgcn-amd-amdhsa--gfx950"
.text
.globl adaLN_cond__sliding_block_cached__glu_gated_glu__decode_kernel
.p2align 8
.type adaLN_cond__sliding_block_cached__glu_gated_glu__decode_kernel,@function
adaLN_cond__sliding_block_cached__glu_gated_glu__decode_kernel:
L_code_begin:
s_load_dwordx16 s[4:19], s[0:1], 0
s_load_dwordx8 s[20:27], s[0:1], 64
s_load_dwordx4 s[28:31], s[0:1], 96
s_cmpk_ge_u32 s2, 256
s_cbranch_scc1 L_end
v_lshrrev_b32 v1, 6, v0
v_and_b32 v0, 63, v0
v_readfirstlane_b32 s3, v1
v_lshlrev_b32 v1, 4, v0
s_lshl_b32 s64, s2, 20
s_add_u32 s64, s64, 0xC0000
s_mov_b32 s42, 0x40000
s_mov_b32 s43, 0x20000
s_and_b32 s34, s3, 3
s_cmp_ge_u32 s3, 4
s_cbranch_scc1 L_helper
s_and_b32 s65, s34, 1
s_lshl_b32 s65, s65, 14
s_lshr_b32 s66, s34, 1
s_lshl_b32 s66, s66, 11
s_or_b32 s65, s65, s66
s_lshl_b32 s66, s2, 10
s_xor_b32 s65, s65, s66
s_waitcnt lgkmcnt(0)
s_add_u32 s40, s6, s64
s_addc_u32 s41, s7, 0
s_add_u32 s44, s8, s64
s_addc_u32 s45, s9, 0
buffer_load_dwordx4 v[8:11], v1, s[40:43], s65 offen nt
s_xor_b32 s64, s65, 32768
buffer_load_dwordx4 v[12:15], v1, s[40:43], s64 offen nt
s_xor_b32 s64, s65, 8192
buffer_load_dwordx4 v[16:19], v1, s[40:43], s64 offen nt
s_xor_b32 s64, s65, 40960
buffer_load_dwordx4 v[20:23], v1, s[40:43], s64 offen nt
s_barrier
s_branch L_srest
L_helper:
s_setprio 2
v_lshlrev_b32 v2, 2, v0
s_cmp_eq_u32 s3, 7
s_cbranch_scc0 L_nopf
s_getpc_b64 s[60:61]
L_pc:
s_lshr_b32 s66, s2, 3
s_lshl_b32 s66, s66, 10
v_add_u32 v10, s66, v1
v_min_u32 v10, L_code_end-L_pc-16, v10
global_load_dwordx4 v[12:15], v10, s[60:61]
v_subrev_u32 v3, 16, v0
v_ashrrev_i32 v3, 31, v3
ds_write_b32 v2, v3 offset:256
L_nopf:
s_and_b32 s67, s2, 7
s_lshr_b32 s68, s2, 3
v_and_b32 v38, 7, v0
v_lshrrev_b32 v37, 3, v0
s_cmp_eq_u32 s34, 0
s_cbranch_scc0 L_p0a
s_mov_b32 s70, 6
s_lshl_b32 s67, s67, 1
s_add_u32 s66, s67, 14
v_min_u32 v38, 5, v38
v_cmp_lt_u32 vcc, 1, v38
v_add_u32 v36, s66, v38
s_nop 0
v_cndmask_b32 v38, v38, v36, vcc
s_branch L_p0b
L_p0a:
s_lshl_b32 s67, s67, 3
s_lshl_b32 s65, s2, 3
s_and_b32 s65, s65, 0xff
s_lshr_b32 s66, s2, 5
s_or_b32 s65, s65, s66
s_cmp_eq_u32 s34, 2
s_cselect_b32 s70, 1, 8
s_cselect_b32 s68, s65, s68
s_cselect_b32 s67, 0, s67
L_p0b:
v_lshl_add_u32 v37, s68, 4, v37
v_mul_u32_u24 v37, s70, v37
v_lshl_add_u32 v38, v37, 3, v38
v_add_lshl_u32 v38, v38, s67, 7
s_lshl_b32 s70, s70, 13
v_add_u32 v39, s70, v38
s_sub_u32 s64, s2, 112
s_cmp_lt_u32 s64, 32
s_waitcnt lgkmcnt(0)
s_barrier
s_cbranch_scc1 L_jan
s_cmp_eq_u32 s34, 3
s_cbranch_scc1 L_p0_125
s_cmp_eq_u32 s34, 0
s_cselect_b32 s62, s24, s10
s_cselect_b32 s63, s25, s11
s_cmp_eq_u32 s34, 2
s_cselect_b32 s62, s12, s62
s_cselect_b32 s63, s13, s63
global_load_dword v12, v38, s[62:63]
global_load_dword v13, v39, s[62:63]
L_p0_125:
L_nop0:
s_mov_b32 s77, 0
s_cmp_eq_u32 s34, 3
s_cselect_b32 s64, 16, 0
s_cmp_lt_u32 s2, s64
s_cbranch_scc0 L_nopc
v_mov_b32 v4, -1
v_mov_b32 v5, -1
v_mov_b32 v6, -1
v_mov_b32 v7, -1
s_and_b32 s66, s2, 7
s_lshl_b32 s66, s66, 11
s_and_b32 s65, s2, 8
s_lshl_b32 s65, s65, 7
s_add_u32 s66, s66, s65
v_add_u32 v8, s66, v1
global_store_dwordx4 v8, v[4:7], s[30:31] sc1
s_mov_b32 s77, 1
L_nopc:
s_cmp_eq_u32 s34, 3
s_cbranch_scc0 L_w_126
s_and_b32 s67, s2, 7
s_lshr_b32 s68, s2, 3
s_min_u32 s64, s67, 3
s_mul_i32 s65, s67, 5
s_add_u32 s64, s64, s65
s_cmp_lt_u32 s67, 3
s_cselect_b32 s65, 6, 5
L_w_126:
s_lshr_b32 s32, s2, 5
s_and_b32 s33, s2, 31
s_and_b32 s67, s2, 7
s_lshr_b32 s68, s2, 3
s_sub_u32 s68, s68, 26
s_min_u32 s74, s67, 3
s_mul_i32 s66, s67, 5
s_add_u32 s74, s74, s66
s_add_u32 s74, s74, s68
s_cmp_lt_u32 s67, 3
s_cselect_b32 s66, 6, 5
s_cmp_lt_u32 s68, s66
s_cselect_b32 s74, s74, -1
s_cmp_lt_u32 s2, 48
s_cselect_b32 s66, 2, 3
s_cselect_b32 s72, 14+26, 42+26
s_cmp_lt_u32 s2, 16
s_cselect_b32 s66, 1, s66
s_cselect_b32 s72, 26, s72
s_lshl_b32 s66, s67, s66
s_add_u32 s72, s72, s66
s_add_u32 s72, s72, s68
s_mov_b32 s36, s30
s_mov_b32 s37, s31
s_mov_b32 s38, 0x1d0000
s_mov_b32 s39, 0x20000
s_mov_b32 s52, s28
s_mov_b32 s53, s29
s_mov_b32 s54, 0x100
s_mov_b32 s55, 0x20000
v_mov_b32 v9, 1
s_cmp_lt_u32 s2, 112
s_cbranch_scc0 L_norole
L_gemm:
v_and_b32 v16, 7, v0
v_lshlrev_b32 v16, 10, v16
v_and_b32 v17, 8, v0
v_lshl_add_u32 v16, v17, 3, v16
v_and_b32 v17, 48, v0
v_add_u32 v16, v16, v17
s_lshl_b32 s67, s34, 8
v_lshrrev_b32 v19, 3, v0
v_and_b32 v17, 2, v19
v_and_b32 v18, 7, v0
v_xor_b32 v17, v17, v18
v_xor_b32 v18, 4, v17
v_lshlrev_b32 v17, 4, v17
v_lshlrev_b32 v18, 4, v18
s_cmp_lt_u32 s2, 48
s_cbranch_scc0 L_gq0
s_mov_b32 s40, s24
s_mov_b32 s41, s25
s_mov_b32 s42, 0x300000
s_mov_b32 s43, 0x20000
s_mov_b32 s48, s22
s_mov_b32 s49, s23
s_mov_b32 s50, 0x2000
s_mov_b32 s51, 0x20000
s_mov_b32 s70, 6144
s_lshl_b32 s64, s72, 7
s_branch L_g1
L_gq0:
s_mov_b32 s40, s10
s_mov_b32 s41, s11
s_mov_b32 s42, 0x400000
s_mov_b32 s43, 0x20000
s_mov_b32 s48, s4
s_mov_b32 s49, s5
s_mov_b32 s50, 0x2000
s_mov_b32 s51, 0x20000
s_mov_b32 s70, 8192
s_sub_u32 s64, s72, 48
s_lshl_b32 s64, s64, 7
L_g1:
buffer_load_dwordx4 v[192:195], v16, s[48:51], s67 offen offset:0
buffer_load_dwordx4 v[196:199], v16, s[48:51], s67 offen offset:128
v_mul_lo_u32 v19, s70, v19
v_add_u32 v17, v17, v19
v_add_u32 v18, v18, v19
s_lshl_b32 s66, s70, 7
s_mul_i32 s66, s66, s34
s_add_u32 s64, s64, s66
s_lshl_b32 s70, s70, 3
s_lshl_b32 s65, s34, 13
s_add_u32 s65, s65, 4096
s_cmp_lt_u32 s2, 16
s_cselect_b32 s71, 0, 2
s_cmp_ge_u32 s2, 48
s_cselect_b32 s71, 1, s71
s_add_u32 m0, s65, 0
s_nop 0
buffer_load_dwordx4 v17, s[40:43], s64 offen  lds
s_add_u32 s64, s64, s70
s_add_u32 m0, s65, 1024
s_nop 0
buffer_load_dwordx4 v18, s[40:43], s64 offen  lds
s_add_u32 s64, s64, s70
s_cmp_eq_u32 s71, 2
s_cbranch_scc0 L_pace_127
s_waitcnt vmcnt(1)
L_pace_127:
s_add_u32 m0, s65, 2048
s_nop 0
buffer_load_dwordx4 v17, s[40:43], s64 offen  lds
s_add_u32 s64, s64, s70
s_cmp_eq_u32 s71, 0
s_cbranch_scc1 L_pace_128
s_waitcnt vmcnt(2)
s_cmp_eq_u32 s71, 2
s_cbranch_scc0 L_pace_128
s_waitcnt vmcnt(1)
L_pace_128:
s_add_u32 m0, s65, 3072
s_nop 0
buffer_load_dwordx4 v18, s[40:43], s64 offen  lds
s_add_u32 s64, s64, s70
s_cmp_eq_u32 s71, 0
s_cbranch_scc1 L_pace_129
s_waitcnt vmcnt(2)
s_cmp_eq_u32 s71, 2
s_cbranch_scc0 L_pace_129
s_waitcnt vmcnt(1)
L_pace_129:
s_add_u32 m0, s65, 4096
s_nop 0
buffer_load_dwordx4 v17, s[40:43], s64 offen  lds
s_add_u32 s64, s64, s70
s_cmp_eq_u32 s71, 0
s_cbranch_scc1 L_pace_130
s_waitcnt vmcnt(2)
s_cmp_eq_u32 s71, 2
s_cbranch_scc0 L_pace_130
s_waitcnt vmcnt(1)
L_pace_130:
s_add_u32 m0, s65, 5120
s_nop 0
buffer_load_dwordx4 v18, s[40:43], s64 offen  lds
s_add_u32 s64, s64, s70
s_cmp_eq_u32 s71, 0
s_cbranch_scc1 L_pace_131
s_waitcnt vmcnt(2)
s_cmp_eq_u32 s71, 2
s_cbranch_scc0 L_pace_131
s_waitcnt vmcnt(1)
L_pace_131:
s_add_u32 m0, s65, 6144
s_nop 0
buffer_load_dwordx4 v17, s[40:43], s64 offen  lds
s_add_u32 s64, s64, s70
s_cmp_eq_u32 s71, 0
s_cbranch_scc1 L_pace_132
s_waitcnt vmcnt(2)
s_cmp_eq_u32 s71, 2
s_cbranch_scc0 L_pace_132
s_waitcnt vmcnt(1)
L_pace_132:
s_add_u32 m0, s65, 7168
s_nop 0
buffer_load_dwordx4 v18, s[40:43], s64 offen  lds
s_add_u32 s64, s64, s70
s_cmp_eq_u32 s71, 0
s_cbranch_scc1 L_pace_133
s_waitcnt vmcnt(2)
s_cmp_eq_u32 s71, 2
s_cbranch_scc0 L_pace_133
s_waitcnt vmcnt(1)
L_pace_133:
s_add_u32 m0, s65, 32768
s_nop 0
buffer_load_dwordx4 v17, s[40:43], s64 offen  lds
s_add_u32 s64, s64, s70
s_cmp_eq_u32 s71, 0
s_cbranch_scc1 L_pace_134
s_waitcnt vmcnt(2)
s_cmp_eq_u32 s71, 2
s_cbranch_scc0 L_pace_134
s_waitcnt vmcnt(1)
L_pace_134:
s_add_u32 m0, s65, 33792
s_nop 0
buffer_load_dwordx4 v18, s[40:43], s64 offen  lds
s_add_u32 s64, s64, s70
s_cmp_eq_u32 s71, 0
s_cbranch_scc1 L_pace_135
s_waitcnt vmcnt(2)
s_cmp_eq_u32 s71, 2
s_cbranch_scc0 L_pace_135
s_waitcnt vmcnt(1)
L_pace_135:
s_add_u32 m0, s65, 34816
s_nop 0
buffer_load_dwordx4 v17, s[40:43], s64 offen  lds
s_add_u32 s64, s64, s70
s_cmp_eq_u32 s71, 0
s_cbranch_scc1 L_pace_136
s_waitcnt vmcnt(2)
s_cmp_eq_u32 s71, 2
s_cbranch_scc0 L_pace_136
s_waitcnt vmcnt(1)
L_pace_136:
s_add_u32 m0, s65, 35840
s_nop 0
buffer_load_dwordx4 v18, s[40:43], s64 offen  lds
s_add_u32 s64, s64, s70
s_cmp_eq_u32 s71, 0
s_cbranch_scc1 L_pace_137
s_waitcnt vmcnt(2)
s_cmp_eq_u32 s71, 2
s_cbranch_scc0 L_pace_137
s_waitcnt vmcnt(1)
L_pace_137:
s_add_u32 m0, s65, 36864
s_nop 0
buffer_load_dwordx4 v17, s[40:43], s64 offen  lds
s_add_u32 s64, s64, s70
s_cmp_eq_u32 s71, 0
s_cbranch_scc1 L_pace_138
s_waitcnt vmcnt(2)
s_cmp_eq_u32 s71, 2
s_cbranch_scc0 L_pace_138
s_waitcnt vmcnt(1)
L_pace_138:
s_add_u32 m0, s65, 37888
s_nop 0
buffer_load_dwordx4 v18, s[40:43], s64 offen  lds
s_add_u32 s64, s64, s70
s_cmp_eq_u32 s71, 0
s_cbranch_scc1 L_pace_139
s_waitcnt vmcnt(2)
s_cmp_eq_u32 s71, 2
s_cbranch_scc0 L_pace_139
s_waitcnt vmcnt(1)
L_pace_139:
s_add_u32 m0, s65, 38912
s_nop 0
buffer_load_dwordx4 v17, s[40:43], s64 offen  lds
s_add_u32 s64, s64, s70
s_cmp_eq_u32 s71, 0
s_cbranch_scc1 L_pace_140
s_waitcnt vmcnt(2)
s_cmp_eq_u32 s71, 2
s_cbranch_scc0 L_pace_140
s_waitcnt vmcnt(1)
L_pace_140:
s_add_u32 m0, s65, 39936
s_nop 0
buffer_load_dwordx4 v18, s[40:43], s64 offen  lds
s_add_u32 s64, s64, s70
s_waitcnt vmcnt(16)
s_cmp_eq_u32 s77, 0
s_cbranch_scc1 L_pc_141
s_lshl_b32 s66, s2, 2
v_mov_b32 v20, s66
v_mov_b32 v21, -1
s_mov_b64 exec, 1
global_store_dword v20, v21, s[28:29] sc1
s_mov_b64 exec, -1
L_pc_141:
s_cmp_eq_u32 s34, 0
s_cselect_b32 s73, 48, 0x1000
v_and_b32 v30, 15, v0
v_lshlrev_b32 v30, 2, v30
s_cmp_ge_u32 s2, s73
s_cbranch_scc0 L_fl_142
buffer_load_dword v31, v30, s[52:55], 0 offen sc1
L_fl_142:
s_mov_b32 s68, 0xffff0000
s_cmp_lt_u32 s2, 48
s_cbranch_scc0 L_gq1
s_mov_b32 s66, 0xbfb8aa3b
v_lshlrev_b32 v20, 16, v192
v_and_b32 v21, s68, v192
v_mul_f32 v22, s66, v20
v_mul_f32 v23, s66, v21
v_exp_f32 v22, v22
v_exp_f32 v23, v23
s_nop 0
v_add_f32 v22, 1.0, v22
v_add_f32 v23, 1.0, v23
v_rcp_f32 v22, v22
v_rcp_f32 v23, v23
s_nop 0
v_mul_f32 v20, v20, v22
v_mul_f32 v21, v21, v23
v_cvt_pk_bf16_f32 v48, v20, v21
v_lshlrev_b32 v20, 16, v193
v_and_b32 v21, s68, v193
v_mul_f32 v22, s66, v20
v_mul_f32 v23, s66, v21
v_exp_f32 v22, v22
v_exp_f32 v23, v23
s_nop 0
v_add_f32 v22, 1.0, v22
v_add_f32 v23, 1.0, v23
v_rcp_f32 v22, v22
v_rcp_f32 v23, v23
s_nop 0
v_mul_f32 v20, v20, v22
v_mul_f32 v21, v21, v23
v_cvt_pk_bf16_f32 v49, v20, v21
v_lshlrev_b32 v20, 16, v194
v_and_b32 v21, s68, v194
v_mul_f32 v22, s66, v20
v_mul_f32 v23, s66, v21
v_exp_f32 v22, v22
v_exp_f32 v23, v23
s_nop 0
v_add_f32 v22, 1.0, v22
v_add_f32 v23, 1.0, v23
v_rcp_f32 v22, v22
v_rcp_f32 v23, v23
s_nop 0
v_mul_f32 v20, v20, v22
v_mul_f32 v21, v21, v23
v_cvt_pk_bf16_f32 v50, v20, v21
v_lshlrev_b32 v20, 16, v195
v_and_b32 v21, s68, v195
v_mul_f32 v22, s66, v20
v_mul_f32 v23, s66, v21
v_exp_f32 v22, v22
v_exp_f32 v23, v23
s_nop 0
v_add_f32 v22, 1.0, v22
v_add_f32 v23, 1.0, v23
v_rcp_f32 v22, v22
v_rcp_f32 v23, v23
s_nop 0
v_mul_f32 v20, v20, v22
v_mul_f32 v21, v21, v23
v_cvt_pk_bf16_f32 v51, v20, v21
v_lshlrev_b32 v20, 16, v196
v_and_b32 v21, s68, v196
v_mul_f32 v22, s66, v20
v_mul_f32 v23, s66, v21
v_exp_f32 v22, v22
v_exp_f32 v23, v23
s_nop 0
v_add_f32 v22, 1.0, v22
v_add_f32 v23, 1.0, v23
v_rcp_f32 v22, v22
v_rcp_f32 v23, v23
s_nop 0
v_mul_f32 v20, v20, v22
v_mul_f32 v21, v21, v23
v_cvt_pk_bf16_f32 v52, v20, v21
v_lshlrev_b32 v20, 16, v197
v_and_b32 v21, s68, v197
v_mul_f32 v22, s66, v20
v_mul_f32 v23, s66, v21
v_exp_f32 v22, v22
v_exp_f32 v23, v23
s_nop 0
v_add_f32 v22, 1.0, v22
v_add_f32 v23, 1.0, v23
v_rcp_f32 v22, v22
v_rcp_f32 v23, v23
s_nop 0
v_mul_f32 v20, v20, v22
v_mul_f32 v21, v21, v23
v_cvt_pk_bf16_f32 v53, v20, v21
v_lshlrev_b32 v20, 16, v198
v_and_b32 v21, s68, v198
v_mul_f32 v22, s66, v20
v_mul_f32 v23, s66, v21
v_exp_f32 v22, v22
v_exp_f32 v23, v23
s_nop 0
v_add_f32 v22, 1.0, v22
v_add_f32 v23, 1.0, v23
v_rcp_f32 v22, v22
v_rcp_f32 v23, v23
s_nop 0
v_mul_f32 v20, v20, v22
v_mul_f32 v21, v21, v23
v_cvt_pk_bf16_f32 v54, v20, v21
v_lshlrev_b32 v20, 16, v199
v_and_b32 v21, s68, v199
v_mul_f32 v22, s66, v20
v_mul_f32 v23, s66, v21
v_exp_f32 v22, v22
v_exp_f32 v23, v23
s_nop 0
v_add_f32 v22, 1.0, v22
v_add_f32 v23, 1.0, v23
v_rcp_f32 v22, v22
v_rcp_f32 v23, v23
s_nop 0
v_mul_f32 v20, v20, v22
v_mul_f32 v21, v21, v23
v_cvt_pk_bf16_f32 v55, v20, v21
s_branch L_g2
L_gq1:
v_and_b32 v32, 7, v0
v_lshlrev_b32 v32, 2, v32
v_lshlrev_b32 v96, 16, v192
v_and_b32 v97, s68, v192
v_lshlrev_b32 v98, 16, v193
v_and_b32 v99, s68, v193
v_lshlrev_b32 v100, 16, v194
v_and_b32 v101, s68, v194
v_lshlrev_b32 v102, 16, v195
v_and_b32 v103, s68, v195
v_lshlrev_b32 v104, 16, v196
v_and_b32 v105, s68, v196
v_lshlrev_b32 v106, 16, v197
v_and_b32 v107, s68, v197
v_lshlrev_b32 v108, 16, v198
v_and_b32 v109, s68, v198
v_lshlrev_b32 v110, 16, v199
v_and_b32 v111, s68, v199
v_add_f32 v20, v96, v97
v_add_f32 v20, v20, v98
v_add_f32 v20, v20, v99
v_add_f32 v20, v20, v100
v_add_f32 v20, v20, v101
v_add_f32 v20, v20, v102
v_add_f32 v20, v20, v103
v_add_f32 v20, v20, v104
v_add_f32 v20, v20, v105
v_add_f32 v20, v20, v106
v_add_f32 v20, v20, v107
v_add_f32 v20, v20, v108
v_add_f32 v20, v20, v109
v_add_f32 v20, v20, v110
v_add_f32 v20, v20, v111
s_nop 1
v_add_f32_dpp v20, v20, v20 row_ror:8 row_mask:0xf bank_mask:0xf
v_mov_b32 v22, v20
s_nop 1
v_permlane16_swap_b32 v20, v22
s_nop 1
v_add_f32 v20, v20, v22
v_mov_b32 v22, v20
s_nop 1
v_permlane32_swap_b32 v20, v22
s_nop 1
v_add_f32 v20, v20, v22
v_mul_f32 v20, 0x3c000000, v20
v_mov_b32 v21, 0
v_sub_f32 v22, v96, v20
v_fmac_f32 v21, v22, v22
v_sub_f32 v22, v97, v20
v_fmac_f32 v21, v22, v22
v_sub_f32 v22, v98, v20
v_fmac_f32 v21, v22, v22
v_sub_f32 v22, v99, v20
v_fmac_f32 v21, v22, v22
v_sub_f32 v22, v100, v20
v_fmac_f32 v21, v22, v22
v_sub_f32 v22, v101, v20
v_fmac_f32 v21, v22, v22
v_sub_f32 v22, v102, v20
v_fmac_f32 v21, v22, v22
v_sub_f32 v22, v103, v20
v_fmac_f32 v21, v22, v22
v_sub_f32 v22, v104, v20
v_fmac_f32 v21, v22, v22
v_sub_f32 v22, v105, v20
v_fmac_f32 v21, v22, v22
v_sub_f32 v22, v106, v20
v_fmac_f32 v21, v22, v22
v_sub_f32 v22, v107, v20
v_fmac_f32 v21, v22, v22
v_sub_f32 v22, v108, v20
v_fmac_f32 v21, v22, v22
v_sub_f32 v22, v109, v20
v_fmac_f32 v21, v22, v22
v_sub_f32 v22, v110, v20
v_fmac_f32 v21, v22, v22
v_sub_f32 v22, v111, v20
v_fmac_f32 v21, v22, v22
s_nop 1
v_add_f32_dpp v21, v21, v21 row_ror:8 row_mask:0xf bank_mask:0xf
v_mov_b32 v22, v21
s_nop 1
v_permlane16_swap_b32 v21, v22
s_nop 1
v_add_f32 v21, v21, v22
v_mov_b32 v22, v21
s_nop 1
v_permlane32_swap_b32 v21, v22
s_nop 1
v_add_f32 v21, v21, v22
v_lshlrev_b32 v22, 1, v32
s_lshl_b32 s66, s34, 6
v_add_u32 v23, s66, v22
ds_write_b64 v23, v[20:21] offset:0
v_mov_b32 v23, 0
s_waitcnt lgkmcnt(0)
s_mov_b64 exec, 1
ds_add_u32 v23, v9 offset:332
s_mov_b64 exec, -1
s_mov_b32 s75, 0
L_poll_143:
ds_read_b32 v24, v23 offset:332
s_waitcnt lgkmcnt(0)
v_cmp_gt_u32 vcc, 4, v24
s_cbranch_vccz L_pollx_144
s_add_u32 s75, s75, 1
s_cmp_lt_u32 s75, 0x1000000
s_cbranch_scc1 L_poll_143
L_pollx_144:
ds_read_b64 v[112:113], v22 offset:0
ds_read_b64 v[114:115], v22 offset:64
ds_read_b64 v[116:117], v22 offset:128
ds_read_b64 v[118:119], v22 offset:192
s_waitcnt lgkmcnt(0)
v_add_f32 v20, v112, v114
v_add_f32 v21, v116, v118
v_add_f32 v20, v20, v21
v_mul_f32 v20, 0x3e800000, v20
v_add_f32 v24, v113, v115
v_add_f32 v21, v117, v119
v_add_f32 v24, v24, v21
v_mov_b32 v21, 0
v_sub_f32 v22, v112, v20
v_fmac_f32 v21, v22, v22
v_sub_f32 v22, v114, v20
v_fmac_f32 v21, v22, v22
v_sub_f32 v22, v116, v20
v_fmac_f32 v21, v22, v22
v_sub_f32 v22, v118, v20
v_fmac_f32 v21, v22, v22
v_fmac_f32 v24, 0x43000000, v21
v_mul_f32 v24, 0x3b000000, v24
v_cvt_pk_bf16_f32 v24, 0, v24
v_cvt_pk_bf16_f32 v20, 0, v20
v_add_f32 v24, 0x3727c5ac, v24
v_cvt_pk_bf16_f32 v24, 0, v24
v_sqrt_f32 v24, v24
s_nop 0
v_cvt_pk_bf16_f32 v24, 0, v24
v_rcp_f32 v24, v24
s_nop 0
v_sub_f32 v96, v96, v20
v_cvt_pk_bf16_f32 v96, 0, v96
v_mul_f32 v96, v96, v24
v_cvt_pk_bf16_f32 v96, 0, v96
v_sub_f32 v97, v97, v20
v_cvt_pk_bf16_f32 v97, 0, v97
v_mul_f32 v97, v97, v24
v_cvt_pk_bf16_f32 v97, 0, v97
v_sub_f32 v98, v98, v20
v_cvt_pk_bf16_f32 v98, 0, v98
v_mul_f32 v98, v98, v24
v_cvt_pk_bf16_f32 v98, 0, v98
v_sub_f32 v99, v99, v20
v_cvt_pk_bf16_f32 v99, 0, v99
v_mul_f32 v99, v99, v24
v_cvt_pk_bf16_f32 v99, 0, v99
v_sub_f32 v100, v100, v20
v_cvt_pk_bf16_f32 v100, 0, v100
v_mul_f32 v100, v100, v24
v_cvt_pk_bf16_f32 v100, 0, v100
v_sub_f32 v101, v101, v20
v_cvt_pk_bf16_f32 v101, 0, v101
v_mul_f32 v101, v101, v24
v_cvt_pk_bf16_f32 v101, 0, v101
v_sub_f32 v102, v102, v20
v_cvt_pk_bf16_f32 v102, 0, v102
v_mul_f32 v102, v102, v24
v_cvt_pk_bf16_f32 v102, 0, v102
v_sub_f32 v103, v103, v20
v_cvt_pk_bf16_f32 v103, 0, v103
v_mul_f32 v103, v103, v24
v_cvt_pk_bf16_f32 v103, 0, v103
v_sub_f32 v104, v104, v20
v_cvt_pk_bf16_f32 v104, 0, v104
v_mul_f32 v104, v104, v24
v_cvt_pk_bf16_f32 v104, 0, v104
v_sub_f32 v105, v105, v20
v_cvt_pk_bf16_f32 v105, 0, v105
v_mul_f32 v105, v105, v24
v_cvt_pk_bf16_f32 v105, 0, v105
v_sub_f32 v106, v106, v20
v_cvt_pk_bf16_f32 v106, 0, v106
v_mul_f32 v106, v106, v24
v_cvt_pk_bf16_f32 v106, 0, v106
v_sub_f32 v107, v107, v20
v_cvt_pk_bf16_f32 v107, 0, v107
v_mul_f32 v107, v107, v24
v_cvt_pk_bf16_f32 v107, 0, v107
v_sub_f32 v108, v108, v20
v_cvt_pk_bf16_f32 v108, 0, v108
v_mul_f32 v108, v108, v24
v_cvt_pk_bf16_f32 v108, 0, v108
v_sub_f32 v109, v109, v20
v_cvt_pk_bf16_f32 v109, 0, v109
v_mul_f32 v109, v109, v24
v_cvt_pk_bf16_f32 v109, 0, v109
v_sub_f32 v110, v110, v20
v_cvt_pk_bf16_f32 v110, 0, v110
v_mul_f32 v110, v110, v24
v_cvt_pk_bf16_f32 v110, 0, v110
v_sub_f32 v111, v111, v20
v_cvt_pk_bf16_f32 v111, 0, v111
v_mul_f32 v111, v111, v24
v_cvt_pk_bf16_f32 v111, 0, v111
L_g2:
s_cmp_ge_u32 s2, s73
s_cbranch_scc0 L_fl_145
s_waitcnt vmcnt(0)
v_cmp_eq_u32 vcc, 0, v31
s_cbranch_vccz L_fl_145
s_mov_b32 s75, 0
L_poll_146:
buffer_load_dword v31, v30, s[52:55], 0 offen sc1
s_waitcnt vmcnt(0)
v_cmp_eq_u32 vcc, 0, v31
s_cbranch_vccz L_pollx_147
s_sleep 40
s_add_u32 s75, s75, 1
s_cmp_lt_u32 s75, 0x100000
s_cbranch_scc1 L_poll_146
L_pollx_147:
L_fl_145:
v_mov_b32 v20, 0
s_cmp_eq_u32 s34, 0
s_cbranch_scc0 L_w_148
ds_write_b32 v20, v9 offset:324
L_w_148:
v_lshrrev_b32 v18, 4, v0
v_bfe_u32 v19, v0, 2, 2
v_lshrrev_b32 v20, 1, v19
v_and_b32 v21, 1, v18
v_lshl_add_u32 v20, v21, 1, v20
v_lshlrev_b32 v20, 5, v20
v_lshl_add_u32 v20, v18, 10, v20
v_lshl_add_u32 v20, v19, 7, v20
v_and_b32 v21, 3, v0
v_lshl_add_u32 v20, v21, 3, v20
v_add_u32 v40, s65, v20
v_xor_b32 v41, 32, v40
v_xor_b32 v42, 64, v40
v_xor_b32 v43, 96, v40
s_cmp_eq_u32 s77, 0
s_cbranch_scc1 L_pc_149
s_waitcnt vmcnt(13) lgkmcnt(0)
s_branch L_pc_150
L_pc_149:
s_waitcnt vmcnt(12) lgkmcnt(0)
L_pc_150:
ds_read_b64_tr_b16 v[128:129], v40 offset:0
ds_read_b64_tr_b16 v[130:131], v40 offset:512
ds_read_b64_tr_b16 v[132:133], v41 offset:0
ds_read_b64_tr_b16 v[134:135], v41 offset:512
ds_read_b64_tr_b16 v[136:137], v42 offset:0
ds_read_b64_tr_b16 v[138:139], v42 offset:512
ds_read_b64_tr_b16 v[140:141], v43 offset:0
ds_read_b64_tr_b16 v[142:143], v43 offset:512
s_cmp_eq_u32 s77, 0
s_cbranch_scc1 L_pc_151
s_waitcnt vmcnt(9) lgkmcnt(0)
s_branch L_pc_152
L_pc_151:
s_waitcnt vmcnt(8) lgkmcnt(0)
L_pc_152:
ds_read_b64_tr_b16 v[144:145], v40 offset:4096
ds_read_b64_tr_b16 v[146:147], v40 offset:4608
ds_read_b64_tr_b16 v[148:149], v41 offset:4096
ds_read_b64_tr_b16 v[150:151], v41 offset:4608
ds_read_b64_tr_b16 v[152:153], v42 offset:4096
ds_read_b64_tr_b16 v[154:155], v42 offset:4608
ds_read_b64_tr_b16 v[156:157], v43 offset:4096
ds_read_b64_tr_b16 v[158:159], v43 offset:4608
s_cmp_eq_u32 s77, 0
s_cbranch_scc1 L_pc_153
s_waitcnt vmcnt(5) lgkmcnt(0)
s_branch L_pc_154
L_pc_153:
s_waitcnt vmcnt(4) lgkmcnt(0)
L_pc_154:
ds_read_b64_tr_b16 v[160:161], v40 offset:32768
ds_read_b64_tr_b16 v[162:163], v40 offset:33280
ds_read_b64_tr_b16 v[164:165], v41 offset:32768
ds_read_b64_tr_b16 v[166:167], v41 offset:33280
ds_read_b64_tr_b16 v[168:169], v42 offset:32768
ds_read_b64_tr_b16 v[170:171], v42 offset:33280
ds_read_b64_tr_b16 v[172:173], v43 offset:32768
ds_read_b64_tr_b16 v[174:175], v43 offset:33280
s_cmp_eq_u32 s77, 0
s_cbranch_scc1 L_pc_155
s_waitcnt vmcnt(1) lgkmcnt(0)
s_branch L_pc_156
L_pc_155:
s_waitcnt vmcnt(0) lgkmcnt(0)
L_pc_156:
ds_read_b64_tr_b16 v[176:177], v40 offset:36864
ds_read_b64_tr_b16 v[178:179], v40 offset:37376
ds_read_b64_tr_b16 v[180:181], v41 offset:36864
ds_read_b64_tr_b16 v[182:183], v41 offset:37376
ds_read_b64_tr_b16 v[184:185], v42 offset:36864
ds_read_b64_tr_b16 v[186:187], v42 offset:37376
ds_read_b64_tr_b16 v[188:189], v43 offset:36864
ds_read_b64_tr_b16 v[190:191], v43 offset:37376
s_waitcnt lgkmcnt(0)
s_cmp_eq_u32 s34, 2
s_cselect_b32 s73, 16, 0x1000
v_and_b32 v30, 31, v0
v_lshlrev_b32 v30, 2, v30
s_cmp_ge_u32 s2, s73
s_cbranch_scc0 L_fl_157
buffer_load_dword v31, v30, s[52:55], 0 offen offset:128 sc1
L_fl_157:
s_cmp_lt_u32 s2, 48
s_cbranch_scc1 L_g3
v_mov_b32 v20, 0
s_mov_b32 s75, 0
L_poll_158:
ds_read_b32 v22, v20 offset:324
s_waitcnt lgkmcnt(0)
v_cmp_eq_u32 vcc, 0, v22
s_cbranch_vccz L_pollx_159
s_sleep 1
s_add_u32 s75, s75, 1
s_cmp_lt_u32 s75, 0x1000000
s_cbranch_scc1 L_poll_158
L_pollx_159:
s_lshl_b32 s64, s34, 11
s_add_u32 s64, s64, 0
s_add_u32 s66, s64, 8192
s_mov_b32 s75, 0
L_poll_160:
buffer_load_dwordx4 v[192:195], v1, s[36:39], s64 offen offset:0 sc1
buffer_load_dwordx4 v[200:203], v1, s[36:39], s66 offen offset:0 sc1
buffer_load_dwordx4 v[196:199], v1, s[36:39], s64 offen offset:1024 sc1
buffer_load_dwordx4 v[204:207], v1, s[36:39], s66 offen offset:1024 sc1
s_waitcnt vmcnt(0)
v_max3_u32 v22, v192, v193, v194
v_max3_u32 v22, v22, v195, v196
v_max3_u32 v22, v22, v197, v198
v_max3_u32 v22, v22, v199, v200
v_max3_u32 v22, v22, v201, v202
v_max3_u32 v22, v22, v203, v204
v_max3_u32 v22, v22, v205, v206
v_max_u32 v22, v22, v207
v_cmp_eq_u32 vcc, -1, v22
s_cbranch_vccz L_pollx_161
s_sleep 4
s_add_u32 s75, s75, 1
s_cmp_lt_u32 s75, 0x100000
s_cbranch_scc1 L_poll_160
L_pollx_161:
v_lshlrev_b32 v20, 16, v200
v_and_b32 v21, s68, v200
v_add_f32 v20, 1.0, v20
v_add_f32 v21, 1.0, v21
v_cvt_pk_bf16_f32 v20, 0, v20
v_cvt_pk_bf16_f32 v21, 0, v21
v_mul_f32 v20, v20, v96
v_mul_f32 v21, v21, v97
v_cvt_pk_bf16_f32 v20, 0, v20
v_cvt_pk_bf16_f32 v21, 0, v21
v_lshlrev_b32 v22, 16, v192
v_and_b32 v23, s68, v192
v_add_f32 v20, v20, v22
v_add_f32 v21, v21, v23
v_cvt_pk_bf16_f32 v48, v20, v21
v_lshlrev_b32 v20, 16, v201
v_and_b32 v21, s68, v201
v_add_f32 v20, 1.0, v20
v_add_f32 v21, 1.0, v21
v_cvt_pk_bf16_f32 v20, 0, v20
v_cvt_pk_bf16_f32 v21, 0, v21
v_mul_f32 v20, v20, v98
v_mul_f32 v21, v21, v99
v_cvt_pk_bf16_f32 v20, 0, v20
v_cvt_pk_bf16_f32 v21, 0, v21
v_lshlrev_b32 v22, 16, v193
v_and_b32 v23, s68, v193
v_add_f32 v20, v20, v22
v_add_f32 v21, v21, v23
v_cvt_pk_bf16_f32 v49, v20, v21
v_lshlrev_b32 v20, 16, v202
v_and_b32 v21, s68, v202
v_add_f32 v20, 1.0, v20
v_add_f32 v21, 1.0, v21
v_cvt_pk_bf16_f32 v20, 0, v20
v_cvt_pk_bf16_f32 v21, 0, v21
v_mul_f32 v20, v20, v100
v_mul_f32 v21, v21, v101
v_cvt_pk_bf16_f32 v20, 0, v20
v_cvt_pk_bf16_f32 v21, 0, v21
v_lshlrev_b32 v22, 16, v194
v_and_b32 v23, s68, v194
v_add_f32 v20, v20, v22
v_add_f32 v21, v21, v23
v_cvt_pk_bf16_f32 v50, v20, v21
v_lshlrev_b32 v20, 16, v203
v_and_b32 v21, s68, v203
v_add_f32 v20, 1.0, v20
v_add_f32 v21, 1.0, v21
v_cvt_pk_bf16_f32 v20, 0, v20
v_cvt_pk_bf16_f32 v21, 0, v21
v_mul_f32 v20, v20, v102
v_mul_f32 v21, v21, v103
v_cvt_pk_bf16_f32 v20, 0, v20
v_cvt_pk_bf16_f32 v21, 0, v21
v_lshlrev_b32 v22, 16, v195
v_and_b32 v23, s68, v195
v_add_f32 v20, v20, v22
v_add_f32 v21, v21, v23
v_cvt_pk_bf16_f32 v51, v20, v21
v_lshlrev_b32 v20, 16, v204
v_and_b32 v21, s68, v204
v_add_f32 v20, 1.0, v20
v_add_f32 v21, 1.0, v21
v_cvt_pk_bf16_f32 v20, 0, v20
v_cvt_pk_bf16_f32 v21, 0, v21
v_mul_f32 v20, v20, v104
v_mul_f32 v21, v21, v105
v_cvt_pk_bf16_f32 v20, 0, v20
v_cvt_pk_bf16_f32 v21, 0, v21
v_lshlrev_b32 v22, 16, v196
v_and_b32 v23, s68, v196
v_add_f32 v20, v20, v22
v_add_f32 v21, v21, v23
v_cvt_pk_bf16_f32 v52, v20, v21
v_lshlrev_b32 v20, 16, v205
v_and_b32 v21, s68, v205
v_add_f32 v20, 1.0, v20
v_add_f32 v21, 1.0, v21
v_cvt_pk_bf16_f32 v20, 0, v20
v_cvt_pk_bf16_f32 v21, 0, v21
v_mul_f32 v20, v20, v106
v_mul_f32 v21, v21, v107
v_cvt_pk_bf16_f32 v20, 0, v20
v_cvt_pk_bf16_f32 v21, 0, v21
v_lshlrev_b32 v22, 16, v197
v_and_b32 v23, s68, v197
v_add_f32 v20, v20, v22
v_add_f32 v21, v21, v23
v_cvt_pk_bf16_f32 v53, v20, v21
v_lshlrev_b32 v20, 16, v206
v_and_b32 v21, s68, v206
v_add_f32 v20, 1.0, v20
v_add_f32 v21, 1.0, v21
v_cvt_pk_bf16_f32 v20, 0, v20
v_cvt_pk_bf16_f32 v21, 0, v21
v_mul_f32 v20, v20, v108
v_mul_f32 v21, v21, v109
v_cvt_pk_bf16_f32 v20, 0, v20
v_cvt_pk_bf16_f32 v21, 0, v21
v_lshlrev_b32 v22, 16, v198
v_and_b32 v23, s68, v198
v_add_f32 v20, v20, v22
v_add_f32 v21, v21, v23
v_cvt_pk_bf16_f32 v54, v20, v21
v_lshlrev_b32 v20, 16, v207
v_and_b32 v21, s68, v207
v_add_f32 v20, 1.0, v20
v_add_f32 v21, 1.0, v21
v_cvt_pk_bf16_f32 v20, 0, v20
v_cvt_pk_bf16_f32 v21, 0, v21
v_mul_f32 v20, v20, v110
v_mul_f32 v21, v21, v111
v_cvt_pk_bf16_f32 v20, 0, v20
v_cvt_pk_bf16_f32 v21, 0, v21
v_lshlrev_b32 v22, 16, v199
v_and_b32 v23, s68, v199
v_add_f32 v20, v20, v22
v_add_f32 v21, v21, v23
v_cvt_pk_bf16_f32 v55, v20, v21
L_g3:
s_cmp_ge_u32 s2, s73
s_cbranch_scc0 L_fl_162
s_waitcnt vmcnt(0)
v_cmp_eq_u32 vcc, 0, v31
s_cbranch_vccz L_fl_162
s_mov_b32 s75, 0
L_poll_163:
buffer_load_dword v31, v30, s[52:55], 0 offen offset:128 sc1
s_waitcnt vmcnt(0)
v_cmp_eq_u32 vcc, 0, v31
s_cbranch_vccz L_pollx_164
s_sleep 40
s_add_u32 s75, s75, 1
s_cmp_lt_u32 s75, 0x100000
s_cbranch_scc1 L_poll_163
L_pollx_164:
L_fl_162:
s_nop 1
v_mfma_f32_16x16x32_bf16 v[64:67], v[128:131], v[48:51], 0
v_mfma_f32_16x16x32_bf16 v[68:71], v[132:135], v[48:51], 0
v_mfma_f32_16x16x32_bf16 v[72:75], v[136:139], v[48:51], 0
v_mfma_f32_16x16x32_bf16 v[76:79], v[140:143], v[48:51], 0
v_mfma_f32_16x16x32_bf16 v[80:83], v[144:147], v[48:51], 0
v_mfma_f32_16x16x32_bf16 v[84:87], v[148:151], v[48:51], 0
v_mfma_f32_16x16x32_bf16 v[88:91], v[152:155], v[48:51], 0
v_mfma_f32_16x16x32_bf16 v[92:95], v[156:159], v[48:51], 0
v_mfma_f32_16x16x32_bf16 v[64:67], v[160:163], v[52:55], v[64:67]
v_mfma_f32_16x16x32_bf16 v[68:71], v[164:167], v[52:55], v[68:71]
v_mfma_f32_16x16x32_bf16 v[72:75], v[168:171], v[52:55], v[72:75]
v_mfma_f32_16x16x32_bf16 v[76:79], v[172:175], v[52:55], v[76:79]
v_mfma_f32_16x16x32_bf16 v[80:83], v[176:179], v[52:55], v[80:83]
v_mfma_f32_16x16x32_bf16 v[84:87], v[180:183], v[52:55], v[84:87]
v_mfma_f32_16x16x32_bf16 v[88:91], v[184:187], v[52:55], v[88:91]
v_mfma_f32_16x16x32_bf16 v[92:95], v[188:191], v[52:55], v[92:95]
v_and_b32 v20, 7, v0
v_mul_u32_u24 v20, 272, v20
v_and_b32 v21, 8, v0
v_lshl_add_u32 v20, v21, 3, v20
v_and_b32 v21, 48, v0
v_add_u32 v20, v20, v21
s_mul_i32 s64, s34, 8192
s_add_u32 s64, s64, 4096
v_add_u32 v20, s64, v20
s_nop 7
v_add_f32_dpp v24, v80, v64 row_ror:8 row_mask:0xf bank_mask:0x3
v_add_f32_dpp v24, v68, v84 row_ror:8 row_mask:0xf bank_mask:0xc
v_add_f32_dpp v25, v81, v65 row_ror:8 row_mask:0xf bank_mask:0x3
v_add_f32_dpp v25, v69, v85 row_ror:8 row_mask:0xf bank_mask:0xc
v_add_f32_dpp v26, v82, v66 row_ror:8 row_mask:0xf bank_mask:0x3
v_add_f32_dpp v26, v70, v86 row_ror:8 row_mask:0xf bank_mask:0xc
v_add_f32_dpp v27, v83, v67 row_ror:8 row_mask:0xf bank_mask:0x3
v_add_f32_dpp v27, v71, v87 row_ror:8 row_mask:0xf bank_mask:0xc
ds_write_b128 v20, v[24:27] offset:0
v_add_f32_dpp v28, v88, v72 row_ror:8 row_mask:0xf bank_mask:0x3
v_add_f32_dpp v28, v76, v92 row_ror:8 row_mask:0xf bank_mask:0xc
v_add_f32_dpp v29, v89, v73 row_ror:8 row_mask:0xf bank_mask:0x3
v_add_f32_dpp v29, v77, v93 row_ror:8 row_mask:0xf bank_mask:0xc
v_add_f32_dpp v30, v90, v74 row_ror:8 row_mask:0xf bank_mask:0x3
v_add_f32_dpp v30, v78, v94 row_ror:8 row_mask:0xf bank_mask:0xc
v_add_f32_dpp v31, v91, v75 row_ror:8 row_mask:0xf bank_mask:0x3
v_add_f32_dpp v31, v79, v95 row_ror:8 row_mask:0xf bank_mask:0xc
ds_write_b128 v20, v[28:31] offset:128
v_mov_b32 v20, 0
s_waitcnt lgkmcnt(0)
s_mov_b64 exec, 1
ds_add_u32 v20, v9 offset:320
s_mov_b64 exec, -1
s_cmp_eq_u32 s34, 0
s_cbranch_scc0 L_waitq
s_cmp_lt_u32 s2, 16
s_cbranch_scc0 L_gq2
v_and_b32 v21, 7, v0
v_lshrrev_b32 v22, 4, v0
v_and_b32 v23, 8, v0
v_lshrrev_b32 v23, 1, v23
v_add_u32 v22, v22, v23
v_mov_b32 v23, v1
s_lshl_b32 s64, s72, 10
s_add_u32 s64, s64, 0
s_branch L_g4
L_gq2:
v_lshrrev_b32 v21, 3, v0
v_and_b32 v22, 7, v0
s_mov_b32 s64, 10240
s_cmp_lt_u32 s2, 48
s_cselect_b32 s64, 22528, s64
s_mov_b32 s65, 12288
v_mul_lo_u32 v23, s65, v21
v_lshl_add_u32 v23, v22, 4, v23
s_lshl_b32 s66, s72, 7
s_add_u32 s64, s64, s66
L_g4:
v_mul_u32_u24 v21, 272, v21
v_lshl_add_u32 v21, v22, 5, v21
v_add_u32 v21, 4096, v21
s_mov_b32 s75, 0
L_poll_165:
ds_read_b32 v22, v20 offset:320
s_waitcnt lgkmcnt(0)
v_cmp_gt_u32 vcc, 4, v22
s_cbranch_vccz L_pollx_166
s_add_u32 s75, s75, 1
s_cmp_lt_u32 s75, 0x1000000
s_cbranch_scc1 L_poll_165
L_pollx_166:
ds_read_b128 v[64:67], v21 offset:0
ds_read_b128 v[68:71], v21 offset:16
ds_read_b128 v[72:75], v21 offset:8192
ds_read_b128 v[76:79], v21 offset:8208
ds_read_b128 v[80:83], v21 offset:16384
ds_read_b128 v[84:87], v21 offset:16400
ds_read_b128 v[88:91], v21 offset:24576
ds_read_b128 v[92:95], v21 offset:24592
s_waitcnt lgkmcnt(0)
v_add_f32 v64, v64, v72
v_add_f32 v65, v65, v73
v_add_f32 v66, v66, v74
v_add_f32 v67, v67, v75
v_add_f32 v68, v68, v76
v_add_f32 v69, v69, v77
v_add_f32 v70, v70, v78
v_add_f32 v71, v71, v79
v_add_f32 v64, v64, v80
v_add_f32 v65, v65, v81
v_add_f32 v66, v66, v82
v_add_f32 v67, v67, v83
v_add_f32 v68, v68, v84
v_add_f32 v69, v69, v85
v_add_f32 v70, v70, v86
v_add_f32 v71, v71, v87
v_add_f32 v64, v64, v88
v_add_f32 v65, v65, v89
v_add_f32 v66, v66, v90
v_add_f32 v67, v67, v91
v_add_f32 v68, v68, v92
v_add_f32 v69, v69, v93
v_add_f32 v70, v70, v94
v_add_f32 v71, v71, v95
v_cvt_pk_bf16_f32 v24, v64, v65
v_cvt_pk_bf16_f32 v25, v66, v67
v_cvt_pk_bf16_f32 v26, v68, v69
v_cvt_pk_bf16_f32 v27, v70, v71
v_min_u32 v24, -2, v24
v_min_u32 v25, -2, v25
v_min_u32 v26, -2, v26
v_min_u32 v27, -2, v27
buffer_store_dwordx4 v[24:27], v23, s[36:39], s64 offen sc1
s_branch L_waitq
L_jan:
v_mov_b32 v4, -1
v_mov_b32 v5, -1
v_mov_b32 v6, -1
v_mov_b32 v7, -1
s_lshl_b32 s67, s64, 2
s_add_u32 s67, s67, s34
s_cmp_lt_u32 s67, 32
s_cselect_b32 s66, 0, 933888
s_mul_i32 s65, s67, 3072
s_add_u32 s65, s65, s66
s_add_u32 s65, s65, 16384
v_add_u32 v8, s65, v1
global_store_dwordx4 v8, v[4:7], s[30:31] offset:0 sc1
global_store_dwordx4 v8, v[4:7], s[30:31] offset:1024 sc1
global_store_dwordx4 v8, v[4:7], s[30:31] offset:2048 sc1
s_and_b32 s66, s67, 64
s_add_u32 s67, s67, s66
s_lshl_b32 s67, s67, 7
s_add_u32 s67, s67, 1343488
v_and_b32 v8, 8, v0
v_lshlrev_b32 v8, 10, v8
v_and_b32 v10, 0x70, v1
v_add3_u32 v8, v8, v10, s67
s_mov_b64 exec, 0xffff
global_store_dwordx4 v8, v[4:7], s[30:31] sc1
s_mov_b64 exec, 1
s_load_dword s68, s[30:31], 0x48000
s_and_b32 s65, s34, 1
s_lshl_b32 s66, s65, 13
s_xor_b32 s67, s67, s66
s_xor_b32 s66, s67, 0x2000
s_waitcnt vmcnt(0) lgkmcnt(0)
s_mov_b64 exec, -1
s_cmp_eq_u32 s34, 3
s_cbranch_scc1 L_p0_167
s_cmp_eq_u32 s34, 0
s_cselect_b32 s62, s24, s10
s_cselect_b32 s63, s25, s11
s_cmp_eq_u32 s34, 2
s_cselect_b32 s62, s12, s62
s_cselect_b32 s63, s13, s63
global_load_dword v12, v38, s[62:63]
global_load_dword v13, v39, s[62:63]
L_p0_167:
s_mov_b64 exec, 1
s_mov_b32 s70, 0
s_load_dword s68, s[30:31], s67
L_race_168:
s_getreg_b32 s69, hwreg(HW_REG_IB_STS, 8, 4)
s_add_u32 s70, s70, 1
s_cmp_eq_u32 s69, 0
s_cbranch_scc0 L_race_168
s_waitcnt lgkmcnt(0)
s_mov_b32 s71, 0
s_load_dword s68, s[30:31], s66
L_race_169:
s_getreg_b32 s69, hwreg(HW_REG_IB_STS, 8, 4)
s_add_u32 s71, s71, 1
s_cmp_eq_u32 s69, 0
s_cbranch_scc0 L_race_169
s_waitcnt lgkmcnt(0)
s_cmp_lt_u32 s71, s70
s_cselect_b32 s70, 1, 0
s_xor_b32 s70, s70, s65
s_getreg_b32 s69, hwreg(HW_REG_XCC_ID, 2, 1)
s_xor_b32 s70, s70, s69
s_lshl_b32 s69, s69, 14
s_lshl_b32 s70, s70, 8
s_add_u32 s70, s70, s69
s_add_u32 s70, s70, 1
v_mov_b32 v9, s70
s_lshl_b32 s65, s64, 2
v_mov_b32 v8, s65
ds_add_rtn_u32 v11, v2, v9 offset:320
s_waitcnt lgkmcnt(0)
v_add_u32 v11, v11, v9
v_and_b32 v10, 0xff, v11
v_cmp_eq_u32 vcc, 4, v10
s_cbranch_vccz L_j_170
global_store_dword v8, v11, s[28:29] offset:128 sc1
L_j_170:
s_mov_b64 exec, -1
s_branch L_nop0
L_norole:
s_cmp_eq_u32 s74, -1
s_cbranch_scc1 L_waitq
L_waitq:
s_cmp_eq_u32 s74, -1
s_cselect_b64 vcc, 0, -1
s_cmp_lt_u32 s2, 112
s_cselect_b64 vcc, -1, vcc
s_mov_b32 s44, s12
s_mov_b32 s45, s13
s_mov_b32 s46, 0x400000
s_mov_b32 s47, 0x20000
v_lshrrev_b32 v18, 4, v0
v_and_b32 v16, 15, v0
v_xor_b32 v16, v16, v18
v_xor_b32 v17, 4, v16
v_lshlrev_b32 v19, 10, v18
v_lshl_add_u32 v22, v16, 4, v19
v_lshl_add_u32 v23, v17, 4, v19
v_and_b32 v19, 1, v18
v_lshlrev_b32 v19, 10, v19
v_lshrrev_b32 v18, 1, v18
v_lshl_add_u32 v18, v18, 11, v19
v_lshl_add_u32 v16, v16, 4, v18
v_lshl_add_u32 v17, v17, 4, v18
v_lshrrev_b32 v18, 4, v0
v_bfe_u32 v19, v0, 2, 2
v_and_b32 v20, 2, v0
v_lshlrev_b32 v20, 2, v20
v_xor_b32 v20, v20, v19
v_and_b32 v21, 1, v18
v_lshlrev_b32 v21, 2, v21
v_xor_b32 v20, v20, v21
v_lshlrev_b32 v20, 4, v20
v_lshl_add_u32 v20, v18, 10, v20
v_lshl_add_u32 v20, v19, 8, v20
v_and_b32 v21, 1, v0
v_lshl_add_u32 v20, v21, 3, v20
s_lshl_b32 s65, s34, 13
s_add_u32 s65, s65, 8192
v_add_u32 v40, s65, v20
v_xor_b32 v41, 16, v40
v_xor_b32 v42, 32, v40
v_xor_b32 v43, 48, v40
v_xor_b32 v44, 64, v40
v_xor_b32 v45, 80, v40
v_xor_b32 v46, 96, v40
v_xor_b32 v47, 112, v40
s_lshl_b32 s64, s33, 17
s_lshl_b32 s66, s34, 8
s_add_u32 s64, s64, s66
s_mov_b32 s68, 0
s_lshl_b32 s66, s68, 10
s_add_u32 s64, s64, s66
s_add_u32 m0, s65, 0
s_xor_b32 s66, s64, 0
buffer_load_dwordx4 v16, s[44:47], s66 offen  lds
s_add_u32 m0, s65, 1024
s_xor_b32 s66, s64, 8192
buffer_load_dwordx4 v17, s[44:47], s66 offen  lds
s_add_u32 m0, s65, 2048
s_xor_b32 s66, s64, 16384
buffer_load_dwordx4 v16, s[44:47], s66 offen  lds
s_waitcnt vmcnt(2)
s_add_u32 m0, s65, 3072
s_xor_b32 s66, s64, 24576
buffer_load_dwordx4 v17, s[44:47], s66 offen  lds
s_waitcnt vmcnt(2)
s_add_u32 m0, s65, 32768
s_xor_b32 s66, s64, 4096
buffer_load_dwordx4 v16, s[44:47], s66 offen  lds
s_waitcnt vmcnt(2)
s_add_u32 m0, s65, 33792
s_xor_b32 s66, s64, 12288
buffer_load_dwordx4 v17, s[44:47], s66 offen  lds
s_waitcnt vmcnt(2)
ds_read_b64_tr_b16 v[128:129], v40 offset:0
ds_read_b64_tr_b16 v[136:137], v41 offset:0
ds_read_b64_tr_b16 v[144:145], v42 offset:0
ds_read_b64_tr_b16 v[152:153], v43 offset:0
ds_read_b64_tr_b16 v[160:161], v44 offset:0
ds_read_b64_tr_b16 v[168:169], v45 offset:0
ds_read_b64_tr_b16 v[176:177], v46 offset:0
ds_read_b64_tr_b16 v[184:185], v47 offset:0
s_add_u32 m0, s65, 34816
s_xor_b32 s66, s64, 20480
buffer_load_dwordx4 v16, s[44:47], s66 offen  lds
s_waitcnt vmcnt(2)
s_add_u32 m0, s65, 35840
s_xor_b32 s66, s64, 28672
buffer_load_dwordx4 v17, s[44:47], s66 offen  lds
s_waitcnt vmcnt(2)
s_waitcnt lgkmcnt(0)
s_add_u32 m0, s65, 0
s_xor_b32 s66, s64, 32768
buffer_load_dwordx4 v16, s[44:47], s66 offen  lds
s_waitcnt vmcnt(2)
s_add_u32 m0, s65, 1024
s_xor_b32 s66, s64, 40960
buffer_load_dwordx4 v17, s[44:47], s66 offen  lds
s_waitcnt vmcnt(2)
ds_read_b64_tr_b16 v[130:131], v40 offset:32768
ds_read_b64_tr_b16 v[138:139], v41 offset:32768
ds_read_b64_tr_b16 v[146:147], v42 offset:32768
ds_read_b64_tr_b16 v[154:155], v43 offset:32768
ds_read_b64_tr_b16 v[162:163], v44 offset:32768
ds_read_b64_tr_b16 v[170:171], v45 offset:32768
ds_read_b64_tr_b16 v[178:179], v46 offset:32768
ds_read_b64_tr_b16 v[186:187], v47 offset:32768
s_add_u32 m0, s65, 2048
s_xor_b32 s66, s64, 49152
buffer_load_dwordx4 v16, s[44:47], s66 offen  lds
s_waitcnt vmcnt(2)
s_add_u32 m0, s65, 3072
s_xor_b32 s66, s64, 57344
buffer_load_dwordx4 v17, s[44:47], s66 offen  lds
s_waitcnt vmcnt(2)
s_waitcnt lgkmcnt(0)
s_add_u32 m0, s65, 32768
s_xor_b32 s66, s64, 36864
buffer_load_dwordx4 v16, s[44:47], s66 offen  lds
s_waitcnt vmcnt(2)
s_add_u32 m0, s65, 33792
s_xor_b32 s66, s64, 45056
buffer_load_dwordx4 v17, s[44:47], s66 offen  lds
s_waitcnt vmcnt(2)
ds_read_b64_tr_b16 v[132:133], v40 offset:0
ds_read_b64_tr_b16 v[140:141], v41 offset:0
ds_read_b64_tr_b16 v[148:149], v42 offset:0
ds_read_b64_tr_b16 v[156:157], v43 offset:0
ds_read_b64_tr_b16 v[164:165], v44 offset:0
ds_read_b64_tr_b16 v[172:173], v45 offset:0
ds_read_b64_tr_b16 v[180:181], v46 offset:0
ds_read_b64_tr_b16 v[188:189], v47 offset:0
s_add_u32 m0, s65, 34816
s_xor_b32 s66, s64, 53248
buffer_load_dwordx4 v16, s[44:47], s66 offen  lds
s_waitcnt vmcnt(2)
s_add_u32 m0, s65, 35840
s_xor_b32 s66, s64, 61440
buffer_load_dwordx4 v17, s[44:47], s66 offen  lds
s_waitcnt vmcnt(2)
s_waitcnt lgkmcnt(0)
s_add_u32 m0, s65, 0
s_xor_b32 s66, s64, 65536
buffer_load_dwordx4 v16, s[44:47], s66 offen  lds
s_waitcnt vmcnt(2)
s_add_u32 m0, s65, 1024
s_xor_b32 s66, s64, 73728
buffer_load_dwordx4 v17, s[44:47], s66 offen  lds
s_waitcnt vmcnt(2)
ds_read_b64_tr_b16 v[134:135], v40 offset:32768
ds_read_b64_tr_b16 v[142:143], v41 offset:32768
ds_read_b64_tr_b16 v[150:151], v42 offset:32768
ds_read_b64_tr_b16 v[158:159], v43 offset:32768
ds_read_b64_tr_b16 v[166:167], v44 offset:32768
ds_read_b64_tr_b16 v[174:175], v45 offset:32768
ds_read_b64_tr_b16 v[182:183], v46 offset:32768
ds_read_b64_tr_b16 v[190:191], v47 offset:32768
s_add_u32 m0, s65, 2048
s_xor_b32 s66, s64, 81920
buffer_load_dwordx4 v16, s[44:47], s66 offen  lds
s_waitcnt vmcnt(2)
s_add_u32 m0, s65, 3072
s_xor_b32 s66, s64, 90112
buffer_load_dwordx4 v17, s[44:47], s66 offen  lds
s_waitcnt vmcnt(2)
s_waitcnt lgkmcnt(0)
s_add_u32 m0, s65, 32768
s_xor_b32 s66, s64, 69632
buffer_load_dwordx4 v16, s[44:47], s66 offen  lds
s_waitcnt vmcnt(2)
s_add_u32 m0, s65, 33792
s_xor_b32 s66, s64, 77824
buffer_load_dwordx4 v17, s[44:47], s66 offen  lds
s_waitcnt vmcnt(2)
ds_read_b64_tr_b16 v[192:193], v40 offset:0
ds_read_b64_tr_b16 v[200:201], v41 offset:0
ds_read_b64_tr_b16 v[208:209], v42 offset:0
ds_read_b64_tr_b16 v[216:217], v43 offset:0
ds_read_b64_tr_b16 v[224:225], v44 offset:0
ds_read_b64_tr_b16 v[232:233], v45 offset:0
ds_read_b64_tr_b16 v[240:241], v46 offset:0
ds_read_b64_tr_b16 v[248:249], v47 offset:0
s_add_u32 m0, s65, 34816
s_xor_b32 s66, s64, 86016
buffer_load_dwordx4 v16, s[44:47], s66 offen  lds
s_waitcnt vmcnt(2)
s_add_u32 m0, s65, 35840
s_xor_b32 s66, s64, 94208
buffer_load_dwordx4 v17, s[44:47], s66 offen  lds
s_waitcnt vmcnt(2)
s_waitcnt lgkmcnt(0)
s_add_u32 m0, s65, 0
s_xor_b32 s66, s64, 98304
buffer_load_dwordx4 v16, s[44:47], s66 offen  lds
s_waitcnt vmcnt(2)
s_add_u32 m0, s65, 1024
s_xor_b32 s66, s64, 106496
buffer_load_dwordx4 v17, s[44:47], s66 offen  lds
s_waitcnt vmcnt(2)
ds_read_b64_tr_b16 v[194:195], v40 offset:32768
ds_read_b64_tr_b16 v[202:203], v41 offset:32768
ds_read_b64_tr_b16 v[210:211], v42 offset:32768
ds_read_b64_tr_b16 v[218:219], v43 offset:32768
ds_read_b64_tr_b16 v[226:227], v44 offset:32768
ds_read_b64_tr_b16 v[234:235], v45 offset:32768
ds_read_b64_tr_b16 v[242:243], v46 offset:32768
ds_read_b64_tr_b16 v[250:251], v47 offset:32768
v_and_b32 v24, 127, v2
buffer_load_dword v25, v24, s[52:55], 0 offen offset:128
s_add_u32 m0, s65, 2048
s_xor_b32 s66, s64, 114688
buffer_load_dwordx4 v16, s[44:47], s66 offen  lds
s_waitcnt vmcnt(2)
s_add_u32 m0, s65, 3072
s_xor_b32 s66, s64, 122880
buffer_load_dwordx4 v17, s[44:47], s66 offen  lds
s_waitcnt vmcnt(2)
s_waitcnt lgkmcnt(0)
s_add_u32 m0, s65, 32768
s_xor_b32 s66, s64, 102400
buffer_load_dwordx4 v16, s[44:47], s66 offen  lds
s_waitcnt vmcnt(2)
s_add_u32 m0, s65, 33792
s_xor_b32 s66, s64, 110592
buffer_load_dwordx4 v17, s[44:47], s66 offen  lds
s_waitcnt vmcnt(2)
ds_read_b64_tr_b16 v[196:197], v40 offset:0
ds_read_b64_tr_b16 v[204:205], v41 offset:0
ds_read_b64_tr_b16 v[212:213], v42 offset:0
ds_read_b64_tr_b16 v[220:221], v43 offset:0
ds_read_b64_tr_b16 v[228:229], v44 offset:0
ds_read_b64_tr_b16 v[236:237], v45 offset:0
ds_read_b64_tr_b16 v[244:245], v46 offset:0
ds_read_b64_tr_b16 v[252:253], v47 offset:0
s_add_u32 m0, s65, 34816
s_xor_b32 s66, s64, 118784
buffer_load_dwordx4 v16, s[44:47], s66 offen  lds
s_waitcnt vmcnt(2)
s_add_u32 m0, s65, 35840
s_xor_b32 s66, s64, 126976
buffer_load_dwordx4 v17, s[44:47], s66 offen  lds
s_waitcnt vmcnt(0)
ds_read_b64_tr_b16 v[198:199], v40 offset:32768
ds_read_b64_tr_b16 v[206:207], v41 offset:32768
ds_read_b64_tr_b16 v[214:215], v42 offset:32768
ds_read_b64_tr_b16 v[222:223], v43 offset:32768
ds_read_b64_tr_b16 v[230:231], v44 offset:32768
ds_read_b64_tr_b16 v[238:239], v45 offset:32768
ds_read_b64_tr_b16 v[246:247], v46 offset:32768
ds_read_b64_tr_b16 v[254:255], v47 offset:32768
s_waitcnt lgkmcnt(0)
v_cmp_eq_u32 vcc, 0, v25
s_cbranch_vccz L_tab_171
s_mov_b32 s75, 0
L_poll_172:
buffer_load_dword v25, v24, s[52:55], 0 offen offset:128 sc1
s_waitcnt vmcnt(0)
v_cmp_eq_u32 vcc, 0, v25
s_cbranch_vccz L_pollx_173
s_sleep 40
s_add_u32 s75, s75, 1
s_cmp_lt_u32 s75, 0x100000
s_cbranch_scc1 L_poll_172
L_pollx_173:
L_tab_171:
v_bfe_u32 v26, v25, 8, 3
v_lshrrev_b32 v25, 16, v25
s_nop 0
v_add_u32_dpp v26, v26, v26 quad_perm:[1,0,3,2] row_mask:0xf bank_mask:0xf
s_nop 1
v_add_u32_dpp v26, v26, v26 quad_perm:[2,3,0,1] row_mask:0xf bank_mask:0xf
s_nop 1
v_add_u32_dpp v26, v26, v26 row_ror:4 row_mask:0xf bank_mask:0xf
s_nop 1
v_add_u32_dpp v26, v26, v26 row_ror:8 row_mask:0xf bank_mask:0xf
s_nop 1
v_readlane_b32 s66, v26, 0
v_readlane_b32 s71, v26, 16
s_add_u32 s66, s66, s71
s_cmp_gt_u32 s66, 64
s_cselect_b32 s66, 1, 0
v_cmp_ne_u32 vcc, s66, v25
s_and_b32 s71, vcc_lo, 0xff
s_bcnt0_i32_b32 s66, s71
s_sub_u32 s66, s66, 24
v_mbcnt_lo_u32_b32 v24, s71, 0
v_sub_u32 v25, v0, v24
v_add_u32 v24, s66, v24
v_cndmask_b32 v24, v25, v24, vcc
v_bfe_u32 v25, v24, 1, 2
v_and_b32 v26, 1, v24
v_lshl_or_b32 v25, v26, 2, v25
v_lshlrev_b32 v25, v2, v25
s_nop 1
v_or_b32_dpp v25, v25, v25 quad_perm:[1,0,3,2] row_mask:0xf bank_mask:0xf
s_nop 1
v_or_b32_dpp v25, v25, v25 quad_perm:[2,3,0,1] row_mask:0xf bank_mask:0xf
s_nop 1
v_or_b32_dpp v25, v25, v25 row_shl:4 row_mask:0xf bank_mask:0xf
s_nop 1
v_readfirstlane_b32 s35, v25
s_mov_b64 exec, 1
ds_write_b32 v2, v25 offset:328
s_mov_b64 exec, -1
s_sub_u32 s64, s2, 144
s_cmp_lt_u32 s64, 64
s_cbranch_scc0 L_rp_174
s_cmp_eq_u32 s34, 0
s_cbranch_scc0 L_rp_174
s_mov_b32 s48, s4
s_mov_b32 s49, s5
s_mov_b32 s50, 0x2000
s_mov_b32 s51, 0x20000
v_and_b32 v5, 15, v0
v_and_b32 v6, 16, v0
v_lshl_add_u32 v5, v6, 1, v5
v_and_b32 v6, 32, v0
v_lshrrev_b32 v6, 1, v6
v_add_u32 v5, v5, v6
v_lshlrev_b32 v5, 1, v5
v_and_b32 v6, 0x7c, v5
s_lshl_b32 s65, s64, 7
s_and_b32 s66, s65, 0x380
s_lshr_b32 s64, s64, 3
s_mul_i32 s64, s64, 12288
s_add_u32 s64, s64, s66
s_add_u32 s64, s64, 24576
buffer_load_ushort v18, v5, s[48:51], s65 offen
s_mov_b32 s75, 0
L_poll_175:
buffer_load_dword v19, v6, s[36:39], s64 offen offset:0 sc1
buffer_load_dword v20, v6, s[36:39], s64 offen offset:3072 sc1
s_waitcnt vmcnt(0)
v_max_u32 v16, v19, v20
v_cmp_eq_u32 vcc, -1, v16
s_cbranch_vccz L_pollx_176
s_sleep 40
s_add_u32 s75, s75, 1
s_cmp_lt_u32 s75, 0x100000
s_cbranch_scc1 L_poll_175
L_pollx_176:
v_and_b32 v16, 1, v0
v_lshlrev_b32 v16, 4, v16
v_xor_b32 v16, 16, v16
v_lshlrev_b32 v18, 16, v18
v_lshlrev_b32 v19, v16, v19
v_and_b32 v19, 0xffff0000, v19
v_lshlrev_b32 v20, v16, v20
v_and_b32 v20, 0xffff0000, v20
ds_write_b32 v2, v18 offset:4096
ds_write_b32 v2, v19 offset:4352
ds_write_b32 v2, v20 offset:4608
L_rp_174:
v_lshlrev_b32 v10, 3, v0
s_lshl_b32 s64, s34, 8
s_add_u32 s64, s64, 2560
s_lshr_b32 s66, s68, 1
v_xor_b32 v12, s66, v0
v_mov_b32 v14, 0
v_bfe_u32 v11, v12, 0, 1
v_lshl_or_b32 v14, v11, 0, v14
v_bfe_u32 v11, v12, 1, 1
v_lshl_or_b32 v14, v11, 1, v14
v_bfe_u32 v11, v12, 2, 1
v_lshl_or_b32 v14, v11, 2, v14
v_bfe_u32 v11, v12, 3, 1
v_lshl_or_b32 v14, v11, 3, v14
v_bfe_u32 v11, v12, 4, 1
v_lshl_or_b32 v14, v11, 4, v14
v_bfe_u32 v11, v12, 5, 1
v_lshl_or_b32 v14, v11, 5, v14
v_and_b32 v11, 0x38, v14
v_and_b32 v12, 1, v14
v_lshl_add_u32 v11, v12, 2, v11
v_bfe_u32 v12, v14, 1, 2
v_add_u32 v11, v11, v12
v_lshl_add_u32 v11, v11, 2, s64
v_and_b32 v14, 1, v0
v_and_b32 v12, 48, v0
v_lshlrev_b32 v12, 1, v12
v_lshl_add_u32 v12, v14, 4, v12
v_add_u32 v12, s64, v12
v_mul_u32_u24 v15, 0xaaaa, v14
v_add_u32 v15, 0x4444, v15
v_mov_b32 v64, 0
v_mov_b32 v65, 0
v_mov_b32 v66, 0
v_mov_b32 v67, 0
v_mov_b32 v68, 0
v_mov_b32 v69, 0
v_mov_b32 v70, 0
v_mov_b32 v71, 0
v_mov_b32 v72, 0
v_mov_b32 v73, 0
v_mov_b32 v74, 0
v_mov_b32 v75, 0
v_mov_b32 v76, 0
v_mov_b32 v77, 0
v_mov_b32 v78, 0
v_mov_b32 v79, 0
v_mov_b32 v80, 0
v_mov_b32 v81, 0
v_mov_b32 v82, 0
v_mov_b32 v83, 0
v_mov_b32 v84, 0
v_mov_b32 v85, 0
v_mov_b32 v86, 0
v_mov_b32 v87, 0
v_mov_b32 v88, 0
v_mov_b32 v89, 0
v_mov_b32 v90, 0
v_mov_b32 v91, 0
v_mov_b32 v92, 0
v_mov_b32 v93, 0
v_mov_b32 v94, 0
v_mov_b32 v95, 0
s_lshl_b32 s64, s34, 3
s_lshr_b32 s64, s35, s64
v_bfe_u32 v13, v0, 3, 1
v_lshlrev_b32 v13, 2, v13
v_bfe_u32 v13, s64, v13, 3
v_and_b32 v14, 0x70, v1
v_lshl_add_u32 v13, v13, 12, v14
s_lshl_b32 s64, s34, 2
s_add_u32 s64, s64, s33
v_bfe_u32 v14, v0, 3, 1
v_lshl_add_u32 v14, v14, 1, s64
v_and_b32 v14, 31, v14
v_lshl_add_u32 v13, v14, 7, v13
s_lshl_b32 s69, s32, 15
s_add_u32 s69, s69, 1048576
s_waitcnt vmcnt(0) lgkmcnt(0)
s_barrier
ds_read_b64 v[20:21], v10 offset:512
ds_read_b64 v[22:23], v10 offset:1024
ds_read_b64 v[24:25], v10 offset:1536
ds_read_b64 v[26:27], v10 offset:2048
s_waitcnt lgkmcnt(2)
v_pk_add_f32 v[20:21], v[20:21], v[22:23]
s_waitcnt lgkmcnt(1)
v_pk_add_f32 v[20:21], v[20:21], v[24:25]
s_waitcnt lgkmcnt(0)
v_pk_add_f32 v[20:21], v[20:21], v[26:27]
v_cvt_pk_bf16_f32 v20, v20, v21
ds_write_b32 v11, v20
ds_read_b128 v[48:51], v12 offset:0
ds_read_b128 v[52:55], v12 offset:128
s_waitcnt lgkmcnt(1)
v_smfmac_f32_16x16x64_bf16 v[64:67], v[48:51], v[128:135], v15
v_smfmac_f32_16x16x64_bf16 v[68:71], v[48:51], v[136:143], v15
v_smfmac_f32_16x16x64_bf16 v[72:75], v[48:51], v[144:151], v15
v_smfmac_f32_16x16x64_bf16 v[76:79], v[48:51], v[152:159], v15
s_waitcnt lgkmcnt(0)
v_smfmac_f32_16x16x64_bf16 v[64:67], v[52:55], v[192:199], v15
v_smfmac_f32_16x16x64_bf16 v[68:71], v[52:55], v[200:207], v15
v_smfmac_f32_16x16x64_bf16 v[72:75], v[52:55], v[208:215], v15
v_smfmac_f32_16x16x64_bf16 v[76:79], v[52:55], v[216:223], v15
v_smfmac_f32_16x16x64_bf16 v[80:83], v[48:51], v[160:167], v15
v_smfmac_f32_16x16x64_bf16 v[84:87], v[48:51], v[168:175], v15
v_smfmac_f32_16x16x64_bf16 v[88:91], v[48:51], v[176:183], v15
v_smfmac_f32_16x16x64_bf16 v[92:95], v[48:51], v[184:191], v15
v_smfmac_f32_16x16x64_bf16 v[80:83], v[52:55], v[224:231], v15
v_add_f32 v64, v64, v65
v_smfmac_f32_16x16x64_bf16 v[84:87], v[52:55], v[232:239], v15
v_add_f32 v68, v68, v69
v_add_f32 v72, v72, v73
v_smfmac_f32_16x16x64_bf16 v[88:91], v[52:55], v[240:247], v15
v_add_f32 v76, v76, v77
v_cvt_pk_bf16_f32 v20, v64, v68
v_smfmac_f32_16x16x64_bf16 v[92:95], v[52:55], v[248:255], v15
v_cvt_pk_bf16_f32 v21, v72, v76
v_add_f32 v80, v80, v81
s_mov_b64 exec, 0xffff
v_add_f32 v84, v84, v85
v_cvt_pk_bf16_f32 v22, v80, v84
s_nop 0
v_add_f32 v88, v88, v89
s_nop 0
v_add_f32 v92, v92, v93
v_cvt_pk_bf16_f32 v23, v88, v92
buffer_store_dwordx4 v[20:23], v13, s[36:39], s69 offen sc1
s_mov_b64 exec, -1
s_sub_u32 s67, s2, 16
s_cmp_lt_u32 s67, 128
s_cbranch_scc0 L_nogp
s_and_b32 s66, s2, 7
s_min_u32 s64, s66, 3
s_mul_i32 s71, s66, 5
s_add_u32 s64, s64, s71
s_cmp_lt_u32 s66, 3
s_cselect_b32 s66, 5, 4
v_and_b32 v8, 7, v0
v_min_u32 v8, s66, v8
v_add_u32 v8, s64, v8
s_and_b32 s64, s67, 0xf8
s_lshl_b32 s64, s64, 2
s_lshl_b32 s66, s34, 3
s_add_u32 s64, s64, s66
v_lshrrev_b32 v9, 3, v0
v_add_u32 v9, s64, v9
v_mul_u32_u24 v9, 2752, v9
v_lshl_add_u32 v8, v8, 6, v9
global_load_dword v10, v8, s[16:17]
global_load_dword v11, v8, s[18:19]
s_and_b32 s66, s2, 7
s_min_u32 s70, s66, 3
s_mul_i32 s71, s66, 5
s_add_u32 s70, s70, s71
s_cmp_lt_u32 s66, 3
s_cselect_b32 s66, 6, 5
s_lshl_b32 s66, s66, 8
s_sub_u32 s66, s66, 1
s_lshr_b32 s71, s67, 3
s_lshl_b32 s71, s71, 2
s_add_u32 s71, s71, s34
s_mul_i32 s71, s71, 24
v_min_u32 v12, 23, v0
v_add_u32 v12, s71, v12
v_min_u32 v12, s66, v12
s_lshl_b32 s70, s70, 15
v_lshl_add_u32 v12, v12, 7, s70
global_load_dword v13, v12, s[20:21]
s_endpgm
L_nogp:
L_tail_s:
s_cmp_eq_u32 s74, -1
s_cbranch_scc0 L_ffn
s_cmp_eq_u32 s3, 0
s_cbranch_scc0 L_fin
s_sub_u32 s70, s2, 144
s_cmp_lt_u32 s70, 64
s_cbranch_scc0 L_fin
s_lshl_b32 s64, s70, 2
s_lshr_b32 s67, s35, s64
s_and_b32 s71, s67, 7
s_andn2_b32 s66, s70, 7
s_add_u32 s66, s66, s71
s_lshl_b32 s66, s66, 12
s_add_u32 s66, s66, 1048576
buffer_load_dwordx4 v[16:19], v1, s[36:39], s66 offen offset:0 sc1
buffer_load_dwordx4 v[20:23], v1, s[36:39], s66 offen offset:1024 sc1
buffer_load_dwordx4 v[24:27], v1, s[36:39], s66 offen offset:2048 sc1
buffer_load_dwordx4 v[28:31], v1, s[36:39], s66 offen offset:3072 sc1
v_mov_b32 v32, -1
v_mov_b32 v33, -1
v_mov_b32 v34, -1
v_mov_b32 v35, -1
s_and_b32 s64, s71, 6
s_lshl_b32 s64, s64, 12
s_and_b32 s65, s71, 1
s_lshl_b32 s65, s65, 15
s_or_b32 s64, s64, s65
s_lshr_b32 s65, s70, 3
s_lshl_b32 s65, s65, 16
s_add_u32 s64, s64, s65
s_lshr_b32 s65, s70, 4
s_lshl_b32 s65, s65, 2
s_and_b32 s67, s70, 7
s_add_u32 s65, s65, s67
s_lshl_b32 s65, s65, 7
s_add_u32 s64, s64, s65
s_add_u32 s64, s64, 1376256
s_add_u32 s65, s64, 4096
buffer_store_dwordx4 v[32:35], v1, s[36:39], s64 offen offset:0 sc1
buffer_store_dwordx4 v[32:35], v1, s[36:39], s64 offen offset:1024 sc1
buffer_store_dwordx4 v[32:35], v1, s[36:39], s64 offen offset:2048 sc1
buffer_store_dwordx4 v[32:35], v1, s[36:39], s64 offen offset:3072 sc1
buffer_store_dwordx4 v[32:35], v1, s[36:39], s65 offen offset:0 sc1
s_mov_b64 exec, 0xffffff
buffer_store_dwordx4 v[32:35], v1, s[36:39], s65 offen offset:1024 sc1
s_mov_b64 exec, -1
v_lshlrev_b32 v2, 2, v0
ds_read_b32 v8, v2 offset:4096
ds_read_b32 v9, v2 offset:4352
ds_read_b32 v10, v2 offset:4608
s_mov_b32 s56, s26
s_mov_b32 s57, s27
s_mov_b32 s58, 0x2000
s_mov_b32 s59, 0x20000
v_and_b32 v5, 15, v0
v_and_b32 v6, 16, v0
v_lshl_add_u32 v5, v6, 1, v5
v_and_b32 v6, 32, v0
v_lshrrev_b32 v6, 1, v6
v_add_u32 v5, v5, v6
v_lshlrev_b32 v5, 1, v5
v_and_b32 v6, 0x7c, v5
s_lshl_b32 s73, s70, 7
v_and_b32 v11, 1, v0
v_lshlrev_b32 v3, 4, v11
v_mov_b32 v7, 0x3f80
v_lshlrev_b32 v7, v3, v7
v_and_b32 v2, 4, v0
v_cmp_eq_u32 vcc, 0, v2
v_bfe_u32 v2, v0, 1, 1
v_mul_u32_u24 v43, 0xaaaa, v2
v_add_u32 v43, 0x4444, v43
v_cndmask_b32 v44, 0, v7, vcc
v_sub_u32 v45, v7, v44
v_mov_b32 v46, v44
v_mov_b32 v47, v45
v_mov_b32 v48, 0
v_mov_b32 v49, 0
v_mov_b32 v50, 0
v_mov_b32 v51, 0
v_mov_b32 v52, 0
v_mov_b32 v53, 0
v_mov_b32 v54, 0
v_mov_b32 v55, 0
s_add_u32 s68, s73, 1310720
s_mov_b32 s76, 0xaaaaaaaa
s_mov_b32 s77, 0xaaaaaaaa
v_cmp_gt_u32 vcc, 24, v0
v_mov_b32 v41, 0x40000000
v_lshl_add_u32 v12, v11, 13, v6
v_cndmask_b32 v41, v41, v1, vcc
s_mov_b32 s75, 0
s_waitcnt vmcnt(0) lgkmcnt(0)
buffer_load_dwordx4 v[16:19], v1, s[36:39], s66 offen offset:0 sc1
buffer_load_dwordx4 v[20:23], v1, s[36:39], s66 offen offset:1024 sc1
buffer_load_dwordx4 v[24:27], v1, s[36:39], s66 offen offset:2048 sc1
buffer_load_dwordx4 v[28:31], v1, s[36:39], s66 offen offset:3072 sc1
s_sleep 1
buffer_load_dwordx4 v[16:19], v1, s[36:39], s66 offen offset:0 sc1
buffer_load_dwordx4 v[20:23], v1, s[36:39], s66 offen offset:1024 sc1
buffer_load_dwordx4 v[24:27], v1, s[36:39], s66 offen offset:2048 sc1
buffer_load_dwordx4 v[28:31], v1, s[36:39], s66 offen offset:3072 sc1
s_sleep 1
buffer_load_dwordx4 v[16:19], v1, s[36:39], s66 offen offset:0 sc1
buffer_load_dwordx4 v[20:23], v1, s[36:39], s66 offen offset:1024 sc1
buffer_load_dwordx4 v[24:27], v1, s[36:39], s66 offen offset:2048 sc1
buffer_load_dwordx4 v[28:31], v1, s[36:39], s66 offen offset:3072 sc1
s_sleep 1
L_rn_179:
v_smfmac_f32_16x16x64_bf16 v[48:51], v[44:47], v[16:23], v43
v_smfmac_f32_16x16x64_bf16 v[48:51], v[44:47], v[24:31], v43
buffer_load_dwordx4 v[16:19], v1, s[36:39], s66 offen offset:0 sc1
buffer_load_dwordx4 v[20:23], v1, s[36:39], s66 offen offset:1024 sc1
buffer_load_dwordx4 v[24:27], v1, s[36:39], s66 offen offset:2048 sc1
buffer_load_dwordx4 v[28:31], v1, s[36:39], s66 offen offset:3072 sc1
s_add_u32 s75, s75, 1
s_and_b32 s78, s75, 15
s_nop 1
v_add_f32_dpp v13, v48, v48 row_ror:8 row_mask:0x3 bank_mask:0x3
v_add_f32_dpp v13, v49, v49 row_ror:8 row_mask:0x3 bank_mask:0xc
v_add_f32_dpp v13, v50, v50 row_ror:8 row_mask:0xc bank_mask:0x3
v_add_f32_dpp v13, v51, v51 row_ror:8 row_mask:0xc bank_mask:0xc
v_cmp_u_f32 vcc, v13, v13
s_cbranch_vccz L_rz_180
v_mov_b32 v48, 0
v_mov_b32 v49, 0
v_mov_b32 v50, 0
v_mov_b32 v51, 0
s_waitcnt vmcnt(12)
s_cbranch_scc1 L_rn_179
v_max3_u32 v2, v16, v17, v18
v_max3_u32 v2, v2, v19, v20
v_max3_u32 v2, v2, v21, v22
v_max3_u32 v2, v2, v23, v24
v_max3_u32 v2, v2, v25, v26
v_max3_u32 v2, v2, v27, v28
v_max3_u32 v2, v2, v29, v30
v_max_u32 v2, v2, v31
v_cmp_eq_u32 vcc, -1, v2
s_cbranch_vccz L_rx_178
s_cmp_lt_u32 s75, 0x100000
s_cbranch_scc1 L_rn_179
L_rx_178:
v_smfmac_f32_16x16x64_bf16 v[48:51], v[44:47], v[16:23], v43
v_smfmac_f32_16x16x64_bf16 v[48:51], v[44:47], v[24:31], v43
s_nop 7
v_add_f32_dpp v13, v48, v48 row_ror:8 row_mask:0x3 bank_mask:0x3
v_add_f32_dpp v13, v49, v49 row_ror:8 row_mask:0x3 bank_mask:0xc
v_add_f32_dpp v13, v50, v50 row_ror:8 row_mask:0xc bank_mask:0x3
v_add_f32_dpp v13, v51, v51 row_ror:8 row_mask:0xc bank_mask:0xc
L_rz_180:
v_fmac_f32 v8, v13, v9
s_nop 1
v_mov_b32_dpp v14, v8 quad_perm:[1,1,3,3] row_mask:0xf bank_mask:0xf
v_mov_b32_dpp v13, v8 quad_perm:[0,0,2,2] row_mask:0xf bank_mask:0xf
v_cvt_pk_bf16_f32 v13, v13, v14
buffer_store_dword v13, v12, s[36:39], s68 offen sc1
v_cvt_pk_bf16_f32 v8, 0, v8
buffer_load_dwordx4 v[64:67], v1, s[36:39], s64 offen offset:0 sc1
buffer_load_dwordx4 v[68:71], v1, s[36:39], s64 offen offset:1024 sc1
buffer_load_dwordx4 v[72:75], v1, s[36:39], s64 offen offset:2048 sc1
buffer_load_dwordx4 v[76:79], v1, s[36:39], s64 offen offset:3072 sc1
buffer_load_dwordx4 v[80:83], v1, s[36:39], s65 offen offset:0 sc1
buffer_load_dwordx4 v[84:87], v41, s[36:39], s65 offen offset:1024 sc1
s_mov_b32 s75, 0
s_waitcnt vmcnt(0)
buffer_load_dwordx4 v[64:67], v1, s[36:39], s64 offen offset:0 sc1
buffer_load_dwordx4 v[68:71], v1, s[36:39], s64 offen offset:1024 sc1
buffer_load_dwordx4 v[72:75], v1, s[36:39], s64 offen offset:2048 sc1
buffer_load_dwordx4 v[76:79], v1, s[36:39], s64 offen offset:3072 sc1
buffer_load_dwordx4 v[80:83], v1, s[36:39], s65 offen offset:0 sc1
buffer_load_dwordx4 v[84:87], v41, s[36:39], s65 offen offset:1024 sc1
s_sleep 1
buffer_load_dwordx4 v[64:67], v1, s[36:39], s64 offen offset:0 sc1
buffer_load_dwordx4 v[68:71], v1, s[36:39], s64 offen offset:1024 sc1
buffer_load_dwordx4 v[72:75], v1, s[36:39], s64 offen offset:2048 sc1
buffer_load_dwordx4 v[76:79], v1, s[36:39], s64 offen offset:3072 sc1
buffer_load_dwordx4 v[80:83], v1, s[36:39], s65 offen offset:0 sc1
buffer_load_dwordx4 v[84:87], v41, s[36:39], s65 offen offset:1024 sc1
s_sleep 1
L_rn_183:
v_smfmac_f32_16x16x64_bf16 v[52:55], v[44:47], v[64:71], v43
v_smfmac_f32_16x16x64_bf16 v[52:55], v[44:47], v[72:79], v43
v_smfmac_f32_16x16x64_bf16 v[52:55], v[44:47], v[80:87], v43
buffer_load_dwordx4 v[64:67], v1, s[36:39], s64 offen offset:0 sc1
buffer_load_dwordx4 v[68:71], v1, s[36:39], s64 offen offset:1024 sc1
buffer_load_dwordx4 v[72:75], v1, s[36:39], s64 offen offset:2048 sc1
buffer_load_dwordx4 v[76:79], v1, s[36:39], s64 offen offset:3072 sc1
buffer_load_dwordx4 v[80:83], v1, s[36:39], s65 offen offset:0 sc1
buffer_load_dwordx4 v[84:87], v41, s[36:39], s65 offen offset:1024 sc1
s_add_u32 s75, s75, 1
s_and_b32 s78, s75, 15
v_add_f32_dpp v13, v52, v52 row_ror:8 row_mask:0x3 bank_mask:0x3
v_add_f32_dpp v13, v53, v53 row_ror:8 row_mask:0x3 bank_mask:0xc
v_add_f32_dpp v13, v54, v54 row_ror:8 row_mask:0xc bank_mask:0x3
v_add_f32_dpp v13, v55, v55 row_ror:8 row_mask:0xc bank_mask:0xc
v_cmp_u_f32 vcc, v13, v13
s_cbranch_vccz L_rz_184
v_mov_b32 v52, 0
v_mov_b32 v53, 0
v_mov_b32 v54, 0
v_mov_b32 v55, 0
s_waitcnt vmcnt(12)
s_cbranch_scc1 L_rn_183
v_max3_u32 v2, v64, v65, v66
v_max3_u32 v2, v2, v67, v68
v_max3_u32 v2, v2, v69, v70
v_max3_u32 v2, v2, v71, v72
v_max3_u32 v2, v2, v73, v74
v_max3_u32 v2, v2, v75, v76
v_max3_u32 v2, v2, v77, v78
v_max3_u32 v2, v2, v79, v80
v_max3_u32 v2, v2, v81, v82
v_max3_u32 v2, v2, v83, v84
v_max3_u32 v2, v2, v85, v86
v_max_u32 v2, v2, v87
v_cmp_eq_u32 vcc, -1, v2
s_cbranch_vccz L_rx_182
s_cmp_lt_u32 s75, 0x100000
s_cbranch_scc1 L_rn_183
L_rx_182:
v_smfmac_f32_16x16x64_bf16 v[52:55], v[44:47], v[64:71], v43
v_smfmac_f32_16x16x64_bf16 v[52:55], v[44:47], v[72:79], v43
v_smfmac_f32_16x16x64_bf16 v[52:55], v[44:47], v[80:87], v43
s_nop 7
v_add_f32_dpp v13, v52, v52 row_ror:8 row_mask:0x3 bank_mask:0x3
v_add_f32_dpp v13, v53, v53 row_ror:8 row_mask:0x3 bank_mask:0xc
v_add_f32_dpp v13, v54, v54 row_ror:8 row_mask:0xc bank_mask:0x3
v_add_f32_dpp v13, v55, v55 row_ror:8 row_mask:0xc bank_mask:0xc
L_rz_184:
v_fmac_f32 v8, v13, v10
s_nop 1
v_mov_b32_dpp v14, v8 quad_perm:[1,1,3,3] row_mask:0xf bank_mask:0xf
s_not_b64 exec, s[76:77]
v_cvt_pk_bf16_f32 v13, v8, v14
buffer_store_dword v13, v6, s[56:59], s73 offen sc1
s_mov_b64 exec, -1
s_cmp_lt_u32 s70, 8
s_cbranch_scc0 L_fin2
s_mov_b64 exec, 0xffff
buffer_store_dwordx4 v[44:47], v1, s[36:39], s62 offen sc1
s_mov_b64 exec, -1
L_fin2:
s_endpgm
L_ffn:
s_mul_i32 s67, s3, 12288
s_add_u32 s67, s67, 25600
v_lshlrev_b32 v7, 3, v0
buffer_load_dwordx4 v[8:11], v1, s[36:39], s67 offen offset:0 sc1
buffer_load_dwordx4 v[12:15], v1, s[36:39], s67 offen offset:1024 sc1
s_cmp_lt_u32 s3, 4
s_cbranch_scc1 L_post_185
s_mov_b32 s40, s16
s_mov_b32 s41, s17
s_mov_b32 s42, 0x158000
s_mov_b32 s43, 0x20000
s_mov_b32 s56, s18
s_mov_b32 s57, s19
s_mov_b32 s58, 0x158000
s_mov_b32 s59, 0x20000
v_lshrrev_b32 v16, 2, v0
v_mul_u32_u24 v16, 2752, v16
v_and_b32 v17, 3, v0
v_lshrrev_b32 v18, 5, v0
v_xor_b32 v17, v17, v18
v_xor_b32 v18, 2, v17
v_lshl_add_u32 v17, v17, 4, v16
v_lshl_add_u32 v18, v18, 4, v16
s_mul_i32 s64, s34, 352256
s_lshl_b32 s65, s74, 6
s_add_u32 s64, s64, s65
s_lshl_b32 s65, s34, 13
s_add_u32 m0, s65, 4096
s_add_u32 s66, s64, 0
buffer_load_dwordx4 v17, s[40:43], s66 offen  lds
s_add_u32 m0, s65, 36864
s_add_u32 s66, s64, 0
buffer_load_dwordx4 v18, s[56:59], s66 offen  lds
s_add_u32 m0, s65, 5120
s_add_u32 s66, s64, 44032
buffer_load_dwordx4 v17, s[40:43], s66 offen  lds
s_add_u32 m0, s65, 37888
s_add_u32 s66, s64, 44032
buffer_load_dwordx4 v18, s[56:59], s66 offen  lds
s_add_u32 m0, s65, 6144
s_add_u32 s66, s64, 88064
buffer_load_dwordx4 v17, s[40:43], s66 offen  lds
s_add_u32 m0, s65, 38912
s_add_u32 s66, s64, 88064
buffer_load_dwordx4 v18, s[56:59], s66 offen  lds
s_add_u32 m0, s65, 7168
s_add_u32 s66, s64, 132096
buffer_load_dwordx4 v17, s[40:43], s66 offen  lds
s_add_u32 m0, s65, 39936
s_add_u32 s66, s64, 132096
buffer_load_dwordx4 v18, s[56:59], s66 offen  lds
s_add_u32 m0, s65, 8192
s_add_u32 s66, s64, 176128
buffer_load_dwordx4 v17, s[40:43], s66 offen  lds
s_add_u32 m0, s65, 40960
s_add_u32 s66, s64, 176128
buffer_load_dwordx4 v18, s[56:59], s66 offen  lds
s_add_u32 m0, s65, 9216
s_add_u32 s66, s64, 220160
buffer_load_dwordx4 v17, s[40:43], s66 offen  lds
s_add_u32 m0, s65, 41984
s_add_u32 s66, s64, 220160
buffer_load_dwordx4 v18, s[56:59], s66 offen  lds
s_add_u32 m0, s65, 10240
s_add_u32 s66, s64, 264192
buffer_load_dwordx4 v17, s[40:43], s66 offen  lds
s_add_u32 m0, s65, 43008
s_add_u32 s66, s64, 264192
buffer_load_dwordx4 v18, s[56:59], s66 offen  lds
s_add_u32 m0, s65, 11264
s_add_u32 s66, s64, 308224
buffer_load_dwordx4 v17, s[40:43], s66 offen  lds
s_add_u32 m0, s65, 44032
s_add_u32 s66, s64, 308224
buffer_load_dwordx4 v18, s[56:59], s66 offen  lds
s_waitcnt vmcnt(16)
s_branch L_post_186
L_post_185:
s_waitcnt vmcnt(0)
L_post_186:
v_max3_u32 v16, v8, v9, v10
v_max3_u32 v16, v16, v11, v12
v_max3_u32 v16, v16, v13, v14
v_max_u32 v16, v16, v15
v_cmp_eq_u32 vcc, -1, v16
s_cbranch_vccz L_cb_187
s_mov_b32 s75, 0
L_poll_188:
buffer_load_dwordx4 v[8:11], v1, s[36:39], s67 offen offset:0 sc1
buffer_load_dwordx4 v[12:15], v1, s[36:39], s67 offen offset:1024 sc1
s_waitcnt vmcnt(0)
v_max3_u32 v16, v8, v9, v10
v_max3_u32 v16, v16, v11, v12
v_max3_u32 v16, v16, v13, v14
v_max_u32 v16, v16, v15
v_cmp_eq_u32 vcc, -1, v16
s_cbranch_vccz L_pollx_189
s_add_u32 s75, s75, 1
s_cmp_lt_u32 s75, 0x100000
s_cbranch_scc1 L_poll_188
L_pollx_189:
L_cb_187:
s_mov_b32 s68, 0xffff0000
v_lshlrev_b32 v24, 16, v8
v_and_b32 v25, s68, v8
v_lshlrev_b32 v32, 16, v12
v_and_b32 v33, s68, v12
v_lshlrev_b32 v26, 16, v9
v_and_b32 v27, s68, v9
v_lshlrev_b32 v34, 16, v13
v_and_b32 v35, s68, v13
v_lshlrev_b32 v28, 16, v10
v_and_b32 v29, s68, v10
v_lshlrev_b32 v36, 16, v14
v_and_b32 v37, s68, v14
v_lshlrev_b32 v30, 16, v11
v_and_b32 v31, s68, v11
v_lshlrev_b32 v38, 16, v15
v_and_b32 v39, s68, v15
v_add_f32 v32, 1.0, v32
v_add_f32 v33, 1.0, v33
v_add_f32 v34, 1.0, v34
v_add_f32 v35, 1.0, v35
v_add_f32 v36, 1.0, v36
v_add_f32 v37, 1.0, v37
v_add_f32 v38, 1.0, v38
v_add_f32 v39, 1.0, v39
v_lshrrev_b32 v2, 3, v0
v_bfe_u32 v3, v0, 1, 3
v_and_b32 v4, 3, v3
s_lshl_b32 s64, s3, 1
v_xor_b32 v3, s64, v3
v_lshlrev_b32 v5, 10, v2
v_lshl_add_u32 v5, v4, 8, v5
v_lshl_add_u32 v5, v3, 4, v5
v_and_b32 v4, 1, v0
v_lshl_add_u32 v5, v4, 3, v5
v_add_u32 v5, 69632, v5
v_xor_b32 v6, 16, v5
v_mul_u32_u24 v16, 0xaaaa, v4
v_add_u32 v16, 0x4444, v16
v_lshrrev_b32 v2, 4, v0
v_bfe_u32 v3, v0, 3, 1
v_xor_b32 v7, v2, v0
v_lshlrev_b32 v7, 4, v7
v_add_u32 v7, 69632, v7
v_xor_b32 v8, 64, v7
v_and_b32 v4, 7, v0
v_and_b32 v9, 0x38, v0
v_lshlrev_b32 v9, 3, v9
v_lshl_add_u32 v9, v4, 1, v9
s_lshl_b32 s64, s34, 4
v_add_u32 v9, s64, v9
v_and_b32 v10, 12, v0
v_lshlrev_b32 v10, 5, v10
v_and_b32 v4, 1, v0
v_lshl_add_u32 v10, v4, 6, v10
v_lshl_add_u32 v10, v2, 4, v10
v_mov_b32 v17, 0xbfb8aa3b
v_mov_b32 v64, 0
v_mov_b32 v65, 0
v_mov_b32 v66, 0
v_mov_b32 v67, 0
s_lshl_b32 s64, s34, 3
s_lshr_b32 s64, s35, s64
v_lshlrev_b32 v3, 2, v3
v_bfe_u32 v3, s64, v3, 3
v_and_b32 v11, 6, v3
v_lshlrev_b32 v11, 12, v11
v_and_b32 v3, 1, v3
v_lshl_add_u32 v11, v3, 15, v11
v_lshl_add_u32 v11, v2, 17, v11
v_and_b32 v4, 240, v1
v_add_u32 v11, v11, v4
v_lshl_add_u32 v11, v2, 9, v11
s_lshl_b32 s64, s34, 8
v_add_u32 v11, s64, v11
s_lshl_b32 s69, s74, 7
s_add_u32 s69, s69, 1376256
s_add_u32 s72, s69, 65536
s_lshl_b32 s64, s3, 10
s_lshl_b32 s65, s2, 2
s_lshr_b32 s65, s35, s65
s_and_b32 s65, s65, 2
s_lshl_b32 s65, s65, 12
s_add_u32 s64, s64, s65
s_add_u32 s64, s64, 1310720
v_mov_b32 v14, 0xbb000000
v_mov_b32 v15, 0x3b000000
v_lshrrev_b32 v18, 4, v0
v_bfe_u32 v19, v0, 2, 2
v_bfe_u32 v20, v0, 1, 1
v_and_b32 v22, 1, v18
v_lshl_add_u32 v22, v20, 1, v22
v_xor_b32 v22, s34, v22
v_lshlrev_b32 v22, 4, v22
v_lshl_add_u32 v22, v20, 15, v22
v_lshl_add_u32 v22, v18, 9, v22
v_lshl_add_u32 v22, v19, 6, v22
v_and_b32 v20, 1, v0
v_lshl_add_u32 v22, v20, 3, v22
v_add_u32 v22, 4096, v22
s_lshr_b32 s73, s3, 2
s_waitcnt vmcnt(0)
s_barrier
buffer_load_dwordx4 v[56:59], v1, s[36:39], s64 offen sc1
s_cmp_eq_u32 s73, 0
s_cbranch_scc1 L_gu_191
ds_read_b64_tr_b16 v[128:129], v22 offset:0
ds_read_b64_tr_b16 v[130:131], v22 offset:256
ds_read_b64_tr_b16 v[132:133], v22 offset:2048
ds_read_b64_tr_b16 v[134:135], v22 offset:2304
ds_read_b64_tr_b16 v[136:137], v22 offset:4096
ds_read_b64_tr_b16 v[138:139], v22 offset:4352
ds_read_b64_tr_b16 v[140:141], v22 offset:6144
ds_read_b64_tr_b16 v[142:143], v22 offset:6400
ds_read_b64_tr_b16 v[144:145], v22 offset:8192
ds_read_b64_tr_b16 v[146:147], v22 offset:8448
ds_read_b64_tr_b16 v[148:149], v22 offset:10240
s_waitcnt lgkmcnt(4)
ds_read_b64_tr_b16 v[150:151], v22 offset:10496
ds_read_b64_tr_b16 v[152:153], v22 offset:12288
ds_read_b64_tr_b16 v[154:155], v22 offset:12544
ds_read_b64_tr_b16 v[156:157], v22 offset:14336
ds_read_b64_tr_b16 v[158:159], v22 offset:14592
ds_read_b64_tr_b16 v[160:161], v22 offset:16384
ds_read_b64_tr_b16 v[162:163], v22 offset:16640
ds_read_b64_tr_b16 v[164:165], v22 offset:18432
ds_read_b64_tr_b16 v[166:167], v22 offset:18688
ds_read_b64_tr_b16 v[168:169], v22 offset:20480
ds_read_b64_tr_b16 v[170:171], v22 offset:20736
s_waitcnt lgkmcnt(4)
ds_read_b64_tr_b16 v[172:173], v22 offset:22528
ds_read_b64_tr_b16 v[174:175], v22 offset:22784
ds_read_b64_tr_b16 v[176:177], v22 offset:24576
ds_read_b64_tr_b16 v[178:179], v22 offset:24832
ds_read_b64_tr_b16 v[180:181], v22 offset:26624
ds_read_b64_tr_b16 v[182:183], v22 offset:26880
ds_read_b64_tr_b16 v[184:185], v22 offset:28672
ds_read_b64_tr_b16 v[186:187], v22 offset:28928
ds_read_b64_tr_b16 v[188:189], v22 offset:30720
ds_read_b64_tr_b16 v[190:191], v22 offset:30976
L_gu_191:
s_cmp_lt_u32 s3, 4
s_cbranch_scc0 L_dma_192
s_mov_b32 s48, s20
s_mov_b32 s49, s21
s_mov_b32 s50, 0x158000
s_mov_b32 s51, 0x20000
v_lshrrev_b32 v18, 4, v0
v_and_b32 v16, 15, v0
v_xor_b32 v16, v16, v18
v_xor_b32 v17, 4, v16
v_lshlrev_b32 v19, 10, v18
v_lshl_add_u32 v22, v16, 4, v19
v_lshl_add_u32 v23, v17, 4, v19
s_lshl_b32 s76, s74, 15
s_lshl_b32 s66, s34, 8
s_add_u32 s76, s76, s66
s_lshl_b32 s77, s34, 13
s_add_u32 s77, s77, 77824
v_bfe_u32 v19, v0, 2, 2
v_and_b32 v16, 2, v0
v_lshlrev_b32 v16, 2, v16
v_xor_b32 v16, v16, v19
v_and_b32 v17, 1, v18
v_lshlrev_b32 v17, 2, v17
v_xor_b32 v16, v16, v17
v_lshlrev_b32 v16, 4, v16
v_lshl_add_u32 v16, v18, 10, v16
v_lshl_add_u32 v16, v19, 8, v16
v_and_b32 v17, 1, v0
v_lshl_add_u32 v16, v17, 3, v16
v_add_u32 v68, s77, v16
v_xor_b32 v69, 16, v68
v_xor_b32 v70, 32, v68
v_xor_b32 v71, 48, v68
v_xor_b32 v72, 64, v68
v_xor_b32 v73, 80, v68
v_xor_b32 v74, 96, v68
v_xor_b32 v75, 112, v68
s_add_u32 m0, s77, 0
s_xor_b32 s66, s76, 0
buffer_load_dwordx4 v22, s[48:51], s66 offen  lds
s_add_u32 m0, s77, 1024
s_xor_b32 s66, s76, 8192
buffer_load_dwordx4 v23, s[48:51], s66 offen  lds
s_add_u32 m0, s77, 2048
s_xor_b32 s66, s76, 16384
buffer_load_dwordx4 v22, s[48:51], s66 offen  lds
s_add_u32 m0, s77, 3072
s_xor_b32 s66, s76, 24576
buffer_load_dwordx4 v23, s[48:51], s66 offen  lds
s_add_u32 m0, s77, 4096
s_xor_b32 s66, s76, 4096
buffer_load_dwordx4 v22, s[48:51], s66 offen  lds
s_add_u32 m0, s77, 5120
s_xor_b32 s66, s76, 12288
buffer_load_dwordx4 v23, s[48:51], s66 offen  lds
s_add_u32 m0, s77, 6144
s_xor_b32 s66, s76, 20480
buffer_load_dwordx4 v22, s[48:51], s66 offen  lds
s_waitcnt vmcnt(7)
s_branch L_dma_193
L_dma_192:
s_waitcnt vmcnt(0)
L_dma_193:
s_mov_b32 s73, 0x3f803f80
v_mov_b32 v20, 0
v_mov_b32 v21, 0
v_max3_u32 v12, v56, v57, v58
v_max_u32 v12, v12, v59
v_cmp_eq_u32 vcc, -1, v12
s_cbranch_vccz L_x_190
buffer_load_dwordx4 v[56:59], v1, s[36:39], s64 offen sc1
s_sleep 1
s_mov_b32 s75, 0
L_poll_194:
buffer_load_dwordx4 v[56:59], v1, s[36:39], s64 offen sc1
s_waitcnt vmcnt(1)
v_max3_u32 v12, v56, v57, v58
v_max_u32 v12, v12, v59
v_cmp_eq_u32 vcc, -1, v12
s_cbranch_vccz L_pollx_195
s_add_u32 s75, s75, 1
s_cmp_lt_u32 s75, 0x100000
s_cbranch_scc1 L_poll_194
L_pollx_195:
L_x_190:
v_dot2c_f32_bf16 v20, s73, v56
v_dot2c_f32_bf16 v21, v56, v56
v_dot2c_f32_bf16 v20, s73, v57
v_dot2c_f32_bf16 v21, v57, v57
v_dot2c_f32_bf16 v20, s73, v58
v_dot2c_f32_bf16 v21, v58, v58
v_dot2c_f32_bf16 v20, s73, v59
v_dot2c_f32_bf16 v21, v59, v59
v_lshlrev_b32 v40, 16, v56
v_and_b32 v41, s68, v56
v_lshlrev_b32 v42, 16, v57
v_permlane32_swap_b32 v20, v21
v_add_f32 v12, v20, v21
v_and_b32 v43, s68, v57
v_lshlrev_b32 v44, 16, v58
v_add_f32_dpp v12, v12, v12 quad_perm:[1,0,3,2] row_mask:0xf bank_mask:0xf
v_and_b32 v45, s68, v58
v_lshlrev_b32 v46, 16, v59
v_add_f32_dpp v12, v12, v12 quad_perm:[2,3,0,1] row_mask:0xf bank_mask:0xf
v_and_b32 v47, s68, v59
v_pk_mul_f32 v[48:49], v[40:41], v[32:33]
v_add_f32_dpp v12, v12, v12 row_ror:4 row_mask:0xf bank_mask:0xf
v_pk_mul_f32 v[50:51], v[42:43], v[34:35]
v_pk_mul_f32 v[52:53], v[44:45], v[36:37]
v_add_f32_dpp v12, v12, v12 row_ror:8 row_mask:0xf bank_mask:0xf
v_pk_mul_f32 v[54:55], v[46:47], v[38:39]
s_nop 0
v_add_f32_dpp v12, v12, v12 row_bcast:15 row_mask:0xa bank_mask:0xf
s_nop 0
v_readlane_b32 s70, v12, 16
v_readlane_b32 s71, v12, 48
s_nop 0
v_mul_f32 v12, s70, v14
v_mul_f32 v13, s71, v15
v_fma_f32 v13, -v12, v12, v13
v_max_f32 v13, 0, v13
v_add_f32 v13, 0x3727c5ac, v13
v_rsq_f32 v2, v13
v_pk_fma_f32 v[48:49], v[12:13], v[32:33], v[48:49] op_sel_hi:[0,1,1]
v_pk_fma_f32 v[50:51], v[12:13], v[34:35], v[50:51] op_sel_hi:[0,1,1]
v_pk_fma_f32 v[52:53], v[12:13], v[36:37], v[52:53] op_sel_hi:[0,1,1]
v_pk_fma_f32 v[54:55], v[12:13], v[38:39], v[54:55] op_sel_hi:[0,1,1]
v_pk_fma_f32 v[24:25], v[2:3], v[48:49], v[24:25] op_sel_hi:[0,1,1]
v_pk_fma_f32 v[28:29], v[2:3], v[52:53], v[28:29] op_sel_hi:[0,1,1]
v_pk_fma_f32 v[26:27], v[2:3], v[50:51], v[26:27] op_sel_hi:[0,1,1]
v_pk_fma_f32 v[30:31], v[2:3], v[54:55], v[30:31] op_sel_hi:[0,1,1]
v_cvt_pk_bf16_f32 v40, v24, v25
v_cvt_pk_bf16_f32 v41, v28, v29
ds_write_b64 v5, v[40:41]
v_cvt_pk_bf16_f32 v42, v26, v27
v_cvt_pk_bf16_f32 v43, v30, v31
ds_write_b64 v6, v[42:43]
s_cmp_lt_u32 s3, 4
s_cbranch_scc0 L_dma_196
s_mov_b32 s48, s20
s_mov_b32 s49, s21
s_mov_b32 s50, 0x158000
s_mov_b32 s51, 0x20000
s_add_u32 m0, s77, 7168
s_xor_b32 s66, s76, 28672
buffer_load_dwordx4 v23, s[48:51], s66 offen  lds
L_dma_196:
s_cmp_lt_u32 s3, 4
s_waitcnt lgkmcnt(0)
s_barrier
s_cbranch_scc1 L_bar_fin
ds_read_b128 v[192:195], v7 offset:0
ds_read_b128 v[196:199], v8 offset:1024
ds_read_b128 v[200:203], v7 offset:2048
ds_read_b128 v[204:207], v8 offset:3072
ds_read_b128 v[208:211], v7 offset:4096
ds_read_b128 v[212:215], v8 offset:5120
ds_read_b128 v[216:219], v7 offset:6144
ds_read_b128 v[220:223], v8 offset:7168
s_waitcnt lgkmcnt(7)
v_smfmac_f32_16x16x64_bf16 v[64:67], v[192:195], v[128:135], v16
s_waitcnt lgkmcnt(6)
v_smfmac_f32_16x16x64_bf16 v[64:67], v[196:199], v[136:143], v16
s_waitcnt lgkmcnt(5)
v_smfmac_f32_16x16x64_bf16 v[64:67], v[200:203], v[144:151], v16
s_waitcnt lgkmcnt(4)
v_smfmac_f32_16x16x64_bf16 v[64:67], v[204:207], v[152:159], v16
s_waitcnt lgkmcnt(3)
v_smfmac_f32_16x16x64_bf16 v[64:67], v[208:211], v[160:167], v16
s_waitcnt lgkmcnt(2)
v_smfmac_f32_16x16x64_bf16 v[64:67], v[212:215], v[168:175], v16
s_waitcnt lgkmcnt(1)
v_smfmac_f32_16x16x64_bf16 v[64:67], v[216:219], v[176:183], v16
s_waitcnt lgkmcnt(0)
v_smfmac_f32_16x16x64_bf16 v[64:67], v[220:223], v[184:191], v16
s_nop 7
v_add_f32 v66, v66, v67
v_add_f32 v64, v64, v65
v_mul_f32 v18, v64, v17
v_mul_f32_dpp v18, v66, v17 row_ror:8 row_mask:0xf bank_mask:0xc
v_exp_f32 v18, v18
v_mov_b32_dpp v66, v64 row_ror:8 row_mask:0xf bank_mask:0x3
v_add_f32 v18, 1.0, v18
v_rcp_f32 v18, v18
s_nop 0
v_mul_f32 v18, v18, v66
v_cvt_pk_bf16_f32 v18, v18, v18
ds_write_b16 v9, v18 offset:3584
s_waitcnt lgkmcnt(0)
s_barrier
s_endpgm
L_bar_fin:
s_waitcnt vmcnt(0)
ds_read_b64_tr_b16 v[96:97], v68 offset:0
ds_read_b64_tr_b16 v[98:99], v68 offset:4096
ds_read_b64_tr_b16 v[100:101], v69 offset:0
ds_read_b64_tr_b16 v[102:103], v69 offset:4096
ds_read_b64_tr_b16 v[104:105], v70 offset:0
ds_read_b64_tr_b16 v[106:107], v70 offset:4096
ds_read_b64_tr_b16 v[108:109], v71 offset:0
ds_read_b64_tr_b16 v[110:111], v71 offset:4096
ds_read_b64_tr_b16 v[112:113], v72 offset:0
ds_read_b64_tr_b16 v[114:115], v72 offset:4096
ds_read_b64_tr_b16 v[116:117], v73 offset:0
s_waitcnt lgkmcnt(4)
ds_read_b64_tr_b16 v[118:119], v73 offset:4096
ds_read_b64_tr_b16 v[120:121], v74 offset:0
ds_read_b64_tr_b16 v[122:123], v74 offset:4096
ds_read_b64_tr_b16 v[124:125], v75 offset:0
ds_read_b64_tr_b16 v[126:127], v75 offset:4096
s_waitcnt lgkmcnt(0)
s_barrier
ds_read_b128 v[48:51], v10 offset:3584
s_waitcnt lgkmcnt(0)
v_mfma_f32_16x16x32_bf16 v[192:195], v[48:51], v[96:99], 0
v_mfma_f32_16x16x32_bf16 v[196:199], v[48:51], v[100:103], 0
v_mfma_f32_16x16x32_bf16 v[200:203], v[48:51], v[104:107], 0
s_nop 1
v_mfma_f32_16x16x32_bf16 v[204:207], v[48:51], v[108:111], 0
s_nop 1
v_mfma_f32_16x16x32_bf16 v[208:211], v[48:51], v[112:115], 0
s_nop 0
v_cvt_pk_bf16_f32 v16, v192, v196
v_mfma_f32_16x16x32_bf16 v[212:215], v[48:51], v[116:119], 0
v_cvt_pk_bf16_f32 v20, v193, v197
v_mfma_f32_16x16x32_bf16 v[216:219], v[48:51], v[120:123], 0
v_cvt_pk_bf16_f32 v17, v200, v204
v_cvt_pk_bf16_f32 v21, v201, v205
v_mfma_f32_16x16x32_bf16 v[220:223], v[48:51], v[124:127], 0
s_nop 2
v_cvt_pk_bf16_f32 v18, v208, v212
v_cvt_pk_bf16_f32 v22, v209, v213
s_nop 2
v_cvt_pk_bf16_f32 v19, v216, v220
buffer_store_dwordx4 v[16:19], v11, s[36:39], s69 offen sc1
v_cvt_pk_bf16_f32 v23, v217, v221
buffer_store_dwordx4 v[20:23], v11, s[36:39], s72 offen sc1
s_endpgm
s_endpgm
L_srest:
s_lshr_b32 s32, s2, 5
s_and_b32 s33, s2, 31
s_and_b32 s67, s2, 7
s_lshr_b32 s68, s2, 3
s_sub_u32 s68, s68, 26
s_min_u32 s74, s67, 3
s_mul_i32 s66, s67, 5
s_add_u32 s74, s74, s66
s_add_u32 s74, s74, s68
s_cmp_lt_u32 s67, 3
s_cselect_b32 s66, 6, 5
s_cmp_lt_u32 s68, s66
s_cselect_b32 s74, s74, -1
s_cmp_lt_u32 s2, 48
s_cselect_b32 s66, 2, 3
s_cselect_b32 s72, 14+26, 42+26
s_cmp_lt_u32 s2, 16
s_cselect_b32 s66, 1, s66
s_cselect_b32 s72, 26, s72
s_lshl_b32 s66, s67, s66
s_add_u32 s72, s72, s66
s_add_u32 s72, s72, s68
s_mov_b32 s36, s30
s_mov_b32 s37, s31
s_mov_b32 s38, 0x1d0000
s_mov_b32 s39, 0x20000
s_mov_b32 s52, s28
s_mov_b32 s53, s29
s_mov_b32 s54, 0x100
s_mov_b32 s55, 0x20000
s_mov_b32 s46, 0x40000
s_mov_b32 s47, 0x20000
s_cmp_eq_u32 s74, -1
s_mov_b32 s69, 30
s_cselect_b32 s69, 20, s69
s_cmp_lt_u32 s2, 144
s_cselect_b32 s69, 0, s69
s_cmp_lt_u32 s2, 112
s_cselect_b32 s69, 50, s69
s_cmp_lt_u32 s2, 48
s_cselect_b32 s69, 30, s69
s_cmp_lt_u32 s2, 16
s_cselect_b32 s69, 40, s69
s_and_b32 s66, s72, 7
s_cmp_eq_u32 s66, 3
s_cselect_b32 s66, 40, 0
s_cmp_lt_u32 s2, 112
s_cselect_b32 s66, s66, 0
s_add_u32 s69, s69, s66
s_xor_b32 s64, s65, 1024
s_cmpk_gt_u32 s69, 4
s_cbranch_scc1 L_d_1
s_waitcnt vmcnt(3)
L_d_1:
buffer_load_dwordx4 v[24:27], v1, s[40:43], s64 offen nt
s_xor_b32 s64, s65, 33792
s_cmpk_gt_u32 s69, 5
s_cbranch_scc1 L_d_2
s_waitcnt vmcnt(3)
L_d_2:
buffer_load_dwordx4 v[28:31], v1, s[40:43], s64 offen nt
s_xor_b32 s64, s65, 9216
s_cmpk_gt_u32 s69, 6
s_cbranch_scc1 L_d_3
s_waitcnt vmcnt(3)
L_d_3:
buffer_load_dwordx4 v[32:35], v1, s[40:43], s64 offen nt
s_xor_b32 s64, s65, 41984
s_cmpk_gt_u32 s69, 7
s_waitcnt vmcnt(6)
s_cbranch_scc1 L_d_4
s_waitcnt vmcnt(3)
L_d_4:
buffer_load_dwordx4 v[36:39], v1, s[40:43], s64 offen nt
s_xor_b32 s64, s65, 65536
s_cmpk_gt_u32 s69, 8
s_waitcnt vmcnt(6)
s_cbranch_scc1 L_d_5
s_waitcnt vmcnt(3)
L_d_5:
buffer_load_dwordx4 v[40:43], v1, s[40:43], s64 offen nt
s_xor_b32 s64, s65, 98304
s_cmpk_gt_u32 s69, 9
s_waitcnt vmcnt(6)
s_cbranch_scc1 L_d_6
s_waitcnt vmcnt(3)
L_d_6:
buffer_load_dwordx4 v[44:47], v1, s[40:43], s64 offen nt
s_xor_b32 s64, s65, 73728
s_cmpk_gt_u32 s69, 10
s_waitcnt vmcnt(6)
s_cbranch_scc1 L_d_7
s_waitcnt vmcnt(3)
L_d_7:
buffer_load_dwordx4 v[48:51], v1, s[40:43], s64 offen nt
s_xor_b32 s64, s65, 106496
s_cmpk_gt_u32 s69, 11
s_waitcnt vmcnt(6)
s_cbranch_scc1 L_d_8
s_waitcnt vmcnt(3)
L_d_8:
buffer_load_dwordx4 v[52:55], v1, s[40:43], s64 offen nt
s_xor_b32 s64, s65, 66560
s_cmpk_gt_u32 s69, 12
s_waitcnt vmcnt(6)
s_cbranch_scc1 L_d_9
s_waitcnt vmcnt(3)
L_d_9:
buffer_load_dwordx4 v[56:59], v1, s[40:43], s64 offen nt
s_xor_b32 s64, s65, 99328
s_cmpk_gt_u32 s69, 13
s_waitcnt vmcnt(6)
s_cbranch_scc1 L_d_10
s_waitcnt vmcnt(3)
L_d_10:
buffer_load_dwordx4 v[60:63], v1, s[40:43], s64 offen nt
s_xor_b32 s64, s65, 74752
s_cmpk_gt_u32 s69, 14
s_waitcnt vmcnt(6)
s_cbranch_scc1 L_d_11
s_waitcnt vmcnt(3)
L_d_11:
buffer_load_dwordx4 v[64:67], v1, s[40:43], s64 offen nt
s_xor_b32 s64, s65, 107520
s_cmpk_gt_u32 s69, 15
s_waitcnt vmcnt(6)
s_cbranch_scc1 L_d_12
s_waitcnt vmcnt(3)
L_d_12:
buffer_load_dwordx4 v[68:71], v1, s[40:43], s64 offen nt
s_xor_b32 s64, s65, 131072
s_cmpk_gt_u32 s69, 16
s_waitcnt vmcnt(6)
s_cbranch_scc1 L_d_13
s_waitcnt vmcnt(3)
L_d_13:
buffer_load_dwordx4 v[72:75], v1, s[40:43], s64 offen nt
s_xor_b32 s64, s65, 163840
s_cmpk_gt_u32 s69, 17
s_waitcnt vmcnt(6)
s_cbranch_scc1 L_d_14
s_waitcnt vmcnt(3)
L_d_14:
buffer_load_dwordx4 v[76:79], v1, s[40:43], s64 offen nt
s_xor_b32 s64, s65, 139264
s_cmpk_gt_u32 s69, 18
s_waitcnt vmcnt(6)
s_cbranch_scc1 L_d_15
s_waitcnt vmcnt(3)
L_d_15:
buffer_load_dwordx4 v[80:83], v1, s[40:43], s64 offen nt
s_xor_b32 s64, s65, 172032
s_cmpk_gt_u32 s69, 19
s_waitcnt vmcnt(6)
s_cbranch_scc1 L_d_16
s_waitcnt vmcnt(3)
L_d_16:
buffer_load_dwordx4 v[84:87], v1, s[40:43], s64 offen nt
s_xor_b32 s64, s65, 132096
s_cmpk_gt_u32 s69, 20
s_waitcnt vmcnt(6)
s_cbranch_scc1 L_d_17
s_waitcnt vmcnt(3)
L_d_17:
buffer_load_dwordx4 v[88:91], v1, s[40:43], s64 offen nt
s_xor_b32 s64, s65, 164864
s_cmpk_gt_u32 s69, 21
s_waitcnt vmcnt(6)
s_cbranch_scc1 L_d_18
s_waitcnt vmcnt(3)
L_d_18:
buffer_load_dwordx4 v[92:95], v1, s[40:43], s64 offen nt
s_xor_b32 s64, s65, 140288
s_cmpk_gt_u32 s69, 22
s_waitcnt vmcnt(6)
s_cbranch_scc1 L_d_19
s_waitcnt vmcnt(3)
L_d_19:
buffer_load_dwordx4 v[96:99], v1, s[40:43], s64 offen nt
s_xor_b32 s64, s65, 173056
s_cmpk_gt_u32 s69, 23
s_waitcnt vmcnt(6)
s_cbranch_scc1 L_d_20
s_waitcnt vmcnt(3)
L_d_20:
buffer_load_dwordx4 v[100:103], v1, s[40:43], s64 offen nt
s_xor_b32 s64, s65, 196608
s_cmpk_gt_u32 s69, 24
s_waitcnt vmcnt(6)
s_cbranch_scc1 L_d_21
s_waitcnt vmcnt(3)
L_d_21:
buffer_load_dwordx4 v[104:107], v1, s[40:43], s64 offen nt
s_xor_b32 s64, s65, 229376
s_cmpk_gt_u32 s69, 25
s_waitcnt vmcnt(6)
s_cbranch_scc1 L_d_22
s_waitcnt vmcnt(3)
L_d_22:
buffer_load_dwordx4 v[108:111], v1, s[40:43], s64 offen nt
s_xor_b32 s64, s65, 204800
s_cmpk_gt_u32 s69, 26
s_waitcnt vmcnt(6)
s_cbranch_scc1 L_d_23
s_waitcnt vmcnt(3)
L_d_23:
buffer_load_dwordx4 v[112:115], v1, s[40:43], s64 offen nt
s_xor_b32 s64, s65, 237568
s_cmpk_gt_u32 s69, 27
s_waitcnt vmcnt(6)
s_cbranch_scc1 L_d_24
s_waitcnt vmcnt(3)
L_d_24:
buffer_load_dwordx4 v[116:119], v1, s[40:43], s64 offen nt
s_xor_b32 s64, s65, 197632
s_cmpk_gt_u32 s69, 28
s_waitcnt vmcnt(6)
s_cbranch_scc1 L_d_25
s_waitcnt vmcnt(3)
L_d_25:
buffer_load_dwordx4 v[120:123], v1, s[40:43], s64 offen nt
s_xor_b32 s64, s65, 230400
s_cmpk_gt_u32 s69, 29
s_waitcnt vmcnt(6)
s_cbranch_scc1 L_d_26
s_waitcnt vmcnt(3)
L_d_26:
buffer_load_dwordx4 v[124:127], v1, s[40:43], s64 offen nt
s_xor_b32 s64, s65, 205824
s_cmpk_gt_u32 s69, 30
s_waitcnt vmcnt(6)
s_cbranch_scc1 L_d_27
s_waitcnt vmcnt(3)
L_d_27:
buffer_load_dwordx4 v[128:131], v1, s[40:43], s64 offen nt
s_xor_b32 s64, s65, 238592
s_cmpk_gt_u32 s69, 31
s_waitcnt vmcnt(6)
s_cbranch_scc1 L_d_28
s_waitcnt vmcnt(3)
L_d_28:
buffer_load_dwordx4 v[132:135], v1, s[40:43], s64 offen nt
s_xor_b32 s64, s65, 4096
s_cmpk_gt_u32 s69, 32
s_waitcnt vmcnt(6)
s_cbranch_scc1 L_d_29
s_waitcnt vmcnt(4)
L_d_29:
buffer_load_dwordx4 v[136:139], v1, s[40:43], s64 offen nt
s_xor_b32 s64, s65, 36864
s_cmpk_gt_u32 s69, 33
s_waitcnt vmcnt(6)
s_cbranch_scc1 L_d_30
s_waitcnt vmcnt(4)
L_d_30:
buffer_load_dwordx4 v[140:143], v1, s[40:43], s64 offen nt
s_xor_b32 s64, s65, 12288
s_cmpk_gt_u32 s69, 34
s_waitcnt vmcnt(6)
s_cbranch_scc1 L_d_31
s_waitcnt vmcnt(4)
L_d_31:
buffer_load_dwordx4 v[144:147], v1, s[40:43], s64 offen nt
s_xor_b32 s64, s65, 45056
s_cmpk_gt_u32 s69, 35
s_waitcnt vmcnt(6)
s_cbranch_scc1 L_d_32
s_waitcnt vmcnt(4)
L_d_32:
buffer_load_dwordx4 v[148:151], v1, s[40:43], s64 offen nt
s_xor_b32 s64, s65, 5120
s_cmpk_gt_u32 s69, 36
s_waitcnt vmcnt(6)
s_cbranch_scc1 L_d_33
s_waitcnt vmcnt(4)
L_d_33:
buffer_load_dwordx4 v[152:155], v1, s[40:43], s64 offen nt
s_xor_b32 s64, s65, 37888
s_cmpk_gt_u32 s69, 37
s_waitcnt vmcnt(6)
s_cbranch_scc1 L_d_34
s_waitcnt vmcnt(4)
L_d_34:
buffer_load_dwordx4 v[156:159], v1, s[40:43], s64 offen nt
s_xor_b32 s64, s65, 13312
s_cmpk_gt_u32 s69, 38
s_waitcnt vmcnt(6)
s_cbranch_scc1 L_d_35
s_waitcnt vmcnt(4)
L_d_35:
buffer_load_dwordx4 v[160:163], v1, s[40:43], s64 offen nt
s_xor_b32 s64, s65, 46080
s_cmpk_gt_u32 s69, 39
s_waitcnt vmcnt(6)
s_cbranch_scc1 L_d_36
s_waitcnt vmcnt(4)
L_d_36:
buffer_load_dwordx4 v[164:167], v1, s[40:43], s64 offen nt
s_xor_b32 s64, s65, 69632
s_cmpk_gt_u32 s69, 40
s_waitcnt vmcnt(6)
s_cbranch_scc1 L_d_37
s_waitcnt vmcnt(4)
L_d_37:
buffer_load_dwordx4 v[168:171], v1, s[40:43], s64 offen nt
s_xor_b32 s64, s65, 102400
s_cmpk_gt_u32 s69, 41
s_waitcnt vmcnt(6)
s_cbranch_scc1 L_d_38
s_waitcnt vmcnt(4)
L_d_38:
buffer_load_dwordx4 v[172:175], v1, s[40:43], s64 offen nt
s_xor_b32 s64, s65, 77824
s_cmpk_gt_u32 s69, 42
s_waitcnt vmcnt(6)
s_cbranch_scc1 L_d_39
s_waitcnt vmcnt(4)
L_d_39:
buffer_load_dwordx4 v[176:179], v1, s[40:43], s64 offen nt
s_xor_b32 s64, s65, 110592
s_cmpk_gt_u32 s69, 43
s_waitcnt vmcnt(6)
s_cbranch_scc1 L_d_40
s_waitcnt vmcnt(4)
L_d_40:
buffer_load_dwordx4 v[180:183], v1, s[40:43], s64 offen nt
s_xor_b32 s64, s65, 70656
s_cmpk_gt_u32 s69, 44
s_waitcnt vmcnt(6)
s_cbranch_scc1 L_d_41
s_waitcnt vmcnt(4)
L_d_41:
buffer_load_dwordx4 v[184:187], v1, s[40:43], s64 offen nt
s_xor_b32 s64, s65, 103424
s_cmpk_gt_u32 s69, 45
s_waitcnt vmcnt(6)
s_cbranch_scc1 L_d_42
s_waitcnt vmcnt(4)
L_d_42:
buffer_load_dwordx4 v[188:191], v1, s[40:43], s64 offen nt
s_xor_b32 s64, s65, 78848
s_cmpk_gt_u32 s69, 46
s_waitcnt vmcnt(6)
s_cbranch_scc1 L_d_43
s_waitcnt vmcnt(4)
L_d_43:
buffer_load_dwordx4 v[192:195], v1, s[40:43], s64 offen nt
s_xor_b32 s64, s65, 111616
s_cmpk_gt_u32 s69, 47
s_waitcnt vmcnt(6)
s_cbranch_scc1 L_d_44
s_waitcnt vmcnt(4)
L_d_44:
buffer_load_dwordx4 v[196:199], v1, s[40:43], s64 offen nt
s_xor_b32 s64, s65, 135168
s_cmpk_gt_u32 s69, 48
s_waitcnt vmcnt(6)
s_cbranch_scc1 L_d_45
s_waitcnt vmcnt(4)
L_d_45:
buffer_load_dwordx4 v[200:203], v1, s[40:43], s64 offen nt
s_xor_b32 s64, s65, 167936
s_cmpk_gt_u32 s69, 49
s_waitcnt vmcnt(6)
s_cbranch_scc1 L_d_46
s_waitcnt vmcnt(4)
L_d_46:
buffer_load_dwordx4 v[204:207], v1, s[40:43], s64 offen nt
s_xor_b32 s64, s65, 143360
s_cmpk_gt_u32 s69, 50
s_waitcnt vmcnt(6)
s_cbranch_scc1 L_d_47
s_waitcnt vmcnt(4)
L_d_47:
buffer_load_dwordx4 v[208:211], v1, s[40:43], s64 offen nt
s_xor_b32 s64, s65, 176128
s_cmpk_gt_u32 s69, 51
s_waitcnt vmcnt(6)
s_cbranch_scc1 L_d_48
s_waitcnt vmcnt(4)
L_d_48:
buffer_load_dwordx4 v[212:215], v1, s[40:43], s64 offen nt
s_xor_b32 s64, s65, 136192
s_cmpk_gt_u32 s69, 52
s_waitcnt vmcnt(6)
s_cbranch_scc1 L_d_49
s_waitcnt vmcnt(4)
L_d_49:
buffer_load_dwordx4 v[216:219], v1, s[40:43], s64 offen nt
s_xor_b32 s64, s65, 168960
s_cmpk_gt_u32 s69, 53
s_waitcnt vmcnt(6)
s_cbranch_scc1 L_d_50
s_waitcnt vmcnt(4)
L_d_50:
buffer_load_dwordx4 v[220:223], v1, s[40:43], s64 offen nt
s_xor_b32 s64, s65, 144384
s_cmpk_gt_u32 s69, 54
s_waitcnt vmcnt(6)
s_cbranch_scc1 L_d_51
s_waitcnt vmcnt(4)
L_d_51:
buffer_load_dwordx4 v[224:227], v1, s[40:43], s64 offen nt
s_xor_b32 s64, s65, 177152
s_cmpk_gt_u32 s69, 55
s_waitcnt vmcnt(6)
s_cbranch_scc1 L_d_52
s_waitcnt vmcnt(4)
L_d_52:
buffer_load_dwordx4 v[228:231], v1, s[40:43], s64 offen nt
s_cmp_eq_u32 s74, -1
s_mov_b32 s69, 64
s_cselect_b32 s69, 64, s69
s_cmp_lt_u32 s2, 144
s_cselect_b32 s69, 112, s69
s_cmp_lt_u32 s2, 112
s_cselect_b32 s69, 0, s69
s_cmp_lt_u32 s2, 48
s_cselect_b32 s69, 72, s69
s_cmp_lt_u32 s2, 16
s_cselect_b32 s69, 112, s69
s_xor_b32 s64, s65, 200704
s_cmpk_gt_u32 s69, 56
s_waitcnt vmcnt(6)
s_cbranch_scc1 L_d_53
s_waitcnt vmcnt(4)
L_d_53:
buffer_load_dwordx4 v[232:235], v1, s[40:43], s64 offen nt
s_xor_b32 s64, s65, 233472
s_cmpk_gt_u32 s69, 57
s_waitcnt vmcnt(6)
s_cbranch_scc1 L_d_54
s_waitcnt vmcnt(4)
L_d_54:
buffer_load_dwordx4 v[236:239], v1, s[40:43], s64 offen nt
s_xor_b32 s64, s65, 208896
s_cmpk_gt_u32 s69, 58
s_waitcnt vmcnt(6)
s_cbranch_scc1 L_d_55
s_waitcnt vmcnt(4)
L_d_55:
buffer_load_dwordx4 v[240:243], v1, s[40:43], s64 offen nt
v_and_b32 v2, 31, v0
v_lshlrev_b32 v2, 2, v2
buffer_load_dword v3, v2, s[52:55], 0 offen offset:128
s_xor_b32 s64, s65, 241664
s_cmpk_gt_u32 s69, 59
s_waitcnt vmcnt(6)
s_cbranch_scc1 L_d_56
s_waitcnt vmcnt(4)
L_d_56:
buffer_load_dwordx4 v[244:247], v1, s[40:43], s64 offen nt
s_xor_b32 s64, s65, 201728
s_cmpk_gt_u32 s69, 60
s_waitcnt vmcnt(6)
s_cbranch_scc1 L_d_57
s_waitcnt vmcnt(4)
L_d_57:
buffer_load_dwordx4 v[248:251], v1, s[40:43], s64 offen nt
s_xor_b32 s64, s65, 234496
s_cmpk_gt_u32 s69, 61
s_waitcnt vmcnt(6)
s_cbranch_scc1 L_d_58
s_waitcnt vmcnt(4)
L_d_58:
buffer_load_dwordx4 v[252:255], v1, s[40:43], s64 offen nt
s_mul_i32 s70, s34, 15360
s_add_u32 s70, s70, 69632
s_add_u32 m0, s70, 0
s_xor_b32 s64, s65, 209920
s_cmpk_gt_u32 s69, 62
s_waitcnt vmcnt(6)
s_cbranch_scc1 L_d_59
s_waitcnt vmcnt(4)
L_d_59:
buffer_load_dwordx4 v1, s[40:43], s64 offen nt lds
s_add_u32 m0, s70, 1024
s_xor_b32 s64, s65, 242688
s_cmpk_gt_u32 s69, 63
s_waitcnt vmcnt(6)
s_cbranch_scc1 L_d_60
s_waitcnt vmcnt(4)
L_d_60:
buffer_load_dwordx4 v1, s[40:43], s64 offen nt lds
s_add_u32 m0, s70, 2048
s_xor_b32 s64, s65, 0
s_cmpk_gt_u32 s69, 64
s_waitcnt vmcnt(6)
s_cbranch_scc1 L_d_61
s_waitcnt vmcnt(4)
L_d_61:
buffer_load_dwordx4 v1, s[44:47], s64 offen nt lds
s_add_u32 m0, s70, 3072
s_xor_b32 s64, s65, 32768
s_cmpk_gt_u32 s69, 65
s_waitcnt vmcnt(6)
s_cbranch_scc1 L_d_62
s_waitcnt vmcnt(4)
L_d_62:
buffer_load_dwordx4 v1, s[44:47], s64 offen nt lds
s_add_u32 m0, s70, 4096
s_xor_b32 s64, s65, 4096
s_cmpk_gt_u32 s69, 66
s_waitcnt vmcnt(6)
s_cbranch_scc1 L_d_63
s_waitcnt vmcnt(4)
L_d_63:
buffer_load_dwordx4 v1, s[44:47], s64 offen nt lds
s_add_u32 m0, s70, 5120
s_xor_b32 s64, s65, 36864
s_cmpk_gt_u32 s69, 67
s_waitcnt vmcnt(6)
s_cbranch_scc1 L_d_64
s_waitcnt vmcnt(4)
L_d_64:
buffer_load_dwordx4 v1, s[44:47], s64 offen nt lds
v_cmp_eq_u32 vcc, 0, v3
s_cbranch_vccz L_jf_66
s_mov_b32 s75, 0
L_poll_67:
v_and_b32 v2, 31, v0
v_lshlrev_b32 v2, 2, v2
buffer_load_dword v3, v2, s[52:55], 0 offen offset:128 sc1
s_waitcnt vmcnt(0)
v_cmp_eq_u32 vcc, 0, v3
s_cbranch_vccz L_pollx_68
s_sleep 40
s_add_u32 s75, s75, 1
s_cmp_lt_u32 s75, 0x100000
s_cbranch_scc1 L_poll_67
L_pollx_68:
L_jf_66:
s_mul_i32 s68, s32, 12288
s_lshl_b32 s67, s33, 8
s_add_u32 s68, s68, s67
s_add_u32 s68, s68, 16384
v_and_b32 v2, 0xf0, v1
buffer_load_dwordx4 v[4:7], v2, s[36:39], s68 offen sc1
s_add_u32 m0, s70, 6144
s_xor_b32 s64, s65, 8192
s_cmpk_gt_u32 s69, 68
s_waitcnt vmcnt(6)
s_cbranch_scc1 L_d_65
s_waitcnt vmcnt(4)
L_d_65:
buffer_load_dwordx4 v1, s[44:47], s64 offen nt lds
s_add_u32 m0, s70, 7168
s_xor_b32 s64, s65, 40960
s_cmpk_gt_u32 s69, 69
s_waitcnt vmcnt(6)
s_cbranch_scc1 L_d_69
s_waitcnt vmcnt(4)
L_d_69:
buffer_load_dwordx4 v1, s[44:47], s64 offen nt lds
s_add_u32 m0, s70, 8192
s_xor_b32 s64, s65, 12288
s_cmpk_gt_u32 s69, 70
s_waitcnt vmcnt(6)
s_cbranch_scc1 L_d_70
s_waitcnt vmcnt(4)
L_d_70:
buffer_load_dwordx4 v1, s[44:47], s64 offen nt lds
s_add_u32 m0, s70, 9216
s_xor_b32 s64, s65, 45056
s_cmpk_gt_u32 s69, 71
s_waitcnt vmcnt(6)
s_cbranch_scc1 L_d_71
s_waitcnt vmcnt(4)
L_d_71:
buffer_load_dwordx4 v1, s[44:47], s64 offen nt lds
s_add_u32 m0, s70, 10240
s_xor_b32 s64, s65, 65536
s_cmpk_gt_u32 s69, 72
s_waitcnt vmcnt(6)
s_cbranch_scc1 L_d_72
s_waitcnt vmcnt(4)
L_d_72:
buffer_load_dwordx4 v1, s[44:47], s64 offen nt lds
s_add_u32 m0, s70, 11264
s_xor_b32 s64, s65, 98304
s_cmpk_gt_u32 s69, 73
s_waitcnt vmcnt(6)
s_cbranch_scc1 L_d_73
s_waitcnt vmcnt(4)
L_d_73:
buffer_load_dwordx4 v1, s[44:47], s64 offen nt lds
s_add_u32 m0, s70, 12288
s_xor_b32 s64, s65, 69632
s_cmpk_gt_u32 s69, 74
s_waitcnt vmcnt(6)
s_cbranch_scc1 L_d_74
s_waitcnt vmcnt(4)
L_d_74:
buffer_load_dwordx4 v1, s[44:47], s64 offen nt lds
s_add_u32 m0, s70, 13312
s_xor_b32 s64, s65, 102400
s_cmpk_gt_u32 s69, 75
s_waitcnt vmcnt(6)
s_cbranch_scc1 L_d_75
s_waitcnt vmcnt(4)
L_d_75:
buffer_load_dwordx4 v1, s[44:47], s64 offen nt lds
s_add_u32 m0, s70, 14336
s_xor_b32 s64, s65, 73728
s_cmpk_gt_u32 s69, 76
s_waitcnt vmcnt(6)
s_cbranch_scc1 L_d_76
s_waitcnt vmcnt(4)
L_d_76:
buffer_load_dwordx4 v1, s[44:47], s64 offen nt lds
v_max3_u32 v3, v4, v5, v6
v_max_u32 v3, v3, v7
v_cmp_eq_u32 vcc, -1, v3
s_cbranch_vccz L_q_77
s_mov_b32 s75, 0
L_poll_78:
s_mul_i32 s68, s32, 12288
s_lshl_b32 s67, s33, 8
s_add_u32 s68, s68, s67
s_add_u32 s68, s68, 16384
v_and_b32 v2, 0xf0, v1
buffer_load_dwordx4 v[4:7], v2, s[36:39], s68 offen sc1
s_waitcnt vmcnt(0)
v_max3_u32 v3, v4, v5, v6
v_max_u32 v3, v3, v7
v_cmp_eq_u32 vcc, -1, v3
s_cbranch_vccz L_pollx_79
s_add_u32 s75, s75, 1
s_cmp_lt_u32 s75, 0x100000
s_cbranch_scc1 L_poll_78
L_pollx_79:
L_q_77:
s_mov_b32 s66, 0x3db504f3
v_dot2_f32_bf16 v8, v8, v4, 0
v_dot2_f32_bf16 v12, v12, v4, 0
v_dot2_f32_bf16 v16, v16, v4, 0
v_dot2_f32_bf16 v20, v20, v4, 0
v_dot2c_f32_bf16 v8, v9, v5
v_dot2c_f32_bf16 v12, v13, v5
v_dot2c_f32_bf16 v16, v17, v5
v_dot2c_f32_bf16 v20, v21, v5
v_dot2c_f32_bf16 v8, v10, v6
v_dot2c_f32_bf16 v12, v14, v6
v_dot2c_f32_bf16 v16, v18, v6
v_dot2c_f32_bf16 v20, v22, v6
v_dot2c_f32_bf16 v8, v11, v7
v_dot2c_f32_bf16 v12, v15, v7
v_dot2c_f32_bf16 v16, v19, v7
v_dot2c_f32_bf16 v20, v23, v7
v_add_f32_dpp v9, v8, v8 row_ror:8 row_mask:0xf bank_mask:0x3
v_add_f32_dpp v13, v12, v12 row_ror:8 row_mask:0xf bank_mask:0x3
v_add_f32_dpp v9, v16, v16 row_ror:8 row_mask:0xf bank_mask:0xc
v_add_f32_dpp v13, v20, v20 row_ror:8 row_mask:0xf bank_mask:0xc
s_nop 0
v_add_f32_dpp v17, v9, v9 row_shl:4 row_mask:0xf bank_mask:0x5
v_add_f32_dpp v17, v13, v13 row_shr:4 row_mask:0xf bank_mask:0xa
s_nop 1
v_add_f32_dpp v17, v17, v17 quad_perm:[1,0,3,2] row_mask:0xf bank_mask:0xf
s_nop 1
v_add_f32_dpp v17, v17, v17 quad_perm:[2,3,0,1] row_mask:0xf bank_mask:0xf
v_cvt_pk_bf16_f32 v17, 0, v17
v_mul_f32 v17, s66, v17
v_cvt_pk_bf16_f32 v17, 0, v17
v_dot2_f32_bf16 v24, v24, v4, 0
v_dot2_f32_bf16 v28, v28, v4, 0
v_dot2_f32_bf16 v32, v32, v4, 0
v_dot2_f32_bf16 v36, v36, v4, 0
v_dot2c_f32_bf16 v24, v25, v5
v_dot2c_f32_bf16 v28, v29, v5
v_dot2c_f32_bf16 v32, v33, v5
v_dot2c_f32_bf16 v36, v37, v5
v_dot2c_f32_bf16 v24, v26, v6
v_dot2c_f32_bf16 v28, v30, v6
v_dot2c_f32_bf16 v32, v34, v6
v_dot2c_f32_bf16 v36, v38, v6
v_dot2c_f32_bf16 v24, v27, v7
v_dot2c_f32_bf16 v28, v31, v7
v_dot2c_f32_bf16 v32, v35, v7
v_dot2c_f32_bf16 v36, v39, v7
v_add_f32_dpp v25, v24, v24 row_ror:8 row_mask:0xf bank_mask:0x3
v_add_f32_dpp v29, v28, v28 row_ror:8 row_mask:0xf bank_mask:0x3
v_add_f32_dpp v25, v32, v32 row_ror:8 row_mask:0xf bank_mask:0xc
v_add_f32_dpp v29, v36, v36 row_ror:8 row_mask:0xf bank_mask:0xc
s_nop 0
v_add_f32_dpp v8, v25, v25 row_shl:4 row_mask:0xf bank_mask:0x5
v_add_f32_dpp v8, v29, v29 row_shr:4 row_mask:0xf bank_mask:0xa
s_nop 1
v_add_f32_dpp v8, v8, v8 quad_perm:[1,0,3,2] row_mask:0xf bank_mask:0xf
s_nop 1
v_add_f32_dpp v8, v8, v8 quad_perm:[2,3,0,1] row_mask:0xf bank_mask:0xf
v_cvt_pk_bf16_f32 v8, 0, v8
v_mul_f32 v8, s66, v8
v_cvt_pk_bf16_f32 v8, 0, v8
s_xor_b32 s64, s65, 106496
s_cmpk_gt_u32 s69, 77
s_waitcnt vmcnt(6)
s_cbranch_scc1 L_d_80
s_waitcnt vmcnt(4)
L_d_80:
buffer_load_dwordx4 v[24:27], v1, s[44:47], s64 offen nt
v_dot2_f32_bf16 v40, v40, v4, 0
v_dot2_f32_bf16 v44, v44, v4, 0
v_dot2_f32_bf16 v48, v48, v4, 0
v_dot2_f32_bf16 v52, v52, v4, 0
v_dot2c_f32_bf16 v40, v41, v5
v_dot2c_f32_bf16 v44, v45, v5
v_dot2c_f32_bf16 v48, v49, v5
v_dot2c_f32_bf16 v52, v53, v5
v_dot2c_f32_bf16 v40, v42, v6
v_dot2c_f32_bf16 v44, v46, v6
v_dot2c_f32_bf16 v48, v50, v6
v_dot2c_f32_bf16 v52, v54, v6
v_dot2c_f32_bf16 v40, v43, v7
v_dot2c_f32_bf16 v44, v47, v7
v_dot2c_f32_bf16 v48, v51, v7
v_dot2c_f32_bf16 v52, v55, v7
v_add_f32_dpp v41, v40, v40 row_ror:8 row_mask:0xf bank_mask:0x3
v_add_f32_dpp v45, v44, v44 row_ror:8 row_mask:0xf bank_mask:0x3
v_add_f32_dpp v41, v48, v48 row_ror:8 row_mask:0xf bank_mask:0xc
v_add_f32_dpp v45, v52, v52 row_ror:8 row_mask:0xf bank_mask:0xc
s_nop 0
v_add_f32_dpp v9, v41, v41 row_shl:4 row_mask:0xf bank_mask:0x5
v_add_f32_dpp v9, v45, v45 row_shr:4 row_mask:0xf bank_mask:0xa
s_nop 1
v_add_f32_dpp v9, v9, v9 quad_perm:[1,0,3,2] row_mask:0xf bank_mask:0xf
s_nop 1
v_add_f32_dpp v9, v9, v9 quad_perm:[2,3,0,1] row_mask:0xf bank_mask:0xf
v_cvt_pk_bf16_f32 v9, 0, v9
v_mul_f32 v9, s66, v9
v_cvt_pk_bf16_f32 v9, 0, v9
s_and_b32 s62, s2, 7
s_lshl_b32 s62, s62, 9
s_add_u32 s62, s62, 1327104
s_lshr_b32 s63, s2, 3
s_lshl_b32 s63, s63, 2
s_add_u32 s63, s63, s62
s_cmp_eq_u32 s34, 0
s_cbranch_scc0 L_w_82
v_mov_b32 v2, 14
s_mov_b64 exec, 1
buffer_store_dword v2, off, s[36:39], s63 offset:0
s_mov_b64 exec, -1
L_w_82:
s_xor_b32 s64, s65, 77824
s_cmpk_gt_u32 s69, 78
s_waitcnt vmcnt(6)
s_cbranch_scc1 L_d_81
s_waitcnt vmcnt(4)
L_d_81:
buffer_load_dwordx4 v[28:31], v1, s[44:47], s64 offen nt
v_dot2_f32_bf16 v56, v56, v4, 0
v_dot2_f32_bf16 v60, v60, v4, 0
v_dot2_f32_bf16 v64, v64, v4, 0
v_dot2_f32_bf16 v68, v68, v4, 0
v_dot2c_f32_bf16 v56, v57, v5
v_dot2c_f32_bf16 v60, v61, v5
v_dot2c_f32_bf16 v64, v65, v5
v_dot2c_f32_bf16 v68, v69, v5
v_dot2c_f32_bf16 v56, v58, v6
v_dot2c_f32_bf16 v60, v62, v6
v_dot2c_f32_bf16 v64, v66, v6
v_dot2c_f32_bf16 v68, v70, v6
v_dot2c_f32_bf16 v56, v59, v7
v_dot2c_f32_bf16 v60, v63, v7
v_dot2c_f32_bf16 v64, v67, v7
v_dot2c_f32_bf16 v68, v71, v7
v_add_f32_dpp v57, v56, v56 row_ror:8 row_mask:0xf bank_mask:0x3
v_add_f32_dpp v61, v60, v60 row_ror:8 row_mask:0xf bank_mask:0x3
v_add_f32_dpp v57, v64, v64 row_ror:8 row_mask:0xf bank_mask:0xc
v_add_f32_dpp v61, v68, v68 row_ror:8 row_mask:0xf bank_mask:0xc
s_nop 0
v_add_f32_dpp v10, v57, v57 row_shl:4 row_mask:0xf bank_mask:0x5
v_add_f32_dpp v10, v61, v61 row_shr:4 row_mask:0xf bank_mask:0xa
s_nop 1
v_add_f32_dpp v10, v10, v10 quad_perm:[1,0,3,2] row_mask:0xf bank_mask:0xf
s_nop 1
v_add_f32_dpp v10, v10, v10 quad_perm:[2,3,0,1] row_mask:0xf bank_mask:0xf
v_cvt_pk_bf16_f32 v10, 0, v10
v_mul_f32 v10, s66, v10
v_cvt_pk_bf16_f32 v10, 0, v10
s_xor_b32 s64, s65, 110592
s_cmpk_gt_u32 s69, 79
s_waitcnt vmcnt(6)
s_cbranch_scc1 L_d_83
s_waitcnt vmcnt(4)
L_d_83:
buffer_load_dwordx4 v[32:35], v1, s[44:47], s64 offen nt
v_dot2_f32_bf16 v72, v72, v4, 0
v_dot2_f32_bf16 v76, v76, v4, 0
v_dot2_f32_bf16 v80, v80, v4, 0
v_dot2_f32_bf16 v84, v84, v4, 0
v_dot2c_f32_bf16 v72, v73, v5
v_dot2c_f32_bf16 v76, v77, v5
v_dot2c_f32_bf16 v80, v81, v5
v_dot2c_f32_bf16 v84, v85, v5
v_dot2c_f32_bf16 v72, v74, v6
v_dot2c_f32_bf16 v76, v78, v6
v_dot2c_f32_bf16 v80, v82, v6
v_dot2c_f32_bf16 v84, v86, v6
v_dot2c_f32_bf16 v72, v75, v7
v_dot2c_f32_bf16 v76, v79, v7
v_dot2c_f32_bf16 v80, v83, v7
v_dot2c_f32_bf16 v84, v87, v7
v_add_f32_dpp v73, v72, v72 row_ror:8 row_mask:0xf bank_mask:0x3
v_add_f32_dpp v77, v76, v76 row_ror:8 row_mask:0xf bank_mask:0x3
v_add_f32_dpp v73, v80, v80 row_ror:8 row_mask:0xf bank_mask:0xc
v_add_f32_dpp v77, v84, v84 row_ror:8 row_mask:0xf bank_mask:0xc
s_nop 0
v_add_f32_dpp v11, v73, v73 row_shl:4 row_mask:0xf bank_mask:0x5
v_add_f32_dpp v11, v77, v77 row_shr:4 row_mask:0xf bank_mask:0xa
s_nop 1
v_add_f32_dpp v11, v11, v11 quad_perm:[1,0,3,2] row_mask:0xf bank_mask:0xf
s_nop 1
v_add_f32_dpp v11, v11, v11 quad_perm:[2,3,0,1] row_mask:0xf bank_mask:0xf
v_cvt_pk_bf16_f32 v11, 0, v11
v_mul_f32 v11, s66, v11
v_cvt_pk_bf16_f32 v11, 0, v11
s_xor_b32 s64, s65, 1024
s_cmpk_gt_u32 s69, 80
s_waitcnt vmcnt(6)
s_cbranch_scc1 L_d_84
s_waitcnt vmcnt(4)
L_d_84:
buffer_load_dwordx4 v[36:39], v1, s[44:47], s64 offen nt
v_dot2_f32_bf16 v88, v88, v4, 0
v_dot2_f32_bf16 v92, v92, v4, 0
v_dot2_f32_bf16 v96, v96, v4, 0
v_dot2_f32_bf16 v100, v100, v4, 0
v_dot2c_f32_bf16 v88, v89, v5
v_dot2c_f32_bf16 v92, v93, v5
v_dot2c_f32_bf16 v96, v97, v5
v_dot2c_f32_bf16 v100, v101, v5
v_dot2c_f32_bf16 v88, v90, v6
v_dot2c_f32_bf16 v92, v94, v6
v_dot2c_f32_bf16 v96, v98, v6
v_dot2c_f32_bf16 v100, v102, v6
v_dot2c_f32_bf16 v88, v91, v7
v_dot2c_f32_bf16 v92, v95, v7
v_dot2c_f32_bf16 v96, v99, v7
v_dot2c_f32_bf16 v100, v103, v7
v_add_f32_dpp v89, v88, v88 row_ror:8 row_mask:0xf bank_mask:0x3
v_add_f32_dpp v93, v92, v92 row_ror:8 row_mask:0xf bank_mask:0x3
v_add_f32_dpp v89, v96, v96 row_ror:8 row_mask:0xf bank_mask:0xc
v_add_f32_dpp v93, v100, v100 row_ror:8 row_mask:0xf bank_mask:0xc
s_nop 0
v_add_f32_dpp v12, v89, v89 row_shl:4 row_mask:0xf bank_mask:0x5
v_add_f32_dpp v12, v93, v93 row_shr:4 row_mask:0xf bank_mask:0xa
s_nop 1
v_add_f32_dpp v12, v12, v12 quad_perm:[1,0,3,2] row_mask:0xf bank_mask:0xf
s_nop 1
v_add_f32_dpp v12, v12, v12 quad_perm:[2,3,0,1] row_mask:0xf bank_mask:0xf
v_cvt_pk_bf16_f32 v12, 0, v12
v_mul_f32 v12, s66, v12
v_cvt_pk_bf16_f32 v12, 0, v12
s_xor_b32 s64, s65, 33792
s_cmpk_gt_u32 s69, 81
s_waitcnt vmcnt(6)
s_cbranch_scc1 L_d_85
s_waitcnt vmcnt(4)
L_d_85:
buffer_load_dwordx4 v[40:43], v1, s[44:47], s64 offen nt
v_dot2_f32_bf16 v104, v104, v4, 0
v_dot2_f32_bf16 v108, v108, v4, 0
v_dot2_f32_bf16 v112, v112, v4, 0
v_dot2_f32_bf16 v116, v116, v4, 0
v_dot2c_f32_bf16 v104, v105, v5
v_dot2c_f32_bf16 v108, v109, v5
v_dot2c_f32_bf16 v112, v113, v5
v_dot2c_f32_bf16 v116, v117, v5
v_dot2c_f32_bf16 v104, v106, v6
v_dot2c_f32_bf16 v108, v110, v6
v_dot2c_f32_bf16 v112, v114, v6
v_dot2c_f32_bf16 v116, v118, v6
v_dot2c_f32_bf16 v104, v107, v7
v_dot2c_f32_bf16 v108, v111, v7
v_dot2c_f32_bf16 v112, v115, v7
v_dot2c_f32_bf16 v116, v119, v7
v_add_f32_dpp v105, v104, v104 row_ror:8 row_mask:0xf bank_mask:0x3
v_add_f32_dpp v109, v108, v108 row_ror:8 row_mask:0xf bank_mask:0x3
v_add_f32_dpp v105, v112, v112 row_ror:8 row_mask:0xf bank_mask:0xc
v_add_f32_dpp v109, v116, v116 row_ror:8 row_mask:0xf bank_mask:0xc
s_nop 0
v_add_f32_dpp v13, v105, v105 row_shl:4 row_mask:0xf bank_mask:0x5
v_add_f32_dpp v13, v109, v109 row_shr:4 row_mask:0xf bank_mask:0xa
s_nop 1
v_add_f32_dpp v13, v13, v13 quad_perm:[1,0,3,2] row_mask:0xf bank_mask:0xf
s_nop 1
v_add_f32_dpp v13, v13, v13 quad_perm:[2,3,0,1] row_mask:0xf bank_mask:0xf
v_cvt_pk_bf16_f32 v13, 0, v13
v_mul_f32 v13, s66, v13
v_cvt_pk_bf16_f32 v13, 0, v13
s_xor_b32 s64, s65, 5120
s_cmpk_gt_u32 s69, 82
s_waitcnt vmcnt(6)
s_cbranch_scc1 L_d_86
s_waitcnt vmcnt(4)
L_d_86:
buffer_load_dwordx4 v[44:47], v1, s[44:47], s64 offen nt
v_dot2_f32_bf16 v120, v120, v4, 0
v_dot2_f32_bf16 v124, v124, v4, 0
v_dot2_f32_bf16 v128, v128, v4, 0
v_dot2_f32_bf16 v132, v132, v4, 0
v_dot2c_f32_bf16 v120, v121, v5
v_dot2c_f32_bf16 v124, v125, v5
v_dot2c_f32_bf16 v128, v129, v5
v_dot2c_f32_bf16 v132, v133, v5
v_dot2c_f32_bf16 v120, v122, v6
v_dot2c_f32_bf16 v124, v126, v6
v_dot2c_f32_bf16 v128, v130, v6
v_dot2c_f32_bf16 v132, v134, v6
v_dot2c_f32_bf16 v120, v123, v7
v_dot2c_f32_bf16 v124, v127, v7
v_dot2c_f32_bf16 v128, v131, v7
v_dot2c_f32_bf16 v132, v135, v7
v_add_f32_dpp v121, v120, v120 row_ror:8 row_mask:0xf bank_mask:0x3
v_add_f32_dpp v125, v124, v124 row_ror:8 row_mask:0xf bank_mask:0x3
v_add_f32_dpp v121, v128, v128 row_ror:8 row_mask:0xf bank_mask:0xc
v_add_f32_dpp v125, v132, v132 row_ror:8 row_mask:0xf bank_mask:0xc
s_nop 0
v_add_f32_dpp v14, v121, v121 row_shl:4 row_mask:0xf bank_mask:0x5
v_add_f32_dpp v14, v125, v125 row_shr:4 row_mask:0xf bank_mask:0xa
s_nop 1
v_add_f32_dpp v14, v14, v14 quad_perm:[1,0,3,2] row_mask:0xf bank_mask:0xf
s_nop 1
v_add_f32_dpp v14, v14, v14 quad_perm:[2,3,0,1] row_mask:0xf bank_mask:0xf
v_cvt_pk_bf16_f32 v14, 0, v14
v_mul_f32 v14, s66, v14
v_cvt_pk_bf16_f32 v14, 0, v14
s_xor_b32 s64, s65, 37888
s_cmpk_gt_u32 s69, 83
s_waitcnt vmcnt(6)
s_cbranch_scc1 L_d_87
s_waitcnt vmcnt(4)
L_d_87:
buffer_load_dwordx4 v[48:51], v1, s[44:47], s64 offen nt
v_dot2_f32_bf16 v136, v136, v4, 0
v_dot2_f32_bf16 v140, v140, v4, 0
v_dot2_f32_bf16 v144, v144, v4, 0
v_dot2_f32_bf16 v148, v148, v4, 0
v_dot2c_f32_bf16 v136, v137, v5
v_dot2c_f32_bf16 v140, v141, v5
v_dot2c_f32_bf16 v144, v145, v5
v_dot2c_f32_bf16 v148, v149, v5
v_dot2c_f32_bf16 v136, v138, v6
v_dot2c_f32_bf16 v140, v142, v6
v_dot2c_f32_bf16 v144, v146, v6
v_dot2c_f32_bf16 v148, v150, v6
v_dot2c_f32_bf16 v136, v139, v7
v_dot2c_f32_bf16 v140, v143, v7
v_dot2c_f32_bf16 v144, v147, v7
v_dot2c_f32_bf16 v148, v151, v7
v_add_f32_dpp v137, v136, v136 row_ror:8 row_mask:0xf bank_mask:0x3
v_add_f32_dpp v141, v140, v140 row_ror:8 row_mask:0xf bank_mask:0x3
v_add_f32_dpp v137, v144, v144 row_ror:8 row_mask:0xf bank_mask:0xc
v_add_f32_dpp v141, v148, v148 row_ror:8 row_mask:0xf bank_mask:0xc
s_nop 0
v_add_f32_dpp v15, v137, v137 row_shl:4 row_mask:0xf bank_mask:0x5
v_add_f32_dpp v15, v141, v141 row_shr:4 row_mask:0xf bank_mask:0xa
s_nop 1
v_add_f32_dpp v15, v15, v15 quad_perm:[1,0,3,2] row_mask:0xf bank_mask:0xf
s_nop 1
v_add_f32_dpp v15, v15, v15 quad_perm:[2,3,0,1] row_mask:0xf bank_mask:0xf
v_cvt_pk_bf16_f32 v15, 0, v15
v_mul_f32 v15, s66, v15
v_cvt_pk_bf16_f32 v15, 0, v15
s_xor_b32 s64, s65, 9216
s_cmpk_gt_u32 s69, 84
s_waitcnt vmcnt(6)
s_cbranch_scc1 L_d_88
s_waitcnt vmcnt(4)
L_d_88:
buffer_load_dwordx4 v[52:55], v1, s[44:47], s64 offen nt
v_dot2_f32_bf16 v152, v152, v4, 0
v_dot2_f32_bf16 v156, v156, v4, 0
v_dot2_f32_bf16 v160, v160, v4, 0
v_dot2_f32_bf16 v164, v164, v4, 0
v_dot2c_f32_bf16 v152, v153, v5
v_dot2c_f32_bf16 v156, v157, v5
v_dot2c_f32_bf16 v160, v161, v5
v_dot2c_f32_bf16 v164, v165, v5
v_dot2c_f32_bf16 v152, v154, v6
v_dot2c_f32_bf16 v156, v158, v6
v_dot2c_f32_bf16 v160, v162, v6
v_dot2c_f32_bf16 v164, v166, v6
v_dot2c_f32_bf16 v152, v155, v7
v_dot2c_f32_bf16 v156, v159, v7
v_dot2c_f32_bf16 v160, v163, v7
v_dot2c_f32_bf16 v164, v167, v7
v_add_f32_dpp v153, v152, v152 row_ror:8 row_mask:0xf bank_mask:0x3
v_add_f32_dpp v157, v156, v156 row_ror:8 row_mask:0xf bank_mask:0x3
v_add_f32_dpp v153, v160, v160 row_ror:8 row_mask:0xf bank_mask:0xc
v_add_f32_dpp v157, v164, v164 row_ror:8 row_mask:0xf bank_mask:0xc
s_nop 0
v_add_f32_dpp v16, v153, v153 row_shl:4 row_mask:0xf bank_mask:0x5
v_add_f32_dpp v16, v157, v157 row_shr:4 row_mask:0xf bank_mask:0xa
s_nop 1
v_add_f32_dpp v16, v16, v16 quad_perm:[1,0,3,2] row_mask:0xf bank_mask:0xf
s_nop 1
v_add_f32_dpp v16, v16, v16 quad_perm:[2,3,0,1] row_mask:0xf bank_mask:0xf
v_cvt_pk_bf16_f32 v16, 0, v16
v_mul_f32 v16, s66, v16
v_cvt_pk_bf16_f32 v16, 0, v16
s_xor_b32 s64, s65, 41984
s_cmpk_gt_u32 s69, 85
s_waitcnt vmcnt(6)
s_cbranch_scc1 L_d_89
s_waitcnt vmcnt(4)
L_d_89:
buffer_load_dwordx4 v[56:59], v1, s[44:47], s64 offen nt
v_dot2_f32_bf16 v168, v168, v4, 0
v_dot2_f32_bf16 v172, v172, v4, 0
v_dot2_f32_bf16 v176, v176, v4, 0
v_dot2_f32_bf16 v180, v180, v4, 0
v_dot2c_f32_bf16 v168, v169, v5
v_dot2c_f32_bf16 v172, v173, v5
v_dot2c_f32_bf16 v176, v177, v5
v_dot2c_f32_bf16 v180, v181, v5
v_dot2c_f32_bf16 v168, v170, v6
v_dot2c_f32_bf16 v172, v174, v6
v_dot2c_f32_bf16 v176, v178, v6
v_dot2c_f32_bf16 v180, v182, v6
v_dot2c_f32_bf16 v168, v171, v7
v_dot2c_f32_bf16 v172, v175, v7
v_dot2c_f32_bf16 v176, v179, v7
v_dot2c_f32_bf16 v180, v183, v7
v_add_f32_dpp v169, v168, v168 row_ror:8 row_mask:0xf bank_mask:0x3
v_add_f32_dpp v173, v172, v172 row_ror:8 row_mask:0xf bank_mask:0x3
v_add_f32_dpp v169, v176, v176 row_ror:8 row_mask:0xf bank_mask:0xc
v_add_f32_dpp v173, v180, v180 row_ror:8 row_mask:0xf bank_mask:0xc
s_nop 0
v_add_f32_dpp v18, v169, v169 row_shl:4 row_mask:0xf bank_mask:0x5
v_add_f32_dpp v18, v173, v173 row_shr:4 row_mask:0xf bank_mask:0xa
s_nop 1
v_add_f32_dpp v18, v18, v18 quad_perm:[1,0,3,2] row_mask:0xf bank_mask:0xf
s_nop 1
v_add_f32_dpp v18, v18, v18 quad_perm:[2,3,0,1] row_mask:0xf bank_mask:0xf
v_cvt_pk_bf16_f32 v18, 0, v18
v_mul_f32 v18, s66, v18
v_cvt_pk_bf16_f32 v18, 0, v18
s_cmp_eq_u32 s34, 1
s_cbranch_scc0 L_w_91
v_mov_b32 v60, 22
s_mov_b64 exec, 1
buffer_store_dword v60, off, s[36:39], s63 offset:0
s_mov_b64 exec, -1
L_w_91:
s_xor_b32 s64, s65, 13312
s_cmpk_gt_u32 s69, 86
s_waitcnt vmcnt(6)
s_cbranch_scc1 L_d_90
s_waitcnt vmcnt(4)
L_d_90:
buffer_load_dwordx4 v[64:67], v1, s[44:47], s64 offen nt
v_dot2_f32_bf16 v184, v184, v4, 0
v_dot2_f32_bf16 v188, v188, v4, 0
v_dot2_f32_bf16 v192, v192, v4, 0
v_dot2_f32_bf16 v196, v196, v4, 0
v_dot2c_f32_bf16 v184, v185, v5
v_dot2c_f32_bf16 v188, v189, v5
v_dot2c_f32_bf16 v192, v193, v5
v_dot2c_f32_bf16 v196, v197, v5
v_dot2c_f32_bf16 v184, v186, v6
v_dot2c_f32_bf16 v188, v190, v6
v_dot2c_f32_bf16 v192, v194, v6
v_dot2c_f32_bf16 v196, v198, v6
v_dot2c_f32_bf16 v184, v187, v7
v_dot2c_f32_bf16 v188, v191, v7
v_dot2c_f32_bf16 v192, v195, v7
v_dot2c_f32_bf16 v196, v199, v7
v_add_f32_dpp v185, v184, v184 row_ror:8 row_mask:0xf bank_mask:0x3
v_add_f32_dpp v189, v188, v188 row_ror:8 row_mask:0xf bank_mask:0x3
v_add_f32_dpp v185, v192, v192 row_ror:8 row_mask:0xf bank_mask:0xc
v_add_f32_dpp v189, v196, v196 row_ror:8 row_mask:0xf bank_mask:0xc
s_nop 0
v_add_f32_dpp v19, v185, v185 row_shl:4 row_mask:0xf bank_mask:0x5
v_add_f32_dpp v19, v189, v189 row_shr:4 row_mask:0xf bank_mask:0xa
s_nop 1
v_add_f32_dpp v19, v19, v19 quad_perm:[1,0,3,2] row_mask:0xf bank_mask:0xf
s_nop 1
v_add_f32_dpp v19, v19, v19 quad_perm:[2,3,0,1] row_mask:0xf bank_mask:0xf
v_cvt_pk_bf16_f32 v19, 0, v19
v_mul_f32 v19, s66, v19
v_cvt_pk_bf16_f32 v19, 0, v19
s_xor_b32 s64, s65, 46080
s_cmpk_gt_u32 s69, 87
s_waitcnt vmcnt(6)
s_cbranch_scc1 L_d_92
s_waitcnt vmcnt(4)
L_d_92:
buffer_load_dwordx4 v[68:71], v1, s[44:47], s64 offen nt
v_dot2_f32_bf16 v200, v200, v4, 0
v_dot2_f32_bf16 v204, v204, v4, 0
v_dot2_f32_bf16 v208, v208, v4, 0
v_dot2_f32_bf16 v212, v212, v4, 0
v_dot2c_f32_bf16 v200, v201, v5
v_dot2c_f32_bf16 v204, v205, v5
v_dot2c_f32_bf16 v208, v209, v5
v_dot2c_f32_bf16 v212, v213, v5
v_dot2c_f32_bf16 v200, v202, v6
v_dot2c_f32_bf16 v204, v206, v6
v_dot2c_f32_bf16 v208, v210, v6
v_dot2c_f32_bf16 v212, v214, v6
v_dot2c_f32_bf16 v200, v203, v7
v_dot2c_f32_bf16 v204, v207, v7
v_dot2c_f32_bf16 v208, v211, v7
v_dot2c_f32_bf16 v212, v215, v7
v_add_f32_dpp v201, v200, v200 row_ror:8 row_mask:0xf bank_mask:0x3
v_add_f32_dpp v205, v204, v204 row_ror:8 row_mask:0xf bank_mask:0x3
v_add_f32_dpp v201, v208, v208 row_ror:8 row_mask:0xf bank_mask:0xc
v_add_f32_dpp v205, v212, v212 row_ror:8 row_mask:0xf bank_mask:0xc
s_nop 0
v_add_f32_dpp v20, v201, v201 row_shl:4 row_mask:0xf bank_mask:0x5
v_add_f32_dpp v20, v205, v205 row_shr:4 row_mask:0xf bank_mask:0xa
s_nop 1
v_add_f32_dpp v20, v20, v20 quad_perm:[1,0,3,2] row_mask:0xf bank_mask:0xf
s_nop 1
v_add_f32_dpp v20, v20, v20 quad_perm:[2,3,0,1] row_mask:0xf bank_mask:0xf
v_cvt_pk_bf16_f32 v20, 0, v20
v_mul_f32 v20, s66, v20
v_cvt_pk_bf16_f32 v20, 0, v20
s_xor_b32 s64, s65, 66560
s_cmpk_gt_u32 s69, 88
s_waitcnt vmcnt(6)
s_cbranch_scc1 L_d_93
s_waitcnt vmcnt(4)
L_d_93:
buffer_load_dwordx4 v[72:75], v1, s[44:47], s64 offen nt
v_dot2_f32_bf16 v216, v216, v4, 0
v_dot2_f32_bf16 v220, v220, v4, 0
v_dot2_f32_bf16 v224, v224, v4, 0
v_dot2_f32_bf16 v228, v228, v4, 0
v_dot2c_f32_bf16 v216, v217, v5
v_dot2c_f32_bf16 v220, v221, v5
v_dot2c_f32_bf16 v224, v225, v5
v_dot2c_f32_bf16 v228, v229, v5
v_dot2c_f32_bf16 v216, v218, v6
v_dot2c_f32_bf16 v220, v222, v6
v_dot2c_f32_bf16 v224, v226, v6
v_dot2c_f32_bf16 v228, v230, v6
v_dot2c_f32_bf16 v216, v219, v7
v_dot2c_f32_bf16 v220, v223, v7
v_dot2c_f32_bf16 v224, v227, v7
v_dot2c_f32_bf16 v228, v231, v7
v_add_f32_dpp v217, v216, v216 row_ror:8 row_mask:0xf bank_mask:0x3
v_add_f32_dpp v221, v220, v220 row_ror:8 row_mask:0xf bank_mask:0x3
v_add_f32_dpp v217, v224, v224 row_ror:8 row_mask:0xf bank_mask:0xc
v_add_f32_dpp v221, v228, v228 row_ror:8 row_mask:0xf bank_mask:0xc
s_nop 0
v_add_f32_dpp v21, v217, v217 row_shl:4 row_mask:0xf bank_mask:0x5
v_add_f32_dpp v21, v221, v221 row_shr:4 row_mask:0xf bank_mask:0xa
s_nop 1
v_add_f32_dpp v21, v21, v21 quad_perm:[1,0,3,2] row_mask:0xf bank_mask:0xf
s_nop 1
v_add_f32_dpp v21, v21, v21 quad_perm:[2,3,0,1] row_mask:0xf bank_mask:0xf
v_cvt_pk_bf16_f32 v21, 0, v21
v_mul_f32 v21, s66, v21
v_cvt_pk_bf16_f32 v21, 0, v21
s_xor_b32 s64, s65, 99328
s_cmpk_gt_u32 s69, 89
s_waitcnt vmcnt(6)
s_cbranch_scc1 L_d_94
s_waitcnt vmcnt(4)
L_d_94:
buffer_load_dwordx4 v[76:79], v1, s[44:47], s64 offen nt
v_dot2_f32_bf16 v232, v232, v4, 0
v_dot2_f32_bf16 v236, v236, v4, 0
v_dot2_f32_bf16 v240, v240, v4, 0
v_dot2_f32_bf16 v244, v244, v4, 0
v_dot2c_f32_bf16 v232, v233, v5
v_dot2c_f32_bf16 v236, v237, v5
v_dot2c_f32_bf16 v240, v241, v5
v_dot2c_f32_bf16 v244, v245, v5
v_dot2c_f32_bf16 v232, v234, v6
v_dot2c_f32_bf16 v236, v238, v6
v_dot2c_f32_bf16 v240, v242, v6
v_dot2c_f32_bf16 v244, v246, v6
v_dot2c_f32_bf16 v232, v235, v7
v_dot2c_f32_bf16 v236, v239, v7
v_dot2c_f32_bf16 v240, v243, v7
v_dot2c_f32_bf16 v244, v247, v7
v_add_f32_dpp v233, v232, v232 row_ror:8 row_mask:0xf bank_mask:0x3
v_add_f32_dpp v237, v236, v236 row_ror:8 row_mask:0xf bank_mask:0x3
v_add_f32_dpp v233, v240, v240 row_ror:8 row_mask:0xf bank_mask:0xc
v_add_f32_dpp v237, v244, v244 row_ror:8 row_mask:0xf bank_mask:0xc
s_nop 0
v_add_f32_dpp v22, v233, v233 row_shl:4 row_mask:0xf bank_mask:0x5
v_add_f32_dpp v22, v237, v237 row_shr:4 row_mask:0xf bank_mask:0xa
s_nop 1
v_add_f32_dpp v22, v22, v22 quad_perm:[1,0,3,2] row_mask:0xf bank_mask:0xf
s_nop 1
v_add_f32_dpp v22, v22, v22 quad_perm:[2,3,0,1] row_mask:0xf bank_mask:0xf
v_cvt_pk_bf16_f32 v22, 0, v22
v_mul_f32 v22, s66, v22
v_cvt_pk_bf16_f32 v22, 0, v22
s_xor_b32 s64, s65, 70656
s_cmpk_gt_u32 s69, 90
s_waitcnt vmcnt(6)
s_cbranch_scc1 L_d_95
s_waitcnt vmcnt(5)
L_d_95:
buffer_load_dwordx4 v[80:83], v1, s[44:47], s64 offen nt
v_lshl_add_u32 v84, v0, 4, s70
ds_read_b128 v[88:91], v84 offset:0
ds_read_b128 v[92:95], v84 offset:1024
s_waitcnt lgkmcnt(0)
v_dot2_f32_bf16 v248, v248, v4, 0
v_dot2_f32_bf16 v252, v252, v4, 0
v_dot2_f32_bf16 v88, v88, v4, 0
v_dot2_f32_bf16 v92, v92, v4, 0
v_dot2c_f32_bf16 v248, v249, v5
v_dot2c_f32_bf16 v252, v253, v5
v_dot2c_f32_bf16 v88, v89, v5
v_dot2c_f32_bf16 v92, v93, v5
v_dot2c_f32_bf16 v248, v250, v6
v_dot2c_f32_bf16 v252, v254, v6
v_dot2c_f32_bf16 v88, v90, v6
v_dot2c_f32_bf16 v92, v94, v6
v_dot2c_f32_bf16 v248, v251, v7
v_dot2c_f32_bf16 v252, v255, v7
v_dot2c_f32_bf16 v88, v91, v7
v_dot2c_f32_bf16 v92, v95, v7
v_add_f32_dpp v249, v248, v248 row_ror:8 row_mask:0xf bank_mask:0x3
v_add_f32_dpp v253, v252, v252 row_ror:8 row_mask:0xf bank_mask:0x3
v_add_f32_dpp v249, v88, v88 row_ror:8 row_mask:0xf bank_mask:0xc
v_add_f32_dpp v253, v92, v92 row_ror:8 row_mask:0xf bank_mask:0xc
s_nop 0
v_add_f32_dpp v23, v249, v249 row_shl:4 row_mask:0xf bank_mask:0x5
v_add_f32_dpp v23, v253, v253 row_shr:4 row_mask:0xf bank_mask:0xa
s_nop 1
v_add_f32_dpp v23, v23, v23 quad_perm:[1,0,3,2] row_mask:0xf bank_mask:0xf
s_nop 1
v_add_f32_dpp v23, v23, v23 quad_perm:[2,3,0,1] row_mask:0xf bank_mask:0xf
v_cvt_pk_bf16_f32 v23, 0, v23
v_mul_f32 v23, s66, v23
v_cvt_pk_bf16_f32 v23, 0, v23
s_xor_b32 s64, s65, 103424
s_cmpk_gt_u32 s69, 91
s_waitcnt vmcnt(6)
s_cbranch_scc1 L_d_96
s_waitcnt vmcnt(5)
L_d_96:
buffer_load_dwordx4 v[96:99], v1, s[44:47], s64 offen nt
v_max3_f32 v2, v17, v8, v9
v_max3_f32 v2, v2, v10, v11
v_max3_f32 v2, v2, v12, v13
v_max3_f32 v2, v2, v14, v15
v_max3_f32 v2, v2, v16, v18
v_max3_f32 v2, v2, v19, v20
v_max3_f32 v2, v2, v21, v22
v_max_f32 v2, v2, v23
v_max_f32 v2, 0xff7fffff, v2
s_nop 1
v_max_f32_dpp v2, v2, v2 row_ror:4 row_mask:0xf bank_mask:0xf
s_nop 1
v_max_f32_dpp v2, v2, v2 row_ror:8 row_mask:0xf bank_mask:0xf
v_mov_b32 v3, v2
s_nop 1
v_permlane16_swap_b32 v2, v3
s_nop 1
v_max_f32 v2, v2, v3
v_mov_b32 v3, v2
s_nop 1
v_permlane32_swap_b32 v2, v3
s_nop 1
v_max_f32 v2, v2, v3
s_mov_b32 s67, 0x3fb8aa3b
v_sub_f32 v17, v17, v2
v_sub_f32 v8, v8, v2
v_sub_f32 v9, v9, v2
v_sub_f32 v10, v10, v2
v_sub_f32 v11, v11, v2
v_sub_f32 v12, v12, v2
v_sub_f32 v13, v13, v2
v_sub_f32 v14, v14, v2
v_sub_f32 v15, v15, v2
v_sub_f32 v16, v16, v2
v_sub_f32 v18, v18, v2
v_sub_f32 v19, v19, v2
v_sub_f32 v20, v20, v2
v_sub_f32 v21, v21, v2
v_sub_f32 v22, v22, v2
v_sub_f32 v23, v23, v2
v_mul_f32 v17, s67, v17
v_mul_f32 v8, s67, v8
v_mul_f32 v9, s67, v9
v_mul_f32 v10, s67, v10
v_mul_f32 v11, s67, v11
v_mul_f32 v12, s67, v12
v_mul_f32 v13, s67, v13
v_mul_f32 v14, s67, v14
v_mul_f32 v15, s67, v15
v_mul_f32 v16, s67, v16
v_mul_f32 v18, s67, v18
v_mul_f32 v19, s67, v19
v_mul_f32 v20, s67, v20
v_mul_f32 v21, s67, v21
v_mul_f32 v22, s67, v22
v_mul_f32 v23, s67, v23
s_xor_b32 s64, s65, 74752
s_cmpk_gt_u32 s69, 92
s_waitcnt vmcnt(6)
s_cbranch_scc1 L_d_97
s_waitcnt vmcnt(5)
L_d_97:
buffer_load_dwordx4 v[120:123], v1, s[44:47], s64 offen nt
v_exp_f32 v17, v17
v_exp_f32 v8, v8
v_exp_f32 v9, v9
v_exp_f32 v10, v10
v_exp_f32 v11, v11
v_exp_f32 v12, v12
v_exp_f32 v13, v13
v_exp_f32 v14, v14
v_exp_f32 v15, v15
v_exp_f32 v16, v16
v_exp_f32 v18, v18
v_exp_f32 v19, v19
v_exp_f32 v20, v20
v_exp_f32 v21, v21
v_exp_f32 v22, v22
v_exp_f32 v23, v23
v_add_f32 v3, v17, v8
v_add_f32 v3, v3, v9
v_add_f32 v3, v3, v10
v_add_f32 v3, v3, v11
v_add_f32 v3, v3, v12
v_add_f32 v3, v3, v13
v_add_f32 v3, v3, v14
v_add_f32 v3, v3, v15
v_add_f32 v3, v3, v16
v_add_f32 v3, v3, v18
v_add_f32 v3, v3, v19
v_add_f32 v3, v3, v20
v_add_f32 v3, v3, v21
v_add_f32 v3, v3, v22
v_add_f32 v3, v3, v23
s_nop 1
v_add_f32_dpp v3, v3, v3 row_ror:4 row_mask:0xf bank_mask:0xf
s_nop 1
v_add_f32_dpp v3, v3, v3 row_ror:8 row_mask:0xf bank_mask:0xf
v_mov_b32 v100, v3
s_nop 1
v_permlane16_swap_b32 v3, v100
s_nop 1
v_add_f32 v3, v3, v100
v_mov_b32 v100, v3
s_nop 1
v_permlane32_swap_b32 v3, v100
s_nop 1
v_add_f32 v3, v3, v100
v_min_u32 v3, -2, v3
s_lshl_b32 s68, s34, 3
v_mov_b32 v100, s68
ds_write_b64 v100, v[2:3] offset:256
v_and_b32 v101, 15, v0
v_lshrrev_b32 v102, 1, v101
v_and_b32 v101, 1, v0
v_lshlrev_b32 v101, 4, v101
v_mov_b32 v103, 0xffff
v_lshlrev_b32 v101, v101, v103
v_cmp_eq_u32 vcc, 0, v102
s_nop 1
v_cndmask_b32 v4, 0, v101, vcc
v_cmp_eq_u32 vcc, 1, v102
s_nop 1
v_cndmask_b32 v5, 0, v101, vcc
v_cmp_eq_u32 vcc, 2, v102
s_nop 1
v_cndmask_b32 v6, 0, v101, vcc
v_cmp_eq_u32 vcc, 3, v102
s_nop 1
v_cndmask_b32 v7, 0, v101, vcc
s_xor_b32 s64, s65, 107520
s_cmpk_gt_u32 s69, 93
s_waitcnt vmcnt(6)
s_cbranch_scc1 L_d_98
s_waitcnt vmcnt(5)
L_d_98:
buffer_load_dwordx4 v[124:127], v1, s[44:47], s64 offen nt
v_mov_b32 v100, 0
s_mov_b32 s75, 0
L_poll_99:
ds_read_b128 v[104:107], v100 offset:256
ds_read_b128 v[108:111], v100 offset:272
s_waitcnt lgkmcnt(0)
v_max3_u32 v101, v105, v107, v109
v_max_u32 v101, v101, v111
v_cmp_eq_u32 vcc, -1, v101
s_cbranch_vccz L_pollx_100
s_add_u32 s75, s75, 1
s_cmp_lt_u32 s75, 0x1000000
s_cbranch_scc1 L_poll_99
L_pollx_100:
v_max3_f32 v101, v104, v106, v108
v_max_f32 v101, v101, v110
v_sub_f32 v104, v104, v101
v_sub_f32 v106, v106, v101
v_sub_f32 v108, v108, v101
v_sub_f32 v110, v110, v101
v_sub_f32 v2, v2, v101
v_mul_f32 v104, s67, v104
v_mul_f32 v106, s67, v106
v_mul_f32 v108, s67, v108
v_mul_f32 v110, s67, v110
v_mul_f32 v2, s67, v2
v_exp_f32 v104, v104
v_exp_f32 v106, v106
v_exp_f32 v108, v108
v_exp_f32 v110, v110
v_exp_f32 v2, v2
v_mul_f32 v3, v104, v105
v_fmac_f32 v3, v106, v107
v_fmac_f32 v3, v108, v109
v_fmac_f32 v3, v110, v111
v_rcp_f32 v3, v3
s_nop 0
v_mul_f32 v2, v2, v3
v_mul_f32 v17, v17, v2
v_mul_f32 v8, v8, v2
v_mul_f32 v9, v9, v2
v_mul_f32 v10, v10, v2
v_mul_f32 v11, v11, v2
v_mul_f32 v12, v12, v2
v_mul_f32 v13, v13, v2
v_mul_f32 v14, v14, v2
v_mul_f32 v15, v15, v2
v_mul_f32 v16, v16, v2
v_mul_f32 v18, v18, v2
v_mul_f32 v19, v19, v2
v_mul_f32 v20, v20, v2
v_mul_f32 v21, v21, v2
v_mul_f32 v22, v22, v2
v_mul_f32 v23, v23, v2
v_cvt_pk_bf16_f32 v17, v17, v17
v_cvt_pk_bf16_f32 v8, v8, v8
v_cvt_pk_bf16_f32 v9, v9, v9
v_cvt_pk_bf16_f32 v10, v10, v10
v_cvt_pk_bf16_f32 v11, v11, v11
v_cvt_pk_bf16_f32 v12, v12, v12
v_cvt_pk_bf16_f32 v13, v13, v13
v_cvt_pk_bf16_f32 v14, v14, v14
v_cvt_pk_bf16_f32 v15, v15, v15
v_cvt_pk_bf16_f32 v16, v16, v16
v_cvt_pk_bf16_f32 v18, v18, v18
v_cvt_pk_bf16_f32 v19, v19, v19
v_cvt_pk_bf16_f32 v20, v20, v20
v_cvt_pk_bf16_f32 v21, v21, v21
v_cvt_pk_bf16_f32 v22, v22, v22
v_cvt_pk_bf16_f32 v23, v23, v23
s_nop 1
s_cmp_eq_u32 s34, 2
s_cbranch_scc0 L_w_102
v_mov_b32 v60, 30
s_mov_b64 exec, 1
buffer_store_dword v60, off, s[36:39], s63 offset:0
s_mov_b64 exec, -1
L_w_102:
s_xor_b32 s64, s65, 78848
s_cmpk_gt_u32 s69, 94
s_waitcnt vmcnt(6)
s_cbranch_scc1 L_d_101
s_waitcnt vmcnt(5)
L_d_101:
buffer_load_dwordx4 v[128:131], v1, s[44:47], s64 offen nt
ds_read_b128 v[132:135], v84 offset:2048
ds_read_b128 v[136:139], v84 offset:3072
ds_read_b128 v[140:143], v84 offset:4096
ds_read_b128 v[144:147], v84 offset:5120
ds_read_b128 v[148:151], v84 offset:6144
ds_read_b128 v[152:155], v84 offset:7168
ds_read_b128 v[156:159], v84 offset:8192
ds_read_b128 v[160:163], v84 offset:9216
s_waitcnt lgkmcnt(0)
v_and_b32_dpp v104, v17, v4 row_newbcast:0 row_mask:0xf bank_mask:0xf
v_and_b32_dpp v105, v17, v5 row_newbcast:0 row_mask:0xf bank_mask:0xf
v_and_b32_dpp v106, v17, v6 row_newbcast:0 row_mask:0xf bank_mask:0xf
v_and_b32_dpp v107, v17, v7 row_newbcast:0 row_mask:0xf bank_mask:0xf
v_and_b32_dpp v108, v17, v4 row_newbcast:4 row_mask:0xf bank_mask:0xf
v_and_b32_dpp v109, v17, v5 row_newbcast:4 row_mask:0xf bank_mask:0xf
v_and_b32_dpp v110, v17, v6 row_newbcast:4 row_mask:0xf bank_mask:0xf
v_and_b32_dpp v111, v17, v7 row_newbcast:4 row_mask:0xf bank_mask:0xf
v_mfma_f32_16x16x32_bf16 v[112:115], v[104:107], v[132:135], 0
v_and_b32_dpp v104, v15, v4 row_newbcast:0 row_mask:0xf bank_mask:0xf
v_and_b32_dpp v105, v15, v5 row_newbcast:0 row_mask:0xf bank_mask:0xf
v_and_b32_dpp v106, v15, v6 row_newbcast:0 row_mask:0xf bank_mask:0xf
v_and_b32_dpp v107, v15, v7 row_newbcast:0 row_mask:0xf bank_mask:0xf
v_mfma_f32_16x16x32_bf16 v[112:115], v[108:111], v[136:139], v[112:115]
v_and_b32_dpp v108, v15, v4 row_newbcast:4 row_mask:0xf bank_mask:0xf
v_and_b32_dpp v109, v15, v5 row_newbcast:4 row_mask:0xf bank_mask:0xf
v_and_b32_dpp v110, v15, v6 row_newbcast:4 row_mask:0xf bank_mask:0xf
v_and_b32_dpp v111, v15, v7 row_newbcast:4 row_mask:0xf bank_mask:0xf
v_mfma_f32_16x16x32_bf16 v[112:115], v[104:107], v[140:143], v[112:115]
s_xor_b32 s64, s65, 111616
s_cmpk_gt_u32 s69, 95
s_waitcnt vmcnt(6)
s_cbranch_scc1 L_d_103
s_waitcnt vmcnt(5)
L_d_103:
buffer_load_dwordx4 v[164:167], v1, s[44:47], s64 offen nt
v_and_b32_dpp v104, v17, v4 row_newbcast:8 row_mask:0xf bank_mask:0xf
v_and_b32_dpp v105, v17, v5 row_newbcast:8 row_mask:0xf bank_mask:0xf
v_and_b32_dpp v106, v17, v6 row_newbcast:8 row_mask:0xf bank_mask:0xf
v_and_b32_dpp v107, v17, v7 row_newbcast:8 row_mask:0xf bank_mask:0xf
v_mfma_f32_16x16x32_bf16 v[112:115], v[108:111], v[144:147], v[112:115]
v_and_b32_dpp v108, v17, v4 row_newbcast:12 row_mask:0xf bank_mask:0xf
v_and_b32_dpp v109, v17, v5 row_newbcast:12 row_mask:0xf bank_mask:0xf
v_and_b32_dpp v110, v17, v6 row_newbcast:12 row_mask:0xf bank_mask:0xf
v_and_b32_dpp v111, v17, v7 row_newbcast:12 row_mask:0xf bank_mask:0xf
v_mfma_f32_16x16x32_bf16 v[112:115], v[104:107], v[148:151], v[112:115]
v_and_b32_dpp v104, v15, v4 row_newbcast:8 row_mask:0xf bank_mask:0xf
v_and_b32_dpp v105, v15, v5 row_newbcast:8 row_mask:0xf bank_mask:0xf
v_and_b32_dpp v106, v15, v6 row_newbcast:8 row_mask:0xf bank_mask:0xf
v_and_b32_dpp v107, v15, v7 row_newbcast:8 row_mask:0xf bank_mask:0xf
v_mfma_f32_16x16x32_bf16 v[112:115], v[108:111], v[152:155], v[112:115]
s_xor_b32 s64, s65, 131072
s_cmpk_gt_u32 s69, 96
s_waitcnt vmcnt(6)
s_cbranch_scc1 L_d_104
s_waitcnt vmcnt(5)
L_d_104:
buffer_load_dwordx4 v[168:171], v1, s[44:47], s64 offen nt
v_and_b32_dpp v108, v15, v4 row_newbcast:12 row_mask:0xf bank_mask:0xf
v_and_b32_dpp v109, v15, v5 row_newbcast:12 row_mask:0xf bank_mask:0xf
v_and_b32_dpp v110, v15, v6 row_newbcast:12 row_mask:0xf bank_mask:0xf
v_and_b32_dpp v111, v15, v7 row_newbcast:12 row_mask:0xf bank_mask:0xf
v_mfma_f32_16x16x32_bf16 v[112:115], v[104:107], v[156:159], v[112:115]
v_and_b32_dpp v104, v9, v4 row_newbcast:0 row_mask:0xf bank_mask:0xf
v_and_b32_dpp v105, v9, v5 row_newbcast:0 row_mask:0xf bank_mask:0xf
v_and_b32_dpp v106, v9, v6 row_newbcast:0 row_mask:0xf bank_mask:0xf
v_and_b32_dpp v107, v9, v7 row_newbcast:0 row_mask:0xf bank_mask:0xf
v_mfma_f32_16x16x32_bf16 v[112:115], v[108:111], v[160:163], v[112:115]
ds_read_b128 v[172:175], v84 offset:10240
ds_read_b128 v[176:179], v84 offset:11264
ds_read_b128 v[180:183], v84 offset:12288
ds_read_b128 v[184:187], v84 offset:13312
ds_read_b128 v[188:191], v84 offset:14336
s_waitcnt lgkmcnt(0)
v_and_b32_dpp v108, v9, v4 row_newbcast:4 row_mask:0xf bank_mask:0xf
v_and_b32_dpp v109, v9, v5 row_newbcast:4 row_mask:0xf bank_mask:0xf
v_and_b32_dpp v110, v9, v6 row_newbcast:4 row_mask:0xf bank_mask:0xf
v_and_b32_dpp v111, v9, v7 row_newbcast:4 row_mask:0xf bank_mask:0xf
v_mfma_f32_16x16x32_bf16 v[112:115], v[104:107], v[172:175], v[112:115]
s_xor_b32 s64, s65, 163840
s_cmpk_gt_u32 s69, 97
s_waitcnt vmcnt(6)
s_cbranch_scc1 L_d_105
s_waitcnt vmcnt(5)
L_d_105:
buffer_load_dwordx4 v[192:195], v1, s[44:47], s64 offen nt
v_and_b32_dpp v104, v18, v4 row_newbcast:0 row_mask:0xf bank_mask:0xf
v_and_b32_dpp v105, v18, v5 row_newbcast:0 row_mask:0xf bank_mask:0xf
v_and_b32_dpp v106, v18, v6 row_newbcast:0 row_mask:0xf bank_mask:0xf
v_and_b32_dpp v107, v18, v7 row_newbcast:0 row_mask:0xf bank_mask:0xf
v_mfma_f32_16x16x32_bf16 v[112:115], v[108:111], v[176:179], v[112:115]
v_and_b32_dpp v108, v18, v4 row_newbcast:4 row_mask:0xf bank_mask:0xf
v_and_b32_dpp v109, v18, v5 row_newbcast:4 row_mask:0xf bank_mask:0xf
v_and_b32_dpp v110, v18, v6 row_newbcast:4 row_mask:0xf bank_mask:0xf
v_and_b32_dpp v111, v18, v7 row_newbcast:4 row_mask:0xf bank_mask:0xf
v_mfma_f32_16x16x32_bf16 v[112:115], v[104:107], v[180:183], v[112:115]
v_and_b32_dpp v104, v9, v4 row_newbcast:8 row_mask:0xf bank_mask:0xf
v_and_b32_dpp v105, v9, v5 row_newbcast:8 row_mask:0xf bank_mask:0xf
v_and_b32_dpp v106, v9, v6 row_newbcast:8 row_mask:0xf bank_mask:0xf
v_and_b32_dpp v107, v9, v7 row_newbcast:8 row_mask:0xf bank_mask:0xf
v_mfma_f32_16x16x32_bf16 v[112:115], v[108:111], v[184:187], v[112:115]
s_xor_b32 s64, s65, 135168
s_cmpk_gt_u32 s69, 98
s_waitcnt vmcnt(6)
s_cbranch_scc1 L_d_106
s_waitcnt vmcnt(5)
L_d_106:
buffer_load_dwordx4 v[196:199], v1, s[44:47], s64 offen nt
v_and_b32_dpp v108, v9, v4 row_newbcast:12 row_mask:0xf bank_mask:0xf
v_and_b32_dpp v109, v9, v5 row_newbcast:12 row_mask:0xf bank_mask:0xf
v_and_b32_dpp v110, v9, v6 row_newbcast:12 row_mask:0xf bank_mask:0xf
v_and_b32_dpp v111, v9, v7 row_newbcast:12 row_mask:0xf bank_mask:0xf
v_mfma_f32_16x16x32_bf16 v[112:115], v[104:107], v[188:191], v[112:115]
v_and_b32_dpp v104, v18, v4 row_newbcast:8 row_mask:0xf bank_mask:0xf
v_and_b32_dpp v105, v18, v5 row_newbcast:8 row_mask:0xf bank_mask:0xf
v_and_b32_dpp v106, v18, v6 row_newbcast:8 row_mask:0xf bank_mask:0xf
v_and_b32_dpp v107, v18, v7 row_newbcast:8 row_mask:0xf bank_mask:0xf
v_mfma_f32_16x16x32_bf16 v[112:115], v[108:111], v[24:27], v[112:115]
v_and_b32_dpp v108, v18, v4 row_newbcast:12 row_mask:0xf bank_mask:0xf
v_and_b32_dpp v109, v18, v5 row_newbcast:12 row_mask:0xf bank_mask:0xf
v_and_b32_dpp v110, v18, v6 row_newbcast:12 row_mask:0xf bank_mask:0xf
v_and_b32_dpp v111, v18, v7 row_newbcast:12 row_mask:0xf bank_mask:0xf
v_mfma_f32_16x16x32_bf16 v[112:115], v[104:107], v[28:31], v[112:115]
s_xor_b32 s64, s65, 167936
s_cmpk_gt_u32 s69, 99
s_waitcnt vmcnt(6)
s_cbranch_scc1 L_d_107
s_waitcnt vmcnt(5)
L_d_107:
buffer_load_dwordx4 v[200:203], v1, s[44:47], s64 offen nt
v_and_b32_dpp v104, v8, v4 row_newbcast:0 row_mask:0xf bank_mask:0xf
v_and_b32_dpp v105, v8, v5 row_newbcast:0 row_mask:0xf bank_mask:0xf
v_and_b32_dpp v106, v8, v6 row_newbcast:0 row_mask:0xf bank_mask:0xf
v_and_b32_dpp v107, v8, v7 row_newbcast:0 row_mask:0xf bank_mask:0xf
v_mfma_f32_16x16x32_bf16 v[112:115], v[108:111], v[32:35], v[112:115]
v_and_b32_dpp v108, v8, v4 row_newbcast:4 row_mask:0xf bank_mask:0xf
v_and_b32_dpp v109, v8, v5 row_newbcast:4 row_mask:0xf bank_mask:0xf
v_and_b32_dpp v110, v8, v6 row_newbcast:4 row_mask:0xf bank_mask:0xf
v_and_b32_dpp v111, v8, v7 row_newbcast:4 row_mask:0xf bank_mask:0xf
v_mfma_f32_16x16x32_bf16 v[112:115], v[104:107], v[36:39], v[112:115]
v_and_b32_dpp v104, v16, v4 row_newbcast:0 row_mask:0xf bank_mask:0xf
v_and_b32_dpp v105, v16, v5 row_newbcast:0 row_mask:0xf bank_mask:0xf
v_and_b32_dpp v106, v16, v6 row_newbcast:0 row_mask:0xf bank_mask:0xf
v_and_b32_dpp v107, v16, v7 row_newbcast:0 row_mask:0xf bank_mask:0xf
v_mfma_f32_16x16x32_bf16 v[112:115], v[108:111], v[40:43], v[112:115]
s_xor_b32 s64, s65, 139264
s_cmpk_gt_u32 s69, 100
s_waitcnt vmcnt(6)
s_cbranch_scc1 L_d_108
s_waitcnt vmcnt(5)
L_d_108:
buffer_load_dwordx4 v[204:207], v1, s[44:47], s64 offen nt
v_and_b32_dpp v108, v16, v4 row_newbcast:4 row_mask:0xf bank_mask:0xf
v_and_b32_dpp v109, v16, v5 row_newbcast:4 row_mask:0xf bank_mask:0xf
v_and_b32_dpp v110, v16, v6 row_newbcast:4 row_mask:0xf bank_mask:0xf
v_and_b32_dpp v111, v16, v7 row_newbcast:4 row_mask:0xf bank_mask:0xf
v_mfma_f32_16x16x32_bf16 v[112:115], v[104:107], v[44:47], v[112:115]
v_and_b32_dpp v104, v8, v4 row_newbcast:8 row_mask:0xf bank_mask:0xf
v_and_b32_dpp v105, v8, v5 row_newbcast:8 row_mask:0xf bank_mask:0xf
v_and_b32_dpp v106, v8, v6 row_newbcast:8 row_mask:0xf bank_mask:0xf
v_and_b32_dpp v107, v8, v7 row_newbcast:8 row_mask:0xf bank_mask:0xf
v_mfma_f32_16x16x32_bf16 v[112:115], v[108:111], v[48:51], v[112:115]
v_and_b32_dpp v108, v8, v4 row_newbcast:12 row_mask:0xf bank_mask:0xf
v_and_b32_dpp v109, v8, v5 row_newbcast:12 row_mask:0xf bank_mask:0xf
v_and_b32_dpp v110, v8, v6 row_newbcast:12 row_mask:0xf bank_mask:0xf
v_and_b32_dpp v111, v8, v7 row_newbcast:12 row_mask:0xf bank_mask:0xf
v_mfma_f32_16x16x32_bf16 v[112:115], v[104:107], v[52:55], v[112:115]
s_xor_b32 s64, s65, 172032
s_cmpk_gt_u32 s69, 101
s_waitcnt vmcnt(6)
s_cbranch_scc1 L_d_109
s_waitcnt vmcnt(5)
L_d_109:
buffer_load_dwordx4 v[208:211], v1, s[44:47], s64 offen nt
v_and_b32_dpp v104, v16, v4 row_newbcast:8 row_mask:0xf bank_mask:0xf
v_and_b32_dpp v105, v16, v5 row_newbcast:8 row_mask:0xf bank_mask:0xf
v_and_b32_dpp v106, v16, v6 row_newbcast:8 row_mask:0xf bank_mask:0xf
v_and_b32_dpp v107, v16, v7 row_newbcast:8 row_mask:0xf bank_mask:0xf
v_mfma_f32_16x16x32_bf16 v[112:115], v[108:111], v[56:59], v[112:115]
v_and_b32_dpp v108, v16, v4 row_newbcast:12 row_mask:0xf bank_mask:0xf
v_and_b32_dpp v109, v16, v5 row_newbcast:12 row_mask:0xf bank_mask:0xf
v_and_b32_dpp v110, v16, v6 row_newbcast:12 row_mask:0xf bank_mask:0xf
v_and_b32_dpp v111, v16, v7 row_newbcast:12 row_mask:0xf bank_mask:0xf
v_mfma_f32_16x16x32_bf16 v[112:115], v[104:107], v[64:67], v[112:115]
v_and_b32_dpp v104, v10, v4 row_newbcast:0 row_mask:0xf bank_mask:0xf
v_and_b32_dpp v105, v10, v5 row_newbcast:0 row_mask:0xf bank_mask:0xf
v_and_b32_dpp v106, v10, v6 row_newbcast:0 row_mask:0xf bank_mask:0xf
v_and_b32_dpp v107, v10, v7 row_newbcast:0 row_mask:0xf bank_mask:0xf
v_mfma_f32_16x16x32_bf16 v[112:115], v[108:111], v[68:71], v[112:115]
s_cmp_eq_u32 s34, 3
s_cbranch_scc0 L_w_111
v_mov_b32 v60, 38
s_mov_b64 exec, 1
buffer_store_dword v60, off, s[36:39], s63 offset:0
s_mov_b64 exec, -1
L_w_111:
s_xor_b32 s64, s65, 143360
s_cmpk_gt_u32 s69, 102
s_waitcnt vmcnt(6)
s_cbranch_scc1 L_d_110
s_waitcnt vmcnt(5)
L_d_110:
buffer_load_dwordx4 v[212:215], v1, s[44:47], s64 offen nt
v_and_b32_dpp v108, v10, v4 row_newbcast:4 row_mask:0xf bank_mask:0xf
v_and_b32_dpp v109, v10, v5 row_newbcast:4 row_mask:0xf bank_mask:0xf
v_and_b32_dpp v110, v10, v6 row_newbcast:4 row_mask:0xf bank_mask:0xf
v_and_b32_dpp v111, v10, v7 row_newbcast:4 row_mask:0xf bank_mask:0xf
v_mfma_f32_16x16x32_bf16 v[112:115], v[104:107], v[72:75], v[112:115]
v_and_b32_dpp v104, v19, v4 row_newbcast:0 row_mask:0xf bank_mask:0xf
v_and_b32_dpp v105, v19, v5 row_newbcast:0 row_mask:0xf bank_mask:0xf
v_and_b32_dpp v106, v19, v6 row_newbcast:0 row_mask:0xf bank_mask:0xf
v_and_b32_dpp v107, v19, v7 row_newbcast:0 row_mask:0xf bank_mask:0xf
v_mfma_f32_16x16x32_bf16 v[112:115], v[108:111], v[76:79], v[112:115]
v_and_b32_dpp v108, v19, v4 row_newbcast:4 row_mask:0xf bank_mask:0xf
v_and_b32_dpp v109, v19, v5 row_newbcast:4 row_mask:0xf bank_mask:0xf
v_and_b32_dpp v110, v19, v6 row_newbcast:4 row_mask:0xf bank_mask:0xf
v_and_b32_dpp v111, v19, v7 row_newbcast:4 row_mask:0xf bank_mask:0xf
v_mfma_f32_16x16x32_bf16 v[112:115], v[104:107], v[80:83], v[112:115]
s_xor_b32 s64, s65, 176128
s_cmpk_gt_u32 s69, 103
s_waitcnt vmcnt(6)
s_cbranch_scc1 L_d_112
s_waitcnt vmcnt(5)
L_d_112:
buffer_load_dwordx4 v[216:219], v1, s[44:47], s64 offen nt
v_and_b32_dpp v104, v10, v4 row_newbcast:8 row_mask:0xf bank_mask:0xf
v_and_b32_dpp v105, v10, v5 row_newbcast:8 row_mask:0xf bank_mask:0xf
v_and_b32_dpp v106, v10, v6 row_newbcast:8 row_mask:0xf bank_mask:0xf
v_and_b32_dpp v107, v10, v7 row_newbcast:8 row_mask:0xf bank_mask:0xf
v_mfma_f32_16x16x32_bf16 v[112:115], v[108:111], v[96:99], v[112:115]
v_and_b32_dpp v108, v10, v4 row_newbcast:12 row_mask:0xf bank_mask:0xf
v_and_b32_dpp v109, v10, v5 row_newbcast:12 row_mask:0xf bank_mask:0xf
v_and_b32_dpp v110, v10, v6 row_newbcast:12 row_mask:0xf bank_mask:0xf
v_and_b32_dpp v111, v10, v7 row_newbcast:12 row_mask:0xf bank_mask:0xf
v_mfma_f32_16x16x32_bf16 v[112:115], v[104:107], v[120:123], v[112:115]
v_and_b32_dpp v104, v19, v4 row_newbcast:8 row_mask:0xf bank_mask:0xf
v_and_b32_dpp v105, v19, v5 row_newbcast:8 row_mask:0xf bank_mask:0xf
v_and_b32_dpp v106, v19, v6 row_newbcast:8 row_mask:0xf bank_mask:0xf
v_and_b32_dpp v107, v19, v7 row_newbcast:8 row_mask:0xf bank_mask:0xf
v_mfma_f32_16x16x32_bf16 v[112:115], v[108:111], v[124:127], v[112:115]
s_xor_b32 s64, s65, 196608
s_cmpk_gt_u32 s69, 104
s_waitcnt vmcnt(6)
s_cbranch_scc1 L_d_113
s_waitcnt vmcnt(5)
L_d_113:
buffer_load_dwordx4 v[220:223], v1, s[44:47], s64 offen nt
v_and_b32_dpp v108, v19, v4 row_newbcast:12 row_mask:0xf bank_mask:0xf
v_and_b32_dpp v109, v19, v5 row_newbcast:12 row_mask:0xf bank_mask:0xf
v_and_b32_dpp v110, v19, v6 row_newbcast:12 row_mask:0xf bank_mask:0xf
v_and_b32_dpp v111, v19, v7 row_newbcast:12 row_mask:0xf bank_mask:0xf
v_mfma_f32_16x16x32_bf16 v[112:115], v[104:107], v[128:131], v[112:115]
v_and_b32_dpp v104, v11, v4 row_newbcast:0 row_mask:0xf bank_mask:0xf
v_and_b32_dpp v105, v11, v5 row_newbcast:0 row_mask:0xf bank_mask:0xf
v_and_b32_dpp v106, v11, v6 row_newbcast:0 row_mask:0xf bank_mask:0xf
v_and_b32_dpp v107, v11, v7 row_newbcast:0 row_mask:0xf bank_mask:0xf
v_mfma_f32_16x16x32_bf16 v[112:115], v[108:111], v[164:167], v[112:115]
v_and_b32_dpp v108, v11, v4 row_newbcast:4 row_mask:0xf bank_mask:0xf
v_and_b32_dpp v109, v11, v5 row_newbcast:4 row_mask:0xf bank_mask:0xf
v_and_b32_dpp v110, v11, v6 row_newbcast:4 row_mask:0xf bank_mask:0xf
v_and_b32_dpp v111, v11, v7 row_newbcast:4 row_mask:0xf bank_mask:0xf
v_mfma_f32_16x16x32_bf16 v[112:115], v[104:107], v[168:171], v[112:115]
s_xor_b32 s64, s65, 229376
s_cmpk_gt_u32 s69, 105
s_waitcnt vmcnt(6)
s_cbranch_scc1 L_d_114
s_waitcnt vmcnt(5)
L_d_114:
buffer_load_dwordx4 v[224:227], v1, s[44:47], s64 offen nt
v_and_b32_dpp v104, v20, v4 row_newbcast:0 row_mask:0xf bank_mask:0xf
v_and_b32_dpp v105, v20, v5 row_newbcast:0 row_mask:0xf bank_mask:0xf
v_and_b32_dpp v106, v20, v6 row_newbcast:0 row_mask:0xf bank_mask:0xf
v_and_b32_dpp v107, v20, v7 row_newbcast:0 row_mask:0xf bank_mask:0xf
v_mfma_f32_16x16x32_bf16 v[112:115], v[108:111], v[192:195], v[112:115]
v_and_b32_dpp v108, v20, v4 row_newbcast:4 row_mask:0xf bank_mask:0xf
v_and_b32_dpp v109, v20, v5 row_newbcast:4 row_mask:0xf bank_mask:0xf
v_and_b32_dpp v110, v20, v6 row_newbcast:4 row_mask:0xf bank_mask:0xf
v_and_b32_dpp v111, v20, v7 row_newbcast:4 row_mask:0xf bank_mask:0xf
v_mfma_f32_16x16x32_bf16 v[112:115], v[104:107], v[196:199], v[112:115]
s_xor_b32 s64, s65, 200704
s_cmpk_gt_u32 s69, 106
s_waitcnt vmcnt(6)
s_cbranch_scc1 L_d_115
s_waitcnt vmcnt(5)
L_d_115:
buffer_load_dwordx4 v[228:231], v1, s[44:47], s64 offen nt
v_and_b32_dpp v104, v11, v4 row_newbcast:8 row_mask:0xf bank_mask:0xf
v_and_b32_dpp v105, v11, v5 row_newbcast:8 row_mask:0xf bank_mask:0xf
v_and_b32_dpp v106, v11, v6 row_newbcast:8 row_mask:0xf bank_mask:0xf
v_and_b32_dpp v107, v11, v7 row_newbcast:8 row_mask:0xf bank_mask:0xf
v_mfma_f32_16x16x32_bf16 v[112:115], v[108:111], v[200:203], v[112:115]
s_xor_b32 s64, s65, 233472
s_cmpk_gt_u32 s69, 107
s_waitcnt vmcnt(6)
s_cbranch_scc1 L_d_116
s_waitcnt vmcnt(5)
L_d_116:
buffer_load_dwordx4 v[232:235], v1, s[44:47], s64 offen nt
v_and_b32_dpp v108, v11, v4 row_newbcast:12 row_mask:0xf bank_mask:0xf
v_and_b32_dpp v109, v11, v5 row_newbcast:12 row_mask:0xf bank_mask:0xf
v_and_b32_dpp v110, v11, v6 row_newbcast:12 row_mask:0xf bank_mask:0xf
v_and_b32_dpp v111, v11, v7 row_newbcast:12 row_mask:0xf bank_mask:0xf
v_mfma_f32_16x16x32_bf16 v[112:115], v[104:107], v[204:207], v[112:115]
s_xor_b32 s64, s65, 204800
s_cmpk_gt_u32 s69, 108
s_waitcnt vmcnt(6)
s_cbranch_scc1 L_d_117
s_waitcnt vmcnt(5)
L_d_117:
buffer_load_dwordx4 v[236:239], v1, s[44:47], s64 offen nt
v_and_b32_dpp v104, v20, v4 row_newbcast:8 row_mask:0xf bank_mask:0xf
v_and_b32_dpp v105, v20, v5 row_newbcast:8 row_mask:0xf bank_mask:0xf
v_and_b32_dpp v106, v20, v6 row_newbcast:8 row_mask:0xf bank_mask:0xf
v_and_b32_dpp v107, v20, v7 row_newbcast:8 row_mask:0xf bank_mask:0xf
v_mfma_f32_16x16x32_bf16 v[112:115], v[108:111], v[208:211], v[112:115]
s_xor_b32 s64, s65, 237568
s_cmpk_gt_u32 s69, 109
s_waitcnt vmcnt(6)
s_cbranch_scc1 L_d_118
s_waitcnt vmcnt(5)
L_d_118:
buffer_load_dwordx4 v[240:243], v1, s[44:47], s64 offen nt
v_and_b32_dpp v108, v20, v4 row_newbcast:12 row_mask:0xf bank_mask:0xf
v_and_b32_dpp v109, v20, v5 row_newbcast:12 row_mask:0xf bank_mask:0xf
v_and_b32_dpp v110, v20, v6 row_newbcast:12 row_mask:0xf bank_mask:0xf
v_and_b32_dpp v111, v20, v7 row_newbcast:12 row_mask:0xf bank_mask:0xf
v_mfma_f32_16x16x32_bf16 v[112:115], v[104:107], v[212:215], v[112:115]
s_cmp_eq_u32 s34, 0
s_cbranch_scc0 L_w_120
v_mov_b32 v60, 46
s_mov_b64 exec, 1
buffer_store_dword v60, off, s[36:39], s63 offset:0
s_mov_b64 exec, -1
L_w_120:
s_xor_b32 s64, s65, 208896
s_cmpk_gt_u32 s69, 110
s_waitcnt vmcnt(6)
s_cbranch_scc1 L_d_119
s_waitcnt vmcnt(5)
L_d_119:
buffer_load_dwordx4 v[244:247], v1, s[44:47], s64 offen nt
v_and_b32_dpp v104, v13, v4 row_newbcast:0 row_mask:0xf bank_mask:0xf
v_and_b32_dpp v105, v13, v5 row_newbcast:0 row_mask:0xf bank_mask:0xf
v_and_b32_dpp v106, v13, v6 row_newbcast:0 row_mask:0xf bank_mask:0xf
v_and_b32_dpp v107, v13, v7 row_newbcast:0 row_mask:0xf bank_mask:0xf
v_mfma_f32_16x16x32_bf16 v[112:115], v[108:111], v[216:219], v[112:115]
s_xor_b32 s64, s65, 241664
s_cmpk_gt_u32 s69, 111
s_waitcnt vmcnt(6)
s_cbranch_scc1 L_d_121
s_waitcnt vmcnt(5)
L_d_121:
buffer_load_dwordx4 v[248:251], v1, s[44:47], s64 offen nt
v_and_b32_dpp v108, v13, v4 row_newbcast:4 row_mask:0xf bank_mask:0xf
v_and_b32_dpp v109, v13, v5 row_newbcast:4 row_mask:0xf bank_mask:0xf
v_and_b32_dpp v110, v13, v6 row_newbcast:4 row_mask:0xf bank_mask:0xf
v_and_b32_dpp v111, v13, v7 row_newbcast:4 row_mask:0xf bank_mask:0xf
v_mfma_f32_16x16x32_bf16 v[112:115], v[104:107], v[220:223], v[112:115]
s_xor_b32 s64, s65, 132096
s_waitcnt vmcnt(5)
buffer_load_dwordx4 v[252:255], v1, s[44:47], s64 offen nt
v_and_b32_dpp v104, v22, v4 row_newbcast:0 row_mask:0xf bank_mask:0xf
v_and_b32_dpp v105, v22, v5 row_newbcast:0 row_mask:0xf bank_mask:0xf
v_and_b32_dpp v106, v22, v6 row_newbcast:0 row_mask:0xf bank_mask:0xf
v_and_b32_dpp v107, v22, v7 row_newbcast:0 row_mask:0xf bank_mask:0xf
v_mfma_f32_16x16x32_bf16 v[112:115], v[108:111], v[224:227], v[112:115]
v_and_b32_dpp v108, v22, v4 row_newbcast:4 row_mask:0xf bank_mask:0xf
v_and_b32_dpp v109, v22, v5 row_newbcast:4 row_mask:0xf bank_mask:0xf
v_and_b32_dpp v110, v22, v6 row_newbcast:4 row_mask:0xf bank_mask:0xf
v_and_b32_dpp v111, v22, v7 row_newbcast:4 row_mask:0xf bank_mask:0xf
v_mfma_f32_16x16x32_bf16 v[112:115], v[104:107], v[228:231], v[112:115]
s_xor_b32 s64, s65, 164864
s_waitcnt vmcnt(5)
buffer_load_dwordx4 v[88:91], v1, s[44:47], s64 offen nt
v_and_b32_dpp v104, v13, v4 row_newbcast:8 row_mask:0xf bank_mask:0xf
v_and_b32_dpp v105, v13, v5 row_newbcast:8 row_mask:0xf bank_mask:0xf
v_and_b32_dpp v106, v13, v6 row_newbcast:8 row_mask:0xf bank_mask:0xf
v_and_b32_dpp v107, v13, v7 row_newbcast:8 row_mask:0xf bank_mask:0xf
v_mfma_f32_16x16x32_bf16 v[112:115], v[108:111], v[232:235], v[112:115]
s_xor_b32 s64, s65, 136192
s_waitcnt vmcnt(5)
buffer_load_dwordx4 v[92:95], v1, s[44:47], s64 offen nt
v_and_b32_dpp v108, v13, v4 row_newbcast:12 row_mask:0xf bank_mask:0xf
v_and_b32_dpp v109, v13, v5 row_newbcast:12 row_mask:0xf bank_mask:0xf
v_and_b32_dpp v110, v13, v6 row_newbcast:12 row_mask:0xf bank_mask:0xf
v_and_b32_dpp v111, v13, v7 row_newbcast:12 row_mask:0xf bank_mask:0xf
v_mfma_f32_16x16x32_bf16 v[112:115], v[104:107], v[236:239], v[112:115]
s_xor_b32 s64, s65, 168960
s_waitcnt vmcnt(5)
buffer_load_dwordx4 v[132:135], v1, s[44:47], s64 offen nt
v_and_b32_dpp v104, v22, v4 row_newbcast:8 row_mask:0xf bank_mask:0xf
v_and_b32_dpp v105, v22, v5 row_newbcast:8 row_mask:0xf bank_mask:0xf
v_and_b32_dpp v106, v22, v6 row_newbcast:8 row_mask:0xf bank_mask:0xf
v_and_b32_dpp v107, v22, v7 row_newbcast:8 row_mask:0xf bank_mask:0xf
v_mfma_f32_16x16x32_bf16 v[112:115], v[108:111], v[240:243], v[112:115]
s_xor_b32 s64, s65, 140288
s_waitcnt vmcnt(5)
buffer_load_dwordx4 v[136:139], v1, s[44:47], s64 offen nt
v_and_b32_dpp v108, v22, v4 row_newbcast:12 row_mask:0xf bank_mask:0xf
v_and_b32_dpp v109, v22, v5 row_newbcast:12 row_mask:0xf bank_mask:0xf
v_and_b32_dpp v110, v22, v6 row_newbcast:12 row_mask:0xf bank_mask:0xf
v_and_b32_dpp v111, v22, v7 row_newbcast:12 row_mask:0xf bank_mask:0xf
v_mfma_f32_16x16x32_bf16 v[112:115], v[104:107], v[244:247], v[112:115]
s_xor_b32 s64, s65, 173056
s_waitcnt vmcnt(5)
buffer_load_dwordx4 v[140:143], v1, s[44:47], s64 offen nt
v_and_b32_dpp v104, v12, v4 row_newbcast:0 row_mask:0xf bank_mask:0xf
v_and_b32_dpp v105, v12, v5 row_newbcast:0 row_mask:0xf bank_mask:0xf
v_and_b32_dpp v106, v12, v6 row_newbcast:0 row_mask:0xf bank_mask:0xf
v_and_b32_dpp v107, v12, v7 row_newbcast:0 row_mask:0xf bank_mask:0xf
v_mfma_f32_16x16x32_bf16 v[112:115], v[108:111], v[248:251], v[112:115]
s_cmp_eq_u32 s34, 1
s_cbranch_scc0 L_w_122
v_mov_b32 v60, 54
s_mov_b64 exec, 1
buffer_store_dword v60, off, s[36:39], s63 offset:0
s_mov_b64 exec, -1
L_w_122:
s_xor_b32 s64, s65, 144384
s_waitcnt vmcnt(5)
buffer_load_dwordx4 v[144:147], v1, s[44:47], s64 offen nt
v_and_b32_dpp v108, v12, v4 row_newbcast:4 row_mask:0xf bank_mask:0xf
v_and_b32_dpp v109, v12, v5 row_newbcast:4 row_mask:0xf bank_mask:0xf
v_and_b32_dpp v110, v12, v6 row_newbcast:4 row_mask:0xf bank_mask:0xf
v_and_b32_dpp v111, v12, v7 row_newbcast:4 row_mask:0xf bank_mask:0xf
v_mfma_f32_16x16x32_bf16 v[112:115], v[104:107], v[252:255], v[112:115]
s_xor_b32 s64, s65, 177152
s_waitcnt vmcnt(5)
buffer_load_dwordx4 v[148:151], v1, s[44:47], s64 offen nt
v_and_b32_dpp v104, v21, v4 row_newbcast:0 row_mask:0xf bank_mask:0xf
v_and_b32_dpp v105, v21, v5 row_newbcast:0 row_mask:0xf bank_mask:0xf
v_and_b32_dpp v106, v21, v6 row_newbcast:0 row_mask:0xf bank_mask:0xf
v_and_b32_dpp v107, v21, v7 row_newbcast:0 row_mask:0xf bank_mask:0xf
v_mfma_f32_16x16x32_bf16 v[112:115], v[108:111], v[88:91], v[112:115]
s_xor_b32 s64, s65, 197632
s_waitcnt vmcnt(5)
buffer_load_dwordx4 v[152:155], v1, s[44:47], s64 offen nt
v_and_b32_dpp v108, v21, v4 row_newbcast:4 row_mask:0xf bank_mask:0xf
v_and_b32_dpp v109, v21, v5 row_newbcast:4 row_mask:0xf bank_mask:0xf
v_and_b32_dpp v110, v21, v6 row_newbcast:4 row_mask:0xf bank_mask:0xf
v_and_b32_dpp v111, v21, v7 row_newbcast:4 row_mask:0xf bank_mask:0xf
v_mfma_f32_16x16x32_bf16 v[112:115], v[104:107], v[92:95], v[112:115]
s_xor_b32 s64, s65, 230400
s_waitcnt vmcnt(5)
buffer_load_dwordx4 v[156:159], v1, s[44:47], s64 offen nt
v_and_b32_dpp v104, v12, v4 row_newbcast:8 row_mask:0xf bank_mask:0xf
v_and_b32_dpp v105, v12, v5 row_newbcast:8 row_mask:0xf bank_mask:0xf
v_and_b32_dpp v106, v12, v6 row_newbcast:8 row_mask:0xf bank_mask:0xf
v_and_b32_dpp v107, v12, v7 row_newbcast:8 row_mask:0xf bank_mask:0xf
v_mfma_f32_16x16x32_bf16 v[112:115], v[108:111], v[132:135], v[112:115]
s_cmp_lt_u32 s2, 208
s_cbranch_scc0 L_hp_123
v_lshlrev_b32 v160, 2, v0
buffer_load_dword v161, v160, s[36:39], s62 offen offset:0 sc1
L_hp_123:
s_xor_b32 s64, s65, 201728
s_waitcnt vmcnt(5)
buffer_load_dwordx4 v[180:183], v1, s[44:47], s64 offen nt
v_and_b32_dpp v108, v12, v4 row_newbcast:12 row_mask:0xf bank_mask:0xf
v_and_b32_dpp v109, v12, v5 row_newbcast:12 row_mask:0xf bank_mask:0xf
v_and_b32_dpp v110, v12, v6 row_newbcast:12 row_mask:0xf bank_mask:0xf
v_and_b32_dpp v111, v12, v7 row_newbcast:12 row_mask:0xf bank_mask:0xf
v_mfma_f32_16x16x32_bf16 v[112:115], v[104:107], v[136:139], v[112:115]
s_xor_b32 s64, s65, 234496
s_waitcnt vmcnt(5)
buffer_load_dwordx4 v[184:187], v1, s[44:47], s64 offen nt
v_and_b32_dpp v104, v21, v4 row_newbcast:8 row_mask:0xf bank_mask:0xf
v_and_b32_dpp v105, v21, v5 row_newbcast:8 row_mask:0xf bank_mask:0xf
v_and_b32_dpp v106, v21, v6 row_newbcast:8 row_mask:0xf bank_mask:0xf
v_and_b32_dpp v107, v21, v7 row_newbcast:8 row_mask:0xf bank_mask:0xf
v_mfma_f32_16x16x32_bf16 v[112:115], v[108:111], v[140:143], v[112:115]
s_xor_b32 s64, s65, 205824
s_waitcnt vmcnt(7)
buffer_load_dwordx4 v[188:191], v1, s[44:47], s64 offen nt
s_xor_b32 s64, s65, 238592
s_waitcnt vmcnt(7)
buffer_load_dwordx4 v[24:27], v1, s[44:47], s64 offen nt
s_cmp_eq_u32 s34, 2
s_cbranch_scc0 L_w_124
v_mov_b32 v60, 62
s_mov_b64 exec, 1
buffer_store_dword v60, off, s[36:39], s63 offset:0
s_mov_b64 exec, -1
L_w_124:
s_xor_b32 s64, s65, 209920
s_waitcnt vmcnt(7)
buffer_load_dwordx4 v[28:31], v1, s[44:47], s64 offen nt
v_and_b32_dpp v108, v21, v4 row_newbcast:12 row_mask:0xf bank_mask:0xf
v_and_b32_dpp v109, v21, v5 row_newbcast:12 row_mask:0xf bank_mask:0xf
v_and_b32_dpp v110, v21, v6 row_newbcast:12 row_mask:0xf bank_mask:0xf
v_and_b32_dpp v111, v21, v7 row_newbcast:12 row_mask:0xf bank_mask:0xf
v_mfma_f32_16x16x32_bf16 v[112:115], v[104:107], v[144:147], v[112:115]
s_xor_b32 s64, s65, 242688
s_waitcnt vmcnt(7)
buffer_load_dwordx4 v[32:35], v1, s[44:47], s64 offen nt
v_and_b32_dpp v104, v14, v4 row_newbcast:0 row_mask:0xf bank_mask:0xf
v_and_b32_dpp v105, v14, v5 row_newbcast:0 row_mask:0xf bank_mask:0xf
v_and_b32_dpp v106, v14, v6 row_newbcast:0 row_mask:0xf bank_mask:0xf
v_and_b32_dpp v107, v14, v7 row_newbcast:0 row_mask:0xf bank_mask:0xf
v_mfma_f32_16x16x32_bf16 v[112:115], v[108:111], v[148:151], v[112:115]
s_cmp_lt_u32 s2, 208
s_cbranch_scc0 L_nohelp
v_lshrrev_b32 v176, 3, v0
v_sub_u32 v176, 63, v176
v_and_b32 v172, 7, v0
v_lshlrev_b32 v172, 7, v172
v_bfe_u32 v162, v176, 0, 1
v_lshl_or_b32 v172, v162, 15, v172
v_bfe_u32 v162, v176, 1, 1
v_lshl_or_b32 v172, v162, 12, v172
v_bfe_u32 v162, v176, 2, 1
v_lshl_or_b32 v172, v162, 13, v172
v_bfe_u32 v162, v176, 3, 1
v_lshl_or_b32 v172, v162, 16, v172
v_bfe_u32 v162, v176, 4, 1
v_lshl_or_b32 v172, v162, 10, v172
v_bfe_u32 v162, v176, 5, 1
v_lshl_or_b32 v172, v162, 17, v172
v_lshrrev_b32 v177, 3, v0
v_sub_u32 v177, 55, v177
v_and_b32 v173, 7, v0
v_lshlrev_b32 v173, 7, v173
v_bfe_u32 v162, v177, 0, 1
v_lshl_or_b32 v173, v162, 15, v173
v_bfe_u32 v162, v177, 1, 1
v_lshl_or_b32 v173, v162, 12, v173
v_bfe_u32 v162, v177, 2, 1
v_lshl_or_b32 v173, v162, 13, v173
v_bfe_u32 v162, v177, 3, 1
v_lshl_or_b32 v173, v162, 16, v173
v_bfe_u32 v162, v177, 4, 1
v_lshl_or_b32 v173, v162, 10, v173
v_bfe_u32 v162, v177, 5, 1
v_lshl_or_b32 v173, v162, 17, v173
v_lshrrev_b32 v178, 3, v0
v_sub_u32 v178, 47, v178
v_and_b32 v174, 7, v0
v_lshlrev_b32 v174, 7, v174
v_bfe_u32 v162, v178, 0, 1
v_lshl_or_b32 v174, v162, 15, v174
v_bfe_u32 v162, v178, 1, 1
v_lshl_or_b32 v174, v162, 12, v174
v_bfe_u32 v162, v178, 2, 1
v_lshl_or_b32 v174, v162, 13, v174
v_bfe_u32 v162, v178, 3, 1
v_lshl_or_b32 v174, v162, 16, v174
v_bfe_u32 v162, v178, 4, 1
v_lshl_or_b32 v174, v162, 10, v174
v_bfe_u32 v162, v178, 5, 1
v_lshl_or_b32 v174, v162, 17, v174
v_lshrrev_b32 v179, 3, v0
v_sub_u32 v179, 39, v179
v_and_b32 v175, 7, v0
v_lshlrev_b32 v175, 7, v175
v_bfe_u32 v162, v179, 0, 1
v_lshl_or_b32 v175, v162, 15, v175
v_bfe_u32 v162, v179, 1, 1
v_lshl_or_b32 v175, v162, 12, v175
v_bfe_u32 v162, v179, 2, 1
v_lshl_or_b32 v175, v162, 13, v175
v_bfe_u32 v162, v179, 3, 1
v_lshl_or_b32 v175, v162, 16, v175
v_bfe_u32 v162, v179, 4, 1
v_lshl_or_b32 v175, v162, 10, v175
v_bfe_u32 v162, v179, 5, 1
v_lshl_or_b32 v175, v162, 17, v175
s_lshr_b32 s71, s2, 3
v_subrev_u32 v163, s71, v0
v_and_b32 v163, 31, v163
s_waitcnt vmcnt(6)
v_mov_b32 v162, v161
s_nop 1
v_permlane32_swap_b32 v161, v162
v_add_u32 v161, 1, v161
v_max_u32 v161, 7, v161
v_cmp_eq_u32 vcc, -1, v162
v_mov_b32 v160, 0xff
s_nop 0
v_cndmask_b32 v161, v160, v161, vcc
v_lshl_or_b32 v161, v161, 5, v163
s_nop 1
v_min_u32_dpp v161, v161, v161 quad_perm:[1,0,3,2] row_mask:0xf bank_mask:0xf
s_nop 1
v_min_u32_dpp v161, v161, v161 quad_perm:[2,3,0,1] row_mask:0xf bank_mask:0xf
s_nop 1
v_min_u32_dpp v161, v161, v161 row_ror:4 row_mask:0xf bank_mask:0xf
s_nop 1
v_min_u32_dpp v161, v161, v161 row_ror:8 row_mask:0xf bank_mask:0xf
s_nop 1
v_readlane_b32 s76, v161, 0
v_readlane_b32 s66, v161, 16
s_min_u32 s76, s76, s66
s_lshr_b32 s66, s76, 5
s_cmp_lt_u32 s66, 50
s_cbranch_scc0 L_drain
s_mov_b32 s48, s8
s_mov_b32 s49, s9
s_mov_b32 s50, 0x10000000
s_mov_b32 s51, 0x20000
s_lshr_b32 s64, s2, 3
s_add_u32 s76, s76, s64
s_and_b32 s76, s76, 31
s_lshl_b32 s67, s76, 2
s_add_u32 s67, s67, s62
s_lshl_b32 s76, s76, 3
s_and_b32 s64, s2, 7
s_or_b32 s76, s76, s64
s_and_b32 s64, s34, 1
s_lshl_b32 s64, s64, 14
s_lshr_b32 s71, s34, 1
s_lshl_b32 s71, s71, 11
s_or_b32 s64, s64, s71
s_lshl_b32 s71, s76, 10
s_xor_b32 s64, s64, s71
s_or_b32 s64, s64, 0xC0000
s_lshl_b32 s76, s76, 20
s_xor_b32 s76, s76, s64
s_add_u32 s66, s66, 11
v_xor_b32 v175, s76, v175
v_cmp_lt_u32 vcc, s66, v179
s_or_b64 exec, vcc, 1
buffer_load_dword v160, v175, s[48:51], 0 offen
s_mov_b64 exec, -1
v_xor_b32 v174, s76, v174
v_cmp_lt_u32 vcc, s66, v178
s_or_b64 exec, vcc, 1
buffer_load_dword v160, v174, s[48:51], 0 offen
s_mov_b64 exec, -1
v_xor_b32 v173, s76, v173
v_cmp_lt_u32 vcc, s66, v177
s_or_b64 exec, vcc, 1
buffer_load_dword v160, v173, s[48:51], 0 offen
s_mov_b64 exec, -1
v_xor_b32 v172, s76, v172
v_cmp_lt_u32 vcc, s66, v176
s_or_b64 exec, vcc, 1
buffer_load_dword v160, v172, s[48:51], 0 offen
s_mov_b64 exec, -1
s_mov_b64 exec, 1
buffer_store_dword v1, off, s[36:39], s67 offset:128
s_mov_b64 exec, -1
s_waitcnt vmcnt(12)
v_and_b32_dpp v108, v14, v4 row_newbcast:4 row_mask:0xf bank_mask:0xf
v_and_b32_dpp v109, v14, v5 row_newbcast:4 row_mask:0xf bank_mask:0xf
v_and_b32_dpp v110, v14, v6 row_newbcast:4 row_mask:0xf bank_mask:0xf
v_and_b32_dpp v111, v14, v7 row_newbcast:4 row_mask:0xf bank_mask:0xf
v_mfma_f32_16x16x32_bf16 v[112:115], v[104:107], v[152:155], v[112:115]
s_waitcnt vmcnt(11)
v_and_b32_dpp v104, v23, v4 row_newbcast:0 row_mask:0xf bank_mask:0xf
v_and_b32_dpp v105, v23, v5 row_newbcast:0 row_mask:0xf bank_mask:0xf
v_and_b32_dpp v106, v23, v6 row_newbcast:0 row_mask:0xf bank_mask:0xf
v_and_b32_dpp v107, v23, v7 row_newbcast:0 row_mask:0xf bank_mask:0xf
v_mfma_f32_16x16x32_bf16 v[112:115], v[108:111], v[156:159], v[112:115]
s_waitcnt vmcnt(10)
v_and_b32_dpp v108, v23, v4 row_newbcast:4 row_mask:0xf bank_mask:0xf
v_and_b32_dpp v109, v23, v5 row_newbcast:4 row_mask:0xf bank_mask:0xf
v_and_b32_dpp v110, v23, v6 row_newbcast:4 row_mask:0xf bank_mask:0xf
v_and_b32_dpp v111, v23, v7 row_newbcast:4 row_mask:0xf bank_mask:0xf
v_mfma_f32_16x16x32_bf16 v[112:115], v[104:107], v[180:183], v[112:115]
s_waitcnt vmcnt(9)
v_and_b32_dpp v104, v14, v4 row_newbcast:8 row_mask:0xf bank_mask:0xf
v_and_b32_dpp v105, v14, v5 row_newbcast:8 row_mask:0xf bank_mask:0xf
v_and_b32_dpp v106, v14, v6 row_newbcast:8 row_mask:0xf bank_mask:0xf
v_and_b32_dpp v107, v14, v7 row_newbcast:8 row_mask:0xf bank_mask:0xf
v_mfma_f32_16x16x32_bf16 v[112:115], v[108:111], v[184:187], v[112:115]
s_waitcnt vmcnt(8)
v_and_b32_dpp v108, v14, v4 row_newbcast:12 row_mask:0xf bank_mask:0xf
v_and_b32_dpp v109, v14, v5 row_newbcast:12 row_mask:0xf bank_mask:0xf
v_and_b32_dpp v110, v14, v6 row_newbcast:12 row_mask:0xf bank_mask:0xf
v_and_b32_dpp v111, v14, v7 row_newbcast:12 row_mask:0xf bank_mask:0xf
v_mfma_f32_16x16x32_bf16 v[112:115], v[104:107], v[188:191], v[112:115]
s_waitcnt vmcnt(7)
v_and_b32_dpp v104, v23, v4 row_newbcast:8 row_mask:0xf bank_mask:0xf
v_and_b32_dpp v105, v23, v5 row_newbcast:8 row_mask:0xf bank_mask:0xf
v_and_b32_dpp v106, v23, v6 row_newbcast:8 row_mask:0xf bank_mask:0xf
v_and_b32_dpp v107, v23, v7 row_newbcast:8 row_mask:0xf bank_mask:0xf
v_mfma_f32_16x16x32_bf16 v[112:115], v[108:111], v[24:27], v[112:115]
s_waitcnt vmcnt(6)
v_and_b32_dpp v108, v23, v4 row_newbcast:12 row_mask:0xf bank_mask:0xf
v_and_b32_dpp v109, v23, v5 row_newbcast:12 row_mask:0xf bank_mask:0xf
v_and_b32_dpp v110, v23, v6 row_newbcast:12 row_mask:0xf bank_mask:0xf
v_and_b32_dpp v111, v23, v7 row_newbcast:12 row_mask:0xf bank_mask:0xf
v_mfma_f32_16x16x32_bf16 v[112:115], v[104:107], v[28:31], v[112:115]
s_waitcnt vmcnt(5)
v_mfma_f32_16x16x32_bf16 v[112:115], v[108:111], v[32:35], v[112:115]
s_branch L_drained
L_nohelp:
L_drain:
s_waitcnt vmcnt(7)
v_and_b32_dpp v108, v14, v4 row_newbcast:4 row_mask:0xf bank_mask:0xf
v_and_b32_dpp v109, v14, v5 row_newbcast:4 row_mask:0xf bank_mask:0xf
v_and_b32_dpp v110, v14, v6 row_newbcast:4 row_mask:0xf bank_mask:0xf
v_and_b32_dpp v111, v14, v7 row_newbcast:4 row_mask:0xf bank_mask:0xf
v_mfma_f32_16x16x32_bf16 v[112:115], v[104:107], v[152:155], v[112:115]
s_waitcnt vmcnt(6)
v_and_b32_dpp v104, v23, v4 row_newbcast:0 row_mask:0xf bank_mask:0xf
v_and_b32_dpp v105, v23, v5 row_newbcast:0 row_mask:0xf bank_mask:0xf
v_and_b32_dpp v106, v23, v6 row_newbcast:0 row_mask:0xf bank_mask:0xf
v_and_b32_dpp v107, v23, v7 row_newbcast:0 row_mask:0xf bank_mask:0xf
v_mfma_f32_16x16x32_bf16 v[112:115], v[108:111], v[156:159], v[112:115]
s_waitcnt vmcnt(5)
v_and_b32_dpp v108, v23, v4 row_newbcast:4 row_mask:0xf bank_mask:0xf
v_and_b32_dpp v109, v23, v5 row_newbcast:4 row_mask:0xf bank_mask:0xf
v_and_b32_dpp v110, v23, v6 row_newbcast:4 row_mask:0xf bank_mask:0xf
v_and_b32_dpp v111, v23, v7 row_newbcast:4 row_mask:0xf bank_mask:0xf
v_mfma_f32_16x16x32_bf16 v[112:115], v[104:107], v[180:183], v[112:115]
s_waitcnt vmcnt(4)
v_and_b32_dpp v104, v14, v4 row_newbcast:8 row_mask:0xf bank_mask:0xf
v_and_b32_dpp v105, v14, v5 row_newbcast:8 row_mask:0xf bank_mask:0xf
v_and_b32_dpp v106, v14, v6 row_newbcast:8 row_mask:0xf bank_mask:0xf
v_and_b32_dpp v107, v14, v7 row_newbcast:8 row_mask:0xf bank_mask:0xf
v_mfma_f32_16x16x32_bf16 v[112:115], v[108:111], v[184:187], v[112:115]
s_waitcnt vmcnt(3)
v_and_b32_dpp v108, v14, v4 row_newbcast:12 row_mask:0xf bank_mask:0xf
v_and_b32_dpp v109, v14, v5 row_newbcast:12 row_mask:0xf bank_mask:0xf
v_and_b32_dpp v110, v14, v6 row_newbcast:12 row_mask:0xf bank_mask:0xf
v_and_b32_dpp v111, v14, v7 row_newbcast:12 row_mask:0xf bank_mask:0xf
v_mfma_f32_16x16x32_bf16 v[112:115], v[104:107], v[188:191], v[112:115]
s_waitcnt vmcnt(2)
v_and_b32_dpp v104, v23, v4 row_newbcast:8 row_mask:0xf bank_mask:0xf
v_and_b32_dpp v105, v23, v5 row_newbcast:8 row_mask:0xf bank_mask:0xf
v_and_b32_dpp v106, v23, v6 row_newbcast:8 row_mask:0xf bank_mask:0xf
v_and_b32_dpp v107, v23, v7 row_newbcast:8 row_mask:0xf bank_mask:0xf
v_mfma_f32_16x16x32_bf16 v[112:115], v[108:111], v[24:27], v[112:115]
s_waitcnt vmcnt(1)
v_and_b32_dpp v108, v23, v4 row_newbcast:12 row_mask:0xf bank_mask:0xf
v_and_b32_dpp v109, v23, v5 row_newbcast:12 row_mask:0xf bank_mask:0xf
v_and_b32_dpp v110, v23, v6 row_newbcast:12 row_mask:0xf bank_mask:0xf
v_and_b32_dpp v111, v23, v7 row_newbcast:12 row_mask:0xf bank_mask:0xf
v_mfma_f32_16x16x32_bf16 v[112:115], v[104:107], v[28:31], v[112:115]
s_waitcnt vmcnt(0)
v_mfma_f32_16x16x32_bf16 v[112:115], v[108:111], v[32:35], v[112:115]
L_drained:
v_and_b32 v2, 15, v0
v_lshlrev_b32 v2, 5, v2
v_and_b32 v3, 16, v0
v_add_u32 v2, v2, v3
s_lshl_b32 s68, s34, 9
v_add_u32 v2, s68, v2
s_mov_b32 exec_hi, 0
s_nop 1
ds_write_b128 v2, v[112:115] offset:512
s_mov_b32 exec_hi, -1
v_lshlrev_b32 v1, 4, v0
s_waitcnt lgkmcnt(0)
s_barrier
v_mov_b32 v2, 0
ds_read_b32 v3, v2 offset:328
s_waitcnt lgkmcnt(0)
v_readfirstlane_b32 s35, v3
s_branch L_tail_s
L_fin:
L_end:
s_endpgm
L_code_end:
.section .rodata,"a"
.p2align 6
.amdhsa_kernel adaLN_cond__sliding_block_cached__glu_gated_glu__decode_kernel
  .amdhsa_next_free_vgpr 256
  .amdhsa_next_free_sgpr 102
  .amdhsa_accum_offset 256
  .amdhsa_group_segment_fixed_size 0
  .amdhsa_kernarg_size 112
  .amdhsa_user_sgpr_count 2
  .amdhsa_user_sgpr_kernarg_segment_ptr 1
  .amdhsa_system_sgpr_workgroup_id_x 1
  .amdhsa_float_denorm_mode_32 3
.end_amdhsa_kernel
```

```asm
; @launch grid=(256,1,1) block=(512,1,1) lds=131072
.amdgcn_target "amdgcn-amd-amdhsa--gfx950"
.text
.globl adaLN_cond__sliding_block_cached__glu_gated_glu__decode_kernel
.p2align 8
.type adaLN_cond__sliding_block_cached__glu_gated_glu__decode_kernel,@function
adaLN_cond__sliding_block_cached__glu_gated_glu__decode_kernel:
L_code_begin:
s_load_dwordx16 s[4:19], s[0:1], 0
s_load_dwordx8 s[20:27], s[0:1], 64
s_load_dwordx4 s[28:31], s[0:1], 96
s_cmpk_ge_u32 s2, 256
s_cbranch_scc1 L_end
v_lshrrev_b32 v1, 6, v0
v_and_b32 v0, 63, v0
v_readfirstlane_b32 s3, v1
v_lshlrev_b32 v1, 4, v0
s_lshl_b32 s64, s2, 20
s_add_u32 s64, s64, 0xC0000
s_mov_b32 s42, 0x40000
s_mov_b32 s43, 0x20000
s_and_b32 s34, s3, 3
s_cmp_ge_u32 s3, 4
s_cbranch_scc1 L_helper
s_and_b32 s65, s34, 1
s_lshl_b32 s65, s65, 14
s_lshr_b32 s66, s34, 1
s_lshl_b32 s66, s66, 11
s_or_b32 s65, s65, s66
s_lshl_b32 s66, s2, 10
s_xor_b32 s65, s65, s66
s_waitcnt lgkmcnt(0)
s_add_u32 s40, s6, s64
s_addc_u32 s41, s7, 0
s_add_u32 s44, s8, s64
s_addc_u32 s45, s9, 0
buffer_load_dwordx4 v[8:11], v1, s[40:43], s65 offen nt
s_xor_b32 s64, s65, 32768
buffer_load_dwordx4 v[12:15], v1, s[40:43], s64 offen nt
s_xor_b32 s64, s65, 8192
buffer_load_dwordx4 v[16:19], v1, s[40:43], s64 offen nt
s_xor_b32 s64, s65, 40960
buffer_load_dwordx4 v[20:23], v1, s[40:43], s64 offen nt
s_barrier
s_branch L_srest
L_helper:
s_setprio 2
v_lshlrev_b32 v2, 2, v0
s_cmp_eq_u32 s3, 7
s_cbranch_scc0 L_nopf
s_getpc_b64 s[60:61]
L_pc:
s_lshr_b32 s66, s2, 3
s_lshl_b32 s66, s66, 10
v_add_u32 v10, s66, v1
v_min_u32 v10, L_code_end-L_pc-16, v10
global_load_dwordx4 v[12:15], v10, s[60:61]
v_subrev_u32 v3, 16, v0
v_ashrrev_i32 v3, 31, v3
ds_write_b32 v2, v3 offset:256
L_nopf:
s_and_b32 s67, s2, 7
s_lshr_b32 s68, s2, 3
v_and_b32 v38, 7, v0
v_lshrrev_b32 v37, 3, v0
s_cmp_eq_u32 s34, 0
s_cbranch_scc0 L_p0a
s_mov_b32 s70, 6
s_lshl_b32 s67, s67, 1
s_add_u32 s66, s67, 14
v_min_u32 v38, 5, v38
v_cmp_lt_u32 vcc, 1, v38
v_add_u32 v36, s66, v38
s_nop 0
v_cndmask_b32 v38, v38, v36, vcc
s_branch L_p0b
L_p0a:
s_lshl_b32 s67, s67, 3
s_lshl_b32 s65, s2, 3
s_and_b32 s65, s65, 0xff
s_lshr_b32 s66, s2, 5
s_or_b32 s65, s65, s66
s_cmp_eq_u32 s34, 2
s_cselect_b32 s70, 1, 8
s_cselect_b32 s68, s65, s68
s_cselect_b32 s67, 0, s67
L_p0b:
v_lshl_add_u32 v37, s68, 4, v37
v_mul_u32_u24 v37, s70, v37
v_lshl_add_u32 v38, v37, 3, v38
v_add_lshl_u32 v38, v38, s67, 7
s_lshl_b32 s70, s70, 13
v_add_u32 v39, s70, v38
s_sub_u32 s64, s2, 112
s_cmp_lt_u32 s64, 32
s_waitcnt lgkmcnt(0)
s_barrier
s_cbranch_scc1 L_jan
s_cmp_eq_u32 s34, 3
s_cbranch_scc1 L_p0_125
s_cmp_eq_u32 s34, 0
s_cselect_b32 s62, s24, s10
s_cselect_b32 s63, s25, s11
s_cmp_eq_u32 s34, 2
s_cselect_b32 s62, s12, s62
s_cselect_b32 s63, s13, s63
global_load_dword v12, v38, s[62:63]
global_load_dword v13, v39, s[62:63]
L_p0_125:
L_nop0:
s_mov_b32 s77, 0
s_cmp_eq_u32 s34, 3
s_cselect_b32 s64, 16, 0
s_cmp_lt_u32 s2, s64
s_cbranch_scc0 L_nopc
v_mov_b32 v4, -1
v_mov_b32 v5, -1
v_mov_b32 v6, -1
v_mov_b32 v7, -1
s_and_b32 s66, s2, 7
s_lshl_b32 s66, s66, 11
s_and_b32 s65, s2, 8
s_lshl_b32 s65, s65, 7
s_add_u32 s66, s66, s65
v_add_u32 v8, s66, v1
global_store_dwordx4 v8, v[4:7], s[30:31] sc1
s_mov_b32 s77, 1
L_nopc:
s_cmp_eq_u32 s34, 3
s_cbranch_scc0 L_w_126
s_and_b32 s67, s2, 7
s_lshr_b32 s68, s2, 3
s_lshl_b32 s64, 1, s67
s_sub_u32 s64, s64, 1
s_and_b32 s64, s64, 42
s_bcnt1_i32_b32 s64, s64
s_mul_i32 s65, s67, 5
s_add_u32 s64, s64, s65
s_bitcmp1_b32 42, s67
s_cselect_b32 s65, 6, 5
L_w_126:
s_lshr_b32 s32, s2, 5
s_and_b32 s33, s2, 31
s_and_b32 s67, s2, 7
s_lshr_b32 s68, s2, 3
s_sub_u32 s68, s68, 26
s_lshl_b32 s74, 1, s67
s_sub_u32 s74, s74, 1
s_and_b32 s74, s74, 42
s_bcnt1_i32_b32 s74, s74
s_mul_i32 s66, s67, 5
s_add_u32 s74, s74, s66
s_add_u32 s74, s74, s68
s_bitcmp1_b32 42, s67
s_cselect_b32 s66, 6, 5
s_cmp_lt_u32 s68, s66
s_cselect_b32 s74, s74, -1
s_cmp_lt_u32 s2, 48
s_cselect_b32 s66, 2, 3
s_cselect_b32 s72, 14+26, 42+26
s_cmp_lt_u32 s2, 16
s_cselect_b32 s66, 1, s66
s_cselect_b32 s72, 26, s72
s_lshl_b32 s66, s67, s66
s_add_u32 s72, s72, s66
s_add_u32 s72, s72, s68
s_mov_b32 s36, s30
s_mov_b32 s37, s31
s_mov_b32 s38, 0x1d0000
s_mov_b32 s39, 0x20000
s_mov_b32 s52, s28
s_mov_b32 s53, s29
s_mov_b32 s54, 0x100
s_mov_b32 s55, 0x20000
v_mov_b32 v9, 1
s_cmp_lt_u32 s2, 112
s_cbranch_scc0 L_norole
L_gemm:
v_and_b32 v16, 7, v0
v_lshlrev_b32 v16, 10, v16
v_and_b32 v17, 8, v0
v_lshl_add_u32 v16, v17, 3, v16
v_and_b32 v17, 48, v0
v_add_u32 v16, v16, v17
s_lshl_b32 s67, s34, 8
v_lshrrev_b32 v19, 3, v0
v_and_b32 v17, 2, v19
v_and_b32 v18, 7, v0
v_xor_b32 v17, v17, v18
v_xor_b32 v18, 4, v17
v_lshlrev_b32 v17, 4, v17
v_lshlrev_b32 v18, 4, v18
s_cmp_lt_u32 s2, 48
s_cbranch_scc0 L_gq0
s_mov_b32 s40, s24
s_mov_b32 s41, s25
s_mov_b32 s42, 0x300000
s_mov_b32 s43, 0x20000
s_mov_b32 s48, s22
s_mov_b32 s49, s23
s_mov_b32 s50, 0x2000
s_mov_b32 s51, 0x20000
s_mov_b32 s70, 6144
s_lshl_b32 s64, s72, 7
s_branch L_g1
L_gq0:
s_mov_b32 s40, s10
s_mov_b32 s41, s11
s_mov_b32 s42, 0x400000
s_mov_b32 s43, 0x20000
s_mov_b32 s48, s4
s_mov_b32 s49, s5
s_mov_b32 s50, 0x2000
s_mov_b32 s51, 0x20000
s_mov_b32 s70, 8192
s_sub_u32 s64, s72, 48
s_lshl_b32 s64, s64, 7
L_g1:
buffer_load_dwordx4 v[192:195], v16, s[48:51], s67 offen offset:0
buffer_load_dwordx4 v[196:199], v16, s[48:51], s67 offen offset:128
v_mul_lo_u32 v19, s70, v19
v_add_u32 v17, v17, v19
v_add_u32 v18, v18, v19
s_lshl_b32 s66, s70, 7
s_mul_i32 s66, s66, s34
s_add_u32 s64, s64, s66
s_lshl_b32 s70, s70, 3
s_lshl_b32 s65, s34, 13
s_add_u32 s65, s65, 4096
s_cmp_lt_u32 s2, 16
s_cselect_b32 s71, 0, 2
s_cmp_ge_u32 s2, 48
s_cselect_b32 s71, 1, s71
s_add_u32 m0, s65, 0
s_nop 0
buffer_load_dwordx4 v17, s[40:43], s64 offen  lds
s_add_u32 s64, s64, s70
s_add_u32 m0, s65, 1024
s_nop 0
buffer_load_dwordx4 v18, s[40:43], s64 offen  lds
s_add_u32 s64, s64, s70
s_cmp_eq_u32 s71, 2
s_cbranch_scc0 L_pace_127
s_waitcnt vmcnt(1)
L_pace_127:
s_add_u32 m0, s65, 2048
s_nop 0
buffer_load_dwordx4 v17, s[40:43], s64 offen  lds
s_add_u32 s64, s64, s70
s_cmp_eq_u32 s71, 0
s_cbranch_scc1 L_pace_128
s_waitcnt vmcnt(2)
s_cmp_eq_u32 s71, 2
s_cbranch_scc0 L_pace_128
s_waitcnt vmcnt(1)
L_pace_128:
s_add_u32 m0, s65, 3072
s_nop 0
buffer_load_dwordx4 v18, s[40:43], s64 offen  lds
s_add_u32 s64, s64, s70
s_cmp_eq_u32 s71, 0
s_cbranch_scc1 L_pace_129
s_waitcnt vmcnt(2)
s_cmp_eq_u32 s71, 2
s_cbranch_scc0 L_pace_129
s_waitcnt vmcnt(1)
L_pace_129:
s_add_u32 m0, s65, 4096
s_nop 0
buffer_load_dwordx4 v17, s[40:43], s64 offen  lds
s_add_u32 s64, s64, s70
s_cmp_eq_u32 s71, 0
s_cbranch_scc1 L_pace_130
s_waitcnt vmcnt(2)
s_cmp_eq_u32 s71, 2
s_cbranch_scc0 L_pace_130
s_waitcnt vmcnt(1)
L_pace_130:
s_add_u32 m0, s65, 5120
s_nop 0
buffer_load_dwordx4 v18, s[40:43], s64 offen  lds
s_add_u32 s64, s64, s70
s_cmp_eq_u32 s71, 0
s_cbranch_scc1 L_pace_131
s_waitcnt vmcnt(2)
s_cmp_eq_u32 s71, 2
s_cbranch_scc0 L_pace_131
s_waitcnt vmcnt(1)
L_pace_131:
s_add_u32 m0, s65, 6144
s_nop 0
buffer_load_dwordx4 v17, s[40:43], s64 offen  lds
s_add_u32 s64, s64, s70
s_cmp_eq_u32 s71, 0
s_cbranch_scc1 L_pace_132
s_waitcnt vmcnt(2)
s_cmp_eq_u32 s71, 2
s_cbranch_scc0 L_pace_132
s_waitcnt vmcnt(1)
L_pace_132:
s_add_u32 m0, s65, 7168
s_nop 0
buffer_load_dwordx4 v18, s[40:43], s64 offen  lds
s_add_u32 s64, s64, s70
s_cmp_eq_u32 s71, 0
s_cbranch_scc1 L_pace_133
s_waitcnt vmcnt(2)
s_cmp_eq_u32 s71, 2
s_cbranch_scc0 L_pace_133
s_waitcnt vmcnt(1)
L_pace_133:
s_add_u32 m0, s65, 32768
s_nop 0
buffer_load_dwordx4 v17, s[40:43], s64 offen  lds
s_add_u32 s64, s64, s70
s_cmp_eq_u32 s71, 0
s_cbranch_scc1 L_pace_134
s_waitcnt vmcnt(2)
s_cmp_eq_u32 s71, 2
s_cbranch_scc0 L_pace_134
s_waitcnt vmcnt(1)
L_pace_134:
s_add_u32 m0, s65, 33792
s_nop 0
buffer_load_dwordx4 v18, s[40:43], s64 offen  lds
s_add_u32 s64, s64, s70
s_cmp_eq_u32 s71, 0
s_cbranch_scc1 L_pace_135
s_waitcnt vmcnt(2)
s_cmp_eq_u32 s71, 2
s_cbranch_scc0 L_pace_135
s_waitcnt vmcnt(1)
L_pace_135:
s_add_u32 m0, s65, 34816
s_nop 0
buffer_load_dwordx4 v17, s[40:43], s64 offen  lds
s_add_u32 s64, s64, s70
s_cmp_eq_u32 s71, 0
s_cbranch_scc1 L_pace_136
s_waitcnt vmcnt(2)
s_cmp_eq_u32 s71, 2
s_cbranch_scc0 L_pace_136
s_waitcnt vmcnt(1)
L_pace_136:
s_add_u32 m0, s65, 35840
s_nop 0
buffer_load_dwordx4 v18, s[40:43], s64 offen  lds
s_add_u32 s64, s64, s70
s_cmp_eq_u32 s71, 0
s_cbranch_scc1 L_pace_137
s_waitcnt vmcnt(2)
s_cmp_eq_u32 s71, 2
s_cbranch_scc0 L_pace_137
s_waitcnt vmcnt(1)
L_pace_137:
s_add_u32 m0, s65, 36864
s_nop 0
buffer_load_dwordx4 v17, s[40:43], s64 offen  lds
s_add_u32 s64, s64, s70
s_cmp_eq_u32 s71, 0
s_cbranch_scc1 L_pace_138
s_waitcnt vmcnt(2)
s_cmp_eq_u32 s71, 2
s_cbranch_scc0 L_pace_138
s_waitcnt vmcnt(1)
L_pace_138:
s_add_u32 m0, s65, 37888
s_nop 0
buffer_load_dwordx4 v18, s[40:43], s64 offen  lds
s_add_u32 s64, s64, s70
s_cmp_eq_u32 s71, 0
s_cbranch_scc1 L_pace_139
s_waitcnt vmcnt(2)
s_cmp_eq_u32 s71, 2
s_cbranch_scc0 L_pace_139
s_waitcnt vmcnt(1)
L_pace_139:
s_add_u32 m0, s65, 38912
s_nop 0
buffer_load_dwordx4 v17, s[40:43], s64 offen  lds
s_add_u32 s64, s64, s70
s_cmp_eq_u32 s71, 0
s_cbranch_scc1 L_pace_140
s_waitcnt vmcnt(2)
s_cmp_eq_u32 s71, 2
s_cbranch_scc0 L_pace_140
s_waitcnt vmcnt(1)
L_pace_140:
s_add_u32 m0, s65, 39936
s_nop 0
buffer_load_dwordx4 v18, s[40:43], s64 offen  lds
s_add_u32 s64, s64, s70
s_waitcnt vmcnt(16)
s_cmp_eq_u32 s77, 0
s_cbranch_scc1 L_pc_141
s_lshl_b32 s66, s2, 2
v_mov_b32 v20, s66
v_mov_b32 v21, -1
s_mov_b64 exec, 1
global_store_dword v20, v21, s[28:29] sc1
s_mov_b64 exec, -1
L_pc_141:
s_cmp_eq_u32 s34, 0
s_cselect_b32 s73, 48, 0x1000
v_and_b32 v30, 15, v0
v_lshlrev_b32 v30, 2, v30
s_cmp_ge_u32 s2, s73
s_cbranch_scc0 L_fl_142
buffer_load_dword v31, v30, s[52:55], 0 offen sc1
L_fl_142:
s_mov_b32 s68, 0xffff0000
s_cmp_lt_u32 s2, 48
s_cbranch_scc0 L_gq1
s_mov_b32 s66, 0xbfb8aa3b
v_lshlrev_b32 v20, 16, v192
v_and_b32 v21, s68, v192
v_mul_f32 v22, s66, v20
v_mul_f32 v23, s66, v21
v_exp_f32 v22, v22
v_exp_f32 v23, v23
s_nop 0
v_add_f32 v22, 1.0, v22
v_add_f32 v23, 1.0, v23
v_rcp_f32 v22, v22
v_rcp_f32 v23, v23
s_nop 0
v_mul_f32 v20, v20, v22
v_mul_f32 v21, v21, v23
v_cvt_pk_bf16_f32 v48, v20, v21
v_lshlrev_b32 v20, 16, v193
v_and_b32 v21, s68, v193
v_mul_f32 v22, s66, v20
v_mul_f32 v23, s66, v21
v_exp_f32 v22, v22
v_exp_f32 v23, v23
s_nop 0
v_add_f32 v22, 1.0, v22
v_add_f32 v23, 1.0, v23
v_rcp_f32 v22, v22
v_rcp_f32 v23, v23
s_nop 0
v_mul_f32 v20, v20, v22
v_mul_f32 v21, v21, v23
v_cvt_pk_bf16_f32 v49, v20, v21
v_lshlrev_b32 v20, 16, v194
v_and_b32 v21, s68, v194
v_mul_f32 v22, s66, v20
v_mul_f32 v23, s66, v21
v_exp_f32 v22, v22
v_exp_f32 v23, v23
s_nop 0
v_add_f32 v22, 1.0, v22
v_add_f32 v23, 1.0, v23
v_rcp_f32 v22, v22
v_rcp_f32 v23, v23
s_nop 0
v_mul_f32 v20, v20, v22
v_mul_f32 v21, v21, v23
v_cvt_pk_bf16_f32 v50, v20, v21
v_lshlrev_b32 v20, 16, v195
v_and_b32 v21, s68, v195
v_mul_f32 v22, s66, v20
v_mul_f32 v23, s66, v21
v_exp_f32 v22, v22
v_exp_f32 v23, v23
s_nop 0
v_add_f32 v22, 1.0, v22
v_add_f32 v23, 1.0, v23
v_rcp_f32 v22, v22
v_rcp_f32 v23, v23
s_nop 0
v_mul_f32 v20, v20, v22
v_mul_f32 v21, v21, v23
v_cvt_pk_bf16_f32 v51, v20, v21
v_lshlrev_b32 v20, 16, v196
v_and_b32 v21, s68, v196
v_mul_f32 v22, s66, v20
v_mul_f32 v23, s66, v21
v_exp_f32 v22, v22
v_exp_f32 v23, v23
s_nop 0
v_add_f32 v22, 1.0, v22
v_add_f32 v23, 1.0, v23
v_rcp_f32 v22, v22
v_rcp_f32 v23, v23
s_nop 0
v_mul_f32 v20, v20, v22
v_mul_f32 v21, v21, v23
v_cvt_pk_bf16_f32 v52, v20, v21
v_lshlrev_b32 v20, 16, v197
v_and_b32 v21, s68, v197
v_mul_f32 v22, s66, v20
v_mul_f32 v23, s66, v21
v_exp_f32 v22, v22
v_exp_f32 v23, v23
s_nop 0
v_add_f32 v22, 1.0, v22
v_add_f32 v23, 1.0, v23
v_rcp_f32 v22, v22
v_rcp_f32 v23, v23
s_nop 0
v_mul_f32 v20, v20, v22
v_mul_f32 v21, v21, v23
v_cvt_pk_bf16_f32 v53, v20, v21
v_lshlrev_b32 v20, 16, v198
v_and_b32 v21, s68, v198
v_mul_f32 v22, s66, v20
v_mul_f32 v23, s66, v21
v_exp_f32 v22, v22
v_exp_f32 v23, v23
s_nop 0
v_add_f32 v22, 1.0, v22
v_add_f32 v23, 1.0, v23
v_rcp_f32 v22, v22
v_rcp_f32 v23, v23
s_nop 0
v_mul_f32 v20, v20, v22
v_mul_f32 v21, v21, v23
v_cvt_pk_bf16_f32 v54, v20, v21
v_lshlrev_b32 v20, 16, v199
v_and_b32 v21, s68, v199
v_mul_f32 v22, s66, v20
v_mul_f32 v23, s66, v21
v_exp_f32 v22, v22
v_exp_f32 v23, v23
s_nop 0
v_add_f32 v22, 1.0, v22
v_add_f32 v23, 1.0, v23
v_rcp_f32 v22, v22
v_rcp_f32 v23, v23
s_nop 0
v_mul_f32 v20, v20, v22
v_mul_f32 v21, v21, v23
v_cvt_pk_bf16_f32 v55, v20, v21
s_branch L_g2
L_gq1:
v_and_b32 v32, 7, v0
v_lshlrev_b32 v32, 2, v32
v_lshlrev_b32 v96, 16, v192
v_and_b32 v97, s68, v192
v_lshlrev_b32 v98, 16, v193
v_and_b32 v99, s68, v193
v_lshlrev_b32 v100, 16, v194
v_and_b32 v101, s68, v194
v_lshlrev_b32 v102, 16, v195
v_and_b32 v103, s68, v195
v_lshlrev_b32 v104, 16, v196
v_and_b32 v105, s68, v196
v_lshlrev_b32 v106, 16, v197
v_and_b32 v107, s68, v197
v_lshlrev_b32 v108, 16, v198
v_and_b32 v109, s68, v198
v_lshlrev_b32 v110, 16, v199
v_and_b32 v111, s68, v199
v_add_f32 v20, v96, v97
v_add_f32 v20, v20, v98
v_add_f32 v20, v20, v99
v_add_f32 v20, v20, v100
v_add_f32 v20, v20, v101
v_add_f32 v20, v20, v102
v_add_f32 v20, v20, v103
v_add_f32 v20, v20, v104
v_add_f32 v20, v20, v105
v_add_f32 v20, v20, v106
v_add_f32 v20, v20, v107
v_add_f32 v20, v20, v108
v_add_f32 v20, v20, v109
v_add_f32 v20, v20, v110
v_add_f32 v20, v20, v111
s_nop 1
v_add_f32_dpp v20, v20, v20 row_ror:8 row_mask:0xf bank_mask:0xf
v_mov_b32 v22, v20
s_nop 1
v_permlane16_swap_b32 v20, v22
s_nop 1
v_add_f32 v20, v20, v22
v_mov_b32 v22, v20
s_nop 1
v_permlane32_swap_b32 v20, v22
s_nop 1
v_add_f32 v20, v20, v22
v_mul_f32 v20, 0x3c000000, v20
v_mov_b32 v21, 0
v_sub_f32 v22, v96, v20
v_fmac_f32 v21, v22, v22
v_sub_f32 v22, v97, v20
v_fmac_f32 v21, v22, v22
v_sub_f32 v22, v98, v20
v_fmac_f32 v21, v22, v22
v_sub_f32 v22, v99, v20
v_fmac_f32 v21, v22, v22
v_sub_f32 v22, v100, v20
v_fmac_f32 v21, v22, v22
v_sub_f32 v22, v101, v20
v_fmac_f32 v21, v22, v22
v_sub_f32 v22, v102, v20
v_fmac_f32 v21, v22, v22
v_sub_f32 v22, v103, v20
v_fmac_f32 v21, v22, v22
v_sub_f32 v22, v104, v20
v_fmac_f32 v21, v22, v22
v_sub_f32 v22, v105, v20
v_fmac_f32 v21, v22, v22
v_sub_f32 v22, v106, v20
v_fmac_f32 v21, v22, v22
v_sub_f32 v22, v107, v20
v_fmac_f32 v21, v22, v22
v_sub_f32 v22, v108, v20
v_fmac_f32 v21, v22, v22
v_sub_f32 v22, v109, v20
v_fmac_f32 v21, v22, v22
v_sub_f32 v22, v110, v20
v_fmac_f32 v21, v22, v22
v_sub_f32 v22, v111, v20
v_fmac_f32 v21, v22, v22
s_nop 1
v_add_f32_dpp v21, v21, v21 row_ror:8 row_mask:0xf bank_mask:0xf
v_mov_b32 v22, v21
s_nop 1
v_permlane16_swap_b32 v21, v22
s_nop 1
v_add_f32 v21, v21, v22
v_mov_b32 v22, v21
s_nop 1
v_permlane32_swap_b32 v21, v22
s_nop 1
v_add_f32 v21, v21, v22
v_lshlrev_b32 v22, 1, v32
s_lshl_b32 s66, s34, 6
v_add_u32 v23, s66, v22
ds_write_b64 v23, v[20:21] offset:0
v_mov_b32 v23, 0
s_waitcnt lgkmcnt(0)
s_mov_b64 exec, 1
ds_add_u32 v23, v9 offset:332
s_mov_b64 exec, -1
s_mov_b32 s75, 0
L_poll_143:
ds_read_b32 v24, v23 offset:332
s_waitcnt lgkmcnt(0)
v_cmp_gt_u32 vcc, 4, v24
s_cbranch_vccz L_pollx_144
s_add_u32 s75, s75, 1
s_cmp_lt_u32 s75, 0x1000000
s_cbranch_scc1 L_poll_143
L_pollx_144:
ds_read_b64 v[112:113], v22 offset:0
ds_read_b64 v[114:115], v22 offset:64
ds_read_b64 v[116:117], v22 offset:128
ds_read_b64 v[118:119], v22 offset:192
s_waitcnt lgkmcnt(0)
v_add_f32 v20, v112, v114
v_add_f32 v21, v116, v118
v_add_f32 v20, v20, v21
v_mul_f32 v20, 0x3e800000, v20
v_add_f32 v24, v113, v115
v_add_f32 v21, v117, v119
v_add_f32 v24, v24, v21
v_mov_b32 v21, 0
v_sub_f32 v22, v112, v20
v_fmac_f32 v21, v22, v22
v_sub_f32 v22, v114, v20
v_fmac_f32 v21, v22, v22
v_sub_f32 v22, v116, v20
v_fmac_f32 v21, v22, v22
v_sub_f32 v22, v118, v20
v_fmac_f32 v21, v22, v22
v_fmac_f32 v24, 0x43000000, v21
v_mul_f32 v24, 0x3b000000, v24
v_cvt_pk_bf16_f32 v24, 0, v24
v_cvt_pk_bf16_f32 v20, 0, v20
v_add_f32 v24, 0x3727c5ac, v24
v_cvt_pk_bf16_f32 v24, 0, v24
v_sqrt_f32 v24, v24
s_nop 0
v_cvt_pk_bf16_f32 v24, 0, v24
v_rcp_f32 v24, v24
s_nop 0
v_sub_f32 v96, v96, v20
v_cvt_pk_bf16_f32 v96, 0, v96
v_mul_f32 v96, v96, v24
v_cvt_pk_bf16_f32 v96, 0, v96
v_sub_f32 v97, v97, v20
v_cvt_pk_bf16_f32 v97, 0, v97
v_mul_f32 v97, v97, v24
v_cvt_pk_bf16_f32 v97, 0, v97
v_sub_f32 v98, v98, v20
v_cvt_pk_bf16_f32 v98, 0, v98
v_mul_f32 v98, v98, v24
v_cvt_pk_bf16_f32 v98, 0, v98
v_sub_f32 v99, v99, v20
v_cvt_pk_bf16_f32 v99, 0, v99
v_mul_f32 v99, v99, v24
v_cvt_pk_bf16_f32 v99, 0, v99
v_sub_f32 v100, v100, v20
v_cvt_pk_bf16_f32 v100, 0, v100
v_mul_f32 v100, v100, v24
v_cvt_pk_bf16_f32 v100, 0, v100
v_sub_f32 v101, v101, v20
v_cvt_pk_bf16_f32 v101, 0, v101
v_mul_f32 v101, v101, v24
v_cvt_pk_bf16_f32 v101, 0, v101
v_sub_f32 v102, v102, v20
v_cvt_pk_bf16_f32 v102, 0, v102
v_mul_f32 v102, v102, v24
v_cvt_pk_bf16_f32 v102, 0, v102
v_sub_f32 v103, v103, v20
v_cvt_pk_bf16_f32 v103, 0, v103
v_mul_f32 v103, v103, v24
v_cvt_pk_bf16_f32 v103, 0, v103
v_sub_f32 v104, v104, v20
v_cvt_pk_bf16_f32 v104, 0, v104
v_mul_f32 v104, v104, v24
v_cvt_pk_bf16_f32 v104, 0, v104
v_sub_f32 v105, v105, v20
v_cvt_pk_bf16_f32 v105, 0, v105
v_mul_f32 v105, v105, v24
v_cvt_pk_bf16_f32 v105, 0, v105
v_sub_f32 v106, v106, v20
v_cvt_pk_bf16_f32 v106, 0, v106
v_mul_f32 v106, v106, v24
v_cvt_pk_bf16_f32 v106, 0, v106
v_sub_f32 v107, v107, v20
v_cvt_pk_bf16_f32 v107, 0, v107
v_mul_f32 v107, v107, v24
v_cvt_pk_bf16_f32 v107, 0, v107
v_sub_f32 v108, v108, v20
v_cvt_pk_bf16_f32 v108, 0, v108
v_mul_f32 v108, v108, v24
v_cvt_pk_bf16_f32 v108, 0, v108
v_sub_f32 v109, v109, v20
v_cvt_pk_bf16_f32 v109, 0, v109
v_mul_f32 v109, v109, v24
v_cvt_pk_bf16_f32 v109, 0, v109
v_sub_f32 v110, v110, v20
v_cvt_pk_bf16_f32 v110, 0, v110
v_mul_f32 v110, v110, v24
v_cvt_pk_bf16_f32 v110, 0, v110
v_sub_f32 v111, v111, v20
v_cvt_pk_bf16_f32 v111, 0, v111
v_mul_f32 v111, v111, v24
v_cvt_pk_bf16_f32 v111, 0, v111
L_g2:
s_cmp_ge_u32 s2, s73
s_cbranch_scc0 L_fl_145
s_waitcnt vmcnt(0)
v_cmp_eq_u32 vcc, 0, v31
s_cbranch_vccz L_fl_145
s_mov_b32 s75, 0
L_poll_146:
buffer_load_dword v31, v30, s[52:55], 0 offen sc1
s_waitcnt vmcnt(0)
v_cmp_eq_u32 vcc, 0, v31
s_cbranch_vccz L_pollx_147
s_sleep 40
s_add_u32 s75, s75, 1
s_cmp_lt_u32 s75, 0x100000
s_cbranch_scc1 L_poll_146
L_pollx_147:
L_fl_145:
v_mov_b32 v20, 0
s_cmp_eq_u32 s34, 0
s_cbranch_scc0 L_w_148
ds_write_b32 v20, v9 offset:324
L_w_148:
v_lshrrev_b32 v18, 4, v0
v_bfe_u32 v19, v0, 2, 2
v_lshrrev_b32 v20, 1, v19
v_and_b32 v21, 1, v18
v_lshl_add_u32 v20, v21, 1, v20
v_lshlrev_b32 v20, 5, v20
v_lshl_add_u32 v20, v18, 10, v20
v_lshl_add_u32 v20, v19, 7, v20
v_and_b32 v21, 3, v0
v_lshl_add_u32 v20, v21, 3, v20
v_add_u32 v40, s65, v20
v_xor_b32 v41, 32, v40
v_xor_b32 v42, 64, v40
v_xor_b32 v43, 96, v40
s_cmp_eq_u32 s77, 0
s_cbranch_scc1 L_pc_149
s_waitcnt vmcnt(13) lgkmcnt(0)
s_branch L_pc_150
L_pc_149:
s_waitcnt vmcnt(12) lgkmcnt(0)
L_pc_150:
ds_read_b64_tr_b16 v[128:129], v40 offset:0
ds_read_b64_tr_b16 v[130:131], v40 offset:512
ds_read_b64_tr_b16 v[132:133], v41 offset:0
ds_read_b64_tr_b16 v[134:135], v41 offset:512
ds_read_b64_tr_b16 v[136:137], v42 offset:0
ds_read_b64_tr_b16 v[138:139], v42 offset:512
ds_read_b64_tr_b16 v[140:141], v43 offset:0
ds_read_b64_tr_b16 v[142:143], v43 offset:512
s_cmp_eq_u32 s77, 0
s_cbranch_scc1 L_pc_151
s_waitcnt vmcnt(9) lgkmcnt(0)
s_branch L_pc_152
L_pc_151:
s_waitcnt vmcnt(8) lgkmcnt(0)
L_pc_152:
ds_read_b64_tr_b16 v[144:145], v40 offset:4096
ds_read_b64_tr_b16 v[146:147], v40 offset:4608
ds_read_b64_tr_b16 v[148:149], v41 offset:4096
ds_read_b64_tr_b16 v[150:151], v41 offset:4608
ds_read_b64_tr_b16 v[152:153], v42 offset:4096
ds_read_b64_tr_b16 v[154:155], v42 offset:4608
ds_read_b64_tr_b16 v[156:157], v43 offset:4096
ds_read_b64_tr_b16 v[158:159], v43 offset:4608
s_cmp_eq_u32 s77, 0
s_cbranch_scc1 L_pc_153
s_waitcnt vmcnt(5) lgkmcnt(0)
s_branch L_pc_154
L_pc_153:
s_waitcnt vmcnt(4) lgkmcnt(0)
L_pc_154:
ds_read_b64_tr_b16 v[160:161], v40 offset:32768
ds_read_b64_tr_b16 v[162:163], v40 offset:33280
ds_read_b64_tr_b16 v[164:165], v41 offset:32768
ds_read_b64_tr_b16 v[166:167], v41 offset:33280
ds_read_b64_tr_b16 v[168:169], v42 offset:32768
ds_read_b64_tr_b16 v[170:171], v42 offset:33280
ds_read_b64_tr_b16 v[172:173], v43 offset:32768
ds_read_b64_tr_b16 v[174:175], v43 offset:33280
s_cmp_eq_u32 s77, 0
s_cbranch_scc1 L_pc_155
s_waitcnt vmcnt(1) lgkmcnt(0)
s_branch L_pc_156
L_pc_155:
s_waitcnt vmcnt(0) lgkmcnt(0)
L_pc_156:
ds_read_b64_tr_b16 v[176:177], v40 offset:36864
ds_read_b64_tr_b16 v[178:179], v40 offset:37376
ds_read_b64_tr_b16 v[180:181], v41 offset:36864
ds_read_b64_tr_b16 v[182:183], v41 offset:37376
ds_read_b64_tr_b16 v[184:185], v42 offset:36864
ds_read_b64_tr_b16 v[186:187], v42 offset:37376
ds_read_b64_tr_b16 v[188:189], v43 offset:36864
ds_read_b64_tr_b16 v[190:191], v43 offset:37376
s_waitcnt lgkmcnt(0)
s_cmp_eq_u32 s34, 2
s_cselect_b32 s73, 16, 0x1000
v_and_b32 v30, 31, v0
v_lshlrev_b32 v30, 2, v30
s_cmp_ge_u32 s2, s73
s_cbranch_scc0 L_fl_157
buffer_load_dword v31, v30, s[52:55], 0 offen offset:128 sc1
L_fl_157:
s_cmp_lt_u32 s2, 48
s_cbranch_scc1 L_g3
v_mov_b32 v20, 0
s_mov_b32 s75, 0
L_poll_158:
ds_read_b32 v22, v20 offset:324
s_waitcnt lgkmcnt(0)
v_cmp_eq_u32 vcc, 0, v22
s_cbranch_vccz L_pollx_159
s_sleep 1
s_add_u32 s75, s75, 1
s_cmp_lt_u32 s75, 0x1000000
s_cbranch_scc1 L_poll_158
L_pollx_159:
s_lshl_b32 s64, s34, 11
s_add_u32 s64, s64, 0
s_add_u32 s66, s64, 8192
s_mov_b32 s75, 0
L_poll_160:
buffer_load_dwordx4 v[192:195], v1, s[36:39], s64 offen offset:0 sc1
buffer_load_dwordx4 v[200:203], v1, s[36:39], s66 offen offset:0 sc1
buffer_load_dwordx4 v[196:199], v1, s[36:39], s64 offen offset:1024 sc1
buffer_load_dwordx4 v[204:207], v1, s[36:39], s66 offen offset:1024 sc1
s_waitcnt vmcnt(0)
v_max3_u32 v22, v192, v193, v194
v_max3_u32 v22, v22, v195, v196
v_max3_u32 v22, v22, v197, v198
v_max3_u32 v22, v22, v199, v200
v_max3_u32 v22, v22, v201, v202
v_max3_u32 v22, v22, v203, v204
v_max3_u32 v22, v22, v205, v206
v_max_u32 v22, v22, v207
v_cmp_eq_u32 vcc, -1, v22
s_cbranch_vccz L_pollx_161
s_sleep 4
s_add_u32 s75, s75, 1
s_cmp_lt_u32 s75, 0x100000
s_cbranch_scc1 L_poll_160
L_pollx_161:
v_lshlrev_b32 v20, 16, v200
v_and_b32 v21, s68, v200
v_add_f32 v20, 1.0, v20
v_add_f32 v21, 1.0, v21
v_cvt_pk_bf16_f32 v20, 0, v20
v_cvt_pk_bf16_f32 v21, 0, v21
v_mul_f32 v20, v20, v96
v_mul_f32 v21, v21, v97
v_cvt_pk_bf16_f32 v20, 0, v20
v_cvt_pk_bf16_f32 v21, 0, v21
v_lshlrev_b32 v22, 16, v192
v_and_b32 v23, s68, v192
v_add_f32 v20, v20, v22
v_add_f32 v21, v21, v23
v_cvt_pk_bf16_f32 v48, v20, v21
v_lshlrev_b32 v20, 16, v201
v_and_b32 v21, s68, v201
v_add_f32 v20, 1.0, v20
v_add_f32 v21, 1.0, v21
v_cvt_pk_bf16_f32 v20, 0, v20
v_cvt_pk_bf16_f32 v21, 0, v21
v_mul_f32 v20, v20, v98
v_mul_f32 v21, v21, v99
v_cvt_pk_bf16_f32 v20, 0, v20
v_cvt_pk_bf16_f32 v21, 0, v21
v_lshlrev_b32 v22, 16, v193
v_and_b32 v23, s68, v193
v_add_f32 v20, v20, v22
v_add_f32 v21, v21, v23
v_cvt_pk_bf16_f32 v49, v20, v21
v_lshlrev_b32 v20, 16, v202
v_and_b32 v21, s68, v202
v_add_f32 v20, 1.0, v20
v_add_f32 v21, 1.0, v21
v_cvt_pk_bf16_f32 v20, 0, v20
v_cvt_pk_bf16_f32 v21, 0, v21
v_mul_f32 v20, v20, v100
v_mul_f32 v21, v21, v101
v_cvt_pk_bf16_f32 v20, 0, v20
v_cvt_pk_bf16_f32 v21, 0, v21
v_lshlrev_b32 v22, 16, v194
v_and_b32 v23, s68, v194
v_add_f32 v20, v20, v22
v_add_f32 v21, v21, v23
v_cvt_pk_bf16_f32 v50, v20, v21
v_lshlrev_b32 v20, 16, v203
v_and_b32 v21, s68, v203
v_add_f32 v20, 1.0, v20
v_add_f32 v21, 1.0, v21
v_cvt_pk_bf16_f32 v20, 0, v20
v_cvt_pk_bf16_f32 v21, 0, v21
v_mul_f32 v20, v20, v102
v_mul_f32 v21, v21, v103
v_cvt_pk_bf16_f32 v20, 0, v20
v_cvt_pk_bf16_f32 v21, 0, v21
v_lshlrev_b32 v22, 16, v195
v_and_b32 v23, s68, v195
v_add_f32 v20, v20, v22
v_add_f32 v21, v21, v23
v_cvt_pk_bf16_f32 v51, v20, v21
v_lshlrev_b32 v20, 16, v204
v_and_b32 v21, s68, v204
v_add_f32 v20, 1.0, v20
v_add_f32 v21, 1.0, v21
v_cvt_pk_bf16_f32 v20, 0, v20
v_cvt_pk_bf16_f32 v21, 0, v21
v_mul_f32 v20, v20, v104
v_mul_f32 v21, v21, v105
v_cvt_pk_bf16_f32 v20, 0, v20
v_cvt_pk_bf16_f32 v21, 0, v21
v_lshlrev_b32 v22, 16, v196
v_and_b32 v23, s68, v196
v_add_f32 v20, v20, v22
v_add_f32 v21, v21, v23
v_cvt_pk_bf16_f32 v52, v20, v21
v_lshlrev_b32 v20, 16, v205
v_and_b32 v21, s68, v205
v_add_f32 v20, 1.0, v20
v_add_f32 v21, 1.0, v21
v_cvt_pk_bf16_f32 v20, 0, v20
v_cvt_pk_bf16_f32 v21, 0, v21
v_mul_f32 v20, v20, v106
v_mul_f32 v21, v21, v107
v_cvt_pk_bf16_f32 v20, 0, v20
v_cvt_pk_bf16_f32 v21, 0, v21
v_lshlrev_b32 v22, 16, v197
v_and_b32 v23, s68, v197
v_add_f32 v20, v20, v22
v_add_f32 v21, v21, v23
v_cvt_pk_bf16_f32 v53, v20, v21
v_lshlrev_b32 v20, 16, v206
v_and_b32 v21, s68, v206
v_add_f32 v20, 1.0, v20
v_add_f32 v21, 1.0, v21
v_cvt_pk_bf16_f32 v20, 0, v20
v_cvt_pk_bf16_f32 v21, 0, v21
v_mul_f32 v20, v20, v108
v_mul_f32 v21, v21, v109
v_cvt_pk_bf16_f32 v20, 0, v20
v_cvt_pk_bf16_f32 v21, 0, v21
v_lshlrev_b32 v22, 16, v198
v_and_b32 v23, s68, v198
v_add_f32 v20, v20, v22
v_add_f32 v21, v21, v23
v_cvt_pk_bf16_f32 v54, v20, v21
v_lshlrev_b32 v20, 16, v207
v_and_b32 v21, s68, v207
v_add_f32 v20, 1.0, v20
v_add_f32 v21, 1.0, v21
v_cvt_pk_bf16_f32 v20, 0, v20
v_cvt_pk_bf16_f32 v21, 0, v21
v_mul_f32 v20, v20, v110
v_mul_f32 v21, v21, v111
v_cvt_pk_bf16_f32 v20, 0, v20
v_cvt_pk_bf16_f32 v21, 0, v21
v_lshlrev_b32 v22, 16, v199
v_and_b32 v23, s68, v199
v_add_f32 v20, v20, v22
v_add_f32 v21, v21, v23
v_cvt_pk_bf16_f32 v55, v20, v21
L_g3:
s_cmp_ge_u32 s2, s73
s_cbranch_scc0 L_fl_162
s_waitcnt vmcnt(0)
v_cmp_eq_u32 vcc, 0, v31
s_cbranch_vccz L_fl_162
s_mov_b32 s75, 0
L_poll_163:
buffer_load_dword v31, v30, s[52:55], 0 offen offset:128 sc1
s_waitcnt vmcnt(0)
v_cmp_eq_u32 vcc, 0, v31
s_cbranch_vccz L_pollx_164
s_sleep 40
s_add_u32 s75, s75, 1
s_cmp_lt_u32 s75, 0x100000
s_cbranch_scc1 L_poll_163
L_pollx_164:
L_fl_162:
s_nop 1
v_mfma_f32_16x16x32_bf16 v[64:67], v[128:131], v[48:51], 0
v_mfma_f32_16x16x32_bf16 v[68:71], v[132:135], v[48:51], 0
v_mfma_f32_16x16x32_bf16 v[72:75], v[136:139], v[48:51], 0
v_mfma_f32_16x16x32_bf16 v[76:79], v[140:143], v[48:51], 0
v_mfma_f32_16x16x32_bf16 v[80:83], v[144:147], v[48:51], 0
v_mfma_f32_16x16x32_bf16 v[84:87], v[148:151], v[48:51], 0
v_mfma_f32_16x16x32_bf16 v[88:91], v[152:155], v[48:51], 0
v_mfma_f32_16x16x32_bf16 v[92:95], v[156:159], v[48:51], 0
v_mfma_f32_16x16x32_bf16 v[64:67], v[160:163], v[52:55], v[64:67]
v_mfma_f32_16x16x32_bf16 v[68:71], v[164:167], v[52:55], v[68:71]
v_mfma_f32_16x16x32_bf16 v[72:75], v[168:171], v[52:55], v[72:75]
v_mfma_f32_16x16x32_bf16 v[76:79], v[172:175], v[52:55], v[76:79]
v_mfma_f32_16x16x32_bf16 v[80:83], v[176:179], v[52:55], v[80:83]
v_mfma_f32_16x16x32_bf16 v[84:87], v[180:183], v[52:55], v[84:87]
v_mfma_f32_16x16x32_bf16 v[88:91], v[184:187], v[52:55], v[88:91]
v_mfma_f32_16x16x32_bf16 v[92:95], v[188:191], v[52:55], v[92:95]
v_and_b32 v20, 7, v0
v_mul_u32_u24 v20, 272, v20
v_and_b32 v21, 8, v0
v_lshl_add_u32 v20, v21, 3, v20
v_and_b32 v21, 48, v0
v_add_u32 v20, v20, v21
s_mul_i32 s64, s34, 8192
s_add_u32 s64, s64, 4096
v_add_u32 v20, s64, v20
s_nop 7
v_add_f32_dpp v24, v80, v64 row_ror:8 row_mask:0xf bank_mask:0x3
v_add_f32_dpp v24, v68, v84 row_ror:8 row_mask:0xf bank_mask:0xc
v_add_f32_dpp v25, v81, v65 row_ror:8 row_mask:0xf bank_mask:0x3
v_add_f32_dpp v25, v69, v85 row_ror:8 row_mask:0xf bank_mask:0xc
v_add_f32_dpp v26, v82, v66 row_ror:8 row_mask:0xf bank_mask:0x3
v_add_f32_dpp v26, v70, v86 row_ror:8 row_mask:0xf bank_mask:0xc
v_add_f32_dpp v27, v83, v67 row_ror:8 row_mask:0xf bank_mask:0x3
v_add_f32_dpp v27, v71, v87 row_ror:8 row_mask:0xf bank_mask:0xc
ds_write_b128 v20, v[24:27] offset:0
v_add_f32_dpp v28, v88, v72 row_ror:8 row_mask:0xf bank_mask:0x3
v_add_f32_dpp v28, v76, v92 row_ror:8 row_mask:0xf bank_mask:0xc
v_add_f32_dpp v29, v89, v73 row_ror:8 row_mask:0xf bank_mask:0x3
v_add_f32_dpp v29, v77, v93 row_ror:8 row_mask:0xf bank_mask:0xc
v_add_f32_dpp v30, v90, v74 row_ror:8 row_mask:0xf bank_mask:0x3
v_add_f32_dpp v30, v78, v94 row_ror:8 row_mask:0xf bank_mask:0xc
v_add_f32_dpp v31, v91, v75 row_ror:8 row_mask:0xf bank_mask:0x3
v_add_f32_dpp v31, v79, v95 row_ror:8 row_mask:0xf bank_mask:0xc
ds_write_b128 v20, v[28:31] offset:128
v_mov_b32 v20, 0
s_waitcnt lgkmcnt(0)
s_mov_b64 exec, 1
ds_add_u32 v20, v9 offset:320
s_mov_b64 exec, -1
s_cmp_eq_u32 s34, 0
s_cbranch_scc0 L_waitq
s_cmp_lt_u32 s2, 16
s_cbranch_scc0 L_gq2
v_and_b32 v21, 7, v0
v_lshrrev_b32 v22, 4, v0
v_and_b32 v23, 8, v0
v_lshrrev_b32 v23, 1, v23
v_add_u32 v22, v22, v23
v_mov_b32 v23, v1
s_lshl_b32 s64, s72, 10
s_add_u32 s64, s64, 0
s_branch L_g4
L_gq2:
v_lshrrev_b32 v21, 3, v0
v_and_b32 v22, 7, v0
s_mov_b32 s64, 10240
s_cmp_lt_u32 s2, 48
s_cselect_b32 s64, 22528, s64
s_mov_b32 s65, 12288
v_mul_lo_u32 v23, s65, v21
v_lshl_add_u32 v23, v22, 4, v23
s_lshl_b32 s66, s72, 7
s_add_u32 s64, s64, s66
L_g4:
v_mul_u32_u24 v21, 272, v21
v_lshl_add_u32 v21, v22, 5, v21
v_add_u32 v21, 4096, v21
s_mov_b32 s75, 0
L_poll_165:
ds_read_b32 v22, v20 offset:320
s_waitcnt lgkmcnt(0)
v_cmp_gt_u32 vcc, 4, v22
s_cbranch_vccz L_pollx_166
s_add_u32 s75, s75, 1
s_cmp_lt_u32 s75, 0x1000000
s_cbranch_scc1 L_poll_165
L_pollx_166:
ds_read_b128 v[64:67], v21 offset:0
ds_read_b128 v[68:71], v21 offset:16
ds_read_b128 v[72:75], v21 offset:8192
ds_read_b128 v[76:79], v21 offset:8208
ds_read_b128 v[80:83], v21 offset:16384
ds_read_b128 v[84:87], v21 offset:16400
ds_read_b128 v[88:91], v21 offset:24576
ds_read_b128 v[92:95], v21 offset:24592
s_waitcnt lgkmcnt(0)
v_add_f32 v64, v64, v72
v_add_f32 v65, v65, v73
v_add_f32 v66, v66, v74
v_add_f32 v67, v67, v75
v_add_f32 v68, v68, v76
v_add_f32 v69, v69, v77
v_add_f32 v70, v70, v78
v_add_f32 v71, v71, v79
v_add_f32 v64, v64, v80
v_add_f32 v65, v65, v81
v_add_f32 v66, v66, v82
v_add_f32 v67, v67, v83
v_add_f32 v68, v68, v84
v_add_f32 v69, v69, v85
v_add_f32 v70, v70, v86
v_add_f32 v71, v71, v87
v_add_f32 v64, v64, v88
v_add_f32 v65, v65, v89
v_add_f32 v66, v66, v90
v_add_f32 v67, v67, v91
v_add_f32 v68, v68, v92
v_add_f32 v69, v69, v93
v_add_f32 v70, v70, v94
v_add_f32 v71, v71, v95
v_cvt_pk_bf16_f32 v24, v64, v65
v_cvt_pk_bf16_f32 v25, v66, v67
v_cvt_pk_bf16_f32 v26, v68, v69
v_cvt_pk_bf16_f32 v27, v70, v71
v_min_u32 v24, -2, v24
v_min_u32 v25, -2, v25
v_min_u32 v26, -2, v26
v_min_u32 v27, -2, v27
buffer_store_dwordx4 v[24:27], v23, s[36:39], s64 offen sc1
s_branch L_waitq
L_jan:
v_mov_b32 v4, -1
v_mov_b32 v5, -1
v_mov_b32 v6, -1
v_mov_b32 v7, -1
s_lshl_b32 s67, s64, 2
s_add_u32 s67, s67, s34
s_cmp_lt_u32 s67, 32
s_cselect_b32 s66, 0, 933888
s_mul_i32 s65, s67, 3072
s_add_u32 s65, s65, s66
s_add_u32 s65, s65, 16384
v_add_u32 v8, s65, v1
global_store_dwordx4 v8, v[4:7], s[30:31] offset:0 sc1
global_store_dwordx4 v8, v[4:7], s[30:31] offset:1024 sc1
global_store_dwordx4 v8, v[4:7], s[30:31] offset:2048 sc1
s_and_b32 s66, s67, 64
s_add_u32 s67, s67, s66
s_lshl_b32 s67, s67, 7
s_add_u32 s67, s67, 1343488
v_and_b32 v8, 8, v0
v_lshlrev_b32 v8, 10, v8
v_and_b32 v10, 0x70, v1
v_add3_u32 v8, v8, v10, s67
s_mov_b64 exec, 0xffff
global_store_dwordx4 v8, v[4:7], s[30:31] sc1
s_mov_b64 exec, 1
s_load_dword s68, s[30:31], 0x48000
s_and_b32 s65, s34, 1
s_lshl_b32 s66, s65, 13
s_xor_b32 s67, s67, s66
s_xor_b32 s66, s67, 0x2000
s_waitcnt vmcnt(0) lgkmcnt(0)
s_mov_b64 exec, -1
s_cmp_eq_u32 s34, 3
s_cbranch_scc1 L_p0_167
s_cmp_eq_u32 s34, 0
s_cselect_b32 s62, s24, s10
s_cselect_b32 s63, s25, s11
s_cmp_eq_u32 s34, 2
s_cselect_b32 s62, s12, s62
s_cselect_b32 s63, s13, s63
global_load_dword v12, v38, s[62:63]
global_load_dword v13, v39, s[62:63]
L_p0_167:
s_mov_b64 exec, 1
s_mov_b32 s70, 0
s_load_dword s68, s[30:31], s67
L_race_168:
s_getreg_b32 s69, hwreg(HW_REG_IB_STS, 8, 4)
s_add_u32 s70, s70, 1
s_cmp_eq_u32 s69, 0
s_cbranch_scc0 L_race_168
s_waitcnt lgkmcnt(0)
s_mov_b32 s71, 0
s_load_dword s68, s[30:31], s66
L_race_169:
s_getreg_b32 s69, hwreg(HW_REG_IB_STS, 8, 4)
s_add_u32 s71, s71, 1
s_cmp_eq_u32 s69, 0
s_cbranch_scc0 L_race_169
s_waitcnt lgkmcnt(0)
s_cmp_lt_u32 s71, s70
s_cselect_b32 s70, 1, 0
s_xor_b32 s70, s70, s65
s_getreg_b32 s69, hwreg(HW_REG_XCC_ID, 2, 1)
s_xor_b32 s70, s70, s69
s_lshl_b32 s69, s69, 14
s_lshl_b32 s70, s70, 8
s_add_u32 s70, s70, s69
s_add_u32 s70, s70, 1
v_mov_b32 v9, s70
s_lshl_b32 s65, s64, 2
v_mov_b32 v8, s65
ds_add_rtn_u32 v11, v2, v9 offset:320
s_waitcnt lgkmcnt(0)
v_add_u32 v11, v11, v9
v_and_b32 v10, 0xff, v11
v_cmp_eq_u32 vcc, 4, v10
s_cbranch_vccz L_j_170
global_store_dword v8, v11, s[28:29] offset:128 sc1
L_j_170:
s_mov_b64 exec, -1
s_branch L_nop0
L_norole:
s_cmp_eq_u32 s74, -1
s_cbranch_scc1 L_waitq
L_waitq:
s_cmp_eq_u32 s74, -1
s_cselect_b64 vcc, 0, -1
s_cmp_lt_u32 s2, 112
s_cselect_b64 vcc, -1, vcc
s_mov_b32 s44, s12
s_mov_b32 s45, s13
s_mov_b32 s46, 0x400000
s_mov_b32 s47, 0x20000
v_lshrrev_b32 v18, 4, v0
v_and_b32 v16, 15, v0
v_xor_b32 v16, v16, v18
v_xor_b32 v17, 4, v16
v_lshlrev_b32 v19, 10, v18
v_lshl_add_u32 v22, v16, 4, v19
v_lshl_add_u32 v23, v17, 4, v19
v_and_b32 v19, 1, v18
v_lshlrev_b32 v19, 10, v19
v_lshrrev_b32 v18, 1, v18
v_lshl_add_u32 v18, v18, 11, v19
v_lshl_add_u32 v16, v16, 4, v18
v_lshl_add_u32 v17, v17, 4, v18
v_lshrrev_b32 v18, 4, v0
v_bfe_u32 v19, v0, 2, 2
v_and_b32 v20, 2, v0
v_lshlrev_b32 v20, 2, v20
v_xor_b32 v20, v20, v19
v_and_b32 v21, 1, v18
v_lshlrev_b32 v21, 2, v21
v_xor_b32 v20, v20, v21
v_lshlrev_b32 v20, 4, v20
v_lshl_add_u32 v20, v18, 10, v20
v_lshl_add_u32 v20, v19, 8, v20
v_and_b32 v21, 1, v0
v_lshl_add_u32 v20, v21, 3, v20
s_lshl_b32 s65, s34, 13
s_add_u32 s65, s65, 8192
v_add_u32 v40, s65, v20
v_xor_b32 v41, 16, v40
v_xor_b32 v42, 32, v40
v_xor_b32 v43, 48, v40
v_xor_b32 v44, 64, v40
v_xor_b32 v45, 80, v40
v_xor_b32 v46, 96, v40
v_xor_b32 v47, 112, v40
s_lshl_b32 s64, s33, 17
s_lshl_b32 s66, s34, 8
s_add_u32 s64, s64, s66
s_mov_b32 s68, 0
s_lshl_b32 s66, s68, 10
s_add_u32 s64, s64, s66
s_add_u32 m0, s65, 0
s_xor_b32 s66, s64, 0
buffer_load_dwordx4 v16, s[44:47], s66 offen  lds
s_add_u32 m0, s65, 1024
s_xor_b32 s66, s64, 8192
buffer_load_dwordx4 v17, s[44:47], s66 offen  lds
s_add_u32 m0, s65, 2048
s_xor_b32 s66, s64, 16384
buffer_load_dwordx4 v16, s[44:47], s66 offen  lds
s_waitcnt vmcnt(2)
s_add_u32 m0, s65, 3072
s_xor_b32 s66, s64, 24576
buffer_load_dwordx4 v17, s[44:47], s66 offen  lds
s_waitcnt vmcnt(2)
s_add_u32 m0, s65, 32768
s_xor_b32 s66, s64, 4096
buffer_load_dwordx4 v16, s[44:47], s66 offen  lds
s_waitcnt vmcnt(2)
s_add_u32 m0, s65, 33792
s_xor_b32 s66, s64, 12288
buffer_load_dwordx4 v17, s[44:47], s66 offen  lds
s_waitcnt vmcnt(2)
ds_read_b64_tr_b16 v[128:129], v40 offset:0
ds_read_b64_tr_b16 v[136:137], v41 offset:0
ds_read_b64_tr_b16 v[144:145], v42 offset:0
ds_read_b64_tr_b16 v[152:153], v43 offset:0
ds_read_b64_tr_b16 v[160:161], v44 offset:0
ds_read_b64_tr_b16 v[168:169], v45 offset:0
ds_read_b64_tr_b16 v[176:177], v46 offset:0
ds_read_b64_tr_b16 v[184:185], v47 offset:0
s_add_u32 m0, s65, 34816
s_xor_b32 s66, s64, 20480
buffer_load_dwordx4 v16, s[44:47], s66 offen  lds
s_waitcnt vmcnt(2)
s_add_u32 m0, s65, 35840
s_xor_b32 s66, s64, 28672
buffer_load_dwordx4 v17, s[44:47], s66 offen  lds
s_waitcnt vmcnt(2)
s_waitcnt lgkmcnt(0)
s_add_u32 m0, s65, 0
s_xor_b32 s66, s64, 32768
buffer_load_dwordx4 v16, s[44:47], s66 offen  lds
s_waitcnt vmcnt(2)
s_add_u32 m0, s65, 1024
s_xor_b32 s66, s64, 40960
buffer_load_dwordx4 v17, s[44:47], s66 offen  lds
s_waitcnt vmcnt(2)
ds_read_b64_tr_b16 v[130:131], v40 offset:32768
ds_read_b64_tr_b16 v[138:139], v41 offset:32768
ds_read_b64_tr_b16 v[146:147], v42 offset:32768
ds_read_b64_tr_b16 v[154:155], v43 offset:32768
ds_read_b64_tr_b16 v[162:163], v44 offset:32768
ds_read_b64_tr_b16 v[170:171], v45 offset:32768
ds_read_b64_tr_b16 v[178:179], v46 offset:32768
ds_read_b64_tr_b16 v[186:187], v47 offset:32768
s_add_u32 m0, s65, 2048
s_xor_b32 s66, s64, 49152
buffer_load_dwordx4 v16, s[44:47], s66 offen  lds
s_waitcnt vmcnt(2)
s_add_u32 m0, s65, 3072
s_xor_b32 s66, s64, 57344
buffer_load_dwordx4 v17, s[44:47], s66 offen  lds
s_waitcnt vmcnt(2)
s_waitcnt lgkmcnt(0)
s_add_u32 m0, s65, 32768
s_xor_b32 s66, s64, 36864
buffer_load_dwordx4 v16, s[44:47], s66 offen  lds
s_waitcnt vmcnt(2)
s_add_u32 m0, s65, 33792
s_xor_b32 s66, s64, 45056
buffer_load_dwordx4 v17, s[44:47], s66 offen  lds
s_waitcnt vmcnt(2)
ds_read_b64_tr_b16 v[132:133], v40 offset:0
ds_read_b64_tr_b16 v[140:141], v41 offset:0
ds_read_b64_tr_b16 v[148:149], v42 offset:0
ds_read_b64_tr_b16 v[156:157], v43 offset:0
ds_read_b64_tr_b16 v[164:165], v44 offset:0
ds_read_b64_tr_b16 v[172:173], v45 offset:0
ds_read_b64_tr_b16 v[180:181], v46 offset:0
ds_read_b64_tr_b16 v[188:189], v47 offset:0
s_add_u32 m0, s65, 34816
s_xor_b32 s66, s64, 53248
buffer_load_dwordx4 v16, s[44:47], s66 offen  lds
s_waitcnt vmcnt(2)
s_add_u32 m0, s65, 35840
s_xor_b32 s66, s64, 61440
buffer_load_dwordx4 v17, s[44:47], s66 offen  lds
s_waitcnt vmcnt(2)
s_waitcnt lgkmcnt(0)
s_add_u32 m0, s65, 0
s_xor_b32 s66, s64, 65536
buffer_load_dwordx4 v16, s[44:47], s66 offen  lds
s_waitcnt vmcnt(2)
s_add_u32 m0, s65, 1024
s_xor_b32 s66, s64, 73728
buffer_load_dwordx4 v17, s[44:47], s66 offen  lds
s_waitcnt vmcnt(2)
ds_read_b64_tr_b16 v[134:135], v40 offset:32768
ds_read_b64_tr_b16 v[142:143], v41 offset:32768
ds_read_b64_tr_b16 v[150:151], v42 offset:32768
ds_read_b64_tr_b16 v[158:159], v43 offset:32768
ds_read_b64_tr_b16 v[166:167], v44 offset:32768
ds_read_b64_tr_b16 v[174:175], v45 offset:32768
ds_read_b64_tr_b16 v[182:183], v46 offset:32768
ds_read_b64_tr_b16 v[190:191], v47 offset:32768
s_add_u32 m0, s65, 2048
s_xor_b32 s66, s64, 81920
buffer_load_dwordx4 v16, s[44:47], s66 offen  lds
s_waitcnt vmcnt(2)
s_add_u32 m0, s65, 3072
s_xor_b32 s66, s64, 90112
buffer_load_dwordx4 v17, s[44:47], s66 offen  lds
s_waitcnt vmcnt(2)
s_waitcnt lgkmcnt(0)
s_add_u32 m0, s65, 32768
s_xor_b32 s66, s64, 69632
buffer_load_dwordx4 v16, s[44:47], s66 offen  lds
s_waitcnt vmcnt(2)
s_add_u32 m0, s65, 33792
s_xor_b32 s66, s64, 77824
buffer_load_dwordx4 v17, s[44:47], s66 offen  lds
s_waitcnt vmcnt(2)
ds_read_b64_tr_b16 v[192:193], v40 offset:0
ds_read_b64_tr_b16 v[200:201], v41 offset:0
ds_read_b64_tr_b16 v[208:209], v42 offset:0
ds_read_b64_tr_b16 v[216:217], v43 offset:0
ds_read_b64_tr_b16 v[224:225], v44 offset:0
ds_read_b64_tr_b16 v[232:233], v45 offset:0
ds_read_b64_tr_b16 v[240:241], v46 offset:0
ds_read_b64_tr_b16 v[248:249], v47 offset:0
s_add_u32 m0, s65, 34816
s_xor_b32 s66, s64, 86016
buffer_load_dwordx4 v16, s[44:47], s66 offen  lds
s_waitcnt vmcnt(2)
s_add_u32 m0, s65, 35840
s_xor_b32 s66, s64, 94208
buffer_load_dwordx4 v17, s[44:47], s66 offen  lds
s_waitcnt vmcnt(2)
s_waitcnt lgkmcnt(0)
s_add_u32 m0, s65, 0
s_xor_b32 s66, s64, 98304
buffer_load_dwordx4 v16, s[44:47], s66 offen  lds
s_waitcnt vmcnt(2)
s_add_u32 m0, s65, 1024
s_xor_b32 s66, s64, 106496
buffer_load_dwordx4 v17, s[44:47], s66 offen  lds
s_waitcnt vmcnt(2)
ds_read_b64_tr_b16 v[194:195], v40 offset:32768
ds_read_b64_tr_b16 v[202:203], v41 offset:32768
ds_read_b64_tr_b16 v[210:211], v42 offset:32768
ds_read_b64_tr_b16 v[218:219], v43 offset:32768
ds_read_b64_tr_b16 v[226:227], v44 offset:32768
ds_read_b64_tr_b16 v[234:235], v45 offset:32768
ds_read_b64_tr_b16 v[242:243], v46 offset:32768
ds_read_b64_tr_b16 v[250:251], v47 offset:32768
v_and_b32 v24, 127, v2
buffer_load_dword v25, v24, s[52:55], 0 offen offset:128
s_add_u32 m0, s65, 2048
s_xor_b32 s66, s64, 114688
buffer_load_dwordx4 v16, s[44:47], s66 offen  lds
s_waitcnt vmcnt(2)
s_add_u32 m0, s65, 3072
s_xor_b32 s66, s64, 122880
buffer_load_dwordx4 v17, s[44:47], s66 offen  lds
s_waitcnt vmcnt(2)
s_waitcnt lgkmcnt(0)
s_add_u32 m0, s65, 32768
s_xor_b32 s66, s64, 102400
buffer_load_dwordx4 v16, s[44:47], s66 offen  lds
s_waitcnt vmcnt(2)
s_add_u32 m0, s65, 33792
s_xor_b32 s66, s64, 110592
buffer_load_dwordx4 v17, s[44:47], s66 offen  lds
s_waitcnt vmcnt(2)
ds_read_b64_tr_b16 v[196:197], v40 offset:0
ds_read_b64_tr_b16 v[204:205], v41 offset:0
ds_read_b64_tr_b16 v[212:213], v42 offset:0
ds_read_b64_tr_b16 v[220:221], v43 offset:0
ds_read_b64_tr_b16 v[228:229], v44 offset:0
ds_read_b64_tr_b16 v[236:237], v45 offset:0
ds_read_b64_tr_b16 v[244:245], v46 offset:0
ds_read_b64_tr_b16 v[252:253], v47 offset:0
s_add_u32 m0, s65, 34816
s_xor_b32 s66, s64, 118784
buffer_load_dwordx4 v16, s[44:47], s66 offen  lds
s_waitcnt vmcnt(2)
s_add_u32 m0, s65, 35840
s_xor_b32 s66, s64, 126976
buffer_load_dwordx4 v17, s[44:47], s66 offen  lds
s_waitcnt vmcnt(0)
ds_read_b64_tr_b16 v[198:199], v40 offset:32768
ds_read_b64_tr_b16 v[206:207], v41 offset:32768
ds_read_b64_tr_b16 v[214:215], v42 offset:32768
ds_read_b64_tr_b16 v[222:223], v43 offset:32768
ds_read_b64_tr_b16 v[230:231], v44 offset:32768
ds_read_b64_tr_b16 v[238:239], v45 offset:32768
ds_read_b64_tr_b16 v[246:247], v46 offset:32768
ds_read_b64_tr_b16 v[254:255], v47 offset:32768
s_waitcnt lgkmcnt(0)
v_cmp_eq_u32 vcc, 0, v25
s_cbranch_vccz L_tab_171
s_mov_b32 s75, 0
L_poll_172:
buffer_load_dword v25, v24, s[52:55], 0 offen offset:128 sc1
s_waitcnt vmcnt(0)
v_cmp_eq_u32 vcc, 0, v25
s_cbranch_vccz L_pollx_173
s_sleep 40
s_add_u32 s75, s75, 1
s_cmp_lt_u32 s75, 0x100000
s_cbranch_scc1 L_poll_172
L_pollx_173:
L_tab_171:
v_bfe_u32 v26, v25, 8, 3
v_lshrrev_b32 v25, 16, v25
s_nop 0
v_add_u32_dpp v26, v26, v26 quad_perm:[1,0,3,2] row_mask:0xf bank_mask:0xf
s_nop 1
v_add_u32_dpp v26, v26, v26 quad_perm:[2,3,0,1] row_mask:0xf bank_mask:0xf
s_nop 1
v_add_u32_dpp v26, v26, v26 row_ror:4 row_mask:0xf bank_mask:0xf
s_nop 1
v_add_u32_dpp v26, v26, v26 row_ror:8 row_mask:0xf bank_mask:0xf
s_nop 1
v_readlane_b32 s66, v26, 0
v_readlane_b32 s71, v26, 16
s_add_u32 s66, s66, s71
s_cmp_gt_u32 s66, 64
s_cselect_b32 s66, 1, 0
v_cmp_ne_u32 vcc, s66, v25
s_and_b32 s71, vcc_lo, 0xff
s_bcnt0_i32_b32 s66, s71
s_sub_u32 s66, s66, 24
v_mbcnt_lo_u32_b32 v24, s71, 0
v_sub_u32 v25, v0, v24
v_add_u32 v24, s66, v24
v_cndmask_b32 v24, v25, v24, vcc
v_bfe_u32 v25, v24, 1, 2
v_and_b32 v26, 1, v24
v_lshl_or_b32 v25, v26, 2, v25
v_lshlrev_b32 v25, v2, v25
s_nop 1
v_or_b32_dpp v25, v25, v25 quad_perm:[1,0,3,2] row_mask:0xf bank_mask:0xf
s_nop 1
v_or_b32_dpp v25, v25, v25 quad_perm:[2,3,0,1] row_mask:0xf bank_mask:0xf
s_nop 1
v_or_b32_dpp v25, v25, v25 row_shl:4 row_mask:0xf bank_mask:0xf
s_nop 1
v_readfirstlane_b32 s35, v25
s_mov_b64 exec, 1
ds_write_b32 v2, v25 offset:328
s_mov_b64 exec, -1
s_sub_u32 s64, s2, 144
s_cmp_lt_u32 s64, 64
s_cbranch_scc0 L_rp_174
s_cmp_eq_u32 s34, 0
s_cbranch_scc0 L_rp_174
s_mov_b32 s48, s4
s_mov_b32 s49, s5
s_mov_b32 s50, 0x2000
s_mov_b32 s51, 0x20000
v_and_b32 v5, 15, v0
v_and_b32 v6, 16, v0
v_lshl_add_u32 v5, v6, 1, v5
v_and_b32 v6, 32, v0
v_lshrrev_b32 v6, 1, v6
v_add_u32 v5, v5, v6
v_lshlrev_b32 v5, 1, v5
v_and_b32 v6, 0x7c, v5
s_lshl_b32 s65, s64, 7
s_and_b32 s66, s65, 0x380
s_lshr_b32 s64, s64, 3
s_mul_i32 s64, s64, 12288
s_add_u32 s64, s64, s66
s_add_u32 s64, s64, 24576
buffer_load_ushort v18, v5, s[48:51], s65 offen
s_mov_b32 s75, 0
L_poll_175:
buffer_load_dword v19, v6, s[36:39], s64 offen offset:0 sc1
buffer_load_dword v20, v6, s[36:39], s64 offen offset:3072 sc1
s_waitcnt vmcnt(0)
v_max_u32 v16, v19, v20
v_cmp_eq_u32 vcc, -1, v16
s_cbranch_vccz L_pollx_176
s_sleep 40
s_add_u32 s75, s75, 1
s_cmp_lt_u32 s75, 0x100000
s_cbranch_scc1 L_poll_175
L_pollx_176:
v_and_b32 v16, 1, v0
v_lshlrev_b32 v16, 4, v16
v_xor_b32 v16, 16, v16
v_lshlrev_b32 v18, 16, v18
v_lshlrev_b32 v19, v16, v19
v_and_b32 v19, 0xffff0000, v19
v_lshlrev_b32 v20, v16, v20
v_and_b32 v20, 0xffff0000, v20
ds_write_b32 v2, v18 offset:4096
ds_write_b32 v2, v19 offset:4352
ds_write_b32 v2, v20 offset:4608
L_rp_174:
v_lshlrev_b32 v10, 3, v0
s_lshl_b32 s64, s34, 8
s_add_u32 s64, s64, 2560
s_lshr_b32 s66, s68, 1
v_xor_b32 v12, s66, v0
v_mov_b32 v14, 0
v_bfe_u32 v11, v12, 0, 1
v_lshl_or_b32 v14, v11, 0, v14
v_bfe_u32 v11, v12, 1, 1
v_lshl_or_b32 v14, v11, 1, v14
v_bfe_u32 v11, v12, 2, 1
v_lshl_or_b32 v14, v11, 2, v14
v_bfe_u32 v11, v12, 3, 1
v_lshl_or_b32 v14, v11, 3, v14
v_bfe_u32 v11, v12, 4, 1
v_lshl_or_b32 v14, v11, 4, v14
v_bfe_u32 v11, v12, 5, 1
v_lshl_or_b32 v14, v11, 5, v14
v_and_b32 v11, 0x38, v14
v_and_b32 v12, 1, v14
v_lshl_add_u32 v11, v12, 2, v11
v_bfe_u32 v12, v14, 1, 2
v_add_u32 v11, v11, v12
v_lshl_add_u32 v11, v11, 2, s64
v_and_b32 v14, 1, v0
v_and_b32 v12, 48, v0
v_lshlrev_b32 v12, 1, v12
v_lshl_add_u32 v12, v14, 4, v12
v_add_u32 v12, s64, v12
v_mul_u32_u24 v15, 0xaaaa, v14
v_add_u32 v15, 0x4444, v15
v_mov_b32 v64, 0
v_mov_b32 v65, 0
v_mov_b32 v66, 0
v_mov_b32 v67, 0
v_mov_b32 v68, 0
v_mov_b32 v69, 0
v_mov_b32 v70, 0
v_mov_b32 v71, 0
v_mov_b32 v72, 0
v_mov_b32 v73, 0
v_mov_b32 v74, 0
v_mov_b32 v75, 0
v_mov_b32 v76, 0
v_mov_b32 v77, 0
v_mov_b32 v78, 0
v_mov_b32 v79, 0
v_mov_b32 v80, 0
v_mov_b32 v81, 0
v_mov_b32 v82, 0
v_mov_b32 v83, 0
v_mov_b32 v84, 0
v_mov_b32 v85, 0
v_mov_b32 v86, 0
v_mov_b32 v87, 0
v_mov_b32 v88, 0
v_mov_b32 v89, 0
v_mov_b32 v90, 0
v_mov_b32 v91, 0
v_mov_b32 v92, 0
v_mov_b32 v93, 0
v_mov_b32 v94, 0
v_mov_b32 v95, 0
s_lshl_b32 s64, s34, 3
s_lshr_b32 s64, s35, s64
v_bfe_u32 v13, v0, 3, 1
v_lshlrev_b32 v13, 2, v13
v_bfe_u32 v13, s64, v13, 3
v_and_b32 v14, 0x70, v1
v_lshl_add_u32 v13, v13, 12, v14
s_lshl_b32 s64, s34, 2
s_add_u32 s64, s64, s33
v_bfe_u32 v14, v0, 3, 1
v_lshl_add_u32 v14, v14, 1, s64
v_and_b32 v14, 31, v14
v_lshl_add_u32 v13, v14, 7, v13
s_lshl_b32 s69, s32, 15
s_add_u32 s69, s69, 1048576
s_waitcnt vmcnt(0) lgkmcnt(0)
s_barrier
ds_read_b64 v[20:21], v10 offset:512
ds_read_b64 v[22:23], v10 offset:1024
ds_read_b64 v[24:25], v10 offset:1536
ds_read_b64 v[26:27], v10 offset:2048
s_waitcnt lgkmcnt(2)
v_pk_add_f32 v[20:21], v[20:21], v[22:23]
s_waitcnt lgkmcnt(1)
v_pk_add_f32 v[20:21], v[20:21], v[24:25]
s_waitcnt lgkmcnt(0)
v_pk_add_f32 v[20:21], v[20:21], v[26:27]
v_cvt_pk_bf16_f32 v20, v20, v21
ds_write_b32 v11, v20
ds_read_b128 v[48:51], v12 offset:0
ds_read_b128 v[52:55], v12 offset:128
s_waitcnt lgkmcnt(1)
v_smfmac_f32_16x16x64_bf16 v[64:67], v[48:51], v[128:135], v15
v_smfmac_f32_16x16x64_bf16 v[68:71], v[48:51], v[136:143], v15
v_smfmac_f32_16x16x64_bf16 v[72:75], v[48:51], v[144:151], v15
v_smfmac_f32_16x16x64_bf16 v[76:79], v[48:51], v[152:159], v15
s_waitcnt lgkmcnt(0)
v_smfmac_f32_16x16x64_bf16 v[64:67], v[52:55], v[192:199], v15
v_smfmac_f32_16x16x64_bf16 v[68:71], v[52:55], v[200:207], v15
v_smfmac_f32_16x16x64_bf16 v[72:75], v[52:55], v[208:215], v15
v_smfmac_f32_16x16x64_bf16 v[76:79], v[52:55], v[216:223], v15
v_smfmac_f32_16x16x64_bf16 v[80:83], v[48:51], v[160:167], v15
v_smfmac_f32_16x16x64_bf16 v[84:87], v[48:51], v[168:175], v15
v_smfmac_f32_16x16x64_bf16 v[88:91], v[48:51], v[176:183], v15
v_smfmac_f32_16x16x64_bf16 v[92:95], v[48:51], v[184:191], v15
v_smfmac_f32_16x16x64_bf16 v[80:83], v[52:55], v[224:231], v15
v_add_f32 v64, v64, v65
v_smfmac_f32_16x16x64_bf16 v[84:87], v[52:55], v[232:239], v15
v_add_f32 v68, v68, v69
v_add_f32 v72, v72, v73
v_smfmac_f32_16x16x64_bf16 v[88:91], v[52:55], v[240:247], v15
v_add_f32 v76, v76, v77
v_cvt_pk_bf16_f32 v20, v64, v68
v_smfmac_f32_16x16x64_bf16 v[92:95], v[52:55], v[248:255], v15
v_cvt_pk_bf16_f32 v21, v72, v76
v_add_f32 v80, v80, v81
s_mov_b64 exec, 0xffff
v_add_f32 v84, v84, v85
v_cvt_pk_bf16_f32 v22, v80, v84
s_nop 0
v_add_f32 v88, v88, v89
s_nop 0
v_add_f32 v92, v92, v93
v_cvt_pk_bf16_f32 v23, v88, v92
buffer_store_dwordx4 v[20:23], v13, s[36:39], s69 offen sc1
s_mov_b64 exec, -1
s_sub_u32 s67, s2, 16
s_cmp_lt_u32 s67, 128
s_cbranch_scc0 L_nogp
s_and_b32 s66, s2, 7
s_lshl_b32 s64, 1, s66
s_sub_u32 s64, s64, 1
s_and_b32 s64, s64, 42
s_bcnt1_i32_b32 s64, s64
s_mul_i32 s71, s66, 5
s_add_u32 s64, s64, s71
s_bitcmp1_b32 42, s66
s_cselect_b32 s66, 5, 4
v_and_b32 v8, 7, v0
v_min_u32 v8, s66, v8
v_add_u32 v8, s64, v8
s_and_b32 s64, s67, 0xf8
s_lshl_b32 s64, s64, 2
s_lshl_b32 s66, s34, 3
s_add_u32 s64, s64, s66
v_lshrrev_b32 v9, 3, v0
v_add_u32 v9, s64, v9
v_mul_u32_u24 v9, 2752, v9
v_lshl_add_u32 v8, v8, 6, v9
global_load_dword v10, v8, s[16:17]
global_load_dword v11, v8, s[18:19]
s_and_b32 s66, s2, 7
s_lshl_b32 s70, 1, s66
s_sub_u32 s70, s70, 1
s_and_b32 s70, s70, 42
s_bcnt1_i32_b32 s70, s70
s_mul_i32 s71, s66, 5
s_add_u32 s70, s70, s71
s_bitcmp1_b32 42, s66
s_cselect_b32 s66, 6, 5
s_lshl_b32 s66, s66, 8
s_sub_u32 s66, s66, 1
s_lshr_b32 s71, s67, 3
s_lshl_b32 s71, s71, 2
s_add_u32 s71, s71, s34
s_mul_i32 s71, s71, 24
v_min_u32 v12, 23, v0
v_add_u32 v12, s71, v12
v_min_u32 v12, s66, v12
s_lshl_b32 s70, s70, 15
v_lshl_add_u32 v12, v12, 7, s70
global_load_dword v13, v12, s[20:21]
s_endpgm
L_nogp:
L_tail_s:
s_cmp_eq_u32 s74, -1
s_cbranch_scc0 L_ffn
s_cmp_eq_u32 s3, 0
s_cbranch_scc0 L_fin
s_sub_u32 s70, s2, 144
s_cmp_lt_u32 s70, 64
s_cbranch_scc0 L_fin
s_lshl_b32 s64, s70, 2
s_lshr_b32 s67, s35, s64
s_and_b32 s71, s67, 7
s_andn2_b32 s66, s70, 7
s_add_u32 s66, s66, s71
s_lshl_b32 s66, s66, 12
s_add_u32 s66, s66, 1048576
buffer_load_dwordx4 v[16:19], v1, s[36:39], s66 offen offset:0 sc1
buffer_load_dwordx4 v[20:23], v1, s[36:39], s66 offen offset:1024 sc1
buffer_load_dwordx4 v[24:27], v1, s[36:39], s66 offen offset:2048 sc1
buffer_load_dwordx4 v[28:31], v1, s[36:39], s66 offen offset:3072 sc1
v_mov_b32 v32, -1
v_mov_b32 v33, -1
v_mov_b32 v34, -1
v_mov_b32 v35, -1
s_and_b32 s64, s71, 6
s_lshl_b32 s64, s64, 12
s_and_b32 s65, s71, 1
s_lshl_b32 s65, s65, 15
s_or_b32 s64, s64, s65
s_lshr_b32 s65, s70, 3
s_lshl_b32 s65, s65, 16
s_add_u32 s64, s64, s65
s_lshr_b32 s65, s70, 4
s_lshl_b32 s65, s65, 2
s_and_b32 s67, s70, 7
s_add_u32 s65, s65, s67
s_lshl_b32 s65, s65, 7
s_add_u32 s64, s64, s65
s_add_u32 s64, s64, 1376256
s_add_u32 s65, s64, 4096
buffer_store_dwordx4 v[32:35], v1, s[36:39], s64 offen offset:0 sc1
buffer_store_dwordx4 v[32:35], v1, s[36:39], s64 offen offset:1024 sc1
buffer_store_dwordx4 v[32:35], v1, s[36:39], s64 offen offset:2048 sc1
buffer_store_dwordx4 v[32:35], v1, s[36:39], s64 offen offset:3072 sc1
buffer_store_dwordx4 v[32:35], v1, s[36:39], s65 offen offset:0 sc1
s_mov_b64 exec, 0xffffff
buffer_store_dwordx4 v[32:35], v1, s[36:39], s65 offen offset:1024 sc1
s_mov_b64 exec, -1
v_lshlrev_b32 v2, 2, v0
ds_read_b32 v8, v2 offset:4096
ds_read_b32 v9, v2 offset:4352
ds_read_b32 v10, v2 offset:4608
s_mov_b32 s56, s26
s_mov_b32 s57, s27
s_mov_b32 s58, 0x2000
s_mov_b32 s59, 0x20000
v_and_b32 v5, 15, v0
v_and_b32 v6, 16, v0
v_lshl_add_u32 v5, v6, 1, v5
v_and_b32 v6, 32, v0
v_lshrrev_b32 v6, 1, v6
v_add_u32 v5, v5, v6
v_lshlrev_b32 v5, 1, v5
v_and_b32 v6, 0x7c, v5
s_lshl_b32 s73, s70, 7
v_and_b32 v11, 1, v0
v_lshlrev_b32 v3, 4, v11
v_mov_b32 v7, 0x3f80
v_lshlrev_b32 v7, v3, v7
v_and_b32 v2, 4, v0
v_cmp_eq_u32 vcc, 0, v2
v_bfe_u32 v2, v0, 1, 1
v_mul_u32_u24 v43, 0xaaaa, v2
v_add_u32 v43, 0x4444, v43
v_cndmask_b32 v44, 0, v7, vcc
v_sub_u32 v45, v7, v44
v_mov_b32 v46, v44
v_mov_b32 v47, v45
v_mov_b32 v48, 0
v_mov_b32 v49, 0
v_mov_b32 v50, 0
v_mov_b32 v51, 0
v_mov_b32 v52, 0
v_mov_b32 v53, 0
v_mov_b32 v54, 0
v_mov_b32 v55, 0
s_add_u32 s68, s73, 1310720
s_mov_b32 s76, 0xaaaaaaaa
s_mov_b32 s77, 0xaaaaaaaa
v_cmp_gt_u32 vcc, 24, v0
v_mov_b32 v41, 0x40000000
v_lshl_add_u32 v12, v11, 13, v6
v_cndmask_b32 v41, v41, v1, vcc
s_mov_b32 s75, 0
s_waitcnt vmcnt(0) lgkmcnt(0)
buffer_load_dwordx4 v[16:19], v1, s[36:39], s66 offen offset:0 sc1
buffer_load_dwordx4 v[20:23], v1, s[36:39], s66 offen offset:1024 sc1
buffer_load_dwordx4 v[24:27], v1, s[36:39], s66 offen offset:2048 sc1
buffer_load_dwordx4 v[28:31], v1, s[36:39], s66 offen offset:3072 sc1
s_sleep 1
buffer_load_dwordx4 v[16:19], v1, s[36:39], s66 offen offset:0 sc1
buffer_load_dwordx4 v[20:23], v1, s[36:39], s66 offen offset:1024 sc1
buffer_load_dwordx4 v[24:27], v1, s[36:39], s66 offen offset:2048 sc1
buffer_load_dwordx4 v[28:31], v1, s[36:39], s66 offen offset:3072 sc1
s_sleep 1
buffer_load_dwordx4 v[16:19], v1, s[36:39], s66 offen offset:0 sc1
buffer_load_dwordx4 v[20:23], v1, s[36:39], s66 offen offset:1024 sc1
buffer_load_dwordx4 v[24:27], v1, s[36:39], s66 offen offset:2048 sc1
buffer_load_dwordx4 v[28:31], v1, s[36:39], s66 offen offset:3072 sc1
s_sleep 1
L_rn_179:
v_smfmac_f32_16x16x64_bf16 v[48:51], v[44:47], v[16:23], v43
v_smfmac_f32_16x16x64_bf16 v[48:51], v[44:47], v[24:31], v43
buffer_load_dwordx4 v[16:19], v1, s[36:39], s66 offen offset:0 sc1
buffer_load_dwordx4 v[20:23], v1, s[36:39], s66 offen offset:1024 sc1
buffer_load_dwordx4 v[24:27], v1, s[36:39], s66 offen offset:2048 sc1
buffer_load_dwordx4 v[28:31], v1, s[36:39], s66 offen offset:3072 sc1
s_add_u32 s75, s75, 1
s_and_b32 s78, s75, 15
s_nop 1
v_add_f32_dpp v13, v48, v48 row_ror:8 row_mask:0x3 bank_mask:0x3
v_add_f32_dpp v13, v49, v49 row_ror:8 row_mask:0x3 bank_mask:0xc
v_add_f32_dpp v13, v50, v50 row_ror:8 row_mask:0xc bank_mask:0x3
v_add_f32_dpp v13, v51, v51 row_ror:8 row_mask:0xc bank_mask:0xc
v_cmp_u_f32 vcc, v13, v13
s_cbranch_vccz L_rz_180
v_mov_b32 v48, 0
v_mov_b32 v49, 0
v_mov_b32 v50, 0
v_mov_b32 v51, 0
s_waitcnt vmcnt(12)
s_cbranch_scc1 L_rn_179
v_max3_u32 v2, v16, v17, v18
v_max3_u32 v2, v2, v19, v20
v_max3_u32 v2, v2, v21, v22
v_max3_u32 v2, v2, v23, v24
v_max3_u32 v2, v2, v25, v26
v_max3_u32 v2, v2, v27, v28
v_max3_u32 v2, v2, v29, v30
v_max_u32 v2, v2, v31
v_cmp_eq_u32 vcc, -1, v2
s_cbranch_vccz L_rx_178
s_cmp_lt_u32 s75, 0x100000
s_cbranch_scc1 L_rn_179
L_rx_178:
v_smfmac_f32_16x16x64_bf16 v[48:51], v[44:47], v[16:23], v43
v_smfmac_f32_16x16x64_bf16 v[48:51], v[44:47], v[24:31], v43
s_nop 7
v_add_f32_dpp v13, v48, v48 row_ror:8 row_mask:0x3 bank_mask:0x3
v_add_f32_dpp v13, v49, v49 row_ror:8 row_mask:0x3 bank_mask:0xc
v_add_f32_dpp v13, v50, v50 row_ror:8 row_mask:0xc bank_mask:0x3
v_add_f32_dpp v13, v51, v51 row_ror:8 row_mask:0xc bank_mask:0xc
L_rz_180:
v_fmac_f32 v8, v13, v9
s_nop 1
v_mov_b32_dpp v14, v8 quad_perm:[1,1,3,3] row_mask:0xf bank_mask:0xf
v_mov_b32_dpp v13, v8 quad_perm:[0,0,2,2] row_mask:0xf bank_mask:0xf
v_cvt_pk_bf16_f32 v13, v13, v14
buffer_store_dword v13, v12, s[36:39], s68 offen sc1
v_cvt_pk_bf16_f32 v8, 0, v8
buffer_load_dwordx4 v[64:67], v1, s[36:39], s64 offen offset:0 sc1
buffer_load_dwordx4 v[68:71], v1, s[36:39], s64 offen offset:1024 sc1
buffer_load_dwordx4 v[72:75], v1, s[36:39], s64 offen offset:2048 sc1
buffer_load_dwordx4 v[76:79], v1, s[36:39], s64 offen offset:3072 sc1
buffer_load_dwordx4 v[80:83], v1, s[36:39], s65 offen offset:0 sc1
buffer_load_dwordx4 v[84:87], v41, s[36:39], s65 offen offset:1024 sc1
s_mov_b32 s75, 0
s_waitcnt vmcnt(0)
buffer_load_dwordx4 v[64:67], v1, s[36:39], s64 offen offset:0 sc1
buffer_load_dwordx4 v[68:71], v1, s[36:39], s64 offen offset:1024 sc1
buffer_load_dwordx4 v[72:75], v1, s[36:39], s64 offen offset:2048 sc1
buffer_load_dwordx4 v[76:79], v1, s[36:39], s64 offen offset:3072 sc1
buffer_load_dwordx4 v[80:83], v1, s[36:39], s65 offen offset:0 sc1
buffer_load_dwordx4 v[84:87], v41, s[36:39], s65 offen offset:1024 sc1
s_sleep 1
buffer_load_dwordx4 v[64:67], v1, s[36:39], s64 offen offset:0 sc1
buffer_load_dwordx4 v[68:71], v1, s[36:39], s64 offen offset:1024 sc1
buffer_load_dwordx4 v[72:75], v1, s[36:39], s64 offen offset:2048 sc1
buffer_load_dwordx4 v[76:79], v1, s[36:39], s64 offen offset:3072 sc1
buffer_load_dwordx4 v[80:83], v1, s[36:39], s65 offen offset:0 sc1
buffer_load_dwordx4 v[84:87], v41, s[36:39], s65 offen offset:1024 sc1
s_sleep 1
L_rn_183:
v_smfmac_f32_16x16x64_bf16 v[52:55], v[44:47], v[64:71], v43
v_smfmac_f32_16x16x64_bf16 v[52:55], v[44:47], v[72:79], v43
v_smfmac_f32_16x16x64_bf16 v[52:55], v[44:47], v[80:87], v43
buffer_load_dwordx4 v[64:67], v1, s[36:39], s64 offen offset:0 sc1
buffer_load_dwordx4 v[68:71], v1, s[36:39], s64 offen offset:1024 sc1
buffer_load_dwordx4 v[72:75], v1, s[36:39], s64 offen offset:2048 sc1
buffer_load_dwordx4 v[76:79], v1, s[36:39], s64 offen offset:3072 sc1
buffer_load_dwordx4 v[80:83], v1, s[36:39], s65 offen offset:0 sc1
buffer_load_dwordx4 v[84:87], v41, s[36:39], s65 offen offset:1024 sc1
s_add_u32 s75, s75, 1
s_and_b32 s78, s75, 15
v_add_f32_dpp v13, v52, v52 row_ror:8 row_mask:0x3 bank_mask:0x3
v_add_f32_dpp v13, v53, v53 row_ror:8 row_mask:0x3 bank_mask:0xc
v_add_f32_dpp v13, v54, v54 row_ror:8 row_mask:0xc bank_mask:0x3
v_add_f32_dpp v13, v55, v55 row_ror:8 row_mask:0xc bank_mask:0xc
v_cmp_u_f32 vcc, v13, v13
s_cbranch_vccz L_rz_184
v_mov_b32 v52, 0
v_mov_b32 v53, 0
v_mov_b32 v54, 0
v_mov_b32 v55, 0
s_waitcnt vmcnt(12)
s_cbranch_scc1 L_rn_183
v_max3_u32 v2, v64, v65, v66
v_max3_u32 v2, v2, v67, v68
v_max3_u32 v2, v2, v69, v70
v_max3_u32 v2, v2, v71, v72
v_max3_u32 v2, v2, v73, v74
v_max3_u32 v2, v2, v75, v76
v_max3_u32 v2, v2, v77, v78
v_max3_u32 v2, v2, v79, v80
v_max3_u32 v2, v2, v81, v82
v_max3_u32 v2, v2, v83, v84
v_max3_u32 v2, v2, v85, v86
v_max_u32 v2, v2, v87
v_cmp_eq_u32 vcc, -1, v2
s_cbranch_vccz L_rx_182
s_cmp_lt_u32 s75, 0x100000
s_cbranch_scc1 L_rn_183
L_rx_182:
v_smfmac_f32_16x16x64_bf16 v[52:55], v[44:47], v[64:71], v43
v_smfmac_f32_16x16x64_bf16 v[52:55], v[44:47], v[72:79], v43
v_smfmac_f32_16x16x64_bf16 v[52:55], v[44:47], v[80:87], v43
s_nop 7
v_add_f32_dpp v13, v52, v52 row_ror:8 row_mask:0x3 bank_mask:0x3
v_add_f32_dpp v13, v53, v53 row_ror:8 row_mask:0x3 bank_mask:0xc
v_add_f32_dpp v13, v54, v54 row_ror:8 row_mask:0xc bank_mask:0x3
v_add_f32_dpp v13, v55, v55 row_ror:8 row_mask:0xc bank_mask:0xc
L_rz_184:
v_fmac_f32 v8, v13, v10
s_nop 1
v_mov_b32_dpp v14, v8 quad_perm:[1,1,3,3] row_mask:0xf bank_mask:0xf
s_not_b64 exec, s[76:77]
v_cvt_pk_bf16_f32 v13, v8, v14
buffer_store_dword v13, v6, s[56:59], s73 offen sc1
s_mov_b64 exec, -1
s_cmp_lt_u32 s70, 8
s_cbranch_scc0 L_fin2
s_mov_b64 exec, 0xffff
buffer_store_dwordx4 v[44:47], v1, s[36:39], s62 offen sc1
s_mov_b64 exec, -1
L_fin2:
s_endpgm
L_ffn:
s_mul_i32 s67, s3, 12288
s_add_u32 s67, s67, 25600
v_lshlrev_b32 v7, 3, v0
buffer_load_dwordx4 v[8:11], v1, s[36:39], s67 offen offset:0 sc1
buffer_load_dwordx4 v[12:15], v1, s[36:39], s67 offen offset:1024 sc1
s_cmp_lt_u32 s3, 4
s_cbranch_scc1 L_post_185
s_mov_b32 s40, s16
s_mov_b32 s41, s17
s_mov_b32 s42, 0x158000
s_mov_b32 s43, 0x20000
s_mov_b32 s56, s18
s_mov_b32 s57, s19
s_mov_b32 s58, 0x158000
s_mov_b32 s59, 0x20000
v_lshrrev_b32 v16, 2, v0
v_mul_u32_u24 v16, 2752, v16
v_and_b32 v17, 3, v0
v_lshrrev_b32 v18, 5, v0
v_xor_b32 v17, v17, v18
v_xor_b32 v18, 2, v17
v_lshl_add_u32 v17, v17, 4, v16
v_lshl_add_u32 v18, v18, 4, v16
s_mul_i32 s64, s34, 352256
s_lshl_b32 s65, s74, 6
s_add_u32 s64, s64, s65
s_lshl_b32 s65, s34, 13
s_add_u32 m0, s65, 4096
s_add_u32 s66, s64, 0
buffer_load_dwordx4 v17, s[40:43], s66 offen  lds
s_add_u32 m0, s65, 36864
s_add_u32 s66, s64, 0
buffer_load_dwordx4 v18, s[56:59], s66 offen  lds
s_add_u32 m0, s65, 5120
s_add_u32 s66, s64, 44032
buffer_load_dwordx4 v17, s[40:43], s66 offen  lds
s_add_u32 m0, s65, 37888
s_add_u32 s66, s64, 44032
buffer_load_dwordx4 v18, s[56:59], s66 offen  lds
s_add_u32 m0, s65, 6144
s_add_u32 s66, s64, 88064
buffer_load_dwordx4 v17, s[40:43], s66 offen  lds
s_add_u32 m0, s65, 38912
s_add_u32 s66, s64, 88064
buffer_load_dwordx4 v18, s[56:59], s66 offen  lds
s_add_u32 m0, s65, 7168
s_add_u32 s66, s64, 132096
buffer_load_dwordx4 v17, s[40:43], s66 offen  lds
s_add_u32 m0, s65, 39936
s_add_u32 s66, s64, 132096
buffer_load_dwordx4 v18, s[56:59], s66 offen  lds
s_add_u32 m0, s65, 8192
s_add_u32 s66, s64, 176128
buffer_load_dwordx4 v17, s[40:43], s66 offen  lds
s_add_u32 m0, s65, 40960
s_add_u32 s66, s64, 176128
buffer_load_dwordx4 v18, s[56:59], s66 offen  lds
s_add_u32 m0, s65, 9216
s_add_u32 s66, s64, 220160
buffer_load_dwordx4 v17, s[40:43], s66 offen  lds
s_add_u32 m0, s65, 41984
s_add_u32 s66, s64, 220160
buffer_load_dwordx4 v18, s[56:59], s66 offen  lds
s_add_u32 m0, s65, 10240
s_add_u32 s66, s64, 264192
buffer_load_dwordx4 v17, s[40:43], s66 offen  lds
s_add_u32 m0, s65, 43008
s_add_u32 s66, s64, 264192
buffer_load_dwordx4 v18, s[56:59], s66 offen  lds
s_add_u32 m0, s65, 11264
s_add_u32 s66, s64, 308224
buffer_load_dwordx4 v17, s[40:43], s66 offen  lds
s_add_u32 m0, s65, 44032
s_add_u32 s66, s64, 308224
buffer_load_dwordx4 v18, s[56:59], s66 offen  lds
s_waitcnt vmcnt(16)
s_branch L_post_186
L_post_185:
s_waitcnt vmcnt(0)
L_post_186:
v_max3_u32 v16, v8, v9, v10
v_max3_u32 v16, v16, v11, v12
v_max3_u32 v16, v16, v13, v14
v_max_u32 v16, v16, v15
v_cmp_eq_u32 vcc, -1, v16
s_cbranch_vccz L_cb_187
s_mov_b32 s75, 0
L_poll_188:
buffer_load_dwordx4 v[8:11], v1, s[36:39], s67 offen offset:0 sc1
buffer_load_dwordx4 v[12:15], v1, s[36:39], s67 offen offset:1024 sc1
s_waitcnt vmcnt(0)
v_max3_u32 v16, v8, v9, v10
v_max3_u32 v16, v16, v11, v12
v_max3_u32 v16, v16, v13, v14
v_max_u32 v16, v16, v15
v_cmp_eq_u32 vcc, -1, v16
s_cbranch_vccz L_pollx_189
s_add_u32 s75, s75, 1
s_cmp_lt_u32 s75, 0x100000
s_cbranch_scc1 L_poll_188
L_pollx_189:
L_cb_187:
s_mov_b32 s68, 0xffff0000
v_lshlrev_b32 v24, 16, v8
v_and_b32 v25, s68, v8
v_lshlrev_b32 v32, 16, v12
v_and_b32 v33, s68, v12
v_lshlrev_b32 v26, 16, v9
v_and_b32 v27, s68, v9
v_lshlrev_b32 v34, 16, v13
v_and_b32 v35, s68, v13
v_lshlrev_b32 v28, 16, v10
v_and_b32 v29, s68, v10
v_lshlrev_b32 v36, 16, v14
v_and_b32 v37, s68, v14
v_lshlrev_b32 v30, 16, v11
v_and_b32 v31, s68, v11
v_lshlrev_b32 v38, 16, v15
v_and_b32 v39, s68, v15
v_add_f32 v32, 1.0, v32
v_add_f32 v33, 1.0, v33
v_add_f32 v34, 1.0, v34
v_add_f32 v35, 1.0, v35
v_add_f32 v36, 1.0, v36
v_add_f32 v37, 1.0, v37
v_add_f32 v38, 1.0, v38
v_add_f32 v39, 1.0, v39
v_lshrrev_b32 v2, 3, v0
v_bfe_u32 v3, v0, 1, 3
v_and_b32 v4, 3, v3
s_lshl_b32 s64, s3, 1
v_xor_b32 v3, s64, v3
v_lshlrev_b32 v5, 10, v2
v_lshl_add_u32 v5, v4, 8, v5
v_lshl_add_u32 v5, v3, 4, v5
v_and_b32 v4, 1, v0
v_lshl_add_u32 v5, v4, 3, v5
v_add_u32 v5, 69632, v5
v_xor_b32 v6, 16, v5
v_mul_u32_u24 v16, 0xaaaa, v4
v_add_u32 v16, 0x4444, v16
v_lshrrev_b32 v2, 4, v0
v_bfe_u32 v3, v0, 3, 1
v_xor_b32 v7, v2, v0
v_lshlrev_b32 v7, 4, v7
v_add_u32 v7, 69632, v7
v_xor_b32 v8, 64, v7
v_and_b32 v4, 7, v0
v_and_b32 v9, 0x38, v0
v_lshlrev_b32 v9, 3, v9
v_lshl_add_u32 v9, v4, 1, v9
s_lshl_b32 s64, s34, 4
v_add_u32 v9, s64, v9
v_and_b32 v10, 12, v0
v_lshlrev_b32 v10, 5, v10
v_and_b32 v4, 1, v0
v_lshl_add_u32 v10, v4, 6, v10
v_lshl_add_u32 v10, v2, 4, v10
v_mov_b32 v17, 0xbfb8aa3b
v_mov_b32 v64, 0
v_mov_b32 v65, 0
v_mov_b32 v66, 0
v_mov_b32 v67, 0
s_lshl_b32 s64, s34, 3
s_lshr_b32 s64, s35, s64
v_lshlrev_b32 v3, 2, v3
v_bfe_u32 v3, s64, v3, 3
v_and_b32 v11, 6, v3
v_lshlrev_b32 v11, 12, v11
v_and_b32 v3, 1, v3
v_lshl_add_u32 v11, v3, 15, v11
v_lshl_add_u32 v11, v2, 17, v11
v_and_b32 v4, 240, v1
v_add_u32 v11, v11, v4
v_lshl_add_u32 v11, v2, 9, v11
s_lshl_b32 s64, s34, 8
v_add_u32 v11, s64, v11
s_lshl_b32 s69, s74, 7
s_add_u32 s69, s69, 1376256
s_add_u32 s72, s69, 65536
s_lshl_b32 s64, s3, 10
s_lshl_b32 s65, s2, 2
s_lshr_b32 s65, s35, s65
s_and_b32 s65, s65, 2
s_lshl_b32 s65, s65, 12
s_add_u32 s64, s64, s65
s_add_u32 s64, s64, 1310720
v_mov_b32 v14, 0xbb000000
v_mov_b32 v15, 0x3b000000
v_lshrrev_b32 v18, 4, v0
v_bfe_u32 v19, v0, 2, 2
v_bfe_u32 v20, v0, 1, 1
v_and_b32 v22, 1, v18
v_lshl_add_u32 v22, v20, 1, v22
v_xor_b32 v22, s34, v22
v_lshlrev_b32 v22, 4, v22
v_lshl_add_u32 v22, v20, 15, v22
v_lshl_add_u32 v22, v18, 9, v22
v_lshl_add_u32 v22, v19, 6, v22
v_and_b32 v20, 1, v0
v_lshl_add_u32 v22, v20, 3, v22
v_add_u32 v22, 4096, v22
s_lshr_b32 s73, s3, 2
s_waitcnt vmcnt(0)
s_barrier
buffer_load_dwordx4 v[56:59], v1, s[36:39], s64 offen sc1
s_cmp_eq_u32 s73, 0
s_cbranch_scc1 L_gu_191
ds_read_b64_tr_b16 v[128:129], v22 offset:0
ds_read_b64_tr_b16 v[130:131], v22 offset:256
ds_read_b64_tr_b16 v[132:133], v22 offset:2048
ds_read_b64_tr_b16 v[134:135], v22 offset:2304
ds_read_b64_tr_b16 v[136:137], v22 offset:4096
ds_read_b64_tr_b16 v[138:139], v22 offset:4352
ds_read_b64_tr_b16 v[140:141], v22 offset:6144
ds_read_b64_tr_b16 v[142:143], v22 offset:6400
ds_read_b64_tr_b16 v[144:145], v22 offset:8192
ds_read_b64_tr_b16 v[146:147], v22 offset:8448
ds_read_b64_tr_b16 v[148:149], v22 offset:10240
s_waitcnt lgkmcnt(4)
ds_read_b64_tr_b16 v[150:151], v22 offset:10496
ds_read_b64_tr_b16 v[152:153], v22 offset:12288
ds_read_b64_tr_b16 v[154:155], v22 offset:12544
ds_read_b64_tr_b16 v[156:157], v22 offset:14336
ds_read_b64_tr_b16 v[158:159], v22 offset:14592
ds_read_b64_tr_b16 v[160:161], v22 offset:16384
ds_read_b64_tr_b16 v[162:163], v22 offset:16640
ds_read_b64_tr_b16 v[164:165], v22 offset:18432
ds_read_b64_tr_b16 v[166:167], v22 offset:18688
ds_read_b64_tr_b16 v[168:169], v22 offset:20480
ds_read_b64_tr_b16 v[170:171], v22 offset:20736
s_waitcnt lgkmcnt(4)
ds_read_b64_tr_b16 v[172:173], v22 offset:22528
ds_read_b64_tr_b16 v[174:175], v22 offset:22784
ds_read_b64_tr_b16 v[176:177], v22 offset:24576
ds_read_b64_tr_b16 v[178:179], v22 offset:24832
ds_read_b64_tr_b16 v[180:181], v22 offset:26624
ds_read_b64_tr_b16 v[182:183], v22 offset:26880
ds_read_b64_tr_b16 v[184:185], v22 offset:28672
ds_read_b64_tr_b16 v[186:187], v22 offset:28928
ds_read_b64_tr_b16 v[188:189], v22 offset:30720
ds_read_b64_tr_b16 v[190:191], v22 offset:30976
L_gu_191:
s_cmp_lt_u32 s3, 4
s_cbranch_scc0 L_dma_192
s_mov_b32 s48, s20
s_mov_b32 s49, s21
s_mov_b32 s50, 0x158000
s_mov_b32 s51, 0x20000
v_lshrrev_b32 v18, 4, v0
v_and_b32 v16, 15, v0
v_xor_b32 v16, v16, v18
v_xor_b32 v17, 4, v16
v_lshlrev_b32 v19, 10, v18
v_lshl_add_u32 v22, v16, 4, v19
v_lshl_add_u32 v23, v17, 4, v19
s_lshl_b32 s76, s74, 15
s_lshl_b32 s66, s34, 8
s_add_u32 s76, s76, s66
s_lshl_b32 s77, s34, 13
s_add_u32 s77, s77, 77824
v_bfe_u32 v19, v0, 2, 2
v_and_b32 v16, 2, v0
v_lshlrev_b32 v16, 2, v16
v_xor_b32 v16, v16, v19
v_and_b32 v17, 1, v18
v_lshlrev_b32 v17, 2, v17
v_xor_b32 v16, v16, v17
v_lshlrev_b32 v16, 4, v16
v_lshl_add_u32 v16, v18, 10, v16
v_lshl_add_u32 v16, v19, 8, v16
v_and_b32 v17, 1, v0
v_lshl_add_u32 v16, v17, 3, v16
v_add_u32 v68, s77, v16
v_xor_b32 v69, 16, v68
v_xor_b32 v70, 32, v68
v_xor_b32 v71, 48, v68
v_xor_b32 v72, 64, v68
v_xor_b32 v73, 80, v68
v_xor_b32 v74, 96, v68
v_xor_b32 v75, 112, v68
s_add_u32 m0, s77, 0
s_xor_b32 s66, s76, 0
buffer_load_dwordx4 v22, s[48:51], s66 offen  lds
s_add_u32 m0, s77, 1024
s_xor_b32 s66, s76, 8192
buffer_load_dwordx4 v23, s[48:51], s66 offen  lds
s_add_u32 m0, s77, 2048
s_xor_b32 s66, s76, 16384
buffer_load_dwordx4 v22, s[48:51], s66 offen  lds
s_add_u32 m0, s77, 3072
s_xor_b32 s66, s76, 24576
buffer_load_dwordx4 v23, s[48:51], s66 offen  lds
s_add_u32 m0, s77, 4096
s_xor_b32 s66, s76, 4096
buffer_load_dwordx4 v22, s[48:51], s66 offen  lds
s_add_u32 m0, s77, 5120
s_xor_b32 s66, s76, 12288
buffer_load_dwordx4 v23, s[48:51], s66 offen  lds
s_add_u32 m0, s77, 6144
s_xor_b32 s66, s76, 20480
buffer_load_dwordx4 v22, s[48:51], s66 offen  lds
s_waitcnt vmcnt(7)
s_branch L_dma_193
L_dma_192:
s_waitcnt vmcnt(0)
L_dma_193:
s_mov_b32 s73, 0x3f803f80
v_mov_b32 v20, 0
v_mov_b32 v21, 0
v_max3_u32 v12, v56, v57, v58
v_max_u32 v12, v12, v59
v_cmp_eq_u32 vcc, -1, v12
s_cbranch_vccz L_x_190
buffer_load_dwordx4 v[56:59], v1, s[36:39], s64 offen sc1
s_sleep 1
s_mov_b32 s75, 0
L_poll_194:
buffer_load_dwordx4 v[56:59], v1, s[36:39], s64 offen sc1
s_waitcnt vmcnt(1)
v_max3_u32 v12, v56, v57, v58
v_max_u32 v12, v12, v59
v_cmp_eq_u32 vcc, -1, v12
s_cbranch_vccz L_pollx_195
s_add_u32 s75, s75, 1
s_cmp_lt_u32 s75, 0x100000
s_cbranch_scc1 L_poll_194
L_pollx_195:
L_x_190:
v_dot2c_f32_bf16 v20, s73, v56
v_dot2c_f32_bf16 v21, v56, v56
v_dot2c_f32_bf16 v20, s73, v57
v_dot2c_f32_bf16 v21, v57, v57
v_dot2c_f32_bf16 v20, s73, v58
v_dot2c_f32_bf16 v21, v58, v58
v_dot2c_f32_bf16 v20, s73, v59
v_dot2c_f32_bf16 v21, v59, v59
v_lshlrev_b32 v40, 16, v56
v_and_b32 v41, s68, v56
v_lshlrev_b32 v42, 16, v57
v_permlane32_swap_b32 v20, v21
v_add_f32 v12, v20, v21
v_and_b32 v43, s68, v57
v_lshlrev_b32 v44, 16, v58
v_add_f32_dpp v12, v12, v12 quad_perm:[1,0,3,2] row_mask:0xf bank_mask:0xf
v_and_b32 v45, s68, v58
v_lshlrev_b32 v46, 16, v59
v_add_f32_dpp v12, v12, v12 quad_perm:[2,3,0,1] row_mask:0xf bank_mask:0xf
v_and_b32 v47, s68, v59
v_pk_mul_f32 v[48:49], v[40:41], v[32:33]
v_add_f32_dpp v12, v12, v12 row_ror:4 row_mask:0xf bank_mask:0xf
v_pk_mul_f32 v[50:51], v[42:43], v[34:35]
v_pk_mul_f32 v[52:53], v[44:45], v[36:37]
v_add_f32_dpp v12, v12, v12 row_ror:8 row_mask:0xf bank_mask:0xf
v_pk_mul_f32 v[54:55], v[46:47], v[38:39]
s_nop 0
v_add_f32_dpp v12, v12, v12 row_bcast:15 row_mask:0xa bank_mask:0xf
s_nop 0
v_readlane_b32 s70, v12, 16
v_readlane_b32 s71, v12, 48
s_nop 0
v_mul_f32 v12, s70, v14
v_mul_f32 v13, s71, v15
v_fma_f32 v13, -v12, v12, v13
v_max_f32 v13, 0, v13
v_add_f32 v13, 0x3727c5ac, v13
v_rsq_f32 v2, v13
v_pk_fma_f32 v[48:49], v[12:13], v[32:33], v[48:49] op_sel_hi:[0,1,1]
v_pk_fma_f32 v[50:51], v[12:13], v[34:35], v[50:51] op_sel_hi:[0,1,1]
v_pk_fma_f32 v[52:53], v[12:13], v[36:37], v[52:53] op_sel_hi:[0,1,1]
v_pk_fma_f32 v[54:55], v[12:13], v[38:39], v[54:55] op_sel_hi:[0,1,1]
v_pk_fma_f32 v[24:25], v[2:3], v[48:49], v[24:25] op_sel_hi:[0,1,1]
v_pk_fma_f32 v[28:29], v[2:3], v[52:53], v[28:29] op_sel_hi:[0,1,1]
v_pk_fma_f32 v[26:27], v[2:3], v[50:51], v[26:27] op_sel_hi:[0,1,1]
v_pk_fma_f32 v[30:31], v[2:3], v[54:55], v[30:31] op_sel_hi:[0,1,1]
v_cvt_pk_bf16_f32 v40, v24, v25
v_cvt_pk_bf16_f32 v41, v28, v29
ds_write_b64 v5, v[40:41]
v_cvt_pk_bf16_f32 v42, v26, v27
v_cvt_pk_bf16_f32 v43, v30, v31
ds_write_b64 v6, v[42:43]
s_cmp_lt_u32 s3, 4
s_cbranch_scc0 L_dma_196
s_mov_b32 s48, s20
s_mov_b32 s49, s21
s_mov_b32 s50, 0x158000
s_mov_b32 s51, 0x20000
s_add_u32 m0, s77, 7168
s_xor_b32 s66, s76, 28672
buffer_load_dwordx4 v23, s[48:51], s66 offen  lds
L_dma_196:
s_cmp_lt_u32 s3, 4
s_waitcnt lgkmcnt(0)
s_barrier
s_cbranch_scc1 L_bar_fin
ds_read_b128 v[192:195], v7 offset:0
ds_read_b128 v[196:199], v8 offset:1024
ds_read_b128 v[200:203], v7 offset:2048
ds_read_b128 v[204:207], v8 offset:3072
ds_read_b128 v[208:211], v7 offset:4096
ds_read_b128 v[212:215], v8 offset:5120
ds_read_b128 v[216:219], v7 offset:6144
ds_read_b128 v[220:223], v8 offset:7168
s_waitcnt lgkmcnt(7)
v_smfmac_f32_16x16x64_bf16 v[64:67], v[192:195], v[128:135], v16
s_waitcnt lgkmcnt(6)
v_smfmac_f32_16x16x64_bf16 v[64:67], v[196:199], v[136:143], v16
s_waitcnt lgkmcnt(5)
v_smfmac_f32_16x16x64_bf16 v[64:67], v[200:203], v[144:151], v16
s_waitcnt lgkmcnt(4)
v_smfmac_f32_16x16x64_bf16 v[64:67], v[204:207], v[152:159], v16
s_waitcnt lgkmcnt(3)
v_smfmac_f32_16x16x64_bf16 v[64:67], v[208:211], v[160:167], v16
s_waitcnt lgkmcnt(2)
v_smfmac_f32_16x16x64_bf16 v[64:67], v[212:215], v[168:175], v16
s_waitcnt lgkmcnt(1)
v_smfmac_f32_16x16x64_bf16 v[64:67], v[216:219], v[176:183], v16
s_waitcnt lgkmcnt(0)
v_smfmac_f32_16x16x64_bf16 v[64:67], v[220:223], v[184:191], v16
s_nop 7
v_add_f32 v66, v66, v67
v_add_f32 v64, v64, v65
v_mul_f32 v18, v64, v17
v_mul_f32_dpp v18, v66, v17 row_ror:8 row_mask:0xf bank_mask:0xc
v_exp_f32 v18, v18
v_mov_b32_dpp v66, v64 row_ror:8 row_mask:0xf bank_mask:0x3
v_add_f32 v18, 1.0, v18
v_rcp_f32 v18, v18
s_nop 0
v_mul_f32 v18, v18, v66
v_cvt_pk_bf16_f32 v18, v18, v18
ds_write_b16 v9, v18 offset:3584
s_waitcnt lgkmcnt(0)
s_barrier
s_endpgm
L_bar_fin:
s_waitcnt vmcnt(0)
ds_read_b64_tr_b16 v[96:97], v68 offset:0
ds_read_b64_tr_b16 v[98:99], v68 offset:4096
ds_read_b64_tr_b16 v[100:101], v69 offset:0
ds_read_b64_tr_b16 v[102:103], v69 offset:4096
ds_read_b64_tr_b16 v[104:105], v70 offset:0
ds_read_b64_tr_b16 v[106:107], v70 offset:4096
ds_read_b64_tr_b16 v[108:109], v71 offset:0
ds_read_b64_tr_b16 v[110:111], v71 offset:4096
ds_read_b64_tr_b16 v[112:113], v72 offset:0
ds_read_b64_tr_b16 v[114:115], v72 offset:4096
ds_read_b64_tr_b16 v[116:117], v73 offset:0
s_waitcnt lgkmcnt(4)
ds_read_b64_tr_b16 v[118:119], v73 offset:4096
ds_read_b64_tr_b16 v[120:121], v74 offset:0
ds_read_b64_tr_b16 v[122:123], v74 offset:4096
ds_read_b64_tr_b16 v[124:125], v75 offset:0
ds_read_b64_tr_b16 v[126:127], v75 offset:4096
s_waitcnt lgkmcnt(0)
s_barrier
ds_read_b128 v[48:51], v10 offset:3584
s_waitcnt lgkmcnt(0)
v_mfma_f32_16x16x32_bf16 v[192:195], v[48:51], v[96:99], 0
v_mfma_f32_16x16x32_bf16 v[196:199], v[48:51], v[100:103], 0
v_mfma_f32_16x16x32_bf16 v[200:203], v[48:51], v[104:107], 0
s_nop 1
v_mfma_f32_16x16x32_bf16 v[204:207], v[48:51], v[108:111], 0
s_nop 1
v_mfma_f32_16x16x32_bf16 v[208:211], v[48:51], v[112:115], 0
s_nop 0
v_cvt_pk_bf16_f32 v16, v192, v196
v_mfma_f32_16x16x32_bf16 v[212:215], v[48:51], v[116:119], 0
v_cvt_pk_bf16_f32 v20, v193, v197
v_mfma_f32_16x16x32_bf16 v[216:219], v[48:51], v[120:123], 0
v_cvt_pk_bf16_f32 v17, v200, v204
v_cvt_pk_bf16_f32 v21, v201, v205
v_mfma_f32_16x16x32_bf16 v[220:223], v[48:51], v[124:127], 0
s_nop 2
v_cvt_pk_bf16_f32 v18, v208, v212
v_cvt_pk_bf16_f32 v22, v209, v213
s_nop 2
v_cvt_pk_bf16_f32 v19, v216, v220
buffer_store_dwordx4 v[16:19], v11, s[36:39], s69 offen sc1
v_cvt_pk_bf16_f32 v23, v217, v221
buffer_store_dwordx4 v[20:23], v11, s[36:39], s72 offen sc1
s_endpgm
s_endpgm
L_srest:
s_lshr_b32 s32, s2, 5
s_and_b32 s33, s2, 31
s_and_b32 s67, s2, 7
s_lshr_b32 s68, s2, 3
s_sub_u32 s68, s68, 26
s_lshl_b32 s74, 1, s67
s_sub_u32 s74, s74, 1
s_and_b32 s74, s74, 42
s_bcnt1_i32_b32 s74, s74
s_mul_i32 s66, s67, 5
s_add_u32 s74, s74, s66
s_add_u32 s74, s74, s68
s_bitcmp1_b32 42, s67
s_cselect_b32 s66, 6, 5
s_cmp_lt_u32 s68, s66
s_cselect_b32 s74, s74, -1
s_cmp_lt_u32 s2, 48
s_cselect_b32 s66, 2, 3
s_cselect_b32 s72, 14+26, 42+26
s_cmp_lt_u32 s2, 16
s_cselect_b32 s66, 1, s66
s_cselect_b32 s72, 26, s72
s_lshl_b32 s66, s67, s66
s_add_u32 s72, s72, s66
s_add_u32 s72, s72, s68
s_mov_b32 s36, s30
s_mov_b32 s37, s31
s_mov_b32 s38, 0x1d0000
s_mov_b32 s39, 0x20000
s_mov_b32 s52, s28
s_mov_b32 s53, s29
s_mov_b32 s54, 0x100
s_mov_b32 s55, 0x20000
s_mov_b32 s46, 0x40000
s_mov_b32 s47, 0x20000
s_cmp_eq_u32 s74, -1
s_mov_b32 s69, 30
s_cselect_b32 s69, 20, s69
s_cmp_lt_u32 s2, 144
s_cselect_b32 s69, 0, s69
s_cmp_lt_u32 s2, 112
s_cselect_b32 s69, 50, s69
s_cmp_lt_u32 s2, 48
s_cselect_b32 s69, 30, s69
s_cmp_lt_u32 s2, 16
s_cselect_b32 s69, 40, s69
s_and_b32 s66, s72, 7
s_cmp_eq_u32 s66, 3
s_cselect_b32 s66, 40, 0
s_cmp_lt_u32 s2, 112
s_cselect_b32 s66, s66, 0
s_add_u32 s69, s69, s66
s_xor_b32 s64, s65, 1024
s_cmpk_gt_u32 s69, 4
s_cbranch_scc1 L_d_1
s_waitcnt vmcnt(3)
L_d_1:
buffer_load_dwordx4 v[24:27], v1, s[40:43], s64 offen nt
s_xor_b32 s64, s65, 33792
s_cmpk_gt_u32 s69, 5
s_cbranch_scc1 L_d_2
s_waitcnt vmcnt(3)
L_d_2:
buffer_load_dwordx4 v[28:31], v1, s[40:43], s64 offen nt
s_xor_b32 s64, s65, 9216
s_cmpk_gt_u32 s69, 6
s_cbranch_scc1 L_d_3
s_waitcnt vmcnt(3)
L_d_3:
buffer_load_dwordx4 v[32:35], v1, s[40:43], s64 offen nt
s_xor_b32 s64, s65, 41984
s_cmpk_gt_u32 s69, 7
s_waitcnt vmcnt(6)
s_cbranch_scc1 L_d_4
s_waitcnt vmcnt(3)
L_d_4:
buffer_load_dwordx4 v[36:39], v1, s[40:43], s64 offen nt
s_xor_b32 s64, s65, 65536
s_cmpk_gt_u32 s69, 8
s_waitcnt vmcnt(6)
s_cbranch_scc1 L_d_5
s_waitcnt vmcnt(3)
L_d_5:
buffer_load_dwordx4 v[40:43], v1, s[40:43], s64 offen nt
s_xor_b32 s64, s65, 98304
s_cmpk_gt_u32 s69, 9
s_waitcnt vmcnt(6)
s_cbranch_scc1 L_d_6
s_waitcnt vmcnt(3)
L_d_6:
buffer_load_dwordx4 v[44:47], v1, s[40:43], s64 offen nt
s_xor_b32 s64, s65, 73728
s_cmpk_gt_u32 s69, 10
s_waitcnt vmcnt(6)
s_cbranch_scc1 L_d_7
s_waitcnt vmcnt(3)
L_d_7:
buffer_load_dwordx4 v[48:51], v1, s[40:43], s64 offen nt
s_xor_b32 s64, s65, 106496
s_cmpk_gt_u32 s69, 11
s_waitcnt vmcnt(6)
s_cbranch_scc1 L_d_8
s_waitcnt vmcnt(3)
L_d_8:
buffer_load_dwordx4 v[52:55], v1, s[40:43], s64 offen nt
s_xor_b32 s64, s65, 66560
s_cmpk_gt_u32 s69, 12
s_waitcnt vmcnt(6)
s_cbranch_scc1 L_d_9
s_waitcnt vmcnt(3)
L_d_9:
buffer_load_dwordx4 v[56:59], v1, s[40:43], s64 offen nt
s_xor_b32 s64, s65, 99328
s_cmpk_gt_u32 s69, 13
s_waitcnt vmcnt(6)
s_cbranch_scc1 L_d_10
s_waitcnt vmcnt(3)
L_d_10:
buffer_load_dwordx4 v[60:63], v1, s[40:43], s64 offen nt
s_xor_b32 s64, s65, 74752
s_cmpk_gt_u32 s69, 14
s_waitcnt vmcnt(6)
s_cbranch_scc1 L_d_11
s_waitcnt vmcnt(3)
L_d_11:
buffer_load_dwordx4 v[64:67], v1, s[40:43], s64 offen nt
s_xor_b32 s64, s65, 107520
s_cmpk_gt_u32 s69, 15
s_waitcnt vmcnt(6)
s_cbranch_scc1 L_d_12
s_waitcnt vmcnt(3)
L_d_12:
buffer_load_dwordx4 v[68:71], v1, s[40:43], s64 offen nt
s_xor_b32 s64, s65, 131072
s_cmpk_gt_u32 s69, 16
s_waitcnt vmcnt(6)
s_cbranch_scc1 L_d_13
s_waitcnt vmcnt(3)
L_d_13:
buffer_load_dwordx4 v[72:75], v1, s[40:43], s64 offen nt
s_xor_b32 s64, s65, 163840
s_cmpk_gt_u32 s69, 17
s_waitcnt vmcnt(6)
s_cbranch_scc1 L_d_14
s_waitcnt vmcnt(3)
L_d_14:
buffer_load_dwordx4 v[76:79], v1, s[40:43], s64 offen nt
s_xor_b32 s64, s65, 139264
s_cmpk_gt_u32 s69, 18
s_waitcnt vmcnt(6)
s_cbranch_scc1 L_d_15
s_waitcnt vmcnt(3)
L_d_15:
buffer_load_dwordx4 v[80:83], v1, s[40:43], s64 offen nt
s_xor_b32 s64, s65, 172032
s_cmpk_gt_u32 s69, 19
s_waitcnt vmcnt(6)
s_cbranch_scc1 L_d_16
s_waitcnt vmcnt(3)
L_d_16:
buffer_load_dwordx4 v[84:87], v1, s[40:43], s64 offen nt
s_xor_b32 s64, s65, 132096
s_cmpk_gt_u32 s69, 20
s_waitcnt vmcnt(6)
s_cbranch_scc1 L_d_17
s_waitcnt vmcnt(3)
L_d_17:
buffer_load_dwordx4 v[88:91], v1, s[40:43], s64 offen nt
s_xor_b32 s64, s65, 164864
s_cmpk_gt_u32 s69, 21
s_waitcnt vmcnt(6)
s_cbranch_scc1 L_d_18
s_waitcnt vmcnt(3)
L_d_18:
buffer_load_dwordx4 v[92:95], v1, s[40:43], s64 offen nt
s_xor_b32 s64, s65, 140288
s_cmpk_gt_u32 s69, 22
s_waitcnt vmcnt(6)
s_cbranch_scc1 L_d_19
s_waitcnt vmcnt(3)
L_d_19:
buffer_load_dwordx4 v[96:99], v1, s[40:43], s64 offen nt
s_xor_b32 s64, s65, 173056
s_cmpk_gt_u32 s69, 23
s_waitcnt vmcnt(6)
s_cbranch_scc1 L_d_20
s_waitcnt vmcnt(3)
L_d_20:
buffer_load_dwordx4 v[100:103], v1, s[40:43], s64 offen nt
s_xor_b32 s64, s65, 196608
s_cmpk_gt_u32 s69, 24
s_waitcnt vmcnt(6)
s_cbranch_scc1 L_d_21
s_waitcnt vmcnt(3)
L_d_21:
buffer_load_dwordx4 v[104:107], v1, s[40:43], s64 offen nt
s_xor_b32 s64, s65, 229376
s_cmpk_gt_u32 s69, 25
s_waitcnt vmcnt(6)
s_cbranch_scc1 L_d_22
s_waitcnt vmcnt(3)
L_d_22:
buffer_load_dwordx4 v[108:111], v1, s[40:43], s64 offen nt
s_xor_b32 s64, s65, 204800
s_cmpk_gt_u32 s69, 26
s_waitcnt vmcnt(6)
s_cbranch_scc1 L_d_23
s_waitcnt vmcnt(3)
L_d_23:
buffer_load_dwordx4 v[112:115], v1, s[40:43], s64 offen nt
s_xor_b32 s64, s65, 237568
s_cmpk_gt_u32 s69, 27
s_waitcnt vmcnt(6)
s_cbranch_scc1 L_d_24
s_waitcnt vmcnt(3)
L_d_24:
buffer_load_dwordx4 v[116:119], v1, s[40:43], s64 offen nt
s_xor_b32 s64, s65, 197632
s_cmpk_gt_u32 s69, 28
s_waitcnt vmcnt(6)
s_cbranch_scc1 L_d_25
s_waitcnt vmcnt(3)
L_d_25:
buffer_load_dwordx4 v[120:123], v1, s[40:43], s64 offen nt
s_xor_b32 s64, s65, 230400
s_cmpk_gt_u32 s69, 29
s_waitcnt vmcnt(6)
s_cbranch_scc1 L_d_26
s_waitcnt vmcnt(3)
L_d_26:
buffer_load_dwordx4 v[124:127], v1, s[40:43], s64 offen nt
s_xor_b32 s64, s65, 205824
s_cmpk_gt_u32 s69, 30
s_waitcnt vmcnt(6)
s_cbranch_scc1 L_d_27
s_waitcnt vmcnt(3)
L_d_27:
buffer_load_dwordx4 v[128:131], v1, s[40:43], s64 offen nt
s_xor_b32 s64, s65, 238592
s_cmpk_gt_u32 s69, 31
s_waitcnt vmcnt(6)
s_cbranch_scc1 L_d_28
s_waitcnt vmcnt(3)
L_d_28:
buffer_load_dwordx4 v[132:135], v1, s[40:43], s64 offen nt
s_xor_b32 s64, s65, 4096
s_cmpk_gt_u32 s69, 32
s_waitcnt vmcnt(6)
s_cbranch_scc1 L_d_29
s_waitcnt vmcnt(4)
L_d_29:
buffer_load_dwordx4 v[136:139], v1, s[40:43], s64 offen nt
s_xor_b32 s64, s65, 36864
s_cmpk_gt_u32 s69, 33
s_waitcnt vmcnt(6)
s_cbranch_scc1 L_d_30
s_waitcnt vmcnt(4)
L_d_30:
buffer_load_dwordx4 v[140:143], v1, s[40:43], s64 offen nt
s_xor_b32 s64, s65, 12288
s_cmpk_gt_u32 s69, 34
s_waitcnt vmcnt(6)
s_cbranch_scc1 L_d_31
s_waitcnt vmcnt(4)
L_d_31:
buffer_load_dwordx4 v[144:147], v1, s[40:43], s64 offen nt
s_xor_b32 s64, s65, 45056
s_cmpk_gt_u32 s69, 35
s_waitcnt vmcnt(6)
s_cbranch_scc1 L_d_32
s_waitcnt vmcnt(4)
L_d_32:
buffer_load_dwordx4 v[148:151], v1, s[40:43], s64 offen nt
s_xor_b32 s64, s65, 5120
s_cmpk_gt_u32 s69, 36
s_waitcnt vmcnt(6)
s_cbranch_scc1 L_d_33
s_waitcnt vmcnt(4)
L_d_33:
buffer_load_dwordx4 v[152:155], v1, s[40:43], s64 offen nt
s_xor_b32 s64, s65, 37888
s_cmpk_gt_u32 s69, 37
s_waitcnt vmcnt(6)
s_cbranch_scc1 L_d_34
s_waitcnt vmcnt(4)
L_d_34:
buffer_load_dwordx4 v[156:159], v1, s[40:43], s64 offen nt
s_xor_b32 s64, s65, 13312
s_cmpk_gt_u32 s69, 38
s_waitcnt vmcnt(6)
s_cbranch_scc1 L_d_35
s_waitcnt vmcnt(4)
L_d_35:
buffer_load_dwordx4 v[160:163], v1, s[40:43], s64 offen nt
s_xor_b32 s64, s65, 46080
s_cmpk_gt_u32 s69, 39
s_waitcnt vmcnt(6)
s_cbranch_scc1 L_d_36
s_waitcnt vmcnt(4)
L_d_36:
buffer_load_dwordx4 v[164:167], v1, s[40:43], s64 offen nt
s_xor_b32 s64, s65, 69632
s_cmpk_gt_u32 s69, 40
s_waitcnt vmcnt(6)
s_cbranch_scc1 L_d_37
s_waitcnt vmcnt(4)
L_d_37:
buffer_load_dwordx4 v[168:171], v1, s[40:43], s64 offen nt
s_xor_b32 s64, s65, 102400
s_cmpk_gt_u32 s69, 41
s_waitcnt vmcnt(6)
s_cbranch_scc1 L_d_38
s_waitcnt vmcnt(4)
L_d_38:
buffer_load_dwordx4 v[172:175], v1, s[40:43], s64 offen nt
s_xor_b32 s64, s65, 77824
s_cmpk_gt_u32 s69, 42
s_waitcnt vmcnt(6)
s_cbranch_scc1 L_d_39
s_waitcnt vmcnt(4)
L_d_39:
buffer_load_dwordx4 v[176:179], v1, s[40:43], s64 offen nt
s_xor_b32 s64, s65, 110592
s_cmpk_gt_u32 s69, 43
s_waitcnt vmcnt(6)
s_cbranch_scc1 L_d_40
s_waitcnt vmcnt(4)
L_d_40:
buffer_load_dwordx4 v[180:183], v1, s[40:43], s64 offen nt
s_xor_b32 s64, s65, 70656
s_cmpk_gt_u32 s69, 44
s_waitcnt vmcnt(6)
s_cbranch_scc1 L_d_41
s_waitcnt vmcnt(4)
L_d_41:
buffer_load_dwordx4 v[184:187], v1, s[40:43], s64 offen nt
s_xor_b32 s64, s65, 103424
s_cmpk_gt_u32 s69, 45
s_waitcnt vmcnt(6)
s_cbranch_scc1 L_d_42
s_waitcnt vmcnt(4)
L_d_42:
buffer_load_dwordx4 v[188:191], v1, s[40:43], s64 offen nt
s_xor_b32 s64, s65, 78848
s_cmpk_gt_u32 s69, 46
s_waitcnt vmcnt(6)
s_cbranch_scc1 L_d_43
s_waitcnt vmcnt(4)
L_d_43:
buffer_load_dwordx4 v[192:195], v1, s[40:43], s64 offen nt
s_xor_b32 s64, s65, 111616
s_cmpk_gt_u32 s69, 47
s_waitcnt vmcnt(6)
s_cbranch_scc1 L_d_44
s_waitcnt vmcnt(4)
L_d_44:
buffer_load_dwordx4 v[196:199], v1, s[40:43], s64 offen nt
s_xor_b32 s64, s65, 135168
s_cmpk_gt_u32 s69, 48
s_waitcnt vmcnt(6)
s_cbranch_scc1 L_d_45
s_waitcnt vmcnt(4)
L_d_45:
buffer_load_dwordx4 v[200:203], v1, s[40:43], s64 offen nt
s_xor_b32 s64, s65, 167936
s_cmpk_gt_u32 s69, 49
s_waitcnt vmcnt(6)
s_cbranch_scc1 L_d_46
s_waitcnt vmcnt(4)
L_d_46:
buffer_load_dwordx4 v[204:207], v1, s[40:43], s64 offen nt
s_xor_b32 s64, s65, 143360
s_cmpk_gt_u32 s69, 50
s_waitcnt vmcnt(6)
s_cbranch_scc1 L_d_47
s_waitcnt vmcnt(4)
L_d_47:
buffer_load_dwordx4 v[208:211], v1, s[40:43], s64 offen nt
s_xor_b32 s64, s65, 176128
s_cmpk_gt_u32 s69, 51
s_waitcnt vmcnt(6)
s_cbranch_scc1 L_d_48
s_waitcnt vmcnt(4)
L_d_48:
buffer_load_dwordx4 v[212:215], v1, s[40:43], s64 offen nt
s_xor_b32 s64, s65, 136192
s_cmpk_gt_u32 s69, 52
s_waitcnt vmcnt(6)
s_cbranch_scc1 L_d_49
s_waitcnt vmcnt(4)
L_d_49:
buffer_load_dwordx4 v[216:219], v1, s[40:43], s64 offen nt
s_xor_b32 s64, s65, 168960
s_cmpk_gt_u32 s69, 53
s_waitcnt vmcnt(6)
s_cbranch_scc1 L_d_50
s_waitcnt vmcnt(4)
L_d_50:
buffer_load_dwordx4 v[220:223], v1, s[40:43], s64 offen nt
s_xor_b32 s64, s65, 144384
s_cmpk_gt_u32 s69, 54
s_waitcnt vmcnt(6)
s_cbranch_scc1 L_d_51
s_waitcnt vmcnt(4)
L_d_51:
buffer_load_dwordx4 v[224:227], v1, s[40:43], s64 offen nt
s_xor_b32 s64, s65, 177152
s_cmpk_gt_u32 s69, 55
s_waitcnt vmcnt(6)
s_cbranch_scc1 L_d_52
s_waitcnt vmcnt(4)
L_d_52:
buffer_load_dwordx4 v[228:231], v1, s[40:43], s64 offen nt
s_cmp_eq_u32 s74, -1
s_mov_b32 s69, 64
s_cselect_b32 s69, 64, s69
s_cmp_lt_u32 s2, 144
s_cselect_b32 s69, 112, s69
s_cmp_lt_u32 s2, 112
s_cselect_b32 s69, 0, s69
s_cmp_lt_u32 s2, 48
s_cselect_b32 s69, 72, s69
s_cmp_lt_u32 s2, 16
s_cselect_b32 s69, 112, s69
s_xor_b32 s64, s65, 200704
s_cmpk_gt_u32 s69, 56
s_waitcnt vmcnt(6)
s_cbranch_scc1 L_d_53
s_waitcnt vmcnt(4)
L_d_53:
buffer_load_dwordx4 v[232:235], v1, s[40:43], s64 offen nt
s_xor_b32 s64, s65, 233472
s_cmpk_gt_u32 s69, 57
s_waitcnt vmcnt(6)
s_cbranch_scc1 L_d_54
s_waitcnt vmcnt(4)
L_d_54:
buffer_load_dwordx4 v[236:239], v1, s[40:43], s64 offen nt
s_xor_b32 s64, s65, 208896
s_cmpk_gt_u32 s69, 58
s_waitcnt vmcnt(6)
s_cbranch_scc1 L_d_55
s_waitcnt vmcnt(4)
L_d_55:
buffer_load_dwordx4 v[240:243], v1, s[40:43], s64 offen nt
v_and_b32 v2, 31, v0
v_lshlrev_b32 v2, 2, v2
buffer_load_dword v3, v2, s[52:55], 0 offen offset:128
s_xor_b32 s64, s65, 241664
s_cmpk_gt_u32 s69, 59
s_waitcnt vmcnt(6)
s_cbranch_scc1 L_d_56
s_waitcnt vmcnt(4)
L_d_56:
buffer_load_dwordx4 v[244:247], v1, s[40:43], s64 offen nt
s_xor_b32 s64, s65, 201728
s_cmpk_gt_u32 s69, 60
s_waitcnt vmcnt(6)
s_cbranch_scc1 L_d_57
s_waitcnt vmcnt(4)
L_d_57:
buffer_load_dwordx4 v[248:251], v1, s[40:43], s64 offen nt
s_xor_b32 s64, s65, 234496
s_cmpk_gt_u32 s69, 61
s_waitcnt vmcnt(6)
s_cbranch_scc1 L_d_58
s_waitcnt vmcnt(4)
L_d_58:
buffer_load_dwordx4 v[252:255], v1, s[40:43], s64 offen nt
s_mul_i32 s70, s34, 15360
s_add_u32 s70, s70, 69632
s_add_u32 m0, s70, 0
s_xor_b32 s64, s65, 209920
s_cmpk_gt_u32 s69, 62
s_waitcnt vmcnt(6)
s_cbranch_scc1 L_d_59
s_waitcnt vmcnt(4)
L_d_59:
buffer_load_dwordx4 v1, s[40:43], s64 offen nt lds
s_add_u32 m0, s70, 1024
s_xor_b32 s64, s65, 242688
s_cmpk_gt_u32 s69, 63
s_waitcnt vmcnt(6)
s_cbranch_scc1 L_d_60
s_waitcnt vmcnt(4)
L_d_60:
buffer_load_dwordx4 v1, s[40:43], s64 offen nt lds
s_add_u32 m0, s70, 2048
s_xor_b32 s64, s65, 0
s_cmpk_gt_u32 s69, 64
s_waitcnt vmcnt(6)
s_cbranch_scc1 L_d_61
s_waitcnt vmcnt(4)
L_d_61:
buffer_load_dwordx4 v1, s[44:47], s64 offen nt lds
s_add_u32 m0, s70, 3072
s_xor_b32 s64, s65, 32768
s_cmpk_gt_u32 s69, 65
s_waitcnt vmcnt(6)
s_cbranch_scc1 L_d_62
s_waitcnt vmcnt(4)
L_d_62:
buffer_load_dwordx4 v1, s[44:47], s64 offen nt lds
s_add_u32 m0, s70, 4096
s_xor_b32 s64, s65, 4096
s_cmpk_gt_u32 s69, 66
s_waitcnt vmcnt(6)
s_cbranch_scc1 L_d_63
s_waitcnt vmcnt(4)
L_d_63:
buffer_load_dwordx4 v1, s[44:47], s64 offen nt lds
s_add_u32 m0, s70, 5120
s_xor_b32 s64, s65, 36864
s_cmpk_gt_u32 s69, 67
s_waitcnt vmcnt(6)
s_cbranch_scc1 L_d_64
s_waitcnt vmcnt(4)
L_d_64:
buffer_load_dwordx4 v1, s[44:47], s64 offen nt lds
v_cmp_eq_u32 vcc, 0, v3
s_cbranch_vccz L_jf_66
s_mov_b32 s75, 0
L_poll_67:
v_and_b32 v2, 31, v0
v_lshlrev_b32 v2, 2, v2
buffer_load_dword v3, v2, s[52:55], 0 offen offset:128 sc1
s_waitcnt vmcnt(0)
v_cmp_eq_u32 vcc, 0, v3
s_cbranch_vccz L_pollx_68
s_sleep 40
s_add_u32 s75, s75, 1
s_cmp_lt_u32 s75, 0x100000
s_cbranch_scc1 L_poll_67
L_pollx_68:
L_jf_66:
s_mul_i32 s68, s32, 12288
s_lshl_b32 s67, s33, 8
s_add_u32 s68, s68, s67
s_add_u32 s68, s68, 16384
v_and_b32 v2, 0xf0, v1
buffer_load_dwordx4 v[4:7], v2, s[36:39], s68 offen sc1
s_add_u32 m0, s70, 6144
s_xor_b32 s64, s65, 8192
s_cmpk_gt_u32 s69, 68
s_waitcnt vmcnt(6)
s_cbranch_scc1 L_d_65
s_waitcnt vmcnt(4)
L_d_65:
buffer_load_dwordx4 v1, s[44:47], s64 offen nt lds
s_add_u32 m0, s70, 7168
s_xor_b32 s64, s65, 40960
s_cmpk_gt_u32 s69, 69
s_waitcnt vmcnt(6)
s_cbranch_scc1 L_d_69
s_waitcnt vmcnt(4)
L_d_69:
buffer_load_dwordx4 v1, s[44:47], s64 offen nt lds
s_add_u32 m0, s70, 8192
s_xor_b32 s64, s65, 12288
s_cmpk_gt_u32 s69, 70
s_waitcnt vmcnt(6)
s_cbranch_scc1 L_d_70
s_waitcnt vmcnt(4)
L_d_70:
buffer_load_dwordx4 v1, s[44:47], s64 offen nt lds
s_add_u32 m0, s70, 9216
s_xor_b32 s64, s65, 45056
s_cmpk_gt_u32 s69, 71
s_waitcnt vmcnt(6)
s_cbranch_scc1 L_d_71
s_waitcnt vmcnt(4)
L_d_71:
buffer_load_dwordx4 v1, s[44:47], s64 offen nt lds
s_add_u32 m0, s70, 10240
s_xor_b32 s64, s65, 65536
s_cmpk_gt_u32 s69, 72
s_waitcnt vmcnt(6)
s_cbranch_scc1 L_d_72
s_waitcnt vmcnt(4)
L_d_72:
buffer_load_dwordx4 v1, s[44:47], s64 offen nt lds
s_add_u32 m0, s70, 11264
s_xor_b32 s64, s65, 98304
s_cmpk_gt_u32 s69, 73
s_waitcnt vmcnt(6)
s_cbranch_scc1 L_d_73
s_waitcnt vmcnt(4)
L_d_73:
buffer_load_dwordx4 v1, s[44:47], s64 offen nt lds
s_add_u32 m0, s70, 12288
s_xor_b32 s64, s65, 69632
s_cmpk_gt_u32 s69, 74
s_waitcnt vmcnt(6)
s_cbranch_scc1 L_d_74
s_waitcnt vmcnt(4)
L_d_74:
buffer_load_dwordx4 v1, s[44:47], s64 offen nt lds
s_add_u32 m0, s70, 13312
s_xor_b32 s64, s65, 102400
s_cmpk_gt_u32 s69, 75
s_waitcnt vmcnt(6)
s_cbranch_scc1 L_d_75
s_waitcnt vmcnt(4)
L_d_75:
buffer_load_dwordx4 v1, s[44:47], s64 offen nt lds
s_add_u32 m0, s70, 14336
s_xor_b32 s64, s65, 73728
s_cmpk_gt_u32 s69, 76
s_waitcnt vmcnt(6)
s_cbranch_scc1 L_d_76
s_waitcnt vmcnt(4)
L_d_76:
buffer_load_dwordx4 v1, s[44:47], s64 offen nt lds
v_max3_u32 v3, v4, v5, v6
v_max_u32 v3, v3, v7
v_cmp_eq_u32 vcc, -1, v3
s_cbranch_vccz L_q_77
s_mov_b32 s75, 0
L_poll_78:
s_mul_i32 s68, s32, 12288
s_lshl_b32 s67, s33, 8
s_add_u32 s68, s68, s67
s_add_u32 s68, s68, 16384
v_and_b32 v2, 0xf0, v1
buffer_load_dwordx4 v[4:7], v2, s[36:39], s68 offen sc1
s_waitcnt vmcnt(0)
v_max3_u32 v3, v4, v5, v6
v_max_u32 v3, v3, v7
v_cmp_eq_u32 vcc, -1, v3
s_cbranch_vccz L_pollx_79
s_add_u32 s75, s75, 1
s_cmp_lt_u32 s75, 0x100000
s_cbranch_scc1 L_poll_78
L_pollx_79:
L_q_77:
s_mov_b32 s66, 0x3db504f3
v_dot2_f32_bf16 v8, v8, v4, 0
v_dot2_f32_bf16 v12, v12, v4, 0
v_dot2_f32_bf16 v16, v16, v4, 0
v_dot2_f32_bf16 v20, v20, v4, 0
v_dot2c_f32_bf16 v8, v9, v5
v_dot2c_f32_bf16 v12, v13, v5
v_dot2c_f32_bf16 v16, v17, v5
v_dot2c_f32_bf16 v20, v21, v5
v_dot2c_f32_bf16 v8, v10, v6
v_dot2c_f32_bf16 v12, v14, v6
v_dot2c_f32_bf16 v16, v18, v6
v_dot2c_f32_bf16 v20, v22, v6
v_dot2c_f32_bf16 v8, v11, v7
v_dot2c_f32_bf16 v12, v15, v7
v_dot2c_f32_bf16 v16, v19, v7
v_dot2c_f32_bf16 v20, v23, v7
v_add_f32_dpp v9, v8, v8 row_ror:8 row_mask:0xf bank_mask:0x3
v_add_f32_dpp v13, v12, v12 row_ror:8 row_mask:0xf bank_mask:0x3
v_add_f32_dpp v9, v16, v16 row_ror:8 row_mask:0xf bank_mask:0xc
v_add_f32_dpp v13, v20, v20 row_ror:8 row_mask:0xf bank_mask:0xc
s_nop 0
v_add_f32_dpp v17, v9, v9 row_shl:4 row_mask:0xf bank_mask:0x5
v_add_f32_dpp v17, v13, v13 row_shr:4 row_mask:0xf bank_mask:0xa
s_nop 1
v_add_f32_dpp v17, v17, v17 quad_perm:[1,0,3,2] row_mask:0xf bank_mask:0xf
s_nop 1
v_add_f32_dpp v17, v17, v17 quad_perm:[2,3,0,1] row_mask:0xf bank_mask:0xf
v_cvt_pk_bf16_f32 v17, 0, v17
v_mul_f32 v17, s66, v17
v_cvt_pk_bf16_f32 v17, 0, v17
v_dot2_f32_bf16 v24, v24, v4, 0
v_dot2_f32_bf16 v28, v28, v4, 0
v_dot2_f32_bf16 v32, v32, v4, 0
v_dot2_f32_bf16 v36, v36, v4, 0
v_dot2c_f32_bf16 v24, v25, v5
v_dot2c_f32_bf16 v28, v29, v5
v_dot2c_f32_bf16 v32, v33, v5
v_dot2c_f32_bf16 v36, v37, v5
v_dot2c_f32_bf16 v24, v26, v6
v_dot2c_f32_bf16 v28, v30, v6
v_dot2c_f32_bf16 v32, v34, v6
v_dot2c_f32_bf16 v36, v38, v6
v_dot2c_f32_bf16 v24, v27, v7
v_dot2c_f32_bf16 v28, v31, v7
v_dot2c_f32_bf16 v32, v35, v7
v_dot2c_f32_bf16 v36, v39, v7
v_add_f32_dpp v25, v24, v24 row_ror:8 row_mask:0xf bank_mask:0x3
v_add_f32_dpp v29, v28, v28 row_ror:8 row_mask:0xf bank_mask:0x3
v_add_f32_dpp v25, v32, v32 row_ror:8 row_mask:0xf bank_mask:0xc
v_add_f32_dpp v29, v36, v36 row_ror:8 row_mask:0xf bank_mask:0xc
s_nop 0
v_add_f32_dpp v8, v25, v25 row_shl:4 row_mask:0xf bank_mask:0x5
v_add_f32_dpp v8, v29, v29 row_shr:4 row_mask:0xf bank_mask:0xa
s_nop 1
v_add_f32_dpp v8, v8, v8 quad_perm:[1,0,3,2] row_mask:0xf bank_mask:0xf
s_nop 1
v_add_f32_dpp v8, v8, v8 quad_perm:[2,3,0,1] row_mask:0xf bank_mask:0xf
v_cvt_pk_bf16_f32 v8, 0, v8
v_mul_f32 v8, s66, v8
v_cvt_pk_bf16_f32 v8, 0, v8
s_xor_b32 s64, s65, 106496
s_cmpk_gt_u32 s69, 77
s_waitcnt vmcnt(6)
s_cbranch_scc1 L_d_80
s_waitcnt vmcnt(4)
L_d_80:
buffer_load_dwordx4 v[24:27], v1, s[44:47], s64 offen nt
v_dot2_f32_bf16 v40, v40, v4, 0
v_dot2_f32_bf16 v44, v44, v4, 0
v_dot2_f32_bf16 v48, v48, v4, 0
v_dot2_f32_bf16 v52, v52, v4, 0
v_dot2c_f32_bf16 v40, v41, v5
v_dot2c_f32_bf16 v44, v45, v5
v_dot2c_f32_bf16 v48, v49, v5
v_dot2c_f32_bf16 v52, v53, v5
v_dot2c_f32_bf16 v40, v42, v6
v_dot2c_f32_bf16 v44, v46, v6
v_dot2c_f32_bf16 v48, v50, v6
v_dot2c_f32_bf16 v52, v54, v6
v_dot2c_f32_bf16 v40, v43, v7
v_dot2c_f32_bf16 v44, v47, v7
v_dot2c_f32_bf16 v48, v51, v7
v_dot2c_f32_bf16 v52, v55, v7
v_add_f32_dpp v41, v40, v40 row_ror:8 row_mask:0xf bank_mask:0x3
v_add_f32_dpp v45, v44, v44 row_ror:8 row_mask:0xf bank_mask:0x3
v_add_f32_dpp v41, v48, v48 row_ror:8 row_mask:0xf bank_mask:0xc
v_add_f32_dpp v45, v52, v52 row_ror:8 row_mask:0xf bank_mask:0xc
s_nop 0
v_add_f32_dpp v9, v41, v41 row_shl:4 row_mask:0xf bank_mask:0x5
v_add_f32_dpp v9, v45, v45 row_shr:4 row_mask:0xf bank_mask:0xa
s_nop 1
v_add_f32_dpp v9, v9, v9 quad_perm:[1,0,3,2] row_mask:0xf bank_mask:0xf
s_nop 1
v_add_f32_dpp v9, v9, v9 quad_perm:[2,3,0,1] row_mask:0xf bank_mask:0xf
v_cvt_pk_bf16_f32 v9, 0, v9
v_mul_f32 v9, s66, v9
v_cvt_pk_bf16_f32 v9, 0, v9
s_and_b32 s62, s2, 7
s_lshl_b32 s62, s62, 9
s_add_u32 s62, s62, 1327104
s_lshr_b32 s63, s2, 3
s_lshl_b32 s63, s63, 2
s_add_u32 s63, s63, s62
s_cmp_eq_u32 s34, 0
s_cbranch_scc0 L_w_82
v_mov_b32 v2, 14
s_mov_b64 exec, 1
buffer_store_dword v2, off, s[36:39], s63 offset:0
s_mov_b64 exec, -1
L_w_82:
s_xor_b32 s64, s65, 77824
s_cmpk_gt_u32 s69, 78
s_waitcnt vmcnt(6)
s_cbranch_scc1 L_d_81
s_waitcnt vmcnt(4)
L_d_81:
buffer_load_dwordx4 v[28:31], v1, s[44:47], s64 offen nt
v_dot2_f32_bf16 v56, v56, v4, 0
v_dot2_f32_bf16 v60, v60, v4, 0
v_dot2_f32_bf16 v64, v64, v4, 0
v_dot2_f32_bf16 v68, v68, v4, 0
v_dot2c_f32_bf16 v56, v57, v5
v_dot2c_f32_bf16 v60, v61, v5
v_dot2c_f32_bf16 v64, v65, v5
v_dot2c_f32_bf16 v68, v69, v5
v_dot2c_f32_bf16 v56, v58, v6
v_dot2c_f32_bf16 v60, v62, v6
v_dot2c_f32_bf16 v64, v66, v6
v_dot2c_f32_bf16 v68, v70, v6
v_dot2c_f32_bf16 v56, v59, v7
v_dot2c_f32_bf16 v60, v63, v7
v_dot2c_f32_bf16 v64, v67, v7
v_dot2c_f32_bf16 v68, v71, v7
v_add_f32_dpp v57, v56, v56 row_ror:8 row_mask:0xf bank_mask:0x3
v_add_f32_dpp v61, v60, v60 row_ror:8 row_mask:0xf bank_mask:0x3
v_add_f32_dpp v57, v64, v64 row_ror:8 row_mask:0xf bank_mask:0xc
v_add_f32_dpp v61, v68, v68 row_ror:8 row_mask:0xf bank_mask:0xc
s_nop 0
v_add_f32_dpp v10, v57, v57 row_shl:4 row_mask:0xf bank_mask:0x5
v_add_f32_dpp v10, v61, v61 row_shr:4 row_mask:0xf bank_mask:0xa
s_nop 1
v_add_f32_dpp v10, v10, v10 quad_perm:[1,0,3,2] row_mask:0xf bank_mask:0xf
s_nop 1
v_add_f32_dpp v10, v10, v10 quad_perm:[2,3,0,1] row_mask:0xf bank_mask:0xf
v_cvt_pk_bf16_f32 v10, 0, v10
v_mul_f32 v10, s66, v10
v_cvt_pk_bf16_f32 v10, 0, v10
s_xor_b32 s64, s65, 110592
s_cmpk_gt_u32 s69, 79
s_waitcnt vmcnt(6)
s_cbranch_scc1 L_d_83
s_waitcnt vmcnt(4)
L_d_83:
buffer_load_dwordx4 v[32:35], v1, s[44:47], s64 offen nt
v_dot2_f32_bf16 v72, v72, v4, 0
v_dot2_f32_bf16 v76, v76, v4, 0
v_dot2_f32_bf16 v80, v80, v4, 0
v_dot2_f32_bf16 v84, v84, v4, 0
v_dot2c_f32_bf16 v72, v73, v5
v_dot2c_f32_bf16 v76, v77, v5
v_dot2c_f32_bf16 v80, v81, v5
v_dot2c_f32_bf16 v84, v85, v5
v_dot2c_f32_bf16 v72, v74, v6
v_dot2c_f32_bf16 v76, v78, v6
v_dot2c_f32_bf16 v80, v82, v6
v_dot2c_f32_bf16 v84, v86, v6
v_dot2c_f32_bf16 v72, v75, v7
v_dot2c_f32_bf16 v76, v79, v7
v_dot2c_f32_bf16 v80, v83, v7
v_dot2c_f32_bf16 v84, v87, v7
v_add_f32_dpp v73, v72, v72 row_ror:8 row_mask:0xf bank_mask:0x3
v_add_f32_dpp v77, v76, v76 row_ror:8 row_mask:0xf bank_mask:0x3
v_add_f32_dpp v73, v80, v80 row_ror:8 row_mask:0xf bank_mask:0xc
v_add_f32_dpp v77, v84, v84 row_ror:8 row_mask:0xf bank_mask:0xc
s_nop 0
v_add_f32_dpp v11, v73, v73 row_shl:4 row_mask:0xf bank_mask:0x5
v_add_f32_dpp v11, v77, v77 row_shr:4 row_mask:0xf bank_mask:0xa
s_nop 1
v_add_f32_dpp v11, v11, v11 quad_perm:[1,0,3,2] row_mask:0xf bank_mask:0xf
s_nop 1
v_add_f32_dpp v11, v11, v11 quad_perm:[2,3,0,1] row_mask:0xf bank_mask:0xf
v_cvt_pk_bf16_f32 v11, 0, v11
v_mul_f32 v11, s66, v11
v_cvt_pk_bf16_f32 v11, 0, v11
s_xor_b32 s64, s65, 1024
s_cmpk_gt_u32 s69, 80
s_waitcnt vmcnt(6)
s_cbranch_scc1 L_d_84
s_waitcnt vmcnt(4)
L_d_84:
buffer_load_dwordx4 v[36:39], v1, s[44:47], s64 offen nt
v_dot2_f32_bf16 v88, v88, v4, 0
v_dot2_f32_bf16 v92, v92, v4, 0
v_dot2_f32_bf16 v96, v96, v4, 0
v_dot2_f32_bf16 v100, v100, v4, 0
v_dot2c_f32_bf16 v88, v89, v5
v_dot2c_f32_bf16 v92, v93, v5
v_dot2c_f32_bf16 v96, v97, v5
v_dot2c_f32_bf16 v100, v101, v5
v_dot2c_f32_bf16 v88, v90, v6
v_dot2c_f32_bf16 v92, v94, v6
v_dot2c_f32_bf16 v96, v98, v6
v_dot2c_f32_bf16 v100, v102, v6
v_dot2c_f32_bf16 v88, v91, v7
v_dot2c_f32_bf16 v92, v95, v7
v_dot2c_f32_bf16 v96, v99, v7
v_dot2c_f32_bf16 v100, v103, v7
v_add_f32_dpp v89, v88, v88 row_ror:8 row_mask:0xf bank_mask:0x3
v_add_f32_dpp v93, v92, v92 row_ror:8 row_mask:0xf bank_mask:0x3
v_add_f32_dpp v89, v96, v96 row_ror:8 row_mask:0xf bank_mask:0xc
v_add_f32_dpp v93, v100, v100 row_ror:8 row_mask:0xf bank_mask:0xc
s_nop 0
v_add_f32_dpp v12, v89, v89 row_shl:4 row_mask:0xf bank_mask:0x5
v_add_f32_dpp v12, v93, v93 row_shr:4 row_mask:0xf bank_mask:0xa
s_nop 1
v_add_f32_dpp v12, v12, v12 quad_perm:[1,0,3,2] row_mask:0xf bank_mask:0xf
s_nop 1
v_add_f32_dpp v12, v12, v12 quad_perm:[2,3,0,1] row_mask:0xf bank_mask:0xf
v_cvt_pk_bf16_f32 v12, 0, v12
v_mul_f32 v12, s66, v12
v_cvt_pk_bf16_f32 v12, 0, v12
s_xor_b32 s64, s65, 33792
s_cmpk_gt_u32 s69, 81
s_waitcnt vmcnt(6)
s_cbranch_scc1 L_d_85
s_waitcnt vmcnt(4)
L_d_85:
buffer_load_dwordx4 v[40:43], v1, s[44:47], s64 offen nt
v_dot2_f32_bf16 v104, v104, v4, 0
v_dot2_f32_bf16 v108, v108, v4, 0
v_dot2_f32_bf16 v112, v112, v4, 0
v_dot2_f32_bf16 v116, v116, v4, 0
v_dot2c_f32_bf16 v104, v105, v5
v_dot2c_f32_bf16 v108, v109, v5
v_dot2c_f32_bf16 v112, v113, v5
v_dot2c_f32_bf16 v116, v117, v5
v_dot2c_f32_bf16 v104, v106, v6
v_dot2c_f32_bf16 v108, v110, v6
v_dot2c_f32_bf16 v112, v114, v6
v_dot2c_f32_bf16 v116, v118, v6
v_dot2c_f32_bf16 v104, v107, v7
v_dot2c_f32_bf16 v108, v111, v7
v_dot2c_f32_bf16 v112, v115, v7
v_dot2c_f32_bf16 v116, v119, v7
v_add_f32_dpp v105, v104, v104 row_ror:8 row_mask:0xf bank_mask:0x3
v_add_f32_dpp v109, v108, v108 row_ror:8 row_mask:0xf bank_mask:0x3
v_add_f32_dpp v105, v112, v112 row_ror:8 row_mask:0xf bank_mask:0xc
v_add_f32_dpp v109, v116, v116 row_ror:8 row_mask:0xf bank_mask:0xc
s_nop 0
v_add_f32_dpp v13, v105, v105 row_shl:4 row_mask:0xf bank_mask:0x5
v_add_f32_dpp v13, v109, v109 row_shr:4 row_mask:0xf bank_mask:0xa
s_nop 1
v_add_f32_dpp v13, v13, v13 quad_perm:[1,0,3,2] row_mask:0xf bank_mask:0xf
s_nop 1
v_add_f32_dpp v13, v13, v13 quad_perm:[2,3,0,1] row_mask:0xf bank_mask:0xf
v_cvt_pk_bf16_f32 v13, 0, v13
v_mul_f32 v13, s66, v13
v_cvt_pk_bf16_f32 v13, 0, v13
s_xor_b32 s64, s65, 5120
s_cmpk_gt_u32 s69, 82
s_waitcnt vmcnt(6)
s_cbranch_scc1 L_d_86
s_waitcnt vmcnt(4)
L_d_86:
buffer_load_dwordx4 v[44:47], v1, s[44:47], s64 offen nt
v_dot2_f32_bf16 v120, v120, v4, 0
v_dot2_f32_bf16 v124, v124, v4, 0
v_dot2_f32_bf16 v128, v128, v4, 0
v_dot2_f32_bf16 v132, v132, v4, 0
v_dot2c_f32_bf16 v120, v121, v5
v_dot2c_f32_bf16 v124, v125, v5
v_dot2c_f32_bf16 v128, v129, v5
v_dot2c_f32_bf16 v132, v133, v5
v_dot2c_f32_bf16 v120, v122, v6
v_dot2c_f32_bf16 v124, v126, v6
v_dot2c_f32_bf16 v128, v130, v6
v_dot2c_f32_bf16 v132, v134, v6
v_dot2c_f32_bf16 v120, v123, v7
v_dot2c_f32_bf16 v124, v127, v7
v_dot2c_f32_bf16 v128, v131, v7
v_dot2c_f32_bf16 v132, v135, v7
v_add_f32_dpp v121, v120, v120 row_ror:8 row_mask:0xf bank_mask:0x3
v_add_f32_dpp v125, v124, v124 row_ror:8 row_mask:0xf bank_mask:0x3
v_add_f32_dpp v121, v128, v128 row_ror:8 row_mask:0xf bank_mask:0xc
v_add_f32_dpp v125, v132, v132 row_ror:8 row_mask:0xf bank_mask:0xc
s_nop 0
v_add_f32_dpp v14, v121, v121 row_shl:4 row_mask:0xf bank_mask:0x5
v_add_f32_dpp v14, v125, v125 row_shr:4 row_mask:0xf bank_mask:0xa
s_nop 1
v_add_f32_dpp v14, v14, v14 quad_perm:[1,0,3,2] row_mask:0xf bank_mask:0xf
s_nop 1
v_add_f32_dpp v14, v14, v14 quad_perm:[2,3,0,1] row_mask:0xf bank_mask:0xf
v_cvt_pk_bf16_f32 v14, 0, v14
v_mul_f32 v14, s66, v14
v_cvt_pk_bf16_f32 v14, 0, v14
s_xor_b32 s64, s65, 37888
s_cmpk_gt_u32 s69, 83
s_waitcnt vmcnt(6)
s_cbranch_scc1 L_d_87
s_waitcnt vmcnt(4)
L_d_87:
buffer_load_dwordx4 v[48:51], v1, s[44:47], s64 offen nt
v_dot2_f32_bf16 v136, v136, v4, 0
v_dot2_f32_bf16 v140, v140, v4, 0
v_dot2_f32_bf16 v144, v144, v4, 0
v_dot2_f32_bf16 v148, v148, v4, 0
v_dot2c_f32_bf16 v136, v137, v5
v_dot2c_f32_bf16 v140, v141, v5
v_dot2c_f32_bf16 v144, v145, v5
v_dot2c_f32_bf16 v148, v149, v5
v_dot2c_f32_bf16 v136, v138, v6
v_dot2c_f32_bf16 v140, v142, v6
v_dot2c_f32_bf16 v144, v146, v6
v_dot2c_f32_bf16 v148, v150, v6
v_dot2c_f32_bf16 v136, v139, v7
v_dot2c_f32_bf16 v140, v143, v7
v_dot2c_f32_bf16 v144, v147, v7
v_dot2c_f32_bf16 v148, v151, v7
v_add_f32_dpp v137, v136, v136 row_ror:8 row_mask:0xf bank_mask:0x3
v_add_f32_dpp v141, v140, v140 row_ror:8 row_mask:0xf bank_mask:0x3
v_add_f32_dpp v137, v144, v144 row_ror:8 row_mask:0xf bank_mask:0xc
v_add_f32_dpp v141, v148, v148 row_ror:8 row_mask:0xf bank_mask:0xc
s_nop 0
v_add_f32_dpp v15, v137, v137 row_shl:4 row_mask:0xf bank_mask:0x5
v_add_f32_dpp v15, v141, v141 row_shr:4 row_mask:0xf bank_mask:0xa
s_nop 1
v_add_f32_dpp v15, v15, v15 quad_perm:[1,0,3,2] row_mask:0xf bank_mask:0xf
s_nop 1
v_add_f32_dpp v15, v15, v15 quad_perm:[2,3,0,1] row_mask:0xf bank_mask:0xf
v_cvt_pk_bf16_f32 v15, 0, v15
v_mul_f32 v15, s66, v15
v_cvt_pk_bf16_f32 v15, 0, v15
s_xor_b32 s64, s65, 9216
s_cmpk_gt_u32 s69, 84
s_waitcnt vmcnt(6)
s_cbranch_scc1 L_d_88
s_waitcnt vmcnt(4)
L_d_88:
buffer_load_dwordx4 v[52:55], v1, s[44:47], s64 offen nt
v_dot2_f32_bf16 v152, v152, v4, 0
v_dot2_f32_bf16 v156, v156, v4, 0
v_dot2_f32_bf16 v160, v160, v4, 0
v_dot2_f32_bf16 v164, v164, v4, 0
v_dot2c_f32_bf16 v152, v153, v5
v_dot2c_f32_bf16 v156, v157, v5
v_dot2c_f32_bf16 v160, v161, v5
v_dot2c_f32_bf16 v164, v165, v5
v_dot2c_f32_bf16 v152, v154, v6
v_dot2c_f32_bf16 v156, v158, v6
v_dot2c_f32_bf16 v160, v162, v6
v_dot2c_f32_bf16 v164, v166, v6
v_dot2c_f32_bf16 v152, v155, v7
v_dot2c_f32_bf16 v156, v159, v7
v_dot2c_f32_bf16 v160, v163, v7
v_dot2c_f32_bf16 v164, v167, v7
v_add_f32_dpp v153, v152, v152 row_ror:8 row_mask:0xf bank_mask:0x3
v_add_f32_dpp v157, v156, v156 row_ror:8 row_mask:0xf bank_mask:0x3
v_add_f32_dpp v153, v160, v160 row_ror:8 row_mask:0xf bank_mask:0xc
v_add_f32_dpp v157, v164, v164 row_ror:8 row_mask:0xf bank_mask:0xc
s_nop 0
v_add_f32_dpp v16, v153, v153 row_shl:4 row_mask:0xf bank_mask:0x5
v_add_f32_dpp v16, v157, v157 row_shr:4 row_mask:0xf bank_mask:0xa
s_nop 1
v_add_f32_dpp v16, v16, v16 quad_perm:[1,0,3,2] row_mask:0xf bank_mask:0xf
s_nop 1
v_add_f32_dpp v16, v16, v16 quad_perm:[2,3,0,1] row_mask:0xf bank_mask:0xf
v_cvt_pk_bf16_f32 v16, 0, v16
v_mul_f32 v16, s66, v16
v_cvt_pk_bf16_f32 v16, 0, v16
s_xor_b32 s64, s65, 41984
s_cmpk_gt_u32 s69, 85
s_waitcnt vmcnt(6)
s_cbranch_scc1 L_d_89
s_waitcnt vmcnt(4)
L_d_89:
buffer_load_dwordx4 v[56:59], v1, s[44:47], s64 offen nt
v_dot2_f32_bf16 v168, v168, v4, 0
v_dot2_f32_bf16 v172, v172, v4, 0
v_dot2_f32_bf16 v176, v176, v4, 0
v_dot2_f32_bf16 v180, v180, v4, 0
v_dot2c_f32_bf16 v168, v169, v5
v_dot2c_f32_bf16 v172, v173, v5
v_dot2c_f32_bf16 v176, v177, v5
v_dot2c_f32_bf16 v180, v181, v5
v_dot2c_f32_bf16 v168, v170, v6
v_dot2c_f32_bf16 v172, v174, v6
v_dot2c_f32_bf16 v176, v178, v6
v_dot2c_f32_bf16 v180, v182, v6
v_dot2c_f32_bf16 v168, v171, v7
v_dot2c_f32_bf16 v172, v175, v7
v_dot2c_f32_bf16 v176, v179, v7
v_dot2c_f32_bf16 v180, v183, v7
v_add_f32_dpp v169, v168, v168 row_ror:8 row_mask:0xf bank_mask:0x3
v_add_f32_dpp v173, v172, v172 row_ror:8 row_mask:0xf bank_mask:0x3
v_add_f32_dpp v169, v176, v176 row_ror:8 row_mask:0xf bank_mask:0xc
v_add_f32_dpp v173, v180, v180 row_ror:8 row_mask:0xf bank_mask:0xc
s_nop 0
v_add_f32_dpp v18, v169, v169 row_shl:4 row_mask:0xf bank_mask:0x5
v_add_f32_dpp v18, v173, v173 row_shr:4 row_mask:0xf bank_mask:0xa
s_nop 1
v_add_f32_dpp v18, v18, v18 quad_perm:[1,0,3,2] row_mask:0xf bank_mask:0xf
s_nop 1
v_add_f32_dpp v18, v18, v18 quad_perm:[2,3,0,1] row_mask:0xf bank_mask:0xf
v_cvt_pk_bf16_f32 v18, 0, v18
v_mul_f32 v18, s66, v18
v_cvt_pk_bf16_f32 v18, 0, v18
s_cmp_eq_u32 s34, 1
s_cbranch_scc0 L_w_91
v_mov_b32 v60, 22
s_mov_b64 exec, 1
buffer_store_dword v60, off, s[36:39], s63 offset:0
s_mov_b64 exec, -1
L_w_91:
s_xor_b32 s64, s65, 13312
s_cmpk_gt_u32 s69, 86
s_waitcnt vmcnt(6)
s_cbranch_scc1 L_d_90
s_waitcnt vmcnt(4)
L_d_90:
buffer_load_dwordx4 v[64:67], v1, s[44:47], s64 offen nt
v_dot2_f32_bf16 v184, v184, v4, 0
v_dot2_f32_bf16 v188, v188, v4, 0
v_dot2_f32_bf16 v192, v192, v4, 0
v_dot2_f32_bf16 v196, v196, v4, 0
v_dot2c_f32_bf16 v184, v185, v5
v_dot2c_f32_bf16 v188, v189, v5
v_dot2c_f32_bf16 v192, v193, v5
v_dot2c_f32_bf16 v196, v197, v5
v_dot2c_f32_bf16 v184, v186, v6
v_dot2c_f32_bf16 v188, v190, v6
v_dot2c_f32_bf16 v192, v194, v6
v_dot2c_f32_bf16 v196, v198, v6
v_dot2c_f32_bf16 v184, v187, v7
v_dot2c_f32_bf16 v188, v191, v7
v_dot2c_f32_bf16 v192, v195, v7
v_dot2c_f32_bf16 v196, v199, v7
v_add_f32_dpp v185, v184, v184 row_ror:8 row_mask:0xf bank_mask:0x3
v_add_f32_dpp v189, v188, v188 row_ror:8 row_mask:0xf bank_mask:0x3
v_add_f32_dpp v185, v192, v192 row_ror:8 row_mask:0xf bank_mask:0xc
v_add_f32_dpp v189, v196, v196 row_ror:8 row_mask:0xf bank_mask:0xc
s_nop 0
v_add_f32_dpp v19, v185, v185 row_shl:4 row_mask:0xf bank_mask:0x5
v_add_f32_dpp v19, v189, v189 row_shr:4 row_mask:0xf bank_mask:0xa
s_nop 1
v_add_f32_dpp v19, v19, v19 quad_perm:[1,0,3,2] row_mask:0xf bank_mask:0xf
s_nop 1
v_add_f32_dpp v19, v19, v19 quad_perm:[2,3,0,1] row_mask:0xf bank_mask:0xf
v_cvt_pk_bf16_f32 v19, 0, v19
v_mul_f32 v19, s66, v19
v_cvt_pk_bf16_f32 v19, 0, v19
s_xor_b32 s64, s65, 46080
s_cmpk_gt_u32 s69, 87
s_waitcnt vmcnt(6)
s_cbranch_scc1 L_d_92
s_waitcnt vmcnt(4)
L_d_92:
buffer_load_dwordx4 v[68:71], v1, s[44:47], s64 offen nt
v_dot2_f32_bf16 v200, v200, v4, 0
v_dot2_f32_bf16 v204, v204, v4, 0
v_dot2_f32_bf16 v208, v208, v4, 0
v_dot2_f32_bf16 v212, v212, v4, 0
v_dot2c_f32_bf16 v200, v201, v5
v_dot2c_f32_bf16 v204, v205, v5
v_dot2c_f32_bf16 v208, v209, v5
v_dot2c_f32_bf16 v212, v213, v5
v_dot2c_f32_bf16 v200, v202, v6
v_dot2c_f32_bf16 v204, v206, v6
v_dot2c_f32_bf16 v208, v210, v6
v_dot2c_f32_bf16 v212, v214, v6
v_dot2c_f32_bf16 v200, v203, v7
v_dot2c_f32_bf16 v204, v207, v7
v_dot2c_f32_bf16 v208, v211, v7
v_dot2c_f32_bf16 v212, v215, v7
v_add_f32_dpp v201, v200, v200 row_ror:8 row_mask:0xf bank_mask:0x3
v_add_f32_dpp v205, v204, v204 row_ror:8 row_mask:0xf bank_mask:0x3
v_add_f32_dpp v201, v208, v208 row_ror:8 row_mask:0xf bank_mask:0xc
v_add_f32_dpp v205, v212, v212 row_ror:8 row_mask:0xf bank_mask:0xc
s_nop 0
v_add_f32_dpp v20, v201, v201 row_shl:4 row_mask:0xf bank_mask:0x5
v_add_f32_dpp v20, v205, v205 row_shr:4 row_mask:0xf bank_mask:0xa
s_nop 1
v_add_f32_dpp v20, v20, v20 quad_perm:[1,0,3,2] row_mask:0xf bank_mask:0xf
s_nop 1
v_add_f32_dpp v20, v20, v20 quad_perm:[2,3,0,1] row_mask:0xf bank_mask:0xf
v_cvt_pk_bf16_f32 v20, 0, v20
v_mul_f32 v20, s66, v20
v_cvt_pk_bf16_f32 v20, 0, v20
s_xor_b32 s64, s65, 66560
s_cmpk_gt_u32 s69, 88
s_waitcnt vmcnt(6)
s_cbranch_scc1 L_d_93
s_waitcnt vmcnt(4)
L_d_93:
buffer_load_dwordx4 v[72:75], v1, s[44:47], s64 offen nt
v_dot2_f32_bf16 v216, v216, v4, 0
v_dot2_f32_bf16 v220, v220, v4, 0
v_dot2_f32_bf16 v224, v224, v4, 0
v_dot2_f32_bf16 v228, v228, v4, 0
v_dot2c_f32_bf16 v216, v217, v5
v_dot2c_f32_bf16 v220, v221, v5
v_dot2c_f32_bf16 v224, v225, v5
v_dot2c_f32_bf16 v228, v229, v5
v_dot2c_f32_bf16 v216, v218, v6
v_dot2c_f32_bf16 v220, v222, v6
v_dot2c_f32_bf16 v224, v226, v6
v_dot2c_f32_bf16 v228, v230, v6
v_dot2c_f32_bf16 v216, v219, v7
v_dot2c_f32_bf16 v220, v223, v7
v_dot2c_f32_bf16 v224, v227, v7
v_dot2c_f32_bf16 v228, v231, v7
v_add_f32_dpp v217, v216, v216 row_ror:8 row_mask:0xf bank_mask:0x3
v_add_f32_dpp v221, v220, v220 row_ror:8 row_mask:0xf bank_mask:0x3
v_add_f32_dpp v217, v224, v224 row_ror:8 row_mask:0xf bank_mask:0xc
v_add_f32_dpp v221, v228, v228 row_ror:8 row_mask:0xf bank_mask:0xc
s_nop 0
v_add_f32_dpp v21, v217, v217 row_shl:4 row_mask:0xf bank_mask:0x5
v_add_f32_dpp v21, v221, v221 row_shr:4 row_mask:0xf bank_mask:0xa
s_nop 1
v_add_f32_dpp v21, v21, v21 quad_perm:[1,0,3,2] row_mask:0xf bank_mask:0xf
s_nop 1
v_add_f32_dpp v21, v21, v21 quad_perm:[2,3,0,1] row_mask:0xf bank_mask:0xf
v_cvt_pk_bf16_f32 v21, 0, v21
v_mul_f32 v21, s66, v21
v_cvt_pk_bf16_f32 v21, 0, v21
s_xor_b32 s64, s65, 99328
s_cmpk_gt_u32 s69, 89
s_waitcnt vmcnt(6)
s_cbranch_scc1 L_d_94
s_waitcnt vmcnt(4)
L_d_94:
buffer_load_dwordx4 v[76:79], v1, s[44:47], s64 offen nt
v_dot2_f32_bf16 v232, v232, v4, 0
v_dot2_f32_bf16 v236, v236, v4, 0
v_dot2_f32_bf16 v240, v240, v4, 0
v_dot2_f32_bf16 v244, v244, v4, 0
v_dot2c_f32_bf16 v232, v233, v5
v_dot2c_f32_bf16 v236, v237, v5
v_dot2c_f32_bf16 v240, v241, v5
v_dot2c_f32_bf16 v244, v245, v5
v_dot2c_f32_bf16 v232, v234, v6
v_dot2c_f32_bf16 v236, v238, v6
v_dot2c_f32_bf16 v240, v242, v6
v_dot2c_f32_bf16 v244, v246, v6
v_dot2c_f32_bf16 v232, v235, v7
v_dot2c_f32_bf16 v236, v239, v7
v_dot2c_f32_bf16 v240, v243, v7
v_dot2c_f32_bf16 v244, v247, v7
v_add_f32_dpp v233, v232, v232 row_ror:8 row_mask:0xf bank_mask:0x3
v_add_f32_dpp v237, v236, v236 row_ror:8 row_mask:0xf bank_mask:0x3
v_add_f32_dpp v233, v240, v240 row_ror:8 row_mask:0xf bank_mask:0xc
v_add_f32_dpp v237, v244, v244 row_ror:8 row_mask:0xf bank_mask:0xc
s_nop 0
v_add_f32_dpp v22, v233, v233 row_shl:4 row_mask:0xf bank_mask:0x5
v_add_f32_dpp v22, v237, v237 row_shr:4 row_mask:0xf bank_mask:0xa
s_nop 1
v_add_f32_dpp v22, v22, v22 quad_perm:[1,0,3,2] row_mask:0xf bank_mask:0xf
s_nop 1
v_add_f32_dpp v22, v22, v22 quad_perm:[2,3,0,1] row_mask:0xf bank_mask:0xf
v_cvt_pk_bf16_f32 v22, 0, v22
v_mul_f32 v22, s66, v22
v_cvt_pk_bf16_f32 v22, 0, v22
s_xor_b32 s64, s65, 70656
s_cmpk_gt_u32 s69, 90
s_waitcnt vmcnt(6)
s_cbranch_scc1 L_d_95
s_waitcnt vmcnt(5)
L_d_95:
buffer_load_dwordx4 v[80:83], v1, s[44:47], s64 offen nt
v_lshl_add_u32 v84, v0, 4, s70
ds_read_b128 v[88:91], v84 offset:0
ds_read_b128 v[92:95], v84 offset:1024
s_waitcnt lgkmcnt(0)
v_dot2_f32_bf16 v248, v248, v4, 0
v_dot2_f32_bf16 v252, v252, v4, 0
v_dot2_f32_bf16 v88, v88, v4, 0
v_dot2_f32_bf16 v92, v92, v4, 0
v_dot2c_f32_bf16 v248, v249, v5
v_dot2c_f32_bf16 v252, v253, v5
v_dot2c_f32_bf16 v88, v89, v5
v_dot2c_f32_bf16 v92, v93, v5
v_dot2c_f32_bf16 v248, v250, v6
v_dot2c_f32_bf16 v252, v254, v6
v_dot2c_f32_bf16 v88, v90, v6
v_dot2c_f32_bf16 v92, v94, v6
v_dot2c_f32_bf16 v248, v251, v7
v_dot2c_f32_bf16 v252, v255, v7
v_dot2c_f32_bf16 v88, v91, v7
v_dot2c_f32_bf16 v92, v95, v7
v_add_f32_dpp v249, v248, v248 row_ror:8 row_mask:0xf bank_mask:0x3
v_add_f32_dpp v253, v252, v252 row_ror:8 row_mask:0xf bank_mask:0x3
v_add_f32_dpp v249, v88, v88 row_ror:8 row_mask:0xf bank_mask:0xc
v_add_f32_dpp v253, v92, v92 row_ror:8 row_mask:0xf bank_mask:0xc
s_nop 0
v_add_f32_dpp v23, v249, v249 row_shl:4 row_mask:0xf bank_mask:0x5
v_add_f32_dpp v23, v253, v253 row_shr:4 row_mask:0xf bank_mask:0xa
s_nop 1
v_add_f32_dpp v23, v23, v23 quad_perm:[1,0,3,2] row_mask:0xf bank_mask:0xf
s_nop 1
v_add_f32_dpp v23, v23, v23 quad_perm:[2,3,0,1] row_mask:0xf bank_mask:0xf
v_cvt_pk_bf16_f32 v23, 0, v23
v_mul_f32 v23, s66, v23
v_cvt_pk_bf16_f32 v23, 0, v23
s_xor_b32 s64, s65, 103424
s_cmpk_gt_u32 s69, 91
s_waitcnt vmcnt(6)
s_cbranch_scc1 L_d_96
s_waitcnt vmcnt(5)
L_d_96:
buffer_load_dwordx4 v[96:99], v1, s[44:47], s64 offen nt
v_max3_f32 v2, v17, v8, v9
v_max3_f32 v2, v2, v10, v11
v_max3_f32 v2, v2, v12, v13
v_max3_f32 v2, v2, v14, v15
v_max3_f32 v2, v2, v16, v18
v_max3_f32 v2, v2, v19, v20
v_max3_f32 v2, v2, v21, v22
v_max_f32 v2, v2, v23
v_max_f32 v2, 0xff7fffff, v2
s_nop 1
v_max_f32_dpp v2, v2, v2 row_ror:4 row_mask:0xf bank_mask:0xf
s_nop 1
v_max_f32_dpp v2, v2, v2 row_ror:8 row_mask:0xf bank_mask:0xf
v_mov_b32 v3, v2
s_nop 1
v_permlane16_swap_b32 v2, v3
s_nop 1
v_max_f32 v2, v2, v3
v_mov_b32 v3, v2
s_nop 1
v_permlane32_swap_b32 v2, v3
s_nop 1
v_max_f32 v2, v2, v3
s_mov_b32 s67, 0x3fb8aa3b
v_sub_f32 v17, v17, v2
v_sub_f32 v8, v8, v2
v_sub_f32 v9, v9, v2
v_sub_f32 v10, v10, v2
v_sub_f32 v11, v11, v2
v_sub_f32 v12, v12, v2
v_sub_f32 v13, v13, v2
v_sub_f32 v14, v14, v2
v_sub_f32 v15, v15, v2
v_sub_f32 v16, v16, v2
v_sub_f32 v18, v18, v2
v_sub_f32 v19, v19, v2
v_sub_f32 v20, v20, v2
v_sub_f32 v21, v21, v2
v_sub_f32 v22, v22, v2
v_sub_f32 v23, v23, v2
v_mul_f32 v17, s67, v17
v_mul_f32 v8, s67, v8
v_mul_f32 v9, s67, v9
v_mul_f32 v10, s67, v10
v_mul_f32 v11, s67, v11
v_mul_f32 v12, s67, v12
v_mul_f32 v13, s67, v13
v_mul_f32 v14, s67, v14
v_mul_f32 v15, s67, v15
v_mul_f32 v16, s67, v16
v_mul_f32 v18, s67, v18
v_mul_f32 v19, s67, v19
v_mul_f32 v20, s67, v20
v_mul_f32 v21, s67, v21
v_mul_f32 v22, s67, v22
v_mul_f32 v23, s67, v23
s_xor_b32 s64, s65, 74752
s_cmpk_gt_u32 s69, 92
s_waitcnt vmcnt(6)
s_cbranch_scc1 L_d_97
s_waitcnt vmcnt(5)
L_d_97:
buffer_load_dwordx4 v[120:123], v1, s[44:47], s64 offen nt
v_exp_f32 v17, v17
v_exp_f32 v8, v8
v_exp_f32 v9, v9
v_exp_f32 v10, v10
v_exp_f32 v11, v11
v_exp_f32 v12, v12
v_exp_f32 v13, v13
v_exp_f32 v14, v14
v_exp_f32 v15, v15
v_exp_f32 v16, v16
v_exp_f32 v18, v18
v_exp_f32 v19, v19
v_exp_f32 v20, v20
v_exp_f32 v21, v21
v_exp_f32 v22, v22
v_exp_f32 v23, v23
v_add_f32 v3, v17, v8
v_add_f32 v3, v3, v9
v_add_f32 v3, v3, v10
v_add_f32 v3, v3, v11
v_add_f32 v3, v3, v12
v_add_f32 v3, v3, v13
v_add_f32 v3, v3, v14
v_add_f32 v3, v3, v15
v_add_f32 v3, v3, v16
v_add_f32 v3, v3, v18
v_add_f32 v3, v3, v19
v_add_f32 v3, v3, v20
v_add_f32 v3, v3, v21
v_add_f32 v3, v3, v22
v_add_f32 v3, v3, v23
s_nop 1
v_add_f32_dpp v3, v3, v3 row_ror:4 row_mask:0xf bank_mask:0xf
s_nop 1
v_add_f32_dpp v3, v3, v3 row_ror:8 row_mask:0xf bank_mask:0xf
v_mov_b32 v100, v3
s_nop 1
v_permlane16_swap_b32 v3, v100
s_nop 1
v_add_f32 v3, v3, v100
v_mov_b32 v100, v3
s_nop 1
v_permlane32_swap_b32 v3, v100
s_nop 1
v_add_f32 v3, v3, v100
v_min_u32 v3, -2, v3
s_lshl_b32 s68, s34, 3
v_mov_b32 v100, s68
ds_write_b64 v100, v[2:3] offset:256
v_and_b32 v101, 15, v0
v_lshrrev_b32 v102, 1, v101
v_and_b32 v101, 1, v0
v_lshlrev_b32 v101, 4, v101
v_mov_b32 v103, 0xffff
v_lshlrev_b32 v101, v101, v103
v_cmp_eq_u32 vcc, 0, v102
s_nop 1
v_cndmask_b32 v4, 0, v101, vcc
v_cmp_eq_u32 vcc, 1, v102
s_nop 1
v_cndmask_b32 v5, 0, v101, vcc
v_cmp_eq_u32 vcc, 2, v102
s_nop 1
v_cndmask_b32 v6, 0, v101, vcc
v_cmp_eq_u32 vcc, 3, v102
s_nop 1
v_cndmask_b32 v7, 0, v101, vcc
s_xor_b32 s64, s65, 107520
s_cmpk_gt_u32 s69, 93
s_waitcnt vmcnt(6)
s_cbranch_scc1 L_d_98
s_waitcnt vmcnt(5)
L_d_98:
buffer_load_dwordx4 v[124:127], v1, s[44:47], s64 offen nt
v_mov_b32 v100, 0
s_mov_b32 s75, 0
L_poll_99:
ds_read_b128 v[104:107], v100 offset:256
ds_read_b128 v[108:111], v100 offset:272
s_waitcnt lgkmcnt(0)
v_max3_u32 v101, v105, v107, v109
v_max_u32 v101, v101, v111
v_cmp_eq_u32 vcc, -1, v101
s_cbranch_vccz L_pollx_100
s_add_u32 s75, s75, 1
s_cmp_lt_u32 s75, 0x1000000
s_cbranch_scc1 L_poll_99
L_pollx_100:
v_max3_f32 v101, v104, v106, v108
v_max_f32 v101, v101, v110
v_sub_f32 v104, v104, v101
v_sub_f32 v106, v106, v101
v_sub_f32 v108, v108, v101
v_sub_f32 v110, v110, v101
v_sub_f32 v2, v2, v101
v_mul_f32 v104, s67, v104
v_mul_f32 v106, s67, v106
v_mul_f32 v108, s67, v108
v_mul_f32 v110, s67, v110
v_mul_f32 v2, s67, v2
v_exp_f32 v104, v104
v_exp_f32 v106, v106
v_exp_f32 v108, v108
v_exp_f32 v110, v110
v_exp_f32 v2, v2
v_mul_f32 v3, v104, v105
v_fmac_f32 v3, v106, v107
v_fmac_f32 v3, v108, v109
v_fmac_f32 v3, v110, v111
v_rcp_f32 v3, v3
s_nop 0
v_mul_f32 v2, v2, v3
v_mul_f32 v17, v17, v2
v_mul_f32 v8, v8, v2
v_mul_f32 v9, v9, v2
v_mul_f32 v10, v10, v2
v_mul_f32 v11, v11, v2
v_mul_f32 v12, v12, v2
v_mul_f32 v13, v13, v2
v_mul_f32 v14, v14, v2
v_mul_f32 v15, v15, v2
v_mul_f32 v16, v16, v2
v_mul_f32 v18, v18, v2
v_mul_f32 v19, v19, v2
v_mul_f32 v20, v20, v2
v_mul_f32 v21, v21, v2
v_mul_f32 v22, v22, v2
v_mul_f32 v23, v23, v2
v_cvt_pk_bf16_f32 v17, v17, v17
v_cvt_pk_bf16_f32 v8, v8, v8
v_cvt_pk_bf16_f32 v9, v9, v9
v_cvt_pk_bf16_f32 v10, v10, v10
v_cvt_pk_bf16_f32 v11, v11, v11
v_cvt_pk_bf16_f32 v12, v12, v12
v_cvt_pk_bf16_f32 v13, v13, v13
v_cvt_pk_bf16_f32 v14, v14, v14
v_cvt_pk_bf16_f32 v15, v15, v15
v_cvt_pk_bf16_f32 v16, v16, v16
v_cvt_pk_bf16_f32 v18, v18, v18
v_cvt_pk_bf16_f32 v19, v19, v19
v_cvt_pk_bf16_f32 v20, v20, v20
v_cvt_pk_bf16_f32 v21, v21, v21
v_cvt_pk_bf16_f32 v22, v22, v22
v_cvt_pk_bf16_f32 v23, v23, v23
s_nop 1
s_cmp_eq_u32 s34, 2
s_cbranch_scc0 L_w_102
v_mov_b32 v60, 30
s_mov_b64 exec, 1
buffer_store_dword v60, off, s[36:39], s63 offset:0
s_mov_b64 exec, -1
L_w_102:
s_xor_b32 s64, s65, 78848
s_cmpk_gt_u32 s69, 94
s_waitcnt vmcnt(6)
s_cbranch_scc1 L_d_101
s_waitcnt vmcnt(5)
L_d_101:
buffer_load_dwordx4 v[128:131], v1, s[44:47], s64 offen nt
ds_read_b128 v[132:135], v84 offset:2048
ds_read_b128 v[136:139], v84 offset:3072
ds_read_b128 v[140:143], v84 offset:4096
ds_read_b128 v[144:147], v84 offset:5120
ds_read_b128 v[148:151], v84 offset:6144
ds_read_b128 v[152:155], v84 offset:7168
ds_read_b128 v[156:159], v84 offset:8192
ds_read_b128 v[160:163], v84 offset:9216
s_waitcnt lgkmcnt(0)
v_and_b32_dpp v104, v17, v4 row_newbcast:0 row_mask:0xf bank_mask:0xf
v_and_b32_dpp v105, v17, v5 row_newbcast:0 row_mask:0xf bank_mask:0xf
v_and_b32_dpp v106, v17, v6 row_newbcast:0 row_mask:0xf bank_mask:0xf
v_and_b32_dpp v107, v17, v7 row_newbcast:0 row_mask:0xf bank_mask:0xf
v_and_b32_dpp v108, v17, v4 row_newbcast:4 row_mask:0xf bank_mask:0xf
v_and_b32_dpp v109, v17, v5 row_newbcast:4 row_mask:0xf bank_mask:0xf
v_and_b32_dpp v110, v17, v6 row_newbcast:4 row_mask:0xf bank_mask:0xf
v_and_b32_dpp v111, v17, v7 row_newbcast:4 row_mask:0xf bank_mask:0xf
v_mfma_f32_16x16x32_bf16 v[112:115], v[104:107], v[132:135], 0
v_and_b32_dpp v104, v15, v4 row_newbcast:0 row_mask:0xf bank_mask:0xf
v_and_b32_dpp v105, v15, v5 row_newbcast:0 row_mask:0xf bank_mask:0xf
v_and_b32_dpp v106, v15, v6 row_newbcast:0 row_mask:0xf bank_mask:0xf
v_and_b32_dpp v107, v15, v7 row_newbcast:0 row_mask:0xf bank_mask:0xf
v_mfma_f32_16x16x32_bf16 v[112:115], v[108:111], v[136:139], v[112:115]
v_and_b32_dpp v108, v15, v4 row_newbcast:4 row_mask:0xf bank_mask:0xf
v_and_b32_dpp v109, v15, v5 row_newbcast:4 row_mask:0xf bank_mask:0xf
v_and_b32_dpp v110, v15, v6 row_newbcast:4 row_mask:0xf bank_mask:0xf
v_and_b32_dpp v111, v15, v7 row_newbcast:4 row_mask:0xf bank_mask:0xf
v_mfma_f32_16x16x32_bf16 v[112:115], v[104:107], v[140:143], v[112:115]
s_xor_b32 s64, s65, 111616
s_cmpk_gt_u32 s69, 95
s_waitcnt vmcnt(6)
s_cbranch_scc1 L_d_103
s_waitcnt vmcnt(5)
L_d_103:
buffer_load_dwordx4 v[164:167], v1, s[44:47], s64 offen nt
v_and_b32_dpp v104, v17, v4 row_newbcast:8 row_mask:0xf bank_mask:0xf
v_and_b32_dpp v105, v17, v5 row_newbcast:8 row_mask:0xf bank_mask:0xf
v_and_b32_dpp v106, v17, v6 row_newbcast:8 row_mask:0xf bank_mask:0xf
v_and_b32_dpp v107, v17, v7 row_newbcast:8 row_mask:0xf bank_mask:0xf
v_mfma_f32_16x16x32_bf16 v[112:115], v[108:111], v[144:147], v[112:115]
v_and_b32_dpp v108, v17, v4 row_newbcast:12 row_mask:0xf bank_mask:0xf
v_and_b32_dpp v109, v17, v5 row_newbcast:12 row_mask:0xf bank_mask:0xf
v_and_b32_dpp v110, v17, v6 row_newbcast:12 row_mask:0xf bank_mask:0xf
v_and_b32_dpp v111, v17, v7 row_newbcast:12 row_mask:0xf bank_mask:0xf
v_mfma_f32_16x16x32_bf16 v[112:115], v[104:107], v[148:151], v[112:115]
v_and_b32_dpp v104, v15, v4 row_newbcast:8 row_mask:0xf bank_mask:0xf
v_and_b32_dpp v105, v15, v5 row_newbcast:8 row_mask:0xf bank_mask:0xf
v_and_b32_dpp v106, v15, v6 row_newbcast:8 row_mask:0xf bank_mask:0xf
v_and_b32_dpp v107, v15, v7 row_newbcast:8 row_mask:0xf bank_mask:0xf
v_mfma_f32_16x16x32_bf16 v[112:115], v[108:111], v[152:155], v[112:115]
s_xor_b32 s64, s65, 131072
s_cmpk_gt_u32 s69, 96
s_waitcnt vmcnt(6)
s_cbranch_scc1 L_d_104
s_waitcnt vmcnt(5)
L_d_104:
buffer_load_dwordx4 v[168:171], v1, s[44:47], s64 offen nt
v_and_b32_dpp v108, v15, v4 row_newbcast:12 row_mask:0xf bank_mask:0xf
v_and_b32_dpp v109, v15, v5 row_newbcast:12 row_mask:0xf bank_mask:0xf
v_and_b32_dpp v110, v15, v6 row_newbcast:12 row_mask:0xf bank_mask:0xf
v_and_b32_dpp v111, v15, v7 row_newbcast:12 row_mask:0xf bank_mask:0xf
v_mfma_f32_16x16x32_bf16 v[112:115], v[104:107], v[156:159], v[112:115]
v_and_b32_dpp v104, v9, v4 row_newbcast:0 row_mask:0xf bank_mask:0xf
v_and_b32_dpp v105, v9, v5 row_newbcast:0 row_mask:0xf bank_mask:0xf
v_and_b32_dpp v106, v9, v6 row_newbcast:0 row_mask:0xf bank_mask:0xf
v_and_b32_dpp v107, v9, v7 row_newbcast:0 row_mask:0xf bank_mask:0xf
v_mfma_f32_16x16x32_bf16 v[112:115], v[108:111], v[160:163], v[112:115]
ds_read_b128 v[172:175], v84 offset:10240
ds_read_b128 v[176:179], v84 offset:11264
ds_read_b128 v[180:183], v84 offset:12288
ds_read_b128 v[184:187], v84 offset:13312
ds_read_b128 v[188:191], v84 offset:14336
s_waitcnt lgkmcnt(0)
v_and_b32_dpp v108, v9, v4 row_newbcast:4 row_mask:0xf bank_mask:0xf
v_and_b32_dpp v109, v9, v5 row_newbcast:4 row_mask:0xf bank_mask:0xf
v_and_b32_dpp v110, v9, v6 row_newbcast:4 row_mask:0xf bank_mask:0xf
v_and_b32_dpp v111, v9, v7 row_newbcast:4 row_mask:0xf bank_mask:0xf
v_mfma_f32_16x16x32_bf16 v[112:115], v[104:107], v[172:175], v[112:115]
s_xor_b32 s64, s65, 163840
s_cmpk_gt_u32 s69, 97
s_waitcnt vmcnt(6)
s_cbranch_scc1 L_d_105
s_waitcnt vmcnt(5)
L_d_105:
buffer_load_dwordx4 v[192:195], v1, s[44:47], s64 offen nt
v_and_b32_dpp v104, v18, v4 row_newbcast:0 row_mask:0xf bank_mask:0xf
v_and_b32_dpp v105, v18, v5 row_newbcast:0 row_mask:0xf bank_mask:0xf
v_and_b32_dpp v106, v18, v6 row_newbcast:0 row_mask:0xf bank_mask:0xf
v_and_b32_dpp v107, v18, v7 row_newbcast:0 row_mask:0xf bank_mask:0xf
v_mfma_f32_16x16x32_bf16 v[112:115], v[108:111], v[176:179], v[112:115]
v_and_b32_dpp v108, v18, v4 row_newbcast:4 row_mask:0xf bank_mask:0xf
v_and_b32_dpp v109, v18, v5 row_newbcast:4 row_mask:0xf bank_mask:0xf
v_and_b32_dpp v110, v18, v6 row_newbcast:4 row_mask:0xf bank_mask:0xf
v_and_b32_dpp v111, v18, v7 row_newbcast:4 row_mask:0xf bank_mask:0xf
v_mfma_f32_16x16x32_bf16 v[112:115], v[104:107], v[180:183], v[112:115]
v_and_b32_dpp v104, v9, v4 row_newbcast:8 row_mask:0xf bank_mask:0xf
v_and_b32_dpp v105, v9, v5 row_newbcast:8 row_mask:0xf bank_mask:0xf
v_and_b32_dpp v106, v9, v6 row_newbcast:8 row_mask:0xf bank_mask:0xf
v_and_b32_dpp v107, v9, v7 row_newbcast:8 row_mask:0xf bank_mask:0xf
v_mfma_f32_16x16x32_bf16 v[112:115], v[108:111], v[184:187], v[112:115]
s_xor_b32 s64, s65, 135168
s_cmpk_gt_u32 s69, 98
s_waitcnt vmcnt(6)
s_cbranch_scc1 L_d_106
s_waitcnt vmcnt(5)
L_d_106:
buffer_load_dwordx4 v[196:199], v1, s[44:47], s64 offen nt
v_and_b32_dpp v108, v9, v4 row_newbcast:12 row_mask:0xf bank_mask:0xf
v_and_b32_dpp v109, v9, v5 row_newbcast:12 row_mask:0xf bank_mask:0xf
v_and_b32_dpp v110, v9, v6 row_newbcast:12 row_mask:0xf bank_mask:0xf
v_and_b32_dpp v111, v9, v7 row_newbcast:12 row_mask:0xf bank_mask:0xf
v_mfma_f32_16x16x32_bf16 v[112:115], v[104:107], v[188:191], v[112:115]
v_and_b32_dpp v104, v18, v4 row_newbcast:8 row_mask:0xf bank_mask:0xf
v_and_b32_dpp v105, v18, v5 row_newbcast:8 row_mask:0xf bank_mask:0xf
v_and_b32_dpp v106, v18, v6 row_newbcast:8 row_mask:0xf bank_mask:0xf
v_and_b32_dpp v107, v18, v7 row_newbcast:8 row_mask:0xf bank_mask:0xf
v_mfma_f32_16x16x32_bf16 v[112:115], v[108:111], v[24:27], v[112:115]
v_and_b32_dpp v108, v18, v4 row_newbcast:12 row_mask:0xf bank_mask:0xf
v_and_b32_dpp v109, v18, v5 row_newbcast:12 row_mask:0xf bank_mask:0xf
v_and_b32_dpp v110, v18, v6 row_newbcast:12 row_mask:0xf bank_mask:0xf
v_and_b32_dpp v111, v18, v7 row_newbcast:12 row_mask:0xf bank_mask:0xf
v_mfma_f32_16x16x32_bf16 v[112:115], v[104:107], v[28:31], v[112:115]
s_xor_b32 s64, s65, 167936
s_cmpk_gt_u32 s69, 99
s_waitcnt vmcnt(6)
s_cbranch_scc1 L_d_107
s_waitcnt vmcnt(5)
L_d_107:
buffer_load_dwordx4 v[200:203], v1, s[44:47], s64 offen nt
v_and_b32_dpp v104, v8, v4 row_newbcast:0 row_mask:0xf bank_mask:0xf
v_and_b32_dpp v105, v8, v5 row_newbcast:0 row_mask:0xf bank_mask:0xf
v_and_b32_dpp v106, v8, v6 row_newbcast:0 row_mask:0xf bank_mask:0xf
v_and_b32_dpp v107, v8, v7 row_newbcast:0 row_mask:0xf bank_mask:0xf
v_mfma_f32_16x16x32_bf16 v[112:115], v[108:111], v[32:35], v[112:115]
v_and_b32_dpp v108, v8, v4 row_newbcast:4 row_mask:0xf bank_mask:0xf
v_and_b32_dpp v109, v8, v5 row_newbcast:4 row_mask:0xf bank_mask:0xf
v_and_b32_dpp v110, v8, v6 row_newbcast:4 row_mask:0xf bank_mask:0xf
v_and_b32_dpp v111, v8, v7 row_newbcast:4 row_mask:0xf bank_mask:0xf
v_mfma_f32_16x16x32_bf16 v[112:115], v[104:107], v[36:39], v[112:115]
v_and_b32_dpp v104, v16, v4 row_newbcast:0 row_mask:0xf bank_mask:0xf
v_and_b32_dpp v105, v16, v5 row_newbcast:0 row_mask:0xf bank_mask:0xf
v_and_b32_dpp v106, v16, v6 row_newbcast:0 row_mask:0xf bank_mask:0xf
v_and_b32_dpp v107, v16, v7 row_newbcast:0 row_mask:0xf bank_mask:0xf
v_mfma_f32_16x16x32_bf16 v[112:115], v[108:111], v[40:43], v[112:115]
s_xor_b32 s64, s65, 139264
s_cmpk_gt_u32 s69, 100
s_waitcnt vmcnt(6)
s_cbranch_scc1 L_d_108
s_waitcnt vmcnt(5)
L_d_108:
buffer_load_dwordx4 v[204:207], v1, s[44:47], s64 offen nt
v_and_b32_dpp v108, v16, v4 row_newbcast:4 row_mask:0xf bank_mask:0xf
v_and_b32_dpp v109, v16, v5 row_newbcast:4 row_mask:0xf bank_mask:0xf
v_and_b32_dpp v110, v16, v6 row_newbcast:4 row_mask:0xf bank_mask:0xf
v_and_b32_dpp v111, v16, v7 row_newbcast:4 row_mask:0xf bank_mask:0xf
v_mfma_f32_16x16x32_bf16 v[112:115], v[104:107], v[44:47], v[112:115]
v_and_b32_dpp v104, v8, v4 row_newbcast:8 row_mask:0xf bank_mask:0xf
v_and_b32_dpp v105, v8, v5 row_newbcast:8 row_mask:0xf bank_mask:0xf
v_and_b32_dpp v106, v8, v6 row_newbcast:8 row_mask:0xf bank_mask:0xf
v_and_b32_dpp v107, v8, v7 row_newbcast:8 row_mask:0xf bank_mask:0xf
v_mfma_f32_16x16x32_bf16 v[112:115], v[108:111], v[48:51], v[112:115]
v_and_b32_dpp v108, v8, v4 row_newbcast:12 row_mask:0xf bank_mask:0xf
v_and_b32_dpp v109, v8, v5 row_newbcast:12 row_mask:0xf bank_mask:0xf
v_and_b32_dpp v110, v8, v6 row_newbcast:12 row_mask:0xf bank_mask:0xf
v_and_b32_dpp v111, v8, v7 row_newbcast:12 row_mask:0xf bank_mask:0xf
v_mfma_f32_16x16x32_bf16 v[112:115], v[104:107], v[52:55], v[112:115]
s_xor_b32 s64, s65, 172032
s_cmpk_gt_u32 s69, 101
s_waitcnt vmcnt(6)
s_cbranch_scc1 L_d_109
s_waitcnt vmcnt(5)
L_d_109:
buffer_load_dwordx4 v[208:211], v1, s[44:47], s64 offen nt
v_and_b32_dpp v104, v16, v4 row_newbcast:8 row_mask:0xf bank_mask:0xf
v_and_b32_dpp v105, v16, v5 row_newbcast:8 row_mask:0xf bank_mask:0xf
v_and_b32_dpp v106, v16, v6 row_newbcast:8 row_mask:0xf bank_mask:0xf
v_and_b32_dpp v107, v16, v7 row_newbcast:8 row_mask:0xf bank_mask:0xf
v_mfma_f32_16x16x32_bf16 v[112:115], v[108:111], v[56:59], v[112:115]
v_and_b32_dpp v108, v16, v4 row_newbcast:12 row_mask:0xf bank_mask:0xf
v_and_b32_dpp v109, v16, v5 row_newbcast:12 row_mask:0xf bank_mask:0xf
v_and_b32_dpp v110, v16, v6 row_newbcast:12 row_mask:0xf bank_mask:0xf
v_and_b32_dpp v111, v16, v7 row_newbcast:12 row_mask:0xf bank_mask:0xf
v_mfma_f32_16x16x32_bf16 v[112:115], v[104:107], v[64:67], v[112:115]
v_and_b32_dpp v104, v10, v4 row_newbcast:0 row_mask:0xf bank_mask:0xf
v_and_b32_dpp v105, v10, v5 row_newbcast:0 row_mask:0xf bank_mask:0xf
v_and_b32_dpp v106, v10, v6 row_newbcast:0 row_mask:0xf bank_mask:0xf
v_and_b32_dpp v107, v10, v7 row_newbcast:0 row_mask:0xf bank_mask:0xf
v_mfma_f32_16x16x32_bf16 v[112:115], v[108:111], v[68:71], v[112:115]
s_cmp_eq_u32 s34, 3
s_cbranch_scc0 L_w_111
v_mov_b32 v60, 38
s_mov_b64 exec, 1
buffer_store_dword v60, off, s[36:39], s63 offset:0
s_mov_b64 exec, -1
L_w_111:
s_xor_b32 s64, s65, 143360
s_cmpk_gt_u32 s69, 102
s_waitcnt vmcnt(6)
s_cbranch_scc1 L_d_110
s_waitcnt vmcnt(5)
L_d_110:
buffer_load_dwordx4 v[212:215], v1, s[44:47], s64 offen nt
v_and_b32_dpp v108, v10, v4 row_newbcast:4 row_mask:0xf bank_mask:0xf
v_and_b32_dpp v109, v10, v5 row_newbcast:4 row_mask:0xf bank_mask:0xf
v_and_b32_dpp v110, v10, v6 row_newbcast:4 row_mask:0xf bank_mask:0xf
v_and_b32_dpp v111, v10, v7 row_newbcast:4 row_mask:0xf bank_mask:0xf
v_mfma_f32_16x16x32_bf16 v[112:115], v[104:107], v[72:75], v[112:115]
v_and_b32_dpp v104, v19, v4 row_newbcast:0 row_mask:0xf bank_mask:0xf
v_and_b32_dpp v105, v19, v5 row_newbcast:0 row_mask:0xf bank_mask:0xf
v_and_b32_dpp v106, v19, v6 row_newbcast:0 row_mask:0xf bank_mask:0xf
v_and_b32_dpp v107, v19, v7 row_newbcast:0 row_mask:0xf bank_mask:0xf
v_mfma_f32_16x16x32_bf16 v[112:115], v[108:111], v[76:79], v[112:115]
v_and_b32_dpp v108, v19, v4 row_newbcast:4 row_mask:0xf bank_mask:0xf
v_and_b32_dpp v109, v19, v5 row_newbcast:4 row_mask:0xf bank_mask:0xf
v_and_b32_dpp v110, v19, v6 row_newbcast:4 row_mask:0xf bank_mask:0xf
v_and_b32_dpp v111, v19, v7 row_newbcast:4 row_mask:0xf bank_mask:0xf
v_mfma_f32_16x16x32_bf16 v[112:115], v[104:107], v[80:83], v[112:115]
s_xor_b32 s64, s65, 176128
s_cmpk_gt_u32 s69, 103
s_waitcnt vmcnt(6)
s_cbranch_scc1 L_d_112
s_waitcnt vmcnt(5)
L_d_112:
buffer_load_dwordx4 v[216:219], v1, s[44:47], s64 offen nt
v_and_b32_dpp v104, v10, v4 row_newbcast:8 row_mask:0xf bank_mask:0xf
v_and_b32_dpp v105, v10, v5 row_newbcast:8 row_mask:0xf bank_mask:0xf
v_and_b32_dpp v106, v10, v6 row_newbcast:8 row_mask:0xf bank_mask:0xf
v_and_b32_dpp v107, v10, v7 row_newbcast:8 row_mask:0xf bank_mask:0xf
v_mfma_f32_16x16x32_bf16 v[112:115], v[108:111], v[96:99], v[112:115]
v_and_b32_dpp v108, v10, v4 row_newbcast:12 row_mask:0xf bank_mask:0xf
v_and_b32_dpp v109, v10, v5 row_newbcast:12 row_mask:0xf bank_mask:0xf
v_and_b32_dpp v110, v10, v6 row_newbcast:12 row_mask:0xf bank_mask:0xf
v_and_b32_dpp v111, v10, v7 row_newbcast:12 row_mask:0xf bank_mask:0xf
v_mfma_f32_16x16x32_bf16 v[112:115], v[104:107], v[120:123], v[112:115]
v_and_b32_dpp v104, v19, v4 row_newbcast:8 row_mask:0xf bank_mask:0xf
v_and_b32_dpp v105, v19, v5 row_newbcast:8 row_mask:0xf bank_mask:0xf
v_and_b32_dpp v106, v19, v6 row_newbcast:8 row_mask:0xf bank_mask:0xf
v_and_b32_dpp v107, v19, v7 row_newbcast:8 row_mask:0xf bank_mask:0xf
v_mfma_f32_16x16x32_bf16 v[112:115], v[108:111], v[124:127], v[112:115]
s_xor_b32 s64, s65, 196608
s_cmpk_gt_u32 s69, 104
s_waitcnt vmcnt(6)
s_cbranch_scc1 L_d_113
s_waitcnt vmcnt(5)
L_d_113:
buffer_load_dwordx4 v[220:223], v1, s[44:47], s64 offen nt
v_and_b32_dpp v108, v19, v4 row_newbcast:12 row_mask:0xf bank_mask:0xf
v_and_b32_dpp v109, v19, v5 row_newbcast:12 row_mask:0xf bank_mask:0xf
v_and_b32_dpp v110, v19, v6 row_newbcast:12 row_mask:0xf bank_mask:0xf
v_and_b32_dpp v111, v19, v7 row_newbcast:12 row_mask:0xf bank_mask:0xf
v_mfma_f32_16x16x32_bf16 v[112:115], v[104:107], v[128:131], v[112:115]
v_and_b32_dpp v104, v11, v4 row_newbcast:0 row_mask:0xf bank_mask:0xf
v_and_b32_dpp v105, v11, v5 row_newbcast:0 row_mask:0xf bank_mask:0xf
v_and_b32_dpp v106, v11, v6 row_newbcast:0 row_mask:0xf bank_mask:0xf
v_and_b32_dpp v107, v11, v7 row_newbcast:0 row_mask:0xf bank_mask:0xf
v_mfma_f32_16x16x32_bf16 v[112:115], v[108:111], v[164:167], v[112:115]
v_and_b32_dpp v108, v11, v4 row_newbcast:4 row_mask:0xf bank_mask:0xf
v_and_b32_dpp v109, v11, v5 row_newbcast:4 row_mask:0xf bank_mask:0xf
v_and_b32_dpp v110, v11, v6 row_newbcast:4 row_mask:0xf bank_mask:0xf
v_and_b32_dpp v111, v11, v7 row_newbcast:4 row_mask:0xf bank_mask:0xf
v_mfma_f32_16x16x32_bf16 v[112:115], v[104:107], v[168:171], v[112:115]
s_xor_b32 s64, s65, 229376
s_cmpk_gt_u32 s69, 105
s_waitcnt vmcnt(6)
s_cbranch_scc1 L_d_114
s_waitcnt vmcnt(5)
L_d_114:
buffer_load_dwordx4 v[224:227], v1, s[44:47], s64 offen nt
v_and_b32_dpp v104, v20, v4 row_newbcast:0 row_mask:0xf bank_mask:0xf
v_and_b32_dpp v105, v20, v5 row_newbcast:0 row_mask:0xf bank_mask:0xf
v_and_b32_dpp v106, v20, v6 row_newbcast:0 row_mask:0xf bank_mask:0xf
v_and_b32_dpp v107, v20, v7 row_newbcast:0 row_mask:0xf bank_mask:0xf
v_mfma_f32_16x16x32_bf16 v[112:115], v[108:111], v[192:195], v[112:115]
v_and_b32_dpp v108, v20, v4 row_newbcast:4 row_mask:0xf bank_mask:0xf
v_and_b32_dpp v109, v20, v5 row_newbcast:4 row_mask:0xf bank_mask:0xf
v_and_b32_dpp v110, v20, v6 row_newbcast:4 row_mask:0xf bank_mask:0xf
v_and_b32_dpp v111, v20, v7 row_newbcast:4 row_mask:0xf bank_mask:0xf
v_mfma_f32_16x16x32_bf16 v[112:115], v[104:107], v[196:199], v[112:115]
s_xor_b32 s64, s65, 200704
s_cmpk_gt_u32 s69, 106
s_waitcnt vmcnt(6)
s_cbranch_scc1 L_d_115
s_waitcnt vmcnt(5)
L_d_115:
buffer_load_dwordx4 v[228:231], v1, s[44:47], s64 offen nt
v_and_b32_dpp v104, v11, v4 row_newbcast:8 row_mask:0xf bank_mask:0xf
v_and_b32_dpp v105, v11, v5 row_newbcast:8 row_mask:0xf bank_mask:0xf
v_and_b32_dpp v106, v11, v6 row_newbcast:8 row_mask:0xf bank_mask:0xf
v_and_b32_dpp v107, v11, v7 row_newbcast:8 row_mask:0xf bank_mask:0xf
v_mfma_f32_16x16x32_bf16 v[112:115], v[108:111], v[200:203], v[112:115]
s_xor_b32 s64, s65, 233472
s_cmpk_gt_u32 s69, 107
s_waitcnt vmcnt(6)
s_cbranch_scc1 L_d_116
s_waitcnt vmcnt(5)
L_d_116:
buffer_load_dwordx4 v[232:235], v1, s[44:47], s64 offen nt
v_and_b32_dpp v108, v11, v4 row_newbcast:12 row_mask:0xf bank_mask:0xf
v_and_b32_dpp v109, v11, v5 row_newbcast:12 row_mask:0xf bank_mask:0xf
v_and_b32_dpp v110, v11, v6 row_newbcast:12 row_mask:0xf bank_mask:0xf
v_and_b32_dpp v111, v11, v7 row_newbcast:12 row_mask:0xf bank_mask:0xf
v_mfma_f32_16x16x32_bf16 v[112:115], v[104:107], v[204:207], v[112:115]
s_xor_b32 s64, s65, 204800
s_cmpk_gt_u32 s69, 108
s_waitcnt vmcnt(6)
s_cbranch_scc1 L_d_117
s_waitcnt vmcnt(5)
L_d_117:
buffer_load_dwordx4 v[236:239], v1, s[44:47], s64 offen nt
v_and_b32_dpp v104, v20, v4 row_newbcast:8 row_mask:0xf bank_mask:0xf
v_and_b32_dpp v105, v20, v5 row_newbcast:8 row_mask:0xf bank_mask:0xf
v_and_b32_dpp v106, v20, v6 row_newbcast:8 row_mask:0xf bank_mask:0xf
v_and_b32_dpp v107, v20, v7 row_newbcast:8 row_mask:0xf bank_mask:0xf
v_mfma_f32_16x16x32_bf16 v[112:115], v[108:111], v[208:211], v[112:115]
s_xor_b32 s64, s65, 237568
s_cmpk_gt_u32 s69, 109
s_waitcnt vmcnt(6)
s_cbranch_scc1 L_d_118
s_waitcnt vmcnt(5)
L_d_118:
buffer_load_dwordx4 v[240:243], v1, s[44:47], s64 offen nt
v_and_b32_dpp v108, v20, v4 row_newbcast:12 row_mask:0xf bank_mask:0xf
v_and_b32_dpp v109, v20, v5 row_newbcast:12 row_mask:0xf bank_mask:0xf
v_and_b32_dpp v110, v20, v6 row_newbcast:12 row_mask:0xf bank_mask:0xf
v_and_b32_dpp v111, v20, v7 row_newbcast:12 row_mask:0xf bank_mask:0xf
v_mfma_f32_16x16x32_bf16 v[112:115], v[104:107], v[212:215], v[112:115]
s_cmp_eq_u32 s34, 0
s_cbranch_scc0 L_w_120
v_mov_b32 v60, 46
s_mov_b64 exec, 1
buffer_store_dword v60, off, s[36:39], s63 offset:0
s_mov_b64 exec, -1
L_w_120:
s_xor_b32 s64, s65, 208896
s_cmpk_gt_u32 s69, 110
s_waitcnt vmcnt(6)
s_cbranch_scc1 L_d_119
s_waitcnt vmcnt(5)
L_d_119:
buffer_load_dwordx4 v[244:247], v1, s[44:47], s64 offen nt
v_and_b32_dpp v104, v13, v4 row_newbcast:0 row_mask:0xf bank_mask:0xf
v_and_b32_dpp v105, v13, v5 row_newbcast:0 row_mask:0xf bank_mask:0xf
v_and_b32_dpp v106, v13, v6 row_newbcast:0 row_mask:0xf bank_mask:0xf
v_and_b32_dpp v107, v13, v7 row_newbcast:0 row_mask:0xf bank_mask:0xf
v_mfma_f32_16x16x32_bf16 v[112:115], v[108:111], v[216:219], v[112:115]
s_xor_b32 s64, s65, 241664
s_cmpk_gt_u32 s69, 111
s_waitcnt vmcnt(6)
s_cbranch_scc1 L_d_121
s_waitcnt vmcnt(5)
L_d_121:
buffer_load_dwordx4 v[248:251], v1, s[44:47], s64 offen nt
v_and_b32_dpp v108, v13, v4 row_newbcast:4 row_mask:0xf bank_mask:0xf
v_and_b32_dpp v109, v13, v5 row_newbcast:4 row_mask:0xf bank_mask:0xf
v_and_b32_dpp v110, v13, v6 row_newbcast:4 row_mask:0xf bank_mask:0xf
v_and_b32_dpp v111, v13, v7 row_newbcast:4 row_mask:0xf bank_mask:0xf
v_mfma_f32_16x16x32_bf16 v[112:115], v[104:107], v[220:223], v[112:115]
s_xor_b32 s64, s65, 132096
s_waitcnt vmcnt(5)
buffer_load_dwordx4 v[252:255], v1, s[44:47], s64 offen nt
v_and_b32_dpp v104, v22, v4 row_newbcast:0 row_mask:0xf bank_mask:0xf
v_and_b32_dpp v105, v22, v5 row_newbcast:0 row_mask:0xf bank_mask:0xf
v_and_b32_dpp v106, v22, v6 row_newbcast:0 row_mask:0xf bank_mask:0xf
v_and_b32_dpp v107, v22, v7 row_newbcast:0 row_mask:0xf bank_mask:0xf
v_mfma_f32_16x16x32_bf16 v[112:115], v[108:111], v[224:227], v[112:115]
v_and_b32_dpp v108, v22, v4 row_newbcast:4 row_mask:0xf bank_mask:0xf
v_and_b32_dpp v109, v22, v5 row_newbcast:4 row_mask:0xf bank_mask:0xf
v_and_b32_dpp v110, v22, v6 row_newbcast:4 row_mask:0xf bank_mask:0xf
v_and_b32_dpp v111, v22, v7 row_newbcast:4 row_mask:0xf bank_mask:0xf
v_mfma_f32_16x16x32_bf16 v[112:115], v[104:107], v[228:231], v[112:115]
s_xor_b32 s64, s65, 164864
s_waitcnt vmcnt(5)
buffer_load_dwordx4 v[88:91], v1, s[44:47], s64 offen nt
v_and_b32_dpp v104, v13, v4 row_newbcast:8 row_mask:0xf bank_mask:0xf
v_and_b32_dpp v105, v13, v5 row_newbcast:8 row_mask:0xf bank_mask:0xf
v_and_b32_dpp v106, v13, v6 row_newbcast:8 row_mask:0xf bank_mask:0xf
v_and_b32_dpp v107, v13, v7 row_newbcast:8 row_mask:0xf bank_mask:0xf
v_mfma_f32_16x16x32_bf16 v[112:115], v[108:111], v[232:235], v[112:115]
s_xor_b32 s64, s65, 136192
s_waitcnt vmcnt(5)
buffer_load_dwordx4 v[92:95], v1, s[44:47], s64 offen nt
v_and_b32_dpp v108, v13, v4 row_newbcast:12 row_mask:0xf bank_mask:0xf
v_and_b32_dpp v109, v13, v5 row_newbcast:12 row_mask:0xf bank_mask:0xf
v_and_b32_dpp v110, v13, v6 row_newbcast:12 row_mask:0xf bank_mask:0xf
v_and_b32_dpp v111, v13, v7 row_newbcast:12 row_mask:0xf bank_mask:0xf
v_mfma_f32_16x16x32_bf16 v[112:115], v[104:107], v[236:239], v[112:115]
s_xor_b32 s64, s65, 168960
s_waitcnt vmcnt(5)
buffer_load_dwordx4 v[132:135], v1, s[44:47], s64 offen nt
v_and_b32_dpp v104, v22, v4 row_newbcast:8 row_mask:0xf bank_mask:0xf
v_and_b32_dpp v105, v22, v5 row_newbcast:8 row_mask:0xf bank_mask:0xf
v_and_b32_dpp v106, v22, v6 row_newbcast:8 row_mask:0xf bank_mask:0xf
v_and_b32_dpp v107, v22, v7 row_newbcast:8 row_mask:0xf bank_mask:0xf
v_mfma_f32_16x16x32_bf16 v[112:115], v[108:111], v[240:243], v[112:115]
s_xor_b32 s64, s65, 140288
s_waitcnt vmcnt(5)
buffer_load_dwordx4 v[136:139], v1, s[44:47], s64 offen nt
v_and_b32_dpp v108, v22, v4 row_newbcast:12 row_mask:0xf bank_mask:0xf
v_and_b32_dpp v109, v22, v5 row_newbcast:12 row_mask:0xf bank_mask:0xf
v_and_b32_dpp v110, v22, v6 row_newbcast:12 row_mask:0xf bank_mask:0xf
v_and_b32_dpp v111, v22, v7 row_newbcast:12 row_mask:0xf bank_mask:0xf
v_mfma_f32_16x16x32_bf16 v[112:115], v[104:107], v[244:247], v[112:115]
s_xor_b32 s64, s65, 173056
s_waitcnt vmcnt(5)
buffer_load_dwordx4 v[140:143], v1, s[44:47], s64 offen nt
v_and_b32_dpp v104, v12, v4 row_newbcast:0 row_mask:0xf bank_mask:0xf
v_and_b32_dpp v105, v12, v5 row_newbcast:0 row_mask:0xf bank_mask:0xf
v_and_b32_dpp v106, v12, v6 row_newbcast:0 row_mask:0xf bank_mask:0xf
v_and_b32_dpp v107, v12, v7 row_newbcast:0 row_mask:0xf bank_mask:0xf
v_mfma_f32_16x16x32_bf16 v[112:115], v[108:111], v[248:251], v[112:115]
s_cmp_eq_u32 s34, 1
s_cbranch_scc0 L_w_122
v_mov_b32 v60, 54
s_mov_b64 exec, 1
buffer_store_dword v60, off, s[36:39], s63 offset:0
s_mov_b64 exec, -1
L_w_122:
s_xor_b32 s64, s65, 144384
s_waitcnt vmcnt(5)
buffer_load_dwordx4 v[144:147], v1, s[44:47], s64 offen nt
v_and_b32_dpp v108, v12, v4 row_newbcast:4 row_mask:0xf bank_mask:0xf
v_and_b32_dpp v109, v12, v5 row_newbcast:4 row_mask:0xf bank_mask:0xf
v_and_b32_dpp v110, v12, v6 row_newbcast:4 row_mask:0xf bank_mask:0xf
v_and_b32_dpp v111, v12, v7 row_newbcast:4 row_mask:0xf bank_mask:0xf
v_mfma_f32_16x16x32_bf16 v[112:115], v[104:107], v[252:255], v[112:115]
s_xor_b32 s64, s65, 177152
s_waitcnt vmcnt(5)
buffer_load_dwordx4 v[148:151], v1, s[44:47], s64 offen nt
v_and_b32_dpp v104, v21, v4 row_newbcast:0 row_mask:0xf bank_mask:0xf
v_and_b32_dpp v105, v21, v5 row_newbcast:0 row_mask:0xf bank_mask:0xf
v_and_b32_dpp v106, v21, v6 row_newbcast:0 row_mask:0xf bank_mask:0xf
v_and_b32_dpp v107, v21, v7 row_newbcast:0 row_mask:0xf bank_mask:0xf
v_mfma_f32_16x16x32_bf16 v[112:115], v[108:111], v[88:91], v[112:115]
s_xor_b32 s64, s65, 197632
s_waitcnt vmcnt(5)
buffer_load_dwordx4 v[152:155], v1, s[44:47], s64 offen nt
v_and_b32_dpp v108, v21, v4 row_newbcast:4 row_mask:0xf bank_mask:0xf
v_and_b32_dpp v109, v21, v5 row_newbcast:4 row_mask:0xf bank_mask:0xf
v_and_b32_dpp v110, v21, v6 row_newbcast:4 row_mask:0xf bank_mask:0xf
v_and_b32_dpp v111, v21, v7 row_newbcast:4 row_mask:0xf bank_mask:0xf
v_mfma_f32_16x16x32_bf16 v[112:115], v[104:107], v[92:95], v[112:115]
s_xor_b32 s64, s65, 230400
s_waitcnt vmcnt(5)
buffer_load_dwordx4 v[156:159], v1, s[44:47], s64 offen nt
v_and_b32_dpp v104, v12, v4 row_newbcast:8 row_mask:0xf bank_mask:0xf
v_and_b32_dpp v105, v12, v5 row_newbcast:8 row_mask:0xf bank_mask:0xf
v_and_b32_dpp v106, v12, v6 row_newbcast:8 row_mask:0xf bank_mask:0xf
v_and_b32_dpp v107, v12, v7 row_newbcast:8 row_mask:0xf bank_mask:0xf
v_mfma_f32_16x16x32_bf16 v[112:115], v[108:111], v[132:135], v[112:115]
s_cmp_lt_u32 s2, 208
s_cbranch_scc0 L_hp_123
v_lshlrev_b32 v160, 2, v0
buffer_load_dword v161, v160, s[36:39], s62 offen offset:0 sc1
L_hp_123:
s_xor_b32 s64, s65, 201728
s_waitcnt vmcnt(5)
buffer_load_dwordx4 v[180:183], v1, s[44:47], s64 offen nt
v_and_b32_dpp v108, v12, v4 row_newbcast:12 row_mask:0xf bank_mask:0xf
v_and_b32_dpp v109, v12, v5 row_newbcast:12 row_mask:0xf bank_mask:0xf
v_and_b32_dpp v110, v12, v6 row_newbcast:12 row_mask:0xf bank_mask:0xf
v_and_b32_dpp v111, v12, v7 row_newbcast:12 row_mask:0xf bank_mask:0xf
v_mfma_f32_16x16x32_bf16 v[112:115], v[104:107], v[136:139], v[112:115]
s_xor_b32 s64, s65, 234496
s_waitcnt vmcnt(5)
buffer_load_dwordx4 v[184:187], v1, s[44:47], s64 offen nt
v_and_b32_dpp v104, v21, v4 row_newbcast:8 row_mask:0xf bank_mask:0xf
v_and_b32_dpp v105, v21, v5 row_newbcast:8 row_mask:0xf bank_mask:0xf
v_and_b32_dpp v106, v21, v6 row_newbcast:8 row_mask:0xf bank_mask:0xf
v_and_b32_dpp v107, v21, v7 row_newbcast:8 row_mask:0xf bank_mask:0xf
v_mfma_f32_16x16x32_bf16 v[112:115], v[108:111], v[140:143], v[112:115]
s_xor_b32 s64, s65, 205824
s_waitcnt vmcnt(7)
buffer_load_dwordx4 v[188:191], v1, s[44:47], s64 offen nt
s_xor_b32 s64, s65, 238592
s_waitcnt vmcnt(7)
buffer_load_dwordx4 v[24:27], v1, s[44:47], s64 offen nt
s_cmp_eq_u32 s34, 2
s_cbranch_scc0 L_w_124
v_mov_b32 v60, 62
s_mov_b64 exec, 1
buffer_store_dword v60, off, s[36:39], s63 offset:0
s_mov_b64 exec, -1
L_w_124:
s_xor_b32 s64, s65, 209920
s_waitcnt vmcnt(7)
buffer_load_dwordx4 v[28:31], v1, s[44:47], s64 offen nt
v_and_b32_dpp v108, v21, v4 row_newbcast:12 row_mask:0xf bank_mask:0xf
v_and_b32_dpp v109, v21, v5 row_newbcast:12 row_mask:0xf bank_mask:0xf
v_and_b32_dpp v110, v21, v6 row_newbcast:12 row_mask:0xf bank_mask:0xf
v_and_b32_dpp v111, v21, v7 row_newbcast:12 row_mask:0xf bank_mask:0xf
v_mfma_f32_16x16x32_bf16 v[112:115], v[104:107], v[144:147], v[112:115]
s_xor_b32 s64, s65, 242688
s_waitcnt vmcnt(7)
buffer_load_dwordx4 v[32:35], v1, s[44:47], s64 offen nt
v_and_b32_dpp v104, v14, v4 row_newbcast:0 row_mask:0xf bank_mask:0xf
v_and_b32_dpp v105, v14, v5 row_newbcast:0 row_mask:0xf bank_mask:0xf
v_and_b32_dpp v106, v14, v6 row_newbcast:0 row_mask:0xf bank_mask:0xf
v_and_b32_dpp v107, v14, v7 row_newbcast:0 row_mask:0xf bank_mask:0xf
v_mfma_f32_16x16x32_bf16 v[112:115], v[108:111], v[148:151], v[112:115]
s_cmp_lt_u32 s2, 208
s_cbranch_scc0 L_nohelp
v_lshrrev_b32 v176, 3, v0
v_sub_u32 v176, 63, v176
v_and_b32 v172, 7, v0
v_lshlrev_b32 v172, 7, v172
v_bfe_u32 v162, v176, 0, 1
v_lshl_or_b32 v172, v162, 15, v172
v_bfe_u32 v162, v176, 1, 1
v_lshl_or_b32 v172, v162, 12, v172
v_bfe_u32 v162, v176, 2, 1
v_lshl_or_b32 v172, v162, 13, v172
v_bfe_u32 v162, v176, 3, 1
v_lshl_or_b32 v172, v162, 16, v172
v_bfe_u32 v162, v176, 4, 1
v_lshl_or_b32 v172, v162, 10, v172
v_bfe_u32 v162, v176, 5, 1
v_lshl_or_b32 v172, v162, 17, v172
v_lshrrev_b32 v177, 3, v0
v_sub_u32 v177, 55, v177
v_and_b32 v173, 7, v0
v_lshlrev_b32 v173, 7, v173
v_bfe_u32 v162, v177, 0, 1
v_lshl_or_b32 v173, v162, 15, v173
v_bfe_u32 v162, v177, 1, 1
v_lshl_or_b32 v173, v162, 12, v173
v_bfe_u32 v162, v177, 2, 1
v_lshl_or_b32 v173, v162, 13, v173
v_bfe_u32 v162, v177, 3, 1
v_lshl_or_b32 v173, v162, 16, v173
v_bfe_u32 v162, v177, 4, 1
v_lshl_or_b32 v173, v162, 10, v173
v_bfe_u32 v162, v177, 5, 1
v_lshl_or_b32 v173, v162, 17, v173
v_lshrrev_b32 v178, 3, v0
v_sub_u32 v178, 47, v178
v_and_b32 v174, 7, v0
v_lshlrev_b32 v174, 7, v174
v_bfe_u32 v162, v178, 0, 1
v_lshl_or_b32 v174, v162, 15, v174
v_bfe_u32 v162, v178, 1, 1
v_lshl_or_b32 v174, v162, 12, v174
v_bfe_u32 v162, v178, 2, 1
v_lshl_or_b32 v174, v162, 13, v174
v_bfe_u32 v162, v178, 3, 1
v_lshl_or_b32 v174, v162, 16, v174
v_bfe_u32 v162, v178, 4, 1
v_lshl_or_b32 v174, v162, 10, v174
v_bfe_u32 v162, v178, 5, 1
v_lshl_or_b32 v174, v162, 17, v174
v_lshrrev_b32 v179, 3, v0
v_sub_u32 v179, 39, v179
v_and_b32 v175, 7, v0
v_lshlrev_b32 v175, 7, v175
v_bfe_u32 v162, v179, 0, 1
v_lshl_or_b32 v175, v162, 15, v175
v_bfe_u32 v162, v179, 1, 1
v_lshl_or_b32 v175, v162, 12, v175
v_bfe_u32 v162, v179, 2, 1
v_lshl_or_b32 v175, v162, 13, v175
v_bfe_u32 v162, v179, 3, 1
v_lshl_or_b32 v175, v162, 16, v175
v_bfe_u32 v162, v179, 4, 1
v_lshl_or_b32 v175, v162, 10, v175
v_bfe_u32 v162, v179, 5, 1
v_lshl_or_b32 v175, v162, 17, v175
s_lshr_b32 s71, s2, 3
v_subrev_u32 v163, s71, v0
v_and_b32 v163, 31, v163
s_waitcnt vmcnt(6)
v_mov_b32 v162, v161
s_nop 1
v_permlane32_swap_b32 v161, v162
v_add_u32 v161, 1, v161
v_max_u32 v161, 7, v161
v_cmp_eq_u32 vcc, -1, v162
v_mov_b32 v160, 0xff
s_nop 0
v_cndmask_b32 v161, v160, v161, vcc
v_lshl_or_b32 v161, v161, 5, v163
s_nop 1
v_min_u32_dpp v161, v161, v161 quad_perm:[1,0,3,2] row_mask:0xf bank_mask:0xf
s_nop 1
v_min_u32_dpp v161, v161, v161 quad_perm:[2,3,0,1] row_mask:0xf bank_mask:0xf
s_nop 1
v_min_u32_dpp v161, v161, v161 row_ror:4 row_mask:0xf bank_mask:0xf
s_nop 1
v_min_u32_dpp v161, v161, v161 row_ror:8 row_mask:0xf bank_mask:0xf
s_nop 1
v_readlane_b32 s76, v161, 0
v_readlane_b32 s66, v161, 16
s_min_u32 s76, s76, s66
s_lshr_b32 s66, s76, 5
s_cmp_lt_u32 s66, 50
s_cbranch_scc0 L_drain
s_mov_b32 s48, s8
s_mov_b32 s49, s9
s_mov_b32 s50, 0x10000000
s_mov_b32 s51, 0x20000
s_lshr_b32 s64, s2, 3
s_add_u32 s76, s76, s64
s_and_b32 s76, s76, 31
s_lshl_b32 s67, s76, 2
s_add_u32 s67, s67, s62
s_lshl_b32 s76, s76, 3
s_and_b32 s64, s2, 7
s_or_b32 s76, s76, s64
s_and_b32 s64, s34, 1
s_lshl_b32 s64, s64, 14
s_lshr_b32 s71, s34, 1
s_lshl_b32 s71, s71, 11
s_or_b32 s64, s64, s71
s_lshl_b32 s71, s76, 10
s_xor_b32 s64, s64, s71
s_or_b32 s64, s64, 0xC0000
s_lshl_b32 s76, s76, 20
s_xor_b32 s76, s76, s64
s_add_u32 s66, s66, 11
v_xor_b32 v175, s76, v175
v_cmp_lt_u32 vcc, s66, v179
s_or_b64 exec, vcc, 1
buffer_load_dword v160, v175, s[48:51], 0 offen
s_mov_b64 exec, -1
v_xor_b32 v174, s76, v174
v_cmp_lt_u32 vcc, s66, v178
s_or_b64 exec, vcc, 1
buffer_load_dword v160, v174, s[48:51], 0 offen
s_mov_b64 exec, -1
v_xor_b32 v173, s76, v173
v_cmp_lt_u32 vcc, s66, v177
s_or_b64 exec, vcc, 1
buffer_load_dword v160, v173, s[48:51], 0 offen
s_mov_b64 exec, -1
v_xor_b32 v172, s76, v172
v_cmp_lt_u32 vcc, s66, v176
s_or_b64 exec, vcc, 1
buffer_load_dword v160, v172, s[48:51], 0 offen
s_mov_b64 exec, -1
s_mov_b64 exec, 1
buffer_store_dword v1, off, s[36:39], s67 offset:128
s_mov_b64 exec, -1
s_waitcnt vmcnt(12)
v_and_b32_dpp v108, v14, v4 row_newbcast:4 row_mask:0xf bank_mask:0xf
v_and_b32_dpp v109, v14, v5 row_newbcast:4 row_mask:0xf bank_mask:0xf
v_and_b32_dpp v110, v14, v6 row_newbcast:4 row_mask:0xf bank_mask:0xf
v_and_b32_dpp v111, v14, v7 row_newbcast:4 row_mask:0xf bank_mask:0xf
v_mfma_f32_16x16x32_bf16 v[112:115], v[104:107], v[152:155], v[112:115]
s_waitcnt vmcnt(11)
v_and_b32_dpp v104, v23, v4 row_newbcast:0 row_mask:0xf bank_mask:0xf
v_and_b32_dpp v105, v23, v5 row_newbcast:0 row_mask:0xf bank_mask:0xf
v_and_b32_dpp v106, v23, v6 row_newbcast:0 row_mask:0xf bank_mask:0xf
v_and_b32_dpp v107, v23, v7 row_newbcast:0 row_mask:0xf bank_mask:0xf
v_mfma_f32_16x16x32_bf16 v[112:115], v[108:111], v[156:159], v[112:115]
s_waitcnt vmcnt(10)
v_and_b32_dpp v108, v23, v4 row_newbcast:4 row_mask:0xf bank_mask:0xf
v_and_b32_dpp v109, v23, v5 row_newbcast:4 row_mask:0xf bank_mask:0xf
v_and_b32_dpp v110, v23, v6 row_newbcast:4 row_mask:0xf bank_mask:0xf
v_and_b32_dpp v111, v23, v7 row_newbcast:4 row_mask:0xf bank_mask:0xf
v_mfma_f32_16x16x32_bf16 v[112:115], v[104:107], v[180:183], v[112:115]
s_waitcnt vmcnt(9)
v_and_b32_dpp v104, v14, v4 row_newbcast:8 row_mask:0xf bank_mask:0xf
v_and_b32_dpp v105, v14, v5 row_newbcast:8 row_mask:0xf bank_mask:0xf
v_and_b32_dpp v106, v14, v6 row_newbcast:8 row_mask:0xf bank_mask:0xf
v_and_b32_dpp v107, v14, v7 row_newbcast:8 row_mask:0xf bank_mask:0xf
v_mfma_f32_16x16x32_bf16 v[112:115], v[108:111], v[184:187], v[112:115]
s_waitcnt vmcnt(8)
v_and_b32_dpp v108, v14, v4 row_newbcast:12 row_mask:0xf bank_mask:0xf
v_and_b32_dpp v109, v14, v5 row_newbcast:12 row_mask:0xf bank_mask:0xf
v_and_b32_dpp v110, v14, v6 row_newbcast:12 row_mask:0xf bank_mask:0xf
v_and_b32_dpp v111, v14, v7 row_newbcast:12 row_mask:0xf bank_mask:0xf
v_mfma_f32_16x16x32_bf16 v[112:115], v[104:107], v[188:191], v[112:115]
s_waitcnt vmcnt(7)
v_and_b32_dpp v104, v23, v4 row_newbcast:8 row_mask:0xf bank_mask:0xf
v_and_b32_dpp v105, v23, v5 row_newbcast:8 row_mask:0xf bank_mask:0xf
v_and_b32_dpp v106, v23, v6 row_newbcast:8 row_mask:0xf bank_mask:0xf
v_and_b32_dpp v107, v23, v7 row_newbcast:8 row_mask:0xf bank_mask:0xf
v_mfma_f32_16x16x32_bf16 v[112:115], v[108:111], v[24:27], v[112:115]
s_waitcnt vmcnt(6)
v_and_b32_dpp v108, v23, v4 row_newbcast:12 row_mask:0xf bank_mask:0xf
v_and_b32_dpp v109, v23, v5 row_newbcast:12 row_mask:0xf bank_mask:0xf
v_and_b32_dpp v110, v23, v6 row_newbcast:12 row_mask:0xf bank_mask:0xf
v_and_b32_dpp v111, v23, v7 row_newbcast:12 row_mask:0xf bank_mask:0xf
v_mfma_f32_16x16x32_bf16 v[112:115], v[104:107], v[28:31], v[112:115]
s_waitcnt vmcnt(5)
v_mfma_f32_16x16x32_bf16 v[112:115], v[108:111], v[32:35], v[112:115]
s_branch L_drained
L_nohelp:
L_drain:
s_waitcnt vmcnt(7)
v_and_b32_dpp v108, v14, v4 row_newbcast:4 row_mask:0xf bank_mask:0xf
v_and_b32_dpp v109, v14, v5 row_newbcast:4 row_mask:0xf bank_mask:0xf
v_and_b32_dpp v110, v14, v6 row_newbcast:4 row_mask:0xf bank_mask:0xf
v_and_b32_dpp v111, v14, v7 row_newbcast:4 row_mask:0xf bank_mask:0xf
v_mfma_f32_16x16x32_bf16 v[112:115], v[104:107], v[152:155], v[112:115]
s_waitcnt vmcnt(6)
v_and_b32_dpp v104, v23, v4 row_newbcast:0 row_mask:0xf bank_mask:0xf
v_and_b32_dpp v105, v23, v5 row_newbcast:0 row_mask:0xf bank_mask:0xf
v_and_b32_dpp v106, v23, v6 row_newbcast:0 row_mask:0xf bank_mask:0xf
v_and_b32_dpp v107, v23, v7 row_newbcast:0 row_mask:0xf bank_mask:0xf
v_mfma_f32_16x16x32_bf16 v[112:115], v[108:111], v[156:159], v[112:115]
s_waitcnt vmcnt(5)
v_and_b32_dpp v108, v23, v4 row_newbcast:4 row_mask:0xf bank_mask:0xf
v_and_b32_dpp v109, v23, v5 row_newbcast:4 row_mask:0xf bank_mask:0xf
v_and_b32_dpp v110, v23, v6 row_newbcast:4 row_mask:0xf bank_mask:0xf
v_and_b32_dpp v111, v23, v7 row_newbcast:4 row_mask:0xf bank_mask:0xf
v_mfma_f32_16x16x32_bf16 v[112:115], v[104:107], v[180:183], v[112:115]
s_waitcnt vmcnt(4)
v_and_b32_dpp v104, v14, v4 row_newbcast:8 row_mask:0xf bank_mask:0xf
v_and_b32_dpp v105, v14, v5 row_newbcast:8 row_mask:0xf bank_mask:0xf
v_and_b32_dpp v106, v14, v6 row_newbcast:8 row_mask:0xf bank_mask:0xf
v_and_b32_dpp v107, v14, v7 row_newbcast:8 row_mask:0xf bank_mask:0xf
v_mfma_f32_16x16x32_bf16 v[112:115], v[108:111], v[184:187], v[112:115]
s_waitcnt vmcnt(3)
v_and_b32_dpp v108, v14, v4 row_newbcast:12 row_mask:0xf bank_mask:0xf
v_and_b32_dpp v109, v14, v5 row_newbcast:12 row_mask:0xf bank_mask:0xf
v_and_b32_dpp v110, v14, v6 row_newbcast:12 row_mask:0xf bank_mask:0xf
v_and_b32_dpp v111, v14, v7 row_newbcast:12 row_mask:0xf bank_mask:0xf
v_mfma_f32_16x16x32_bf16 v[112:115], v[104:107], v[188:191], v[112:115]
s_waitcnt vmcnt(2)
v_and_b32_dpp v104, v23, v4 row_newbcast:8 row_mask:0xf bank_mask:0xf
v_and_b32_dpp v105, v23, v5 row_newbcast:8 row_mask:0xf bank_mask:0xf
v_and_b32_dpp v106, v23, v6 row_newbcast:8 row_mask:0xf bank_mask:0xf
v_and_b32_dpp v107, v23, v7 row_newbcast:8 row_mask:0xf bank_mask:0xf
v_mfma_f32_16x16x32_bf16 v[112:115], v[108:111], v[24:27], v[112:115]
s_waitcnt vmcnt(1)
v_and_b32_dpp v108, v23, v4 row_newbcast:12 row_mask:0xf bank_mask:0xf
v_and_b32_dpp v109, v23, v5 row_newbcast:12 row_mask:0xf bank_mask:0xf
v_and_b32_dpp v110, v23, v6 row_newbcast:12 row_mask:0xf bank_mask:0xf
v_and_b32_dpp v111, v23, v7 row_newbcast:12 row_mask:0xf bank_mask:0xf
v_mfma_f32_16x16x32_bf16 v[112:115], v[104:107], v[28:31], v[112:115]
s_waitcnt vmcnt(0)
v_mfma_f32_16x16x32_bf16 v[112:115], v[108:111], v[32:35], v[112:115]
L_drained:
v_and_b32 v2, 15, v0
v_lshlrev_b32 v2, 5, v2
v_and_b32 v3, 16, v0
v_add_u32 v2, v2, v3
s_lshl_b32 s68, s34, 9
v_add_u32 v2, s68, v2
s_mov_b32 exec_hi, 0
s_nop 1
ds_write_b128 v2, v[112:115] offset:512
s_mov_b32 exec_hi, -1
v_lshlrev_b32 v1, 4, v0
s_waitcnt lgkmcnt(0)
s_barrier
v_mov_b32 v2, 0
ds_read_b32 v3, v2 offset:328
s_waitcnt lgkmcnt(0)
v_readfirstlane_b32 s35, v3
s_branch L_tail_s
L_fin:
L_end:
s_endpgm
L_code_end:
.section .rodata,"a"
.p2align 6
.amdhsa_kernel adaLN_cond__sliding_block_cached__glu_gated_glu__decode_kernel
  .amdhsa_next_free_vgpr 256
  .amdhsa_next_free_sgpr 102
  .amdhsa_accum_offset 256
  .amdhsa_group_segment_fixed_size 0
  .amdhsa_kernarg_size 112
  .amdhsa_user_sgpr_count 2
  .amdhsa_user_sgpr_kernarg_segment_ptr 1
  .amdhsa_system_sgpr_workgroup_id_x 1
  .amdhsa_float_denorm_mode_32 3
.end_amdhsa_kernel
```
